```python
import torch

def _softmax(x, axis=-1):
    return torch.softmax(x, dim=axis)
def _gelu(x):
    return torch.nn.functional.gelu(x, approximate="tanh")
def _silu(x):
    return torch.nn.functional.silu(x)
def _sigmoid(x):
    return torch.sigmoid(x)
def _layernorm(x, axis=-1, eps=1e-5):
    m = x.mean(dim=axis, keepdim=True)
    v = x.var(dim=axis, keepdim=True, unbiased=False)
    return (x - m) / torch.sqrt(v + eps)
def _scatter_add(tgt, idx, src, axis=0):
    return tgt.clone().index_add_(axis, idx, src)
def _segment_sum(src, seg, n):
    out = torch.zeros((n,) + src.shape[1:], dtype=src.dtype)
    return out.index_add_(0, seg, src)
def _pad(x, pw):
    flat = tuple(v for pair in reversed(pw) for v in pair)
    return torch.nn.functional.pad(x, flat)

kernel_name = 'recurrent_scan__spectral_fnet__moe_arch_mod__prompt'

def setup_inputs():

    _w = (lambda a: (lambda t: t.to(torch.bfloat16) if t.is_floating_point() else t)(torch.as_tensor(a)))
    def _A_setup():
        B, S, D = 1, 2048, 1024
        ns = torch.arange(S)[:, None] * torch.arange(S)[None, :]
        nd = torch.arange(D)[:, None] * torch.arange(D)[None, :]
        Ws_re = torch.cos(-2.0 * torch.pi * ns / S).to(float)
        Ws_im = torch.sin(-2.0 * torch.pi * ns / S).to(float)
        Wd_re = torch.cos(-2.0 * torch.pi * nd / D).to(float)
        Wd_im = torch.sin(-2.0 * torch.pi * nd / D).to(float)
        return {
            "x": _w((lambda *s: torch.randn(*s, dtype=torch.bfloat16) * 0.05)(B, S, D)),
            "dft_seq_re": _w(Ws_re),
            "dft_seq_im": _w(Ws_im),
            "dft_hid_re": _w(Wd_re),
            "dft_hid_im": _w(Wd_im),
        }
    _A_in = _A_setup()

    def _B_setup():
        B, S, D, F, C = 1, 2048, 1024, 3584, 1
        return {
            "x": _w((lambda *s: torch.randn(*s, dtype=torch.bfloat16) * 0.05)(B, S, D)),
            "w_r": _w((lambda *s: torch.randn(*s, dtype=torch.bfloat16) * 0.05)(D)),
            "w_gate": _w((lambda *s: torch.randn(*s, dtype=torch.bfloat16) * 0.05)(D, F)),
            "w_up": _w((lambda *s: torch.randn(*s, dtype=torch.bfloat16) * 0.05)(D, F)),
            "w_down": _w((lambda *s: torch.randn(*s, dtype=torch.bfloat16) * 0.05)(F, D)),
        }
    _B_in = _B_setup()

    return {
        "A_x": _A_in["x"],
        "A_dft_seq_re": _A_in["dft_seq_re"],
        "A_dft_seq_im": _A_in["dft_seq_im"],
        "A_dft_hid_re": _A_in["dft_hid_re"],
        "A_dft_hid_im": _A_in["dft_hid_im"],
        "B_x": _B_in["x"],
        "B_w_r": _B_in["w_r"],
        "B_w_gate": _B_in["w_gate"],
        "B_w_up": _B_in["w_up"],
        "B_w_down": _B_in["w_down"],
    }

def reference(A_x, A_dft_seq_re, A_dft_seq_im, A_dft_hid_re, A_dft_hid_im, B_x, B_w_r, B_w_gate, B_w_up, B_w_down):
    def _A_ref(x, dft_seq_re, dft_seq_im, dft_hid_re, dft_hid_im):
        a = torch.einsum("bsd,ed->bse", x, dft_hid_re)
        b = torch.einsum("bsd,ed->bse", x, dft_hid_im)
        y = torch.einsum("ts,bse->bte", dft_seq_re, a) - torch.einsum("ts,bse->bte", dft_seq_im, b)
        return y

    def _B_ref(x, w_r, w_gate, w_up, w_down):
        B, S, D = x.shape
        C = 1
        r = x @ w_r
        idx = torch.argsort(-r, axis=-1)[:, :C]
        idx_e = (lambda x, n, axis: torch.repeat_interleave(x, n, dim=axis))(idx.reshape(B, C, 1), D, axis=2)
        x_sel = (lambda x, i, axis: torch.take_along_dim(x, i, dim=axis))(x, idx_e, axis=1)
        g = _silu(x_sel @ w_gate)
        u = x_sel @ w_up
        y = (g * u) @ w_down
        r_sel = _sigmoid((lambda x, i, axis: torch.take_along_dim(x, i, dim=axis))(r, idx, axis=1))
        y = y * r_sel.reshape(B, C, 1)
        b_off = (torch.arange(B) * S).reshape(B, 1)
        flat_idx = (idx + b_off).reshape(B * C)
        zero = (x * 0.0).reshape(B * S, D)
        upd = _scatter_add(zero, flat_idx, y.reshape(B * C, D), axis=0)
        return x + upd.reshape(B, S, D)

    x = A_x
    xn = _layernorm(x, axis=-1)
    s = _A_ref(xn, A_dft_seq_re, A_dft_seq_im, A_dft_hid_re, A_dft_hid_im)
    g = _silu(_B_ref(xn, B_w_r, B_w_gate, B_w_up, B_w_down))
    return x + s * g
```

```asm
; @launch grid=(482,1,1) block=(512,1,1) lds=59392
.amdgcn_target "amdgcn-amd-amdhsa--gfx950"
.text
.globl recurrent_scan__spectral_fnet__moe_arch_mod__prompt_kernel
.p2align 8
.type recurrent_scan__spectral_fnet__moe_arch_mod__prompt_kernel,@function
recurrent_scan__spectral_fnet__moe_arch_mod__prompt_kernel:
    s_cmp_ge_u32 s2, 482
    s_cbranch_scc1 L_exit
    s_load_dwordx2 s[4:5], s[0:1], 0
    s_load_dwordx2 s[6:7], s[0:1], 96
    s_load_dwordx8 s[36:43], s[0:1], 48
    s_load_dwordx2 s[44:45], s[0:1], 80
    v_lshrrev_b32 v1, 6, v0
    v_and_b32 v2, 63, v0
    v_readfirstlane_b32 s30, v1
    s_mov_b32 s10, 0x400000
    s_mov_b32 s11, 0x00020000
    s_mov_b32 s14, 0x10000000
    s_mov_b32 s15, 0x00020000
    s_mov_b32 s35, 65536
    s_sub_u32 s31, s2, 256
    s_cmp_lt_u32 s31, 224
    s_cbranch_scc1 L_moe
    s_and_b32 s31, s2, 7
    s_lshr_b32 s32, s2, 4
    s_lshl_b32 s32, s32, 3
    s_add_u32 s46, s32, s31
    s_bfe_u32 s47, s2, 0x10003
    s_and_b32 s31, s2, 1
    s_cmp_lt_u32 s2, 256
    s_cselect_b32 s46, s46, 128
    s_cselect_b32 s47, s47, s31
    s_lshl_b32 s31, s30, 8
    s_add_u32 s31, s31, s46
    s_sub_u32 s32, 2048, s31
    s_and_b32 s32, s32, 2047
    s_cmp_eq_u32 s47, 0
    s_cselect_b32 s48, s31, s32
    s_cselect_b32 s49, s32, s31
    s_lshl_b32 s54, s48, 11
    s_lshl_b32 s55, s49, 11
    v_lshlrev_b32 v3, 4, v2
    s_and_b32 s51, s48, 255
    s_and_b32 s31, s46, 127
    s_cmp_lg_u32 s31, 0
    s_cselect_b32 s50, 1, 0
    s_xor_b32 s31, s47, 1
    s_or_b32 s50, s50, s31
    s_mul_i32 s31, s51, 4608
    s_add_u32 s31, s31, 262144
    s_cmp_lt_u32 s51, 224
    s_cselect_b32 s32, s50, 0
    s_cmp_eq_u32 s32, 1
    s_cselect_b32 s31, s31, 2147483392
    v_lshlrev_b32 v5, 4, v0
    v_add_u32 v5, s31, v5
    v_mov_b32 v6, 2147483392
    v_cmp_gt_u32 vcc, 288, v0
    s_nop 1
    v_cndmask_b32 v5, v6, v5, vcc
    v_mov_b32 v116, -1
    v_mov_b32 v117, -1
    v_mov_b32 v118, -1
    v_mov_b32 v119, -1
    s_mov_b32 s22, 2048
    s_mov_b32 s23, 0x00020000
    s_mov_b32 s18, 0x400000
    s_mov_b32 s19, 0x00020000
    s_waitcnt lgkmcnt(0)
    s_mov_b32 s8, s4
    s_mov_b32 s9, s5
    s_mov_b32 s12, s6
    s_mov_b32 s13, s7
    s_mov_b32 s20, s36
    s_mov_b32 s21, s37
    s_mov_b32 s16, s44
    s_mov_b32 s17, s45
    buffer_load_dwordx4 v[80:83], v3, s[8:11], s54 offen
    buffer_load_dwordx4 v[84:87], v3, s[8:11], s54 offen offset:1024
    buffer_load_dwordx4 v[104:107], v3, s[20:23], 0 offen
    buffer_load_dwordx4 v[108:111], v3, s[20:23], 0 offen offset:1024
    buffer_load_dwordx4 v[88:91], v3, s[8:11], s55 offen
    buffer_load_dwordx4 v[92:95], v3, s[8:11], s55 offen offset:1024
    buffer_store_dwordx4 v[116:119], v5, s[12:15], 0 offen sc1
    s_load_dwordx2 s[28:29], s[6:7], 0
    v_mov_b32 v6, 0
    v_mov_b32 v7, 0
    v_mov_b32 v5, 57920
    ds_write_b64 v5, v[6:7]
    s_lshl_b32 s31, s51, 7
    s_add_u32 s31, s31, 32768
    v_add_u32 v4, s31, v3
    s_lshl_b32 s31, s51, 6
    s_add_u32 s31, s31, 4096
    v_writelane_b32 v4, s31, 8
    v_mov_b32 v6, 2147483392
    v_cmp_gt_u32 vcc, 9, v2
    s_nop 1
    v_cndmask_b32 v4, v6, v4, vcc
    v_bfe_u32 v96, v2, 2, 2
    s_lshl_b32 s31, s47, 2
    v_add_u32 v96, s31, v96
    v_lshrrev_b32 v97, 4, v2
    v_bfe_u32 v98, v2, 1, 1
    v_mul_u32_u24 v97, v97, v98
    v_and_b32 v98, 1, v2
    v_add_u32 v97, v97, v98
    v_cvt_f32_u32 v96, v96
    v_cvt_f32_u32 v97, v97
    v_mul_f32 v96, 0x3e000000, v96
    v_mul_f32 v97, 0x3e800000, v97
    s_and_b32 s31, s46, 127
    s_cmp_lg_u32 s31, 0
    s_cselect_b32 s31, 1.0, 0.5
    v_cos_f32 v98, v97
    v_add_f32 v97, v97, v96
    v_cos_f32 v99, v97
    v_add_f32 v97, v97, v96
    v_mul_f32 v98, s31, v98
    v_mul_f32 v99, s31, v99
    v_cvt_pk_bf16_f32 v8, v98, v99
    v_cos_f32 v98, v97
    v_add_f32 v97, v97, v96
    v_cos_f32 v99, v97
    v_add_f32 v97, v97, v96
    v_mul_f32 v98, s31, v98
    v_mul_f32 v99, s31, v99
    v_cvt_pk_bf16_f32 v9, v98, v99
    v_cos_f32 v98, v97
    v_add_f32 v97, v97, v96
    v_cos_f32 v99, v97
    v_add_f32 v97, v97, v96
    v_mul_f32 v98, s31, v98
    v_mul_f32 v99, s31, v99
    v_cvt_pk_bf16_f32 v10, v98, v99
    v_cos_f32 v98, v97
    v_add_f32 v97, v97, v96
    v_cos_f32 v99, v97
    v_add_f32 v97, v97, v96
    v_mul_f32 v98, s31, v98
    v_mul_f32 v99, s31, v99
    v_cvt_pk_bf16_f32 v11, v98, v99
    v_bfe_u32 v98, v2, 4, 1
    v_sub_u32 v98, 0, v98
    v_and_b32 v98, 0x80008000, v98
    v_xor_b32 v12, v98, v8
    v_xor_b32 v13, v98, v9
    v_xor_b32 v14, v98, v10
    v_xor_b32 v15, v98, v11
    s_cmp_ge_u32 s30, 4
    s_cbranch_scc1 L_light_consts
    v_lshrrev_b32 v96, 2, v2
    v_and_b32 v96, 12, v96
    v_and_b32 v97, 15, v2
    v_lshlrev_b32 v97, 2, v97
    v_cvt_f32_u32 v96, v96
    v_cvt_f32_u32 v97, v97
    v_mul_f32 v96, 0x3c800000, v96
    s_lshl_b32 s31, s47, 2
    s_add_u32 s52, s31, s30
    s_mul_i32 s31, s52, s46
    v_cvt_f32_u32 v98, s31
    v_mul_f32 v98, 0x3a000000, v98
    s_mov_b32 s31, 0x3d800000
    v_mov_b32 v99, v96
    v_add_f32 v100, 0x3c800000, v96
    v_add_f32 v101, 0x3d000000, v96
    v_add_f32 v102, 0x3d400000, v96
    v_mul_f32 v96, v99, v97
    v_fma_f32 v52, v96, s31, v98
    v_sin_f32 v20, v96
    v_cos_f32 v96, v96
    v_cos_f32 v48, v52
    v_sin_f32 v52, v52
    v_cvt_pk_f16_f32 v16, v96, v20
    v_cvt_pk_f16_f32 v20, -v20, v96
    v_mul_f32 v96, v100, v97
    v_fma_f32 v53, v96, s31, v98
    v_sin_f32 v21, v96
    v_cos_f32 v96, v96
    v_cos_f32 v49, v53
    v_sin_f32 v53, v53
    v_cvt_pk_f16_f32 v17, v96, v21
    v_cvt_pk_f16_f32 v21, -v21, v96
    v_mul_f32 v96, v101, v97
    v_fma_f32 v54, v96, s31, v98
    v_sin_f32 v22, v96
    v_cos_f32 v96, v96
    v_cos_f32 v50, v54
    v_sin_f32 v54, v54
    v_cvt_pk_f16_f32 v18, v96, v22
    v_cvt_pk_f16_f32 v22, -v22, v96
    v_mul_f32 v96, v102, v97
    v_fma_f32 v55, v96, s31, v98
    v_sin_f32 v23, v96
    v_cos_f32 v96, v96
    v_cos_f32 v51, v55
    v_sin_f32 v55, v55
    v_cvt_pk_f16_f32 v19, v96, v23
    v_cvt_pk_f16_f32 v23, -v23, v96
    v_add_f32 v97, 1.0, v97
    v_mul_f32 v96, v99, v97
    v_fma_f32 v60, v96, s31, v98
    v_sin_f32 v28, v96
    v_cos_f32 v96, v96
    v_cos_f32 v56, v60
    v_sin_f32 v60, v60
    v_cvt_pk_f16_f32 v24, v96, v28
    v_cvt_pk_f16_f32 v28, -v28, v96
    v_mul_f32 v96, v100, v97
    v_fma_f32 v61, v96, s31, v98
    v_sin_f32 v29, v96
    v_cos_f32 v96, v96
    v_cos_f32 v57, v61
    v_sin_f32 v61, v61
    v_cvt_pk_f16_f32 v25, v96, v29
    v_cvt_pk_f16_f32 v29, -v29, v96
    v_mul_f32 v96, v101, v97
    v_fma_f32 v62, v96, s31, v98
    v_sin_f32 v30, v96
    v_cos_f32 v96, v96
    v_cos_f32 v58, v62
    v_sin_f32 v62, v62
    v_cvt_pk_f16_f32 v26, v96, v30
    v_cvt_pk_f16_f32 v30, -v30, v96
    v_mul_f32 v96, v102, v97
    v_fma_f32 v63, v96, s31, v98
    v_sin_f32 v31, v96
    v_cos_f32 v96, v96
    v_cos_f32 v59, v63
    v_sin_f32 v63, v63
    v_cvt_pk_f16_f32 v27, v96, v31
    v_cvt_pk_f16_f32 v31, -v31, v96
    v_add_f32 v97, 1.0, v97
    v_mul_f32 v96, v99, v97
    v_fma_f32 v68, v96, s31, v98
    v_sin_f32 v36, v96
    v_cos_f32 v96, v96
    v_cos_f32 v64, v68
    v_sin_f32 v68, v68
    v_cvt_pk_f16_f32 v32, v96, v36
    v_cvt_pk_f16_f32 v36, -v36, v96
    v_mul_f32 v96, v100, v97
    v_fma_f32 v69, v96, s31, v98
    v_sin_f32 v37, v96
    v_cos_f32 v96, v96
    v_cos_f32 v65, v69
    v_sin_f32 v69, v69
    v_cvt_pk_f16_f32 v33, v96, v37
    v_cvt_pk_f16_f32 v37, -v37, v96
    v_mul_f32 v96, v101, v97
    v_fma_f32 v70, v96, s31, v98
    v_sin_f32 v38, v96
    v_cos_f32 v96, v96
    v_cos_f32 v66, v70
    v_sin_f32 v70, v70
    v_cvt_pk_f16_f32 v34, v96, v38
    v_cvt_pk_f16_f32 v38, -v38, v96
    v_mul_f32 v96, v102, v97
    v_fma_f32 v71, v96, s31, v98
    v_sin_f32 v39, v96
    v_cos_f32 v96, v96
    v_cos_f32 v67, v71
    v_sin_f32 v71, v71
    v_cvt_pk_f16_f32 v35, v96, v39
    v_cvt_pk_f16_f32 v39, -v39, v96
    v_add_f32 v97, 1.0, v97
    v_mul_f32 v96, v99, v97
    v_fma_f32 v76, v96, s31, v98
    v_sin_f32 v44, v96
    v_cos_f32 v96, v96
    v_cos_f32 v72, v76
    v_sin_f32 v76, v76
    v_cvt_pk_f16_f32 v40, v96, v44
    v_cvt_pk_f16_f32 v44, -v44, v96
    v_mul_f32 v96, v100, v97
    v_fma_f32 v77, v96, s31, v98
    v_sin_f32 v45, v96
    v_cos_f32 v96, v96
    v_cos_f32 v73, v77
    v_sin_f32 v77, v77
    v_cvt_pk_f16_f32 v41, v96, v45
    v_cvt_pk_f16_f32 v45, -v45, v96
    v_mul_f32 v96, v101, v97
    v_fma_f32 v78, v96, s31, v98
    v_sin_f32 v46, v96
    v_cos_f32 v96, v96
    v_cos_f32 v74, v78
    v_sin_f32 v78, v78
    v_cvt_pk_f16_f32 v42, v96, v46
    v_cvt_pk_f16_f32 v46, -v46, v96
    v_mul_f32 v96, v102, v97
    v_fma_f32 v79, v96, s31, v98
    v_sin_f32 v47, v96
    v_cos_f32 v96, v96
    v_cos_f32 v75, v79
    v_sin_f32 v79, v79
    v_cvt_pk_f16_f32 v43, v96, v47
    v_cvt_pk_f16_f32 v47, -v47, v96
    s_branch L_consts_done
L_light_consts:
    v_and_b32 v96, 15, v2
    s_lshl_b32 s31, s30, 4
    v_add_u32 v96, s31, v96
    v_lshrrev_b32 v97, 5, v2
    v_bfe_u32 v98, v2, 4, 1
    v_lshlrev_b32 v97, 4, v97
    v_lshl_add_u32 v97, v98, 2, v97
    v_mul_u32_u24 v97, v97, v96
    v_cvt_f32_u32 v96, v96
    v_cvt_f32_u32 v97, v97
    v_mul_f32 v96, 0x3b800000, v96
    v_mul_f32 v97, 0x3b800000, v97
    v_fmamk_f32 v16, v96, 0x0, v97
    v_fmamk_f32 v17, v96, 0x40000000, v97
    v_sin_f32 v98, v16
    v_cos_f32 v16, v16
    v_sin_f32 v99, v17
    v_cos_f32 v17, v17
    v_cvt_pk_f16_f32 v16, v16, v98
    v_cvt_pk_f16_f32 v17, v17, v99
    v_fmamk_f32 v18, v96, 0x41000000, v97
    v_fmamk_f32 v19, v96, 0x41200000, v97
    v_sin_f32 v98, v18
    v_cos_f32 v18, v18
    v_sin_f32 v99, v19
    v_cos_f32 v19, v19
    v_cvt_pk_f16_f32 v18, v18, v98
    v_cvt_pk_f16_f32 v19, v19, v99
    v_fmamk_f32 v20, v96, 0x42000000, v97
    v_fmamk_f32 v21, v96, 0x42080000, v97
    v_sin_f32 v98, v20
    v_cos_f32 v20, v20
    v_sin_f32 v99, v21
    v_cos_f32 v21, v21
    v_cvt_pk_f16_f32 v20, v20, v98
    v_cvt_pk_f16_f32 v21, v21, v99
    v_fmamk_f32 v22, v96, 0x42200000, v97
    v_fmamk_f32 v23, v96, 0x42280000, v97
    v_sin_f32 v98, v22
    v_cos_f32 v22, v22
    v_sin_f32 v99, v23
    v_cos_f32 v23, v23
    v_cvt_pk_f16_f32 v22, v22, v98
    v_cvt_pk_f16_f32 v23, v23, v99
    v_fmamk_f32 v24, v96, 0x42800000, v97
    v_fmamk_f32 v25, v96, 0x42840000, v97
    v_sin_f32 v98, v24
    v_cos_f32 v24, v24
    v_sin_f32 v99, v25
    v_cos_f32 v25, v25
    v_cvt_pk_f16_f32 v24, v24, v98
    v_cvt_pk_f16_f32 v25, v25, v99
    v_fmamk_f32 v26, v96, 0x42900000, v97
    v_fmamk_f32 v27, v96, 0x42940000, v97
    v_sin_f32 v98, v26
    v_cos_f32 v26, v26
    v_sin_f32 v99, v27
    v_cos_f32 v27, v27
    v_cvt_pk_f16_f32 v26, v26, v98
    v_cvt_pk_f16_f32 v27, v27, v99
    v_fmamk_f32 v28, v96, 0x42c00000, v97
    v_fmamk_f32 v29, v96, 0x42c40000, v97
    v_sin_f32 v98, v28
    v_cos_f32 v28, v28
    v_sin_f32 v99, v29
    v_cos_f32 v29, v29
    v_cvt_pk_f16_f32 v28, v28, v98
    v_cvt_pk_f16_f32 v29, v29, v99
    v_fmamk_f32 v30, v96, 0x42d00000, v97
    v_fmamk_f32 v31, v96, 0x42d40000, v97
    v_sin_f32 v98, v30
    v_cos_f32 v30, v30
    v_sin_f32 v99, v31
    v_cos_f32 v31, v31
    v_cvt_pk_f16_f32 v30, v30, v98
    v_cvt_pk_f16_f32 v31, v31, v99
    v_fmamk_f32 v32, v96, 0x3f800000, v97
    v_fmamk_f32 v33, v96, 0x40400000, v97
    v_sin_f32 v98, v32
    v_cos_f32 v32, v32
    v_sin_f32 v99, v33
    v_cos_f32 v33, v33
    v_cvt_pk_f16_f32 v32, v32, v98
    v_cvt_pk_f16_f32 v33, v33, v99
    v_fmamk_f32 v34, v96, 0x41100000, v97
    v_fmamk_f32 v35, v96, 0x41300000, v97
    v_sin_f32 v98, v34
    v_cos_f32 v34, v34
    v_sin_f32 v99, v35
    v_cos_f32 v35, v35
    v_cvt_pk_f16_f32 v34, v34, v98
    v_cvt_pk_f16_f32 v35, v35, v99
    v_fmamk_f32 v36, v96, 0x42040000, v97
    v_fmamk_f32 v37, v96, 0x420c0000, v97
    v_sin_f32 v98, v36
    v_cos_f32 v36, v36
    v_sin_f32 v99, v37
    v_cos_f32 v37, v37
    v_cvt_pk_f16_f32 v36, v36, v98
    v_cvt_pk_f16_f32 v37, v37, v99
    v_fmamk_f32 v38, v96, 0x42240000, v97
    v_fmamk_f32 v39, v96, 0x422c0000, v97
    v_sin_f32 v98, v38
    v_cos_f32 v38, v38
    v_sin_f32 v99, v39
    v_cos_f32 v39, v39
    v_cvt_pk_f16_f32 v38, v38, v98
    v_cvt_pk_f16_f32 v39, v39, v99
    v_fmamk_f32 v40, v96, 0x42820000, v97
    v_fmamk_f32 v41, v96, 0x42860000, v97
    v_sin_f32 v98, v40
    v_cos_f32 v40, v40
    v_sin_f32 v99, v41
    v_cos_f32 v41, v41
    v_cvt_pk_f16_f32 v40, v40, v98
    v_cvt_pk_f16_f32 v41, v41, v99
    v_fmamk_f32 v42, v96, 0x42920000, v97
    v_fmamk_f32 v43, v96, 0x42960000, v97
    v_sin_f32 v98, v42
    v_cos_f32 v42, v42
    v_sin_f32 v99, v43
    v_cos_f32 v43, v43
    v_cvt_pk_f16_f32 v42, v42, v98
    v_cvt_pk_f16_f32 v43, v43, v99
    v_fmamk_f32 v44, v96, 0x42c20000, v97
    v_fmamk_f32 v45, v96, 0x42c60000, v97
    v_sin_f32 v98, v44
    v_cos_f32 v44, v44
    v_sin_f32 v99, v45
    v_cos_f32 v45, v45
    v_cvt_pk_f16_f32 v44, v44, v98
    v_cvt_pk_f16_f32 v45, v45, v99
    v_fmamk_f32 v46, v96, 0x42d20000, v97
    v_fmamk_f32 v47, v96, 0x42d60000, v97
    v_sin_f32 v98, v46
    v_cos_f32 v46, v46
    v_sin_f32 v99, v47
    v_cos_f32 v47, v47
    v_cvt_pk_f16_f32 v46, v46, v98
    v_cvt_pk_f16_f32 v47, v47, v99
    v_lshlrev_b32 v98, 31, v2
    v_or_b32 v98, 0x3c003c00, v98
    v_cmp_gt_u32 vcc, 16, v2
    s_nop 1
    v_cndmask_b32 v16, v16, v98, vcc
L_consts_done:
    s_waitcnt lgkmcnt(0)
    s_barrier
    s_add_u32 s28, s28, 0x7f4a7c15
    s_addc_u32 s29, s29, 0x9e3779b9
    s_mov_b32 s53, 0
    s_mov_b32 s56, s47
    s_mov_b32 s57, 0x3f803f80
    s_mov_b32 s66, 0
    s_brev_b32 s67, 1
    s_sub_u32 s58, 2047, s48
    s_waitcnt vmcnt(3)
L_row:
    v_mov_b32 v112, 0
    v_mov_b32 v113, 0
    v_mov_b32 v114, 0
    v_mov_b32 v115, 0
    v_dot2c_f32_bf16 v112, s57, v80
    v_dot2c_f32_bf16 v113, v80, v80
    v_dot2c_f32_bf16 v114, v104, v80
    v_dot2c_f32_bf16 v115, s57, v104
    v_dot2c_f32_bf16 v112, s57, v81
    v_dot2c_f32_bf16 v113, v81, v81
    v_dot2c_f32_bf16 v114, v105, v81
    v_dot2c_f32_bf16 v115, s57, v105
    v_dot2c_f32_bf16 v112, s57, v82
    v_dot2c_f32_bf16 v113, v82, v82
    v_dot2c_f32_bf16 v114, v106, v82
    v_dot2c_f32_bf16 v115, s57, v106
    v_dot2c_f32_bf16 v112, s57, v83
    v_dot2c_f32_bf16 v113, v83, v83
    v_dot2c_f32_bf16 v114, v107, v83
    v_dot2c_f32_bf16 v115, s57, v107
    v_dot2c_f32_bf16 v112, s57, v84
    v_dot2c_f32_bf16 v113, v84, v84
    v_dot2c_f32_bf16 v114, v108, v84
    v_dot2c_f32_bf16 v115, s57, v108
    v_dot2c_f32_bf16 v112, s57, v85
    v_dot2c_f32_bf16 v113, v85, v85
    v_dot2c_f32_bf16 v114, v109, v85
    v_dot2c_f32_bf16 v115, s57, v109
    v_dot2c_f32_bf16 v112, s57, v86
    v_dot2c_f32_bf16 v113, v86, v86
    v_dot2c_f32_bf16 v114, v110, v86
    v_dot2c_f32_bf16 v115, s57, v110
    v_dot2c_f32_bf16 v112, s57, v87
    v_dot2c_f32_bf16 v113, v87, v87
    v_dot2c_f32_bf16 v114, v111, v87
    v_dot2c_f32_bf16 v115, s57, v111
    v_add_f32_dpp v112, v112, v112 row_shr:1 row_mask:0xf bank_mask:0xf
    v_add_f32_dpp v113, v113, v113 row_shr:1 row_mask:0xf bank_mask:0xf
    v_add_f32_dpp v114, v114, v114 row_shr:1 row_mask:0xf bank_mask:0xf
    v_add_f32_dpp v115, v115, v115 row_shr:1 row_mask:0xf bank_mask:0xf
    v_add_f32_dpp v112, v112, v112 row_shr:2 row_mask:0xf bank_mask:0xf
    v_add_f32_dpp v113, v113, v113 row_shr:2 row_mask:0xf bank_mask:0xf
    v_add_f32_dpp v114, v114, v114 row_shr:2 row_mask:0xf bank_mask:0xf
    v_add_f32_dpp v115, v115, v115 row_shr:2 row_mask:0xf bank_mask:0xf
    v_add_f32_dpp v112, v112, v112 row_shr:4 row_mask:0xf bank_mask:0xf
    v_add_f32_dpp v113, v113, v113 row_shr:4 row_mask:0xf bank_mask:0xf
    v_add_f32_dpp v114, v114, v114 row_shr:4 row_mask:0xf bank_mask:0xf
    v_add_f32_dpp v115, v115, v115 row_shr:4 row_mask:0xf bank_mask:0xf
    v_add_f32_dpp v112, v112, v112 row_shr:8 row_mask:0xf bank_mask:0xf
    v_add_f32_dpp v113, v113, v113 row_shr:8 row_mask:0xf bank_mask:0xf
    v_add_f32_dpp v114, v114, v114 row_shr:8 row_mask:0xf bank_mask:0xf
    v_add_f32_dpp v115, v115, v115 row_shr:8 row_mask:0xf bank_mask:0xf
    v_add_f32_dpp v112, v112, v112 row_bcast:15 row_mask:0xa bank_mask:0xf
    v_add_f32_dpp v113, v113, v113 row_bcast:15 row_mask:0xa bank_mask:0xf
    v_add_f32_dpp v114, v114, v114 row_bcast:15 row_mask:0xa bank_mask:0xf
    v_add_f32_dpp v115, v115, v115 row_bcast:15 row_mask:0xa bank_mask:0xf
    v_add_f32_dpp v112, v112, v112 row_bcast:31 row_mask:0xc bank_mask:0xf
    v_add_f32_dpp v113, v113, v113 row_bcast:31 row_mask:0xc bank_mask:0xf
    v_add_f32_dpp v114, v114, v114 row_bcast:31 row_mask:0xc bank_mask:0xf
    v_add_f32_dpp v115, v115, v115 row_bcast:31 row_mask:0xc bank_mask:0xf
    v_mul_f32 v112, 0x3a800000, v112
    v_mul_f32 v113, 0x3a800000, v113
    v_fma_f32 v113, -v112, v112, v113
    v_max_f32 v113, 0, v113
    v_cvt_pk_bf16_f32 v113, v113, v113
    v_lshlrev_b32 v113, 16, v113
    v_add_f32 v113, 0x3727c5ac, v113
    v_cvt_pk_bf16_f32 v113, v113, v113
    v_lshlrev_b32 v113, 16, v113
    v_sqrt_f32 v113, v113
    s_nop 0
    v_cvt_pk_bf16_f32 v118, v112, v113
    v_and_b32 v113, 0xffff0000, v118
    v_lshlrev_b32 v112, 16, v118
    v_rcp_f32 v113, v113
    v_fma_f32 v116, -v112, v115, v114
    v_readlane_b32 s62, v112, 63
    v_mul_f32 v116, v116, v113
    v_readlane_b32 s64, v113, 63
    s_cmp_lg_u32 s53, 0
    s_cbranch_scc1 L_norm
    v_ashrrev_i32 v117, 31, v116
    v_or_b32 v117, 0x80000000, v117
    v_xor_b32 v116, v116, v117
    v_and_b32 v116, 0xfffff800, v116
    v_or_b32 v119, s58, v116
    s_lshr_b32 s31, s48, 8
    s_lshl_b32 s31, s31, 3
    s_add_u32 s31, s31, 57856
    v_mov_b32 v116, s31
    s_mov_b64 exec, s[66:67]
    ds_write_b64 v116, v[118:119]
    ds_max_u64 v5, v[118:119]
    s_mov_b64 exec, -1
    s_waitcnt vmcnt(0) lgkmcnt(0)
    s_barrier
    s_cmp_eq_u32 s30, 0
    s_cselect_b32 s31, s50, 0
    s_cmp_eq_u32 s31, 0
    s_cbranch_scc1 L_norm
    v_min_u32 v116, 8, v2
    v_lshlrev_b32 v116, 3, v116
    ds_read_b64 v[112:113], v116 offset:57856
    v_mov_b32 v114, s28
    v_mov_b32 v115, s29
    s_waitcnt lgkmcnt(0)
    buffer_store_dwordx4 v[112:115], v4, s[12:15], 0 offen sc1
L_norm:
    v_lshlrev_b32 v96, 16, v80
    v_and_b32 v97, 0xffff0000, v80
    v_lshlrev_b32 v98, 16, v81
    v_and_b32 v99, 0xffff0000, v81
    v_lshlrev_b32 v100, 16, v82
    v_and_b32 v101, 0xffff0000, v82
    v_lshlrev_b32 v102, 16, v83
    v_and_b32 v103, 0xffff0000, v83
    v_lshlrev_b32 v104, 16, v84
    v_and_b32 v105, 0xffff0000, v84
    v_lshlrev_b32 v106, 16, v85
    v_and_b32 v107, 0xffff0000, v85
    v_lshlrev_b32 v108, 16, v86
    v_and_b32 v109, 0xffff0000, v86
    v_lshlrev_b32 v110, 16, v87
    v_and_b32 v111, 0xffff0000, v87
    v_pk_add_f32 v[96:97], v[96:97], s[62:63] op_sel_hi:[1,0] neg_lo:[0,1] neg_hi:[0,1]
    v_pk_add_f32 v[98:99], v[98:99], s[62:63] op_sel_hi:[1,0] neg_lo:[0,1] neg_hi:[0,1]
    v_pk_add_f32 v[100:101], v[100:101], s[62:63] op_sel_hi:[1,0] neg_lo:[0,1] neg_hi:[0,1]
    v_pk_add_f32 v[102:103], v[102:103], s[62:63] op_sel_hi:[1,0] neg_lo:[0,1] neg_hi:[0,1]
    v_pk_add_f32 v[104:105], v[104:105], s[62:63] op_sel_hi:[1,0] neg_lo:[0,1] neg_hi:[0,1]
    v_pk_add_f32 v[106:107], v[106:107], s[62:63] op_sel_hi:[1,0] neg_lo:[0,1] neg_hi:[0,1]
    v_pk_add_f32 v[108:109], v[108:109], s[62:63] op_sel_hi:[1,0] neg_lo:[0,1] neg_hi:[0,1]
    v_pk_add_f32 v[110:111], v[110:111], s[62:63] op_sel_hi:[1,0] neg_lo:[0,1] neg_hi:[0,1]
    v_cvt_pk_bf16_f32 v80, v96, v97
    v_cvt_pk_bf16_f32 v81, v98, v99
    v_cvt_pk_bf16_f32 v82, v100, v101
    v_cvt_pk_bf16_f32 v83, v102, v103
    v_cvt_pk_bf16_f32 v84, v104, v105
    v_cvt_pk_bf16_f32 v85, v106, v107
    v_cvt_pk_bf16_f32 v86, v108, v109
    v_cvt_pk_bf16_f32 v87, v110, v111
    v_lshlrev_b32 v96, 16, v80
    v_and_b32 v97, 0xffff0000, v80
    v_lshlrev_b32 v98, 16, v81
    v_and_b32 v99, 0xffff0000, v81
    v_lshlrev_b32 v100, 16, v82
    v_and_b32 v101, 0xffff0000, v82
    v_lshlrev_b32 v102, 16, v83
    v_and_b32 v103, 0xffff0000, v83
    v_lshlrev_b32 v104, 16, v84
    v_and_b32 v105, 0xffff0000, v84
    v_lshlrev_b32 v106, 16, v85
    v_and_b32 v107, 0xffff0000, v85
    v_lshlrev_b32 v108, 16, v86
    v_and_b32 v109, 0xffff0000, v86
    v_lshlrev_b32 v110, 16, v87
    v_and_b32 v111, 0xffff0000, v87
    v_pk_mul_f32 v[96:97], v[96:97], s[64:65] op_sel_hi:[1,0]
    v_pk_mul_f32 v[98:99], v[98:99], s[64:65] op_sel_hi:[1,0]
    v_pk_mul_f32 v[100:101], v[100:101], s[64:65] op_sel_hi:[1,0]
    v_pk_mul_f32 v[102:103], v[102:103], s[64:65] op_sel_hi:[1,0]
    v_pk_mul_f32 v[104:105], v[104:105], s[64:65] op_sel_hi:[1,0]
    v_pk_mul_f32 v[106:107], v[106:107], s[64:65] op_sel_hi:[1,0]
    v_pk_mul_f32 v[108:109], v[108:109], s[64:65] op_sel_hi:[1,0]
    v_pk_mul_f32 v[110:111], v[110:111], s[64:65] op_sel_hi:[1,0]
    s_mul_i32 s31, s30, 2592
    s_cmp_lg_u32 s56, 0
    s_cbranch_scc1 L_pack_mirror
    v_cvt_pk_bf16_f32 v80, v96, v97
    v_cvt_pk_bf16_f32 v81, v98, v99
    v_cvt_pk_bf16_f32 v82, v100, v101
    v_cvt_pk_bf16_f32 v83, v102, v103
    v_cvt_pk_bf16_f32 v84, v104, v105
    v_cvt_pk_bf16_f32 v85, v106, v107
    v_cvt_pk_bf16_f32 v86, v108, v109
    v_cvt_pk_bf16_f32 v87, v110, v111
    v_mov_b32 v116, v2
    s_branch L_pack_done
L_pack_mirror:
    v_mov_b32_dpp v116, v96 wave_rol:1 row_mask:0xf bank_mask:0xf
    v_mov_b32_dpp v117, v104 wave_rol:1 row_mask:0xf bank_mask:0xf
    v_cndmask_b32 v96, v116, v117, s[66:67]
    v_cndmask_b32 v104, v117, v116, s[66:67]
    v_cvt_pk_bf16_f32 v84, v96, v103
    v_cvt_pk_bf16_f32 v85, v102, v101
    v_cvt_pk_bf16_f32 v86, v100, v99
    v_cvt_pk_bf16_f32 v87, v98, v97
    v_cvt_pk_bf16_f32 v80, v104, v111
    v_cvt_pk_bf16_f32 v81, v110, v109
    v_cvt_pk_bf16_f32 v82, v108, v107
    v_cvt_pk_bf16_f32 v83, v106, v105
    v_sub_u32 v116, 63, v2
    s_add_u32 s31, s31, 20736
L_pack_done:
    v_lshrrev_b32 v117, 5, v116
    v_lshlrev_b32 v116, 4, v116
    v_lshlrev_b32 v117, 7, v117
    v_add3_u32 v116, v116, v117, s31
    ds_write_b128 v116, v[80:83]
    ds_write_b128 v116, v[84:87] offset:1280
    s_cmp_lg_u32 s53, 0
    s_cbranch_scc1 L_rows_done
    s_mov_b32 s53, 1
    s_xor_b32 s56, s56, 1
    s_waitcnt lgkmcnt(0)
    v_mov_b32 v80, v88
    v_mov_b32 v81, v89
    v_mov_b32 v82, v90
    v_mov_b32 v83, v91
    v_mov_b32 v84, v92
    v_mov_b32 v85, v93
    v_mov_b32 v86, v94
    v_mov_b32 v87, v95
    s_branch L_row
L_rows_done:
    v_bfe_u32 v5, v2, 2, 2
    v_mul_u32_u24 v5, 2592, v5
    v_lshrrev_b32 v6, 4, v2
    v_mul_u32_u24 v7, 640, v6
    v_add_u32 v5, v5, v7
    v_and_b32 v7, 3, v2
    v_lshlrev_b32 v7, 3, v7
    s_lshl_b32 s31, s30, 6
    v_add3_u32 v5, v5, v7, s31
    v_lshlrev_b32 v6, 12, v6
    v_and_b32 v7, 15, v2
    v_lshl_add_u32 v6, v7, 4, v6
    s_lshr_b32 s31, s30, 1
    s_lshl_b32 s31, s31, 8
    s_and_b32 s32, s30, 1
    s_lshl_b32 s32, s32, 3
    s_add_u32 s31, s31, s32
    v_add_u32 v6, s31, v6
    s_waitcnt lgkmcnt(0)
    s_barrier
    ds_read_b64_tr_b16 v[80:81], v5 offset:0
    ds_read_b64_tr_b16 v[82:83], v5 offset:10368
    ds_read_b64_tr_b16 v[84:85], v5 offset:20736
    ds_read_b64_tr_b16 v[86:87], v5 offset:31104
    ds_read_b64_tr_b16 v[88:89], v5 offset:32
    ds_read_b64_tr_b16 v[90:91], v5 offset:10400
    ds_read_b64_tr_b16 v[92:93], v5 offset:20768
    ds_read_b64_tr_b16 v[94:95], v5 offset:31136
    s_waitcnt lgkmcnt(6)
    v_mfma_f32_16x16x32_bf16 v[96:99], v[8:11], v[80:83], 0
    v_mfma_f32_16x16x32_bf16 v[100:103], v[12:15], v[80:83], 0
    s_waitcnt lgkmcnt(4)
    v_mfma_f32_16x16x32_bf16 v[96:99], v[8:11], v[84:87], v[96:99]
    v_mfma_f32_16x16x32_bf16 v[100:103], v[12:15], v[84:87], v[100:103]
    s_waitcnt lgkmcnt(2)
    v_mfma_f32_16x16x32_bf16 v[104:107], v[8:11], v[88:91], 0
    v_mfma_f32_16x16x32_bf16 v[108:111], v[12:15], v[88:91], 0
    s_waitcnt lgkmcnt(0)
    v_mfma_f32_16x16x32_bf16 v[104:107], v[8:11], v[92:95], v[104:107]
    v_mfma_f32_16x16x32_bf16 v[108:111], v[12:15], v[92:95], v[108:111]
    s_nop 0
    v_cvt_pk_f16_f32 v112, v96, v97
    v_cvt_pk_f16_f32 v114, v98, v99
    v_cvt_pk_f16_f32 v116, v100, v101
    v_cvt_pk_f16_f32 v118, v102, v103
    s_nop 1
    v_cvt_pk_f16_f32 v113, v104, v105
    v_cvt_pk_f16_f32 v115, v106, v107
    v_cvt_pk_f16_f32 v117, v108, v109
    v_cvt_pk_f16_f32 v119, v110, v111
    ds_write_b64 v6, v[112:113] offset:41472
    ds_write_b64 v6, v[114:115] offset:42496
    ds_write_b64 v6, v[116:117] offset:43520
    ds_write_b64 v6, v[118:119] offset:44544
    s_waitcnt lgkmcnt(0)
    s_barrier
    s_cmp_ge_u32 s30, 4
    s_cbranch_scc1 L_p1_done
    s_lshl_b32 s31, s30, 12
    v_add_u32 v5, s31, v3
    ds_read_b128 v[80:83], v5 offset:41472
    ds_read_b128 v[84:87], v5 offset:42496
    ds_read_b128 v[88:91], v5 offset:43520
    ds_read_b128 v[92:95], v5 offset:44544
    s_and_b32 s31, s46, 1
    s_lshl_b32 s31, s31, 6
    s_lshr_b32 s32, s46, 1
    s_add_u32 s59, s31, s32
    s_cmp_eq_u32 s46, 128
    s_cselect_b32 s59, 128, s59
    s_bfe_u32 s31, s59, 0x10001
    v_and_b32 v6, 7, v2
    v_xor_b32 v6, s31, v6
    v_lshlrev_b32 v6, 4, v6
    v_lshrrev_b32 v7, 4, v2
    v_lshlrev_b32 v7, 3, v7
    v_bfe_u32 v5, v2, 3, 1
    v_add_u32 v7, v7, v5
    v_mul_u32_u24 v7, 16512, v7
    v_add_u32 v6, v6, v7
    s_mul_i32 s31, s52, 528384
    s_lshl_b32 s32, s59, 7
    s_add_u32 s31, s31, s32
    s_add_u32 s60, s31, 2097152
    s_add_u32 s61, s60, 33024
    s_add_u32 s62, s61, 33024
    s_add_u32 s63, s62, 33024
    s_waitcnt lgkmcnt(3)
    v_mfma_f32_16x16x32_f16 v[96:99], v[80:83], v[16:19], 0
    v_mfma_f32_16x16x32_f16 v[100:103], v[80:83], v[20:23], 0
    s_waitcnt lgkmcnt(2)
    v_mfma_f32_16x16x32_f16 v[104:107], v[84:87], v[24:27], 0
    v_mfma_f32_16x16x32_f16 v[108:111], v[84:87], v[28:31], 0
    s_nop 3
    v_pk_mul_f32 v[112:113], v[48:49], v[96:97]
    v_pk_mul_f32 v[116:117], v[48:49], v[100:101]
    v_pk_mul_f32 v[114:115], v[50:51], v[98:99]
    v_pk_mul_f32 v[118:119], v[50:51], v[102:103]
    v_pk_fma_f32 v[112:113], v[52:53], v[100:101], v[112:113]
    v_pk_fma_f32 v[116:117], v[52:53], v[96:97], v[116:117] neg_lo:[1,0,0] neg_hi:[1,0,0]
    v_pk_fma_f32 v[114:115], v[54:55], v[102:103], v[114:115]
    v_pk_fma_f32 v[118:119], v[54:55], v[98:99], v[118:119] neg_lo:[1,0,0] neg_hi:[1,0,0]
    v_cvt_pk_f16_f32 v80, v112, v116
    v_cvt_pk_f16_f32 v81, v113, v117
    v_cvt_pk_f16_f32 v82, v114, v118
    v_cvt_pk_f16_f32 v83, v115, v119
    s_waitcnt lgkmcnt(1)
    v_mfma_f32_16x16x32_f16 v[96:99], v[88:91], v[32:35], 0
    v_mfma_f32_16x16x32_f16 v[100:103], v[88:91], v[36:39], 0
    v_mfma_f32_16x16x32_f16 v[48:51], v[16:19], v[80:83], 0
    v_mfma_f32_16x16x32_f16 v[52:55], v[20:23], v[80:83], 0
    v_pk_mul_f32 v[112:113], v[56:57], v[104:105]
    v_pk_mul_f32 v[116:117], v[56:57], v[108:109]
    v_pk_mul_f32 v[114:115], v[58:59], v[106:107]
    v_pk_mul_f32 v[118:119], v[58:59], v[110:111]
    v_pk_fma_f32 v[112:113], v[60:61], v[108:109], v[112:113]
    v_pk_fma_f32 v[116:117], v[60:61], v[104:105], v[116:117] neg_lo:[1,0,0] neg_hi:[1,0,0]
    v_pk_fma_f32 v[114:115], v[62:63], v[110:111], v[114:115]
    v_pk_fma_f32 v[118:119], v[62:63], v[106:107], v[118:119] neg_lo:[1,0,0] neg_hi:[1,0,0]
    v_cvt_pk_f16_f32 v84, v112, v116
    v_cvt_pk_f16_f32 v85, v113, v117
    v_cvt_pk_f16_f32 v86, v114, v118
    v_cvt_pk_f16_f32 v87, v115, v119
    s_waitcnt lgkmcnt(0)
    v_mfma_f32_16x16x32_f16 v[104:107], v[92:95], v[40:43], 0
    v_mfma_f32_16x16x32_f16 v[108:111], v[92:95], v[44:47], 0
    v_mfma_f32_16x16x32_f16 v[56:59], v[16:19], v[84:87], 0
    v_mfma_f32_16x16x32_f16 v[60:63], v[20:23], v[84:87], 0
    v_pk_mul_f32 v[112:113], v[64:65], v[96:97]
    v_pk_mul_f32 v[116:117], v[64:65], v[100:101]
    v_pk_mul_f32 v[114:115], v[66:67], v[98:99]
    v_pk_mul_f32 v[118:119], v[66:67], v[102:103]
    v_pk_fma_f32 v[112:113], v[68:69], v[100:101], v[112:113]
    v_pk_fma_f32 v[116:117], v[68:69], v[96:97], v[116:117] neg_lo:[1,0,0] neg_hi:[1,0,0]
    v_pk_fma_f32 v[114:115], v[70:71], v[102:103], v[114:115]
    v_pk_fma_f32 v[118:119], v[70:71], v[98:99], v[118:119] neg_lo:[1,0,0] neg_hi:[1,0,0]
    v_cvt_pk_f16_f32 v88, v112, v116
    v_cvt_pk_f16_f32 v89, v113, v117
    v_cvt_pk_f16_f32 v90, v114, v118
    v_cvt_pk_f16_f32 v91, v115, v119
    s_nop 1
    v_mfma_f32_16x16x32_f16 v[64:67], v[16:19], v[88:91], 0
    v_mfma_f32_16x16x32_f16 v[68:71], v[20:23], v[88:91], 0
    v_pk_mul_f32 v[112:113], v[72:73], v[104:105]
    v_pk_mul_f32 v[116:117], v[72:73], v[108:109]
    v_pk_mul_f32 v[114:115], v[74:75], v[106:107]
    v_pk_mul_f32 v[118:119], v[74:75], v[110:111]
    v_pk_fma_f32 v[112:113], v[76:77], v[108:109], v[112:113]
    v_pk_fma_f32 v[116:117], v[76:77], v[104:105], v[116:117] neg_lo:[1,0,0] neg_hi:[1,0,0]
    v_pk_fma_f32 v[114:115], v[78:79], v[110:111], v[114:115]
    v_pk_fma_f32 v[118:119], v[78:79], v[106:107], v[118:119] neg_lo:[1,0,0] neg_hi:[1,0,0]
    v_cvt_pk_f16_f32 v92, v112, v116
    v_cvt_pk_f16_f32 v93, v113, v117
    v_cvt_pk_f16_f32 v94, v114, v118
    v_cvt_pk_f16_f32 v95, v115, v119
    s_nop 1
    v_mfma_f32_16x16x32_f16 v[72:75], v[16:19], v[92:95], 0
    v_mfma_f32_16x16x32_f16 v[76:79], v[20:23], v[92:95], 0
    v_cvt_pk_f16_f32 v96, v48, v56
    v_cvt_pk_f16_f32 v98, v52, v60
    v_cvt_pk_f16_f32 v100, v49, v57
    v_cvt_pk_f16_f32 v102, v53, v61
    v_cvt_pk_f16_f32 v104, v50, v58
    v_cvt_pk_f16_f32 v106, v54, v62
    v_cvt_pk_f16_f32 v108, v51, v59
    v_cvt_pk_f16_f32 v110, v55, v63
    v_cvt_pk_f16_f32 v97, v64, v72
    v_cvt_pk_f16_f32 v99, v68, v76
    buffer_store_dwordx4 v[96:99], v6, s[12:15], s60 offen sc1
    v_cvt_pk_f16_f32 v101, v65, v73
    v_cvt_pk_f16_f32 v103, v69, v77
    buffer_store_dwordx4 v[100:103], v6, s[12:15], s61 offen sc1
    v_cvt_pk_f16_f32 v105, v66, v74
    v_cvt_pk_f16_f32 v107, v70, v78
    buffer_store_dwordx4 v[104:107], v6, s[12:15], s62 offen sc1
    v_cvt_pk_f16_f32 v109, v67, v75
    v_cvt_pk_f16_f32 v111, v71, v79
    buffer_store_dwordx4 v[108:111], v6, s[12:15], s63 offen sc1
    v_and_b32 v80, 15, v2
    s_lshl_b32 s31, s30, 4
    v_add_u32 v80, s31, v80
    v_lshrrev_b32 v81, 5, v2
    v_bfe_u32 v82, v2, 4, 1
    v_lshlrev_b32 v81, 4, v81
    v_lshl_add_u32 v81, v82, 2, v81
    v_mul_u32_u24 v81, v81, v80
    v_cvt_f32_u32 v80, v80
    v_cvt_f32_u32 v81, v81
    v_mul_f32 v80, 0x3b800000, v80
    v_mul_f32 v81, 0x3b800000, v81
    v_fmamk_f32 v16, v80, 0x0, v81
    v_fmamk_f32 v17, v80, 0x40000000, v81
    v_sin_f32 v82, v16
    v_cos_f32 v16, v16
    v_sin_f32 v83, v17
    v_cos_f32 v17, v17
    v_cvt_pk_f16_f32 v16, v16, v82
    v_cvt_pk_f16_f32 v17, v17, v83
    v_fmamk_f32 v18, v80, 0x41000000, v81
    v_fmamk_f32 v19, v80, 0x41200000, v81
    v_sin_f32 v82, v18
    v_cos_f32 v18, v18
    v_sin_f32 v83, v19
    v_cos_f32 v19, v19
    v_cvt_pk_f16_f32 v18, v18, v82
    v_cvt_pk_f16_f32 v19, v19, v83
    v_fmamk_f32 v20, v80, 0x42000000, v81
    v_fmamk_f32 v21, v80, 0x42080000, v81
    v_sin_f32 v82, v20
    v_cos_f32 v20, v20
    v_sin_f32 v83, v21
    v_cos_f32 v21, v21
    v_cvt_pk_f16_f32 v20, v20, v82
    v_cvt_pk_f16_f32 v21, v21, v83
    v_fmamk_f32 v22, v80, 0x42200000, v81
    v_fmamk_f32 v23, v80, 0x42280000, v81
    v_sin_f32 v82, v22
    v_cos_f32 v22, v22
    v_sin_f32 v83, v23
    v_cos_f32 v23, v23
    v_cvt_pk_f16_f32 v22, v22, v82
    v_cvt_pk_f16_f32 v23, v23, v83
    v_fmamk_f32 v24, v80, 0x42800000, v81
    v_fmamk_f32 v25, v80, 0x42840000, v81
    v_sin_f32 v82, v24
    v_cos_f32 v24, v24
    v_sin_f32 v83, v25
    v_cos_f32 v25, v25
    v_cvt_pk_f16_f32 v24, v24, v82
    v_cvt_pk_f16_f32 v25, v25, v83
    v_fmamk_f32 v26, v80, 0x42900000, v81
    v_fmamk_f32 v27, v80, 0x42940000, v81
    v_sin_f32 v82, v26
    v_cos_f32 v26, v26
    v_sin_f32 v83, v27
    v_cos_f32 v27, v27
    v_cvt_pk_f16_f32 v26, v26, v82
    v_cvt_pk_f16_f32 v27, v27, v83
    v_fmamk_f32 v28, v80, 0x42c00000, v81
    v_fmamk_f32 v29, v80, 0x42c40000, v81
    v_sin_f32 v82, v28
    v_cos_f32 v28, v28
    v_sin_f32 v83, v29
    v_cos_f32 v29, v29
    v_cvt_pk_f16_f32 v28, v28, v82
    v_cvt_pk_f16_f32 v29, v29, v83
    v_fmamk_f32 v30, v80, 0x42d00000, v81
    v_fmamk_f32 v31, v80, 0x42d40000, v81
    v_sin_f32 v82, v30
    v_cos_f32 v30, v30
    v_sin_f32 v83, v31
    v_cos_f32 v31, v31
    v_cvt_pk_f16_f32 v30, v30, v82
    v_cvt_pk_f16_f32 v31, v31, v83
    v_fmamk_f32 v32, v80, 0x3f800000, v81
    v_fmamk_f32 v33, v80, 0x40400000, v81
    v_sin_f32 v82, v32
    v_cos_f32 v32, v32
    v_sin_f32 v83, v33
    v_cos_f32 v33, v33
    v_cvt_pk_f16_f32 v32, v32, v82
    v_cvt_pk_f16_f32 v33, v33, v83
    v_fmamk_f32 v34, v80, 0x41100000, v81
    v_fmamk_f32 v35, v80, 0x41300000, v81
    v_sin_f32 v82, v34
    v_cos_f32 v34, v34
    v_sin_f32 v83, v35
    v_cos_f32 v35, v35
    v_cvt_pk_f16_f32 v34, v34, v82
    v_cvt_pk_f16_f32 v35, v35, v83
    v_fmamk_f32 v36, v80, 0x42040000, v81
    v_fmamk_f32 v37, v80, 0x420c0000, v81
    v_sin_f32 v82, v36
    v_cos_f32 v36, v36
    v_sin_f32 v83, v37
    v_cos_f32 v37, v37
    v_cvt_pk_f16_f32 v36, v36, v82
    v_cvt_pk_f16_f32 v37, v37, v83
    v_fmamk_f32 v38, v80, 0x42240000, v81
    v_fmamk_f32 v39, v80, 0x422c0000, v81
    v_sin_f32 v82, v38
    v_cos_f32 v38, v38
    v_sin_f32 v83, v39
    v_cos_f32 v39, v39
    v_cvt_pk_f16_f32 v38, v38, v82
    v_cvt_pk_f16_f32 v39, v39, v83
    v_fmamk_f32 v40, v80, 0x42820000, v81
    v_fmamk_f32 v41, v80, 0x42860000, v81
    v_sin_f32 v82, v40
    v_cos_f32 v40, v40
    v_sin_f32 v83, v41
    v_cos_f32 v41, v41
    v_cvt_pk_f16_f32 v40, v40, v82
    v_cvt_pk_f16_f32 v41, v41, v83
    v_fmamk_f32 v42, v80, 0x42920000, v81
    v_fmamk_f32 v43, v80, 0x42960000, v81
    v_sin_f32 v82, v42
    v_cos_f32 v42, v42
    v_sin_f32 v83, v43
    v_cos_f32 v43, v43
    v_cvt_pk_f16_f32 v42, v42, v82
    v_cvt_pk_f16_f32 v43, v43, v83
    v_fmamk_f32 v44, v80, 0x42c20000, v81
    v_fmamk_f32 v45, v80, 0x42c60000, v81
    v_sin_f32 v82, v44
    v_cos_f32 v44, v44
    v_sin_f32 v83, v45
    v_cos_f32 v45, v45
    v_cvt_pk_f16_f32 v44, v44, v82
    v_cvt_pk_f16_f32 v45, v45, v83
    v_fmamk_f32 v46, v80, 0x42d20000, v81
    v_fmamk_f32 v47, v80, 0x42d60000, v81
    v_sin_f32 v82, v46
    v_cos_f32 v46, v46
    v_sin_f32 v83, v47
    v_cos_f32 v47, v47
    v_cvt_pk_f16_f32 v46, v46, v82
    v_cvt_pk_f16_f32 v47, v47, v83
    v_lshlrev_b32 v82, 31, v2
    v_or_b32 v82, 0x3c003c00, v82
    v_cmp_gt_u32 vcc, 16, v2
    s_nop 1
    v_cndmask_b32 v16, v16, v82, vcc
    s_lshl_b32 s31, s52, 14
    s_lshl_b32 s32, s59, 6
    s_add_u32 s31, s31, s32
    s_add_u32 s31, s31, 65536
    v_mov_b32 v5, 2147483392
    v_writelane_b32 v5, s31, 0
    v_mov_b32 v6, s28
    v_mov_b32 v7, s29
    s_waitcnt vmcnt(0)
    buffer_store_dwordx2 v[6:7], v5, s[12:15], 0 offen sc1
L_p1_done:
    s_cmp_ge_u32 s2, 256
    s_cbranch_scc1 L_fin
    s_lshr_b32 s46, s2, 5
    s_and_b32 s31, s2, 7
    s_lshl_b32 s31, s31, 2
    s_bfe_u32 s32, s2, 0x20003
    s_add_u32 s47, s31, s32
    v_and_b32 v120, 15, v2
    s_lshl_b32 s31, s30, 7
    s_add_u32 s31, s31, s46
    v_lshl_add_u32 v120, v120, 3, s31
    v_lshlrev_b32 v4, 11, v120
    v_and_b32 v5, 48, v2
    s_lshl_b32 s31, s47, 6
    v_add3_u32 v4, v4, v5, s31
    v_and_b32 v5, 255, v120
    v_lshlrev_b32 v5, 7, v5
    v_lshrrev_b32 v6, 8, v120
    v_lshl_add_u32 v5, v6, 4, v5
    v_add_u32 v5, 32768, v5
    s_mov_b32 s48, 0x200000
    buffer_load_dwordx4 v[8:11], v4, s[8:11], 0 offen
    buffer_load_dwordx4 v[12:15], v4, s[8:11], s48 offen
L_stat_poll:
    buffer_load_dwordx4 v[48:51], v5, s[12:15], 0 offen sc1
    buffer_load_dwordx4 v[52:55], v5, s[12:15], 0 offen offset:64 sc1
    s_waitcnt vmcnt(0)
    v_cmp_ne_u64 vcc, s[28:29], v[50:51]
    v_cmp_ne_u64 s[54:55], s[28:29], v[54:55]
    s_nop 0
    s_or_b64 s[54:55], s[54:55], vcc
    s_cbranch_scc0 L_stat_got
    s_cmp_eq_u32 s35, 0
    s_cbranch_scc1 L_stat_got
    s_sub_u32 s35, s35, 1
    s_branch L_stat_poll
L_stat_got:
    v_and_b32 v50, 0xffff0000, v48
    v_lshlrev_b32 v48, 16, v48
    v_rcp_f32 v50, v50
    v_and_b32 v54, 0xffff0000, v52
    v_lshlrev_b32 v52, 16, v52
    v_rcp_f32 v54, v54
    v_lshlrev_b32 v56, 16, v8
    v_and_b32 v57, 0xffff0000, v8
    v_lshlrev_b32 v58, 16, v9
    v_and_b32 v59, 0xffff0000, v9
    v_lshlrev_b32 v60, 16, v10
    v_and_b32 v61, 0xffff0000, v10
    v_lshlrev_b32 v62, 16, v11
    v_and_b32 v63, 0xffff0000, v11
    v_lshlrev_b32 v64, 16, v12
    v_and_b32 v65, 0xffff0000, v12
    v_lshlrev_b32 v66, 16, v13
    v_and_b32 v67, 0xffff0000, v13
    v_lshlrev_b32 v68, 16, v14
    v_and_b32 v69, 0xffff0000, v14
    v_lshlrev_b32 v70, 16, v15
    v_and_b32 v71, 0xffff0000, v15
    v_pk_add_f32 v[72:73], v[56:57], v[48:49] op_sel_hi:[1,0] neg_lo:[0,1] neg_hi:[0,1]
    v_pk_add_f32 v[74:75], v[58:59], v[48:49] op_sel_hi:[1,0] neg_lo:[0,1] neg_hi:[0,1]
    v_pk_add_f32 v[76:77], v[60:61], v[48:49] op_sel_hi:[1,0] neg_lo:[0,1] neg_hi:[0,1]
    v_pk_add_f32 v[78:79], v[62:63], v[48:49] op_sel_hi:[1,0] neg_lo:[0,1] neg_hi:[0,1]
    v_pk_add_f32 v[80:81], v[64:65], v[52:53] op_sel_hi:[1,0] neg_lo:[0,1] neg_hi:[0,1]
    v_pk_add_f32 v[82:83], v[66:67], v[52:53] op_sel_hi:[1,0] neg_lo:[0,1] neg_hi:[0,1]
    v_pk_add_f32 v[84:85], v[68:69], v[52:53] op_sel_hi:[1,0] neg_lo:[0,1] neg_hi:[0,1]
    v_pk_add_f32 v[86:87], v[70:71], v[52:53] op_sel_hi:[1,0] neg_lo:[0,1] neg_hi:[0,1]
    v_cvt_pk_bf16_f32 v8, v72, v73
    v_cvt_pk_bf16_f32 v9, v74, v75
    v_cvt_pk_bf16_f32 v10, v76, v77
    v_cvt_pk_bf16_f32 v11, v78, v79
    v_cvt_pk_bf16_f32 v12, v80, v81
    v_cvt_pk_bf16_f32 v13, v82, v83
    v_cvt_pk_bf16_f32 v14, v84, v85
    v_cvt_pk_bf16_f32 v15, v86, v87
    v_lshlrev_b32 v72, 16, v8
    v_and_b32 v73, 0xffff0000, v8
    v_lshlrev_b32 v74, 16, v9
    v_and_b32 v75, 0xffff0000, v9
    v_lshlrev_b32 v76, 16, v10
    v_and_b32 v77, 0xffff0000, v10
    v_lshlrev_b32 v78, 16, v11
    v_and_b32 v79, 0xffff0000, v11
    v_lshlrev_b32 v80, 16, v12
    v_and_b32 v81, 0xffff0000, v12
    v_lshlrev_b32 v82, 16, v13
    v_and_b32 v83, 0xffff0000, v13
    v_lshlrev_b32 v84, 16, v14
    v_and_b32 v85, 0xffff0000, v14
    v_lshlrev_b32 v86, 16, v15
    v_and_b32 v87, 0xffff0000, v15
    v_pk_mul_f32 v[72:73], v[72:73], v[50:51] op_sel_hi:[1,0]
    v_pk_mul_f32 v[74:75], v[74:75], v[50:51] op_sel_hi:[1,0]
    v_pk_mul_f32 v[76:77], v[76:77], v[50:51] op_sel_hi:[1,0]
    v_pk_mul_f32 v[78:79], v[78:79], v[50:51] op_sel_hi:[1,0]
    v_pk_mul_f32 v[80:81], v[80:81], v[54:55] op_sel_hi:[1,0]
    v_pk_mul_f32 v[82:83], v[82:83], v[54:55] op_sel_hi:[1,0]
    v_pk_mul_f32 v[84:85], v[84:85], v[54:55] op_sel_hi:[1,0]
    v_pk_mul_f32 v[86:87], v[86:87], v[54:55] op_sel_hi:[1,0]
    v_cvt_pk_bf16_f32 v8, v72, v73
    v_cvt_pk_bf16_f32 v9, v74, v75
    v_cvt_pk_bf16_f32 v10, v76, v77
    v_cvt_pk_bf16_f32 v11, v78, v79
    v_cvt_pk_bf16_f32 v12, v80, v81
    v_cvt_pk_bf16_f32 v13, v82, v83
    v_cvt_pk_bf16_f32 v14, v84, v85
    v_cvt_pk_bf16_f32 v15, v86, v87
    v_lshlrev_b32 v72, 16, v8
    v_and_b32 v73, 0xffff0000, v8
    v_lshlrev_b32 v74, 16, v9
    v_and_b32 v75, 0xffff0000, v9
    v_lshlrev_b32 v76, 16, v10
    v_and_b32 v77, 0xffff0000, v10
    v_lshlrev_b32 v78, 16, v11
    v_and_b32 v79, 0xffff0000, v11
    v_lshlrev_b32 v80, 16, v12
    v_and_b32 v81, 0xffff0000, v12
    v_lshlrev_b32 v82, 16, v13
    v_and_b32 v83, 0xffff0000, v13
    v_lshlrev_b32 v84, 16, v14
    v_and_b32 v85, 0xffff0000, v14
    v_lshlrev_b32 v86, 16, v15
    v_and_b32 v87, 0xffff0000, v15
    s_mov_b32 s54, 0xbfb8aa3b
    s_mov_b32 s56, 1.0
    v_pk_mul_f32 v[88:89], v[72:73], s[54:55] op_sel_hi:[1,0]
    v_pk_mul_f32 v[90:91], v[74:75], s[54:55] op_sel_hi:[1,0]
    v_pk_mul_f32 v[92:93], v[76:77], s[54:55] op_sel_hi:[1,0]
    v_pk_mul_f32 v[94:95], v[78:79], s[54:55] op_sel_hi:[1,0]
    v_pk_mul_f32 v[96:97], v[80:81], s[54:55] op_sel_hi:[1,0]
    v_pk_mul_f32 v[98:99], v[82:83], s[54:55] op_sel_hi:[1,0]
    v_pk_mul_f32 v[100:101], v[84:85], s[54:55] op_sel_hi:[1,0]
    v_pk_mul_f32 v[102:103], v[86:87], s[54:55] op_sel_hi:[1,0]
    v_exp_f32 v88, v88
    v_exp_f32 v89, v89
    v_exp_f32 v90, v90
    v_exp_f32 v91, v91
    v_exp_f32 v92, v92
    v_exp_f32 v93, v93
    v_exp_f32 v94, v94
    v_exp_f32 v95, v95
    v_exp_f32 v96, v96
    v_exp_f32 v97, v97
    v_exp_f32 v98, v98
    v_exp_f32 v99, v99
    v_exp_f32 v100, v100
    v_exp_f32 v101, v101
    v_exp_f32 v102, v102
    v_exp_f32 v103, v103
    v_pk_add_f32 v[88:89], v[88:89], s[56:57] op_sel_hi:[1,0]
    v_pk_add_f32 v[90:91], v[90:91], s[56:57] op_sel_hi:[1,0]
    v_pk_add_f32 v[92:93], v[92:93], s[56:57] op_sel_hi:[1,0]
    v_pk_add_f32 v[94:95], v[94:95], s[56:57] op_sel_hi:[1,0]
    v_pk_add_f32 v[96:97], v[96:97], s[56:57] op_sel_hi:[1,0]
    v_pk_add_f32 v[98:99], v[98:99], s[56:57] op_sel_hi:[1,0]
    v_pk_add_f32 v[100:101], v[100:101], s[56:57] op_sel_hi:[1,0]
    v_pk_add_f32 v[102:103], v[102:103], s[56:57] op_sel_hi:[1,0]
    v_rcp_f32 v88, v88
    v_rcp_f32 v89, v89
    v_rcp_f32 v90, v90
    v_rcp_f32 v91, v91
    v_rcp_f32 v92, v92
    v_rcp_f32 v93, v93
    v_rcp_f32 v94, v94
    v_rcp_f32 v95, v95
    v_rcp_f32 v96, v96
    v_rcp_f32 v97, v97
    v_rcp_f32 v98, v98
    v_rcp_f32 v99, v99
    v_rcp_f32 v100, v100
    v_rcp_f32 v101, v101
    v_rcp_f32 v102, v102
    v_rcp_f32 v103, v103
    v_pk_mul_f32 v[72:73], v[72:73], v[88:89]
    v_pk_mul_f32 v[74:75], v[74:75], v[90:91]
    v_pk_mul_f32 v[76:77], v[76:77], v[92:93]
    v_pk_mul_f32 v[78:79], v[78:79], v[94:95]
    v_pk_mul_f32 v[80:81], v[80:81], v[96:97]
    v_pk_mul_f32 v[82:83], v[82:83], v[98:99]
    v_pk_mul_f32 v[84:85], v[84:85], v[100:101]
    v_pk_mul_f32 v[86:87], v[86:87], v[102:103]
    s_cmp_lg_u32 s30, 7
    s_cbranch_scc1 L_no_idx
    v_lshlrev_b32 v5, 6, v2
    v_add_u32 v5, 4096, v5
    s_mov_b32 s60, 4096
    s_mov_b32 s61, 8192
    s_mov_b32 s62, 12288
L_di_poll:
    buffer_load_dwordx4 v[88:91], v5, s[12:15], 0 offen sc1
    buffer_load_dwordx4 v[92:95], v5, s[12:15], s60 offen sc1
    buffer_load_dwordx4 v[96:99], v5, s[12:15], s61 offen sc1
    buffer_load_dwordx4 v[100:103], v5, s[12:15], s62 offen sc1
    s_waitcnt vmcnt(0)
    v_cmp_ne_u64 vcc, s[28:29], v[90:91]
    v_cmp_ne_u64 s[54:55], s[28:29], v[94:95]
    v_cmp_ne_u64 s[56:57], s[28:29], v[98:99]
    v_cmp_ne_u64 s[58:59], s[28:29], v[102:103]
    v_max_u32 v6, v89, v93
    v_max3_u32 v6, v6, v97, v101
    s_or_b64 s[54:55], s[54:55], vcc
    s_or_b64 s[56:57], s[56:57], s[58:59]
    s_or_b64 s[54:55], s[54:55], s[56:57]
    s_cbranch_scc0 L_di_got
    s_cmp_eq_u32 s35, 0
    s_cbranch_scc1 L_di_got
    s_sub_u32 s35, s35, 1
    s_branch L_di_poll
L_di_got:
    v_mov_b32 v7, v6
    s_nop 1
    v_max_u32_dpp v7, v7, v7 row_shr:1 row_mask:0xf bank_mask:0xf
    s_nop 1
    v_max_u32_dpp v7, v7, v7 row_shr:2 row_mask:0xf bank_mask:0xf
    s_nop 1
    v_max_u32_dpp v7, v7, v7 row_shr:4 row_mask:0xf bank_mask:0xf
    s_nop 1
    v_max_u32_dpp v7, v7, v7 row_shr:8 row_mask:0xf bank_mask:0xf
    s_nop 1
    v_max_u32_dpp v7, v7, v7 row_bcast:15 row_mask:0xa bank_mask:0xf
    s_nop 1
    v_max_u32_dpp v7, v7, v7 row_bcast:31 row_mask:0xc bank_mask:0xf
    s_nop 0
    v_readlane_b32 s33, v7, 63
    v_mov_b32 v7, v88
    s_nop 0
    v_cmp_eq_u32 vcc, s33, v93
    s_nop 1
    v_cndmask_b32 v7, v7, v92, vcc
    v_cmp_eq_u32 vcc, s33, v97
    s_nop 1
    v_cndmask_b32 v7, v7, v96, vcc
    v_cmp_eq_u32 vcc, s33, v101
    s_nop 1
    v_cndmask_b32 v7, v7, v100, vcc
    v_cmp_eq_u32 vcc, s33, v6
    s_nop 0
    s_ff1_i32_b64 s32, vcc
    v_readlane_b32 s34, v7, s32
    s_nop 1
    v_mov_b32 v6, s34
    v_mov_b32 v7, s33
    v_mov_b32 v5, 57936
    ds_write_b64 v5, v[6:7]
L_no_idx:
    s_lshl_b32 s31, s46, 14
    s_add_u32 s31, s31, 65536
    s_lshl_b32 s32, s30, 10
    s_add_u32 s32, s32, s31
    s_add_u32 s31, s31, 8192
    v_lshlrev_b32 v5, 6, v2
    v_add_u32 v5, s32, v5
    v_mov_b32 v6, s31
    v_cmp_gt_u32 vcc, 16, v2
    s_nop 1
    v_cndmask_b32 v5, v6, v5, vcc
    s_mov_b32 s31, 131072
    v_writelane_b32 v5, s31, 17
    s_mov_b32 s31, 139264
    v_writelane_b32 v5, s31, 18
    s_lshl_b32 s31, s46, 5
    s_add_u32 s31, s31, s47
    s_mul_i32 s31, s31, 16512
    s_add_u32 s49, s31, 2097152
    s_lshl_b32 s32, s30, 11
    s_add_u32 s50, s49, s32
    s_add_u32 s49, s49, 16384
    s_mov_b32 m0, s32
L_zf_poll:
    buffer_load_dwordx2 v[6:7], v5, s[12:15], 0 offen sc1
    s_waitcnt vmcnt(0)
    v_cmp_ne_u64 vcc, s[28:29], v[6:7]
    s_nop 0
    s_cbranch_vccz L_zf_got
    s_cmp_eq_u32 s35, 0
    s_cbranch_scc1 L_zf_got
    s_sub_u32 s35, s35, 1
    s_branch L_zf_poll
L_zf_got:
    buffer_load_dwordx4 v3, s[12:15], s50 offen sc1 lds
    buffer_load_dwordx4 v3, s[12:15], s50 offen offset:1024 sc1 lds
    s_cmp_lg_u32 s30, 0
    s_cbranch_scc1 L_no_nyq
    s_mov_b32 m0, 16384
    s_mov_b64 exec, 0xff
    buffer_load_dwordx4 v3, s[12:15], s49 offen sc1 lds
    s_mov_b64 exec, -1
L_no_nyq:
    v_lshrrev_b32 v5, 5, v2
    v_lshlrev_b32 v5, 10, v5
    v_bfe_u32 v6, v2, 3, 2
    v_lshl_add_u32 v5, v6, 7, v5
    v_bfe_u32 v6, v2, 2, 1
    v_lshl_add_u32 v5, v6, 3, v5
    v_and_b32 v7, 3, v2
    v_lshl_add_u32 v5, v7, 5, v5
    v_and_b32 v6, 16, v2
    v_add_u32 v5, v5, v6
    v_xor_b32 v6, 16, v5
    v_lshrrev_b32 v8, 2, v2
    v_cmp_eq_u32 vcc, 1, v8
    v_add_u32 v7, 16376, v5
    v_add_u32 v8, 16376, v6
    v_cndmask_b32 v7, v5, v7, vcc
    v_cndmask_b32 v8, v6, v8, vcc
    s_waitcnt vmcnt(0) lgkmcnt(0)
    s_barrier
    v_mov_b32 v9, 57936
    ds_read_b64 v[10:11], v9
    ds_read_b64_tr_b16 v[104:105], v7 offset:0
    ds_read_b64_tr_b16 v[106:107], v5 offset:512
    ds_read_b64_tr_b16 v[108:109], v8 offset:0
    ds_read_b64_tr_b16 v[110:111], v6 offset:512
    ds_read_b64_tr_b16 v[112:113], v5 offset:2048
    ds_read_b64_tr_b16 v[114:115], v5 offset:2560
    ds_read_b64_tr_b16 v[116:117], v6 offset:2048
    ds_read_b64_tr_b16 v[118:119], v6 offset:2560
    s_waitcnt lgkmcnt(6)
    v_mfma_f32_16x16x32_f16 v[88:91], v[104:107], v[16:19], 0
    s_waitcnt lgkmcnt(4)
    v_mfma_f32_16x16x32_f16 v[92:95], v[108:111], v[16:19], 0
    ds_read_b64_tr_b16 v[104:105], v5 offset:4096
    ds_read_b64_tr_b16 v[106:107], v5 offset:4608
    ds_read_b64_tr_b16 v[108:109], v6 offset:4096
    ds_read_b64_tr_b16 v[110:111], v6 offset:4608
    s_waitcnt lgkmcnt(6)
    v_mfma_f32_16x16x32_f16 v[88:91], v[112:115], v[20:23], v[88:91]
    s_waitcnt lgkmcnt(4)
    v_mfma_f32_16x16x32_f16 v[92:95], v[116:119], v[20:23], v[92:95]
    ds_read_b64_tr_b16 v[112:113], v5 offset:6144
    ds_read_b64_tr_b16 v[114:115], v5 offset:6656
    ds_read_b64_tr_b16 v[116:117], v6 offset:6144
    ds_read_b64_tr_b16 v[118:119], v6 offset:6656
    s_waitcnt lgkmcnt(6)
    v_mfma_f32_16x16x32_f16 v[88:91], v[104:107], v[24:27], v[88:91]
    s_waitcnt lgkmcnt(4)
    v_mfma_f32_16x16x32_f16 v[92:95], v[108:111], v[24:27], v[92:95]
    ds_read_b64_tr_b16 v[104:105], v5 offset:8192
    ds_read_b64_tr_b16 v[106:107], v5 offset:8704
    ds_read_b64_tr_b16 v[108:109], v6 offset:8192
    ds_read_b64_tr_b16 v[110:111], v6 offset:8704
    s_waitcnt lgkmcnt(6)
    v_mfma_f32_16x16x32_f16 v[88:91], v[112:115], v[28:31], v[88:91]
    s_waitcnt lgkmcnt(4)
    v_mfma_f32_16x16x32_f16 v[92:95], v[116:119], v[28:31], v[92:95]
    ds_read_b64_tr_b16 v[112:113], v5 offset:10240
    ds_read_b64_tr_b16 v[114:115], v5 offset:10752
    ds_read_b64_tr_b16 v[116:117], v6 offset:10240
    ds_read_b64_tr_b16 v[118:119], v6 offset:10752
    s_waitcnt lgkmcnt(6)
    v_mfma_f32_16x16x32_f16 v[96:99], v[104:107], v[32:35], 0
    s_waitcnt lgkmcnt(4)
    v_mfma_f32_16x16x32_f16 v[100:103], v[108:111], v[32:35], 0
    ds_read_b64_tr_b16 v[104:105], v5 offset:12288
    ds_read_b64_tr_b16 v[106:107], v5 offset:12800
    ds_read_b64_tr_b16 v[108:109], v6 offset:12288
    ds_read_b64_tr_b16 v[110:111], v6 offset:12800
    s_waitcnt lgkmcnt(6)
    v_mfma_f32_16x16x32_f16 v[96:99], v[112:115], v[36:39], v[96:99]
    s_waitcnt lgkmcnt(4)
    v_mfma_f32_16x16x32_f16 v[100:103], v[116:119], v[36:39], v[100:103]
    ds_read_b64_tr_b16 v[112:113], v5 offset:14336
    ds_read_b64_tr_b16 v[114:115], v5 offset:14848
    ds_read_b64_tr_b16 v[116:117], v6 offset:14336
    ds_read_b64_tr_b16 v[118:119], v6 offset:14848
    s_waitcnt lgkmcnt(6)
    v_mfma_f32_16x16x32_f16 v[96:99], v[104:107], v[40:43], v[96:99]
    s_waitcnt lgkmcnt(4)
    v_mfma_f32_16x16x32_f16 v[100:103], v[108:111], v[40:43], v[100:103]
    s_waitcnt lgkmcnt(2)
    v_mfma_f32_16x16x32_f16 v[96:99], v[112:115], v[44:47], v[96:99]
    s_waitcnt lgkmcnt(0)
    v_mfma_f32_16x16x32_f16 v[100:103], v[116:119], v[44:47], v[100:103]
    v_readfirstlane_b32 s33, v11
    v_readfirstlane_b32 s34, v10
    s_andn2_b32 s51, 0x7ff, s33
    s_and_b32 s31, s51, 7
    s_cmp_eq_u32 s31, s46
    s_cselect_b32 s52, 1, 0
    s_cbranch_scc0 L_not_owner1
    v_lshrrev_b32 v5, 3, v2
    s_lshl_b32 s31, s30, 5
    v_add_u32 v5, s31, v5
    v_mul_u32_u24 v5, 4608, v5
    v_and_b32 v6, 7, v2
    v_lshlrev_b32 v6, 4, v6
    s_lshl_b32 s31, s47, 7
    s_add_u32 s31, s31, 262144
    s_cmp_eq_u32 s30, 7
    s_cselect_b32 s31, 2147483392, s31
    v_add3_u32 v5, v5, v6, s31
    s_mov_b32 s60, 36864
    s_mov_b32 s61, 73728
    s_mov_b32 s62, 110592
    s_lshl_b32 s31, s51, 11
    s_lshl_b32 s32, s47, 6
    s_add_u32 s53, s31, s32
    v_and_b32 v12, 31, v2
    v_lshlrev_b32 v12, 1, v12
    buffer_load_ushort v13, v12, s[8:11], s53 offen
    buffer_load_dwordx4 v[16:19], v5, s[12:15], 0 offen sc1
    buffer_load_dwordx4 v[20:23], v5, s[12:15], s60 offen sc1
    buffer_load_dwordx4 v[24:27], v5, s[12:15], s61 offen sc1
    buffer_load_dwordx4 v[28:31], v5, s[12:15], s62 offen sc1
L_not_owner1:
    v_pk_add_f32 v[104:105], v[88:89], v[96:97]
    v_pk_add_f32 v[112:113], v[88:89], v[96:97] neg_lo:[0,1] neg_hi:[0,1]
    v_pk_add_f32 v[106:107], v[90:91], v[98:99]
    v_pk_add_f32 v[114:115], v[90:91], v[98:99] neg_lo:[0,1] neg_hi:[0,1]
    v_pk_add_f32 v[108:109], v[92:93], v[100:101]
    v_pk_add_f32 v[116:117], v[92:93], v[100:101] neg_lo:[0,1] neg_hi:[0,1]
    v_pk_add_f32 v[110:111], v[94:95], v[102:103]
    v_pk_add_f32 v[118:119], v[94:95], v[102:103] neg_lo:[0,1] neg_hi:[0,1]
    v_cmp_ne_u32 s[54:55], s51, v120
    s_sub_u32 s31, s51, 1024
    v_cmp_ne_u32 s[56:57], s31, v120
    v_pk_fma_f32 v[56:57], v[104:105], v[72:73], v[56:57]
    v_pk_fma_f32 v[58:59], v[106:107], v[74:75], v[58:59]
    v_pk_fma_f32 v[60:61], v[108:109], v[76:77], v[60:61]
    v_pk_fma_f32 v[62:63], v[110:111], v[78:79], v[62:63]
    v_cvt_pk_bf16_f32 v48, v56, v57
    v_cvt_pk_bf16_f32 v49, v58, v59
    v_cvt_pk_bf16_f32 v50, v60, v61
    v_cvt_pk_bf16_f32 v51, v62, v63
    s_mov_b64 exec, s[54:55]
    buffer_store_dwordx4 v[48:51], v4, s[16:19], 0 offen sc1
    s_mov_b64 exec, -1
    v_pk_fma_f32 v[64:65], v[112:113], v[80:81], v[64:65]
    v_pk_fma_f32 v[66:67], v[114:115], v[82:83], v[66:67]
    v_pk_fma_f32 v[68:69], v[116:117], v[84:85], v[68:69]
    v_pk_fma_f32 v[70:71], v[118:119], v[86:87], v[70:71]
    v_cvt_pk_bf16_f32 v52, v64, v65
    v_cvt_pk_bf16_f32 v53, v66, v67
    v_cvt_pk_bf16_f32 v54, v68, v69
    v_cvt_pk_bf16_f32 v55, v70, v71
    s_mov_b64 exec, s[56:57]
    buffer_store_dwordx4 v[52:55], v4, s[16:19], s48 offen sc1
    s_mov_b64 exec, -1
    s_cmp_eq_u32 s52, 0
    s_cbranch_scc1 L_fin
    v_and_b32 v6, 48, v2
    v_lshlrev_b32 v6, 1, v6
    s_not_b64 exec, s[54:55]
    ds_write_b128 v6, v[104:107] offset:58880
    ds_write_b128 v6, v[108:111] offset:58896
    s_not_b64 exec, s[56:57]
    ds_write_b128 v6, v[112:115] offset:58880
    ds_write_b128 v6, v[116:119] offset:58896
    s_mov_b64 exec, -1
    s_waitcnt vmcnt(2)
    s_cmp_eq_u32 s30, 7
    s_cbranch_scc1 L_row_prep
L_y_check:
    v_max3_u32 v6, v16, v17, v18
    v_max3_u32 v6, v6, v19, v20
    v_max3_u32 v6, v6, v21, v22
    v_max3_u32 v6, v6, v23, v24
    v_max3_u32 v6, v6, v25, v26
    v_max3_u32 v6, v6, v27, v28
    v_max3_u32 v6, v6, v29, v30
    v_max_u32 v6, v6, v31
    v_cmp_eq_u32 vcc, -1, v6
    s_nop 0
    s_cbranch_vccz L_y_got
    s_cmp_eq_u32 s35, 0
    s_cbranch_scc1 L_y_got
    s_sub_u32 s35, s35, 1
    buffer_load_dwordx4 v[16:19], v5, s[12:15], 0 offen sc1
    buffer_load_dwordx4 v[20:23], v5, s[12:15], s60 offen sc1
    buffer_load_dwordx4 v[24:27], v5, s[12:15], s61 offen sc1
    buffer_load_dwordx4 v[28:31], v5, s[12:15], s62 offen sc1
    s_waitcnt vmcnt(0)
    s_branch L_y_check
L_y_got:
    v_pk_add_f32 v[16:17], v[16:17], v[20:21]
    v_pk_add_f32 v[24:25], v[24:25], v[28:29]
    v_pk_add_f32 v[18:19], v[18:19], v[22:23]
    v_pk_add_f32 v[26:27], v[26:27], v[30:31]
    v_pk_add_f32 v[16:17], v[16:17], v[24:25]
    v_pk_add_f32 v[18:19], v[18:19], v[26:27]
    v_and_b32 v6, 7, v2
    v_lshlrev_b32 v6, 4, v6
    v_lshrrev_b32 v7, 4, v2
    v_lshl_add_u32 v6, v7, 2, v6
    s_lshl_b32 s31, s30, 7
    v_add_u32 v6, s31, v6
    v_permlane16_swap_b32 v16, v17
    v_permlane16_swap_b32 v18, v19
    v_add_f32 v16, v16, v17
    v_add_f32 v18, v18, v19
    s_nop 1
    v_permlane32_swap_b32 v16, v18
    v_add_f32 v16, v16, v18
    s_nop 1
    v_add_f32_dpp v16, v16, v16 row_ror:8 row_mask:0xf bank_mask:0xf
    ds_write_b32 v6, v16 offset:57984
    s_waitcnt lgkmcnt(0)
    s_barrier
    s_branch L_fin
L_row_prep:
    s_lshl_b32 s31, s34, 16
    s_and_b32 s32, s34, 0xffff0000
    v_rcp_f32 v14, s32
    v_lshlrev_b32 v13, 16, v13
    v_subrev_f32 v15, s31, v13
    v_cvt_pk_bf16_f32 v15, v15, v15
    v_lshlrev_b32 v15, 16, v15
    v_mul_f32 v15, v15, v14
    v_cvt_pk_bf16_f32 v15, v15, v15
    v_lshlrev_b32 v15, 16, v15
    s_ashr_i32 s31, s33, 31
    s_orn2_b32 s31, 0x80000000, s31
    s_xor_b32 s31, s31, s33
    s_and_b32 s31, s31, 0xfffff800
    v_cvt_pk_bf16_f32 v14, s31, s31
    v_lshlrev_b32 v14, 16, v14
    v_mul_f32 v14, 0xbfb8aa3b, v14
    v_exp_f32 v14, v14
    s_nop 0
    v_add_f32 v14, 1.0, v14
    v_rcp_f32 v14, v14
    s_nop 0
    v_cvt_pk_bf16_f32 v14, v14, v14
    v_lshlrev_b32 v14, 16, v14
    v_lshlrev_b32 v6, 1, v12
    s_waitcnt lgkmcnt(0)
    s_barrier
    ds_read_b32 v16, v6 offset:57984
    ds_read_b32 v17, v6 offset:58112
    ds_read_b32 v18, v6 offset:58240
    ds_read_b32 v19, v6 offset:58368
    ds_read_b32 v20, v6 offset:58496
    ds_read_b32 v21, v6 offset:58624
    ds_read_b32 v22, v6 offset:58752
    ds_read_b32 v23, v6 offset:58880
    s_waitcnt lgkmcnt(0)
    v_add_f32 v16, v16, v17
    v_add_f32 v18, v18, v19
    v_add_f32 v20, v20, v21
    v_add_f32 v16, v16, v22
    v_add_f32 v18, v18, v20
    v_add_f32 v16, v16, v18
    v_cvt_pk_bf16_f32 v16, v16, v16
    v_lshlrev_b32 v16, 16, v16
    v_mul_f32 v16, v16, v14
    v_cvt_pk_bf16_f32 v16, v16, v16
    v_lshlrev_b32 v16, 16, v16
    v_add_f32 v16, v16, v15
    v_cvt_pk_bf16_f32 v16, v16, v16
    v_lshlrev_b32 v16, 16, v16
    v_mul_f32 v14, 0xbfb8aa3b, v16
    v_exp_f32 v14, v14
    s_nop 0
    v_add_f32 v14, 1.0, v14
    v_rcp_f32 v14, v14
    s_nop 0
    v_mul_f32 v16, v16, v14
    v_fma_f32 v16, v16, v23, v13
    v_cvt_pk_bf16_f32 v16, v16, v16
    s_mov_b32 exec_hi, 0
    buffer_store_short v16, v12, s[16:19], s53 offen sc1
    s_mov_b64 exec, -1
    s_cmp_eq_u32 s47, 0
    s_cselect_b32 s31, 0, 2147483392
    v_mov_b32 v5, 2147483392
    v_writelane_b32 v5, s31, 0
    v_mov_b32 v6, s28
    v_mov_b32 v7, s29
    buffer_store_dwordx2 v[6:7], v5, s[12:15], 0 offen sc1
    s_branch L_fin
L_moe:
    s_cmp_ge_u32 s30, 6
    s_cbranch_scc1 L_exit
    s_and_b32 s32, s31, 7
    s_mul_i32 s32, s32, 7
    s_lshr_b32 s46, s31, 5
    s_add_u32 s46, s46, s32
    s_bfe_u32 s47, s31, 0x20003
    s_lshl_b32 s48, s46, 2
    s_add_u32 s48, s48, s47
    s_cmp_eq_u32 s30, 4
    s_cbranch_scc1 L_h1
    s_cmp_eq_u32 s30, 5
    s_cbranch_scc1 L_h2
    s_mov_b32 s18, 7340032
    s_mov_b32 s19, 0x00020000
    s_mov_b32 s22, 7340032
    s_mov_b32 s23, 0x00020000
    s_mov_b32 s26, 7340032
    s_mov_b32 s27, 0x00020000
    s_lshl_b32 s31, s47, 8
    s_lshl_b32 s32, s30, 6
    s_add_u32 s31, s31, s32
    v_and_b32 v3, 48, v2
    v_add_u32 v3, s31, v3
    v_mul_u32_u24 v3, 7168, v3
    v_and_b32 v4, 15, v2
    v_lshlrev_b32 v4, 3, v4
    s_lshl_b32 s31, s46, 7
    v_add3_u32 v3, v3, v4, s31
    s_lshl_b32 s31, s48, 15
    s_lshl_b32 s32, s30, 9
    s_add_u32 s31, s31, s32
    v_lshl_add_u32 v4, v2, 3, s31
    s_mov_b32 s50, 0x05040100
    s_mov_b32 s51, 0x07060302
    s_waitcnt lgkmcnt(0)
    s_mov_b32 s8, s4
    s_mov_b32 s9, s5
    s_mov_b32 s12, s6
    s_mov_b32 s13, s7
    s_mov_b32 s16, s38
    s_mov_b32 s17, s39
    s_mov_b32 s20, s40
    s_mov_b32 s21, s41
    s_mov_b32 s24, s42
    s_mov_b32 s25, s43
    s_mov_b32 s49, 0
    buffer_load_dwordx2 v[24:25], v3, s[16:19], s49 offen nt
    buffer_load_dwordx2 v[26:27], v3, s[20:23], s49 offen nt
    s_mov_b32 s49, 7168
    buffer_load_dwordx2 v[28:29], v3, s[16:19], s49 offen nt
    buffer_load_dwordx2 v[30:31], v3, s[20:23], s49 offen nt
    s_mov_b32 s49, 14336
    buffer_load_dwordx2 v[32:33], v3, s[16:19], s49 offen nt
    buffer_load_dwordx2 v[34:35], v3, s[20:23], s49 offen nt
    s_mov_b32 s49, 21504
    buffer_load_dwordx2 v[36:37], v3, s[16:19], s49 offen nt
    buffer_load_dwordx2 v[38:39], v3, s[20:23], s49 offen nt
    s_waitcnt vmcnt(6)
    s_mov_b32 s49, 28672
    buffer_load_dwordx2 v[40:41], v3, s[16:19], s49 offen nt
    buffer_load_dwordx2 v[42:43], v3, s[20:23], s49 offen nt
    s_waitcnt vmcnt(6)
    s_mov_b32 s49, 35840
    buffer_load_dwordx2 v[44:45], v3, s[16:19], s49 offen nt
    buffer_load_dwordx2 v[46:47], v3, s[20:23], s49 offen nt
    v_perm_b32 v8, v28, v24, s50
    v_perm_b32 v28, v28, v24, s51
    v_perm_b32 v24, v29, v25, s50
    v_perm_b32 v29, v29, v25, s51
    v_perm_b32 v25, v30, v26, s50
    v_perm_b32 v30, v30, v26, s51
    v_perm_b32 v26, v31, v27, s50
    v_perm_b32 v31, v31, v27, s51
    s_waitcnt vmcnt(6)
    s_mov_b32 s49, 43008
    buffer_load_dwordx2 v[48:49], v3, s[16:19], s49 offen nt
    buffer_load_dwordx2 v[50:51], v3, s[20:23], s49 offen nt
    s_waitcnt vmcnt(6)
    s_mov_b32 s49, 50176
    buffer_load_dwordx2 v[52:53], v3, s[16:19], s49 offen nt
    buffer_load_dwordx2 v[54:55], v3, s[20:23], s49 offen nt
    v_perm_b32 v27, v36, v32, s50
    v_perm_b32 v36, v36, v32, s51
    v_perm_b32 v32, v37, v33, s50
    v_perm_b32 v37, v37, v33, s51
    v_perm_b32 v33, v38, v34, s50
    v_perm_b32 v38, v38, v34, s51
    v_perm_b32 v34, v39, v35, s50
    v_perm_b32 v39, v39, v35, s51
    s_waitcnt vmcnt(6)
    s_mov_b32 s49, 57344
    buffer_load_dwordx2 v[56:57], v3, s[16:19], s49 offen nt
    buffer_load_dwordx2 v[58:59], v3, s[20:23], s49 offen nt
    s_waitcnt vmcnt(6)
    s_mov_b32 s49, 64512
    buffer_load_dwordx2 v[60:61], v3, s[16:19], s49 offen nt
    buffer_load_dwordx2 v[62:63], v3, s[20:23], s49 offen nt
    v_perm_b32 v35, v44, v40, s50
    v_perm_b32 v44, v44, v40, s51
    v_perm_b32 v40, v45, v41, s50
    v_perm_b32 v45, v45, v41, s51
    v_perm_b32 v41, v46, v42, s50
    v_perm_b32 v46, v46, v42, s51
    v_perm_b32 v42, v47, v43, s50
    v_perm_b32 v47, v47, v43, s51
    s_waitcnt vmcnt(6)
    s_mov_b32 s49, 71680
    buffer_load_dwordx2 v[64:65], v3, s[16:19], s49 offen nt
    buffer_load_dwordx2 v[66:67], v3, s[20:23], s49 offen nt
    s_waitcnt vmcnt(6)
    s_mov_b32 s49, 78848
    buffer_load_dwordx2 v[68:69], v3, s[16:19], s49 offen nt
    buffer_load_dwordx2 v[70:71], v3, s[20:23], s49 offen nt
    v_perm_b32 v43, v52, v48, s50
    v_perm_b32 v52, v52, v48, s51
    v_perm_b32 v48, v53, v49, s50
    v_perm_b32 v53, v53, v49, s51
    v_perm_b32 v49, v54, v50, s50
    v_perm_b32 v54, v54, v50, s51
    v_perm_b32 v50, v55, v51, s50
    v_perm_b32 v55, v55, v51, s51
    s_waitcnt vmcnt(6)
    s_mov_b32 s49, 86016
    buffer_load_dwordx2 v[72:73], v3, s[16:19], s49 offen nt
    buffer_load_dwordx2 v[74:75], v3, s[20:23], s49 offen nt
    s_waitcnt vmcnt(6)
    s_mov_b32 s49, 93184
    buffer_load_dwordx2 v[76:77], v3, s[16:19], s49 offen nt
    buffer_load_dwordx2 v[78:79], v3, s[20:23], s49 offen nt
    v_perm_b32 v51, v60, v56, s50
    v_perm_b32 v60, v60, v56, s51
    v_perm_b32 v56, v61, v57, s50
    v_perm_b32 v61, v61, v57, s51
    v_perm_b32 v57, v62, v58, s50
    v_perm_b32 v62, v62, v58, s51
    v_perm_b32 v58, v63, v59, s50
    v_perm_b32 v63, v63, v59, s51
    s_waitcnt vmcnt(6)
    s_mov_b32 s49, 100352
    buffer_load_dwordx2 v[80:81], v3, s[16:19], s49 offen nt
    buffer_load_dwordx2 v[82:83], v3, s[20:23], s49 offen nt
    s_waitcnt vmcnt(6)
    s_mov_b32 s49, 107520
    buffer_load_dwordx2 v[84:85], v3, s[16:19], s49 offen nt
    buffer_load_dwordx2 v[86:87], v3, s[20:23], s49 offen nt
    v_perm_b32 v59, v68, v64, s50
    v_perm_b32 v68, v68, v64, s51
    v_perm_b32 v64, v69, v65, s50
    v_perm_b32 v69, v69, v65, s51
    v_perm_b32 v65, v70, v66, s50
    v_perm_b32 v70, v70, v66, s51
    v_perm_b32 v66, v71, v67, s50
    v_perm_b32 v71, v71, v67, s51
    s_waitcnt vmcnt(6)
    s_mov_b32 s49, 0
    buffer_load_dwordx2 v[88:89], v4, s[24:27], s49 offen nt
    buffer_load_dwordx2 v[90:91], v4, s[24:27], s49 offen offset:2048 nt
    s_waitcnt vmcnt(6)
    s_mov_b32 s49, 4096
    buffer_load_dwordx2 v[92:93], v4, s[24:27], s49 offen nt
    buffer_load_dwordx2 v[94:95], v4, s[24:27], s49 offen offset:2048 nt
    v_perm_b32 v67, v76, v72, s50
    v_perm_b32 v76, v76, v72, s51
    v_perm_b32 v72, v77, v73, s50
    v_perm_b32 v77, v77, v73, s51
    v_perm_b32 v73, v78, v74, s50
    v_perm_b32 v78, v78, v74, s51
    v_perm_b32 v74, v79, v75, s50
    v_perm_b32 v79, v79, v75, s51
    s_waitcnt vmcnt(6)
    s_mov_b32 s49, 8192
    buffer_load_dwordx2 v[96:97], v4, s[24:27], s49 offen nt
    buffer_load_dwordx2 v[98:99], v4, s[24:27], s49 offen offset:2048 nt
    s_waitcnt vmcnt(6)
    s_mov_b32 s49, 12288
    buffer_load_dwordx2 v[100:101], v4, s[24:27], s49 offen nt
    buffer_load_dwordx2 v[102:103], v4, s[24:27], s49 offen offset:2048 nt
    v_perm_b32 v75, v84, v80, s50
    v_perm_b32 v84, v84, v80, s51
    v_perm_b32 v80, v85, v81, s50
    v_perm_b32 v85, v85, v81, s51
    v_perm_b32 v81, v86, v82, s50
    v_perm_b32 v86, v86, v82, s51
    v_perm_b32 v82, v87, v83, s50
    v_perm_b32 v87, v87, v83, s51
    s_mov_b32 s49, 16384
    buffer_load_dwordx2 v[104:105], v4, s[24:27], s49 offen nt
    buffer_load_dwordx2 v[106:107], v4, s[24:27], s49 offen offset:2048 nt
    s_mov_b32 s49, 20480
    buffer_load_dwordx2 v[108:109], v4, s[24:27], s49 offen nt
    buffer_load_dwordx2 v[110:111], v4, s[24:27], s49 offen offset:2048 nt
    s_mov_b32 s49, 24576
    buffer_load_dwordx2 v[112:113], v4, s[24:27], s49 offen nt
    buffer_load_dwordx2 v[114:115], v4, s[24:27], s49 offen offset:2048 nt
    s_mov_b32 s49, 28672
    buffer_load_dwordx2 v[116:117], v4, s[24:27], s49 offen nt
    buffer_load_dwordx2 v[118:119], v4, s[24:27], s49 offen offset:2048 nt
    v_mov_b32 v10, 0
    v_mov_b32 v11, 0
    v_mov_b32 v12, 0
    v_mov_b32 v13, 0
    v_mov_b32 v14, 0
    v_mov_b32 v15, 0
    v_mov_b32 v16, 0
    v_mov_b32 v17, 0
    s_lshl_b32 s31, s30, 7
    v_and_b32 v5, 48, v2
    v_lshl_add_u32 v5, v5, 1, s31
    v_and_b32 v6, 15, v2
    v_lshrrev_b32 v7, 4, v2
    v_lshlrev_b32 v6, 5, v6
    v_lshl_add_u32 v6, v7, 3, v6
    s_lshl_b32 s31, s30, 9
    v_add_u32 v6, s31, v6
    s_barrier
    ds_read_b128 v[120:123], v5 offset:0
    ds_read_b128 v[124:127], v5 offset:16
    s_waitcnt lgkmcnt(1)
    v_dot2c_f32_bf16 v10, v120, v8
    v_dot2c_f32_bf16 v11, v120, v28
    v_dot2c_f32_bf16 v12, v120, v24
    v_dot2c_f32_bf16 v13, v120, v29
    v_dot2c_f32_bf16 v14, v120, v25
    v_dot2c_f32_bf16 v15, v120, v30
    v_dot2c_f32_bf16 v16, v120, v26
    v_dot2c_f32_bf16 v17, v120, v31
    v_dot2c_f32_bf16 v10, v121, v27
    v_dot2c_f32_bf16 v11, v121, v36
    v_dot2c_f32_bf16 v12, v121, v32
    v_dot2c_f32_bf16 v13, v121, v37
    v_dot2c_f32_bf16 v14, v121, v33
    v_dot2c_f32_bf16 v15, v121, v38
    v_dot2c_f32_bf16 v16, v121, v34
    v_dot2c_f32_bf16 v17, v121, v39
    v_dot2c_f32_bf16 v10, v122, v35
    v_dot2c_f32_bf16 v11, v122, v44
    v_dot2c_f32_bf16 v12, v122, v40
    v_dot2c_f32_bf16 v13, v122, v45
    v_dot2c_f32_bf16 v14, v122, v41
    v_dot2c_f32_bf16 v15, v122, v46
    v_dot2c_f32_bf16 v16, v122, v42
    v_dot2c_f32_bf16 v17, v122, v47
    v_dot2c_f32_bf16 v10, v123, v43
    v_dot2c_f32_bf16 v11, v123, v52
    v_dot2c_f32_bf16 v12, v123, v48
    v_dot2c_f32_bf16 v13, v123, v53
    v_dot2c_f32_bf16 v14, v123, v49
    v_dot2c_f32_bf16 v15, v123, v54
    v_dot2c_f32_bf16 v16, v123, v50
    v_dot2c_f32_bf16 v17, v123, v55
    s_waitcnt lgkmcnt(0)
    v_dot2c_f32_bf16 v10, v124, v51
    v_dot2c_f32_bf16 v11, v124, v60
    v_dot2c_f32_bf16 v12, v124, v56
    v_dot2c_f32_bf16 v13, v124, v61
    v_dot2c_f32_bf16 v14, v124, v57
    v_dot2c_f32_bf16 v15, v124, v62
    v_dot2c_f32_bf16 v16, v124, v58
    v_dot2c_f32_bf16 v17, v124, v63
    v_dot2c_f32_bf16 v10, v125, v59
    v_dot2c_f32_bf16 v11, v125, v68
    v_dot2c_f32_bf16 v12, v125, v64
    v_dot2c_f32_bf16 v13, v125, v69
    v_dot2c_f32_bf16 v14, v125, v65
    v_dot2c_f32_bf16 v15, v125, v70
    v_dot2c_f32_bf16 v16, v125, v66
    v_dot2c_f32_bf16 v17, v125, v71
    v_dot2c_f32_bf16 v10, v126, v67
    v_dot2c_f32_bf16 v11, v126, v76
    v_dot2c_f32_bf16 v12, v126, v72
    v_dot2c_f32_bf16 v13, v126, v77
    v_dot2c_f32_bf16 v14, v126, v73
    v_dot2c_f32_bf16 v15, v126, v78
    v_dot2c_f32_bf16 v16, v126, v74
    v_dot2c_f32_bf16 v17, v126, v79
    v_dot2c_f32_bf16 v10, v127, v75
    v_dot2c_f32_bf16 v11, v127, v84
    v_dot2c_f32_bf16 v12, v127, v80
    v_dot2c_f32_bf16 v13, v127, v85
    v_dot2c_f32_bf16 v14, v127, v81
    v_dot2c_f32_bf16 v15, v127, v86
    v_dot2c_f32_bf16 v16, v127, v82
    v_dot2c_f32_bf16 v17, v127, v87
    v_permlane16_swap_b32 v10, v11
    v_permlane16_swap_b32 v12, v13
    v_permlane16_swap_b32 v14, v15
    v_permlane16_swap_b32 v16, v17
    v_add_f32 v10, v10, v11
    v_add_f32 v12, v12, v13
    v_add_f32 v14, v14, v15
    v_add_f32 v16, v16, v17
    v_permlane32_swap_b32 v10, v12
    s_nop 0
    v_permlane32_swap_b32 v14, v16
    v_add_f32 v10, v10, v12
    v_add_f32 v11, v14, v16
    ds_write_b64 v6, v[10:11] offset:512
    s_waitcnt lgkmcnt(0)
    s_barrier
    s_mul_i32 s31, s48, 4608
    s_lshl_b32 s32, s30, 10
    s_add_u32 s31, s31, s32
    s_add_u32 s31, s31, 262144
    v_lshl_add_u32 v5, v2, 4, s31
    v_mov_b32 v6, 0
    v_mov_b32 v12, 0
    v_mov_b32 v13, 0
    v_mov_b32 v14, 0
    v_mov_b32 v15, 0
    s_waitcnt vmcnt(14)
    v_perm_b32 v83, v90, v88, s50
    v_perm_b32 v90, v90, v88, s51
    v_perm_b32 v88, v91, v89, s50
    v_perm_b32 v91, v91, v89, s51
    s_waitcnt vmcnt(12)
    v_perm_b32 v89, v94, v92, s50
    v_perm_b32 v94, v94, v92, s51
    v_perm_b32 v92, v95, v93, s50
    v_perm_b32 v95, v95, v93, s51
    s_waitcnt vmcnt(10)
    v_perm_b32 v93, v98, v96, s50
    v_perm_b32 v98, v98, v96, s51
    v_perm_b32 v96, v99, v97, s50
    v_perm_b32 v99, v99, v97, s51
    s_waitcnt vmcnt(8)
    v_perm_b32 v97, v102, v100, s50
    v_perm_b32 v102, v102, v100, s51
    v_perm_b32 v100, v103, v101, s50
    v_perm_b32 v103, v103, v101, s51
    s_waitcnt vmcnt(6)
    v_perm_b32 v101, v106, v104, s50
    v_perm_b32 v106, v106, v104, s51
    v_perm_b32 v104, v107, v105, s50
    v_perm_b32 v107, v107, v105, s51
    s_waitcnt vmcnt(4)
    v_perm_b32 v105, v110, v108, s50
    v_perm_b32 v110, v110, v108, s51
    v_perm_b32 v108, v111, v109, s50
    v_perm_b32 v111, v111, v109, s51
    s_waitcnt vmcnt(2)
    v_perm_b32 v109, v114, v112, s50
    v_perm_b32 v114, v114, v112, s51
    v_perm_b32 v112, v115, v113, s50
    v_perm_b32 v115, v115, v113, s51
    s_waitcnt vmcnt(0)
    v_perm_b32 v113, v118, v116, s50
    v_perm_b32 v118, v118, v116, s51
    v_perm_b32 v116, v119, v117, s50
    v_perm_b32 v119, v119, v117, s51
    s_barrier
    ds_read_b128 v[120:123], v6 offset:2560
    ds_read_b128 v[124:127], v6 offset:2576
    s_waitcnt lgkmcnt(1)
    v_dot2c_f32_bf16 v12, v120, v83
    v_dot2c_f32_bf16 v13, v120, v90
    v_dot2c_f32_bf16 v14, v120, v88
    v_dot2c_f32_bf16 v15, v120, v91
    v_dot2c_f32_bf16 v12, v121, v89
    v_dot2c_f32_bf16 v13, v121, v94
    v_dot2c_f32_bf16 v14, v121, v92
    v_dot2c_f32_bf16 v15, v121, v95
    v_dot2c_f32_bf16 v12, v122, v93
    v_dot2c_f32_bf16 v13, v122, v98
    v_dot2c_f32_bf16 v14, v122, v96
    v_dot2c_f32_bf16 v15, v122, v99
    v_dot2c_f32_bf16 v12, v123, v97
    v_dot2c_f32_bf16 v13, v123, v102
    v_dot2c_f32_bf16 v14, v123, v100
    v_dot2c_f32_bf16 v15, v123, v103
    s_waitcnt lgkmcnt(0)
    v_dot2c_f32_bf16 v12, v124, v101
    v_dot2c_f32_bf16 v13, v124, v106
    v_dot2c_f32_bf16 v14, v124, v104
    v_dot2c_f32_bf16 v15, v124, v107
    v_dot2c_f32_bf16 v12, v125, v105
    v_dot2c_f32_bf16 v13, v125, v110
    v_dot2c_f32_bf16 v14, v125, v108
    v_dot2c_f32_bf16 v15, v125, v111
    v_dot2c_f32_bf16 v12, v126, v109
    v_dot2c_f32_bf16 v13, v126, v114
    v_dot2c_f32_bf16 v14, v126, v112
    v_dot2c_f32_bf16 v15, v126, v115
    v_dot2c_f32_bf16 v12, v127, v113
    v_dot2c_f32_bf16 v13, v127, v118
    v_dot2c_f32_bf16 v14, v127, v116
    v_dot2c_f32_bf16 v15, v127, v119
    s_nop 2
    buffer_store_dwordx4 v[12:15], v5, s[12:15], 0 offen sc1
    s_branch L_fin
L_h1:
    s_waitcnt lgkmcnt(0)
    s_mov_b32 s8, s4
    s_mov_b32 s9, s5
    s_mov_b32 s12, s6
    s_mov_b32 s13, s7
    s_load_dwordx2 s[28:29], s[6:7], 0
    s_lshl_b32 s31, s47, 9
    v_lshlrev_b32 v3, 3, v2
    v_add_u32 v4, s31, v3
    v_lshrrev_b32 v9, 4, v2
    v_mul_u32_u24 v9, 4608, v9
    v_and_b32 v10, 15, v2
    v_lshl_add_u32 v9, v10, 3, v9
    s_mul_i32 s31, s46, 18432
    s_lshl_b32 s32, s47, 7
    s_add_u32 s31, s31, s32
    s_add_u32 s31, s31, 266240
    v_add_u32 v9, s31, v9
    s_waitcnt lgkmcnt(0)
    s_add_u32 s28, s28, 0x7f4a7c15
    s_addc_u32 s29, s29, 0x9e3779b9
    v_lshlrev_b32 v5, 6, v2
    v_add_u32 v5, 4096, v5
    s_mov_b32 s60, 4096
    s_mov_b32 s61, 8192
    s_mov_b32 s62, 12288
L_mi_poll:
    buffer_load_dwordx4 v[16:19], v5, s[12:15], 0 offen sc1
    buffer_load_dwordx4 v[20:23], v5, s[12:15], s60 offen sc1
    buffer_load_dwordx4 v[24:27], v5, s[12:15], s61 offen sc1
    buffer_load_dwordx4 v[28:31], v5, s[12:15], s62 offen sc1
    s_waitcnt vmcnt(0)
    v_cmp_ne_u64 vcc, s[28:29], v[18:19]
    v_cmp_ne_u64 s[54:55], s[28:29], v[22:23]
    v_cmp_ne_u64 s[56:57], s[28:29], v[26:27]
    v_cmp_ne_u64 s[58:59], s[28:29], v[30:31]
    v_max_u32 v6, v17, v21
    v_max3_u32 v6, v6, v25, v29
    s_or_b64 s[54:55], s[54:55], vcc
    s_or_b64 s[56:57], s[56:57], s[58:59]
    s_or_b64 s[54:55], s[54:55], s[56:57]
    s_cbranch_scc0 L_mi_got
    s_cmp_eq_u32 s35, 0
    s_cbranch_scc1 L_mi_got
    s_sub_u32 s35, s35, 1
    s_branch L_mi_poll
L_mi_got:
    v_mov_b32 v7, v6
    s_nop 1
    v_max_u32_dpp v7, v7, v7 row_shr:1 row_mask:0xf bank_mask:0xf
    s_nop 1
    v_max_u32_dpp v7, v7, v7 row_shr:2 row_mask:0xf bank_mask:0xf
    s_nop 1
    v_max_u32_dpp v7, v7, v7 row_shr:4 row_mask:0xf bank_mask:0xf
    s_nop 1
    v_max_u32_dpp v7, v7, v7 row_shr:8 row_mask:0xf bank_mask:0xf
    s_nop 1
    v_max_u32_dpp v7, v7, v7 row_bcast:15 row_mask:0xa bank_mask:0xf
    s_nop 1
    v_max_u32_dpp v7, v7, v7 row_bcast:31 row_mask:0xc bank_mask:0xf
    s_nop 0
    v_readlane_b32 s33, v7, 63
    s_nop 0
    s_andn2_b32 s51, 0x7ff, s33
    s_lshl_b32 s51, s51, 11
    buffer_load_dwordx2 v[10:11], v4, s[8:11], s51 offen
    v_mov_b32 v7, v16
    v_cmp_eq_u32 vcc, s33, v21
    s_nop 1
    v_cndmask_b32 v7, v7, v20, vcc
    v_cmp_eq_u32 vcc, s33, v25
    s_nop 1
    v_cndmask_b32 v7, v7, v24, vcc
    v_cmp_eq_u32 vcc, s33, v29
    s_nop 1
    v_cndmask_b32 v7, v7, v28, vcc
    v_cmp_eq_u32 vcc, s33, v6
    s_nop 0
    s_ff1_i32_b64 s32, vcc
    v_readlane_b32 s34, v7, s32
    s_nop 0
    s_lshl_b32 s62, s34, 16
    s_and_b32 s32, s34, 0xffff0000
    v_rcp_f32 v16, s32
    s_waitcnt vmcnt(0)
    v_lshlrev_b32 v12, 16, v10
    v_and_b32 v13, 0xffff0000, v10
    v_lshlrev_b32 v14, 16, v11
    v_and_b32 v15, 0xffff0000, v11
    v_pk_add_f32 v[12:13], v[12:13], s[62:63] op_sel_hi:[1,0] neg_lo:[0,1] neg_hi:[0,1]
    v_pk_add_f32 v[14:15], v[14:15], s[62:63] op_sel_hi:[1,0] neg_lo:[0,1] neg_hi:[0,1]
    v_cvt_pk_bf16_f32 v10, v12, v13
    v_cvt_pk_bf16_f32 v11, v14, v15
    v_lshlrev_b32 v12, 16, v10
    v_and_b32 v13, 0xffff0000, v10
    v_lshlrev_b32 v14, 16, v11
    v_and_b32 v15, 0xffff0000, v11
    v_pk_mul_f32 v[12:13], v[12:13], v[16:17] op_sel_hi:[1,0]
    v_pk_mul_f32 v[14:15], v[14:15], v[16:17] op_sel_hi:[1,0]
    v_cvt_pk_bf16_f32 v10, v12, v13
    v_cvt_pk_bf16_f32 v11, v14, v15
    ds_write_b64 v3, v[10:11] offset:0
    s_waitcnt lgkmcnt(0)
    s_barrier
    s_barrier
    ds_read_b64 v[10:11], v3 offset:512
    ds_read_b64 v[12:13], v3 offset:1024
    ds_read_b64 v[14:15], v3 offset:1536
    ds_read_b64 v[16:17], v3 offset:2048
    s_waitcnt lgkmcnt(0)
    v_pk_add_f32 v[10:11], v[10:11], v[12:13]
    v_pk_add_f32 v[14:15], v[14:15], v[16:17]
    v_pk_add_f32 v[10:11], v[10:11], v[14:15]
    buffer_store_dwordx2 v[10:11], v9, s[12:15], 0 offen sc1
    s_barrier
    s_branch L_fin
L_h2:
    s_waitcnt lgkmcnt(0)
    s_mov_b32 s8, s4
    s_mov_b32 s9, s5
    s_mov_b32 s12, s6
    s_mov_b32 s13, s7
    s_mul_i32 s31, s48, 4608
    s_add_u32 s31, s31, 266240
    v_lshl_add_u32 v3, v2, 3, s31
    v_and_b32 v4, 15, v2
    v_lshlrev_b32 v4, 1, v4
    s_barrier
    s_barrier
L_hp_poll:
    buffer_load_dwordx2 v[10:11], v3, s[12:15], 0 offen sc1
    s_waitcnt vmcnt(0)
    v_max_u32 v12, v10, v11
    v_cmp_eq_u32 vcc, -1, v12
    s_nop 0
    s_cbranch_vccz L_hp_got
    s_cmp_eq_u32 s35, 0
    s_cbranch_scc1 L_hp_got
    s_sub_u32 s35, s35, 1
    s_branch L_hp_poll
L_hp_got:
    v_permlane16_swap_b32 v10, v11
    v_add_f32 v10, v10, v11
    v_mov_b32 v11, v10
    s_nop 1
    v_permlane32_swap_b32 v10, v11
    v_add_f32 v10, v10, v11
    v_mov_b32 v11, v10
    s_nop 1
    v_permlane16_swap_b32 v10, v11
    v_cvt_pk_bf16_f32 v10, v10, v11
    v_and_b32 v11, 0xffff0000, v10
    v_lshlrev_b32 v10, 16, v10
    v_mul_f32 v12, 0xbfb8aa3b, v10
    v_exp_f32 v12, v12
    s_nop 0
    v_add_f32 v12, 1.0, v12
    v_rcp_f32 v12, v12
    s_nop 0
    v_mul_f32 v10, v10, v12
    v_cvt_pk_bf16_f32 v10, v10, v10
    v_lshlrev_b32 v10, 16, v10
    v_mul_f32 v10, v10, v11
    v_cvt_pk_bf16_f32 v10, v10, v10
    ds_write_b16 v4, v10 offset:2560
    s_waitcnt lgkmcnt(0)
    s_barrier
L_fin:
L_exit:
    s_endpgm
.section .rodata,"a"
.p2align 6
.amdhsa_kernel recurrent_scan__spectral_fnet__moe_arch_mod__prompt_kernel
  .amdhsa_next_free_vgpr 128
  .amdhsa_next_free_sgpr 72
  .amdhsa_accum_offset 128
  .amdhsa_group_segment_fixed_size 0
  .amdhsa_kernarg_size 104
  .amdhsa_user_sgpr_count 2
  .amdhsa_user_sgpr_kernarg_segment_ptr 1
  .amdhsa_system_sgpr_workgroup_id_x 1
  .amdhsa_float_denorm_mode_32 3
.end_amdhsa_kernel
```

```asm
; @launch grid=(480,1,1) block=(256,1,1) lds=75776
.amdgcn_target "amdgcn-amd-amdhsa--gfx950"
.text
.globl recurrent_scan__spectral_fnet__moe_arch_mod__prompt_kernel
.p2align 8
.type recurrent_scan__spectral_fnet__moe_arch_mod__prompt_kernel,@function
recurrent_scan__spectral_fnet__moe_arch_mod__prompt_kernel:
    s_cmp_ge_u32 s2, 480
    s_cbranch_scc1 L_exit
    s_load_dwordx2 s[4:5], s[0:1], 0
    s_load_dwordx2 s[6:7], s[0:1], 96
    s_load_dwordx8 s[36:43], s[0:1], 48
    s_load_dwordx2 s[44:45], s[0:1], 80
    s_getpc_b64 s[32:33]
L_pc:
    s_bfe_u32 s31, s2, 0x30003
    v_subrev_u32 v3, 240, v0
    v_lshl_add_u32 v3, v3, 3, s31
    v_lshlrev_b32 v3, 7, v3
    v_cmp_gt_u32 vcc, L_code_end-L_pc, v3
    s_nop 0
    s_and_saveexec_b64 s[46:47], vcc
    s_cbranch_execz L_nopf
    global_load_dword v255, v3, s[32:33]
L_nopf:
    s_mov_b64 exec, -1
    v_lshrrev_b32 v1, 6, v0
    v_and_b32 v2, 63, v0
    v_readfirstlane_b32 s30, v1
    s_mov_b32 s10, 0x400000
    s_mov_b32 s11, 0x00020000
    s_mov_b32 s14, 0x10000000
    s_mov_b32 s15, 0x00020000
    s_mov_b32 s35, 65536
    v_lshlrev_b32 v3, 4, v2
    s_cmp_ge_u32 s2, 256
    s_cbranch_scc1 L_moe
    s_and_b32 s31, s2, 7
    s_lshr_b32 s32, s2, 4
    s_sub_u32 s32, 15, s32
    s_lshl_b32 s32, s32, 3
    s_add_u32 s46, s32, s31
    s_bfe_u32 s47, s2, 0x10003
    s_lshl_b32 s31, s30, 9
    s_add_u32 s52, s31, s46
    s_sub_u32 s54, 2048, s52
    s_add_u32 s31, s52, 128
    s_cmp_eq_u32 s46, 0
    s_cselect_b32 s54, s31, s54
    s_cselect_b32 s50, 1, 0
    s_cselect_b32 s31, 1, -1
    s_lshl_b32 s31, s31, 8
    s_add_u32 s53, s52, 256
    s_add_u32 s55, s54, s31
    s_lshl_b32 s56, s52, 11
    s_lshl_b32 s57, s53, 11
    s_lshl_b32 s58, s54, 11
    s_lshl_b32 s59, s55, 11
    s_mov_b32 s22, 2048
    s_mov_b32 s23, 0x00020000
    s_waitcnt lgkmcnt(0)
    s_mov_b32 s8, s4
    s_mov_b32 s9, s5
    s_mov_b32 s12, s6
    s_mov_b32 s13, s7
    s_mov_b32 s20, s36
    s_mov_b32 s21, s37
    buffer_load_dwordx4 v[152:155], v3, s[20:23], 0 offen
    buffer_load_dwordx4 v[156:159], v3, s[20:23], 0 offen offset:1024
    buffer_load_dwordx4 v[120:123], v3, s[8:11], s56 offen
    buffer_load_dwordx4 v[124:127], v3, s[8:11], s56 offen offset:1024
    buffer_load_dwordx4 v[128:131], v3, s[8:11], s57 offen
    buffer_load_dwordx4 v[132:135], v3, s[8:11], s57 offen offset:1024
    buffer_load_dwordx4 v[136:139], v3, s[8:11], s58 offen
    buffer_load_dwordx4 v[140:143], v3, s[8:11], s58 offen offset:1024
    buffer_load_dwordx4 v[144:147], v3, s[8:11], s59 offen
    buffer_load_dwordx4 v[148:151], v3, s[8:11], s59 offen offset:1024
    s_load_dwordx2 s[28:29], s[6:7], 0
    s_mov_b32 s16, s44
    s_mov_b32 s17, s45
    s_mov_b32 s18, 0x400000
    s_mov_b32 s19, 0x00020000
    v_mov_b32 v6, 0
    v_mov_b32 v7, 0
    v_mov_b32 v5, 41536
    ds_write_b64 v5, v[6:7]
    v_writelane_b32 v200, s52, 15
    v_writelane_b32 v200, s53, 31
    v_writelane_b32 v200, s54, 47
    v_writelane_b32 v200, s55, 63
    v_lshrrev_b32 v201, 8, v200
    v_lshlrev_b32 v201, 3, v201
    v_sub_u32 v200, 2047, v200
    v_bfe_u32 v202, v2, 4, 1
    v_lshrrev_b32 v6, 5, v2
    v_lshl_add_u32 v202, v6, 3, v202
    s_lshl_b32 s31, s30, 1
    v_add_u32 v202, s31, v202
    v_lshlrev_b32 v203, 2, v202
    v_lshlrev_b32 v202, 1, v202
    s_cmp_eq_u32 s47, 0
    s_cselect_b32 s51, s52, s54
    s_and_b32 s51, s51, 255
    s_cmp_eq_u32 s30, 3
    s_cselect_b32 s32, 9, 0
    v_cmp_gt_u32 vcc, s32, v2
    s_lshl_b32 s31, s51, 7
    s_add_u32 s31, s31, 32768
    v_add_u32 v4, s31, v3
    s_lshl_b32 s31, s51, 4
    s_add_u32 s31, s31, 4096
    v_writelane_b32 v4, s31, 8
    v_mov_b32 v6, 2147483392
    v_cndmask_b32 v4, v6, v4, vcc
    s_mul_i32 s31, s30, 5184
    v_and_b32 v204, 32, v2
    v_lshlrev_b32 v204, 2, v204
    v_add3_u32 v204, v204, v3, s31
    s_lshl_b32 s32, s31, 1
    s_add_u32 s32, s32, 21872
    v_sub_u32 v205, s32, v204
    v_bfe_u32 v206, v2, 2, 2
    v_mul_u32_u24 v206, 2592, v206
    v_lshrrev_b32 v6, 4, v2
    v_mul_u32_u24 v7, 640, v6
    v_add_u32 v206, v206, v7
    v_and_b32 v7, 3, v2
    v_lshlrev_b32 v7, 3, v7
    s_lshl_b32 s31, s30, 7
    v_add3_u32 v206, v206, v7, s31
    v_lshlrev_b32 v6, 12, v6
    v_and_b32 v7, 15, v2
    v_lshl_add_u32 v6, v7, 4, v6
    s_lshl_b32 s31, s30, 8
    v_add_u32 v207, s31, v6
    v_bfe_i32 v208, v2, 4, 1
    v_and_b32 v208, 0x80008000, v208
    v_bfe_u32 v160, v2, 2, 2
    s_lshl_b32 s31, s47, 2
    v_add_u32 v160, s31, v160
    v_lshrrev_b32 v161, 4, v2
    v_bfe_u32 v162, v2, 1, 1
    v_mul_u32_u24 v161, v161, v162
    v_and_b32 v162, 1, v2
    v_add_u32 v161, v161, v162
    v_cvt_f32_u32 v160, v160
    v_cvt_f32_u32 v161, v161
    v_mul_f32 v160, 0x3e000000, v160
    v_mul_f32 v161, 0x3e800000, v161
    v_cos_f32 v8, v161
    v_add_f32 v161, v161, v160
    v_cos_f32 v9, v161
    v_add_f32 v161, v161, v160
    v_cos_f32 v10, v161
    v_add_f32 v161, v161, v160
    v_cos_f32 v11, v161
    v_add_f32 v161, v161, v160
    v_cos_f32 v12, v161
    v_add_f32 v161, v161, v160
    v_cos_f32 v13, v161
    v_add_f32 v161, v161, v160
    v_cos_f32 v14, v161
    v_add_f32 v161, v161, v160
    v_cos_f32 v15, v161
    v_lshrrev_b32 v160, 2, v2
    v_and_b32 v160, 12, v160
    v_and_b32 v161, 15, v2
    v_lshlrev_b32 v161, 2, v161
    v_cvt_f32_u32 v160, v160
    v_cvt_f32_u32 v161, v161
    v_mul_f32 v212, 0x3c800000, v160
    s_lshl_b32 s31, s47, 2
    s_add_u32 s48, s31, s30
    s_sub_u32 s31, s48, 4
    s_mul_i32 s31, s31, s46
    v_cvt_f32_i32 v162, s31
    v_mul_f32 v162, 0x3a000000, v162
    v_add_f32 v213, 0x3c800000, v212
    v_add_f32 v214, 0x3d000000, v212
    v_add_f32 v215, 0x3d400000, v212
    v_mul_f32 v160, v212, v161
    v_fmamk_f32 v52, v160, 0x3d800000, v162
    v_sin_f32 v20, v160
    v_cos_f32 v160, v160
    v_cos_f32 v48, v52
    v_sin_f32 v52, v52
    v_cvt_pk_f16_f32 v16, v160, v20
    v_cvt_pk_f16_f32 v20, -v20, v160
    v_mul_f32 v160, v213, v161
    v_fmamk_f32 v53, v160, 0x3d800000, v162
    v_sin_f32 v21, v160
    v_cos_f32 v160, v160
    v_cos_f32 v49, v53
    v_sin_f32 v53, v53
    v_cvt_pk_f16_f32 v17, v160, v21
    v_cvt_pk_f16_f32 v21, -v21, v160
    v_mul_f32 v160, v214, v161
    v_fmamk_f32 v54, v160, 0x3d800000, v162
    v_sin_f32 v22, v160
    v_cos_f32 v160, v160
    v_cos_f32 v50, v54
    v_sin_f32 v54, v54
    v_cvt_pk_f16_f32 v18, v160, v22
    v_cvt_pk_f16_f32 v22, -v22, v160
    v_mul_f32 v160, v215, v161
    v_fmamk_f32 v55, v160, 0x3d800000, v162
    v_sin_f32 v23, v160
    v_cos_f32 v160, v160
    v_cos_f32 v51, v55
    v_sin_f32 v55, v55
    v_cvt_pk_f16_f32 v19, v160, v23
    v_cvt_pk_f16_f32 v23, -v23, v160
    v_add_f32 v161, 1.0, v161
    v_mul_f32 v160, v212, v161
    v_fmamk_f32 v60, v160, 0x3d800000, v162
    v_sin_f32 v28, v160
    v_cos_f32 v160, v160
    v_cos_f32 v56, v60
    v_sin_f32 v60, v60
    v_cvt_pk_f16_f32 v24, v160, v28
    v_cvt_pk_f16_f32 v28, -v28, v160
    v_mul_f32 v160, v213, v161
    v_fmamk_f32 v61, v160, 0x3d800000, v162
    v_sin_f32 v29, v160
    v_cos_f32 v160, v160
    v_cos_f32 v57, v61
    v_sin_f32 v61, v61
    v_cvt_pk_f16_f32 v25, v160, v29
    v_cvt_pk_f16_f32 v29, -v29, v160
    v_mul_f32 v160, v214, v161
    v_fmamk_f32 v62, v160, 0x3d800000, v162
    v_sin_f32 v30, v160
    v_cos_f32 v160, v160
    v_cos_f32 v58, v62
    v_sin_f32 v62, v62
    v_cvt_pk_f16_f32 v26, v160, v30
    v_cvt_pk_f16_f32 v30, -v30, v160
    v_mul_f32 v160, v215, v161
    v_fmamk_f32 v63, v160, 0x3d800000, v162
    v_sin_f32 v31, v160
    v_cos_f32 v160, v160
    v_cos_f32 v59, v63
    v_sin_f32 v63, v63
    v_cvt_pk_f16_f32 v27, v160, v31
    v_cvt_pk_f16_f32 v31, -v31, v160
    v_add_f32 v161, 1.0, v161
    v_mul_f32 v160, v212, v161
    v_fmamk_f32 v68, v160, 0x3d800000, v162
    v_sin_f32 v36, v160
    v_cos_f32 v160, v160
    v_cos_f32 v64, v68
    v_sin_f32 v68, v68
    v_cvt_pk_f16_f32 v32, v160, v36
    v_cvt_pk_f16_f32 v36, -v36, v160
    v_mul_f32 v160, v213, v161
    v_fmamk_f32 v69, v160, 0x3d800000, v162
    v_sin_f32 v37, v160
    v_cos_f32 v160, v160
    v_cos_f32 v65, v69
    v_sin_f32 v69, v69
    v_cvt_pk_f16_f32 v33, v160, v37
    v_cvt_pk_f16_f32 v37, -v37, v160
    v_mul_f32 v160, v214, v161
    v_fmamk_f32 v70, v160, 0x3d800000, v162
    v_sin_f32 v38, v160
    v_cos_f32 v160, v160
    v_cos_f32 v66, v70
    v_sin_f32 v70, v70
    v_cvt_pk_f16_f32 v34, v160, v38
    v_cvt_pk_f16_f32 v38, -v38, v160
    v_mul_f32 v160, v215, v161
    v_fmamk_f32 v71, v160, 0x3d800000, v162
    v_sin_f32 v39, v160
    v_cos_f32 v160, v160
    v_cos_f32 v67, v71
    v_sin_f32 v71, v71
    v_cvt_pk_f16_f32 v35, v160, v39
    v_cvt_pk_f16_f32 v39, -v39, v160
    v_add_f32 v161, 1.0, v161
    v_mul_f32 v160, v212, v161
    v_fmamk_f32 v76, v160, 0x3d800000, v162
    v_sin_f32 v44, v160
    v_cos_f32 v160, v160
    v_cos_f32 v72, v76
    v_sin_f32 v76, v76
    v_cvt_pk_f16_f32 v40, v160, v44
    v_cvt_pk_f16_f32 v44, -v44, v160
    v_mul_f32 v160, v213, v161
    v_fmamk_f32 v77, v160, 0x3d800000, v162
    v_sin_f32 v45, v160
    v_cos_f32 v160, v160
    v_cos_f32 v73, v77
    v_sin_f32 v77, v77
    v_cvt_pk_f16_f32 v41, v160, v45
    v_cvt_pk_f16_f32 v45, -v45, v160
    v_mul_f32 v160, v214, v161
    v_fmamk_f32 v78, v160, 0x3d800000, v162
    v_sin_f32 v46, v160
    v_cos_f32 v160, v160
    v_cos_f32 v74, v78
    v_sin_f32 v78, v78
    v_cvt_pk_f16_f32 v42, v160, v46
    v_cvt_pk_f16_f32 v46, -v46, v160
    v_mul_f32 v160, v215, v161
    v_fmamk_f32 v79, v160, 0x3d800000, v162
    v_sin_f32 v47, v160
    v_cos_f32 v160, v160
    v_cos_f32 v75, v79
    v_sin_f32 v79, v79
    v_cvt_pk_f16_f32 v43, v160, v47
    v_cvt_pk_f16_f32 v47, -v47, v160
    s_and_b32 s31, s46, 1
    s_lshl_b32 s31, s31, 6
    s_lshr_b32 s32, s46, 1
    s_add_u32 s49, s31, s32
    s_bitcmp1_b32 s49, 2
    s_cselect_b64 vcc, -1, 0
    v_cndmask_b32 v80, v16, v20, vcc
    v_cndmask_b32 v84, v20, v16, vcc
    v_cndmask_b32 v81, v17, v21, vcc
    v_cndmask_b32 v85, v21, v17, vcc
    v_cndmask_b32 v82, v18, v22, vcc
    v_cndmask_b32 v86, v22, v18, vcc
    v_cndmask_b32 v83, v19, v23, vcc
    v_cndmask_b32 v87, v23, v19, vcc
    s_bfe_u32 s31, s49, 0x10001
    v_and_b32 v6, 7, v2
    v_xor_b32 v6, s31, v6
    v_lshlrev_b32 v6, 4, v6
    v_lshrrev_b32 v7, 4, v2
    v_lshlrev_b32 v7, 3, v7
    v_bfe_u32 v209, v2, 3, 1
    v_add_u32 v7, v7, v209
    v_mul_u32_u24 v7, 16512, v7
    v_add_u32 v209, v6, v7
    s_mul_i32 s31, s48, 528384
    s_lshl_b32 s32, s49, 7
    s_add_u32 s31, s31, s32
    s_add_u32 s60, s31, 2097152
    v_and_b32 v160, 15, v2
    s_lshl_b32 s31, s30, 4
    v_add_u32 v160, s31, v160
    v_cvt_f32_u32 v160, v160
    v_add_f32 v160, 0.5, v160
    v_mul_f32 v160, 0x3b800000, v160
    v_and_b32 v161, 32, v2
    v_bfe_u32 v162, v2, 4, 1
    v_lshl_add_u32 v161, v162, 3, v161
    v_cvt_f32_u32 v161, v161
    v_mul_f32 v161, v161, v160
    v_fmamk_f32 v88, v160, 0x0, v161
    v_fmamk_f32 v162, v160, 0x40000000, v161
    v_sin_f32 v104, v88
    v_sin_f32 v163, v162
    v_cos_f32 v88, v88
    v_cos_f32 v162, v162
    v_cvt_pk_f16_f32 v104, v104, v163
    v_cvt_pk_f16_f32 v88, v88, v162
    v_fmamk_f32 v89, v160, 0x40800000, v161
    v_fmamk_f32 v162, v160, 0x40c00000, v161
    v_sin_f32 v105, v89
    v_sin_f32 v163, v162
    v_cos_f32 v89, v89
    v_cos_f32 v162, v162
    v_cvt_pk_f16_f32 v105, v105, v163
    v_cvt_pk_f16_f32 v89, v89, v162
    v_fmamk_f32 v90, v160, 0x41800000, v161
    v_fmamk_f32 v162, v160, 0x41900000, v161
    v_sin_f32 v106, v90
    v_sin_f32 v163, v162
    v_cos_f32 v90, v90
    v_cos_f32 v162, v162
    v_cvt_pk_f16_f32 v106, v106, v163
    v_cvt_pk_f16_f32 v90, v90, v162
    v_fmamk_f32 v91, v160, 0x41a00000, v161
    v_fmamk_f32 v162, v160, 0x41b00000, v161
    v_sin_f32 v107, v91
    v_sin_f32 v163, v162
    v_cos_f32 v91, v91
    v_cos_f32 v162, v162
    v_cvt_pk_f16_f32 v107, v107, v163
    v_cvt_pk_f16_f32 v91, v91, v162
    v_fmamk_f32 v92, v160, 0x42800000, v161
    v_fmamk_f32 v162, v160, 0x42840000, v161
    v_sin_f32 v108, v92
    v_sin_f32 v163, v162
    v_cos_f32 v92, v92
    v_cos_f32 v162, v162
    v_cvt_pk_f16_f32 v108, v108, v163
    v_cvt_pk_f16_f32 v92, v92, v162
    v_fmamk_f32 v93, v160, 0x42880000, v161
    v_fmamk_f32 v162, v160, 0x428c0000, v161
    v_sin_f32 v109, v93
    v_sin_f32 v163, v162
    v_cos_f32 v93, v93
    v_cos_f32 v162, v162
    v_cvt_pk_f16_f32 v109, v109, v163
    v_cvt_pk_f16_f32 v93, v93, v162
    v_fmamk_f32 v94, v160, 0x42a00000, v161
    v_fmamk_f32 v162, v160, 0x42a40000, v161
    v_sin_f32 v110, v94
    v_sin_f32 v163, v162
    v_cos_f32 v94, v94
    v_cos_f32 v162, v162
    v_cvt_pk_f16_f32 v110, v110, v163
    v_cvt_pk_f16_f32 v94, v94, v162
    v_fmamk_f32 v95, v160, 0x42a80000, v161
    v_fmamk_f32 v162, v160, 0x42ac0000, v161
    v_sin_f32 v111, v95
    v_sin_f32 v163, v162
    v_cos_f32 v95, v95
    v_cos_f32 v162, v162
    v_cvt_pk_f16_f32 v111, v111, v163
    v_cvt_pk_f16_f32 v95, v95, v162
    v_fmamk_f32 v96, v160, 0x3f800000, v161
    v_fmamk_f32 v162, v160, 0x40400000, v161
    v_sin_f32 v112, v96
    v_sin_f32 v163, v162
    v_cos_f32 v96, v96
    v_cos_f32 v162, v162
    v_cvt_pk_f16_f32 v112, v112, v163
    v_cvt_pk_f16_f32 v96, v96, v162
    v_fmamk_f32 v97, v160, 0x40a00000, v161
    v_fmamk_f32 v162, v160, 0x40e00000, v161
    v_sin_f32 v113, v97
    v_sin_f32 v163, v162
    v_cos_f32 v97, v97
    v_cos_f32 v162, v162
    v_cvt_pk_f16_f32 v113, v113, v163
    v_cvt_pk_f16_f32 v97, v97, v162
    v_fmamk_f32 v98, v160, 0x41880000, v161
    v_fmamk_f32 v162, v160, 0x41980000, v161
    v_sin_f32 v114, v98
    v_sin_f32 v163, v162
    v_cos_f32 v98, v98
    v_cos_f32 v162, v162
    v_cvt_pk_f16_f32 v114, v114, v163
    v_cvt_pk_f16_f32 v98, v98, v162
    v_fmamk_f32 v99, v160, 0x41a80000, v161
    v_fmamk_f32 v162, v160, 0x41b80000, v161
    v_sin_f32 v115, v99
    v_sin_f32 v163, v162
    v_cos_f32 v99, v99
    v_cos_f32 v162, v162
    v_cvt_pk_f16_f32 v115, v115, v163
    v_cvt_pk_f16_f32 v99, v99, v162
    v_fmamk_f32 v100, v160, 0x42820000, v161
    v_fmamk_f32 v162, v160, 0x42860000, v161
    v_sin_f32 v116, v100
    v_sin_f32 v163, v162
    v_cos_f32 v100, v100
    v_cos_f32 v162, v162
    v_cvt_pk_f16_f32 v116, v116, v163
    v_cvt_pk_f16_f32 v100, v100, v162
    v_fmamk_f32 v101, v160, 0x428a0000, v161
    v_fmamk_f32 v162, v160, 0x428e0000, v161
    v_sin_f32 v117, v101
    v_sin_f32 v163, v162
    v_cos_f32 v101, v101
    v_cos_f32 v162, v162
    v_cvt_pk_f16_f32 v117, v117, v163
    v_cvt_pk_f16_f32 v101, v101, v162
    v_fmamk_f32 v102, v160, 0x42a20000, v161
    v_fmamk_f32 v162, v160, 0x42a60000, v161
    v_sin_f32 v118, v102
    v_sin_f32 v163, v162
    v_cos_f32 v102, v102
    v_cos_f32 v162, v162
    v_cvt_pk_f16_f32 v118, v118, v163
    v_cvt_pk_f16_f32 v102, v102, v162
    v_fmamk_f32 v103, v160, 0x42aa0000, v161
    v_fmamk_f32 v162, v160, 0x42ae0000, v161
    v_sin_f32 v119, v103
    v_sin_f32 v163, v162
    v_cos_f32 v103, v103
    v_cos_f32 v162, v162
    v_cvt_pk_f16_f32 v119, v119, v163
    v_cvt_pk_f16_f32 v103, v103, v162
    v_cmp_gt_u32 vcc, 16, v2
    v_and_b32 v162, 1, v2
    v_lshlrev_b32 v162, 15, v162
    v_or_b32 v162, 0x3c00, v162
    v_and_b32 v160, 0xffff0000, v104
    v_or_b32 v162, v162, v160
    v_cndmask_b32 v104, v104, v162, vcc
    v_mov_b32 v160, 0
    v_mov_b32 v161, 0
    v_mov_b32 v162, 0
    v_mov_b32 v163, 0
    v_mov_b32 v164, 0
    v_mov_b32 v165, 0
    v_mov_b32 v166, 0
    v_mov_b32 v167, 0
    v_mov_b32 v168, 0
    v_mov_b32 v169, 0
    v_mov_b32 v170, 0
    s_mov_b32 s57, 0x3f803f80
    s_mov_b32 s59, 0xffff
    s_brev_b32 s67, 1
    s_mov_b32 s66, 0
    s_mov_b32 s64, 0x80008000
    s_mov_b32 s65, 0x80008000
    s_cmp_eq_u32 s47, 0
    s_cselect_b32 s62, s64, 0
    s_cselect_b32 s63, 0, s64
    s_waitcnt vmcnt(8)
    v_dot2c_f32_bf16 v170, s57, v152
    v_dot2c_f32_bf16 v170, s57, v153
    v_dot2c_f32_bf16 v170, s57, v154
    v_dot2c_f32_bf16 v170, s57, v155
    v_dot2c_f32_bf16 v170, s57, v156
    v_dot2c_f32_bf16 v170, s57, v157
    v_dot2c_f32_bf16 v170, s57, v158
    v_dot2c_f32_bf16 v170, s57, v159
    s_nop 2
    v_add_f32_dpp v170, v170, v170 row_shr:1 row_mask:0xf bank_mask:0xf
    s_nop 1
    v_add_f32_dpp v170, v170, v170 row_shr:2 row_mask:0xf bank_mask:0xf
    s_nop 1
    v_add_f32_dpp v170, v170, v170 row_shr:4 row_mask:0xf bank_mask:0xf
    s_nop 1
    v_add_f32_dpp v170, v170, v170 row_shr:8 row_mask:0xf bank_mask:0xf
    s_nop 1
    v_add_f32_dpp v170, v170, v170 row_bcast:15 row_mask:0xa bank_mask:0xf
    s_nop 1
    v_add_f32_dpp v170, v170, v170 row_bcast:31 row_mask:0xc bank_mask:0xf
    s_nop 0
    v_readlane_b32 s56, v170, 63
    s_waitcnt lgkmcnt(0)
    s_barrier
    s_add_u32 s28, s28, 0x7f4a7c15
    s_addc_u32 s29, s29, 0x9e3779b9
    s_setprio 2
    s_waitcnt vmcnt(6)
    ds_write_b128 v204, v[120:123] offset:0
    ds_write_b128 v204, v[124:127] offset:1280
    v_dot2c_f32_bf16 v160, s57, v120
    v_dot2c_f32_bf16 v164, v120, v120
    v_dot2c_f32_bf16 v160, s57, v121
    v_dot2c_f32_bf16 v164, v121, v121
    v_dot2c_f32_bf16 v160, s57, v122
    v_dot2c_f32_bf16 v164, v122, v122
    v_dot2c_f32_bf16 v160, s57, v123
    v_dot2c_f32_bf16 v164, v123, v123
    v_dot2c_f32_bf16 v160, s57, v124
    v_dot2c_f32_bf16 v164, v124, v124
    v_dot2c_f32_bf16 v160, s57, v125
    v_dot2c_f32_bf16 v164, v125, v125
    v_dot2c_f32_bf16 v160, s57, v126
    v_dot2c_f32_bf16 v164, v126, v126
    v_dot2c_f32_bf16 v160, s57, v127
    v_dot2c_f32_bf16 v164, v127, v127
    s_waitcnt vmcnt(4)
    ds_write_b128 v204, v[128:131] offset:2592
    ds_write_b128 v204, v[132:135] offset:3872
    v_dot2c_f32_bf16 v161, s57, v128
    v_dot2c_f32_bf16 v165, v128, v128
    v_dot2c_f32_bf16 v161, s57, v129
    v_dot2c_f32_bf16 v165, v129, v129
    v_dot2c_f32_bf16 v161, s57, v130
    v_dot2c_f32_bf16 v165, v130, v130
    v_dot2c_f32_bf16 v161, s57, v131
    v_dot2c_f32_bf16 v165, v131, v131
    v_dot2c_f32_bf16 v161, s57, v132
    v_dot2c_f32_bf16 v165, v132, v132
    v_dot2c_f32_bf16 v161, s57, v133
    v_dot2c_f32_bf16 v165, v133, v133
    v_dot2c_f32_bf16 v161, s57, v134
    v_dot2c_f32_bf16 v165, v134, v134
    v_dot2c_f32_bf16 v161, s57, v135
    v_dot2c_f32_bf16 v165, v135, v135
    s_cmp_lg_u32 s47, 0
    s_cbranch_scc1 L_dot_m
    v_dot2c_f32_bf16 v168, v152, v120
    v_dot2c_f32_bf16 v169, v152, v128
    v_dot2c_f32_bf16 v168, v153, v121
    v_dot2c_f32_bf16 v169, v153, v129
    v_dot2c_f32_bf16 v168, v154, v122
    v_dot2c_f32_bf16 v169, v154, v130
    v_dot2c_f32_bf16 v168, v155, v123
    v_dot2c_f32_bf16 v169, v155, v131
    v_dot2c_f32_bf16 v168, v156, v124
    v_dot2c_f32_bf16 v169, v156, v132
    v_dot2c_f32_bf16 v168, v157, v125
    v_dot2c_f32_bf16 v169, v157, v133
    v_dot2c_f32_bf16 v168, v158, v126
    v_dot2c_f32_bf16 v169, v158, v134
    v_dot2c_f32_bf16 v168, v159, v127
    v_dot2c_f32_bf16 v169, v159, v135
    s_waitcnt vmcnt(0)
    s_branch L_dot_done
L_dot_m:
    s_waitcnt vmcnt(0)
    v_dot2c_f32_bf16 v168, v152, v136
    v_dot2c_f32_bf16 v169, v152, v144
    v_dot2c_f32_bf16 v168, v153, v137
    v_dot2c_f32_bf16 v169, v153, v145
    v_dot2c_f32_bf16 v168, v154, v138
    v_dot2c_f32_bf16 v169, v154, v146
    v_dot2c_f32_bf16 v168, v155, v139
    v_dot2c_f32_bf16 v169, v155, v147
    v_dot2c_f32_bf16 v168, v156, v140
    v_dot2c_f32_bf16 v169, v156, v148
    v_dot2c_f32_bf16 v168, v157, v141
    v_dot2c_f32_bf16 v169, v157, v149
    v_dot2c_f32_bf16 v168, v158, v142
    v_dot2c_f32_bf16 v169, v158, v150
    v_dot2c_f32_bf16 v168, v159, v143
    v_dot2c_f32_bf16 v169, v159, v151
L_dot_done:
    v_dot2c_f32_bf16 v162, s57, v136
    v_dot2c_f32_bf16 v166, v136, v136
    v_dot2c_f32_bf16 v162, s57, v137
    v_dot2c_f32_bf16 v166, v137, v137
    v_dot2c_f32_bf16 v162, s57, v138
    v_dot2c_f32_bf16 v166, v138, v138
    v_dot2c_f32_bf16 v162, s57, v139
    v_dot2c_f32_bf16 v166, v139, v139
    v_dot2c_f32_bf16 v162, s57, v140
    v_dot2c_f32_bf16 v166, v140, v140
    v_dot2c_f32_bf16 v162, s57, v141
    v_dot2c_f32_bf16 v166, v141, v141
    v_dot2c_f32_bf16 v162, s57, v142
    v_dot2c_f32_bf16 v166, v142, v142
    v_dot2c_f32_bf16 v162, s57, v143
    v_dot2c_f32_bf16 v166, v143, v143
    v_permlane16_swap_b32 v168, v169
    v_permlane16_swap_b32 v160, v161
    v_permlane16_swap_b32 v164, v165
    v_add_f32 v168, v168, v169
    v_add_f32 v160, v160, v161
    v_add_f32 v164, v164, v165
    v_mov_b32 v169, v168
    v_dot2c_f32_bf16 v163, s57, v144
    v_dot2c_f32_bf16 v167, v144, v144
    v_dot2c_f32_bf16 v163, s57, v145
    v_dot2c_f32_bf16 v167, v145, v145
    v_dot2c_f32_bf16 v163, s57, v146
    v_dot2c_f32_bf16 v167, v146, v146
    v_dot2c_f32_bf16 v163, s57, v147
    v_dot2c_f32_bf16 v167, v147, v147
    v_dot2c_f32_bf16 v163, s57, v148
    v_dot2c_f32_bf16 v167, v148, v148
    v_dot2c_f32_bf16 v163, s57, v149
    v_dot2c_f32_bf16 v167, v149, v149
    v_dot2c_f32_bf16 v163, s57, v150
    v_dot2c_f32_bf16 v167, v150, v150
    v_dot2c_f32_bf16 v163, s57, v151
    v_dot2c_f32_bf16 v167, v151, v151
    v_permlane32_swap_b32 v168, v169
    v_add_f32 v168, v168, v169
    v_permlane16_swap_b32 v162, v163
    v_permlane16_swap_b32 v166, v167
    v_add_f32 v162, v162, v163
    v_add_f32 v166, v166, v167
    v_add_f32_dpp v168, v168, v168 row_shr:1 row_mask:0xf bank_mask:0xf
    v_permlane32_swap_b32 v160, v162
    v_permlane32_swap_b32 v164, v166
    v_add_f32 v160, v160, v162
    v_add_f32 v164, v164, v166
    v_add_f32_dpp v168, v168, v168 row_shr:2 row_mask:0xf bank_mask:0xf
    v_add_f32_dpp v160, v160, v160 row_shr:1 row_mask:0xf bank_mask:0xf
    v_add_f32_dpp v164, v164, v164 row_shr:1 row_mask:0xf bank_mask:0xf
    v_add_f32_dpp v168, v168, v168 row_shr:4 row_mask:0xf bank_mask:0xf
    v_add_f32_dpp v160, v160, v160 row_shr:2 row_mask:0xf bank_mask:0xf
    v_add_f32_dpp v164, v164, v164 row_shr:2 row_mask:0xf bank_mask:0xf
    v_add_f32_dpp v168, v168, v168 row_shr:8 row_mask:0xf bank_mask:0xf
    v_add_f32_dpp v160, v160, v160 row_shr:4 row_mask:0xf bank_mask:0xf
    v_add_f32_dpp v164, v164, v164 row_shr:4 row_mask:0xf bank_mask:0xf
    s_nop 0
    v_add_f32_dpp v160, v160, v160 row_shr:8 row_mask:0xf bank_mask:0xf
    v_add_f32_dpp v164, v164, v164 row_shr:8 row_mask:0xf bank_mask:0xf
    v_mul_f32 v160, 0x3a800000, v160
    v_mul_f32 v164, 0x3a800000, v164
    v_fma_f32 v164, -v160, v160, v164
    v_cvt_pk_bf16_f32 v161, -v160, -v160
    v_max_f32 v164, 0, v164
    v_cvt_pk_bf16_f32 v164, v164, v164
    v_and_b32 v164, 0xffff0000, v164
    v_add_f32 v164, 0x3727c5ac, v164
    v_cvt_pk_bf16_f32 v164, v164, v164
    v_and_b32 v164, 0xffff0000, v164
    v_sqrt_f32 v164, v164
    v_and_b32 v170, 0xffff0000, v161
    v_cvt_pk_bf16_f32 v162, v160, v164
    v_and_b32 v164, 0xffff0000, v162
    v_rcp_f32 v164, v164
    v_fmac_f32 v168, s56, v170
    v_mul_f32 v168, v168, v164
    v_ashrrev_i32 v170, 31, v168
    v_or_b32 v170, 0x80000000, v170
    v_xor_b32 v168, v168, v170
    v_and_b32 v168, 0xfffff800, v168
    v_or_b32 v163, v200, v168
    s_mov_b64 exec, s[62:63]
    ds_write_b64 v201, v[162:163] offset:41472
    ds_max_u64 v5, v[162:163]
    s_mov_b64 exec, s[64:65]
    ds_write_b16 v202, v161 offset:41568
    ds_write_b32 v203, v164 offset:42752
    s_mov_b64 exec, -1
    v_min_u32 v5, 8, v2
    v_lshlrev_b32 v5, 3, v5
    v_mov_b32 v174, s28
    v_mov_b32 v175, s29
    v_mov_b32 v1, 0
    s_waitcnt lgkmcnt(0)
    s_barrier
    ds_read_b64 v[172:173], v5 offset:41472
    ds_read_b128 v[176:179], v1 offset:42752
    ds_read_b128 v[180:183], v1 offset:42768
    ds_read_b128 v[184:187], v1 offset:42784
    ds_read_b128 v[188:191], v1 offset:42800
    ds_read_b128 v[192:195], v1 offset:41568
    ds_read_b128 v[196:199], v1 offset:41584
    v_mov_b32_dpp v160, v136 wave_rol:1 row_mask:0xf bank_mask:0xf
    v_mov_b32_dpp v161, v140 wave_rol:1 row_mask:0xf bank_mask:0xf
    v_mov_b32_dpp v162, v144 wave_rol:1 row_mask:0xf bank_mask:0xf
    v_mov_b32_dpp v163, v148 wave_rol:1 row_mask:0xf bank_mask:0xf
    v_cndmask_b32 v164, v160, v161, s[66:67]
    v_cndmask_b32 v165, v161, v160, s[66:67]
    v_cndmask_b32 v166, v162, v163, s[66:67]
    v_cndmask_b32 v167, v163, v162, s[66:67]
    s_waitcnt lgkmcnt(6)
    buffer_store_dwordx4 v[172:175], v4, s[12:15], 0 offen sc1
    s_setprio 1
    s_cmp_lg_u32 s50, 0
    s_cbranch_scc1 L_second_plain
    v_bfi_b32 v220, s59, v164, v139
    v_bfi_b32 v221, s59, v139, v138
    v_bfi_b32 v222, s59, v138, v137
    v_bfi_b32 v223, s59, v137, v136
    ds_write_b128 v205, v[220:223] offset:1280
    v_bfi_b32 v216, s59, v165, v143
    v_bfi_b32 v217, s59, v143, v142
    v_bfi_b32 v218, s59, v142, v141
    v_bfi_b32 v219, s59, v141, v140
    ds_write_b128 v205, v[216:219] offset:0
    v_bfi_b32 v228, s59, v166, v147
    v_bfi_b32 v229, s59, v147, v146
    v_bfi_b32 v230, s59, v146, v145
    v_bfi_b32 v231, s59, v145, v144
    ds_write_b128 v205, v[228:231] offset:3872
    v_bfi_b32 v224, s59, v167, v151
    v_bfi_b32 v225, s59, v151, v150
    v_bfi_b32 v226, s59, v150, v149
    v_bfi_b32 v227, s59, v149, v148
    ds_write_b128 v205, v[224:227] offset:2592
    s_branch L_second_done
L_second_plain:
    ds_write_b128 v204, v[136:139] offset:20736
    ds_write_b128 v204, v[140:143] offset:22016
    ds_write_b128 v204, v[144:147] offset:23328
    ds_write_b128 v204, v[148:151] offset:24608
L_second_done:
    s_waitcnt lgkmcnt(4)
    v_pk_mul_f32 v[176:177], v[176:177], v[8:9]
    v_pk_mul_f32 v[178:179], v[178:179], v[10:11]
    v_pk_mul_f32 v[180:181], v[180:181], v[12:13]
    v_pk_mul_f32 v[182:183], v[182:183], v[14:15]
    v_pk_mul_f32 v[184:185], v[184:185], v[8:9]
    v_pk_mul_f32 v[186:187], v[186:187], v[10:11]
    v_pk_mul_f32 v[188:189], v[188:189], v[12:13]
    v_pk_mul_f32 v[190:191], v[190:191], v[14:15]
    v_cvt_pk_bf16_f32 v160, v176, v177
    v_cvt_pk_bf16_f32 v152, v184, v185
    v_cvt_pk_bf16_f32 v161, v178, v179
    v_cvt_pk_bf16_f32 v153, v186, v187
    v_cvt_pk_bf16_f32 v162, v180, v181
    v_cvt_pk_bf16_f32 v154, v188, v189
    v_cvt_pk_bf16_f32 v163, v182, v183
    v_cvt_pk_bf16_f32 v155, v190, v191
    s_waitcnt lgkmcnt(0)
    s_barrier
    ds_read_b64_tr_b16 v[120:121], v206 offset:0
    ds_read_b64_tr_b16 v[122:123], v206 offset:10368
    ds_read_b64_tr_b16 v[124:125], v206 offset:20736
    ds_read_b64_tr_b16 v[126:127], v206 offset:31104
    ds_read_b64_tr_b16 v[128:129], v206 offset:32
    ds_read_b64_tr_b16 v[130:131], v206 offset:10400
    ds_read_b64_tr_b16 v[132:133], v206 offset:20768
    ds_read_b64_tr_b16 v[134:135], v206 offset:31136
    ds_read_b64_tr_b16 v[136:137], v206 offset:64
    ds_read_b64_tr_b16 v[138:139], v206 offset:10432
    ds_read_b64_tr_b16 v[140:141], v206 offset:20800
    ds_read_b64_tr_b16 v[142:143], v206 offset:31168
    v_xor_b32 v164, v208, v160
    v_xor_b32 v156, v208, v152
    v_xor_b32 v165, v208, v161
    v_xor_b32 v157, v208, v153
    v_xor_b32 v166, v208, v162
    v_xor_b32 v158, v208, v154
    v_xor_b32 v167, v208, v163
    v_xor_b32 v159, v208, v155
    s_cmp_lg_u32 s50, 0
    s_cbranch_scc1 L_st1_split
    v_mfma_f32_16x16x32_bf16 v[168:171], v[160:163], v[192:195], 0
    v_mfma_f32_16x16x32_bf16 v[168:171], v[152:155], v[196:199], v[168:171]
    s_waitcnt lgkmcnt(10)
    ds_read_b64_tr_b16 v[144:145], v206 offset:96
    ds_read_b64_tr_b16 v[146:147], v206 offset:10464
    ds_read_b64_tr_b16 v[148:149], v206 offset:20832
    ds_read_b64_tr_b16 v[150:151], v206 offset:31200
    v_mfma_f32_16x16x32_bf16 v[220:223], v[164:167], v[120:123], 0
    v_mfma_f32_16x16x32_bf16 v[216:219], v[160:163], v[120:123], v[168:171]
    s_waitcnt lgkmcnt(12)
    v_mfma_f32_16x16x32_bf16 v[220:223], v[156:159], v[124:127], v[220:223]
    v_mfma_f32_16x16x32_bf16 v[216:219], v[152:155], v[124:127], v[216:219]
    s_waitcnt lgkmcnt(10)
    v_mfma_f32_16x16x32_bf16 v[228:231], v[164:167], v[128:131], 0
    v_mfma_f32_16x16x32_bf16 v[224:227], v[160:163], v[128:131], v[168:171]
    s_waitcnt lgkmcnt(8)
    v_mfma_f32_16x16x32_bf16 v[228:231], v[156:159], v[132:135], v[228:231]
    v_mfma_f32_16x16x32_bf16 v[224:227], v[152:155], v[132:135], v[224:227]
    s_waitcnt lgkmcnt(6)
    v_mfma_f32_16x16x32_bf16 v[236:239], v[164:167], v[136:139], 0
    v_mfma_f32_16x16x32_bf16 v[232:235], v[160:163], v[136:139], v[168:171]
    s_waitcnt lgkmcnt(4)
    v_mfma_f32_16x16x32_bf16 v[236:239], v[156:159], v[140:143], v[236:239]
    v_mfma_f32_16x16x32_bf16 v[232:235], v[152:155], v[140:143], v[232:235]
    v_cvt_pk_f16_f32 v176, v216, v217
    v_cvt_pk_f16_f32 v180, v218, v219
    v_cvt_pk_f16_f32 v184, v220, v221
    v_cvt_pk_f16_f32 v188, v222, v223
    s_waitcnt lgkmcnt(2)
    v_mfma_f32_16x16x32_bf16 v[244:247], v[164:167], v[144:147], 0
    v_mfma_f32_16x16x32_bf16 v[240:243], v[160:163], v[144:147], v[168:171]
    s_waitcnt lgkmcnt(0)
    v_mfma_f32_16x16x32_bf16 v[244:247], v[156:159], v[148:151], v[244:247]
    v_mfma_f32_16x16x32_bf16 v[240:243], v[152:155], v[148:151], v[240:243]
    v_cvt_pk_f16_f32 v177, v224, v225
    v_cvt_pk_f16_f32 v181, v226, v227
    v_cvt_pk_f16_f32 v185, v228, v229
    v_cvt_pk_f16_f32 v189, v230, v231
    v_cvt_pk_f16_f32 v178, v232, v233
    v_cvt_pk_f16_f32 v182, v234, v235
    v_cvt_pk_f16_f32 v186, v236, v237
    v_cvt_pk_f16_f32 v190, v238, v239
    v_cvt_pk_f16_f32 v179, v240, v241
    v_cvt_pk_f16_f32 v183, v242, v243
    v_cvt_pk_f16_f32 v187, v244, v245
    v_cvt_pk_f16_f32 v191, v246, v247
    ds_write_b128 v207, v[176:179] offset:43008
    ds_write_b128 v207, v[180:183] offset:44032
    ds_write_b128 v207, v[184:187] offset:45056
    ds_write_b128 v207, v[188:191] offset:46080
    s_branch L_st1_done
L_st1_split:
    s_waitcnt lgkmcnt(8)
    ds_read_b64_tr_b16 v[144:145], v206 offset:96
    ds_read_b64_tr_b16 v[146:147], v206 offset:10464
    ds_read_b64_tr_b16 v[148:149], v206 offset:20832
    ds_read_b64_tr_b16 v[150:151], v206 offset:31200
    s_waitcnt lgkmcnt(0)
    v_mfma_f32_16x16x32_bf16 v[168:171], v[160:163], v[192:195], 0
    v_mfma_f32_16x16x32_bf16 v[220:223], v[164:167], v[120:123], 0
    v_mfma_f32_16x16x32_bf16 v[216:219], v[160:163], v[120:123], v[168:171]
    v_mfma_f32_16x16x32_bf16 v[228:231], v[164:167], v[128:131], 0
    v_mfma_f32_16x16x32_bf16 v[224:227], v[160:163], v[128:131], v[168:171]
    v_mfma_f32_16x16x32_bf16 v[236:239], v[164:167], v[136:139], 0
    v_mfma_f32_16x16x32_bf16 v[232:235], v[160:163], v[136:139], v[168:171]
    v_mfma_f32_16x16x32_bf16 v[244:247], v[164:167], v[144:147], 0
    v_mfma_f32_16x16x32_bf16 v[240:243], v[160:163], v[144:147], v[168:171]
    s_nop 1
    v_cvt_pk_f16_f32 v176, v216, v217
    v_cvt_pk_f16_f32 v180, v218, v219
    v_cvt_pk_f16_f32 v184, v220, v221
    v_cvt_pk_f16_f32 v188, v222, v223
    v_cvt_pk_f16_f32 v177, v224, v225
    v_cvt_pk_f16_f32 v181, v226, v227
    v_cvt_pk_f16_f32 v185, v228, v229
    v_cvt_pk_f16_f32 v189, v230, v231
    v_cvt_pk_f16_f32 v178, v232, v233
    v_cvt_pk_f16_f32 v182, v234, v235
    v_cvt_pk_f16_f32 v186, v236, v237
    v_cvt_pk_f16_f32 v190, v238, v239
    v_cvt_pk_f16_f32 v179, v240, v241
    v_cvt_pk_f16_f32 v183, v242, v243
    v_cvt_pk_f16_f32 v187, v244, v245
    v_cvt_pk_f16_f32 v191, v246, v247
    ds_write_b128 v207, v[176:179] offset:43008
    ds_write_b128 v207, v[180:183] offset:44032
    ds_write_b128 v207, v[184:187] offset:45056
    ds_write_b128 v207, v[188:191] offset:46080
    v_mfma_f32_16x16x32_bf16 v[168:171], v[152:155], v[196:199], 0
    v_mfma_f32_16x16x32_bf16 v[220:223], v[156:159], v[124:127], 0
    v_mfma_f32_16x16x32_bf16 v[216:219], v[152:155], v[124:127], v[168:171]
    v_mfma_f32_16x16x32_bf16 v[228:231], v[156:159], v[132:135], 0
    v_mfma_f32_16x16x32_bf16 v[224:227], v[152:155], v[132:135], v[168:171]
    v_mfma_f32_16x16x32_bf16 v[236:239], v[156:159], v[140:143], 0
    v_mfma_f32_16x16x32_bf16 v[232:235], v[152:155], v[140:143], v[168:171]
    v_mfma_f32_16x16x32_bf16 v[244:247], v[156:159], v[148:151], 0
    v_mfma_f32_16x16x32_bf16 v[240:243], v[152:155], v[148:151], v[168:171]
    s_waitcnt lgkmcnt(0)
    s_nop 0
    v_cvt_pk_f16_f32 v176, v216, v217
    v_cvt_pk_f16_f32 v180, v218, v219
    v_cvt_pk_f16_f32 v184, v220, v221
    v_cvt_pk_f16_f32 v188, v222, v223
    v_cvt_pk_f16_f32 v177, v224, v225
    v_cvt_pk_f16_f32 v181, v226, v227
    v_cvt_pk_f16_f32 v185, v228, v229
    v_cvt_pk_f16_f32 v189, v230, v231
    v_cvt_pk_f16_f32 v178, v232, v233
    v_cvt_pk_f16_f32 v182, v234, v235
    v_cvt_pk_f16_f32 v186, v236, v237
    v_cvt_pk_f16_f32 v190, v238, v239
    v_cvt_pk_f16_f32 v179, v240, v241
    v_cvt_pk_f16_f32 v183, v242, v243
    v_cvt_pk_f16_f32 v187, v244, v245
    v_cvt_pk_f16_f32 v191, v246, v247
    ds_write_b128 v207, v[176:179] offset:59392
    ds_write_b128 v207, v[180:183] offset:60416
    ds_write_b128 v207, v[184:187] offset:61440
    ds_write_b128 v207, v[188:191] offset:62464
L_st1_done:
    s_lshl_b32 s31, s30, 12
    v_add_u32 v5, s31, v3
    s_and_b32 s31, s28, 0x30003
    v_mov_b32 v210, s31
    s_mov_b32 s58, 0xfffcfffc
    s_waitcnt lgkmcnt(0)
    s_barrier
L_st23:
    ds_read_b128 v[120:123], v5 offset:43008
    ds_read_b128 v[124:127], v5 offset:44032
    ds_read_b128 v[128:131], v5 offset:45056
    ds_read_b128 v[132:135], v5 offset:46080
    s_add_u32 s61, s60, 33024
    s_add_u32 s62, s61, 33024
    s_add_u32 s63, s62, 33024
    s_waitcnt lgkmcnt(3)
    v_mfma_f32_16x16x32_f16 v[136:139], v[120:123], v[16:19], 0
    v_mfma_f32_16x16x32_f16 v[140:143], v[120:123], v[20:23], 0
    s_waitcnt lgkmcnt(2)
    v_mfma_f32_16x16x32_f16 v[144:147], v[124:127], v[24:27], 0
    v_mfma_f32_16x16x32_f16 v[148:151], v[124:127], v[28:31], 0
    s_nop 3
    v_pk_mul_f32 v[152:153], v[48:49], v[136:137]
    v_pk_mul_f32 v[154:155], v[50:51], v[138:139]
    v_pk_mul_f32 v[156:157], v[52:53], v[136:137]
    v_pk_mul_f32 v[158:159], v[54:55], v[138:139]
    v_pk_fma_f32 v[152:153], v[52:53], v[140:141], v[152:153]
    v_pk_fma_f32 v[156:157], v[48:49], v[140:141], v[156:157] neg_lo:[0,0,1] neg_hi:[0,0,1]
    v_pk_fma_f32 v[154:155], v[54:55], v[142:143], v[154:155]
    v_pk_fma_f32 v[158:159], v[50:51], v[142:143], v[158:159] neg_lo:[0,0,1] neg_hi:[0,0,1]
    v_cvt_pk_f16_f32 v120, v152, v156
    v_cvt_pk_f16_f32 v121, v153, v157
    v_cvt_pk_f16_f32 v122, v154, v158
    v_cvt_pk_f16_f32 v123, v155, v159
    s_waitcnt lgkmcnt(1)
    v_mfma_f32_16x16x32_f16 v[136:139], v[128:131], v[32:35], 0
    v_mfma_f32_16x16x32_f16 v[140:143], v[128:131], v[36:39], 0
    v_mfma_f32_16x16x32_f16 v[216:219], v[80:83], v[120:123], 0
    v_mfma_f32_16x16x32_f16 v[220:223], v[84:87], v[120:123], 0
    v_pk_mul_f32 v[152:153], v[56:57], v[144:145]
    v_pk_mul_f32 v[154:155], v[58:59], v[146:147]
    v_pk_mul_f32 v[156:157], v[60:61], v[144:145]
    v_pk_mul_f32 v[158:159], v[62:63], v[146:147]
    v_pk_fma_f32 v[152:153], v[60:61], v[148:149], v[152:153]
    v_pk_fma_f32 v[156:157], v[56:57], v[148:149], v[156:157] neg_lo:[0,0,1] neg_hi:[0,0,1]
    v_pk_fma_f32 v[154:155], v[62:63], v[150:151], v[154:155]
    v_pk_fma_f32 v[158:159], v[58:59], v[150:151], v[158:159] neg_lo:[0,0,1] neg_hi:[0,0,1]
    v_cvt_pk_f16_f32 v124, v152, v156
    v_cvt_pk_f16_f32 v125, v153, v157
    v_cvt_pk_f16_f32 v126, v154, v158
    v_cvt_pk_f16_f32 v127, v155, v159
    s_waitcnt lgkmcnt(0)
    v_mfma_f32_16x16x32_f16 v[144:147], v[132:135], v[40:43], 0
    v_mfma_f32_16x16x32_f16 v[148:151], v[132:135], v[44:47], 0
    v_mfma_f32_16x16x32_f16 v[224:227], v[80:83], v[124:127], 0
    v_mfma_f32_16x16x32_f16 v[228:231], v[84:87], v[124:127], 0
    v_pk_mul_f32 v[152:153], v[64:65], v[136:137]
    v_pk_mul_f32 v[154:155], v[66:67], v[138:139]
    v_pk_mul_f32 v[156:157], v[68:69], v[136:137]
    v_pk_mul_f32 v[158:159], v[70:71], v[138:139]
    v_pk_fma_f32 v[152:153], v[68:69], v[140:141], v[152:153]
    v_pk_fma_f32 v[156:157], v[64:65], v[140:141], v[156:157] neg_lo:[0,0,1] neg_hi:[0,0,1]
    v_pk_fma_f32 v[154:155], v[70:71], v[142:143], v[154:155]
    v_pk_fma_f32 v[158:159], v[66:67], v[142:143], v[158:159] neg_lo:[0,0,1] neg_hi:[0,0,1]
    v_cvt_pk_f16_f32 v128, v152, v156
    v_cvt_pk_f16_f32 v129, v153, v157
    v_cvt_pk_f16_f32 v130, v154, v158
    v_cvt_pk_f16_f32 v131, v155, v159
    s_nop 1
    v_mfma_f32_16x16x32_f16 v[232:235], v[80:83], v[128:131], 0
    v_mfma_f32_16x16x32_f16 v[236:239], v[84:87], v[128:131], 0
    v_pk_mul_f32 v[152:153], v[72:73], v[144:145]
    v_pk_mul_f32 v[154:155], v[74:75], v[146:147]
    v_pk_mul_f32 v[156:157], v[76:77], v[144:145]
    v_pk_mul_f32 v[158:159], v[78:79], v[146:147]
    v_pk_fma_f32 v[152:153], v[76:77], v[148:149], v[152:153]
    v_pk_fma_f32 v[156:157], v[72:73], v[148:149], v[156:157] neg_lo:[0,0,1] neg_hi:[0,0,1]
    v_pk_fma_f32 v[154:155], v[78:79], v[150:151], v[154:155]
    v_pk_fma_f32 v[158:159], v[74:75], v[150:151], v[158:159] neg_lo:[0,0,1] neg_hi:[0,0,1]
    v_cvt_pk_f16_f32 v132, v152, v156
    v_cvt_pk_f16_f32 v133, v153, v157
    v_cvt_pk_f16_f32 v134, v154, v158
    v_cvt_pk_f16_f32 v135, v155, v159
    s_nop 1
    v_mfma_f32_16x16x32_f16 v[240:243], v[80:83], v[132:135], 0
    v_mfma_f32_16x16x32_f16 v[244:247], v[84:87], v[132:135], 0
    v_cvt_pk_f16_f32 v176, v216, v224
    v_cvt_pk_f16_f32 v178, v220, v228
    v_and_or_b32 v176, v176, s58, v210
    v_and_or_b32 v178, v178, s58, v210
    v_cvt_pk_f16_f32 v180, v217, v225
    v_cvt_pk_f16_f32 v182, v221, v229
    v_and_or_b32 v180, v180, s58, v210
    v_and_or_b32 v182, v182, s58, v210
    v_cvt_pk_f16_f32 v184, v218, v226
    v_cvt_pk_f16_f32 v186, v222, v230
    v_and_or_b32 v184, v184, s58, v210
    v_and_or_b32 v186, v186, s58, v210
    v_cvt_pk_f16_f32 v188, v219, v227
    v_cvt_pk_f16_f32 v190, v223, v231
    v_and_or_b32 v188, v188, s58, v210
    v_and_or_b32 v190, v190, s58, v210
    v_cvt_pk_f16_f32 v177, v232, v240
    v_cvt_pk_f16_f32 v179, v236, v244
    v_and_or_b32 v177, v177, s58, v210
    v_and_or_b32 v179, v179, s58, v210
    buffer_store_dwordx4 v[176:179], v209, s[12:15], s60 offen sc1
    v_cvt_pk_f16_f32 v181, v233, v241
    v_cvt_pk_f16_f32 v183, v237, v245
    v_and_or_b32 v181, v181, s58, v210
    v_and_or_b32 v183, v183, s58, v210
    buffer_store_dwordx4 v[180:183], v209, s[12:15], s61 offen sc1
    v_cvt_pk_f16_f32 v185, v234, v242
    v_cvt_pk_f16_f32 v187, v238, v246
    v_and_or_b32 v185, v185, s58, v210
    v_and_or_b32 v187, v187, s58, v210
    buffer_store_dwordx4 v[184:187], v209, s[12:15], s62 offen sc1
    v_cvt_pk_f16_f32 v189, v235, v243
    v_cvt_pk_f16_f32 v191, v239, v247
    v_and_or_b32 v189, v189, s58, v210
    v_and_or_b32 v191, v191, s58, v210
    buffer_store_dwordx4 v[188:191], v209, s[12:15], s63 offen sc1
    s_cmp_eq_u32 s50, 0
    s_cbranch_scc1 L_p1_done
    s_mov_b32 s50, 0
    s_add_u32 s60, s60, 16384
    v_add_u32 v5, 16384, v5
    s_sub_u32 s31, s48, 4
    v_cvt_f32_i32 v162, s31
    v_mul_f32 v162, 0x3d800000, v162
    v_and_b32 v161, 15, v2
    v_lshlrev_b32 v161, 2, v161
    v_cvt_f32_u32 v161, v161
    v_fma_f32 v160, v212, v161, v162
    v_sin_f32 v84, v160
    v_cos_f32 v160, v160
    s_nop 0
    v_cvt_pk_f16_f32 v80, v160, v84
    v_cvt_pk_f16_f32 v84, -v84, v160
    v_fma_f32 v160, v213, v161, v162
    v_sin_f32 v85, v160
    v_cos_f32 v160, v160
    s_nop 0
    v_cvt_pk_f16_f32 v81, v160, v85
    v_cvt_pk_f16_f32 v85, -v85, v160
    v_fma_f32 v160, v214, v161, v162
    v_sin_f32 v86, v160
    v_cos_f32 v160, v160
    s_nop 0
    v_cvt_pk_f16_f32 v82, v160, v86
    v_cvt_pk_f16_f32 v86, -v86, v160
    v_fma_f32 v160, v215, v161, v162
    v_sin_f32 v87, v160
    v_cos_f32 v160, v160
    s_nop 0
    v_cvt_pk_f16_f32 v83, v160, v87
    v_cvt_pk_f16_f32 v87, -v87, v160
    s_branch L_st23
L_p1_done:
    s_setprio 0
    s_and_b32 s46, s2, 7
    s_lshr_b32 s47, s2, 3
    s_mov_b32 s48, 0x200000
    v_and_b32 v248, 15, v2
    s_lshl_b32 s31, s30, 7
    s_add_u32 s31, s31, s46
    v_lshl_add_u32 v248, v248, 3, s31
    s_lshl_b32 s31, s46, 1
    s_add_u32 s31, s31, 1016
    v_sub_u32 v249, s31, v248
    v_and_b32 v6, 48, v2
    s_lshl_b32 s31, s47, 6
    v_add_u32 v6, s31, v6
    v_lshl_add_u32 v4, v248, 11, v6
    v_lshl_add_u32 v5, v249, 11, v6
    s_mov_b32 s49, 32768
    v_and_b32 v6, 255, v248
    v_lshlrev_b32 v6, 7, v6
    v_lshrrev_b32 v1, 8, v248
    v_lshl_add_u32 v6, v1, 4, v6
    v_and_b32 v7, 255, v249
    v_lshlrev_b32 v7, 7, v7
    v_lshrrev_b32 v1, 8, v249
    v_lshl_add_u32 v7, v1, 4, v7
    buffer_load_dwordx4 v[8:11], v4, s[8:11], 0 offen
    buffer_load_dwordx4 v[12:15], v4, s[8:11], s48 offen
    buffer_load_dwordx4 v[16:19], v5, s[8:11], 0 offen
    buffer_load_dwordx4 v[20:23], v5, s[8:11], s48 offen
    buffer_load_dwordx4 v[24:27], v6, s[12:15], s49 offen offset:0
    buffer_load_dwordx4 v[28:31], v6, s[12:15], s49 offen offset:64
    buffer_load_dwordx4 v[32:35], v7, s[12:15], s49 offen offset:0
    buffer_load_dwordx4 v[36:39], v7, s[12:15], s49 offen offset:64
    s_lshl_b32 s31, s46, 5
    s_add_u32 s31, s31, s47
    s_mul_i32 s31, s31, 16512
    s_add_u32 s51, s31, 2097152
    s_lshl_b32 s32, s30, 12
    s_add_u32 s50, s51, s32
    s_add_u32 s51, s51, 16384
    v_add_u32 v250, s32, v3
    s_mov_b32 s63, 4096
    v_lshrrev_b32 v251, 5, v2
    v_lshlrev_b32 v251, 11, v251
    v_bfe_u32 v1, v2, 2, 3
    v_lshl_add_u32 v251, v1, 7, v251
    v_and_b32 v1, 3, v2
    v_lshl_add_u32 v251, v1, 5, v251
    v_bfe_u32 v1, v2, 3, 1
    v_lshl_add_u32 v251, v1, 4, v251
    v_bfe_u32 v1, v2, 4, 1
    v_lshl_add_u32 v251, v1, 3, v251
    v_xor_b32 v252, 16, v251
    v_xor_b32 v253, 8, v251
    v_xor_b32 v254, 24, v251
    v_cmp_gt_u32 vcc, 4, v2
    v_mov_b32 v1, 0
    v_mov_b32 v255, 16384
    v_cndmask_b32 v1, v1, v255, vcc
    v_add_u32 v208, v253, v1
    v_add_u32 v209, v254, v1
L_stat_wait:
    s_waitcnt vmcnt(0)
    v_cmp_ne_u64 s[52:53], s[28:29], v[26:27]
    v_cmp_ne_u64 s[54:55], s[28:29], v[30:31]
    v_cmp_ne_u64 s[56:57], s[28:29], v[34:35]
    v_cmp_ne_u64 s[58:59], s[28:29], v[38:39]
    s_or_b64 s[52:53], s[52:53], s[54:55]
    s_or_b64 s[56:57], s[56:57], s[58:59]
    s_or_b64 s[52:53], s[52:53], s[56:57]
    s_cbranch_scc0 L_stat_got
    s_cmp_eq_u32 s35, 0
    s_cbranch_scc1 L_stat_got
    s_sub_u32 s35, s35, 1
    s_sleep 2
    s_mov_b64 exec, s[52:53]
    buffer_load_dwordx4 v[24:27], v6, s[12:15], s49 offen offset:0 sc1
    buffer_load_dwordx4 v[28:31], v6, s[12:15], s49 offen offset:64 sc1
    buffer_load_dwordx4 v[32:35], v7, s[12:15], s49 offen offset:0 sc1
    buffer_load_dwordx4 v[36:39], v7, s[12:15], s49 offen offset:64 sc1
    s_mov_b64 exec, -1
    s_branch L_stat_wait
L_stat_got:
    v_mov_b32 v212, v210
    v_mov_b32 v213, v210
    v_mov_b32 v214, v210
    v_mov_b32 v215, v210
    s_cmp_lg_u32 s30, 3
    s_cbranch_scc1 L_no_gl
    buffer_load_dwordx4 v[192:195], v3, s[12:15], s63 offen offset:0 sc1
    buffer_load_dwordx4 v[196:199], v3, s[12:15], s63 offen offset:1024 sc1
    buffer_load_dwordx4 v[200:203], v3, s[12:15], s63 offen offset:2048 sc1
    buffer_load_dwordx4 v[204:207], v3, s[12:15], s63 offen offset:3072 sc1
L_no_gl:
    buffer_load_dwordx4 v[72:75], v3, s[12:15], s50 offen offset:0 sc1
    buffer_load_dwordx4 v[76:79], v3, s[12:15], s50 offen offset:1024 sc1
    buffer_load_dwordx4 v[80:83], v3, s[12:15], s50 offen offset:2048 sc1
    buffer_load_dwordx4 v[84:87], v3, s[12:15], s50 offen offset:3072 sc1
    s_mov_b64 exec, 0xff
    buffer_load_dwordx4 v[212:215], v3, s[12:15], s51 offen sc1
    s_mov_b64 exec, -1
    v_lshlrev_b32 v26, 16, v24
    v_and_b32 v24, 0xffff0000, v24
    v_rcp_f32 v24, v24
    v_lshlrev_b32 v30, 16, v28
    v_and_b32 v28, 0xffff0000, v28
    v_rcp_f32 v28, v28
    v_lshlrev_b32 v34, 16, v32
    v_and_b32 v32, 0xffff0000, v32
    v_rcp_f32 v32, v32
    v_lshlrev_b32 v38, 16, v36
    v_and_b32 v36, 0xffff0000, v36
    v_rcp_f32 v36, v36
    v_lshlrev_b32 v40, 16, v8
    v_and_b32 v41, 0xffff0000, v8
    v_lshlrev_b32 v42, 16, v9
    v_and_b32 v43, 0xffff0000, v9
    v_lshlrev_b32 v44, 16, v10
    v_and_b32 v45, 0xffff0000, v10
    v_lshlrev_b32 v46, 16, v11
    v_and_b32 v47, 0xffff0000, v11
    v_lshlrev_b32 v48, 16, v12
    v_and_b32 v49, 0xffff0000, v12
    v_lshlrev_b32 v50, 16, v13
    v_and_b32 v51, 0xffff0000, v13
    v_lshlrev_b32 v52, 16, v14
    v_and_b32 v53, 0xffff0000, v14
    v_lshlrev_b32 v54, 16, v15
    v_and_b32 v55, 0xffff0000, v15
    v_lshlrev_b32 v56, 16, v16
    v_and_b32 v57, 0xffff0000, v16
    v_lshlrev_b32 v58, 16, v17
    v_and_b32 v59, 0xffff0000, v17
    v_lshlrev_b32 v60, 16, v18
    v_and_b32 v61, 0xffff0000, v18
    v_lshlrev_b32 v62, 16, v19
    v_and_b32 v63, 0xffff0000, v19
    v_lshlrev_b32 v64, 16, v20
    v_and_b32 v65, 0xffff0000, v20
    v_lshlrev_b32 v66, 16, v21
    v_and_b32 v67, 0xffff0000, v21
    v_lshlrev_b32 v68, 16, v22
    v_and_b32 v69, 0xffff0000, v22
    v_lshlrev_b32 v70, 16, v23
    v_and_b32 v71, 0xffff0000, v23
    v_mul_f32_e64 v26, -v26, v24
    v_mul_f32 v152, 0xbfb8aa3b, v24
    v_mul_f32 v154, 0xbfb8aa3b, v26
    v_mul_f32_e64 v30, -v30, v28
    v_mul_f32 v156, 0xbfb8aa3b, v28
    v_mul_f32 v158, 0xbfb8aa3b, v30
    v_mul_f32_e64 v34, -v34, v32
    v_mul_f32 v160, 0xbfb8aa3b, v32
    v_mul_f32 v162, 0xbfb8aa3b, v34
    v_mul_f32_e64 v38, -v38, v36
    v_mul_f32 v164, 0xbfb8aa3b, v36
    v_mul_f32 v166, 0xbfb8aa3b, v38
    v_pk_fma_f32 v[216:217], v[40:41], v[152:153], v[154:155] op_sel_hi:[1,0,0]
    v_pk_fma_f32 v[218:219], v[42:43], v[152:153], v[154:155] op_sel_hi:[1,0,0]
    v_pk_fma_f32 v[220:221], v[44:45], v[152:153], v[154:155] op_sel_hi:[1,0,0]
    v_pk_fma_f32 v[222:223], v[46:47], v[152:153], v[154:155] op_sel_hi:[1,0,0]
    v_pk_fma_f32 v[224:225], v[48:49], v[156:157], v[158:159] op_sel_hi:[1,0,0]
    v_pk_fma_f32 v[226:227], v[50:51], v[156:157], v[158:159] op_sel_hi:[1,0,0]
    v_pk_fma_f32 v[228:229], v[52:53], v[156:157], v[158:159] op_sel_hi:[1,0,0]
    v_pk_fma_f32 v[230:231], v[54:55], v[156:157], v[158:159] op_sel_hi:[1,0,0]
    v_pk_fma_f32 v[232:233], v[56:57], v[160:161], v[162:163] op_sel_hi:[1,0,0]
    v_pk_fma_f32 v[234:235], v[58:59], v[160:161], v[162:163] op_sel_hi:[1,0,0]
    v_pk_fma_f32 v[236:237], v[60:61], v[160:161], v[162:163] op_sel_hi:[1,0,0]
    v_pk_fma_f32 v[238:239], v[62:63], v[160:161], v[162:163] op_sel_hi:[1,0,0]
    v_pk_fma_f32 v[240:241], v[64:65], v[164:165], v[166:167] op_sel_hi:[1,0,0]
    v_pk_fma_f32 v[242:243], v[66:67], v[164:165], v[166:167] op_sel_hi:[1,0,0]
    v_pk_fma_f32 v[244:245], v[68:69], v[164:165], v[166:167] op_sel_hi:[1,0,0]
    v_pk_fma_f32 v[246:247], v[70:71], v[164:165], v[166:167] op_sel_hi:[1,0,0]
    v_exp_f32 v216, v216
    v_exp_f32 v217, v217
    v_exp_f32 v218, v218
    v_exp_f32 v219, v219
    v_exp_f32 v220, v220
    v_exp_f32 v221, v221
    v_exp_f32 v222, v222
    v_exp_f32 v223, v223
    v_exp_f32 v224, v224
    v_exp_f32 v225, v225
    v_exp_f32 v226, v226
    v_exp_f32 v227, v227
    v_exp_f32 v228, v228
    v_exp_f32 v229, v229
    v_exp_f32 v230, v230
    v_exp_f32 v231, v231
    v_exp_f32 v232, v232
    v_exp_f32 v233, v233
    v_exp_f32 v234, v234
    v_exp_f32 v235, v235
    v_exp_f32 v236, v236
    v_exp_f32 v237, v237
    v_exp_f32 v238, v238
    v_exp_f32 v239, v239
    v_exp_f32 v240, v240
    v_exp_f32 v241, v241
    v_exp_f32 v242, v242
    v_exp_f32 v243, v243
    v_exp_f32 v244, v244
    v_exp_f32 v245, v245
    v_exp_f32 v246, v246
    v_exp_f32 v247, v247
    v_pk_fma_f32 v[120:121], v[40:41], v[24:25], v[26:27] op_sel_hi:[1,0,0]
    v_pk_fma_f32 v[122:123], v[42:43], v[24:25], v[26:27] op_sel_hi:[1,0,0]
    v_pk_fma_f32 v[124:125], v[44:45], v[24:25], v[26:27] op_sel_hi:[1,0,0]
    v_pk_fma_f32 v[126:127], v[46:47], v[24:25], v[26:27] op_sel_hi:[1,0,0]
    v_pk_fma_f32 v[128:129], v[48:49], v[28:29], v[30:31] op_sel_hi:[1,0,0]
    v_pk_fma_f32 v[130:131], v[50:51], v[28:29], v[30:31] op_sel_hi:[1,0,0]
    v_pk_fma_f32 v[132:133], v[52:53], v[28:29], v[30:31] op_sel_hi:[1,0,0]
    v_pk_fma_f32 v[134:135], v[54:55], v[28:29], v[30:31] op_sel_hi:[1,0,0]
    v_pk_fma_f32 v[136:137], v[56:57], v[32:33], v[34:35] op_sel_hi:[1,0,0]
    v_pk_fma_f32 v[138:139], v[58:59], v[32:33], v[34:35] op_sel_hi:[1,0,0]
    v_pk_fma_f32 v[140:141], v[60:61], v[32:33], v[34:35] op_sel_hi:[1,0,0]
    v_pk_fma_f32 v[142:143], v[62:63], v[32:33], v[34:35] op_sel_hi:[1,0,0]
    v_pk_fma_f32 v[144:145], v[64:65], v[36:37], v[38:39] op_sel_hi:[1,0,0]
    v_pk_fma_f32 v[146:147], v[66:67], v[36:37], v[38:39] op_sel_hi:[1,0,0]
    v_pk_fma_f32 v[148:149], v[68:69], v[36:37], v[38:39] op_sel_hi:[1,0,0]
    v_pk_fma_f32 v[150:151], v[70:71], v[36:37], v[38:39] op_sel_hi:[1,0,0]
    v_pk_add_f32 v[216:217], v[216:217], 1.0 op_sel_hi:[1,0]
    v_pk_add_f32 v[218:219], v[218:219], 1.0 op_sel_hi:[1,0]
    v_pk_add_f32 v[220:221], v[220:221], 1.0 op_sel_hi:[1,0]
    v_pk_add_f32 v[222:223], v[222:223], 1.0 op_sel_hi:[1,0]
    v_pk_add_f32 v[224:225], v[224:225], 1.0 op_sel_hi:[1,0]
    v_pk_add_f32 v[226:227], v[226:227], 1.0 op_sel_hi:[1,0]
    v_pk_add_f32 v[228:229], v[228:229], 1.0 op_sel_hi:[1,0]
    v_pk_add_f32 v[230:231], v[230:231], 1.0 op_sel_hi:[1,0]
    v_pk_add_f32 v[232:233], v[232:233], 1.0 op_sel_hi:[1,0]
    v_pk_add_f32 v[234:235], v[234:235], 1.0 op_sel_hi:[1,0]
    v_pk_add_f32 v[236:237], v[236:237], 1.0 op_sel_hi:[1,0]
    v_pk_add_f32 v[238:239], v[238:239], 1.0 op_sel_hi:[1,0]
    v_pk_add_f32 v[240:241], v[240:241], 1.0 op_sel_hi:[1,0]
    v_pk_add_f32 v[242:243], v[242:243], 1.0 op_sel_hi:[1,0]
    v_pk_add_f32 v[244:245], v[244:245], 1.0 op_sel_hi:[1,0]
    v_pk_add_f32 v[246:247], v[246:247], 1.0 op_sel_hi:[1,0]
    v_rcp_f32 v216, v216
    v_rcp_f32 v217, v217
    v_rcp_f32 v218, v218
    v_rcp_f32 v219, v219
    v_rcp_f32 v220, v220
    v_rcp_f32 v221, v221
    v_rcp_f32 v222, v222
    v_rcp_f32 v223, v223
    v_rcp_f32 v224, v224
    v_rcp_f32 v225, v225
    v_rcp_f32 v226, v226
    v_rcp_f32 v227, v227
    v_rcp_f32 v228, v228
    v_rcp_f32 v229, v229
    v_rcp_f32 v230, v230
    v_rcp_f32 v231, v231
    v_rcp_f32 v232, v232
    v_rcp_f32 v233, v233
    v_rcp_f32 v234, v234
    v_rcp_f32 v235, v235
    v_rcp_f32 v236, v236
    v_rcp_f32 v237, v237
    v_rcp_f32 v238, v238
    v_rcp_f32 v239, v239
    v_rcp_f32 v240, v240
    v_rcp_f32 v241, v241
    v_rcp_f32 v242, v242
    v_rcp_f32 v243, v243
    v_rcp_f32 v244, v244
    v_rcp_f32 v245, v245
    v_rcp_f32 v246, v246
    v_rcp_f32 v247, v247
    v_pk_mul_f32 v[120:121], v[120:121], v[216:217]
    v_pk_mul_f32 v[122:123], v[122:123], v[218:219]
    v_pk_mul_f32 v[124:125], v[124:125], v[220:221]
    v_pk_mul_f32 v[126:127], v[126:127], v[222:223]
    v_pk_mul_f32 v[128:129], v[128:129], v[224:225]
    v_pk_mul_f32 v[130:131], v[130:131], v[226:227]
    v_pk_mul_f32 v[132:133], v[132:133], v[228:229]
    v_pk_mul_f32 v[134:135], v[134:135], v[230:231]
    v_pk_mul_f32 v[136:137], v[136:137], v[232:233]
    v_pk_mul_f32 v[138:139], v[138:139], v[234:235]
    v_pk_mul_f32 v[140:141], v[140:141], v[236:237]
    v_pk_mul_f32 v[142:143], v[142:143], v[238:239]
    v_pk_mul_f32 v[144:145], v[144:145], v[240:241]
    v_pk_mul_f32 v[146:147], v[146:147], v[242:243]
    v_pk_mul_f32 v[148:149], v[148:149], v[244:245]
    v_pk_mul_f32 v[150:151], v[150:151], v[246:247]
    s_cmp_lg_u32 s30, 3
    s_cbranch_scc1 L_z_wait
    s_waitcnt vmcnt(5)
L_di_check:
    v_cmp_ne_u64 s[52:53], s[28:29], v[194:195]
    v_cmp_ne_u64 s[54:55], s[28:29], v[198:199]
    v_cmp_ne_u64 s[56:57], s[28:29], v[202:203]
    v_cmp_ne_u64 s[58:59], s[28:29], v[206:207]
    v_max_u32 v6, v193, v197
    v_max3_u32 v6, v6, v201, v205
    s_or_b64 s[64:65], s[52:53], s[54:55]
    s_or_b64 vcc, s[56:57], s[58:59]
    s_or_b64 s[64:65], s[64:65], vcc
    s_cbranch_scc0 L_di_got
    s_cmp_eq_u32 s35, 0
    s_cbranch_scc1 L_di_got
    s_sub_u32 s35, s35, 1
    s_sleep 2
    s_mov_b64 exec, s[52:53]
    s_cbranch_execz L_di_skip0
    buffer_load_dwordx4 v[192:195], v3, s[12:15], s63 offen offset:0 sc1
L_di_skip0:
    s_mov_b64 exec, s[54:55]
    s_cbranch_execz L_di_skip1
    buffer_load_dwordx4 v[196:199], v3, s[12:15], s63 offen offset:1024 sc1
L_di_skip1:
    s_mov_b64 exec, s[56:57]
    s_cbranch_execz L_di_skip2
    buffer_load_dwordx4 v[200:203], v3, s[12:15], s63 offen offset:2048 sc1
L_di_skip2:
    s_mov_b64 exec, s[58:59]
    s_cbranch_execz L_di_skip3
    buffer_load_dwordx4 v[204:207], v3, s[12:15], s63 offen offset:3072 sc1
L_di_skip3:
    s_mov_b64 exec, -1
    s_waitcnt vmcnt(0)
    s_branch L_di_check
L_di_got:
    v_max_u32_dpp v7, v6, v6 row_ror:1 row_mask:0xf bank_mask:0xf
    s_nop 1
    v_max_u32_dpp v7, v7, v7 row_ror:2 row_mask:0xf bank_mask:0xf
    s_nop 1
    v_max_u32_dpp v7, v7, v7 row_ror:4 row_mask:0xf bank_mask:0xf
    s_nop 1
    v_max_u32_dpp v7, v7, v7 row_ror:8 row_mask:0xf bank_mask:0xf
    s_nop 0
    v_readlane_b32 s33, v7, 0
    v_readlane_b32 s31, v7, 16
    v_readlane_b32 s32, v7, 32
    v_readlane_b32 s34, v7, 48
    s_max_u32 s33, s33, s31
    s_max_u32 s32, s32, s34
    s_max_u32 s33, s33, s32
    v_cmp_eq_u32 s[52:53], s33, v197
    v_cmp_eq_u32 s[54:55], s33, v201
    v_cmp_eq_u32 s[56:57], s33, v205
    v_cmp_eq_u32 vcc, s33, v6
    v_cndmask_b32 v7, v192, v196, s[52:53]
    v_cndmask_b32 v7, v7, v200, s[54:55]
    v_cndmask_b32 v7, v7, v204, s[56:57]
    s_ff1_i32_b64 s32, vcc
    v_readlane_b32 s34, v7, s32
    s_nop 1
    v_mov_b32 v6, s34
    v_mov_b32 v7, s33
    v_mov_b32 v1, 41552
    ds_write_b64 v1, v[6:7]
L_z_wait:
    s_setprio 1
    s_waitcnt vmcnt(4)
    v_xor_b32 v152, v210, v72
    v_xor_b32 v153, v210, v73
    v_xor_b32 v154, v210, v74
    v_xor_b32 v155, v210, v75
    ds_write_b128 v250, v[152:155] offset:0
    v_or3_b32 v1, v152, v153, v154
    v_or_b32 v1, v1, v155
    s_waitcnt vmcnt(3)
    v_xor_b32 v156, v210, v76
    v_xor_b32 v157, v210, v77
    v_xor_b32 v158, v210, v78
    v_xor_b32 v159, v210, v79
    ds_write_b128 v250, v[156:159] offset:1024
    v_or3_b32 v1, v1, v156, v157
    v_or3_b32 v1, v1, v158, v159
    s_waitcnt vmcnt(2)
    v_xor_b32 v160, v210, v80
    v_xor_b32 v161, v210, v81
    v_xor_b32 v162, v210, v82
    v_xor_b32 v163, v210, v83
    ds_write_b128 v250, v[160:163] offset:2048
    v_or3_b32 v1, v1, v160, v161
    v_or3_b32 v1, v1, v162, v163
    s_waitcnt vmcnt(1)
    v_xor_b32 v164, v210, v84
    v_xor_b32 v165, v210, v85
    v_xor_b32 v166, v210, v86
    v_xor_b32 v167, v210, v87
    ds_write_b128 v250, v[164:167] offset:3072
    v_or3_b32 v1, v1, v164, v165
    v_or3_b32 v1, v1, v166, v167
    s_waitcnt vmcnt(0)
    v_xor_b32 v168, v210, v212
    v_xor_b32 v169, v210, v213
    v_xor_b32 v170, v210, v214
    v_xor_b32 v171, v210, v215
    s_mov_b64 exec, 0xff
    ds_write_b128 v3, v[168:171] offset:16384
    s_mov_b64 exec, -1
    v_or3_b32 v1, v1, v168, v169
    v_or3_b32 v1, v1, v170, v171
    v_and_b32 v1, 0x30003, v1
    v_cmp_ne_u32 vcc, 0, v1
    s_nop 0
    s_cbranch_vccz L_z_got
    s_cmp_eq_u32 s35, 0
    s_cbranch_scc1 L_z_got
    s_sub_u32 s35, s35, 1
    s_sleep 2
    s_mov_b64 exec, vcc
    buffer_load_dwordx4 v[72:75], v3, s[12:15], s50 offen offset:0 sc1
    buffer_load_dwordx4 v[76:79], v3, s[12:15], s50 offen offset:1024 sc1
    buffer_load_dwordx4 v[80:83], v3, s[12:15], s50 offen offset:2048 sc1
    buffer_load_dwordx4 v[84:87], v3, s[12:15], s50 offen offset:3072 sc1
    s_mov_b64 exec, 0xff
    buffer_load_dwordx4 v[212:215], v3, s[12:15], s51 offen sc1
    s_mov_b64 exec, -1
    s_waitcnt lgkmcnt(0)
    s_branch L_z_wait
L_z_got:
    v_mov_b32 v1, 41552
    s_waitcnt lgkmcnt(0)
    s_barrier
    ds_read_b64 v[6:7], v1
    ds_read_b64_tr_b16 v[152:153], v251 offset:0
    ds_read_b64_tr_b16 v[154:155], v251 offset:1024
    ds_read_b64_tr_b16 v[156:157], v252 offset:0
    ds_read_b64_tr_b16 v[158:159], v252 offset:1024
    ds_read_b64_tr_b16 v[160:161], v251 offset:4096
    ds_read_b64_tr_b16 v[162:163], v251 offset:5120
    ds_read_b64_tr_b16 v[164:165], v252 offset:4096
    ds_read_b64_tr_b16 v[166:167], v252 offset:5120
    ds_read_b64_tr_b16 v[168:169], v251 offset:8192
    ds_read_b64_tr_b16 v[170:171], v251 offset:9216
    ds_read_b64_tr_b16 v[172:173], v252 offset:8192
    ds_read_b64_tr_b16 v[174:175], v252 offset:9216
    s_waitcnt lgkmcnt(10)
    v_mfma_f32_16x16x32_f16 v[216:219], v[152:155], v[88:91], 0
    s_waitcnt lgkmcnt(8)
    v_mfma_f32_16x16x32_f16 v[220:223], v[156:159], v[88:91], 0
    ds_read_b64_tr_b16 v[176:177], v251 offset:12288
    ds_read_b64_tr_b16 v[178:179], v251 offset:13312
    ds_read_b64_tr_b16 v[180:181], v252 offset:12288
    ds_read_b64_tr_b16 v[182:183], v252 offset:13312
    s_waitcnt lgkmcnt(10)
    v_mfma_f32_16x16x32_f16 v[216:219], v[160:163], v[92:95], v[216:219]
    s_waitcnt lgkmcnt(8)
    v_mfma_f32_16x16x32_f16 v[220:223], v[164:167], v[92:95], v[220:223]
    ds_read_b64_tr_b16 v[152:153], v208 offset:0
    ds_read_b64_tr_b16 v[154:155], v253 offset:1024
    ds_read_b64_tr_b16 v[156:157], v209 offset:0
    ds_read_b64_tr_b16 v[158:159], v254 offset:1024
    v_readfirstlane_b32 s33, v7
    v_readfirstlane_b32 s34, v6
    s_waitcnt lgkmcnt(10)
    v_mfma_f32_16x16x32_f16 v[224:227], v[168:171], v[96:99], 0
    s_waitcnt lgkmcnt(8)
    v_mfma_f32_16x16x32_f16 v[228:231], v[172:175], v[96:99], 0
    ds_read_b64_tr_b16 v[160:161], v253 offset:4096
    ds_read_b64_tr_b16 v[162:163], v253 offset:5120
    ds_read_b64_tr_b16 v[164:165], v254 offset:4096
    ds_read_b64_tr_b16 v[166:167], v254 offset:5120
    s_andn2_b32 s51, 0x7ff, s33
    s_sub_u32 s31, s51, 1024
    s_waitcnt lgkmcnt(10)
    v_mfma_f32_16x16x32_f16 v[224:227], v[176:179], v[100:103], v[224:227]
    s_waitcnt lgkmcnt(8)
    v_mfma_f32_16x16x32_f16 v[228:231], v[180:183], v[100:103], v[228:231]
    ds_read_b64_tr_b16 v[168:169], v253 offset:8192
    ds_read_b64_tr_b16 v[170:171], v253 offset:9216
    ds_read_b64_tr_b16 v[172:173], v254 offset:8192
    ds_read_b64_tr_b16 v[174:175], v254 offset:9216
    v_cmp_ne_u32 s[54:55], s51, v248
    v_cmp_ne_u32 s[56:57], s31, v248
    s_waitcnt lgkmcnt(10)
    v_mfma_f32_16x16x32_f16 v[232:235], v[152:155], v[104:107], 0
    s_waitcnt lgkmcnt(8)
    v_mfma_f32_16x16x32_f16 v[236:239], v[156:159], v[104:107], 0
    ds_read_b64_tr_b16 v[176:177], v253 offset:12288
    ds_read_b64_tr_b16 v[178:179], v253 offset:13312
    ds_read_b64_tr_b16 v[180:181], v254 offset:12288
    ds_read_b64_tr_b16 v[182:183], v254 offset:13312
    v_cmp_ne_u32 s[58:59], s51, v249
    v_cmp_ne_u32 s[60:61], s31, v249
    s_waitcnt lgkmcnt(10)
    v_mfma_f32_16x16x32_f16 v[232:235], v[160:163], v[108:111], v[232:235]
    s_waitcnt lgkmcnt(8)
    v_mfma_f32_16x16x32_f16 v[236:239], v[164:167], v[108:111], v[236:239]
    v_pk_add_f32 v[72:73], v[216:217], v[224:225]
    v_pk_add_f32 v[80:81], v[216:217], v[224:225] neg_lo:[0,1] neg_hi:[0,1]
    v_pk_add_f32 v[74:75], v[218:219], v[226:227]
    v_pk_add_f32 v[82:83], v[218:219], v[226:227] neg_lo:[0,1] neg_hi:[0,1]
    s_waitcnt lgkmcnt(6)
    v_mfma_f32_16x16x32_f16 v[240:243], v[168:171], v[112:115], 0
    s_waitcnt lgkmcnt(4)
    v_mfma_f32_16x16x32_f16 v[244:247], v[172:175], v[112:115], 0
    v_pk_add_f32 v[76:77], v[220:221], v[228:229]
    v_pk_add_f32 v[84:85], v[220:221], v[228:229] neg_lo:[0,1] neg_hi:[0,1]
    v_pk_add_f32 v[78:79], v[222:223], v[230:231]
    v_pk_add_f32 v[86:87], v[222:223], v[230:231] neg_lo:[0,1] neg_hi:[0,1]
    s_waitcnt lgkmcnt(2)
    v_mfma_f32_16x16x32_f16 v[240:243], v[176:179], v[116:119], v[240:243]
    s_waitcnt lgkmcnt(0)
    v_mfma_f32_16x16x32_f16 v[244:247], v[180:183], v[116:119], v[244:247]
    s_and_b32 s31, s51, 7
    s_cmp_eq_u32 s31, s46
    s_cselect_b32 s52, 1, 0
    s_cbranch_scc0 L_not_owner1
    s_and_b32 s53, s28, 0xff
    v_lshrrev_b32 v250, 3, v2
    s_lshl_b32 s31, s30, 4
    v_add_u32 v250, s31, v250
    v_lshlrev_b32 v250, 12, v250
    v_and_b32 v1, 7, v2
    v_lshlrev_b32 v1, 4, v1
    s_lshl_b32 s31, s47, 7
    s_add_u32 s31, s31, 524288
    v_add3_u32 v250, v250, v1, s31
    s_mov_b32 s62, 32768
    v_mov_b32 v196, s53
    v_mov_b32 v197, s53
    v_mov_b32 v198, s53
    v_mov_b32 v199, s53
    s_lshl_b32 s31, s51, 11
    s_lshl_b32 s32, s47, 6
    s_add_u32 s63, s31, s32
    v_and_b32 v251, 31, v2
    v_lshlrev_b32 v251, 1, v251
    buffer_load_ushort v252, v251, s[8:11], s63 offen
    buffer_load_dwordx4 v[192:195], v250, s[12:15], 0 offen sc1
    s_cmp_eq_u32 s30, 3
    s_cbranch_scc1 L_not_owner1
    buffer_load_dwordx4 v[196:199], v250, s[12:15], s62 offen sc1
L_not_owner1:
    s_nop 1
    v_pk_add_f32 v[216:217], v[232:233], v[240:241]
    v_pk_add_f32 v[224:225], v[232:233], v[240:241] neg_lo:[0,1] neg_hi:[0,1]
    v_pk_add_f32 v[218:219], v[234:235], v[242:243]
    v_pk_add_f32 v[226:227], v[234:235], v[242:243] neg_lo:[0,1] neg_hi:[0,1]
    v_pk_add_f32 v[220:221], v[236:237], v[244:245]
    v_pk_add_f32 v[228:229], v[236:237], v[244:245] neg_lo:[0,1] neg_hi:[0,1]
    v_pk_add_f32 v[222:223], v[238:239], v[246:247]
    v_pk_add_f32 v[230:231], v[238:239], v[246:247] neg_lo:[0,1] neg_hi:[0,1]
    v_pk_add_f32 v[152:153], v[72:73], v[216:217]
    v_pk_add_f32 v[154:155], v[74:75], v[218:219]
    v_pk_add_f32 v[156:157], v[76:77], v[220:221]
    v_pk_add_f32 v[158:159], v[78:79], v[222:223]
    v_pk_fma_f32 v[40:41], v[152:153], v[120:121], v[40:41]
    v_pk_fma_f32 v[42:43], v[154:155], v[122:123], v[42:43]
    v_pk_fma_f32 v[44:45], v[156:157], v[124:125], v[44:45]
    v_pk_fma_f32 v[46:47], v[158:159], v[126:127], v[46:47]
    v_cvt_pk_bf16_f32 v8, v40, v41
    v_cvt_pk_bf16_f32 v9, v42, v43
    v_cvt_pk_bf16_f32 v10, v44, v45
    v_cvt_pk_bf16_f32 v11, v46, v47
    s_mov_b64 exec, s[54:55]
    buffer_store_dwordx4 v[8:11], v4, s[16:19], 0 offen sc1
    s_mov_b64 exec, -1
    v_pk_add_f32 v[160:161], v[80:81], v[224:225]
    v_pk_add_f32 v[162:163], v[82:83], v[226:227]
    v_pk_add_f32 v[164:165], v[84:85], v[228:229]
    v_pk_add_f32 v[166:167], v[86:87], v[230:231]
    v_pk_fma_f32 v[48:49], v[160:161], v[128:129], v[48:49]
    v_pk_fma_f32 v[50:51], v[162:163], v[130:131], v[50:51]
    v_pk_fma_f32 v[52:53], v[164:165], v[132:133], v[52:53]
    v_pk_fma_f32 v[54:55], v[166:167], v[134:135], v[54:55]
    v_cvt_pk_bf16_f32 v12, v48, v49
    v_cvt_pk_bf16_f32 v13, v50, v51
    v_cvt_pk_bf16_f32 v14, v52, v53
    v_cvt_pk_bf16_f32 v15, v54, v55
    s_mov_b64 exec, s[56:57]
    buffer_store_dwordx4 v[12:15], v4, s[16:19], s48 offen sc1
    s_mov_b64 exec, -1
    v_pk_add_f32 v[168:169], v[80:81], v[224:225] neg_lo:[0,1] neg_hi:[0,1]
    v_pk_add_f32 v[170:171], v[82:83], v[226:227] neg_lo:[0,1] neg_hi:[0,1]
    v_pk_add_f32 v[172:173], v[84:85], v[228:229] neg_lo:[0,1] neg_hi:[0,1]
    v_pk_add_f32 v[174:175], v[86:87], v[230:231] neg_lo:[0,1] neg_hi:[0,1]
    v_pk_fma_f32 v[56:57], v[168:169], v[136:137], v[56:57]
    v_pk_fma_f32 v[58:59], v[170:171], v[138:139], v[58:59]
    v_pk_fma_f32 v[60:61], v[172:173], v[140:141], v[60:61]
    v_pk_fma_f32 v[62:63], v[174:175], v[142:143], v[62:63]
    v_cvt_pk_bf16_f32 v16, v56, v57
    v_cvt_pk_bf16_f32 v17, v58, v59
    v_cvt_pk_bf16_f32 v18, v60, v61
    v_cvt_pk_bf16_f32 v19, v62, v63
    s_mov_b64 exec, s[58:59]
    buffer_store_dwordx4 v[16:19], v5, s[16:19], 0 offen sc1
    s_mov_b64 exec, -1
    v_pk_add_f32 v[176:177], v[72:73], v[216:217] neg_lo:[0,1] neg_hi:[0,1]
    v_pk_add_f32 v[178:179], v[74:75], v[218:219] neg_lo:[0,1] neg_hi:[0,1]
    v_pk_add_f32 v[180:181], v[76:77], v[220:221] neg_lo:[0,1] neg_hi:[0,1]
    v_pk_add_f32 v[182:183], v[78:79], v[222:223] neg_lo:[0,1] neg_hi:[0,1]
    v_pk_fma_f32 v[64:65], v[176:177], v[144:145], v[64:65]
    v_pk_fma_f32 v[66:67], v[178:179], v[146:147], v[66:67]
    v_pk_fma_f32 v[68:69], v[180:181], v[148:149], v[68:69]
    v_pk_fma_f32 v[70:71], v[182:183], v[150:151], v[70:71]
    v_cvt_pk_bf16_f32 v20, v64, v65
    v_cvt_pk_bf16_f32 v21, v66, v67
    v_cvt_pk_bf16_f32 v22, v68, v69
    v_cvt_pk_bf16_f32 v23, v70, v71
    s_mov_b64 exec, s[60:61]
    buffer_store_dwordx4 v[20:23], v5, s[16:19], s48 offen sc1
    s_mov_b64 exec, -1
    s_cmp_eq_u32 s52, 0
    s_cbranch_scc1 L_fin
    v_and_b32 v6, 48, v2
    v_lshlrev_b32 v6, 1, v6
    s_not_b64 exec, s[54:55]
    ds_write_b128 v6, v[152:155] offset:42496
    ds_write_b128 v6, v[156:159] offset:42512
    s_not_b64 exec, s[56:57]
    ds_write_b128 v6, v[160:163] offset:42496
    ds_write_b128 v6, v[164:167] offset:42512
    s_not_b64 exec, s[58:59]
    ds_write_b128 v6, v[168:171] offset:42496
    ds_write_b128 v6, v[172:175] offset:42512
    s_not_b64 exec, s[60:61]
    ds_write_b128 v6, v[176:179] offset:42496
    ds_write_b128 v6, v[180:183] offset:42512
    s_mov_b64 exec, -1
    v_and_b32 v6, 7, v2
    v_lshlrev_b32 v6, 4, v6
    v_lshrrev_b32 v7, 4, v2
    v_lshl_add_u32 v6, v7, 2, v6
    s_lshl_b32 s31, s30, 7
    v_add_u32 v6, s31, v6
    s_ashr_i32 s31, s33, 31
    s_orn2_b32 s31, 0x80000000, s31
    s_xor_b32 s31, s31, s33
    s_and_b32 s31, s31, 0xfffff800
    v_cvt_pk_bf16_f32 v254, s31, s31
    v_lshlrev_b32 v254, 16, v254
    v_mul_f32 v254, 0xbfb8aa3b, v254
    v_exp_f32 v254, v254
    s_and_b32 s32, s34, 0xffff0000
    v_add_f32 v254, 1.0, v254
    v_rcp_f32 v254, v254
    v_rcp_f32 v1, s32
    v_cvt_pk_bf16_f32 v254, v254, v254
    v_lshlrev_b32 v254, 16, v254
    s_lshl_b32 s31, s34, 16
    s_waitcnt vmcnt(4)
    v_lshlrev_b32 v252, 16, v252
    v_subrev_f32 v253, s31, v252
    v_cvt_pk_bf16_f32 v253, v253, v253
    v_lshlrev_b32 v253, 16, v253
    v_mul_f32 v253, v253, v1
    v_cvt_pk_bf16_f32 v253, v253, v253
    v_lshlrev_b32 v253, 16, v253
    v_lshlrev_b32 v7, 1, v251
L_y_check:
    v_xor_b32 v200, s53, v192
    v_xor_b32 v201, s53, v193
    v_xor_b32 v202, s53, v194
    v_xor_b32 v203, s53, v195
    v_xor_b32 v204, s53, v196
    v_xor_b32 v205, s53, v197
    v_xor_b32 v206, s53, v198
    v_xor_b32 v207, s53, v199
    v_or3_b32 v1, v200, v201, v202
    v_or3_b32 v1, v1, v203, v204
    v_or3_b32 v1, v1, v205, v206
    v_or_b32 v1, v1, v207
    v_and_b32 v1, 0xff, v1
    v_cmp_ne_u32 vcc, 0, v1
    v_pk_add_f32 v[200:201], v[200:201], v[204:205]
    v_pk_add_f32 v[202:203], v[202:203], v[206:207]
    s_cbranch_vccz L_y_got
    s_cmp_eq_u32 s35, 0
    s_cbranch_scc1 L_y_got
    s_sub_u32 s35, s35, 1
    s_sleep 2
    s_mov_b64 exec, vcc
    buffer_load_dwordx4 v[192:195], v250, s[12:15], 0 offen sc1
    s_cmp_eq_u32 s30, 3
    s_cbranch_scc1 L_y_retry
    buffer_load_dwordx4 v[196:199], v250, s[12:15], s62 offen sc1
L_y_retry:
    s_mov_b64 exec, -1
    s_waitcnt vmcnt(0)
    s_branch L_y_check
L_y_got:
    v_permlane16_swap_b32 v200, v201
    v_permlane16_swap_b32 v202, v203
    v_add_f32 v200, v200, v201
    v_add_f32 v202, v202, v203
    s_nop 1
    v_permlane32_swap_b32 v200, v202
    v_add_f32 v200, v200, v202
    s_nop 1
    v_add_f32_dpp v200, v200, v200 row_ror:8 row_mask:0xf bank_mask:0xf
    ds_write_b32 v6, v200 offset:41600
    s_waitcnt lgkmcnt(0)
    s_barrier
    s_cmp_lg_u32 s30, 0
    s_cbranch_scc1 L_fin
    ds_read_b32 v192, v7 offset:41600
    ds_read_b32 v193, v7 offset:41728
    ds_read_b32 v194, v7 offset:41856
    ds_read_b32 v195, v7 offset:41984
    ds_read_b32 v196, v7 offset:42496
    s_cmp_eq_u32 s47, 0
    s_cselect_b32 s31, 0, 2147483392
    v_mov_b32 v5, 2147483392
    v_writelane_b32 v5, s31, 0
    v_mov_b32 v6, s28
    v_mov_b32 v7, s29
    s_waitcnt lgkmcnt(0)
    v_add_f32 v192, v192, v193
    v_add_f32 v194, v194, v195
    v_add_f32 v192, v192, v194
    v_cvt_pk_bf16_f32 v192, v192, v192
    v_lshlrev_b32 v192, 16, v192
    v_mul_f32 v192, v192, v254
    v_cvt_pk_bf16_f32 v192, v192, v192
    v_lshlrev_b32 v192, 16, v192
    v_add_f32 v192, v192, v253
    v_cvt_pk_bf16_f32 v192, v192, v192
    v_lshlrev_b32 v192, 16, v192
    v_mul_f32 v1, 0xbfb8aa3b, v192
    v_exp_f32 v1, v1
    v_mul_f32 v192, v192, v196
    v_add_f32 v1, 1.0, v1
    v_rcp_f32 v1, v1
    s_mov_b32 exec_hi, 0
    v_fma_f32 v192, v192, v1, v252
    v_cvt_pk_bf16_f32 v192, v192, v192
    buffer_store_short v192, v251, s[16:19], s63 offen sc1
    buffer_store_dwordx2 v[6:7], v5, s[12:15], 0 offen sc1
    s_mov_b64 exec, -1
    s_branch L_fin
L_moe:
    s_sub_u32 s31, s2, 256
    s_and_b32 s32, s31, 7
    s_mul_i32 s32, s32, 28
    s_lshr_b32 s31, s31, 3
    s_add_u32 s31, s31, s32
    s_lshr_b32 s46, s31, 3
    s_and_b32 s47, s31, 7
    s_mov_b32 s18, 7340032
    s_mov_b32 s19, 0x00020000
    s_mov_b32 s22, 7340032
    s_mov_b32 s23, 0x00020000
    s_mov_b32 s26, 7340032
    s_mov_b32 s27, 0x00020000
    v_lshrrev_b32 v4, 4, v2
    v_lshlrev_b32 v5, 5, v4
    v_and_b32 v6, 0xf0, v3
    v_xor_b32 v5, v5, v6
    v_mul_u32_u24 v4, 7168, v4
    s_mul_i32 s31, s47, 917504
    s_lshl_b32 s32, s46, 8
    s_add_u32 s31, s31, s32
    v_add3_u32 v4, v4, v5, s31
    s_mul_i32 s48, s30, 9
    s_add_u32 s49, s48, 9
    s_cmp_eq_u32 s30, 3
    s_cselect_b32 s49, 32, s49
    s_waitcnt lgkmcnt(0)
    s_mov_b32 s8, s4
    s_mov_b32 s9, s5
    s_mov_b32 s12, s6
    s_mov_b32 s13, s7
    s_mov_b32 s16, s38
    s_mov_b32 s17, s39
    s_mov_b32 s20, s40
    s_mov_b32 s21, s41
    s_mov_b32 s24, s42
    s_mov_b32 s25, s43
    s_load_dwordx2 s[28:29], s[6:7], 0
L_dma:
    s_bfe_u32 s31, s48, 0x10001
    s_lshl_b32 s31, s31, 7
    v_xor_b32 v5, s31, v4
    s_lshl_b32 s32, s48, 10
    s_add_u32 m0, s32, 512
    s_mul_i32 s31, s48, 28672
    buffer_load_dwordx4 v5, s[16:19], s31 offen  lds
    s_add_u32 m0, s32, 33280
    s_add_u32 s48, s48, 1
    buffer_load_dwordx4 v5, s[20:23], s31 offen  lds
    s_cmp_eq_u32 s30, 3
    s_cbranch_scc1 L_dma3
    s_waitcnt vmcnt(6)
    s_cmp_lt_u32 s48, s49
    s_cbranch_scc1 L_dma
    s_branch L_dma_done
L_dma3:
    s_waitcnt vmcnt(4)
    s_cmp_lt_u32 s48, s49
    s_cbranch_scc1 L_dma
L_dma_done:
    s_setprio 3
    s_lshr_b32 s31, s47, 2
    s_lshl_b32 s32, s46, 1
    s_add_u32 s50, s31, s32
    s_lshl_b32 s31, s50, 17
    s_and_b32 s32, s47, 3
    s_lshl_b32 s32, s32, 2
    s_add_u32 s51, s32, s30
    s_lshl_b32 s32, s51, 7
    s_add_u32 s31, s31, s32
    v_lshrrev_b32 v6, 3, v2
    v_lshlrev_b32 v6, 14, v6
    v_and_b32 v7, 0x70, v3
    v_add3_u32 v6, v6, v7, s31
    s_mov_b32 s60, 4096
    s_mov_b32 s61, 8192
    s_mov_b32 s62, 12288
    v_bfe_u32 v8, v2, 2, 3
    v_lshlrev_b32 v9, 5, v8
    s_lshl_b32 s31, s30, 6
    v_xor_b32 v9, s31, v9
    v_bfe_u32 v8, v2, 2, 2
    v_lshl_add_u32 v9, v8, 8, v9
    v_lshrrev_b32 v8, 4, v2
    v_lshl_add_u32 v9, v8, 11, v9
    v_and_b32 v10, 3, v2
    v_lshl_add_u32 v9, v10, 3, v9
    v_xor_b32 v10, 32, v9
    v_add_u32 v11, 33280, v9
    v_add_u32 v12, 33280, v10
    v_lshlrev_b32 v8, 4, v8
    s_lshr_b32 s31, s30, 1
    s_lshl_b32 s32, s46, 1
    s_add_u32 s31, s31, s32
    s_lshl_b32 s31, s31, 12
    s_lshl_b32 s32, s47, 9
    s_add_u32 s31, s31, s32
    s_and_b32 s32, s30, 1
    s_lshl_b32 s32, s32, 8
    s_add_u32 s31, s31, s32
    s_add_u32 s31, s31, 262144
    v_lshl_add_u32 v13, v2, 3, s31
    s_waitcnt lgkmcnt(0)
    s_add_u32 s28, s28, 0x7f4a7c15
    s_addc_u32 s29, s29, 0x9e3779b9
    s_and_b32 s31, s28, 0xff
    v_mov_b32 v14, s31
    s_mov_b32 s49, 0xffffff00
    s_cmp_eq_u32 s30, 3
    s_cbranch_scc1 L_h1
    buffer_load_dwordx4 v[100:103], v6, s[24:27], 0 offen offset:0
    buffer_load_dwordx4 v[104:107], v6, s[24:27], 0 offen offset:2048
    buffer_load_dwordx4 v[108:111], v6, s[24:27], s60 offen offset:0
    buffer_load_dwordx4 v[112:115], v6, s[24:27], s60 offen offset:2048
    buffer_load_dwordx4 v[116:119], v6, s[24:27], s61 offen offset:0
    buffer_load_dwordx4 v[120:123], v6, s[24:27], s61 offen offset:2048
    buffer_load_dwordx4 v[124:127], v6, s[24:27], s62 offen offset:0
    buffer_load_dwordx4 v[128:131], v6, s[24:27], s62 offen offset:2048
    s_waitcnt vmcnt(8)
    s_branch L_bx
L_h1:
    s_mov_b32 s63, 4096
    s_lshl_b32 s31, s47, 8
    v_lshlrev_b32 v15, 2, v2
    v_add_u32 v16, s31, v15
    s_waitcnt vmcnt(0)
    buffer_load_dwordx4 v[20:23], v3, s[12:15], s63 offen offset:0 sc1
    buffer_load_dwordx4 v[24:27], v3, s[12:15], s63 offen offset:1024 sc1
    buffer_load_dwordx4 v[28:31], v3, s[12:15], s63 offen offset:2048 sc1
    buffer_load_dwordx4 v[32:35], v3, s[12:15], s63 offen offset:3072 sc1
    s_waitcnt vmcnt(0)
L_mi_check:
    v_cmp_ne_u64 s[52:53], s[28:29], v[22:23]
    v_cmp_ne_u64 s[54:55], s[28:29], v[26:27]
    v_cmp_ne_u64 s[56:57], s[28:29], v[30:31]
    v_cmp_ne_u64 s[58:59], s[28:29], v[34:35]
    v_max_u32 v18, v21, v25
    v_max3_u32 v18, v18, v29, v33
    s_or_b64 s[64:65], s[52:53], s[54:55]
    s_or_b64 vcc, s[56:57], s[58:59]
    s_or_b64 s[64:65], s[64:65], vcc
    s_cbranch_scc0 L_mi_got
    s_cmp_eq_u32 s35, 0
    s_cbranch_scc1 L_mi_got
    s_sub_u32 s35, s35, 1
    s_sleep 2
    s_mov_b64 exec, s[52:53]
    s_cbranch_execz L_mi_skip0
    buffer_load_dwordx4 v[20:23], v3, s[12:15], s63 offen offset:0 sc1
L_mi_skip0:
    s_mov_b64 exec, s[54:55]
    s_cbranch_execz L_mi_skip1
    buffer_load_dwordx4 v[24:27], v3, s[12:15], s63 offen offset:1024 sc1
L_mi_skip1:
    s_mov_b64 exec, s[56:57]
    s_cbranch_execz L_mi_skip2
    buffer_load_dwordx4 v[28:31], v3, s[12:15], s63 offen offset:2048 sc1
L_mi_skip2:
    s_mov_b64 exec, s[58:59]
    s_cbranch_execz L_mi_skip3
    buffer_load_dwordx4 v[32:35], v3, s[12:15], s63 offen offset:3072 sc1
L_mi_skip3:
    s_mov_b64 exec, -1
    s_waitcnt vmcnt(0)
    s_branch L_mi_check
L_mi_got:
    v_max_u32_dpp v19, v18, v18 row_ror:1 row_mask:0xf bank_mask:0xf
    s_nop 1
    v_max_u32_dpp v19, v19, v19 row_ror:2 row_mask:0xf bank_mask:0xf
    s_nop 1
    v_max_u32_dpp v19, v19, v19 row_ror:4 row_mask:0xf bank_mask:0xf
    s_nop 1
    v_max_u32_dpp v19, v19, v19 row_ror:8 row_mask:0xf bank_mask:0xf
    s_nop 0
    v_readlane_b32 s33, v19, 0
    v_readlane_b32 s31, v19, 16
    v_readlane_b32 s32, v19, 32
    v_readlane_b32 s34, v19, 48
    s_max_u32 s33, s33, s31
    s_max_u32 s32, s32, s34
    s_max_u32 s33, s33, s32
    s_andn2_b32 s31, 0x7ff, s33
    s_lshl_b32 s48, s31, 11
    buffer_load_dword v17, v16, s[8:11], s48 offen
    buffer_load_dwordx4 v[100:103], v6, s[24:27], 0 offen offset:0
    buffer_load_dwordx4 v[104:107], v6, s[24:27], 0 offen offset:2048
    buffer_load_dwordx4 v[108:111], v6, s[24:27], s60 offen offset:0
    buffer_load_dwordx4 v[112:115], v6, s[24:27], s60 offen offset:2048
    buffer_load_dwordx4 v[116:119], v6, s[24:27], s61 offen offset:0
    buffer_load_dwordx4 v[120:123], v6, s[24:27], s61 offen offset:2048
    buffer_load_dwordx4 v[124:127], v6, s[24:27], s62 offen offset:0
    buffer_load_dwordx4 v[128:131], v6, s[24:27], s62 offen offset:2048
    v_cmp_eq_u32 s[52:53], s33, v25
    v_cmp_eq_u32 s[54:55], s33, v29
    v_cmp_eq_u32 s[56:57], s33, v33
    v_cmp_eq_u32 vcc, s33, v18
    v_cndmask_b32 v19, v20, v24, s[52:53]
    v_cndmask_b32 v19, v19, v28, s[54:55]
    v_cndmask_b32 v19, v19, v32, s[56:57]
    s_ff1_i32_b64 s32, vcc
    v_readlane_b32 s34, v19, s32
    s_nop 0
    s_lshl_b32 s52, s34, 16
    s_and_b32 s32, s34, 0xffff0000
    v_rcp_f32 v20, s32
    s_waitcnt vmcnt(8)
    v_lshlrev_b32 v18, 16, v17
    v_and_b32 v19, 0xffff0000, v17
    v_pk_add_f32 v[18:19], v[18:19], s[52:53] op_sel_hi:[1,0] neg_lo:[0,1] neg_hi:[0,1]
    s_nop 0
    v_cvt_pk_bf16_f32 v17, v18, v19
    v_lshlrev_b32 v18, 16, v17
    v_and_b32 v19, 0xffff0000, v17
    v_pk_mul_f32 v[18:19], v[18:19], v[20:21] op_sel_hi:[1,0]
    s_nop 0
    v_cvt_pk_bf16_f32 v17, v18, v19
    ds_write_b32 v15, v17 offset:0
    s_waitcnt lgkmcnt(0)
L_bx:
    s_barrier
    ds_read_b128 v[20:23], v8 offset:0
    ds_read_b64_tr_b16 v[36:37], v9 offset:512
    ds_read_b64_tr_b16 v[38:39], v9 offset:1536
    ds_read_b64_tr_b16 v[40:41], v10 offset:512
    ds_read_b64_tr_b16 v[42:43], v10 offset:1536
    ds_read_b64_tr_b16 v[44:45], v11 offset:0
    ds_read_b64_tr_b16 v[46:47], v11 offset:1024
    ds_read_b64_tr_b16 v[48:49], v12 offset:0
    ds_read_b64_tr_b16 v[50:51], v12 offset:1024
    ds_read_b128 v[24:27], v8 offset:64
    ds_read_b64_tr_b16 v[52:53], v9 offset:8704
    ds_read_b64_tr_b16 v[54:55], v9 offset:9728
    ds_read_b64_tr_b16 v[56:57], v10 offset:8704
    ds_read_b64_tr_b16 v[58:59], v10 offset:9728
    s_waitcnt lgkmcnt(11)
    v_mfma_f32_16x16x32_bf16 v[132:135], v[20:23], v[36:39], 0
    ds_read_b64_tr_b16 v[60:61], v11 offset:8192
    ds_read_b64_tr_b16 v[62:63], v11 offset:9216
    s_waitcnt lgkmcnt(11)
    v_mfma_f32_16x16x32_bf16 v[136:139], v[20:23], v[40:43], 0
    ds_read_b64_tr_b16 v[64:65], v12 offset:8192
    ds_read_b64_tr_b16 v[66:67], v12 offset:9216
    s_waitcnt lgkmcnt(11)
    v_mfma_f32_16x16x32_bf16 v[140:143], v[20:23], v[44:47], 0
    ds_read_b128 v[28:31], v8 offset:128
    ds_read_b64_tr_b16 v[68:69], v9 offset:16896
    ds_read_b64_tr_b16 v[70:71], v9 offset:17920
    s_waitcnt lgkmcnt(12)
    v_mfma_f32_16x16x32_bf16 v[144:147], v[20:23], v[48:51], 0
    ds_read_b64_tr_b16 v[72:73], v10 offset:16896
    ds_read_b64_tr_b16 v[74:75], v10 offset:17920
    s_waitcnt lgkmcnt(11)
    v_mfma_f32_16x16x32_bf16 v[132:135], v[24:27], v[52:55], v[132:135]
    ds_read_b64_tr_b16 v[76:77], v11 offset:16384
    ds_read_b64_tr_b16 v[78:79], v11 offset:17408
    s_waitcnt lgkmcnt(11)
    v_mfma_f32_16x16x32_bf16 v[136:139], v[24:27], v[56:59], v[136:139]
    ds_read_b64_tr_b16 v[80:81], v12 offset:16384
    ds_read_b64_tr_b16 v[82:83], v12 offset:17408
    s_waitcnt lgkmcnt(11)
    v_mfma_f32_16x16x32_bf16 v[140:143], v[24:27], v[60:63], v[140:143]
    ds_read_b128 v[32:35], v8 offset:192
    ds_read_b64_tr_b16 v[84:85], v9 offset:25088
    ds_read_b64_tr_b16 v[86:87], v9 offset:26112
    s_waitcnt lgkmcnt(12)
    v_mfma_f32_16x16x32_bf16 v[144:147], v[24:27], v[64:67], v[144:147]
    ds_read_b64_tr_b16 v[88:89], v10 offset:25088
    ds_read_b64_tr_b16 v[90:91], v10 offset:26112
    s_waitcnt lgkmcnt(11)
    v_mfma_f32_16x16x32_bf16 v[132:135], v[28:31], v[68:71], v[132:135]
    ds_read_b64_tr_b16 v[92:93], v11 offset:24576
    ds_read_b64_tr_b16 v[94:95], v11 offset:25600
    s_waitcnt lgkmcnt(11)
    v_mfma_f32_16x16x32_bf16 v[136:139], v[28:31], v[72:75], v[136:139]
    ds_read_b64_tr_b16 v[96:97], v12 offset:24576
    ds_read_b64_tr_b16 v[98:99], v12 offset:25600
    s_waitcnt lgkmcnt(11)
    v_mfma_f32_16x16x32_bf16 v[140:143], v[28:31], v[76:79], v[140:143]
    s_waitcnt lgkmcnt(9)
    v_mfma_f32_16x16x32_bf16 v[144:147], v[28:31], v[80:83], v[144:147]
    s_waitcnt lgkmcnt(6)
    v_mfma_f32_16x16x32_bf16 v[132:135], v[32:35], v[84:87], v[132:135]
    s_waitcnt lgkmcnt(4)
    v_mfma_f32_16x16x32_bf16 v[136:139], v[32:35], v[88:91], v[136:139]
    s_waitcnt lgkmcnt(2)
    v_mfma_f32_16x16x32_bf16 v[140:143], v[32:35], v[92:95], v[140:143]
    s_waitcnt lgkmcnt(0)
    v_mfma_f32_16x16x32_bf16 v[144:147], v[32:35], v[96:99], v[144:147]
    s_mov_b32 vcc_lo, 0xffff0000
    s_mov_b32 vcc_hi, 0
    s_lshl_b32 s31, s50, 12
    s_lshl_b32 s32, s30, 7
    s_add_u32 s31, s31, s32
    s_add_u32 s31, s31, 262144
    v_lshrrev_b32 v15, 3, v2
    v_lshlrev_b32 v15, 9, v15
    v_add3_u32 v15, v15, v7, s31
    v_cndmask_b32 v20, v132, v136, vcc
    v_cndmask_b32 v21, v140, v144, vcc
    v_and_or_b32 v20, v20, s49, v14
    v_and_or_b32 v21, v21, s49, v14
    s_mov_b32 exec_hi, 0
    buffer_store_dwordx2 v[20:21], v13, s[12:15], 0 offen sc1
    s_mov_b64 exec, -1
    s_mov_b32 s52, 0x05040100
    s_mov_b32 s53, 0x07060302
    v_mov_b32 v36, 0
    v_mov_b32 v37, 0
    v_mov_b32 v38, 0
    v_mov_b32 v39, 0
    v_mov_b32 v40, 0
    v_mov_b32 v41, 0
    v_mov_b32 v42, 0
    v_mov_b32 v43, 0
    v_and_b32 v16, 7, v2
    v_lshlrev_b32 v16, 2, v16
    v_lshrrev_b32 v17, 5, v2
    v_lshl_add_u32 v16, v17, 1, v16
    s_lshl_b32 s31, s30, 5
    v_add_u32 v16, s31, v16
    v_lshrrev_b32 v17, 3, v2
    v_lshlrev_b32 v17, 4, v17
    s_lshl_b32 s31, s50, 12
    s_lshl_b32 s32, s51, 8
    s_add_u32 s31, s31, s32
    s_add_u32 s31, s31, 524288
    v_lshlrev_b32 v18, 1, v7
    v_lshrrev_b32 v19, 4, v2
    v_lshl_add_u32 v18, v19, 3, v18
    v_add_u32 v18, s31, v18
    s_waitcnt vmcnt(7)
    v_perm_b32 v98, v104, v100, s52
    v_perm_b32 v104, v104, v100, s53
    v_perm_b32 v100, v105, v101, s52
    v_perm_b32 v105, v105, v101, s53
    v_perm_b32 v101, v106, v102, s52
    v_perm_b32 v106, v106, v102, s53
    v_perm_b32 v102, v107, v103, s52
    v_perm_b32 v107, v107, v103, s53
    s_waitcnt vmcnt(5)
    v_perm_b32 v103, v112, v108, s52
    v_perm_b32 v112, v112, v108, s53
    v_perm_b32 v108, v113, v109, s52
    v_perm_b32 v113, v113, v109, s53
    v_perm_b32 v109, v114, v110, s52
    v_perm_b32 v114, v114, v110, s53
    v_perm_b32 v110, v115, v111, s52
    v_perm_b32 v115, v115, v111, s53
    s_waitcnt vmcnt(3)
    v_perm_b32 v111, v120, v116, s52
    v_perm_b32 v120, v120, v116, s53
    v_perm_b32 v116, v121, v117, s52
    v_perm_b32 v121, v121, v117, s53
    v_perm_b32 v117, v122, v118, s52
    v_perm_b32 v122, v122, v118, s53
    v_perm_b32 v118, v123, v119, s52
    v_perm_b32 v123, v123, v119, s53
    s_waitcnt vmcnt(1)
    v_perm_b32 v119, v128, v124, s52
    v_perm_b32 v128, v128, v124, s53
    v_perm_b32 v124, v129, v125, s52
    v_perm_b32 v129, v129, v125, s53
    v_perm_b32 v125, v130, v126, s52
    v_perm_b32 v130, v130, v126, s53
    v_perm_b32 v126, v131, v127, s52
    v_perm_b32 v131, v131, v127, s53
L_hp_poll:
    buffer_load_dwordx4 v[20:23], v15, s[12:15], 0 offen sc1
    s_waitcnt vmcnt(0)
    v_xor_b32 v20, v14, v20
    v_xor_b32 v21, v14, v21
    v_xor_b32 v22, v14, v22
    v_xor_b32 v23, v14, v23
    v_or3_b32 v24, v20, v21, v22
    v_or_b32 v24, v24, v23
    v_and_b32 v24, 0xff, v24
    v_cmp_ne_u32 vcc, 0, v24
    v_permlane16_swap_b32 v20, v21
    v_permlane16_swap_b32 v22, v23
    s_cbranch_vccz L_hp_got
    s_cmp_eq_u32 s35, 0
    s_cbranch_scc1 L_hp_got
    s_sub_u32 s35, s35, 1
    s_sleep 2
    s_branch L_hp_poll
L_hp_got:
    v_add_f32 v20, v20, v21
    v_add_f32 v22, v22, v23
    s_nop 1
    v_permlane32_swap_b32 v20, v22
    v_add_f32 v20, v20, v22
    s_nop 1
    v_add_f32_dpp v21, v20, v20 row_ror:8 row_mask:0xf bank_mask:0xf
    v_add_f32_dpp v20, v20, v20 row_ror:8 row_mask:0xf bank_mask:0xf
    s_nop 1
    v_permlane16_swap_b32 v20, v21
    v_cvt_pk_bf16_f32 v20, v20, v21
    v_and_b32 v21, 0xffff0000, v20
    v_lshlrev_b32 v20, 16, v20
    v_mul_f32 v22, 0xbfb8aa3b, v20
    v_exp_f32 v22, v22
    s_nop 0
    v_add_f32 v22, 1.0, v22
    v_rcp_f32 v22, v22
    s_nop 0
    v_mul_f32 v20, v20, v22
    v_cvt_pk_bf16_f32 v20, v20, v20
    v_lshlrev_b32 v20, 16, v20
    v_mul_f32 v20, v20, v21
    v_cvt_pk_bf16_f32 v20, v20, v20
    ds_write_b16 v16, v20 offset:256
    s_waitcnt lgkmcnt(0)
    s_barrier
    ds_read_b128 v[20:23], v17 offset:256
    s_waitcnt lgkmcnt(0)
    v_dot2c_f32_bf16 v36, v20, v98
    v_dot2c_f32_bf16 v37, v20, v104
    v_dot2c_f32_bf16 v38, v20, v100
    v_dot2c_f32_bf16 v39, v20, v105
    v_dot2c_f32_bf16 v40, v20, v101
    v_dot2c_f32_bf16 v41, v20, v106
    v_dot2c_f32_bf16 v42, v20, v102
    v_dot2c_f32_bf16 v43, v20, v107
    v_dot2c_f32_bf16 v36, v21, v103
    v_dot2c_f32_bf16 v37, v21, v112
    v_dot2c_f32_bf16 v38, v21, v108
    v_dot2c_f32_bf16 v39, v21, v113
    v_dot2c_f32_bf16 v40, v21, v109
    v_dot2c_f32_bf16 v41, v21, v114
    v_dot2c_f32_bf16 v42, v21, v110
    v_dot2c_f32_bf16 v43, v21, v115
    v_dot2c_f32_bf16 v36, v22, v111
    v_dot2c_f32_bf16 v37, v22, v120
    v_dot2c_f32_bf16 v38, v22, v116
    v_dot2c_f32_bf16 v39, v22, v121
    v_dot2c_f32_bf16 v40, v22, v117
    v_dot2c_f32_bf16 v41, v22, v122
    v_dot2c_f32_bf16 v42, v22, v118
    v_dot2c_f32_bf16 v43, v22, v123
    v_dot2c_f32_bf16 v36, v23, v119
    v_dot2c_f32_bf16 v37, v23, v128
    v_dot2c_f32_bf16 v38, v23, v124
    v_dot2c_f32_bf16 v39, v23, v129
    v_dot2c_f32_bf16 v40, v23, v125
    v_dot2c_f32_bf16 v41, v23, v130
    v_dot2c_f32_bf16 v42, v23, v126
    v_dot2c_f32_bf16 v43, v23, v131
    v_permlane32_swap_b32 v36, v40
    v_permlane32_swap_b32 v37, v41
    v_permlane32_swap_b32 v38, v42
    v_permlane32_swap_b32 v39, v43
    v_add_f32 v36, v36, v40
    v_add_f32 v37, v37, v41
    v_add_f32 v38, v38, v42
    v_add_f32 v39, v39, v43
    s_nop 0
    v_permlane16_swap_b32 v36, v38
    v_permlane16_swap_b32 v37, v39
    v_add_f32 v36, v36, v38
    v_add_f32 v37, v37, v39
    s_nop 0
    v_add_f32_dpp v36, v36, v36 row_ror:8 row_mask:0xf bank_mask:0xf
    v_add_f32_dpp v37, v37, v37 row_ror:8 row_mask:0xf bank_mask:0xf
    v_and_or_b32 v36, v36, s49, v14
    v_and_or_b32 v37, v37, s49, v14
    s_mov_b32 exec_lo, 0x00ff00ff
    s_mov_b32 exec_hi, 0x00ff00ff
    buffer_store_dwordx2 v[36:37], v18, s[12:15], 0 offen sc1
    s_mov_b64 exec, -1
L_fin:
L_exit:
    s_endpgm
L_code_end:
.section .rodata,"a"
.p2align 6
.amdhsa_kernel recurrent_scan__spectral_fnet__moe_arch_mod__prompt_kernel
  .amdhsa_next_free_vgpr 256
  .amdhsa_next_free_sgpr 72
  .amdhsa_accum_offset 256
  .amdhsa_group_segment_fixed_size 0
  .amdhsa_kernarg_size 104
  .amdhsa_user_sgpr_count 2
  .amdhsa_user_sgpr_kernarg_segment_ptr 1
  .amdhsa_system_sgpr_workgroup_id_x 1
  .amdhsa_float_denorm_mode_32 3
.end_amdhsa_kernel
```

```asm
; @launch grid=(256,1,1) block=(512,1,1) lds=141312
.amdgcn_target "amdgcn-amd-amdhsa--gfx950"
.text
.globl recurrent_scan__spectral_fnet__moe_arch_mod__prompt_kernel
.p2align 8
.type recurrent_scan__spectral_fnet__moe_arch_mod__prompt_kernel,@function
recurrent_scan__spectral_fnet__moe_arch_mod__prompt_kernel:
    s_cmp_ge_u32 s2, 256
    s_cbranch_scc1 L_exit
    s_load_dwordx2 s[4:5], s[0:1], 0
    s_load_dwordx2 s[6:7], s[0:1], 96
    s_load_dwordx8 s[36:43], s[0:1], 48
    s_load_dwordx2 s[44:45], s[0:1], 80
    s_getpc_b64 s[32:33]
L_pc:
    s_bfe_u32 s31, s2, 0x30003
    v_subrev_u32 v3, 496, v0
    v_lshl_add_u32 v3, v3, 3, s31
    v_lshlrev_b32 v3, 7, v3
    v_cmp_gt_u32 vcc, L_code_end-L_pc, v3
    s_nop 0
    s_and_saveexec_b64 s[46:47], vcc
    s_cbranch_execz L_nopf
    global_load_dword v254, v3, s[32:33]
L_nopf:
    s_mov_b64 exec, -1
    v_lshrrev_b32 v1, 6, v0
    v_and_b32 v2, 63, v0
    v_readfirstlane_b32 s30, v1
    s_mov_b32 s10, 0x400000
    s_mov_b32 s11, 0x00020000
    s_mov_b32 s14, 0x10000000
    s_mov_b32 s15, 0x00020000
    s_mov_b32 s35, 65536
    v_lshlrev_b32 v3, 4, v2
    v_mov_b32 v0, 0
    v_mov_b32 v255, 1
    s_mov_b32 s3, s30
    s_and_b32 s30, s30, 3
    s_cmp_ge_u32 s3, 4
    s_cbranch_scc1 L_moe
    s_and_b32 s31, s2, 7
    s_lshr_b32 s32, s2, 4
    s_sub_u32 s32, 15, s32
    s_lshl_b32 s32, s32, 3
    s_add_u32 s46, s32, s31
    s_bfe_u32 s47, s2, 0x10003
    s_lshl_b32 s31, s30, 9
    s_add_u32 s52, s31, s46
    s_sub_u32 s54, 2048, s52
    s_add_u32 s31, s52, 128
    s_cmp_eq_u32 s46, 0
    s_cselect_b32 s54, s31, s54
    s_cselect_b32 s50, 1, 0
    s_cselect_b32 s31, 1, -1
    s_lshl_b32 s31, s31, 8
    s_add_u32 s53, s52, 256
    s_add_u32 s55, s54, s31
    s_lshl_b32 s56, s52, 11
    s_lshl_b32 s57, s53, 11
    s_lshl_b32 s58, s54, 11
    s_lshl_b32 s59, s55, 11
    s_mov_b32 s22, 2048
    s_mov_b32 s23, 0x00020000
    v_mov_b32 v1, 0
    v_and_b32 v6, 15, v2
    v_lshlrev_b32 v6, 2, v6
    ds_write_b64 v0, v[0:1] offset:41536
    ds_write_b32 v6, v0 offset:42816
    s_waitcnt lgkmcnt(0)
    s_mov_b32 s8, s4
    s_mov_b32 s9, s5
    s_mov_b32 s12, s6
    s_mov_b32 s13, s7
    s_mov_b32 s20, s36
    s_mov_b32 s21, s37
    buffer_load_dwordx4 v[152:155], v3, s[20:23], 0 offen
    buffer_load_dwordx4 v[156:159], v3, s[20:23], 0 offen offset:1024
    buffer_load_dwordx4 v[120:123], v3, s[8:11], s56 offen
    buffer_load_dwordx4 v[124:127], v3, s[8:11], s56 offen offset:1024
    buffer_load_dwordx4 v[128:131], v3, s[8:11], s57 offen
    buffer_load_dwordx4 v[132:135], v3, s[8:11], s57 offen offset:1024
    buffer_load_dwordx4 v[136:139], v3, s[8:11], s58 offen
    buffer_load_dwordx4 v[140:143], v3, s[8:11], s58 offen offset:1024
    buffer_load_dwordx4 v[144:147], v3, s[8:11], s59 offen
    buffer_load_dwordx4 v[148:151], v3, s[8:11], s59 offen offset:1024
    s_barrier
    s_load_dwordx2 s[28:29], s[6:7], 0
    s_mov_b32 s16, s44
    s_mov_b32 s17, s45
    s_mov_b32 s18, 0x400000
    s_mov_b32 s19, 0x00020000
    v_mov_b32 v5, 41536
    v_writelane_b32 v200, s52, 15
    v_writelane_b32 v200, s53, 31
    v_writelane_b32 v200, s54, 47
    v_writelane_b32 v200, s55, 63
    v_lshrrev_b32 v201, 8, v200
    v_lshlrev_b32 v201, 3, v201
    v_sub_u32 v200, 2047, v200
    v_bfe_u32 v202, v2, 4, 1
    v_lshrrev_b32 v6, 5, v2
    v_lshl_add_u32 v202, v6, 3, v202
    s_lshl_b32 s31, s30, 1
    v_add_u32 v202, s31, v202
    v_lshlrev_b32 v203, 2, v202
    v_lshlrev_b32 v202, 1, v202
    s_cmp_eq_u32 s47, 0
    s_cselect_b32 s51, s52, s54
    s_and_b32 s51, s51, 255
    s_cmp_eq_u32 s30, 3
    s_cselect_b32 s32, 9, 0
    v_cmp_gt_u32 vcc, s32, v2
    s_lshl_b32 s31, s51, 7
    s_add_u32 s31, s31, 32768
    v_add_u32 v4, s31, v3
    s_lshl_b32 s31, s51, 4
    s_add_u32 s31, s31, 4096
    v_writelane_b32 v4, s31, 8
    v_mov_b32 v6, 2147483392
    v_cndmask_b32 v4, v6, v4, vcc
    s_mul_i32 s31, s30, 5184
    v_and_b32 v204, 32, v2
    v_lshlrev_b32 v204, 2, v204
    v_add3_u32 v204, v204, v3, s31
    s_lshl_b32 s32, s31, 1
    s_add_u32 s32, s32, 21872
    v_sub_u32 v205, s32, v204
    v_bfe_u32 v206, v2, 2, 2
    v_mul_u32_u24 v206, 2592, v206
    v_lshrrev_b32 v6, 4, v2
    v_mul_u32_u24 v7, 640, v6
    v_add_u32 v206, v206, v7
    v_and_b32 v7, 3, v2
    v_lshlrev_b32 v7, 3, v7
    s_lshl_b32 s31, s30, 7
    v_add3_u32 v206, v206, v7, s31
    v_lshlrev_b32 v6, 12, v6
    v_and_b32 v7, 15, v2
    v_lshl_add_u32 v6, v7, 4, v6
    s_lshl_b32 s31, s30, 8
    v_add_u32 v207, s31, v6
    v_bfe_i32 v208, v2, 4, 1
    v_and_b32 v208, 0x80008000, v208
    v_bfe_u32 v160, v2, 2, 2
    s_lshl_b32 s31, s47, 2
    v_add_u32 v160, s31, v160
    v_lshrrev_b32 v161, 4, v2
    v_bfe_u32 v162, v2, 1, 1
    v_mul_u32_u24 v161, v161, v162
    v_and_b32 v162, 1, v2
    v_add_u32 v161, v161, v162
    v_cvt_f32_u32 v160, v160
    v_cvt_f32_u32 v161, v161
    v_mul_f32 v160, 0x3e000000, v160
    v_mul_f32 v161, 0x3e800000, v161
    v_cos_f32 v8, v161
    v_add_f32 v161, v161, v160
    v_cos_f32 v9, v161
    v_add_f32 v161, v161, v160
    v_cos_f32 v10, v161
    v_add_f32 v161, v161, v160
    v_cos_f32 v11, v161
    v_add_f32 v161, v161, v160
    v_cos_f32 v12, v161
    v_add_f32 v161, v161, v160
    v_cos_f32 v13, v161
    v_add_f32 v161, v161, v160
    v_cos_f32 v14, v161
    v_add_f32 v161, v161, v160
    v_cos_f32 v15, v161
    v_lshrrev_b32 v160, 2, v2
    v_and_b32 v160, 12, v160
    v_and_b32 v161, 15, v2
    v_lshlrev_b32 v161, 2, v161
    v_cvt_f32_u32 v160, v160
    v_cvt_f32_u32 v161, v161
    v_mul_f32 v212, 0x3c800000, v160
    s_lshl_b32 s31, s47, 2
    s_add_u32 s48, s31, s30
    s_sub_u32 s31, s48, 4
    s_mul_i32 s31, s31, s46
    v_cvt_f32_i32 v162, s31
    v_mul_f32 v162, 0x3a000000, v162
    v_add_f32 v213, 0x3c800000, v212
    v_add_f32 v214, 0x3d000000, v212
    v_add_f32 v215, 0x3d400000, v212
    v_mul_f32 v160, v212, v161
    v_fmamk_f32 v52, v160, 0x3d800000, v162
    v_sin_f32 v20, v160
    v_cos_f32 v160, v160
    v_cos_f32 v48, v52
    v_sin_f32 v52, v52
    v_cvt_pk_f16_f32 v16, v160, v20
    v_cvt_pk_f16_f32 v20, -v20, v160
    v_mul_f32 v160, v213, v161
    v_fmamk_f32 v53, v160, 0x3d800000, v162
    v_sin_f32 v21, v160
    v_cos_f32 v160, v160
    v_cos_f32 v49, v53
    v_sin_f32 v53, v53
    v_cvt_pk_f16_f32 v17, v160, v21
    v_cvt_pk_f16_f32 v21, -v21, v160
    v_mul_f32 v160, v214, v161
    v_fmamk_f32 v54, v160, 0x3d800000, v162
    v_sin_f32 v22, v160
    v_cos_f32 v160, v160
    v_cos_f32 v50, v54
    v_sin_f32 v54, v54
    v_cvt_pk_f16_f32 v18, v160, v22
    v_cvt_pk_f16_f32 v22, -v22, v160
    v_mul_f32 v160, v215, v161
    v_fmamk_f32 v55, v160, 0x3d800000, v162
    v_sin_f32 v23, v160
    v_cos_f32 v160, v160
    v_cos_f32 v51, v55
    v_sin_f32 v55, v55
    v_cvt_pk_f16_f32 v19, v160, v23
    v_cvt_pk_f16_f32 v23, -v23, v160
    v_add_f32 v161, 1.0, v161
    v_mul_f32 v160, v212, v161
    v_fmamk_f32 v60, v160, 0x3d800000, v162
    v_sin_f32 v28, v160
    v_cos_f32 v160, v160
    v_cos_f32 v56, v60
    v_sin_f32 v60, v60
    v_cvt_pk_f16_f32 v24, v160, v28
    v_cvt_pk_f16_f32 v28, -v28, v160
    v_mul_f32 v160, v213, v161
    v_fmamk_f32 v61, v160, 0x3d800000, v162
    v_sin_f32 v29, v160
    v_cos_f32 v160, v160
    v_cos_f32 v57, v61
    v_sin_f32 v61, v61
    v_cvt_pk_f16_f32 v25, v160, v29
    v_cvt_pk_f16_f32 v29, -v29, v160
    v_mul_f32 v160, v214, v161
    v_fmamk_f32 v62, v160, 0x3d800000, v162
    v_sin_f32 v30, v160
    v_cos_f32 v160, v160
    v_cos_f32 v58, v62
    v_sin_f32 v62, v62
    v_cvt_pk_f16_f32 v26, v160, v30
    v_cvt_pk_f16_f32 v30, -v30, v160
    v_mul_f32 v160, v215, v161
    v_fmamk_f32 v63, v160, 0x3d800000, v162
    v_sin_f32 v31, v160
    v_cos_f32 v160, v160
    v_cos_f32 v59, v63
    v_sin_f32 v63, v63
    v_cvt_pk_f16_f32 v27, v160, v31
    v_cvt_pk_f16_f32 v31, -v31, v160
    v_add_f32 v161, 1.0, v161
    v_mul_f32 v160, v212, v161
    v_fmamk_f32 v68, v160, 0x3d800000, v162
    v_sin_f32 v36, v160
    v_cos_f32 v160, v160
    v_cos_f32 v64, v68
    v_sin_f32 v68, v68
    v_cvt_pk_f16_f32 v32, v160, v36
    v_cvt_pk_f16_f32 v36, -v36, v160
    v_mul_f32 v160, v213, v161
    v_fmamk_f32 v69, v160, 0x3d800000, v162
    v_sin_f32 v37, v160
    v_cos_f32 v160, v160
    v_cos_f32 v65, v69
    v_sin_f32 v69, v69
    v_cvt_pk_f16_f32 v33, v160, v37
    v_cvt_pk_f16_f32 v37, -v37, v160
    v_mul_f32 v160, v214, v161
    v_fmamk_f32 v70, v160, 0x3d800000, v162
    v_sin_f32 v38, v160
    v_cos_f32 v160, v160
    v_cos_f32 v66, v70
    v_sin_f32 v70, v70
    v_cvt_pk_f16_f32 v34, v160, v38
    v_cvt_pk_f16_f32 v38, -v38, v160
    v_mul_f32 v160, v215, v161
    v_fmamk_f32 v71, v160, 0x3d800000, v162
    v_sin_f32 v39, v160
    v_cos_f32 v160, v160
    v_cos_f32 v67, v71
    v_sin_f32 v71, v71
    v_cvt_pk_f16_f32 v35, v160, v39
    v_cvt_pk_f16_f32 v39, -v39, v160
    v_add_f32 v161, 1.0, v161
    v_mul_f32 v160, v212, v161
    v_fmamk_f32 v76, v160, 0x3d800000, v162
    v_sin_f32 v44, v160
    v_cos_f32 v160, v160
    v_cos_f32 v72, v76
    v_sin_f32 v76, v76
    v_cvt_pk_f16_f32 v40, v160, v44
    v_cvt_pk_f16_f32 v44, -v44, v160
    v_mul_f32 v160, v213, v161
    v_fmamk_f32 v77, v160, 0x3d800000, v162
    v_sin_f32 v45, v160
    v_cos_f32 v160, v160
    v_cos_f32 v73, v77
    v_sin_f32 v77, v77
    v_cvt_pk_f16_f32 v41, v160, v45
    v_cvt_pk_f16_f32 v45, -v45, v160
    v_mul_f32 v160, v214, v161
    v_fmamk_f32 v78, v160, 0x3d800000, v162
    v_sin_f32 v46, v160
    v_cos_f32 v160, v160
    v_cos_f32 v74, v78
    v_sin_f32 v78, v78
    v_cvt_pk_f16_f32 v42, v160, v46
    v_cvt_pk_f16_f32 v46, -v46, v160
    v_mul_f32 v160, v215, v161
    v_fmamk_f32 v79, v160, 0x3d800000, v162
    v_sin_f32 v47, v160
    v_cos_f32 v160, v160
    v_cos_f32 v75, v79
    v_sin_f32 v79, v79
    v_cvt_pk_f16_f32 v43, v160, v47
    v_cvt_pk_f16_f32 v47, -v47, v160
    s_and_b32 s31, s46, 1
    s_lshl_b32 s31, s31, 6
    s_lshr_b32 s32, s46, 1
    s_add_u32 s49, s31, s32
    s_bitcmp1_b32 s49, 2
    s_cselect_b64 vcc, -1, 0
    v_cndmask_b32 v80, v16, v20, vcc
    v_cndmask_b32 v84, v20, v16, vcc
    v_cndmask_b32 v81, v17, v21, vcc
    v_cndmask_b32 v85, v21, v17, vcc
    v_cndmask_b32 v82, v18, v22, vcc
    v_cndmask_b32 v86, v22, v18, vcc
    v_cndmask_b32 v83, v19, v23, vcc
    v_cndmask_b32 v87, v23, v19, vcc
    s_bfe_u32 s31, s49, 0x10001
    v_and_b32 v6, 7, v2
    v_xor_b32 v6, s31, v6
    v_lshlrev_b32 v6, 4, v6
    v_lshrrev_b32 v7, 4, v2
    v_lshlrev_b32 v7, 3, v7
    v_bfe_u32 v209, v2, 3, 1
    v_add_u32 v7, v7, v209
    v_mul_u32_u24 v7, 16512, v7
    v_add_u32 v209, v6, v7
    s_mul_i32 s31, s48, 528384
    s_lshl_b32 s32, s49, 7
    s_add_u32 s31, s31, s32
    s_add_u32 s60, s31, 2097152
    v_mov_b32 v160, 0
    v_mov_b32 v161, 0
    v_mov_b32 v162, 0
    v_mov_b32 v163, 0
    v_mov_b32 v164, 0
    v_mov_b32 v165, 0
    v_mov_b32 v166, 0
    v_mov_b32 v167, 0
    v_mov_b32 v168, 0
    v_mov_b32 v169, 0
    v_mov_b32 v170, 0
    s_mov_b32 s57, 0x3f803f80
    s_mov_b32 s59, 0xffff
    s_brev_b32 s67, 1
    s_mov_b32 s66, 0
    s_mov_b32 s64, 0x80008000
    s_mov_b32 s65, 0x80008000
    s_cmp_eq_u32 s47, 0
    s_cselect_b32 s62, s64, 0
    s_cselect_b32 s63, 0, s64
    s_cmp_ge_u32 s2, 224
    s_cselect_b32 s61, 8, 4
    s_waitcnt vmcnt(8)
    v_dot2c_f32_bf16 v170, s57, v152
    v_dot2c_f32_bf16 v170, s57, v153
    v_dot2c_f32_bf16 v170, s57, v154
    v_dot2c_f32_bf16 v170, s57, v155
    v_dot2c_f32_bf16 v170, s57, v156
    v_dot2c_f32_bf16 v170, s57, v157
    v_dot2c_f32_bf16 v170, s57, v158
    v_dot2c_f32_bf16 v170, s57, v159
    s_nop 2
    v_add_f32_dpp v170, v170, v170 row_shr:1 row_mask:0xf bank_mask:0xf
    s_nop 1
    v_add_f32_dpp v170, v170, v170 row_shr:2 row_mask:0xf bank_mask:0xf
    s_nop 1
    v_add_f32_dpp v170, v170, v170 row_shr:4 row_mask:0xf bank_mask:0xf
    s_nop 1
    v_add_f32_dpp v170, v170, v170 row_shr:8 row_mask:0xf bank_mask:0xf
    s_nop 1
    v_add_f32_dpp v170, v170, v170 row_bcast:15 row_mask:0xa bank_mask:0xf
    s_nop 1
    v_add_f32_dpp v170, v170, v170 row_bcast:31 row_mask:0xc bank_mask:0xf
    s_nop 0
    v_readlane_b32 s56, v170, 63
    s_waitcnt lgkmcnt(0)
    s_add_u32 s28, s28, 0x7f4a7c15
    s_addc_u32 s29, s29, 0x9e3779b9
    s_setprio 2
    s_waitcnt vmcnt(6)
    ds_write_b128 v204, v[120:123] offset:0
    ds_write_b128 v204, v[124:127] offset:1280
    v_dot2c_f32_bf16 v160, s57, v120
    v_dot2c_f32_bf16 v164, v120, v120
    v_dot2c_f32_bf16 v160, s57, v121
    v_dot2c_f32_bf16 v164, v121, v121
    v_dot2c_f32_bf16 v160, s57, v122
    v_dot2c_f32_bf16 v164, v122, v122
    v_dot2c_f32_bf16 v160, s57, v123
    v_dot2c_f32_bf16 v164, v123, v123
    v_dot2c_f32_bf16 v160, s57, v124
    v_dot2c_f32_bf16 v164, v124, v124
    v_dot2c_f32_bf16 v160, s57, v125
    v_dot2c_f32_bf16 v164, v125, v125
    v_dot2c_f32_bf16 v160, s57, v126
    v_dot2c_f32_bf16 v164, v126, v126
    v_dot2c_f32_bf16 v160, s57, v127
    v_dot2c_f32_bf16 v164, v127, v127
    s_waitcnt vmcnt(4)
    ds_write_b128 v204, v[128:131] offset:2592
    ds_write_b128 v204, v[132:135] offset:3872
    v_dot2c_f32_bf16 v161, s57, v128
    v_dot2c_f32_bf16 v165, v128, v128
    v_dot2c_f32_bf16 v161, s57, v129
    v_dot2c_f32_bf16 v165, v129, v129
    v_dot2c_f32_bf16 v161, s57, v130
    v_dot2c_f32_bf16 v165, v130, v130
    v_dot2c_f32_bf16 v161, s57, v131
    v_dot2c_f32_bf16 v165, v131, v131
    v_dot2c_f32_bf16 v161, s57, v132
    v_dot2c_f32_bf16 v165, v132, v132
    v_dot2c_f32_bf16 v161, s57, v133
    v_dot2c_f32_bf16 v165, v133, v133
    v_dot2c_f32_bf16 v161, s57, v134
    v_dot2c_f32_bf16 v165, v134, v134
    v_dot2c_f32_bf16 v161, s57, v135
    v_dot2c_f32_bf16 v165, v135, v135
    s_cmp_lg_u32 s47, 0
    s_cbranch_scc1 L_dot_m
    v_dot2c_f32_bf16 v168, v152, v120
    v_dot2c_f32_bf16 v169, v152, v128
    v_dot2c_f32_bf16 v168, v153, v121
    v_dot2c_f32_bf16 v169, v153, v129
    v_dot2c_f32_bf16 v168, v154, v122
    v_dot2c_f32_bf16 v169, v154, v130
    v_dot2c_f32_bf16 v168, v155, v123
    v_dot2c_f32_bf16 v169, v155, v131
    v_dot2c_f32_bf16 v168, v156, v124
    v_dot2c_f32_bf16 v169, v156, v132
    v_dot2c_f32_bf16 v168, v157, v125
    v_dot2c_f32_bf16 v169, v157, v133
    v_dot2c_f32_bf16 v168, v158, v126
    v_dot2c_f32_bf16 v169, v158, v134
    v_dot2c_f32_bf16 v168, v159, v127
    v_dot2c_f32_bf16 v169, v159, v135
    s_waitcnt vmcnt(0)
    s_branch L_dot_done
L_dot_m:
    s_waitcnt vmcnt(0)
    v_dot2c_f32_bf16 v168, v152, v136
    v_dot2c_f32_bf16 v169, v152, v144
    v_dot2c_f32_bf16 v168, v153, v137
    v_dot2c_f32_bf16 v169, v153, v145
    v_dot2c_f32_bf16 v168, v154, v138
    v_dot2c_f32_bf16 v169, v154, v146
    v_dot2c_f32_bf16 v168, v155, v139
    v_dot2c_f32_bf16 v169, v155, v147
    v_dot2c_f32_bf16 v168, v156, v140
    v_dot2c_f32_bf16 v169, v156, v148
    v_dot2c_f32_bf16 v168, v157, v141
    v_dot2c_f32_bf16 v169, v157, v149
    v_dot2c_f32_bf16 v168, v158, v142
    v_dot2c_f32_bf16 v169, v158, v150
    v_dot2c_f32_bf16 v168, v159, v143
    v_dot2c_f32_bf16 v169, v159, v151
L_dot_done:
    v_dot2c_f32_bf16 v162, s57, v136
    v_dot2c_f32_bf16 v166, v136, v136
    v_dot2c_f32_bf16 v162, s57, v137
    v_dot2c_f32_bf16 v166, v137, v137
    v_dot2c_f32_bf16 v162, s57, v138
    v_dot2c_f32_bf16 v166, v138, v138
    v_dot2c_f32_bf16 v162, s57, v139
    v_dot2c_f32_bf16 v166, v139, v139
    v_dot2c_f32_bf16 v162, s57, v140
    v_dot2c_f32_bf16 v166, v140, v140
    v_dot2c_f32_bf16 v162, s57, v141
    v_dot2c_f32_bf16 v166, v141, v141
    v_dot2c_f32_bf16 v162, s57, v142
    v_dot2c_f32_bf16 v166, v142, v142
    v_dot2c_f32_bf16 v162, s57, v143
    v_dot2c_f32_bf16 v166, v143, v143
    v_permlane16_swap_b32 v168, v169
    v_permlane16_swap_b32 v160, v161
    v_permlane16_swap_b32 v164, v165
    v_add_f32 v168, v168, v169
    v_add_f32 v160, v160, v161
    v_add_f32 v164, v164, v165
    v_mov_b32 v169, v168
    v_dot2c_f32_bf16 v163, s57, v144
    v_dot2c_f32_bf16 v167, v144, v144
    v_dot2c_f32_bf16 v163, s57, v145
    v_dot2c_f32_bf16 v167, v145, v145
    v_dot2c_f32_bf16 v163, s57, v146
    v_dot2c_f32_bf16 v167, v146, v146
    v_dot2c_f32_bf16 v163, s57, v147
    v_dot2c_f32_bf16 v167, v147, v147
    v_dot2c_f32_bf16 v163, s57, v148
    v_dot2c_f32_bf16 v167, v148, v148
    v_dot2c_f32_bf16 v163, s57, v149
    v_dot2c_f32_bf16 v167, v149, v149
    v_dot2c_f32_bf16 v163, s57, v150
    v_dot2c_f32_bf16 v167, v150, v150
    v_dot2c_f32_bf16 v163, s57, v151
    v_dot2c_f32_bf16 v167, v151, v151
    v_permlane32_swap_b32 v168, v169
    v_add_f32 v168, v168, v169
    v_permlane16_swap_b32 v162, v163
    v_permlane16_swap_b32 v166, v167
    v_add_f32 v162, v162, v163
    v_add_f32 v166, v166, v167
    v_add_f32_dpp v168, v168, v168 row_shr:1 row_mask:0xf bank_mask:0xf
    v_permlane32_swap_b32 v160, v162
    v_permlane32_swap_b32 v164, v166
    v_add_f32 v160, v160, v162
    v_add_f32 v164, v164, v166
    v_add_f32_dpp v168, v168, v168 row_shr:2 row_mask:0xf bank_mask:0xf
    v_add_f32_dpp v160, v160, v160 row_shr:1 row_mask:0xf bank_mask:0xf
    v_add_f32_dpp v164, v164, v164 row_shr:1 row_mask:0xf bank_mask:0xf
    v_add_f32_dpp v168, v168, v168 row_shr:4 row_mask:0xf bank_mask:0xf
    v_add_f32_dpp v160, v160, v160 row_shr:2 row_mask:0xf bank_mask:0xf
    v_add_f32_dpp v164, v164, v164 row_shr:2 row_mask:0xf bank_mask:0xf
    v_add_f32_dpp v168, v168, v168 row_shr:8 row_mask:0xf bank_mask:0xf
    v_add_f32_dpp v160, v160, v160 row_shr:4 row_mask:0xf bank_mask:0xf
    v_add_f32_dpp v164, v164, v164 row_shr:4 row_mask:0xf bank_mask:0xf
    s_nop 0
    v_add_f32_dpp v160, v160, v160 row_shr:8 row_mask:0xf bank_mask:0xf
    v_add_f32_dpp v164, v164, v164 row_shr:8 row_mask:0xf bank_mask:0xf
    v_mul_f32 v160, 0x3a800000, v160
    v_mul_f32 v164, 0x3a800000, v164
    v_fma_f32 v164, -v160, v160, v164
    v_cvt_pk_bf16_f32 v161, -v160, -v160
    v_max_f32 v164, 0, v164
    v_cvt_pk_bf16_f32 v164, v164, v164
    v_and_b32 v164, 0xffff0000, v164
    v_add_f32 v164, 0x3727c5ac, v164
    v_cvt_pk_bf16_f32 v164, v164, v164
    v_and_b32 v164, 0xffff0000, v164
    v_sqrt_f32 v164, v164
    v_and_b32 v170, 0xffff0000, v161
    v_cvt_pk_bf16_f32 v162, v160, v164
    v_and_b32 v164, 0xffff0000, v162
    v_rcp_f32 v164, v164
    v_fmac_f32 v168, s56, v170
    v_mul_f32 v168, v168, v164
    v_ashrrev_i32 v170, 31, v168
    v_or_b32 v170, 0x80000000, v170
    v_xor_b32 v168, v168, v170
    v_and_b32 v168, 0xfffff800, v168
    v_or_b32 v163, v200, v168
    s_mov_b64 exec, s[62:63]
    ds_write_b64 v201, v[162:163] offset:41472
    ds_max_u64 v5, v[162:163]
    s_mov_b64 exec, s[64:65]
    ds_write_b16 v202, v161 offset:41568
    ds_write_b32 v203, v164 offset:42752
    s_mov_b64 exec, 1
    ds_add_u32 v0, v255 offset:42816
    s_mov_b64 exec, -1
    v_min_u32 v5, 8, v2
    v_lshlrev_b32 v5, 3, v5
    v_mov_b32 v174, s28
    v_mov_b32 v175, s29
L_sync1:
    ds_read_b32 v1, v0 offset:42816
    s_waitcnt lgkmcnt(0)
    v_readfirstlane_b32 s31, v1
    s_nop 0
    s_cmp_ge_u32 s31, s61
    s_cbranch_scc0 L_sync1
    ds_read_b64 v[172:173], v5 offset:41472
    ds_read_b128 v[176:179], v0 offset:42752
    ds_read_b128 v[180:183], v0 offset:42768
    ds_read_b128 v[184:187], v0 offset:42784
    ds_read_b128 v[188:191], v0 offset:42800
    ds_read_b128 v[192:195], v0 offset:41568
    ds_read_b128 v[196:199], v0 offset:41584
    v_mov_b32_dpp v160, v136 wave_rol:1 row_mask:0xf bank_mask:0xf
    v_mov_b32_dpp v161, v140 wave_rol:1 row_mask:0xf bank_mask:0xf
    v_mov_b32_dpp v162, v144 wave_rol:1 row_mask:0xf bank_mask:0xf
    v_mov_b32_dpp v163, v148 wave_rol:1 row_mask:0xf bank_mask:0xf
    v_cndmask_b32 v164, v160, v161, s[66:67]
    v_cndmask_b32 v165, v161, v160, s[66:67]
    v_cndmask_b32 v166, v162, v163, s[66:67]
    v_cndmask_b32 v167, v163, v162, s[66:67]
    s_waitcnt lgkmcnt(6)
    buffer_store_dwordx4 v[172:175], v4, s[12:15], 0 offen sc1
    s_setprio 1
    s_cmp_lg_u32 s50, 0
    s_cbranch_scc1 L_second_plain
    v_bfi_b32 v220, s59, v164, v139
    v_bfi_b32 v221, s59, v139, v138
    v_bfi_b32 v222, s59, v138, v137
    v_bfi_b32 v223, s59, v137, v136
    ds_write_b128 v205, v[220:223] offset:1280
    v_bfi_b32 v216, s59, v165, v143
    v_bfi_b32 v217, s59, v143, v142
    v_bfi_b32 v218, s59, v142, v141
    v_bfi_b32 v219, s59, v141, v140
    ds_write_b128 v205, v[216:219] offset:0
    v_bfi_b32 v228, s59, v166, v147
    v_bfi_b32 v229, s59, v147, v146
    v_bfi_b32 v230, s59, v146, v145
    v_bfi_b32 v231, s59, v145, v144
    ds_write_b128 v205, v[228:231] offset:3872
    v_bfi_b32 v224, s59, v167, v151
    v_bfi_b32 v225, s59, v151, v150
    v_bfi_b32 v226, s59, v150, v149
    v_bfi_b32 v227, s59, v149, v148
    ds_write_b128 v205, v[224:227] offset:2592
    s_branch L_second_done
L_second_plain:
    ds_write_b128 v204, v[136:139] offset:20736
    ds_write_b128 v204, v[140:143] offset:22016
    ds_write_b128 v204, v[144:147] offset:23328
    ds_write_b128 v204, v[148:151] offset:24608
L_second_done:
    s_mov_b64 exec, 1
    ds_add_u32 v0, v255 offset:42820
    s_mov_b64 exec, -1
    s_waitcnt lgkmcnt(5)
    v_pk_mul_f32 v[176:177], v[176:177], v[8:9]
    v_pk_mul_f32 v[178:179], v[178:179], v[10:11]
    v_pk_mul_f32 v[180:181], v[180:181], v[12:13]
    v_pk_mul_f32 v[182:183], v[182:183], v[14:15]
    v_pk_mul_f32 v[184:185], v[184:185], v[8:9]
    v_pk_mul_f32 v[186:187], v[186:187], v[10:11]
    v_pk_mul_f32 v[188:189], v[188:189], v[12:13]
    v_pk_mul_f32 v[190:191], v[190:191], v[14:15]
    v_cvt_pk_bf16_f32 v160, v176, v177
    v_cvt_pk_bf16_f32 v152, v184, v185
    v_cvt_pk_bf16_f32 v161, v178, v179
    v_cvt_pk_bf16_f32 v153, v186, v187
    v_cvt_pk_bf16_f32 v162, v180, v181
    v_cvt_pk_bf16_f32 v154, v188, v189
    v_cvt_pk_bf16_f32 v163, v182, v183
    v_cvt_pk_bf16_f32 v155, v190, v191
    v_xor_b32 v164, v208, v160
    v_xor_b32 v156, v208, v152
    v_xor_b32 v165, v208, v161
    v_xor_b32 v157, v208, v153
    v_xor_b32 v166, v208, v162
    v_xor_b32 v158, v208, v154
    v_xor_b32 v167, v208, v163
    v_xor_b32 v159, v208, v155
L_sync2:
    ds_read_b32 v1, v0 offset:42820
    s_waitcnt lgkmcnt(0)
    v_readfirstlane_b32 s31, v1
    s_nop 0
    s_cmp_ge_u32 s31, 4
    s_cbranch_scc0 L_sync2
    ds_read_b64_tr_b16 v[120:121], v206 offset:0
    ds_read_b64_tr_b16 v[122:123], v206 offset:10368
    ds_read_b64_tr_b16 v[124:125], v206 offset:20736
    ds_read_b64_tr_b16 v[126:127], v206 offset:31104
    ds_read_b64_tr_b16 v[128:129], v206 offset:32
    ds_read_b64_tr_b16 v[130:131], v206 offset:10400
    ds_read_b64_tr_b16 v[132:133], v206 offset:20768
    ds_read_b64_tr_b16 v[134:135], v206 offset:31136
    ds_read_b64_tr_b16 v[136:137], v206 offset:64
    ds_read_b64_tr_b16 v[138:139], v206 offset:10432
    ds_read_b64_tr_b16 v[140:141], v206 offset:20800
    ds_read_b64_tr_b16 v[142:143], v206 offset:31168
    s_cmp_lg_u32 s50, 0
    s_cbranch_scc1 L_st1_split
    v_mfma_f32_16x16x32_bf16 v[168:171], v[160:163], v[192:195], 0
    v_mfma_f32_16x16x32_bf16 v[168:171], v[152:155], v[196:199], v[168:171]
    s_waitcnt lgkmcnt(10)
    ds_read_b64_tr_b16 v[144:145], v206 offset:96
    ds_read_b64_tr_b16 v[146:147], v206 offset:10464
    ds_read_b64_tr_b16 v[148:149], v206 offset:20832
    ds_read_b64_tr_b16 v[150:151], v206 offset:31200
    v_mfma_f32_16x16x32_bf16 v[216:219], v[160:163], v[120:123], v[168:171]
    s_waitcnt lgkmcnt(12)
    v_mfma_f32_16x16x32_bf16 v[216:219], v[152:155], v[124:127], v[216:219]
    s_waitcnt lgkmcnt(10)
    v_mfma_f32_16x16x32_bf16 v[224:227], v[160:163], v[128:131], v[168:171]
    s_waitcnt lgkmcnt(8)
    v_mfma_f32_16x16x32_bf16 v[224:227], v[152:155], v[132:135], v[224:227]
    s_waitcnt lgkmcnt(6)
    v_mfma_f32_16x16x32_bf16 v[232:235], v[160:163], v[136:139], v[168:171]
    s_waitcnt lgkmcnt(4)
    v_mfma_f32_16x16x32_bf16 v[232:235], v[152:155], v[140:143], v[232:235]
    s_waitcnt lgkmcnt(2)
    v_mfma_f32_16x16x32_bf16 v[240:243], v[160:163], v[144:147], v[168:171]
    s_waitcnt lgkmcnt(0)
    v_mfma_f32_16x16x32_bf16 v[240:243], v[152:155], v[148:151], v[240:243]
    v_mfma_f32_16x16x32_bf16 v[220:223], v[164:167], v[120:123], 0
    v_mfma_f32_16x16x32_bf16 v[220:223], v[156:159], v[124:127], v[220:223]
    v_mfma_f32_16x16x32_bf16 v[228:231], v[164:167], v[128:131], 0
    v_mfma_f32_16x16x32_bf16 v[228:231], v[156:159], v[132:135], v[228:231]
    v_cvt_pk_f16_f32 v176, v216, v217
    v_cvt_pk_f16_f32 v177, v224, v225
    v_cvt_pk_f16_f32 v178, v232, v233
    s_nop 0
    v_cvt_pk_f16_f32 v179, v240, v241
    ds_write_b128 v207, v[176:179] offset:43008
    v_mfma_f32_16x16x32_bf16 v[236:239], v[164:167], v[136:139], 0
    v_mfma_f32_16x16x32_bf16 v[236:239], v[156:159], v[140:143], v[236:239]
    v_cvt_pk_f16_f32 v180, v218, v219
    v_cvt_pk_f16_f32 v181, v226, v227
    v_cvt_pk_f16_f32 v182, v234, v235
    v_cvt_pk_f16_f32 v183, v242, v243
    ds_write_b128 v207, v[180:183] offset:44032
    v_mfma_f32_16x16x32_bf16 v[244:247], v[164:167], v[144:147], 0
    v_mfma_f32_16x16x32_bf16 v[244:247], v[156:159], v[148:151], v[244:247]
    v_cvt_pk_f16_f32 v184, v220, v221
    v_cvt_pk_f16_f32 v185, v228, v229
    v_cvt_pk_f16_f32 v186, v236, v237
    s_nop 4
    v_cvt_pk_f16_f32 v187, v244, v245
    ds_write_b128 v207, v[184:187] offset:45056
    v_cvt_pk_f16_f32 v188, v222, v223
    v_cvt_pk_f16_f32 v189, v230, v231
    v_cvt_pk_f16_f32 v190, v238, v239
    v_cvt_pk_f16_f32 v191, v246, v247
    ds_write_b128 v207, v[188:191] offset:46080
    s_branch L_st1_done
L_st1_split:
    s_waitcnt lgkmcnt(8)
    ds_read_b64_tr_b16 v[144:145], v206 offset:96
    ds_read_b64_tr_b16 v[146:147], v206 offset:10464
    ds_read_b64_tr_b16 v[148:149], v206 offset:20832
    ds_read_b64_tr_b16 v[150:151], v206 offset:31200
    s_waitcnt lgkmcnt(0)
    v_mfma_f32_16x16x32_bf16 v[168:171], v[160:163], v[192:195], 0
    v_mfma_f32_16x16x32_bf16 v[220:223], v[164:167], v[120:123], 0
    v_mfma_f32_16x16x32_bf16 v[216:219], v[160:163], v[120:123], v[168:171]
    v_mfma_f32_16x16x32_bf16 v[228:231], v[164:167], v[128:131], 0
    v_mfma_f32_16x16x32_bf16 v[224:227], v[160:163], v[128:131], v[168:171]
    v_mfma_f32_16x16x32_bf16 v[236:239], v[164:167], v[136:139], 0
    v_mfma_f32_16x16x32_bf16 v[232:235], v[160:163], v[136:139], v[168:171]
    v_mfma_f32_16x16x32_bf16 v[244:247], v[164:167], v[144:147], 0
    v_mfma_f32_16x16x32_bf16 v[240:243], v[160:163], v[144:147], v[168:171]
    s_nop 1
    v_cvt_pk_f16_f32 v176, v216, v217
    v_cvt_pk_f16_f32 v180, v218, v219
    v_cvt_pk_f16_f32 v184, v220, v221
    v_cvt_pk_f16_f32 v188, v222, v223
    v_cvt_pk_f16_f32 v177, v224, v225
    v_cvt_pk_f16_f32 v181, v226, v227
    v_cvt_pk_f16_f32 v185, v228, v229
    v_cvt_pk_f16_f32 v189, v230, v231
    v_cvt_pk_f16_f32 v178, v232, v233
    v_cvt_pk_f16_f32 v182, v234, v235
    v_cvt_pk_f16_f32 v186, v236, v237
    v_cvt_pk_f16_f32 v190, v238, v239
    v_cvt_pk_f16_f32 v179, v240, v241
    v_cvt_pk_f16_f32 v183, v242, v243
    v_cvt_pk_f16_f32 v187, v244, v245
    v_cvt_pk_f16_f32 v191, v246, v247
    ds_write_b128 v207, v[176:179] offset:43008
    ds_write_b128 v207, v[180:183] offset:44032
    ds_write_b128 v207, v[184:187] offset:45056
    ds_write_b128 v207, v[188:191] offset:46080
    v_mfma_f32_16x16x32_bf16 v[168:171], v[152:155], v[196:199], 0
    v_mfma_f32_16x16x32_bf16 v[220:223], v[156:159], v[124:127], 0
    v_mfma_f32_16x16x32_bf16 v[216:219], v[152:155], v[124:127], v[168:171]
    v_mfma_f32_16x16x32_bf16 v[228:231], v[156:159], v[132:135], 0
    v_mfma_f32_16x16x32_bf16 v[224:227], v[152:155], v[132:135], v[168:171]
    v_mfma_f32_16x16x32_bf16 v[236:239], v[156:159], v[140:143], 0
    v_mfma_f32_16x16x32_bf16 v[232:235], v[152:155], v[140:143], v[168:171]
    v_mfma_f32_16x16x32_bf16 v[244:247], v[156:159], v[148:151], 0
    v_mfma_f32_16x16x32_bf16 v[240:243], v[152:155], v[148:151], v[168:171]
    s_waitcnt lgkmcnt(0)
    s_nop 0
    v_cvt_pk_f16_f32 v176, v216, v217
    v_cvt_pk_f16_f32 v180, v218, v219
    v_cvt_pk_f16_f32 v184, v220, v221
    v_cvt_pk_f16_f32 v188, v222, v223
    v_cvt_pk_f16_f32 v177, v224, v225
    v_cvt_pk_f16_f32 v181, v226, v227
    v_cvt_pk_f16_f32 v185, v228, v229
    v_cvt_pk_f16_f32 v189, v230, v231
    v_cvt_pk_f16_f32 v178, v232, v233
    v_cvt_pk_f16_f32 v182, v234, v235
    v_cvt_pk_f16_f32 v186, v236, v237
    v_cvt_pk_f16_f32 v190, v238, v239
    v_cvt_pk_f16_f32 v179, v240, v241
    v_cvt_pk_f16_f32 v183, v242, v243
    v_cvt_pk_f16_f32 v187, v244, v245
    v_cvt_pk_f16_f32 v191, v246, v247
    ds_write_b128 v207, v[176:179] offset:59392
    ds_write_b128 v207, v[180:183] offset:60416
    ds_write_b128 v207, v[184:187] offset:61440
    ds_write_b128 v207, v[188:191] offset:62464
L_st1_done:
    s_mov_b64 exec, 1
    ds_add_u32 v0, v255 offset:42824
    s_mov_b64 exec, -1
    s_lshl_b32 s31, s30, 12
    v_add_u32 v5, s31, v3
    s_and_b32 s31, s28, 0x30003
    v_mov_b32 v210, s31
    s_mov_b32 s58, 0xfffcfffc
L_sync3:
    ds_read_b32 v1, v0 offset:42824
    s_waitcnt lgkmcnt(0)
    v_readfirstlane_b32 s31, v1
    s_nop 0
    s_cmp_ge_u32 s31, 4
    s_cbranch_scc0 L_sync3
L_st23:
    ds_read_b128 v[120:123], v5 offset:43008
    ds_read_b128 v[124:127], v5 offset:44032
    ds_read_b128 v[128:131], v5 offset:45056
    ds_read_b128 v[132:135], v5 offset:46080
    s_add_u32 s61, s60, 33024
    s_add_u32 s62, s61, 33024
    s_add_u32 s63, s62, 33024
    s_waitcnt lgkmcnt(3)
    v_mfma_f32_16x16x32_f16 v[136:139], v[120:123], v[16:19], 0
    v_mfma_f32_16x16x32_f16 v[140:143], v[120:123], v[20:23], 0
    s_waitcnt lgkmcnt(2)
    v_mfma_f32_16x16x32_f16 v[144:147], v[124:127], v[24:27], 0
    v_mfma_f32_16x16x32_f16 v[148:151], v[124:127], v[28:31], 0
    s_nop 3
    v_pk_mul_f32 v[152:153], v[48:49], v[136:137]
    v_pk_mul_f32 v[154:155], v[50:51], v[138:139]
    v_pk_mul_f32 v[156:157], v[52:53], v[136:137]
    v_pk_mul_f32 v[158:159], v[54:55], v[138:139]
    v_pk_fma_f32 v[152:153], v[52:53], v[140:141], v[152:153]
    v_pk_fma_f32 v[156:157], v[48:49], v[140:141], v[156:157] neg_lo:[0,0,1] neg_hi:[0,0,1]
    v_pk_fma_f32 v[154:155], v[54:55], v[142:143], v[154:155]
    v_pk_fma_f32 v[158:159], v[50:51], v[142:143], v[158:159] neg_lo:[0,0,1] neg_hi:[0,0,1]
    v_cvt_pk_f16_f32 v120, v152, v156
    v_cvt_pk_f16_f32 v121, v153, v157
    v_cvt_pk_f16_f32 v122, v154, v158
    v_cvt_pk_f16_f32 v123, v155, v159
    s_waitcnt lgkmcnt(1)
    v_mfma_f32_16x16x32_f16 v[136:139], v[128:131], v[32:35], 0
    v_mfma_f32_16x16x32_f16 v[140:143], v[128:131], v[36:39], 0
    v_mfma_f32_16x16x32_f16 v[216:219], v[80:83], v[120:123], 0
    v_mfma_f32_16x16x32_f16 v[220:223], v[84:87], v[120:123], 0
    v_pk_mul_f32 v[152:153], v[56:57], v[144:145]
    v_pk_mul_f32 v[154:155], v[58:59], v[146:147]
    v_pk_mul_f32 v[156:157], v[60:61], v[144:145]
    v_pk_mul_f32 v[158:159], v[62:63], v[146:147]
    v_pk_fma_f32 v[152:153], v[60:61], v[148:149], v[152:153]
    v_pk_fma_f32 v[156:157], v[56:57], v[148:149], v[156:157] neg_lo:[0,0,1] neg_hi:[0,0,1]
    v_pk_fma_f32 v[154:155], v[62:63], v[150:151], v[154:155]
    v_pk_fma_f32 v[158:159], v[58:59], v[150:151], v[158:159] neg_lo:[0,0,1] neg_hi:[0,0,1]
    v_cvt_pk_f16_f32 v124, v152, v156
    v_cvt_pk_f16_f32 v125, v153, v157
    v_cvt_pk_f16_f32 v126, v154, v158
    v_cvt_pk_f16_f32 v127, v155, v159
    s_waitcnt lgkmcnt(0)
    v_mfma_f32_16x16x32_f16 v[144:147], v[132:135], v[40:43], 0
    v_mfma_f32_16x16x32_f16 v[148:151], v[132:135], v[44:47], 0
    v_mfma_f32_16x16x32_f16 v[224:227], v[80:83], v[124:127], 0
    v_mfma_f32_16x16x32_f16 v[228:231], v[84:87], v[124:127], 0
    v_pk_mul_f32 v[152:153], v[64:65], v[136:137]
    v_pk_mul_f32 v[154:155], v[66:67], v[138:139]
    v_pk_mul_f32 v[156:157], v[68:69], v[136:137]
    v_pk_mul_f32 v[158:159], v[70:71], v[138:139]
    v_pk_fma_f32 v[152:153], v[68:69], v[140:141], v[152:153]
    v_pk_fma_f32 v[156:157], v[64:65], v[140:141], v[156:157] neg_lo:[0,0,1] neg_hi:[0,0,1]
    v_pk_fma_f32 v[154:155], v[70:71], v[142:143], v[154:155]
    v_pk_fma_f32 v[158:159], v[66:67], v[142:143], v[158:159] neg_lo:[0,0,1] neg_hi:[0,0,1]
    v_cvt_pk_f16_f32 v128, v152, v156
    v_cvt_pk_f16_f32 v129, v153, v157
    v_cvt_pk_f16_f32 v130, v154, v158
    v_cvt_pk_f16_f32 v131, v155, v159
    s_nop 1
    v_mfma_f32_16x16x32_f16 v[232:235], v[80:83], v[128:131], 0
    v_mfma_f32_16x16x32_f16 v[236:239], v[84:87], v[128:131], 0
    v_pk_mul_f32 v[152:153], v[72:73], v[144:145]
    v_pk_mul_f32 v[154:155], v[74:75], v[146:147]
    v_pk_mul_f32 v[156:157], v[76:77], v[144:145]
    v_pk_mul_f32 v[158:159], v[78:79], v[146:147]
    v_pk_fma_f32 v[152:153], v[76:77], v[148:149], v[152:153]
    v_pk_fma_f32 v[156:157], v[72:73], v[148:149], v[156:157] neg_lo:[0,0,1] neg_hi:[0,0,1]
    v_pk_fma_f32 v[154:155], v[78:79], v[150:151], v[154:155]
    v_pk_fma_f32 v[158:159], v[74:75], v[150:151], v[158:159] neg_lo:[0,0,1] neg_hi:[0,0,1]
    v_cvt_pk_f16_f32 v132, v152, v156
    v_cvt_pk_f16_f32 v133, v153, v157
    v_cvt_pk_f16_f32 v134, v154, v158
    v_cvt_pk_f16_f32 v135, v155, v159
    s_nop 1
    v_mfma_f32_16x16x32_f16 v[240:243], v[80:83], v[132:135], 0
    v_mfma_f32_16x16x32_f16 v[244:247], v[84:87], v[132:135], 0
    v_cvt_pk_f16_f32 v176, v216, v224
    v_cvt_pk_f16_f32 v178, v220, v228
    v_and_or_b32 v176, v176, s58, v210
    v_and_or_b32 v178, v178, s58, v210
    v_cvt_pk_f16_f32 v180, v217, v225
    v_cvt_pk_f16_f32 v182, v221, v229
    v_and_or_b32 v180, v180, s58, v210
    v_and_or_b32 v182, v182, s58, v210
    v_cvt_pk_f16_f32 v184, v218, v226
    v_cvt_pk_f16_f32 v186, v222, v230
    v_and_or_b32 v184, v184, s58, v210
    v_and_or_b32 v186, v186, s58, v210
    v_cvt_pk_f16_f32 v188, v219, v227
    v_cvt_pk_f16_f32 v190, v223, v231
    v_and_or_b32 v188, v188, s58, v210
    v_and_or_b32 v190, v190, s58, v210
    v_cvt_pk_f16_f32 v177, v232, v240
    v_cvt_pk_f16_f32 v179, v236, v244
    v_and_or_b32 v177, v177, s58, v210
    v_and_or_b32 v179, v179, s58, v210
    v_cvt_pk_f16_f32 v181, v233, v241
    v_cvt_pk_f16_f32 v183, v237, v245
    v_and_or_b32 v181, v181, s58, v210
    v_and_or_b32 v183, v183, s58, v210
    v_cvt_pk_f16_f32 v185, v234, v242
    v_cvt_pk_f16_f32 v187, v238, v246
    v_and_or_b32 v185, v185, s58, v210
    v_and_or_b32 v187, v187, s58, v210
    v_cvt_pk_f16_f32 v189, v235, v243
    v_cvt_pk_f16_f32 v191, v239, v247
    v_and_or_b32 v189, v189, s58, v210
    v_and_or_b32 v191, v191, s58, v210
    s_cmp_eq_u32 s50, 0
    s_cbranch_scc1 L_p1_done
    buffer_store_dwordx4 v[176:179], v209, s[12:15], s60 offen sc1
    buffer_store_dwordx4 v[180:183], v209, s[12:15], s61 offen sc1
    buffer_store_dwordx4 v[184:187], v209, s[12:15], s62 offen sc1
    buffer_store_dwordx4 v[188:191], v209, s[12:15], s63 offen sc1
    s_mov_b32 s50, 0
    s_add_u32 s60, s60, 16384
    v_add_u32 v5, 16384, v5
    s_sub_u32 s31, s48, 4
    v_cvt_f32_i32 v162, s31
    v_mul_f32 v162, 0x3d800000, v162
    v_and_b32 v161, 15, v2
    v_lshlrev_b32 v161, 2, v161
    v_cvt_f32_u32 v161, v161
    v_fma_f32 v160, v212, v161, v162
    v_sin_f32 v84, v160
    v_cos_f32 v160, v160
    s_nop 0
    v_cvt_pk_f16_f32 v80, v160, v84
    v_cvt_pk_f16_f32 v84, -v84, v160
    v_fma_f32 v160, v213, v161, v162
    v_sin_f32 v85, v160
    v_cos_f32 v160, v160
    s_nop 0
    v_cvt_pk_f16_f32 v81, v160, v85
    v_cvt_pk_f16_f32 v85, -v85, v160
    v_fma_f32 v160, v214, v161, v162
    v_sin_f32 v86, v160
    v_cos_f32 v160, v160
    s_nop 0
    v_cvt_pk_f16_f32 v82, v160, v86
    v_cvt_pk_f16_f32 v86, -v86, v160
    v_fma_f32 v160, v215, v161, v162
    v_sin_f32 v87, v160
    v_cos_f32 v160, v160
    s_nop 0
    v_cvt_pk_f16_f32 v83, v160, v87
    v_cvt_pk_f16_f32 v87, -v87, v160
    s_branch L_st23
L_p1_done:
    s_mov_b64 exec, 1
    ds_add_u32 v0, v255 offset:42828
    s_mov_b64 exec, -1
    s_setprio 0
    v_and_b32 v160, 15, v2
    s_lshl_b32 s31, s30, 4
    v_add_u32 v160, s31, v160
    v_cvt_f32_u32 v160, v160
    v_add_f32 v160, 0.5, v160
    v_mul_f32 v160, 0x3b800000, v160
    v_and_b32 v161, 32, v2
    v_bfe_u32 v162, v2, 4, 1
    v_lshl_add_u32 v161, v162, 3, v161
    v_cvt_f32_u32 v161, v161
    v_mul_f32 v161, v161, v160
    v_fmamk_f32 v88, v160, 0x0, v161
    v_fmamk_f32 v162, v160, 0x40000000, v161
    v_sin_f32 v104, v88
    v_sin_f32 v163, v162
    v_cos_f32 v88, v88
    v_cos_f32 v162, v162
    v_cvt_pk_f16_f32 v104, v104, v163
    v_cvt_pk_f16_f32 v88, v88, v162
    v_fmamk_f32 v89, v160, 0x40800000, v161
    v_fmamk_f32 v162, v160, 0x40c00000, v161
    v_sin_f32 v105, v89
    v_sin_f32 v163, v162
    v_cos_f32 v89, v89
    v_cos_f32 v162, v162
    v_cvt_pk_f16_f32 v105, v105, v163
    v_cvt_pk_f16_f32 v89, v89, v162
    v_fmamk_f32 v90, v160, 0x41800000, v161
    v_fmamk_f32 v162, v160, 0x41900000, v161
    v_sin_f32 v106, v90
    v_sin_f32 v163, v162
    v_cos_f32 v90, v90
    v_cos_f32 v162, v162
    v_cvt_pk_f16_f32 v106, v106, v163
    v_cvt_pk_f16_f32 v90, v90, v162
    v_fmamk_f32 v91, v160, 0x41a00000, v161
    v_fmamk_f32 v162, v160, 0x41b00000, v161
    v_sin_f32 v107, v91
    v_sin_f32 v163, v162
    v_cos_f32 v91, v91
    v_cos_f32 v162, v162
    v_cvt_pk_f16_f32 v107, v107, v163
    v_cvt_pk_f16_f32 v91, v91, v162
    v_fmamk_f32 v92, v160, 0x42800000, v161
    v_fmamk_f32 v162, v160, 0x42840000, v161
    v_sin_f32 v108, v92
    v_sin_f32 v163, v162
    v_cos_f32 v92, v92
    v_cos_f32 v162, v162
    v_cvt_pk_f16_f32 v108, v108, v163
    v_cvt_pk_f16_f32 v92, v92, v162
    v_fmamk_f32 v93, v160, 0x42880000, v161
    v_fmamk_f32 v162, v160, 0x428c0000, v161
    v_sin_f32 v109, v93
    v_sin_f32 v163, v162
    v_cos_f32 v93, v93
    v_cos_f32 v162, v162
    v_cvt_pk_f16_f32 v109, v109, v163
    v_cvt_pk_f16_f32 v93, v93, v162
    v_fmamk_f32 v94, v160, 0x42a00000, v161
    v_fmamk_f32 v162, v160, 0x42a40000, v161
    v_sin_f32 v110, v94
    v_sin_f32 v163, v162
    v_cos_f32 v94, v94
    v_cos_f32 v162, v162
    v_cvt_pk_f16_f32 v110, v110, v163
    v_cvt_pk_f16_f32 v94, v94, v162
    v_fmamk_f32 v95, v160, 0x42a80000, v161
    v_fmamk_f32 v162, v160, 0x42ac0000, v161
    v_sin_f32 v111, v95
    v_sin_f32 v163, v162
    v_cos_f32 v95, v95
    v_cos_f32 v162, v162
    v_cvt_pk_f16_f32 v111, v111, v163
    v_cvt_pk_f16_f32 v95, v95, v162
    v_fmamk_f32 v96, v160, 0x3f800000, v161
    v_fmamk_f32 v162, v160, 0x40400000, v161
    v_sin_f32 v112, v96
    v_sin_f32 v163, v162
    v_cos_f32 v96, v96
    v_cos_f32 v162, v162
    v_cvt_pk_f16_f32 v112, v112, v163
    v_cvt_pk_f16_f32 v96, v96, v162
    v_fmamk_f32 v97, v160, 0x40a00000, v161
    v_fmamk_f32 v162, v160, 0x40e00000, v161
    v_sin_f32 v113, v97
    v_sin_f32 v163, v162
    v_cos_f32 v97, v97
    v_cos_f32 v162, v162
    v_cvt_pk_f16_f32 v113, v113, v163
    v_cvt_pk_f16_f32 v97, v97, v162
    v_fmamk_f32 v98, v160, 0x41880000, v161
    v_fmamk_f32 v162, v160, 0x41980000, v161
    v_sin_f32 v114, v98
    v_sin_f32 v163, v162
    v_cos_f32 v98, v98
    v_cos_f32 v162, v162
    v_cvt_pk_f16_f32 v114, v114, v163
    v_cvt_pk_f16_f32 v98, v98, v162
    v_fmamk_f32 v99, v160, 0x41a80000, v161
    v_fmamk_f32 v162, v160, 0x41b80000, v161
    v_sin_f32 v115, v99
    v_sin_f32 v163, v162
    v_cos_f32 v99, v99
    v_cos_f32 v162, v162
    v_cvt_pk_f16_f32 v115, v115, v163
    v_cvt_pk_f16_f32 v99, v99, v162
    v_fmamk_f32 v100, v160, 0x42820000, v161
    v_fmamk_f32 v162, v160, 0x42860000, v161
    v_sin_f32 v116, v100
    v_sin_f32 v163, v162
    v_cos_f32 v100, v100
    v_cos_f32 v162, v162
    v_cvt_pk_f16_f32 v116, v116, v163
    v_cvt_pk_f16_f32 v100, v100, v162
    v_fmamk_f32 v101, v160, 0x428a0000, v161
    v_fmamk_f32 v162, v160, 0x428e0000, v161
    v_sin_f32 v117, v101
    v_sin_f32 v163, v162
    v_cos_f32 v101, v101
    v_cos_f32 v162, v162
    v_cvt_pk_f16_f32 v117, v117, v163
    v_cvt_pk_f16_f32 v101, v101, v162
    v_fmamk_f32 v102, v160, 0x42a20000, v161
    v_fmamk_f32 v162, v160, 0x42a60000, v161
    v_sin_f32 v118, v102
    v_sin_f32 v163, v162
    v_cos_f32 v102, v102
    v_cos_f32 v162, v162
    v_cvt_pk_f16_f32 v118, v118, v163
    v_cvt_pk_f16_f32 v102, v102, v162
    v_fmamk_f32 v103, v160, 0x42aa0000, v161
    v_fmamk_f32 v162, v160, 0x42ae0000, v161
    v_sin_f32 v119, v103
    v_sin_f32 v163, v162
    v_cos_f32 v103, v103
    v_cos_f32 v162, v162
    v_cvt_pk_f16_f32 v119, v119, v163
    v_cvt_pk_f16_f32 v103, v103, v162
    v_cmp_gt_u32 vcc, 16, v2
    v_and_b32 v162, 1, v2
    v_lshlrev_b32 v162, 15, v162
    v_or_b32 v162, 0x3c00, v162
    v_and_b32 v160, 0xffff0000, v104
    v_or_b32 v162, v162, v160
    v_cndmask_b32 v104, v104, v162, vcc
L_sync4:
    ds_read_b32 v1, v0 offset:42860
    s_waitcnt lgkmcnt(0)
    v_readfirstlane_b32 s31, v1
    s_nop 0
    s_cmp_ge_u32 s31, 1
    s_cbranch_scc0 L_sync4
    buffer_store_dwordx4 v[176:179], v209, s[12:15], s60 offen sc1
    buffer_store_dwordx4 v[180:183], v209, s[12:15], s61 offen sc1
    buffer_store_dwordx4 v[184:187], v209, s[12:15], s62 offen sc1
    buffer_store_dwordx4 v[188:191], v209, s[12:15], s63 offen sc1
    s_and_b32 s46, s2, 7
    s_lshr_b32 s47, s2, 3
    s_mov_b32 s48, 0x200000
    v_and_b32 v248, 15, v2
    s_lshl_b32 s31, s30, 7
    s_add_u32 s31, s31, s46
    v_lshl_add_u32 v248, v248, 3, s31
    s_lshl_b32 s31, s46, 1
    s_add_u32 s31, s31, 1016
    v_sub_u32 v249, s31, v248
    v_and_b32 v6, 48, v2
    s_lshl_b32 s31, s47, 6
    v_add_u32 v6, s31, v6
    v_lshl_add_u32 v4, v248, 11, v6
    v_lshl_add_u32 v5, v249, 11, v6
    s_mov_b32 s49, 32768
    s_mov_b32 vcc_lo, 0
    s_mov_b32 vcc_hi, -1
    v_cndmask_b32 v7, v248, v249, vcc
    v_and_b32 v6, 255, v7
    v_lshlrev_b32 v6, 7, v6
    v_lshrrev_b32 v7, 8, v7
    v_lshl_add_u32 v6, v7, 4, v6
    v_and_b32 v7, 16, v2
    v_lshl_add_u32 v6, v7, 2, v6
    buffer_load_dwordx4 v[24:27], v6, s[12:15], s49 offen
    v_lshrrev_b32 v7, 2, v2
    s_lshl_b32 s31, s30, 7
    s_add_u32 s31, s31, s46
    v_lshl_add_u32 v7, v7, 3, s31
    s_lshl_b32 s31, s46, 1
    s_add_u32 s31, s31, 1016
    v_sub_u32 v40, s31, v7
    v_and_b32 v1, 48, v3
    v_and_b32 v41, 32, v2
    v_xor_b32 v1, v1, v41
    s_lshl_b32 s31, s47, 6
    v_add_u32 v1, s31, v1
    v_lshl_add_u32 v7, v7, 11, v1
    v_lshl_add_u32 v40, v40, 11, v1
    s_lshl_b32 s52, s30, 12
    s_add_u32 s52, s52, 43008
    v_and_b32 v1, 15, v2
    v_lshlrev_b32 v41, 6, v1
    v_and_b32 v1, 8, v2
    v_lshlrev_b32 v1, 2, v1
    v_and_b32 v42, 48, v2
    v_xor_b32 v1, v1, v42
    v_add3_u32 v41, v41, v1, s52
L_sync5:
    ds_read_b32 v1, v0 offset:42848
    s_waitcnt lgkmcnt(0)
    v_readfirstlane_b32 s31, v1
    s_nop 0
    s_cmp_ge_u32 s31, 4
    s_cbranch_scc0 L_sync5
    s_add_u32 m0, s52, 0
    s_nop 0
    buffer_load_dwordx4 v7, s[8:11], 0 offen lds
    s_add_u32 m0, s52, 1024
    s_nop 0
    buffer_load_dwordx4 v7, s[8:11], s48 offen lds
    s_add_u32 m0, s52, 2048
    s_nop 0
    buffer_load_dwordx4 v40, s[8:11], 0 offen lds
    s_add_u32 m0, s52, 3072
    s_nop 0
    buffer_load_dwordx4 v40, s[8:11], s48 offen lds
    s_lshl_b32 s31, s46, 5
    s_add_u32 s31, s31, s47
    s_mul_i32 s31, s31, 16512
    s_add_u32 s51, s31, 2097152
    s_lshl_b32 s32, s30, 12
    s_add_u32 s50, s51, s32
    s_add_u32 s51, s51, 16384
    v_add_u32 v250, s32, v3
    v_lshrrev_b32 v251, 5, v2
    v_lshlrev_b32 v251, 11, v251
    v_bfe_u32 v1, v2, 2, 3
    v_lshl_add_u32 v251, v1, 7, v251
    v_and_b32 v1, 3, v2
    v_lshl_add_u32 v251, v1, 5, v251
    v_bfe_u32 v1, v2, 3, 1
    v_lshl_add_u32 v251, v1, 4, v251
    v_bfe_u32 v1, v2, 4, 1
    v_lshl_add_u32 v251, v1, 3, v251
    v_xor_b32 v252, 16, v251
    v_xor_b32 v253, 8, v251
    v_xor_b32 v254, 24, v251
    v_cmp_gt_u32 vcc, 4, v2
    v_mov_b32 v1, 16384
    s_nop 0
    v_cndmask_b32 v1, v0, v1, vcc
    v_add_u32 v208, v253, v1
    v_add_u32 v209, v254, v1
    s_waitcnt vmcnt(4)
L_stat_check:
    v_cmp_ne_u64 vcc, s[28:29], v[26:27]
    s_nop 0
    s_cbranch_vccz L_stat_got
    s_cmp_eq_u32 s35, 0
    s_cbranch_scc1 L_stat_got
    s_sub_u32 s35, s35, 1
    s_sleep 2
    s_mov_b64 exec, vcc
    buffer_load_dwordx4 v[24:27], v6, s[12:15], s49 offen sc1
    s_mov_b64 exec, -1
    s_waitcnt vmcnt(0)
    s_branch L_stat_check
L_stat_got:
    v_mov_b32 v32, v24
    s_nop 1
    v_permlane32_swap_b32 v24, v32
    v_mov_b32 v28, v24
    v_mov_b32 v36, v32
    s_nop 0
    v_permlane16_swap_b32 v24, v28
    v_permlane16_swap_b32 v32, v36
    v_lshlrev_b32 v26, 16, v24
    v_and_b32 v24, 0xffff0000, v24
    v_rcp_f32 v24, v24
    v_lshlrev_b32 v30, 16, v28
    v_and_b32 v28, 0xffff0000, v28
    v_rcp_f32 v28, v28
    v_lshlrev_b32 v34, 16, v32
    v_and_b32 v32, 0xffff0000, v32
    v_rcp_f32 v32, v32
    v_lshlrev_b32 v38, 16, v36
    v_and_b32 v36, 0xffff0000, v36
    v_rcp_f32 v36, v36
    v_mul_f32_e64 v26, -v26, v24
    v_mul_f32 v152, 0xbfb8aa3b, v24
    v_mul_f32 v154, 0xbfb8aa3b, v26
    v_mul_f32_e64 v30, -v30, v28
    v_mul_f32 v156, 0xbfb8aa3b, v28
    v_mul_f32 v158, 0xbfb8aa3b, v30
    v_mul_f32_e64 v34, -v34, v32
    v_mul_f32 v160, 0xbfb8aa3b, v32
    v_mul_f32 v162, 0xbfb8aa3b, v34
    v_mul_f32_e64 v38, -v38, v36
    v_mul_f32 v164, 0xbfb8aa3b, v36
    v_mul_f32 v166, 0xbfb8aa3b, v38
    s_waitcnt vmcnt(0)
    ds_read_b128 v[8:11], v41 offset:0
    ds_read_b128 v[12:15], v41 offset:1024
    ds_read_b128 v[16:19], v41 offset:2048
    ds_read_b128 v[20:23], v41 offset:3072
    s_waitcnt lgkmcnt(0)
    v_mov_b32 v212, v210
    v_mov_b32 v213, v210
    v_mov_b32 v214, v210
    v_mov_b32 v215, v210
    v_lshlrev_b32 v40, 16, v8
    v_and_b32 v41, 0xffff0000, v8
    v_lshlrev_b32 v42, 16, v9
    v_and_b32 v43, 0xffff0000, v9
    v_lshlrev_b32 v44, 16, v10
    v_and_b32 v45, 0xffff0000, v10
    v_lshlrev_b32 v46, 16, v11
    v_and_b32 v47, 0xffff0000, v11
    v_lshlrev_b32 v48, 16, v12
    v_and_b32 v49, 0xffff0000, v12
    v_lshlrev_b32 v50, 16, v13
    v_and_b32 v51, 0xffff0000, v13
    v_lshlrev_b32 v52, 16, v14
    v_and_b32 v53, 0xffff0000, v14
    v_lshlrev_b32 v54, 16, v15
    v_and_b32 v55, 0xffff0000, v15
    v_pk_fma_f32 v[216:217], v[40:41], v[152:153], v[154:155] op_sel_hi:[1,0,0]
    v_pk_fma_f32 v[218:219], v[42:43], v[152:153], v[154:155] op_sel_hi:[1,0,0]
    v_pk_fma_f32 v[220:221], v[44:45], v[152:153], v[154:155] op_sel_hi:[1,0,0]
    v_pk_fma_f32 v[222:223], v[46:47], v[152:153], v[154:155] op_sel_hi:[1,0,0]
    v_pk_fma_f32 v[224:225], v[48:49], v[156:157], v[158:159] op_sel_hi:[1,0,0]
    v_pk_fma_f32 v[226:227], v[50:51], v[156:157], v[158:159] op_sel_hi:[1,0,0]
    v_pk_fma_f32 v[228:229], v[52:53], v[156:157], v[158:159] op_sel_hi:[1,0,0]
    v_pk_fma_f32 v[230:231], v[54:55], v[156:157], v[158:159] op_sel_hi:[1,0,0]
    v_exp_f32 v216, v216
    v_exp_f32 v217, v217
    v_exp_f32 v218, v218
    v_exp_f32 v219, v219
    v_exp_f32 v220, v220
    v_exp_f32 v221, v221
    v_exp_f32 v222, v222
    v_exp_f32 v223, v223
    v_exp_f32 v224, v224
    v_exp_f32 v225, v225
    v_exp_f32 v226, v226
    v_exp_f32 v227, v227
    v_exp_f32 v228, v228
    v_exp_f32 v229, v229
    v_exp_f32 v230, v230
    v_exp_f32 v231, v231
    v_pk_fma_f32 v[120:121], v[40:41], v[24:25], v[26:27] op_sel_hi:[1,0,0]
    v_pk_fma_f32 v[122:123], v[42:43], v[24:25], v[26:27] op_sel_hi:[1,0,0]
    v_pk_fma_f32 v[124:125], v[44:45], v[24:25], v[26:27] op_sel_hi:[1,0,0]
    v_pk_fma_f32 v[126:127], v[46:47], v[24:25], v[26:27] op_sel_hi:[1,0,0]
    v_pk_fma_f32 v[128:129], v[48:49], v[28:29], v[30:31] op_sel_hi:[1,0,0]
    v_pk_fma_f32 v[130:131], v[50:51], v[28:29], v[30:31] op_sel_hi:[1,0,0]
    v_pk_fma_f32 v[132:133], v[52:53], v[28:29], v[30:31] op_sel_hi:[1,0,0]
    v_pk_fma_f32 v[134:135], v[54:55], v[28:29], v[30:31] op_sel_hi:[1,0,0]
    v_pk_add_f32 v[216:217], v[216:217], 1.0 op_sel_hi:[1,0]
    v_pk_add_f32 v[218:219], v[218:219], 1.0 op_sel_hi:[1,0]
    v_pk_add_f32 v[220:221], v[220:221], 1.0 op_sel_hi:[1,0]
    v_pk_add_f32 v[222:223], v[222:223], 1.0 op_sel_hi:[1,0]
    v_pk_add_f32 v[224:225], v[224:225], 1.0 op_sel_hi:[1,0]
    v_pk_add_f32 v[226:227], v[226:227], 1.0 op_sel_hi:[1,0]
    v_pk_add_f32 v[228:229], v[228:229], 1.0 op_sel_hi:[1,0]
    v_pk_add_f32 v[230:231], v[230:231], 1.0 op_sel_hi:[1,0]
    v_rcp_f32 v216, v216
    v_rcp_f32 v217, v217
    v_rcp_f32 v218, v218
    v_rcp_f32 v219, v219
    v_rcp_f32 v220, v220
    v_rcp_f32 v221, v221
    v_rcp_f32 v222, v222
    v_rcp_f32 v223, v223
    v_rcp_f32 v224, v224
    v_rcp_f32 v225, v225
    v_rcp_f32 v226, v226
    v_rcp_f32 v227, v227
    v_rcp_f32 v228, v228
    v_rcp_f32 v229, v229
    v_rcp_f32 v230, v230
    v_rcp_f32 v231, v231
    v_pk_mul_f32 v[120:121], v[120:121], v[216:217]
    v_pk_mul_f32 v[122:123], v[122:123], v[218:219]
    v_pk_mul_f32 v[124:125], v[124:125], v[220:221]
    v_pk_mul_f32 v[126:127], v[126:127], v[222:223]
    v_pk_mul_f32 v[128:129], v[128:129], v[224:225]
    v_pk_mul_f32 v[130:131], v[130:131], v[226:227]
    v_pk_mul_f32 v[132:133], v[132:133], v[228:229]
    v_pk_mul_f32 v[134:135], v[134:135], v[230:231]
L_sync6:
    ds_read_b32 v1, v0 offset:42852
    s_waitcnt lgkmcnt(0)
    v_readfirstlane_b32 s31, v1
    s_nop 0
    s_cmp_ge_u32 s31, 4
    s_cbranch_scc0 L_sync6
    buffer_load_dwordx4 v[72:75], v3, s[12:15], s50 offen offset:0 sc1
    buffer_load_dwordx4 v[76:79], v3, s[12:15], s50 offen offset:1024 sc1
    buffer_load_dwordx4 v[80:83], v3, s[12:15], s50 offen offset:2048 sc1
    buffer_load_dwordx4 v[84:87], v3, s[12:15], s50 offen offset:3072 sc1
    s_mov_b64 exec, 0xff
    buffer_load_dwordx4 v[212:215], v3, s[12:15], s51 offen sc1
    s_mov_b64 exec, -1
    v_lshlrev_b32 v56, 16, v16
    v_and_b32 v57, 0xffff0000, v16
    v_lshlrev_b32 v58, 16, v17
    v_and_b32 v59, 0xffff0000, v17
    v_lshlrev_b32 v60, 16, v18
    v_and_b32 v61, 0xffff0000, v18
    v_lshlrev_b32 v62, 16, v19
    v_and_b32 v63, 0xffff0000, v19
    v_lshlrev_b32 v64, 16, v20
    v_and_b32 v65, 0xffff0000, v20
    v_lshlrev_b32 v66, 16, v21
    v_and_b32 v67, 0xffff0000, v21
    v_lshlrev_b32 v68, 16, v22
    v_and_b32 v69, 0xffff0000, v22
    v_lshlrev_b32 v70, 16, v23
    v_and_b32 v71, 0xffff0000, v23
    v_pk_fma_f32 v[232:233], v[56:57], v[160:161], v[162:163] op_sel_hi:[1,0,0]
    v_pk_fma_f32 v[234:235], v[58:59], v[160:161], v[162:163] op_sel_hi:[1,0,0]
    v_pk_fma_f32 v[236:237], v[60:61], v[160:161], v[162:163] op_sel_hi:[1,0,0]
    v_pk_fma_f32 v[238:239], v[62:63], v[160:161], v[162:163] op_sel_hi:[1,0,0]
    v_pk_fma_f32 v[240:241], v[64:65], v[164:165], v[166:167] op_sel_hi:[1,0,0]
    v_pk_fma_f32 v[242:243], v[66:67], v[164:165], v[166:167] op_sel_hi:[1,0,0]
    v_pk_fma_f32 v[244:245], v[68:69], v[164:165], v[166:167] op_sel_hi:[1,0,0]
    v_pk_fma_f32 v[246:247], v[70:71], v[164:165], v[166:167] op_sel_hi:[1,0,0]
    v_exp_f32 v232, v232
    v_exp_f32 v233, v233
    v_exp_f32 v234, v234
    v_exp_f32 v235, v235
    v_exp_f32 v236, v236
    v_exp_f32 v237, v237
    v_exp_f32 v238, v238
    v_exp_f32 v239, v239
    v_exp_f32 v240, v240
    v_exp_f32 v241, v241
    v_exp_f32 v242, v242
    v_exp_f32 v243, v243
    v_exp_f32 v244, v244
    v_exp_f32 v245, v245
    v_exp_f32 v246, v246
    v_exp_f32 v247, v247
    v_pk_fma_f32 v[136:137], v[56:57], v[32:33], v[34:35] op_sel_hi:[1,0,0]
    v_pk_fma_f32 v[138:139], v[58:59], v[32:33], v[34:35] op_sel_hi:[1,0,0]
    v_pk_fma_f32 v[140:141], v[60:61], v[32:33], v[34:35] op_sel_hi:[1,0,0]
    v_pk_fma_f32 v[142:143], v[62:63], v[32:33], v[34:35] op_sel_hi:[1,0,0]
    v_pk_fma_f32 v[144:145], v[64:65], v[36:37], v[38:39] op_sel_hi:[1,0,0]
    v_pk_fma_f32 v[146:147], v[66:67], v[36:37], v[38:39] op_sel_hi:[1,0,0]
    v_pk_fma_f32 v[148:149], v[68:69], v[36:37], v[38:39] op_sel_hi:[1,0,0]
    v_pk_fma_f32 v[150:151], v[70:71], v[36:37], v[38:39] op_sel_hi:[1,0,0]
    v_pk_add_f32 v[232:233], v[232:233], 1.0 op_sel_hi:[1,0]
    v_pk_add_f32 v[234:235], v[234:235], 1.0 op_sel_hi:[1,0]
    v_pk_add_f32 v[236:237], v[236:237], 1.0 op_sel_hi:[1,0]
    v_pk_add_f32 v[238:239], v[238:239], 1.0 op_sel_hi:[1,0]
    v_pk_add_f32 v[240:241], v[240:241], 1.0 op_sel_hi:[1,0]
    v_pk_add_f32 v[242:243], v[242:243], 1.0 op_sel_hi:[1,0]
    v_pk_add_f32 v[244:245], v[244:245], 1.0 op_sel_hi:[1,0]
    v_pk_add_f32 v[246:247], v[246:247], 1.0 op_sel_hi:[1,0]
    v_rcp_f32 v232, v232
    v_rcp_f32 v233, v233
    v_rcp_f32 v234, v234
    v_rcp_f32 v235, v235
    v_rcp_f32 v236, v236
    v_rcp_f32 v237, v237
    v_rcp_f32 v238, v238
    v_rcp_f32 v239, v239
    v_rcp_f32 v240, v240
    v_rcp_f32 v241, v241
    v_rcp_f32 v242, v242
    v_rcp_f32 v243, v243
    v_rcp_f32 v244, v244
    v_rcp_f32 v245, v245
    v_rcp_f32 v246, v246
    v_rcp_f32 v247, v247
    v_pk_mul_f32 v[136:137], v[136:137], v[232:233]
    v_pk_mul_f32 v[138:139], v[138:139], v[234:235]
    v_pk_mul_f32 v[140:141], v[140:141], v[236:237]
    v_pk_mul_f32 v[142:143], v[142:143], v[238:239]
    v_pk_mul_f32 v[144:145], v[144:145], v[240:241]
    v_pk_mul_f32 v[146:147], v[146:147], v[242:243]
    v_pk_mul_f32 v[148:149], v[148:149], v[244:245]
    v_pk_mul_f32 v[150:151], v[150:151], v[246:247]
L_sync7:
    ds_read_b32 v1, v0 offset:42840
    s_waitcnt lgkmcnt(0)
    v_readfirstlane_b32 s31, v1
    s_nop 0
    s_cmp_ge_u32 s31, 1
    s_cbranch_scc0 L_sync7
L_z_wait:
    s_setprio 1
    s_waitcnt vmcnt(4)
    v_xor_b32 v152, v210, v72
    v_xor_b32 v153, v210, v73
    v_xor_b32 v154, v210, v74
    v_xor_b32 v155, v210, v75
    ds_write_b128 v250, v[152:155] offset:0
    v_or3_b32 v1, v152, v153, v154
    v_or_b32 v1, v1, v155
    s_waitcnt vmcnt(3)
    v_xor_b32 v156, v210, v76
    v_xor_b32 v157, v210, v77
    v_xor_b32 v158, v210, v78
    v_xor_b32 v159, v210, v79
    ds_write_b128 v250, v[156:159] offset:1024
    v_or3_b32 v1, v1, v156, v157
    v_or3_b32 v1, v1, v158, v159
    s_waitcnt vmcnt(2)
    v_xor_b32 v160, v210, v80
    v_xor_b32 v161, v210, v81
    v_xor_b32 v162, v210, v82
    v_xor_b32 v163, v210, v83
    ds_write_b128 v250, v[160:163] offset:2048
    v_or3_b32 v1, v1, v160, v161
    v_or3_b32 v1, v1, v162, v163
    s_waitcnt vmcnt(1)
    v_xor_b32 v164, v210, v84
    v_xor_b32 v165, v210, v85
    v_xor_b32 v166, v210, v86
    v_xor_b32 v167, v210, v87
    ds_write_b128 v250, v[164:167] offset:3072
    v_or3_b32 v1, v1, v164, v165
    v_or3_b32 v1, v1, v166, v167
    s_waitcnt vmcnt(0)
    v_xor_b32 v168, v210, v212
    v_xor_b32 v169, v210, v213
    v_xor_b32 v170, v210, v214
    v_xor_b32 v171, v210, v215
    s_mov_b64 exec, 0xff
    ds_write_b128 v3, v[168:171] offset:16384
    s_mov_b64 exec, -1
    v_or3_b32 v1, v1, v168, v169
    v_or3_b32 v1, v1, v170, v171
    v_and_b32 v1, 0x30003, v1
    v_cmp_ne_u32 vcc, 0, v1
    s_nop 0
    s_cbranch_vccz L_z_got
    s_cmp_eq_u32 s35, 0
    s_cbranch_scc1 L_z_got
    s_sub_u32 s35, s35, 1
    s_sleep 2
    s_mov_b64 exec, vcc
    buffer_load_dwordx4 v[72:75], v3, s[12:15], s50 offen offset:0 sc1
    buffer_load_dwordx4 v[76:79], v3, s[12:15], s50 offen offset:1024 sc1
    buffer_load_dwordx4 v[80:83], v3, s[12:15], s50 offen offset:2048 sc1
    buffer_load_dwordx4 v[84:87], v3, s[12:15], s50 offen offset:3072 sc1
    s_mov_b64 exec, 0xff
    buffer_load_dwordx4 v[212:215], v3, s[12:15], s51 offen sc1
    s_mov_b64 exec, -1
    s_waitcnt lgkmcnt(0)
    s_branch L_z_wait
L_z_got:
    s_mov_b64 exec, 1
    ds_add_u32 v0, v255 offset:42832
    s_mov_b64 exec, -1
L_sync8:
    ds_read_b32 v1, v0 offset:42832
    s_waitcnt lgkmcnt(0)
    v_readfirstlane_b32 s31, v1
    s_nop 0
    s_cmp_ge_u32 s31, 4
    s_cbranch_scc0 L_sync8
    ds_read_b64 v[6:7], v0 offset:41552
    ds_read_b64_tr_b16 v[152:153], v251 offset:0
    ds_read_b64_tr_b16 v[154:155], v251 offset:1024
    ds_read_b64_tr_b16 v[156:157], v252 offset:0
    ds_read_b64_tr_b16 v[158:159], v252 offset:1024
    ds_read_b64_tr_b16 v[160:161], v251 offset:4096
    ds_read_b64_tr_b16 v[162:163], v251 offset:5120
    ds_read_b64_tr_b16 v[164:165], v252 offset:4096
    ds_read_b64_tr_b16 v[166:167], v252 offset:5120
    ds_read_b64_tr_b16 v[168:169], v251 offset:8192
    ds_read_b64_tr_b16 v[170:171], v251 offset:9216
    ds_read_b64_tr_b16 v[172:173], v252 offset:8192
    ds_read_b64_tr_b16 v[174:175], v252 offset:9216
    s_waitcnt lgkmcnt(10)
    v_mfma_f32_16x16x32_f16 v[216:219], v[152:155], v[88:91], 0
    s_waitcnt lgkmcnt(8)
    v_mfma_f32_16x16x32_f16 v[220:223], v[156:159], v[88:91], 0
    ds_read_b64_tr_b16 v[176:177], v251 offset:12288
    ds_read_b64_tr_b16 v[178:179], v251 offset:13312
    ds_read_b64_tr_b16 v[180:181], v252 offset:12288
    ds_read_b64_tr_b16 v[182:183], v252 offset:13312
    s_waitcnt lgkmcnt(10)
    v_mfma_f32_16x16x32_f16 v[216:219], v[160:163], v[92:95], v[216:219]
    s_waitcnt lgkmcnt(8)
    v_mfma_f32_16x16x32_f16 v[220:223], v[164:167], v[92:95], v[220:223]
    ds_read_b64_tr_b16 v[152:153], v208 offset:0
    ds_read_b64_tr_b16 v[154:155], v253 offset:1024
    ds_read_b64_tr_b16 v[156:157], v209 offset:0
    ds_read_b64_tr_b16 v[158:159], v254 offset:1024
    v_readfirstlane_b32 s33, v7
    v_and_b32 v6, 48, v2
    v_lshlrev_b32 v6, 1, v6
    s_waitcnt lgkmcnt(10)
    v_mfma_f32_16x16x32_f16 v[224:227], v[168:171], v[96:99], 0
    s_waitcnt lgkmcnt(8)
    v_mfma_f32_16x16x32_f16 v[228:231], v[172:175], v[96:99], 0
    ds_read_b64_tr_b16 v[160:161], v253 offset:4096
    ds_read_b64_tr_b16 v[162:163], v253 offset:5120
    ds_read_b64_tr_b16 v[164:165], v254 offset:4096
    ds_read_b64_tr_b16 v[166:167], v254 offset:5120
    s_andn2_b32 s51, 0x7ff, s33
    s_sub_u32 s31, s51, 1024
    s_waitcnt lgkmcnt(10)
    v_mfma_f32_16x16x32_f16 v[224:227], v[176:179], v[100:103], v[224:227]
    s_waitcnt lgkmcnt(8)
    v_mfma_f32_16x16x32_f16 v[228:231], v[180:183], v[100:103], v[228:231]
    ds_read_b64_tr_b16 v[168:169], v253 offset:8192
    ds_read_b64_tr_b16 v[170:171], v253 offset:9216
    ds_read_b64_tr_b16 v[172:173], v254 offset:8192
    ds_read_b64_tr_b16 v[174:175], v254 offset:9216
    v_cmp_ne_u32 s[54:55], s51, v248
    v_cmp_ne_u32 s[56:57], s31, v248
    s_waitcnt lgkmcnt(10)
    v_mfma_f32_16x16x32_f16 v[232:235], v[152:155], v[104:107], 0
    s_waitcnt lgkmcnt(8)
    v_mfma_f32_16x16x32_f16 v[236:239], v[156:159], v[104:107], 0
    ds_read_b64_tr_b16 v[176:177], v253 offset:12288
    ds_read_b64_tr_b16 v[178:179], v253 offset:13312
    ds_read_b64_tr_b16 v[180:181], v254 offset:12288
    ds_read_b64_tr_b16 v[182:183], v254 offset:13312
    v_cmp_ne_u32 s[58:59], s51, v249
    v_cmp_ne_u32 s[60:61], s31, v249
    s_waitcnt lgkmcnt(10)
    v_mfma_f32_16x16x32_f16 v[232:235], v[160:163], v[108:111], v[232:235]
    s_waitcnt lgkmcnt(8)
    v_mfma_f32_16x16x32_f16 v[236:239], v[164:167], v[108:111], v[236:239]
    v_pk_add_f32 v[72:73], v[216:217], v[224:225]
    v_pk_add_f32 v[80:81], v[216:217], v[224:225] neg_lo:[0,1] neg_hi:[0,1]
    v_pk_add_f32 v[74:75], v[218:219], v[226:227]
    v_pk_add_f32 v[82:83], v[218:219], v[226:227] neg_lo:[0,1] neg_hi:[0,1]
    s_waitcnt lgkmcnt(6)
    v_mfma_f32_16x16x32_f16 v[240:243], v[168:171], v[112:115], 0
    s_waitcnt lgkmcnt(4)
    v_mfma_f32_16x16x32_f16 v[244:247], v[172:175], v[112:115], 0
    v_pk_add_f32 v[76:77], v[220:221], v[228:229]
    v_pk_add_f32 v[84:85], v[220:221], v[228:229] neg_lo:[0,1] neg_hi:[0,1]
    v_pk_add_f32 v[78:79], v[222:223], v[230:231]
    v_pk_add_f32 v[86:87], v[222:223], v[230:231] neg_lo:[0,1] neg_hi:[0,1]
    s_waitcnt lgkmcnt(2)
    v_mfma_f32_16x16x32_f16 v[240:243], v[176:179], v[116:119], v[240:243]
    s_waitcnt lgkmcnt(0)
    v_mfma_f32_16x16x32_f16 v[244:247], v[180:183], v[116:119], v[244:247]
    s_nop 5
    v_pk_add_f32 v[216:217], v[232:233], v[240:241]
    v_pk_add_f32 v[224:225], v[232:233], v[240:241] neg_lo:[0,1] neg_hi:[0,1]
    v_pk_add_f32 v[218:219], v[234:235], v[242:243]
    v_pk_add_f32 v[226:227], v[234:235], v[242:243] neg_lo:[0,1] neg_hi:[0,1]
    v_pk_add_f32 v[220:221], v[236:237], v[244:245]
    v_pk_add_f32 v[228:229], v[236:237], v[244:245] neg_lo:[0,1] neg_hi:[0,1]
    v_pk_add_f32 v[222:223], v[238:239], v[246:247]
    v_pk_add_f32 v[230:231], v[238:239], v[246:247] neg_lo:[0,1] neg_hi:[0,1]
    v_pk_add_f32 v[152:153], v[72:73], v[216:217]
    v_pk_add_f32 v[154:155], v[74:75], v[218:219]
    v_pk_add_f32 v[156:157], v[76:77], v[220:221]
    v_pk_add_f32 v[158:159], v[78:79], v[222:223]
    v_pk_fma_f32 v[40:41], v[152:153], v[120:121], v[40:41]
    v_pk_fma_f32 v[42:43], v[154:155], v[122:123], v[42:43]
    v_pk_fma_f32 v[44:45], v[156:157], v[124:125], v[44:45]
    v_pk_fma_f32 v[46:47], v[158:159], v[126:127], v[46:47]
    v_cvt_pk_bf16_f32 v8, v40, v41
    v_cvt_pk_bf16_f32 v9, v42, v43
    v_cvt_pk_bf16_f32 v10, v44, v45
    v_cvt_pk_bf16_f32 v11, v46, v47
    s_mov_b64 exec, s[54:55]
    buffer_store_dwordx4 v[8:11], v4, s[16:19], 0 offen sc1
    s_not_b64 exec, exec
    s_cbranch_scc0 L_nodump0
    ds_write_b128 v6, v[152:155] offset:42496
    ds_write_b128 v6, v[156:159] offset:42512
    s_mov_b64 exec, 1
    ds_add_u32 v0, v255 offset:42836
    s_mov_b64 exec, -1
L_nodump0:
    s_mov_b64 exec, -1
    v_pk_add_f32 v[160:161], v[80:81], v[224:225]
    v_pk_add_f32 v[162:163], v[82:83], v[226:227]
    v_pk_add_f32 v[164:165], v[84:85], v[228:229]
    v_pk_add_f32 v[166:167], v[86:87], v[230:231]
    v_pk_fma_f32 v[48:49], v[160:161], v[128:129], v[48:49]
    v_pk_fma_f32 v[50:51], v[162:163], v[130:131], v[50:51]
    v_pk_fma_f32 v[52:53], v[164:165], v[132:133], v[52:53]
    v_pk_fma_f32 v[54:55], v[166:167], v[134:135], v[54:55]
    v_cvt_pk_bf16_f32 v12, v48, v49
    v_cvt_pk_bf16_f32 v13, v50, v51
    v_cvt_pk_bf16_f32 v14, v52, v53
    v_cvt_pk_bf16_f32 v15, v54, v55
    s_mov_b64 exec, s[56:57]
    buffer_store_dwordx4 v[12:15], v4, s[16:19], s48 offen sc1
    s_not_b64 exec, exec
    s_cbranch_scc0 L_nodump1
    ds_write_b128 v6, v[160:163] offset:42496
    ds_write_b128 v6, v[164:167] offset:42512
    s_mov_b64 exec, 1
    ds_add_u32 v0, v255 offset:42836
    s_mov_b64 exec, -1
L_nodump1:
    s_mov_b64 exec, -1
    v_pk_add_f32 v[168:169], v[80:81], v[224:225] neg_lo:[0,1] neg_hi:[0,1]
    v_pk_add_f32 v[170:171], v[82:83], v[226:227] neg_lo:[0,1] neg_hi:[0,1]
    v_pk_add_f32 v[172:173], v[84:85], v[228:229] neg_lo:[0,1] neg_hi:[0,1]
    v_pk_add_f32 v[174:175], v[86:87], v[230:231] neg_lo:[0,1] neg_hi:[0,1]
    v_pk_fma_f32 v[56:57], v[168:169], v[136:137], v[56:57]
    v_pk_fma_f32 v[58:59], v[170:171], v[138:139], v[58:59]
    v_pk_fma_f32 v[60:61], v[172:173], v[140:141], v[60:61]
    v_pk_fma_f32 v[62:63], v[174:175], v[142:143], v[62:63]
    v_cvt_pk_bf16_f32 v16, v56, v57
    v_cvt_pk_bf16_f32 v17, v58, v59
    v_cvt_pk_bf16_f32 v18, v60, v61
    v_cvt_pk_bf16_f32 v19, v62, v63
    s_mov_b64 exec, s[58:59]
    buffer_store_dwordx4 v[16:19], v5, s[16:19], 0 offen sc1
    s_not_b64 exec, exec
    s_cbranch_scc0 L_nodump2
    ds_write_b128 v6, v[168:171] offset:42496
    ds_write_b128 v6, v[172:175] offset:42512
    s_mov_b64 exec, 1
    ds_add_u32 v0, v255 offset:42836
    s_mov_b64 exec, -1
L_nodump2:
    s_mov_b64 exec, -1
    v_pk_add_f32 v[176:177], v[72:73], v[216:217] neg_lo:[0,1] neg_hi:[0,1]
    v_pk_add_f32 v[178:179], v[74:75], v[218:219] neg_lo:[0,1] neg_hi:[0,1]
    v_pk_add_f32 v[180:181], v[76:77], v[220:221] neg_lo:[0,1] neg_hi:[0,1]
    v_pk_add_f32 v[182:183], v[78:79], v[222:223] neg_lo:[0,1] neg_hi:[0,1]
    v_pk_fma_f32 v[64:65], v[176:177], v[144:145], v[64:65]
    v_pk_fma_f32 v[66:67], v[178:179], v[146:147], v[66:67]
    v_pk_fma_f32 v[68:69], v[180:181], v[148:149], v[68:69]
    v_pk_fma_f32 v[70:71], v[182:183], v[150:151], v[70:71]
    v_cvt_pk_bf16_f32 v20, v64, v65
    v_cvt_pk_bf16_f32 v21, v66, v67
    v_cvt_pk_bf16_f32 v22, v68, v69
    v_cvt_pk_bf16_f32 v23, v70, v71
    s_mov_b64 exec, s[60:61]
    buffer_store_dwordx4 v[20:23], v5, s[16:19], s48 offen sc1
    s_not_b64 exec, exec
    s_cbranch_scc0 L_nodump3
    ds_write_b128 v6, v[176:179] offset:42496
    ds_write_b128 v6, v[180:183] offset:42512
    s_mov_b64 exec, 1
    ds_add_u32 v0, v255 offset:42836
    s_mov_b64 exec, -1
L_nodump3:
    s_mov_b64 exec, -1
    s_branch L_fin
L_moe:
    s_and_b32 s32, s2, 7
    s_mul_i32 s32, s32, 28
    s_lshr_b32 s31, s2, 3
    s_add_u32 s31, s31, s32
    s_lshr_b32 s46, s31, 3
    s_and_b32 s47, s31, 7
    s_mov_b32 s18, 7340032
    s_mov_b32 s19, 0x00020000
    s_mov_b32 s22, 7340032
    s_mov_b32 s23, 0x00020000
    s_mov_b32 s26, 7340032
    s_mov_b32 s27, 0x00020000
    v_lshrrev_b32 v4, 4, v2
    v_lshlrev_b32 v5, 5, v4
    v_and_b32 v6, 0xf0, v3
    v_xor_b32 v5, v5, v6
    v_mul_u32_u24 v4, 7168, v4
    s_mul_i32 s31, s47, 917504
    s_lshl_b32 s32, s46, 8
    s_add_u32 s31, s31, s32
    v_add3_u32 v4, v4, v5, s31
    s_mul_i32 s48, s30, 8
    s_add_u32 s49, s48, 8
    s_cmp_eq_u32 s30, 3
    s_cselect_b32 s49, 32, s49
    s_waitcnt lgkmcnt(0)
    s_mov_b32 s8, s4
    s_mov_b32 s9, s5
    s_mov_b32 s12, s6
    s_mov_b32 s13, s7
    s_mov_b32 s16, s38
    s_mov_b32 s17, s39
    s_mov_b32 s20, s40
    s_mov_b32 s21, s41
    s_mov_b32 s24, s42
    s_mov_b32 s25, s43
    s_load_dwordx2 s[28:29], s[6:7], 0
    s_barrier
    s_cmp_ge_u32 s2, 224
    s_cselect_b32 s66, 0, 1
    s_cbranch_scc1 L_dma_done
L_dma:
    s_bfe_u32 s31, s48, 0x10001
    s_lshl_b32 s31, s31, 7
    v_xor_b32 v5, s31, v4
    s_lshl_b32 s32, s48, 10
    s_add_u32 m0, s32, 75776
    s_mul_i32 s31, s48, 28672
    buffer_load_dwordx4 v5, s[16:19], s31 offen  lds
    s_add_u32 m0, s32, 108544
    s_add_u32 s48, s48, 1
    buffer_load_dwordx4 v5, s[20:23], s31 offen  lds
    s_cmp_eq_u32 s30, 3
    s_cbranch_scc1 L_dma3
    s_waitcnt vmcnt(4)
    s_cmp_lt_u32 s48, s49
    s_cbranch_scc1 L_dma
    s_branch L_dma_done
L_dma3:
    s_waitcnt vmcnt(4)
    s_cmp_lt_u32 s48, s49
    s_cbranch_scc1 L_dma
L_dma_done:
    s_setprio 3
    s_lshr_b32 s31, s47, 2
    s_lshl_b32 s32, s46, 1
    s_add_u32 s50, s31, s32
    s_lshl_b32 s31, s50, 17
    s_and_b32 s32, s47, 3
    s_lshl_b32 s32, s32, 2
    s_add_u32 s51, s32, s30
    s_lshl_b32 s32, s51, 7
    s_add_u32 s31, s31, s32
    v_lshrrev_b32 v6, 3, v2
    v_lshlrev_b32 v6, 14, v6
    v_and_b32 v7, 0x70, v3
    v_add3_u32 v6, v6, v7, s31
    s_mov_b32 s60, 4096
    s_mov_b32 s61, 8192
    s_mov_b32 s62, 12288
    v_bfe_u32 v8, v2, 2, 3
    v_lshlrev_b32 v9, 5, v8
    s_lshl_b32 s31, s30, 6
    v_xor_b32 v9, s31, v9
    v_bfe_u32 v8, v2, 2, 2
    v_lshl_add_u32 v9, v8, 8, v9
    v_lshrrev_b32 v8, 4, v2
    v_lshl_add_u32 v9, v8, 11, v9
    v_and_b32 v10, 3, v2
    v_lshl_add_u32 v9, v10, 3, v9
    v_add_u32 v9, 75776, v9
    v_xor_b32 v10, 32, v9
    v_lshlrev_b32 v8, 4, v8
    s_lshr_b32 s31, s30, 1
    s_lshl_b32 s32, s46, 1
    s_add_u32 s31, s31, s32
    s_lshl_b32 s31, s31, 12
    s_lshl_b32 s32, s47, 9
    s_add_u32 s31, s31, s32
    s_and_b32 s32, s30, 1
    s_lshl_b32 s32, s32, 8
    s_add_u32 s31, s31, s32
    s_add_u32 s31, s31, 262144
    v_lshl_add_u32 v13, v2, 3, s31
    s_waitcnt lgkmcnt(0)
    s_add_u32 s28, s28, 0x7f4a7c15
    s_addc_u32 s29, s29, 0x9e3779b9
    s_and_b32 s31, s28, 0xff
    v_mov_b32 v14, s31
    s_mov_b32 s49, 0xffffff00
    s_cmp_lg_u32 s66, 0
    s_cbranch_scc1 L_tagged
    s_mov_b64 exec, 1
    ds_add_u32 v0, v255 offset:42816
    s_mov_b64 exec, -1
L_tagged:
    s_lshl_b32 s31, s47, 8
    s_lshl_b32 s32, s30, 6
    s_add_u32 s67, s31, s32
    v_lshlrev_b32 v15, 2, v2
    v_add_u32 v15, s32, v15
    s_cmp_eq_u32 s30, 3
    s_cbranch_scc1 L_h1
    s_cmp_eq_u32 s66, 0
    s_cbranch_scc1 L_key
    s_waitcnt vmcnt(0)
L_key:
L_sync9:
    ds_read_b32 v1, v0 offset:42840
    s_waitcnt lgkmcnt(0)
    v_readfirstlane_b32 s31, v1
    s_nop 0
    s_cmp_ge_u32 s31, 1
    s_cbranch_scc0 L_sync9
    ds_read_b64 v[18:19], v0 offset:41552
    s_waitcnt lgkmcnt(0)
    v_readfirstlane_b32 s33, v19
    v_readfirstlane_b32 s34, v18
    s_andn2_b32 s31, 0x7ff, s33
    s_lshl_b32 s31, s31, 11
    s_add_u32 s31, s31, s67
    s_load_dwordx16 s[76:91], s[4:5], s31
    s_cmp_eq_u32 s66, 0
    s_cbranch_scc1 L_slice
    buffer_load_dwordx4 v[100:103], v6, s[24:27], 0 offen offset:0
    buffer_load_dwordx4 v[104:107], v6, s[24:27], 0 offen offset:2048
    s_branch L_slice
L_h1:
    s_mov_b32 s63, 4096
    s_waitcnt vmcnt(2)
L_sync10:
    ds_read_b32 v1, v0 offset:42828
    s_waitcnt lgkmcnt(0)
    v_readfirstlane_b32 s31, v1
    s_nop 0
    s_cmp_ge_u32 s31, 4
    s_cbranch_scc0 L_sync10
L_nogate:
    buffer_load_dwordx4 v[20:23], v3, s[12:15], s63 offen offset:0 sc1
    buffer_load_dwordx4 v[24:27], v3, s[12:15], s63 offen offset:1024 sc1
    buffer_load_dwordx4 v[28:31], v3, s[12:15], s63 offen offset:2048 sc1
    buffer_load_dwordx4 v[32:35], v3, s[12:15], s63 offen offset:3072 sc1
    s_mov_b64 exec, 1
    ds_add_u32 v0, v255 offset:42860
    s_mov_b64 exec, -1
    s_waitcnt vmcnt(0)
L_mi_check:
    v_cmp_ne_u64 s[52:53], s[28:29], v[22:23]
    v_cmp_ne_u64 s[54:55], s[28:29], v[26:27]
    v_cmp_ne_u64 s[56:57], s[28:29], v[30:31]
    v_cmp_ne_u64 s[58:59], s[28:29], v[34:35]
    v_max_u32 v18, v21, v25
    v_max3_u32 v18, v18, v29, v33
    s_or_b64 s[64:65], s[52:53], s[54:55]
    s_or_b64 vcc, s[56:57], s[58:59]
    s_or_b64 s[64:65], s[64:65], vcc
    s_cbranch_scc0 L_mi_got
    s_cmp_eq_u32 s35, 0
    s_cbranch_scc1 L_mi_got
    s_sub_u32 s35, s35, 1
    s_sleep 2
    s_mov_b64 exec, s[52:53]
    s_cbranch_execz L_mi_skip0
    buffer_load_dwordx4 v[20:23], v3, s[12:15], s63 offen offset:0 sc1
L_mi_skip0:
    s_mov_b64 exec, s[54:55]
    s_cbranch_execz L_mi_skip1
    buffer_load_dwordx4 v[24:27], v3, s[12:15], s63 offen offset:1024 sc1
L_mi_skip1:
    s_mov_b64 exec, s[56:57]
    s_cbranch_execz L_mi_skip2
    buffer_load_dwordx4 v[28:31], v3, s[12:15], s63 offen offset:2048 sc1
L_mi_skip2:
    s_mov_b64 exec, s[58:59]
    s_cbranch_execz L_mi_skip3
    buffer_load_dwordx4 v[32:35], v3, s[12:15], s63 offen offset:3072 sc1
L_mi_skip3:
    s_mov_b64 exec, -1
    s_waitcnt vmcnt(0)
    s_branch L_mi_check
L_mi_got:
    v_max_u32_dpp v19, v18, v18 row_ror:1 row_mask:0xf bank_mask:0xf
    s_nop 1
    v_max_u32_dpp v19, v19, v19 row_ror:2 row_mask:0xf bank_mask:0xf
    s_nop 1
    v_max_u32_dpp v19, v19, v19 row_ror:4 row_mask:0xf bank_mask:0xf
    s_nop 1
    v_max_u32_dpp v19, v19, v19 row_ror:8 row_mask:0xf bank_mask:0xf
    s_nop 0
    v_readlane_b32 s33, v19, 0
    v_readlane_b32 s31, v19, 16
    v_readlane_b32 s32, v19, 32
    v_readlane_b32 s34, v19, 48
    s_max_u32 s33, s33, s31
    s_max_u32 s32, s32, s34
    s_max_u32 s33, s33, s32
    s_andn2_b32 s31, 0x7ff, s33
    s_lshl_b32 s31, s31, 11
    s_add_u32 s31, s31, s67
    s_load_dwordx16 s[76:91], s[4:5], s31
    s_sub_u32 s31, s31, 128
    s_load_dword s72, s[4:5], s31
    v_cmp_eq_u32 s[52:53], s33, v25
    v_cmp_eq_u32 s[54:55], s33, v29
    v_cmp_eq_u32 s[56:57], s33, v33
    v_cmp_eq_u32 vcc, s33, v18
    v_cndmask_b32 v19, v20, v24, s[52:53]
    v_cndmask_b32 v19, v19, v28, s[54:55]
    v_cndmask_b32 v19, v19, v32, s[56:57]
    s_ff1_i32_b64 s32, vcc
    v_readlane_b32 s34, v19, s32
    v_mov_b32 v19, s33
    s_nop 0
    v_mov_b32 v18, s34
    ds_write_b64 v0, v[18:19] offset:41552
    s_mov_b64 exec, 1
    ds_add_u32 v0, v255 offset:42840
    s_mov_b64 exec, -1
    s_cmp_eq_u32 s66, 0
    s_cbranch_scc1 L_slice
    buffer_load_dwordx4 v[100:103], v6, s[24:27], 0 offen offset:0
    buffer_load_dwordx4 v[104:107], v6, s[24:27], 0 offen offset:2048
L_slice:
    s_lshl_b32 s52, s34, 16
    s_and_b32 s32, s34, 0xffff0000
    v_rcp_f32 v20, s32
    s_waitcnt lgkmcnt(0)
    s_cmp_eq_u32 s66, 0
    s_cbranch_scc1 L_idle
    buffer_load_dwordx4 v[108:111], v6, s[24:27], s60 offen offset:0
    buffer_load_dwordx4 v[112:115], v6, s[24:27], s60 offen offset:2048
    v_writelane_b32 v17, s76, 0
    v_writelane_b32 v17, s77, 1
    v_writelane_b32 v17, s78, 2
    v_writelane_b32 v17, s79, 3
    v_writelane_b32 v17, s80, 4
    v_writelane_b32 v17, s81, 5
    v_writelane_b32 v17, s82, 6
    v_writelane_b32 v17, s83, 7
    v_writelane_b32 v17, s84, 8
    v_writelane_b32 v17, s85, 9
    v_writelane_b32 v17, s86, 10
    v_writelane_b32 v17, s87, 11
    v_writelane_b32 v17, s88, 12
    v_writelane_b32 v17, s89, 13
    v_writelane_b32 v17, s90, 14
    v_writelane_b32 v17, s91, 15
    v_lshlrev_b32 v18, 16, v17
    v_and_b32 v19, 0xffff0000, v17
    v_pk_add_f32 v[18:19], v[18:19], s[52:53] op_sel_hi:[1,0] neg_lo:[0,1] neg_hi:[0,1]
    s_nop 0
    v_cvt_pk_bf16_f32 v17, v18, v19
    v_lshlrev_b32 v18, 16, v17
    v_and_b32 v19, 0xffff0000, v17
    v_pk_mul_f32 v[18:19], v[18:19], v[20:21] op_sel_hi:[1,0]
    s_nop 0
    v_cvt_pk_bf16_f32 v17, v18, v19
    s_mov_b64 exec, 0xffff
    ds_write_b32 v15, v17 offset:42112
    s_mov_b64 exec, 1
    ds_add_u32 v0, v255 offset:42844
    s_mov_b64 exec, -1
L_sync11:
    ds_read_b32 v1, v0 offset:42844
    s_waitcnt lgkmcnt(0)
    v_readfirstlane_b32 s31, v1
    s_nop 0
    s_cmp_ge_u32 s31, 4
    s_cbranch_scc0 L_sync11
    ds_read_b128 v[20:23], v8 offset:42112
    ds_read_b64_tr_b16 v[36:37], v9 offset:0
    ds_read_b64_tr_b16 v[38:39], v9 offset:1024
    ds_read_b64_tr_b16 v[40:41], v10 offset:0
    ds_read_b64_tr_b16 v[42:43], v10 offset:1024
    ds_read_b64_tr_b16 v[44:45], v9 offset:32768
    ds_read_b64_tr_b16 v[46:47], v9 offset:33792
    ds_read_b64_tr_b16 v[48:49], v10 offset:32768
    ds_read_b64_tr_b16 v[50:51], v10 offset:33792
    ds_read_b128 v[24:27], v8 offset:42176
    ds_read_b64_tr_b16 v[52:53], v9 offset:8192
    ds_read_b64_tr_b16 v[54:55], v9 offset:9216
    ds_read_b64_tr_b16 v[56:57], v10 offset:8192
    ds_read_b64_tr_b16 v[58:59], v10 offset:9216
    s_waitcnt lgkmcnt(11)
    v_mfma_f32_16x16x32_bf16 v[132:135], v[20:23], v[36:39], 0
    ds_read_b64_tr_b16 v[60:61], v9 offset:40960
    ds_read_b64_tr_b16 v[62:63], v9 offset:41984
    s_waitcnt lgkmcnt(11)
    v_mfma_f32_16x16x32_bf16 v[136:139], v[20:23], v[40:43], 0
    ds_read_b64_tr_b16 v[64:65], v10 offset:40960
    ds_read_b64_tr_b16 v[66:67], v10 offset:41984
    s_waitcnt lgkmcnt(11)
    v_mfma_f32_16x16x32_bf16 v[140:143], v[20:23], v[44:47], 0
    ds_read_b128 v[28:31], v8 offset:42240
    ds_read_b64_tr_b16 v[68:69], v9 offset:16384
    ds_read_b64_tr_b16 v[70:71], v9 offset:17408
    s_waitcnt lgkmcnt(12)
    v_mfma_f32_16x16x32_bf16 v[144:147], v[20:23], v[48:51], 0
    ds_read_b64_tr_b16 v[72:73], v10 offset:16384
    ds_read_b64_tr_b16 v[74:75], v10 offset:17408
    s_waitcnt lgkmcnt(11)
    v_mfma_f32_16x16x32_bf16 v[132:135], v[24:27], v[52:55], v[132:135]
    ds_read_b64_tr_b16 v[76:77], v9 offset:49152
    ds_read_b64_tr_b16 v[78:79], v9 offset:50176
    s_waitcnt lgkmcnt(11)
    v_mfma_f32_16x16x32_bf16 v[136:139], v[24:27], v[56:59], v[136:139]
    ds_read_b64_tr_b16 v[80:81], v10 offset:49152
    ds_read_b64_tr_b16 v[82:83], v10 offset:50176
    s_waitcnt lgkmcnt(11)
    v_mfma_f32_16x16x32_bf16 v[140:143], v[24:27], v[60:63], v[140:143]
    ds_read_b128 v[32:35], v8 offset:42304
    ds_read_b64_tr_b16 v[84:85], v9 offset:24576
    ds_read_b64_tr_b16 v[86:87], v9 offset:25600
    s_waitcnt lgkmcnt(12)
    v_mfma_f32_16x16x32_bf16 v[144:147], v[24:27], v[64:67], v[144:147]
    ds_read_b64_tr_b16 v[88:89], v10 offset:24576
    ds_read_b64_tr_b16 v[90:91], v10 offset:25600
    s_waitcnt lgkmcnt(11)
    v_mfma_f32_16x16x32_bf16 v[132:135], v[28:31], v[68:71], v[132:135]
    ds_read_b64_tr_b16 v[92:93], v9 offset:57344
    ds_read_b64_tr_b16 v[94:95], v9 offset:58368
    s_waitcnt lgkmcnt(11)
    v_mfma_f32_16x16x32_bf16 v[136:139], v[28:31], v[72:75], v[136:139]
    ds_read_b64_tr_b16 v[96:97], v10 offset:57344
    ds_read_b64_tr_b16 v[98:99], v10 offset:58368
    s_waitcnt lgkmcnt(11)
    v_mfma_f32_16x16x32_bf16 v[140:143], v[28:31], v[76:79], v[140:143]
    s_waitcnt lgkmcnt(9)
    v_mfma_f32_16x16x32_bf16 v[144:147], v[28:31], v[80:83], v[144:147]
    s_waitcnt lgkmcnt(6)
    v_mfma_f32_16x16x32_bf16 v[132:135], v[32:35], v[84:87], v[132:135]
    s_waitcnt lgkmcnt(4)
    v_mfma_f32_16x16x32_bf16 v[136:139], v[32:35], v[88:91], v[136:139]
    s_waitcnt lgkmcnt(2)
    v_mfma_f32_16x16x32_bf16 v[140:143], v[32:35], v[92:95], v[140:143]
    s_waitcnt lgkmcnt(0)
    v_mfma_f32_16x16x32_bf16 v[144:147], v[32:35], v[96:99], v[144:147]
    s_mov_b32 vcc_lo, 0xffff0000
    s_mov_b32 vcc_hi, 0
    s_lshl_b32 s31, s50, 12
    s_lshl_b32 s32, s30, 7
    s_add_u32 s31, s31, s32
    s_add_u32 s31, s31, 262144
    v_lshrrev_b32 v15, 3, v2
    v_lshlrev_b32 v15, 9, v15
    v_add3_u32 v15, v15, v7, s31
    v_cndmask_b32 v20, v132, v136, vcc
    v_cndmask_b32 v21, v140, v144, vcc
    v_and_or_b32 v20, v20, s49, v14
    v_and_or_b32 v21, v21, s49, v14
    s_mov_b32 exec_hi, 0
    buffer_store_dwordx2 v[20:21], v13, s[12:15], 0 offen sc1
    s_mov_b64 exec, -1
    buffer_load_dwordx4 v[116:119], v6, s[24:27], s61 offen offset:0
    buffer_load_dwordx4 v[120:123], v6, s[24:27], s61 offen offset:2048
    buffer_load_dwordx4 v[124:127], v6, s[24:27], s62 offen offset:0
    buffer_load_dwordx4 v[128:131], v6, s[24:27], s62 offen offset:2048
    s_mov_b64 exec, 1
    ds_add_u32 v0, v255 offset:42848
    s_mov_b64 exec, -1
    s_mov_b32 s52, 0x05040100
    s_mov_b32 s53, 0x07060302
    v_mov_b32 v36, 0
    v_mov_b32 v37, 0
    v_mov_b32 v38, 0
    v_mov_b32 v39, 0
    v_mov_b32 v40, 0
    v_mov_b32 v41, 0
    v_mov_b32 v42, 0
    v_mov_b32 v43, 0
    v_and_b32 v16, 7, v2
    v_lshlrev_b32 v16, 2, v16
    v_lshrrev_b32 v17, 5, v2
    v_lshl_add_u32 v16, v17, 1, v16
    s_lshl_b32 s31, s30, 5
    v_add_u32 v16, s31, v16
    v_lshrrev_b32 v17, 3, v2
    v_lshlrev_b32 v17, 4, v17
    s_lshl_b32 s31, s50, 12
    s_lshl_b32 s32, s51, 8
    s_add_u32 s31, s31, s32
    s_add_u32 s31, s31, 524288
    v_lshlrev_b32 v18, 1, v7
    v_lshrrev_b32 v19, 4, v2
    v_lshl_add_u32 v18, v19, 3, v18
    v_add_u32 v18, s31, v18
    s_waitcnt vmcnt(7)
    v_perm_b32 v98, v104, v100, s52
    v_perm_b32 v104, v104, v100, s53
    v_perm_b32 v100, v105, v101, s52
    v_perm_b32 v105, v105, v101, s53
    v_perm_b32 v101, v106, v102, s52
    v_perm_b32 v106, v106, v102, s53
    v_perm_b32 v102, v107, v103, s52
    v_perm_b32 v107, v107, v103, s53
    s_waitcnt vmcnt(5)
    v_perm_b32 v103, v112, v108, s52
    v_perm_b32 v112, v112, v108, s53
    v_perm_b32 v108, v113, v109, s52
    v_perm_b32 v113, v113, v109, s53
    v_perm_b32 v109, v114, v110, s52
    v_perm_b32 v114, v114, v110, s53
    v_perm_b32 v110, v115, v111, s52
    v_perm_b32 v115, v115, v111, s53
    s_waitcnt vmcnt(2)
    v_perm_b32 v111, v120, v116, s52
    v_perm_b32 v120, v120, v116, s53
    v_perm_b32 v116, v121, v117, s52
    v_perm_b32 v121, v121, v117, s53
    v_perm_b32 v117, v122, v118, s52
    v_perm_b32 v122, v122, v118, s53
    v_perm_b32 v118, v123, v119, s52
    v_perm_b32 v123, v123, v119, s53
    s_waitcnt vmcnt(0)
    v_perm_b32 v119, v128, v124, s52
    v_perm_b32 v128, v128, v124, s53
    v_perm_b32 v124, v129, v125, s52
    v_perm_b32 v129, v129, v125, s53
    v_perm_b32 v125, v130, v126, s52
    v_perm_b32 v130, v130, v126, s53
    v_perm_b32 v126, v131, v127, s52
    v_perm_b32 v131, v131, v127, s53
L_hp_poll:
    buffer_load_dwordx4 v[20:23], v15, s[12:15], 0 offen sc1
L_hp_wait:
    s_waitcnt vmcnt(0)
    v_xor_b32 v20, v14, v20
    v_xor_b32 v21, v14, v21
    v_xor_b32 v22, v14, v22
    v_xor_b32 v23, v14, v23
    v_or3_b32 v24, v20, v21, v22
    v_or_b32 v24, v24, v23
    v_and_b32 v24, 0xff, v24
    v_cmp_ne_u32 vcc, 0, v24
    v_permlane16_swap_b32 v20, v21
    v_permlane16_swap_b32 v22, v23
    s_cbranch_vccz L_hp_got
    s_cmp_eq_u32 s35, 0
    s_cbranch_scc1 L_hp_got
    s_sub_u32 s35, s35, 1
    s_sleep 2
    s_branch L_hp_poll
L_hp_got:
    v_add_f32 v20, v20, v21
    v_add_f32 v22, v22, v23
    s_nop 1
    v_permlane32_swap_b32 v20, v22
    v_add_f32 v20, v20, v22
    s_nop 1
    v_add_f32_dpp v21, v20, v20 row_ror:8 row_mask:0xf bank_mask:0xf
    v_add_f32_dpp v20, v20, v20 row_ror:8 row_mask:0xf bank_mask:0xf
    s_nop 1
    v_permlane16_swap_b32 v20, v21
    v_cvt_pk_bf16_f32 v20, v20, v21
    v_and_b32 v21, 0xffff0000, v20
    v_lshlrev_b32 v20, 16, v20
    v_mul_f32 v22, 0xbfb8aa3b, v20
    v_exp_f32 v22, v22
    s_nop 0
    v_add_f32 v22, 1.0, v22
    v_rcp_f32 v22, v22
    s_nop 0
    v_mul_f32 v20, v20, v22
    v_cvt_pk_bf16_f32 v20, v20, v20
    v_lshlrev_b32 v20, 16, v20
    v_mul_f32 v20, v20, v21
    v_cvt_pk_bf16_f32 v20, v20, v20
    ds_write_b16 v16, v20 offset:42368
    s_mov_b64 exec, 1
    ds_add_u32 v0, v255 offset:42852
    s_mov_b64 exec, -1
L_sync12:
    ds_read_b32 v1, v0 offset:42852
    s_waitcnt lgkmcnt(0)
    v_readfirstlane_b32 s31, v1
    s_nop 0
    s_cmp_ge_u32 s31, 4
    s_cbranch_scc0 L_sync12
    ds_read_b128 v[20:23], v17 offset:42368
    s_waitcnt lgkmcnt(0)
    v_dot2c_f32_bf16 v36, v20, v98
    v_dot2c_f32_bf16 v37, v20, v104
    v_dot2c_f32_bf16 v38, v20, v100
    v_dot2c_f32_bf16 v39, v20, v105
    v_dot2c_f32_bf16 v40, v20, v101
    v_dot2c_f32_bf16 v41, v20, v106
    v_dot2c_f32_bf16 v42, v20, v102
    v_dot2c_f32_bf16 v43, v20, v107
    v_dot2c_f32_bf16 v36, v21, v103
    v_dot2c_f32_bf16 v37, v21, v112
    v_dot2c_f32_bf16 v38, v21, v108
    v_dot2c_f32_bf16 v39, v21, v113
    v_dot2c_f32_bf16 v40, v21, v109
    v_dot2c_f32_bf16 v41, v21, v114
    v_dot2c_f32_bf16 v42, v21, v110
    v_dot2c_f32_bf16 v43, v21, v115
    v_dot2c_f32_bf16 v36, v22, v111
    v_dot2c_f32_bf16 v37, v22, v120
    v_dot2c_f32_bf16 v38, v22, v116
    v_dot2c_f32_bf16 v39, v22, v121
    v_dot2c_f32_bf16 v40, v22, v117
    v_dot2c_f32_bf16 v41, v22, v122
    v_dot2c_f32_bf16 v42, v22, v118
    v_dot2c_f32_bf16 v43, v22, v123
    v_dot2c_f32_bf16 v36, v23, v119
    v_dot2c_f32_bf16 v37, v23, v128
    v_dot2c_f32_bf16 v38, v23, v124
    v_dot2c_f32_bf16 v39, v23, v129
    v_dot2c_f32_bf16 v40, v23, v125
    v_dot2c_f32_bf16 v41, v23, v130
    v_dot2c_f32_bf16 v42, v23, v126
    v_dot2c_f32_bf16 v43, v23, v131
    v_permlane32_swap_b32 v36, v40
    v_permlane32_swap_b32 v37, v41
    v_permlane32_swap_b32 v38, v42
    v_permlane32_swap_b32 v39, v43
    v_add_f32 v36, v36, v40
    v_add_f32 v37, v37, v41
    v_add_f32 v38, v38, v42
    v_add_f32 v39, v39, v43
    s_nop 0
    v_permlane16_swap_b32 v36, v38
    v_permlane16_swap_b32 v37, v39
    v_add_f32 v36, v36, v38
    v_add_f32 v37, v37, v39
    s_nop 0
    v_add_f32_dpp v36, v36, v36 row_ror:8 row_mask:0xf bank_mask:0xf
    v_add_f32_dpp v37, v37, v37 row_ror:8 row_mask:0xf bank_mask:0xf
    v_and_or_b32 v36, v36, s49, v14
    v_and_or_b32 v37, v37, s49, v14
    s_mov_b32 exec_lo, 0x00ff00ff
    s_mov_b32 exec_hi, 0x00ff00ff
    buffer_store_dwordx2 v[36:37], v18, s[12:15], 0 offen sc1
    s_mov_b64 exec, 1
    ds_add_u32 v0, v255 offset:42856
    s_mov_b64 exec, -1
    s_branch L_owner
L_idle:
    s_mov_b64 exec, 1
    ds_add_u32 v0, v255 offset:42844
    s_mov_b64 exec, -1
    s_mov_b64 exec, 1
    ds_add_u32 v0, v255 offset:42848
    s_mov_b64 exec, -1
    s_mov_b64 exec, 1
    ds_add_u32 v0, v255 offset:42852
    s_mov_b64 exec, -1
    s_mov_b64 exec, 1
    ds_add_u32 v0, v255 offset:42856
    s_mov_b64 exec, -1
L_owner:
    s_andn2_b32 s51, 0x7ff, s33
    s_xor_b32 s31, s51, s2
    s_and_b32 s31, s31, 7
    s_cbranch_scc1 L_fin
    s_mov_b32 s16, s44
    s_mov_b32 s17, s45
    s_mov_b32 s18, 0x400000
    s_lshr_b32 s47, s2, 3
    s_lshl_b32 s31, s51, 11
    s_lshl_b32 s32, s47, 6
    s_add_u32 s63, s31, s32
    v_and_b32 v8, 31, v2
    v_lshlrev_b32 v8, 1, v8
    buffer_load_ushort v9, v8, s[8:11], s63 offen
    v_lshrrev_b32 v4, 3, v2
    s_lshl_b32 s31, s30, 4
    v_add_u32 v4, s31, v4
    v_lshlrev_b32 v4, 12, v4
    s_lshl_b32 s31, s47, 7
    s_add_u32 s31, s31, 524288
    v_add3_u32 v4, v4, v7, s31
    s_mov_b32 s62, 32768
    v_mov_b32 v24, v14
    v_mov_b32 v25, v14
    v_mov_b32 v26, v14
    v_mov_b32 v27, v14
    v_lshrrev_b32 v5, 4, v2
    v_lshl_add_u32 v6, v5, 2, v7
    s_lshl_b32 s31, s30, 7
    v_add_u32 v6, s31, v6
    s_ashr_i32 s31, s33, 31
    s_orn2_b32 s31, 0x80000000, s31
    s_xor_b32 s31, s31, s33
    s_and_b32 s31, s31, 0xfffff800
    v_cvt_pk_bf16_f32 v11, s31, s31
    v_lshlrev_b32 v11, 16, v11
    v_mul_f32 v11, 0xbfb8aa3b, v11
    v_exp_f32 v11, v11
    s_and_b32 s32, s34, 0xffff0000
    v_add_f32 v11, 1.0, v11
    v_rcp_f32 v11, v11
    v_rcp_f32 v12, s32
    v_cvt_pk_bf16_f32 v11, v11, v11
    v_lshlrev_b32 v11, 16, v11
    s_lshl_b32 s31, s34, 16
    s_waitcnt vmcnt(0)
    v_lshlrev_b32 v9, 16, v9
    v_subrev_f32 v10, s31, v9
    v_cvt_pk_bf16_f32 v10, v10, v10
    v_lshlrev_b32 v10, 16, v10
    v_mul_f32 v10, v10, v12
    v_cvt_pk_bf16_f32 v10, v10, v10
    v_lshlrev_b32 v10, 16, v10
    v_lshlrev_b32 v13, 1, v8
    s_mov_b64 vcc, -1
L_y_poll:
    s_mov_b64 exec, vcc
    buffer_load_dwordx4 v[20:23], v4, s[12:15], 0 offen sc1
    s_cmp_eq_u32 s30, 3
    s_cbranch_scc1 L_y_one
    buffer_load_dwordx4 v[24:27], v4, s[12:15], s62 offen sc1
L_y_one:
    s_mov_b64 exec, -1
    s_waitcnt vmcnt(0)
    v_xor_b32 v28, v14, v20
    v_xor_b32 v29, v14, v21
    v_xor_b32 v30, v14, v22
    v_xor_b32 v31, v14, v23
    v_xor_b32 v32, v14, v24
    v_xor_b32 v33, v14, v25
    v_xor_b32 v34, v14, v26
    v_xor_b32 v35, v14, v27
    v_or3_b32 v1, v28, v29, v30
    v_or3_b32 v1, v1, v31, v32
    v_or3_b32 v1, v1, v33, v34
    v_or_b32 v1, v1, v35
    v_and_b32 v1, 0xff, v1
    v_cmp_ne_u32 vcc, 0, v1
    v_pk_add_f32 v[28:29], v[28:29], v[32:33]
    v_pk_add_f32 v[30:31], v[30:31], v[34:35]
    s_cbranch_vccz L_y_got
    s_cmp_eq_u32 s35, 0
    s_cbranch_scc1 L_y_got
    s_sub_u32 s35, s35, 1
    s_sleep 2
    s_branch L_y_poll
L_y_got:
    v_permlane16_swap_b32 v28, v29
    v_permlane16_swap_b32 v30, v31
    v_add_f32 v28, v28, v29
    v_add_f32 v30, v30, v31
    s_nop 1
    v_permlane32_swap_b32 v28, v30
    v_add_f32 v28, v28, v30
    s_nop 1
    v_add_f32_dpp v28, v28, v28 row_ror:8 row_mask:0xf bank_mask:0xf
    ds_write_b32 v6, v28 offset:41600
    s_mov_b64 exec, 1
    ds_add_u32 v0, v255 offset:42836
    s_mov_b64 exec, -1
    s_cmp_lg_u32 s30, 0
    s_cbranch_scc1 L_fin
    s_cmp_eq_u32 s47, 0
    s_cselect_b32 s32, 0, 2147483392
    v_mov_b32 v5, 2147483392
    v_writelane_b32 v5, s32, 0
    v_mov_b32 v6, s28
    v_mov_b32 v7, s29
L_sync13:
    ds_read_b32 v1, v0 offset:42836
    s_waitcnt lgkmcnt(0)
    v_readfirstlane_b32 s31, v1
    s_nop 0
    s_cmp_ge_u32 s31, 5
    s_cbranch_scc0 L_sync13
    ds_read_b32 v20, v13 offset:41600
    ds_read_b32 v21, v13 offset:41728
    ds_read_b32 v22, v13 offset:41856
    ds_read_b32 v23, v13 offset:41984
    ds_read_b32 v24, v13 offset:42496
    s_waitcnt lgkmcnt(0)
    v_add_f32 v20, v20, v21
    v_add_f32 v22, v22, v23
    v_add_f32 v20, v20, v22
    v_cvt_pk_bf16_f32 v20, v20, v20
    v_lshlrev_b32 v20, 16, v20
    v_mul_f32 v20, v20, v11
    v_cvt_pk_bf16_f32 v20, v20, v20
    v_lshlrev_b32 v20, 16, v20
    v_add_f32 v20, v20, v10
    v_cvt_pk_bf16_f32 v20, v20, v20
    v_lshlrev_b32 v20, 16, v20
    v_mul_f32 v1, 0xbfb8aa3b, v20
    v_exp_f32 v1, v1
    v_mul_f32 v20, v20, v24
    v_add_f32 v1, 1.0, v1
    v_rcp_f32 v1, v1
    s_mov_b32 exec_hi, 0
    v_fma_f32 v20, v20, v1, v9
    v_cvt_pk_bf16_f32 v20, v20, v20
    buffer_store_short v20, v8, s[16:19], s63 offen sc1
    buffer_store_dwordx2 v[6:7], v5, s[12:15], 0 offen sc1
    s_mov_b64 exec, -1
L_fin:
L_exit:
    s_endpgm
L_code_end:
.section .rodata,"a"
.p2align 6
.amdhsa_kernel recurrent_scan__spectral_fnet__moe_arch_mod__prompt_kernel
  .amdhsa_next_free_vgpr 256
  .amdhsa_next_free_sgpr 92
  .amdhsa_accum_offset 256
  .amdhsa_group_segment_fixed_size 0
  .amdhsa_kernarg_size 104
  .amdhsa_user_sgpr_count 2
  .amdhsa_user_sgpr_kernarg_segment_ptr 1
  .amdhsa_system_sgpr_workgroup_id_x 1
  .amdhsa_float_denorm_mode_32 3
.end_amdhsa_kernel
```

```asm
; @launch grid=(256,1,1) block=(512,1,1) lds=158720
.amdgcn_target "amdgcn-amd-amdhsa--gfx950"
.text
.globl recurrent_scan__spectral_fnet__moe_arch_mod__prompt_kernel
.p2align 8
.type recurrent_scan__spectral_fnet__moe_arch_mod__prompt_kernel,@function
recurrent_scan__spectral_fnet__moe_arch_mod__prompt_kernel:
    s_cmp_ge_u32 s2, 256
    s_cbranch_scc1 L_exit
    s_load_dwordx2 s[8:9], s[0:1], 0
    s_load_dwordx4 s[36:39], s[0:1], 48
    s_load_dwordx2 s[12:13], s[0:1], 96
    s_getpc_b64 s[32:33]
L_pc:
    s_bfe_u32 s31, s2, 0x30003
    v_subrev_u32 v3, 496, v0
    v_lshl_add_u32 v3, v3, 3, s31
    v_lshlrev_b32 v3, 7, v3
    v_cmp_gt_u32 vcc, L_code_end-L_pc, v3
    s_nop 0
    s_and_saveexec_b64 s[46:47], vcc
    s_cbranch_execz L_nopf
    global_load_dword v254, v3, s[32:33]
L_nopf:
    s_mov_b64 exec, -1
    v_lshrrev_b32 v1, 6, v0
    v_and_b32 v2, 63, v0
    v_readfirstlane_b32 s30, v1
    s_mov_b32 s10, 0x400000
    s_mov_b32 s11, 0x00020000
    s_mov_b32 s14, 0x10000000
    s_mov_b32 s15, 0x00020000
    s_mov_b32 s35, 65536
    v_lshlrev_b32 v3, 4, v2
    v_mov_b32 v0, 0
    v_mov_b32 v255, 1
    s_mov_b32 s3, s30
    s_and_b32 s30, s30, 3
    s_cmp_ge_u32 s3, 4
    s_cbranch_scc1 L_moe
    s_and_b32 s31, s2, 7
    s_lshr_b32 s32, s2, 4
    s_sub_u32 s32, 15, s32
    s_lshl_b32 s32, s32, 3
    s_add_u32 s46, s32, s31
    s_bfe_u32 s47, s2, 0x10003
    s_lshl_b32 s31, s47, 2
    s_add_u32 s51, s31, s30
    s_lshl_b32 s31, s51, 8
    s_add_u32 s52, s31, s46
    s_xor_b32 s54, s52, 1024
    s_sub_u32 s53, 2048, s52
    s_add_u32 s31, s52, 128
    s_cmp_eq_u32 s46, 0
    s_cselect_b32 s53, s31, s53
    s_cselect_b32 s50, 1, 0
    s_xor_b32 s55, s53, 1024
    s_lshl_b32 s56, s52, 11
    s_lshl_b32 s57, s53, 11
    s_lshl_b32 s58, s54, 11
    s_lshl_b32 s59, s55, 11
    s_mov_b32 s22, 2048
    s_mov_b32 s23, 0x00020000
    v_mov_b32 v1, 0
    v_and_b32 v6, 15, v2
    v_lshlrev_b32 v6, 2, v6
    ds_write_b64 v0, v[0:1] offset:41504
    ds_write_b32 v6, v0 offset:42816
    s_waitcnt lgkmcnt(0)
    s_load_dwordx2 s[28:29], s[12:13], 0
    s_load_dwordx2 s[16:17], s[0:1], 80
    buffer_load_dwordx4 v[120:123], v3, s[8:11], s56 offen
    buffer_load_dwordx4 v[124:127], v3, s[8:11], s56 offen offset:1024
    buffer_load_dwordx4 v[128:131], v3, s[8:11], s57 offen
    buffer_load_dwordx4 v[132:135], v3, s[8:11], s57 offen offset:1024
    s_mov_b32 s20, s36
    s_mov_b32 s21, s37
    buffer_load_dwordx4 v[152:155], v3, s[20:23], 0 offen
    buffer_load_dwordx4 v[156:159], v3, s[20:23], 0 offen offset:1024
    buffer_load_dwordx4 v[136:139], v3, s[8:11], s58 offen
    buffer_load_dwordx4 v[140:143], v3, s[8:11], s58 offen offset:1024
    buffer_load_dwordx4 v[144:147], v3, s[8:11], s59 offen
    buffer_load_dwordx4 v[148:151], v3, s[8:11], s59 offen offset:1024
    s_barrier
    s_branch L_dft_rest
L_moe:
    s_load_dwordx2 s[20:21], s[0:1], 64
    s_and_b32 s32, s2, 7
    s_mul_i32 s32, s32, 7
    s_lshr_b32 s31, s2, 6
    s_lshl_b32 s31, s31, 1
    s_add_u32 s46, s31, s32
    s_bfe_u32 s47, s2, 0x30003
    s_cmp_ge_u32 s2, 192
    s_cselect_b32 s75, 1, 0
    s_lshl_b32 s47, s47, s75
    s_and_b32 s47, s47, 7
    s_mov_b32 s18, 7340032
    s_mov_b32 s19, 0x00020000
    s_mov_b32 s22, 7340032
    s_mov_b32 s23, 0x00020000
    s_mov_b32 s26, 7340032
    s_mov_b32 s27, 0x00020000
    v_lshrrev_b32 v4, 4, v2
    v_lshlrev_b32 v5, 5, v4
    v_and_b32 v6, 0x70, v3
    v_xor_b32 v5, v5, v6
    v_mul_u32_u24 v4, 7168, v4
    s_mul_i32 s31, s47, 917504
    s_lshl_b32 s32, s46, 7
    s_add_u32 s31, s31, s32
    v_add3_u32 v4, v4, v5, s31
    s_cmp_eq_u32 s75, 0
    s_mov_b32 s31, 917504
    s_cselect_b32 s31, 128, s31
    v_add_u32 v6, s31, v4
    s_mov_b32 vcc_lo, 0xff00ff00
    s_mov_b32 vcc_hi, 0xff00ff00
    v_cndmask_b32 v5, v6, v4, vcc
    v_cndmask_b32 v4, v4, v6, vcc
    s_mov_b32 s48, 0
    s_mov_b32 s49, 76800
    s_waitcnt lgkmcnt(0)
    s_mov_b32 s16, s38
    s_mov_b32 s17, s39
    s_load_dwordx2 s[28:29], s[12:13], 0
    s_load_dwordx2 s[24:25], s[0:1], 72
    s_load_dwordx2 s[44:45], s[0:1], 80
    s_barrier
    s_cmp_ge_u32 s2, 224
    s_cselect_b32 s66, 0, 1
    s_cbranch_scc1 L_dma_done
    s_cmp_lg_u32 s30, 0
    s_cbranch_scc1 L_dma_done
    s_setprio 3
L_dma:
    s_mov_b32 m0, s49
    s_waitcnt vmcnt(22)
    buffer_load_dwordx4 v4, s[16:19], s48 offen nt lds
    s_add_u32 m0, s49, 32768
    s_add_u32 s49, s49, 1024
    buffer_load_dwordx4 v4, s[20:23], s48 offen nt lds
    s_add_u32 s48, s48, 28672
    s_mov_b32 m0, s49
    s_waitcnt vmcnt(22)
    buffer_load_dwordx4 v4, s[16:19], s48 offen nt lds
    s_add_u32 m0, s49, 32768
    s_add_u32 s49, s49, 1024
    buffer_load_dwordx4 v4, s[20:23], s48 offen nt lds
    s_add_u32 s48, s48, 28672
    s_mov_b32 m0, s49
    s_waitcnt vmcnt(22)
    buffer_load_dwordx4 v5, s[16:19], s48 offen nt lds
    s_add_u32 m0, s49, 32768
    s_add_u32 s49, s49, 1024
    buffer_load_dwordx4 v5, s[20:23], s48 offen nt lds
    s_add_u32 s48, s48, 28672
    s_mov_b32 m0, s49
    s_waitcnt vmcnt(22)
    buffer_load_dwordx4 v5, s[16:19], s48 offen nt lds
    s_add_u32 m0, s49, 32768
    s_add_u32 s49, s49, 1024
    buffer_load_dwordx4 v5, s[20:23], s48 offen nt lds
    s_add_u32 s48, s48, 28672
    s_cmp_lt_u32 s48, 917504
    s_cbranch_scc1 L_dma
    s_branch L_dma_done
L_dft_rest:
    s_mov_b32 s18, 0x400000
    s_mov_b32 s19, 0x00020000
    s_sub_u32 s31, 2047, s52
    s_sub_u32 s32, 2047, s53
    v_mov_b32 v200, s31
    v_writelane_b32 v200, s32, 63
    s_lshl_b32 s31, s30, 2
    v_mov_b32 v201, s31
    s_bfe_u32 s31, s53, 0x20008
    s_lshl_b32 s31, s31, 2
    s_add_u32 s31, s31, 16
    v_writelane_b32 v201, s31, 63
    v_and_b32 v6, 32, v2
    s_lshl_b32 s31, s51, 2
    v_add_u32 v203, s31, v6
    v_lshrrev_b32 v202, 1, v203
    s_lshl_b32 s31, s2, 4
    s_add_u32 s31, s31, 4096
    v_mov_b32 v4, s31
    v_lshlrev_b32 v5, 3, v2
    s_and_b32 s31, s52, 7
    s_lshl_b32 s31, s31, 11
    s_and_b32 s32, s52, 1024
    s_add_u32 s31, s31, s32
    s_and_b32 s32, s52, 0xf8
    s_lshl_b32 s32, s32, 2
    s_add_u32 s31, s31, s32
    s_add_u32 s31, s31, 32768
    v_writelane_b32 v4, s31, 0
    s_add_u32 s31, s31, 16
    v_writelane_b32 v4, s31, 1
    s_and_b32 s31, s53, 7
    s_lshl_b32 s31, s31, 11
    s_and_b32 s32, s53, 1024
    s_add_u32 s31, s31, s32
    s_and_b32 s32, s53, 0xf8
    s_lshl_b32 s32, s32, 2
    s_add_u32 s31, s31, s32
    s_add_u32 s31, s31, 32768
    v_writelane_b32 v4, s31, 2
    s_add_u32 s31, s31, 16
    v_writelane_b32 v4, s31, 3
    s_mul_i32 s31, s51, 2592
    v_and_b32 v204, 32, v2
    v_lshlrev_b32 v204, 2, v204
    v_add3_u32 v204, v204, v3, s31
    s_lshl_b32 s32, s31, 1
    s_add_u32 s32, s32, 21872
    v_sub_u32 v205, s32, v204
    v_bfe_u32 v206, v2, 2, 2
    v_mul_u32_u24 v206, 2592, v206
    v_lshrrev_b32 v6, 4, v2
    v_mul_u32_u24 v7, 640, v6
    v_add_u32 v206, v206, v7
    v_and_b32 v7, 3, v2
    v_lshlrev_b32 v7, 3, v7
    s_lshl_b32 s31, s30, 7
    v_add3_u32 v206, v206, v7, s31
    v_lshlrev_b32 v6, 12, v6
    v_and_b32 v7, 15, v2
    v_lshl_add_u32 v6, v7, 4, v6
    s_lshl_b32 s31, s30, 8
    v_add_u32 v207, s31, v6
    v_bfe_i32 v208, v2, 4, 1
    v_and_b32 v208, 0x80008000, v208
    s_cmp_eq_u32 s47, 0
    s_movk_i32 s48, 0x7403
    s_cselect_b32 s48, 0x7721, s48
    v_and_b32 v250, 12, v2
    v_bfe_u32 v250, s48, v250, 4
    v_lshrrev_b32 v251, 4, v2
    v_bfe_u32 v252, v2, 1, 1
    v_mul_u32_u24 v251, v251, v252
    v_and_b32 v252, 1, v2
    v_add_u32 v251, v251, v252
    v_cvt_f32_u32 v250, v250
    v_cvt_f32_u32 v251, v251
    v_mul_f32 v250, 0x3e000000, v250
    v_mul_f32 v251, 0x3e800000, v251
    v_cos_f32 v8, v251
    v_add_f32 v251, v251, v250
    v_cos_f32 v9, v251
    v_add_f32 v251, v251, v250
    v_cos_f32 v10, v251
    v_add_f32 v251, v251, v250
    v_cos_f32 v11, v251
    v_add_f32 v251, v251, v250
    v_cos_f32 v12, v251
    v_add_f32 v251, v251, v250
    v_cos_f32 v13, v251
    v_add_f32 v251, v251, v250
    v_cos_f32 v14, v251
    v_add_f32 v251, v251, v250
    v_cos_f32 v15, v251
    v_mul_f32 v8, 0xbf317218, v8
    v_mul_f32 v9, 0xbf317218, v9
    v_mul_f32 v10, 0xbf317218, v10
    v_mul_f32 v11, 0xbf317218, v11
    v_mul_f32 v12, 0xbf317218, v12
    v_mul_f32 v13, 0xbf317218, v13
    v_mul_f32 v14, 0xbf317218, v14
    v_mul_f32 v15, 0xbf317218, v15
    v_lshrrev_b32 v250, 2, v2
    v_and_b32 v250, 12, v250
    v_and_b32 v251, 15, v2
    v_lshlrev_b32 v251, 2, v251
    v_cvt_f32_u32 v250, v250
    v_cvt_f32_u32 v251, v251
    v_mul_f32 v212, 0x3c800000, v250
    s_lshl_b32 s31, s30, 2
    s_lshr_b32 s48, s48, s31
    s_and_b32 s48, s48, 15
    s_sub_u32 s31, s48, 4
    s_mul_i32 s31, s31, s46
    v_cvt_f32_i32 v252, s31
    v_mul_f32 v252, 0x3a000000, v252
    v_add_f32 v213, 0x3c800000, v212
    v_add_f32 v214, 0x3d000000, v212
    v_add_f32 v215, 0x3d400000, v212
    s_and_b32 s31, s2, 7
    s_sub_u32 s32, 8, s31
    s_min_u32 s76, s31, s32
    s_cmp_gt_u32 s31, 4
    s_cselect_b32 s31, 16, 0
    s_lshr_b32 s77, s2, 4
    s_add_u32 s77, s77, s31
    s_bfe_u32 s78, s2, 0x10003
    s_lshl_b32 s78, s78, 7
    s_add_u32 s78, s78, s31
    s_lshl_b32 s31, s30, 5
    s_add_u32 s78, s78, s31
    s_lshl_b32 s78, s78, 3
    s_add_u32 s78, s78, s76
    s_lshl_b32 s77, s77, 6
    s_sub_u32 s79, 1984, s77
    s_lshl_b32 s76, s76, 1
    s_add_u32 s76, s76, 2040
    v_and_b32 v116, 15, v2
    v_lshl_add_u32 v116, v116, 3, s78
    s_mov_b32 vcc_lo, 0
    s_mov_b32 vcc_hi, -1
    v_sub_u32 v7, s76, v116
    v_cndmask_b32 v7, v116, v7, vcc
    s_mov_b32 vcc_lo, 0xffff0000
    s_mov_b32 vcc_hi, 0xffff0000
    v_sub_u32 v6, 0, v7
    v_cndmask_b32 v7, v7, v6, vcc
    v_and_b32 v6, 7, v7
    v_and_b32 v1, 1024, v7
    v_lshl_add_u32 v6, v6, 11, v1
    v_and_b32 v1, 0xf8, v7
    v_lshl_add_u32 v6, v1, 2, v6
    v_bfe_u32 v1, v7, 9, 1
    v_lshl_add_u32 v119, v1, 4, v6
    v_and_b32 v1, 256, v7
    v_cmp_ne_u32 s[88:89], 0, v1
    v_lshrrev_b32 v118, 2, v2
    v_lshl_add_u32 v118, v118, 3, s78
    v_lshlrev_b32 v1, 1, v2
    v_xor_b32 v1, v1, v3
    v_and_b32 v1, 48, v1
    v_sub_u32 v113, 0, v118
    v_sub_u32 v114, s76, v118
    v_and_b32 v113, 2047, v113
    v_sub_u32 v115, 2048, v114
    v_add_u32 v112, s77, v1
    v_lshl_add_u32 v114, v114, 11, v112
    v_lshl_add_u32 v112, v118, 11, v112
    v_xor_b32 v1, 48, v1
    v_add_u32 v1, s79, v1
    v_lshl_add_u32 v113, v113, 11, v1
    v_lshl_add_u32 v115, v115, 11, v1
    s_lshl_b32 s76, s30, 12
    s_add_u32 s76, s76, 142336
    v_and_b32 v1, 15, v2
    v_lshlrev_b32 v6, 6, v1
    v_lshlrev_b32 v1, 3, v2
    v_xor_b32 v1, v1, v2
    v_and_b32 v1, 48, v1
    v_add3_u32 v117, v6, v1, s76
    v_mul_f32 v250, v212, v251
    v_fmamk_f32 v52, v250, 0x3d800000, v252
    v_sin_f32 v20, v250
    v_cos_f32 v250, v250
    v_cos_f32 v48, v52
    v_sin_f32 v52, v52
    v_cvt_pk_f16_f32 v16, v250, v20
    v_cvt_pk_f16_f32 v20, -v20, v250
    v_mul_f32 v250, v213, v251
    v_fmamk_f32 v53, v250, 0x3d800000, v252
    v_sin_f32 v21, v250
    v_cos_f32 v250, v250
    v_cos_f32 v49, v53
    v_sin_f32 v53, v53
    v_cvt_pk_f16_f32 v17, v250, v21
    v_cvt_pk_f16_f32 v21, -v21, v250
    v_mul_f32 v250, v214, v251
    v_fmamk_f32 v54, v250, 0x3d800000, v252
    v_sin_f32 v22, v250
    v_cos_f32 v250, v250
    v_cos_f32 v50, v54
    v_sin_f32 v54, v54
    v_cvt_pk_f16_f32 v18, v250, v22
    v_cvt_pk_f16_f32 v22, -v22, v250
    v_mul_f32 v250, v215, v251
    v_fmamk_f32 v55, v250, 0x3d800000, v252
    v_sin_f32 v23, v250
    v_cos_f32 v250, v250
    v_cos_f32 v51, v55
    v_sin_f32 v55, v55
    v_cvt_pk_f16_f32 v19, v250, v23
    v_cvt_pk_f16_f32 v23, -v23, v250
    v_add_f32 v251, 1.0, v251
    v_mul_f32 v250, v212, v251
    v_fmamk_f32 v60, v250, 0x3d800000, v252
    v_sin_f32 v28, v250
    v_cos_f32 v250, v250
    v_cos_f32 v56, v60
    v_sin_f32 v60, v60
    v_cvt_pk_f16_f32 v24, v250, v28
    v_cvt_pk_f16_f32 v28, -v28, v250
    v_mul_f32 v250, v213, v251
    v_fmamk_f32 v61, v250, 0x3d800000, v252
    v_sin_f32 v29, v250
    v_cos_f32 v250, v250
    v_cos_f32 v57, v61
    v_sin_f32 v61, v61
    v_cvt_pk_f16_f32 v25, v250, v29
    v_cvt_pk_f16_f32 v29, -v29, v250
    v_mul_f32 v250, v214, v251
    v_fmamk_f32 v62, v250, 0x3d800000, v252
    v_sin_f32 v30, v250
    v_cos_f32 v250, v250
    v_cos_f32 v58, v62
    v_sin_f32 v62, v62
    v_cvt_pk_f16_f32 v26, v250, v30
    v_cvt_pk_f16_f32 v30, -v30, v250
    v_mul_f32 v250, v215, v251
    v_fmamk_f32 v63, v250, 0x3d800000, v252
    v_sin_f32 v31, v250
    v_cos_f32 v250, v250
    v_cos_f32 v59, v63
    v_sin_f32 v63, v63
    v_cvt_pk_f16_f32 v27, v250, v31
    v_cvt_pk_f16_f32 v31, -v31, v250
    v_add_f32 v251, 1.0, v251
    v_mov_b32 v160, 0
    v_mov_b32 v161, 0
    v_mov_b32 v162, 0
    v_mov_b32 v163, 0
    v_mov_b32 v164, 0
    v_mov_b32 v165, 0
    v_mov_b32 v166, 0
    v_mov_b32 v167, 0
    v_mov_b32 v168, 0
    v_mov_b32 v169, 0
    v_mov_b32 v170, 0
    s_mov_b32 s57, 0x3f803f80
    s_mov_b32 s59, 0xffff
    s_brev_b32 s67, 1
    s_mov_b32 s66, 0
    s_brev_b32 s64, 1
    s_brev_b32 s65, 1
    s_cmp_eq_u32 s47, 0
    s_movk_i32 s62, -10368
    s_cselect_b32 s62, 10368, s62
    s_waitcnt lgkmcnt(0)
    s_add_u32 s28, s28, 0x7f4a7c15
    s_addc_u32 s29, s29, 0x9e3779b9
    v_mov_b32 v174, s28
    v_mov_b32 v175, s29
    s_cmp_lt_u32 s2, 224
    s_cbranch_scc1 L_epoch_ok
L_sync1:
    ds_read_b32 v1, v0 offset:42872
    s_waitcnt lgkmcnt(0)
    v_readfirstlane_b32 s31, v1
    s_nop 0
    s_cmp_ge_u32 s31, 4
    s_cbranch_scc0 L_sync1
L_epoch_ok:
    s_setprio 2
    s_waitcnt vmcnt(8)
    v_dot2c_f32_bf16 v160, s57, v120
    v_dot2c_f32_bf16 v164, v120, v120
    v_dot2c_f32_bf16 v160, s57, v121
    v_dot2c_f32_bf16 v164, v121, v121
    v_dot2c_f32_bf16 v160, s57, v122
    v_dot2c_f32_bf16 v164, v122, v122
    v_dot2c_f32_bf16 v160, s57, v123
    v_dot2c_f32_bf16 v164, v123, v123
    v_dot2c_f32_bf16 v160, s57, v124
    v_dot2c_f32_bf16 v164, v124, v124
    v_dot2c_f32_bf16 v160, s57, v125
    v_dot2c_f32_bf16 v164, v125, v125
    v_dot2c_f32_bf16 v160, s57, v126
    v_dot2c_f32_bf16 v164, v126, v126
    v_dot2c_f32_bf16 v160, s57, v127
    v_dot2c_f32_bf16 v164, v127, v127
    s_waitcnt vmcnt(6)
    v_dot2c_f32_bf16 v161, s57, v128
    v_dot2c_f32_bf16 v165, v128, v128
    v_dot2c_f32_bf16 v161, s57, v129
    v_dot2c_f32_bf16 v165, v129, v129
    v_dot2c_f32_bf16 v161, s57, v130
    v_dot2c_f32_bf16 v165, v130, v130
    v_dot2c_f32_bf16 v161, s57, v131
    v_dot2c_f32_bf16 v165, v131, v131
    v_dot2c_f32_bf16 v161, s57, v132
    v_dot2c_f32_bf16 v165, v132, v132
    v_dot2c_f32_bf16 v161, s57, v133
    v_dot2c_f32_bf16 v165, v133, v133
    v_dot2c_f32_bf16 v161, s57, v134
    v_dot2c_f32_bf16 v165, v134, v134
    v_dot2c_f32_bf16 v161, s57, v135
    v_dot2c_f32_bf16 v165, v135, v135
    s_waitcnt vmcnt(4)
    v_dot2c_f32_bf16 v170, s57, v152
    v_dot2c_f32_bf16 v170, s57, v153
    v_dot2c_f32_bf16 v170, s57, v154
    v_dot2c_f32_bf16 v170, s57, v155
    v_dot2c_f32_bf16 v170, s57, v156
    v_dot2c_f32_bf16 v170, s57, v157
    v_dot2c_f32_bf16 v170, s57, v158
    v_dot2c_f32_bf16 v170, s57, v159
    v_dot2c_f32_bf16 v168, v152, v120
    v_dot2c_f32_bf16 v169, v152, v128
    v_dot2c_f32_bf16 v168, v153, v121
    v_dot2c_f32_bf16 v169, v153, v129
    v_dot2c_f32_bf16 v168, v154, v122
    v_dot2c_f32_bf16 v169, v154, v130
    v_dot2c_f32_bf16 v168, v155, v123
    v_dot2c_f32_bf16 v169, v155, v131
    v_mov_b32 v171, v170
    v_dot2c_f32_bf16 v168, v156, v124
    v_dot2c_f32_bf16 v169, v156, v132
    v_dot2c_f32_bf16 v168, v157, v125
    v_dot2c_f32_bf16 v169, v157, v133
    v_dot2c_f32_bf16 v168, v158, v126
    v_dot2c_f32_bf16 v169, v158, v134
    v_dot2c_f32_bf16 v168, v159, v127
    v_dot2c_f32_bf16 v169, v159, v135
    v_permlane32_swap_b32 v160, v161
    v_permlane32_swap_b32 v164, v165
    v_permlane32_swap_b32 v170, v171
    v_permlane32_swap_b32 v168, v169
    v_add_f32 v160, v160, v161
    v_add_f32 v164, v164, v165
    v_add_f32 v170, v170, v171
    v_add_f32 v168, v168, v169
    v_add_f32_dpp v160, v160, v160 row_shr:1 row_mask:0xf bank_mask:0xf
    v_add_f32_dpp v164, v164, v164 row_shr:1 row_mask:0xf bank_mask:0xf
    v_add_f32_dpp v170, v170, v170 row_shr:1 row_mask:0xf bank_mask:0xf
    v_add_f32_dpp v168, v168, v168 row_shr:1 row_mask:0xf bank_mask:0xf
    v_add_f32_dpp v160, v160, v160 row_shr:2 row_mask:0xf bank_mask:0xf
    v_add_f32_dpp v164, v164, v164 row_shr:2 row_mask:0xf bank_mask:0xf
    v_add_f32_dpp v170, v170, v170 row_shr:2 row_mask:0xf bank_mask:0xf
    v_add_f32_dpp v168, v168, v168 row_shr:2 row_mask:0xf bank_mask:0xf
    v_add_f32_dpp v160, v160, v160 row_shr:4 row_mask:0xf bank_mask:0xf
    v_add_f32_dpp v164, v164, v164 row_shr:4 row_mask:0xf bank_mask:0xf
    v_add_f32_dpp v170, v170, v170 row_shr:4 row_mask:0xf bank_mask:0xf
    v_add_f32_dpp v168, v168, v168 row_shr:4 row_mask:0xf bank_mask:0xf
    v_add_f32_dpp v160, v160, v160 row_shr:8 row_mask:0xf bank_mask:0xf
    v_add_f32_dpp v164, v164, v164 row_shr:8 row_mask:0xf bank_mask:0xf
    v_add_f32_dpp v170, v170, v170 row_shr:8 row_mask:0xf bank_mask:0xf
    v_add_f32_dpp v168, v168, v168 row_shr:8 row_mask:0xf bank_mask:0xf
    v_add_f32_dpp v160, v160, v160 row_bcast:15 row_mask:0xa bank_mask:0xf
    v_add_f32_dpp v164, v164, v164 row_bcast:15 row_mask:0xa bank_mask:0xf
    v_add_f32_dpp v170, v170, v170 row_bcast:15 row_mask:0xa bank_mask:0xf
    v_add_f32_dpp v168, v168, v168 row_bcast:15 row_mask:0xa bank_mask:0xf
    v_mul_f32 v160, 0x3a800000, v160
    v_mul_f32 v164, 0x3a800000, v164
    v_fma_f32 v164, -v160, v160, v164
    v_cvt_pk_bf16_f32 v161, -v160, -v160
    v_max_f32 v164, 0, v164
    v_cvt_pk_bf16_f32 v164, v164, v164
    v_and_b32 v164, 0xffff0000, v164
    v_add_f32 v164, 0x3727c5ac, v164
    v_cvt_pk_bf16_f32 v164, v164, v164
    v_and_b32 v164, 0xffff0000, v164
    v_sqrt_f32 v164, v164
    v_and_b32 v165, 0xffff0000, v161
    v_cvt_pk_bf16_f32 v248, v160, v164
    v_and_b32 v164, 0xffff0000, v248
    v_rcp_f32 v164, v164
    v_fmac_f32 v168, v170, v165
    v_mul_f32 v168, v168, v164
    v_ashrrev_i32 v170, 31, v168
    v_or_b32 v170, 0x80000000, v170
    v_xor_b32 v168, v168, v170
    v_and_b32 v168, 0xfffff800, v168
    v_or_b32 v249, v200, v168
    s_mov_b64 exec, s[64:65]
    ds_write_b32 v201, v248 offset:41472
    ds_max_u64 v0, v[248:249] offset:41504
    s_mov_b64 exec, 1
    ds_add_rtn_u32 v1, v0, v255 offset:42816
    s_mov_b64 exec, 31
    ds_read_b64 v[172:173], v5 offset:41472
    s_mov_b64 exec, s[64:65]
    ds_write_b16 v202, v161 offset:41568
    ds_write_b32 v203, v164 offset:42752
    s_mov_b64 exec, -1
    v_mov_b32_dpp v6, v128 wave_rol:1 row_mask:0xf bank_mask:0xf
    v_mov_b32_dpp v7, v132 wave_rol:1 row_mask:0xf bank_mask:0xf
    v_bfi_b32 v221, s59, v131, v130
    v_bfi_b32 v222, s59, v130, v129
    v_bfi_b32 v223, s59, v129, v128
    v_bfi_b32 v217, s59, v135, v134
    v_bfi_b32 v218, s59, v134, v133
    v_bfi_b32 v219, s59, v133, v132
    v_cndmask_b32 v220, v6, v7, s[66:67]
    v_cndmask_b32 v216, v7, v6, s[66:67]
    v_bfi_b32 v220, s59, v220, v131
    v_bfi_b32 v216, s59, v216, v135
    s_waitcnt lgkmcnt(2)
    v_readfirstlane_b32 s31, v1
    s_nop 0
    s_cmp_lg_u32 s31, 3
    s_cbranch_scc1 L_not_last
    s_mov_b64 exec, 31
    buffer_store_dwordx4 v[172:175], v4, s[12:15], 0 offen sc1
    s_mov_b64 exec, -1
    s_waitcnt vmcnt(1)
    s_branch L_b_ready
L_not_last:
    s_waitcnt vmcnt(0)
L_b_ready:
    s_setprio 1
    ds_write_b128 v204, v[120:123] offset:0
    ds_write_b128 v204, v[124:127] offset:1280
    s_cmp_lg_u32 s50, 0
    s_cbranch_scc1 L_plain1
    ds_write_b128 v205, v[216:219]
    ds_write_b128 v205, v[220:223] offset:1280
    s_branch L_second1
L_plain1:
    ds_write_b128 v204, v[128:131] offset:20736
    ds_write_b128 v204, v[132:135] offset:22016
L_second1:
    v_add_u32 v204, s62, v204
    v_add_u32 v205, s62, v205
    v_dot2c_f32_bf16 v162, s57, v136
    v_dot2c_f32_bf16 v166, v136, v136
    v_dot2c_f32_bf16 v162, s57, v137
    v_dot2c_f32_bf16 v166, v137, v137
    v_dot2c_f32_bf16 v162, s57, v138
    v_dot2c_f32_bf16 v166, v138, v138
    v_dot2c_f32_bf16 v162, s57, v139
    v_dot2c_f32_bf16 v166, v139, v139
    v_dot2c_f32_bf16 v162, s57, v140
    v_dot2c_f32_bf16 v166, v140, v140
    v_dot2c_f32_bf16 v162, s57, v141
    v_dot2c_f32_bf16 v166, v141, v141
    v_dot2c_f32_bf16 v162, s57, v142
    v_dot2c_f32_bf16 v166, v142, v142
    v_dot2c_f32_bf16 v162, s57, v143
    v_dot2c_f32_bf16 v166, v143, v143
    ds_write_b128 v204, v[136:139] offset:0
    ds_write_b128 v204, v[140:143] offset:1280
    v_dot2c_f32_bf16 v163, s57, v144
    v_dot2c_f32_bf16 v167, v144, v144
    v_dot2c_f32_bf16 v163, s57, v145
    v_dot2c_f32_bf16 v167, v145, v145
    v_dot2c_f32_bf16 v163, s57, v146
    v_dot2c_f32_bf16 v167, v146, v146
    v_dot2c_f32_bf16 v163, s57, v147
    v_dot2c_f32_bf16 v167, v147, v147
    v_dot2c_f32_bf16 v163, s57, v148
    v_dot2c_f32_bf16 v167, v148, v148
    v_dot2c_f32_bf16 v163, s57, v149
    v_dot2c_f32_bf16 v167, v149, v149
    v_dot2c_f32_bf16 v163, s57, v150
    v_dot2c_f32_bf16 v167, v150, v150
    v_dot2c_f32_bf16 v163, s57, v151
    v_dot2c_f32_bf16 v167, v151, v151
    v_xor_b32 v202, 8, v202
    v_xor_b32 v203, 16, v203
    s_waitcnt lgkmcnt(2)
    v_mov_b32_dpp v6, v144 wave_rol:1 row_mask:0xf bank_mask:0xf
    v_mov_b32_dpp v7, v148 wave_rol:1 row_mask:0xf bank_mask:0xf
    v_bfi_b32 v221, s59, v147, v146
    v_bfi_b32 v222, s59, v146, v145
    v_bfi_b32 v223, s59, v145, v144
    v_bfi_b32 v217, s59, v151, v150
    v_bfi_b32 v218, s59, v150, v149
    v_bfi_b32 v219, s59, v149, v148
    v_cndmask_b32 v220, v6, v7, s[66:67]
    v_cndmask_b32 v216, v7, v6, s[66:67]
    v_bfi_b32 v220, s59, v220, v147
    v_bfi_b32 v216, s59, v216, v151
    s_cmp_lg_u32 s50, 0
    s_cbranch_scc1 L_plain3
    ds_write_b128 v205, v[216:219]
    ds_write_b128 v205, v[220:223] offset:1280
    s_branch L_second3
L_plain3:
    ds_write_b128 v204, v[144:147] offset:20736
    ds_write_b128 v204, v[148:151] offset:22016
L_second3:
    v_permlane32_swap_b32 v162, v163
    v_permlane32_swap_b32 v166, v167
    v_add_f32 v162, v162, v163
    v_add_f32 v166, v166, v167
    s_nop 0
    v_add_f32_dpp v162, v162, v162 row_shr:1 row_mask:0xf bank_mask:0xf
    v_add_f32_dpp v166, v166, v166 row_shr:1 row_mask:0xf bank_mask:0xf
    s_nop 0
    v_add_f32_dpp v162, v162, v162 row_shr:2 row_mask:0xf bank_mask:0xf
    v_add_f32_dpp v166, v166, v166 row_shr:2 row_mask:0xf bank_mask:0xf
    s_nop 0
    v_add_f32_dpp v162, v162, v162 row_shr:4 row_mask:0xf bank_mask:0xf
    v_add_f32_dpp v166, v166, v166 row_shr:4 row_mask:0xf bank_mask:0xf
    s_nop 0
    v_add_f32_dpp v162, v162, v162 row_shr:8 row_mask:0xf bank_mask:0xf
    v_add_f32_dpp v166, v166, v166 row_shr:8 row_mask:0xf bank_mask:0xf
    s_nop 0
    v_add_f32_dpp v162, v162, v162 row_bcast:15 row_mask:0xa bank_mask:0xf
    v_add_f32_dpp v166, v166, v166 row_bcast:15 row_mask:0xa bank_mask:0xf
    v_mul_f32 v162, 0x3a800000, v162
    v_mul_f32 v166, 0x3a800000, v166
    v_fma_f32 v166, -v162, v162, v166
    v_cvt_pk_bf16_f32 v161, -v162, -v162
    v_max_f32 v166, 0, v166
    v_cvt_pk_bf16_f32 v166, v166, v166
    v_and_b32 v166, 0xffff0000, v166
    v_add_f32 v166, 0x3727c5ac, v166
    v_cvt_pk_bf16_f32 v166, v166, v166
    v_and_b32 v166, 0xffff0000, v166
    v_sqrt_f32 v166, v166
    v_and_b32 v167, 0xffff0000, v161
    v_cvt_pk_bf16_f32 v248, v162, v166
    v_and_b32 v166, 0xffff0000, v248
    v_rcp_f32 v166, v166
    s_mov_b64 exec, s[64:65]
    ds_write_b16 v202, v161 offset:41568
    ds_write_b32 v203, v166 offset:42752
    s_mov_b64 exec, 1
    ds_add_u32 v0, v255 offset:42820
    s_mov_b64 exec, -1
L_sync2:
    ds_read_b32 v1, v0 offset:42820
    s_waitcnt lgkmcnt(0)
    v_readfirstlane_b32 s31, v1
    s_nop 0
    s_cmp_ge_u32 s31, 4
    s_cbranch_scc0 L_sync2
    s_add_u32 m0, s76, 0
    s_nop 0
    buffer_load_dwordx4 v112, s[8:11], 0 offen lds
    s_add_u32 m0, s76, 1024
    s_nop 0
    buffer_load_dwordx4 v113, s[8:11], 0 offen lds
    ds_read_b128 v[176:179], v0 offset:42752
    ds_read_b128 v[180:183], v0 offset:42768
    ds_read_b128 v[184:187], v0 offset:42784
    ds_read_b128 v[188:191], v0 offset:42800
    ds_read_b128 v[192:195], v0 offset:41568
    ds_read_b128 v[196:199], v0 offset:41584
    ds_read_b64_tr_b16 v[120:121], v206 offset:0
    ds_read_b64_tr_b16 v[122:123], v206 offset:10368
    ds_read_b64_tr_b16 v[124:125], v206 offset:20736
    ds_read_b64_tr_b16 v[126:127], v206 offset:31104
    ds_read_b64_tr_b16 v[128:129], v206 offset:32
    ds_read_b64_tr_b16 v[130:131], v206 offset:10400
    ds_read_b64_tr_b16 v[132:133], v206 offset:20768
    ds_read_b64_tr_b16 v[134:135], v206 offset:31136
    s_waitcnt lgkmcnt(10)
    ds_read_b64_tr_b16 v[136:137], v206 offset:64
    ds_read_b64_tr_b16 v[138:139], v206 offset:10432
    ds_read_b64_tr_b16 v[140:141], v206 offset:20800
    ds_read_b64_tr_b16 v[142:143], v206 offset:31168
    v_pk_mul_f32 v[176:177], v[176:177], v[8:9]
    v_pk_mul_f32 v[178:179], v[178:179], v[10:11]
    v_pk_mul_f32 v[180:181], v[180:181], v[12:13]
    v_pk_mul_f32 v[182:183], v[182:183], v[14:15]
    v_pk_mul_f32 v[184:185], v[184:185], v[8:9]
    v_pk_mul_f32 v[186:187], v[186:187], v[10:11]
    v_pk_mul_f32 v[188:189], v[188:189], v[12:13]
    v_pk_mul_f32 v[190:191], v[190:191], v[14:15]
    v_cvt_pk_bf16_f32 v160, v176, v177
    v_cvt_pk_bf16_f32 v152, v184, v185
    v_cvt_pk_bf16_f32 v161, v178, v179
    v_cvt_pk_bf16_f32 v153, v186, v187
    v_cvt_pk_bf16_f32 v162, v180, v181
    v_cvt_pk_bf16_f32 v154, v188, v189
    v_cvt_pk_bf16_f32 v163, v182, v183
    v_cvt_pk_bf16_f32 v155, v190, v191
    v_xor_b32 v164, v208, v160
    v_xor_b32 v156, v208, v152
    v_xor_b32 v165, v208, v161
    v_xor_b32 v157, v208, v153
    v_xor_b32 v166, v208, v162
    v_xor_b32 v158, v208, v154
    v_xor_b32 v167, v208, v163
    v_xor_b32 v159, v208, v155
    s_waitcnt lgkmcnt(12)
    s_cmp_lg_u32 s50, 0
    s_cbranch_scc1 L_st1_split
    v_mfma_f32_16x16x32_bf16 v[168:171], v[160:163], v[192:195], 0
    v_mfma_f32_16x16x32_bf16 v[168:171], v[152:155], v[196:199], v[168:171]
    s_waitcnt lgkmcnt(10)
    ds_read_b64_tr_b16 v[144:145], v206 offset:96
    ds_read_b64_tr_b16 v[146:147], v206 offset:10464
    ds_read_b64_tr_b16 v[148:149], v206 offset:20832
    ds_read_b64_tr_b16 v[150:151], v206 offset:31200
    v_mfma_f32_16x16x32_bf16 v[216:219], v[160:163], v[120:123], v[168:171]
    s_waitcnt lgkmcnt(12)
    v_mfma_f32_16x16x32_bf16 v[216:219], v[152:155], v[124:127], v[216:219]
    s_waitcnt lgkmcnt(10)
    v_mfma_f32_16x16x32_bf16 v[224:227], v[160:163], v[128:131], v[168:171]
    s_waitcnt lgkmcnt(8)
    v_mfma_f32_16x16x32_bf16 v[224:227], v[152:155], v[132:135], v[224:227]
    s_waitcnt lgkmcnt(6)
    v_mfma_f32_16x16x32_bf16 v[232:235], v[160:163], v[136:139], v[168:171]
    s_waitcnt lgkmcnt(4)
    v_mfma_f32_16x16x32_bf16 v[232:235], v[152:155], v[140:143], v[232:235]
    s_waitcnt lgkmcnt(2)
    v_mfma_f32_16x16x32_bf16 v[240:243], v[160:163], v[144:147], v[168:171]
    s_waitcnt lgkmcnt(0)
    v_mfma_f32_16x16x32_bf16 v[240:243], v[152:155], v[148:151], v[240:243]
    v_mfma_f32_16x16x32_bf16 v[220:223], v[164:167], v[120:123], 0
    v_mfma_f32_16x16x32_bf16 v[220:223], v[156:159], v[124:127], v[220:223]
    v_mfma_f32_16x16x32_bf16 v[228:231], v[164:167], v[128:131], 0
    v_mfma_f32_16x16x32_bf16 v[228:231], v[156:159], v[132:135], v[228:231]
    v_cvt_pk_f16_f32 v176, v216, v217
    v_cvt_pk_f16_f32 v177, v224, v225
    v_cvt_pk_f16_f32 v178, v232, v233
    s_nop 0
    v_cvt_pk_f16_f32 v179, v240, v241
    ds_write_b128 v207, v[176:179] offset:44032
    v_mfma_f32_16x16x32_bf16 v[236:239], v[164:167], v[136:139], 0
    v_mfma_f32_16x16x32_bf16 v[236:239], v[156:159], v[140:143], v[236:239]
    v_cvt_pk_f16_f32 v180, v218, v219
    v_cvt_pk_f16_f32 v181, v226, v227
    v_cvt_pk_f16_f32 v182, v234, v235
    v_cvt_pk_f16_f32 v183, v242, v243
    ds_write_b128 v207, v[180:183] offset:45056
    v_mfma_f32_16x16x32_bf16 v[244:247], v[164:167], v[144:147], 0
    v_mfma_f32_16x16x32_bf16 v[244:247], v[156:159], v[148:151], v[244:247]
    v_cvt_pk_f16_f32 v184, v220, v221
    v_cvt_pk_f16_f32 v185, v228, v229
    v_cvt_pk_f16_f32 v186, v236, v237
    s_nop 4
    v_cvt_pk_f16_f32 v187, v244, v245
    ds_write_b128 v207, v[184:187] offset:46080
    v_cvt_pk_f16_f32 v188, v222, v223
    v_cvt_pk_f16_f32 v189, v230, v231
    v_cvt_pk_f16_f32 v190, v238, v239
    v_cvt_pk_f16_f32 v191, v246, v247
    ds_write_b128 v207, v[188:191] offset:47104
    s_branch L_st1_done
L_st1_split:
    s_waitcnt lgkmcnt(8)
    ds_read_b64_tr_b16 v[144:145], v206 offset:96
    ds_read_b64_tr_b16 v[146:147], v206 offset:10464
    ds_read_b64_tr_b16 v[148:149], v206 offset:20832
    ds_read_b64_tr_b16 v[150:151], v206 offset:31200
    s_waitcnt lgkmcnt(0)
    v_mfma_f32_16x16x32_bf16 v[168:171], v[160:163], v[192:195], 0
    v_mfma_f32_16x16x32_bf16 v[220:223], v[164:167], v[120:123], 0
    v_mfma_f32_16x16x32_bf16 v[216:219], v[160:163], v[120:123], v[168:171]
    v_mfma_f32_16x16x32_bf16 v[228:231], v[164:167], v[128:131], 0
    v_mfma_f32_16x16x32_bf16 v[224:227], v[160:163], v[128:131], v[168:171]
    v_mfma_f32_16x16x32_bf16 v[236:239], v[164:167], v[136:139], 0
    v_mfma_f32_16x16x32_bf16 v[232:235], v[160:163], v[136:139], v[168:171]
    v_mfma_f32_16x16x32_bf16 v[244:247], v[164:167], v[144:147], 0
    v_mfma_f32_16x16x32_bf16 v[240:243], v[160:163], v[144:147], v[168:171]
    s_nop 1
    v_cvt_pk_f16_f32 v176, v216, v217
    v_cvt_pk_f16_f32 v180, v218, v219
    v_cvt_pk_f16_f32 v184, v220, v221
    v_cvt_pk_f16_f32 v188, v222, v223
    v_cvt_pk_f16_f32 v177, v224, v225
    v_cvt_pk_f16_f32 v181, v226, v227
    v_cvt_pk_f16_f32 v185, v228, v229
    v_cvt_pk_f16_f32 v189, v230, v231
    v_cvt_pk_f16_f32 v178, v232, v233
    v_cvt_pk_f16_f32 v182, v234, v235
    v_cvt_pk_f16_f32 v186, v236, v237
    v_cvt_pk_f16_f32 v190, v238, v239
    v_cvt_pk_f16_f32 v179, v240, v241
    v_cvt_pk_f16_f32 v183, v242, v243
    v_cvt_pk_f16_f32 v187, v244, v245
    v_cvt_pk_f16_f32 v191, v246, v247
    ds_write_b128 v207, v[176:179] offset:44032
    ds_write_b128 v207, v[180:183] offset:45056
    ds_write_b128 v207, v[184:187] offset:46080
    ds_write_b128 v207, v[188:191] offset:47104
    v_mfma_f32_16x16x32_bf16 v[168:171], v[152:155], v[196:199], 0
    v_mfma_f32_16x16x32_bf16 v[220:223], v[156:159], v[124:127], 0
    v_mfma_f32_16x16x32_bf16 v[216:219], v[152:155], v[124:127], v[168:171]
    v_mfma_f32_16x16x32_bf16 v[228:231], v[156:159], v[132:135], 0
    v_mfma_f32_16x16x32_bf16 v[224:227], v[152:155], v[132:135], v[168:171]
    v_mfma_f32_16x16x32_bf16 v[236:239], v[156:159], v[140:143], 0
    v_mfma_f32_16x16x32_bf16 v[232:235], v[152:155], v[140:143], v[168:171]
    v_mfma_f32_16x16x32_bf16 v[244:247], v[156:159], v[148:151], 0
    v_mfma_f32_16x16x32_bf16 v[240:243], v[152:155], v[148:151], v[168:171]
    s_waitcnt lgkmcnt(0)
    s_nop 0
    v_cvt_pk_f16_f32 v176, v216, v217
    v_cvt_pk_f16_f32 v180, v218, v219
    v_cvt_pk_f16_f32 v184, v220, v221
    v_cvt_pk_f16_f32 v188, v222, v223
    v_cvt_pk_f16_f32 v177, v224, v225
    v_cvt_pk_f16_f32 v181, v226, v227
    v_cvt_pk_f16_f32 v185, v228, v229
    v_cvt_pk_f16_f32 v189, v230, v231
    v_cvt_pk_f16_f32 v178, v232, v233
    v_cvt_pk_f16_f32 v182, v234, v235
    v_cvt_pk_f16_f32 v186, v236, v237
    v_cvt_pk_f16_f32 v190, v238, v239
    v_cvt_pk_f16_f32 v179, v240, v241
    v_cvt_pk_f16_f32 v183, v242, v243
    v_cvt_pk_f16_f32 v187, v244, v245
    v_cvt_pk_f16_f32 v191, v246, v247
    ds_write_b128 v207, v[176:179] offset:60416
    ds_write_b128 v207, v[180:183] offset:61440
    ds_write_b128 v207, v[184:187] offset:62464
    ds_write_b128 v207, v[188:191] offset:63488
L_st1_done:
    s_mov_b64 exec, 1
    ds_add_u32 v0, v255 offset:42824
    s_mov_b64 exec, -1
    s_lshl_b32 s31, s30, 12
    v_add_u32 v5, s31, v3
    s_and_b32 s31, s28, 0x30003
    v_mov_b32 v210, s31
    s_mov_b32 s58, 0xfffcfffc
    s_and_b32 s32, s48, 3
    s_cselect_b32 s72, -1, 0xff
    s_cselect_b32 s73, -1, 0
    s_mov_b32 s74, s48
    v_mov_b32 v209, 2147483392
    s_cmp_eq_u32 s48, 7
    s_cbranch_scc1 L_no_consts
    v_mul_f32 v250, v212, v251
    v_fmamk_f32 v68, v250, 0x3d800000, v252
    v_sin_f32 v36, v250
    v_cos_f32 v250, v250
    v_cos_f32 v64, v68
    v_sin_f32 v68, v68
    v_cvt_pk_f16_f32 v32, v250, v36
    v_cvt_pk_f16_f32 v36, -v36, v250
    v_mul_f32 v250, v213, v251
    v_fmamk_f32 v69, v250, 0x3d800000, v252
    v_sin_f32 v37, v250
    v_cos_f32 v250, v250
    v_cos_f32 v65, v69
    v_sin_f32 v69, v69
    v_cvt_pk_f16_f32 v33, v250, v37
    v_cvt_pk_f16_f32 v37, -v37, v250
    v_mul_f32 v250, v214, v251
    v_fmamk_f32 v70, v250, 0x3d800000, v252
    v_sin_f32 v38, v250
    v_cos_f32 v250, v250
    v_cos_f32 v66, v70
    v_sin_f32 v70, v70
    v_cvt_pk_f16_f32 v34, v250, v38
    v_cvt_pk_f16_f32 v38, -v38, v250
    v_mul_f32 v250, v215, v251
    v_fmamk_f32 v71, v250, 0x3d800000, v252
    v_sin_f32 v39, v250
    v_cos_f32 v250, v250
    v_cos_f32 v67, v71
    v_sin_f32 v71, v71
    v_cvt_pk_f16_f32 v35, v250, v39
    v_cvt_pk_f16_f32 v39, -v39, v250
    v_add_f32 v251, 1.0, v251
    v_mul_f32 v250, v212, v251
    v_fmamk_f32 v76, v250, 0x3d800000, v252
    v_sin_f32 v44, v250
    v_cos_f32 v250, v250
    v_cos_f32 v72, v76
    v_sin_f32 v76, v76
    v_cvt_pk_f16_f32 v40, v250, v44
    v_cvt_pk_f16_f32 v44, -v44, v250
    v_mul_f32 v250, v213, v251
    v_fmamk_f32 v77, v250, 0x3d800000, v252
    v_sin_f32 v45, v250
    v_cos_f32 v250, v250
    v_cos_f32 v73, v77
    v_sin_f32 v77, v77
    v_cvt_pk_f16_f32 v41, v250, v45
    v_cvt_pk_f16_f32 v45, -v45, v250
    v_mul_f32 v250, v214, v251
    v_fmamk_f32 v78, v250, 0x3d800000, v252
    v_sin_f32 v46, v250
    v_cos_f32 v250, v250
    v_cos_f32 v74, v78
    v_sin_f32 v78, v78
    v_cvt_pk_f16_f32 v42, v250, v46
    v_cvt_pk_f16_f32 v46, -v46, v250
    v_mul_f32 v250, v215, v251
    v_fmamk_f32 v79, v250, 0x3d800000, v252
    v_sin_f32 v47, v250
    v_cos_f32 v250, v250
    v_cos_f32 v75, v79
    v_sin_f32 v79, v79
    v_cvt_pk_f16_f32 v43, v250, v47
    v_cvt_pk_f16_f32 v47, -v47, v250
    s_and_b32 s31, s46, 1
    s_lshl_b32 s31, s31, 6
    s_lshr_b32 s32, s46, 1
    s_add_u32 s49, s31, s32
    s_bitcmp1_b32 s49, 2
    s_cselect_b64 vcc, -1, 0
    v_cndmask_b32 v80, v16, v20, vcc
    v_cndmask_b32 v84, v20, v16, vcc
    v_cndmask_b32 v81, v17, v21, vcc
    v_cndmask_b32 v85, v21, v17, vcc
    v_cndmask_b32 v82, v18, v22, vcc
    v_cndmask_b32 v86, v22, v18, vcc
    v_cndmask_b32 v83, v19, v23, vcc
    v_cndmask_b32 v87, v23, v19, vcc
    s_bfe_u32 s31, s49, 0x10001
    v_and_b32 v6, 7, v2
    v_xor_b32 v6, s31, v6
    v_lshlrev_b32 v6, 4, v6
    v_lshrrev_b32 v7, 4, v2
    v_lshlrev_b32 v7, 3, v7
    v_bfe_u32 v209, v2, 3, 1
    v_add_u32 v7, v7, v209
    v_mul_u32_u24 v7, 16512, v7
    v_add_u32 v209, v6, v7
    s_mul_i32 s31, s48, 528384
    s_lshl_b32 s32, s49, 7
    s_add_u32 s31, s31, s32
    s_add_u32 s60, s31, 2097152
L_no_consts:
L_sync3:
    ds_read_b32 v1, v0 offset:42824
    s_waitcnt lgkmcnt(0)
    v_readfirstlane_b32 s31, v1
    s_nop 0
    s_cmp_ge_u32 s31, 4
    s_cbranch_scc0 L_sync3
    s_cmp_eq_u32 s48, 7
    s_cbranch_scc1 L_p1_done
L_st23:
    ds_read_b128 v[120:123], v5 offset:44032
    ds_read_b128 v[124:127], v5 offset:45056
    ds_read_b128 v[128:131], v5 offset:46080
    ds_read_b128 v[132:135], v5 offset:47104
    s_add_u32 s61, s60, 33024
    s_add_u32 s62, s61, 33024
    s_add_u32 s63, s62, 33024
    s_waitcnt lgkmcnt(3)
    v_mfma_f32_16x16x32_f16 v[136:139], v[120:123], v[16:19], 0
    v_mfma_f32_16x16x32_f16 v[140:143], v[120:123], v[20:23], 0
    s_waitcnt lgkmcnt(2)
    v_mfma_f32_16x16x32_f16 v[144:147], v[124:127], v[24:27], 0
    v_mfma_f32_16x16x32_f16 v[148:151], v[124:127], v[28:31], 0
    s_nop 3
    v_pk_mul_f32 v[152:153], v[48:49], v[136:137]
    v_pk_mul_f32 v[154:155], v[50:51], v[138:139]
    v_pk_mul_f32 v[156:157], v[52:53], v[136:137]
    v_pk_mul_f32 v[158:159], v[54:55], v[138:139]
    v_pk_fma_f32 v[152:153], v[52:53], v[140:141], v[152:153]
    v_pk_fma_f32 v[156:157], v[48:49], v[140:141], v[156:157] neg_lo:[0,0,1] neg_hi:[0,0,1]
    v_pk_fma_f32 v[154:155], v[54:55], v[142:143], v[154:155]
    v_pk_fma_f32 v[158:159], v[50:51], v[142:143], v[158:159] neg_lo:[0,0,1] neg_hi:[0,0,1]
    v_cvt_pk_f16_f32 v120, v152, v156
    v_cvt_pk_f16_f32 v121, v153, v157
    v_cvt_pk_f16_f32 v122, v154, v158
    v_cvt_pk_f16_f32 v123, v155, v159
    s_waitcnt lgkmcnt(1)
    v_mfma_f32_16x16x32_f16 v[136:139], v[128:131], v[32:35], 0
    v_mfma_f32_16x16x32_f16 v[140:143], v[128:131], v[36:39], 0
    v_mfma_f32_16x16x32_f16 v[216:219], v[80:83], v[120:123], 0
    v_mfma_f32_16x16x32_f16 v[220:223], v[84:87], v[120:123], 0
    v_pk_mul_f32 v[152:153], v[56:57], v[144:145]
    v_pk_mul_f32 v[154:155], v[58:59], v[146:147]
    v_pk_mul_f32 v[156:157], v[60:61], v[144:145]
    v_pk_mul_f32 v[158:159], v[62:63], v[146:147]
    v_pk_fma_f32 v[152:153], v[60:61], v[148:149], v[152:153]
    v_pk_fma_f32 v[156:157], v[56:57], v[148:149], v[156:157] neg_lo:[0,0,1] neg_hi:[0,0,1]
    v_pk_fma_f32 v[154:155], v[62:63], v[150:151], v[154:155]
    v_pk_fma_f32 v[158:159], v[58:59], v[150:151], v[158:159] neg_lo:[0,0,1] neg_hi:[0,0,1]
    v_cvt_pk_f16_f32 v124, v152, v156
    v_cvt_pk_f16_f32 v125, v153, v157
    v_cvt_pk_f16_f32 v126, v154, v158
    v_cvt_pk_f16_f32 v127, v155, v159
    s_waitcnt lgkmcnt(0)
    v_mfma_f32_16x16x32_f16 v[144:147], v[132:135], v[40:43], 0
    v_mfma_f32_16x16x32_f16 v[148:151], v[132:135], v[44:47], 0
    v_mfma_f32_16x16x32_f16 v[224:227], v[80:83], v[124:127], 0
    v_mfma_f32_16x16x32_f16 v[228:231], v[84:87], v[124:127], 0
    v_pk_mul_f32 v[152:153], v[64:65], v[136:137]
    v_pk_mul_f32 v[154:155], v[66:67], v[138:139]
    v_pk_mul_f32 v[156:157], v[68:69], v[136:137]
    v_pk_mul_f32 v[158:159], v[70:71], v[138:139]
    v_pk_fma_f32 v[152:153], v[68:69], v[140:141], v[152:153]
    v_pk_fma_f32 v[156:157], v[64:65], v[140:141], v[156:157] neg_lo:[0,0,1] neg_hi:[0,0,1]
    v_pk_fma_f32 v[154:155], v[70:71], v[142:143], v[154:155]
    v_pk_fma_f32 v[158:159], v[66:67], v[142:143], v[158:159] neg_lo:[0,0,1] neg_hi:[0,0,1]
    v_cvt_pk_f16_f32 v128, v152, v156
    v_cvt_pk_f16_f32 v129, v153, v157
    v_cvt_pk_f16_f32 v130, v154, v158
    v_cvt_pk_f16_f32 v131, v155, v159
    s_nop 1
    v_mfma_f32_16x16x32_f16 v[232:235], v[80:83], v[128:131], 0
    v_mfma_f32_16x16x32_f16 v[236:239], v[84:87], v[128:131], 0
    v_pk_mul_f32 v[152:153], v[72:73], v[144:145]
    v_pk_mul_f32 v[154:155], v[74:75], v[146:147]
    v_pk_mul_f32 v[156:157], v[76:77], v[144:145]
    v_pk_mul_f32 v[158:159], v[78:79], v[146:147]
    v_pk_fma_f32 v[152:153], v[76:77], v[148:149], v[152:153]
    v_pk_fma_f32 v[156:157], v[72:73], v[148:149], v[156:157] neg_lo:[0,0,1] neg_hi:[0,0,1]
    v_pk_fma_f32 v[154:155], v[78:79], v[150:151], v[154:155]
    v_pk_fma_f32 v[158:159], v[74:75], v[150:151], v[158:159] neg_lo:[0,0,1] neg_hi:[0,0,1]
    v_cvt_pk_f16_f32 v132, v152, v156
    v_cvt_pk_f16_f32 v133, v153, v157
    v_cvt_pk_f16_f32 v134, v154, v158
    v_cvt_pk_f16_f32 v135, v155, v159
    s_nop 1
    v_mfma_f32_16x16x32_f16 v[240:243], v[80:83], v[132:135], 0
    v_mfma_f32_16x16x32_f16 v[244:247], v[84:87], v[132:135], 0
    v_cvt_pk_f16_f32 v176, v216, v224
    v_cvt_pk_f16_f32 v178, v220, v228
    v_and_or_b32 v176, v176, s58, v210
    v_and_or_b32 v178, v178, s58, v210
    v_cvt_pk_f16_f32 v180, v217, v225
    v_cvt_pk_f16_f32 v182, v221, v229
    v_and_or_b32 v180, v180, s58, v210
    v_and_or_b32 v182, v182, s58, v210
    v_cvt_pk_f16_f32 v184, v218, v226
    v_cvt_pk_f16_f32 v186, v222, v230
    v_and_or_b32 v184, v184, s58, v210
    v_and_or_b32 v186, v186, s58, v210
    v_cvt_pk_f16_f32 v188, v219, v227
    v_cvt_pk_f16_f32 v190, v223, v231
    v_and_or_b32 v188, v188, s58, v210
    v_and_or_b32 v190, v190, s58, v210
    v_cvt_pk_f16_f32 v177, v232, v240
    v_cvt_pk_f16_f32 v179, v236, v244
    v_and_or_b32 v177, v177, s58, v210
    v_and_or_b32 v179, v179, s58, v210
    v_cvt_pk_f16_f32 v181, v233, v241
    v_cvt_pk_f16_f32 v183, v237, v245
    v_and_or_b32 v181, v181, s58, v210
    v_and_or_b32 v183, v183, s58, v210
    v_cvt_pk_f16_f32 v185, v234, v242
    v_cvt_pk_f16_f32 v187, v238, v246
    v_and_or_b32 v185, v185, s58, v210
    v_and_or_b32 v187, v187, s58, v210
    v_cvt_pk_f16_f32 v189, v235, v243
    v_cvt_pk_f16_f32 v191, v239, v247
    v_and_or_b32 v189, v189, s58, v210
    v_and_or_b32 v191, v191, s58, v210
    s_cmp_eq_u32 s50, 0
    s_cbranch_scc1 L_p1_done
    s_mov_b32 exec_hi, s72
    buffer_store_dwordx4 v[176:179], v209, s[12:15], s60 offen sc1
    s_mov_b32 exec_hi, s73
    buffer_store_dwordx4 v[180:183], v209, s[12:15], s61 offen sc1
    buffer_store_dwordx4 v[184:187], v209, s[12:15], s62 offen sc1
    buffer_store_dwordx4 v[188:191], v209, s[12:15], s63 offen sc1
    s_mov_b32 exec_hi, -1
    s_mov_b32 s50, 0
    s_add_u32 s60, s60, 16384
    v_add_u32 v5, 16384, v5
    s_sub_u32 s31, s48, 4
    v_cvt_f32_i32 v252, s31
    v_mul_f32 v252, 0x3d800000, v252
    v_and_b32 v251, 15, v2
    v_lshlrev_b32 v251, 2, v251
    v_cvt_f32_u32 v251, v251
    v_fma_f32 v250, v212, v251, v252
    v_sin_f32 v84, v250
    v_cos_f32 v250, v250
    s_nop 0
    v_cvt_pk_f16_f32 v80, v250, v84
    v_cvt_pk_f16_f32 v84, -v84, v250
    v_fma_f32 v250, v213, v251, v252
    v_sin_f32 v85, v250
    v_cos_f32 v250, v250
    s_nop 0
    v_cvt_pk_f16_f32 v81, v250, v85
    v_cvt_pk_f16_f32 v85, -v85, v250
    v_fma_f32 v250, v214, v251, v252
    v_sin_f32 v86, v250
    v_cos_f32 v250, v250
    s_nop 0
    v_cvt_pk_f16_f32 v82, v250, v86
    v_cvt_pk_f16_f32 v86, -v86, v250
    v_fma_f32 v250, v215, v251, v252
    v_sin_f32 v87, v250
    v_cos_f32 v250, v250
    s_nop 0
    v_cvt_pk_f16_f32 v83, v250, v87
    v_cvt_pk_f16_f32 v87, -v87, v250
    s_branch L_st23
L_p1_done:
    s_mov_b64 exec, 1
    ds_add_u32 v0, v255 offset:42828
    s_mov_b64 exec, -1
    s_setprio 0
    v_mov_b32 v4, v112
    v_mov_b32 v5, v113
    v_mov_b32 v249, v114
    v_mov_b32 v205, v115
    v_mov_b32 v248, v116
    v_mov_b32 v208, v117
    v_mov_b32 v7, v118
    v_mov_b32 v6, v119
    s_and_b32 s31, s2, 7
    s_sub_u32 s32, 8, s31
    s_min_u32 s46, s31, s32
    s_cmp_gt_u32 s31, 4
    s_cselect_b32 s31, 16, 0
    s_lshr_b32 s47, s2, 4
    s_add_u32 s47, s47, s31
    s_bfe_u32 s53, s2, 0x10003
    s_lshl_b32 s53, s53, 7
    s_add_u32 s53, s53, s31
    s_lshl_b32 s31, s30, 5
    s_add_u32 s53, s53, s31
    s_lshl_b32 s48, s46, 1
    s_add_u32 s48, s48, 2040
    s_mov_b32 s49, 32768
    v_and_b32 v160, 15, v2
    v_add_u32 v160, s53, v160
    v_cvt_f32_u32 v160, v160
    v_add_f32 v160, 0.5, v160
    v_mul_f32 v160, 0x3b800000, v160
    v_and_b32 v161, 32, v2
    v_bfe_u32 v162, v2, 4, 1
    v_lshl_add_u32 v161, v162, 3, v161
    v_cvt_f32_u32 v161, v161
    v_mul_f32 v161, v161, v160
    v_fmamk_f32 v88, v160, 0x0, v161
    v_fmamk_f32 v162, v160, 0x40000000, v161
    v_sin_f32 v104, v88
    v_sin_f32 v163, v162
    v_cos_f32 v88, v88
    v_cos_f32 v162, v162
    v_cvt_pk_f16_f32 v104, v104, v163
    v_cvt_pk_f16_f32 v88, v88, v162
    v_fmamk_f32 v89, v160, 0x40800000, v161
    v_fmamk_f32 v162, v160, 0x40c00000, v161
    v_sin_f32 v105, v89
    v_sin_f32 v163, v162
    v_cos_f32 v89, v89
    v_cos_f32 v162, v162
    v_cvt_pk_f16_f32 v105, v105, v163
    v_cvt_pk_f16_f32 v89, v89, v162
    v_fmamk_f32 v90, v160, 0x41800000, v161
    v_fmamk_f32 v162, v160, 0x41900000, v161
    v_sin_f32 v106, v90
    v_sin_f32 v163, v162
    v_cos_f32 v90, v90
    v_cos_f32 v162, v162
    v_cvt_pk_f16_f32 v106, v106, v163
    v_cvt_pk_f16_f32 v90, v90, v162
    v_fmamk_f32 v91, v160, 0x41a00000, v161
    v_fmamk_f32 v162, v160, 0x41b00000, v161
    v_sin_f32 v107, v91
    v_sin_f32 v163, v162
    v_cos_f32 v91, v91
    v_cos_f32 v162, v162
    v_cvt_pk_f16_f32 v107, v107, v163
    v_cvt_pk_f16_f32 v91, v91, v162
    v_fmamk_f32 v92, v160, 0x42800000, v161
    v_fmamk_f32 v162, v160, 0x42840000, v161
    v_sin_f32 v108, v92
    v_sin_f32 v163, v162
    v_cos_f32 v92, v92
    v_cos_f32 v162, v162
    v_cvt_pk_f16_f32 v108, v108, v163
    v_cvt_pk_f16_f32 v92, v92, v162
    v_fmamk_f32 v93, v160, 0x42880000, v161
    v_fmamk_f32 v162, v160, 0x428c0000, v161
    v_sin_f32 v109, v93
    v_sin_f32 v163, v162
    v_cos_f32 v93, v93
    v_cos_f32 v162, v162
    v_cvt_pk_f16_f32 v109, v109, v163
    v_cvt_pk_f16_f32 v93, v93, v162
    v_fmamk_f32 v94, v160, 0x42a00000, v161
    v_fmamk_f32 v162, v160, 0x42a40000, v161
    v_sin_f32 v110, v94
    v_sin_f32 v163, v162
    v_cos_f32 v94, v94
    v_cos_f32 v162, v162
    v_cvt_pk_f16_f32 v110, v110, v163
    v_cvt_pk_f16_f32 v94, v94, v162
    v_fmamk_f32 v95, v160, 0x42a80000, v161
    v_fmamk_f32 v162, v160, 0x42ac0000, v161
    v_sin_f32 v111, v95
    v_sin_f32 v163, v162
    v_cos_f32 v95, v95
    v_cos_f32 v162, v162
    v_cvt_pk_f16_f32 v111, v111, v163
    v_cvt_pk_f16_f32 v95, v95, v162
    v_fmamk_f32 v96, v160, 0x3f800000, v161
    v_fmamk_f32 v162, v160, 0x40400000, v161
    v_sin_f32 v112, v96
    v_sin_f32 v163, v162
    v_cos_f32 v96, v96
    v_cos_f32 v162, v162
    v_cvt_pk_f16_f32 v112, v112, v163
    v_cvt_pk_f16_f32 v96, v96, v162
    v_fmamk_f32 v97, v160, 0x40a00000, v161
    v_fmamk_f32 v162, v160, 0x40e00000, v161
    v_sin_f32 v113, v97
    v_sin_f32 v163, v162
    v_cos_f32 v97, v97
    v_cos_f32 v162, v162
    v_cvt_pk_f16_f32 v113, v113, v163
    v_cvt_pk_f16_f32 v97, v97, v162
    v_fmamk_f32 v98, v160, 0x41880000, v161
    v_fmamk_f32 v162, v160, 0x41980000, v161
    v_sin_f32 v114, v98
    v_sin_f32 v163, v162
    v_cos_f32 v98, v98
    v_cos_f32 v162, v162
    v_cvt_pk_f16_f32 v114, v114, v163
    v_cvt_pk_f16_f32 v98, v98, v162
    v_fmamk_f32 v99, v160, 0x41a80000, v161
    v_fmamk_f32 v162, v160, 0x41b80000, v161
    v_sin_f32 v115, v99
    v_sin_f32 v163, v162
    v_cos_f32 v99, v99
    v_cos_f32 v162, v162
    v_cvt_pk_f16_f32 v115, v115, v163
    v_cvt_pk_f16_f32 v99, v99, v162
    v_fmamk_f32 v100, v160, 0x42820000, v161
    v_fmamk_f32 v162, v160, 0x42860000, v161
    v_sin_f32 v116, v100
    v_sin_f32 v163, v162
    v_cos_f32 v100, v100
    v_cos_f32 v162, v162
    v_cvt_pk_f16_f32 v116, v116, v163
    v_cvt_pk_f16_f32 v100, v100, v162
    v_fmamk_f32 v101, v160, 0x428a0000, v161
    v_fmamk_f32 v162, v160, 0x428e0000, v161
    v_sin_f32 v117, v101
    v_sin_f32 v163, v162
    v_cos_f32 v101, v101
    v_cos_f32 v162, v162
    v_cvt_pk_f16_f32 v117, v117, v163
    v_cvt_pk_f16_f32 v101, v101, v162
    v_fmamk_f32 v102, v160, 0x42a20000, v161
    v_fmamk_f32 v162, v160, 0x42a60000, v161
    v_sin_f32 v118, v102
    v_sin_f32 v163, v162
    v_cos_f32 v102, v102
    v_cos_f32 v162, v162
    v_cvt_pk_f16_f32 v118, v118, v163
    v_cvt_pk_f16_f32 v102, v102, v162
    v_fmamk_f32 v103, v160, 0x42aa0000, v161
    v_fmamk_f32 v162, v160, 0x42ae0000, v161
    v_sin_f32 v119, v103
    v_sin_f32 v163, v162
    v_cos_f32 v103, v103
    v_cos_f32 v162, v162
    v_cvt_pk_f16_f32 v119, v119, v163
    v_cvt_pk_f16_f32 v103, v103, v162
    v_cmp_gt_u32 vcc, 16, v2
    v_and_b32 v162, 1, v2
    v_lshlrev_b32 v162, 15, v162
    v_or_b32 v162, 0x3c00, v162
    v_and_b32 v160, 0xffff0000, v104
    v_or_b32 v162, v162, v160
    v_cndmask_b32 v104, v104, v162, vcc
    s_cmp_eq_u32 s74, 7
    s_cbranch_scc1 L_no_zst
L_sync4:
    ds_read_b32 v1, v0 offset:42840
    s_waitcnt lgkmcnt(0)
    v_readfirstlane_b32 s31, v1
    s_nop 0
    s_cmp_ge_u32 s31, 1
    s_cbranch_scc0 L_sync4
    s_mov_b32 exec_hi, s72
    buffer_store_dwordx4 v[176:179], v209, s[12:15], s60 offen sc1
    s_mov_b32 exec_hi, s73
    buffer_store_dwordx4 v[180:183], v209, s[12:15], s61 offen sc1
    buffer_store_dwordx4 v[184:187], v209, s[12:15], s62 offen sc1
    buffer_store_dwordx4 v[188:191], v209, s[12:15], s63 offen sc1
    s_mov_b32 exec_hi, -1
L_no_zst:
L_sync5:
    ds_read_b32 v1, v0 offset:42840
    s_waitcnt lgkmcnt(0)
    v_readfirstlane_b32 s31, v1
    s_nop 0
    s_cmp_ge_u32 s31, 1
    s_cbranch_scc0 L_sync5
    buffer_load_dwordx4 v[24:27], v6, s[12:15], s49 offen
    s_mul_i32 s51, s46, 528384
    s_add_u32 s51, s51, 2097152
    s_mul_i32 s54, s47, 16512
    s_lshl_b32 s32, s30, 12
    s_add_u32 s50, s51, s54
    s_add_u32 s50, s50, s32
    s_add_u32 s55, s47, 1
    s_and_b32 s55, s55, 31
    s_mul_i32 s55, s55, 16512
    v_add_u32 v250, s32, v3
    v_add_u32 v199, s76, v3
    v_lshl_add_u32 v200, v2, 7, s32
    v_and_b32 v1, 2, v2
    v_lshl_add_u32 v200, v1, 3, v200
    v_and_b32 v1, 0x70, v3
    v_add_u32 v1, 16384, v1
    s_mov_b32 vcc_lo, 0
    s_mov_b32 vcc_hi, -1
    v_cndmask_b32 v200, v200, v1, vcc
    s_mov_b32 vcc_hi, 0xff
    v_mov_b32 v1, s55
    v_mov_b32 v201, s54
    v_cndmask_b32 v1, v1, v201, vcc
    v_mov_b32 v201, 16640
    v_cndmask_b32 v201, v201, v0, vcc
    v_add_u32 v201, v201, v200
    v_add_u32 v200, v1, v200
    v_lshrrev_b32 v251, 5, v2
    v_lshlrev_b32 v251, 11, v251
    v_bfe_u32 v1, v2, 2, 3
    v_lshl_add_u32 v251, v1, 7, v251
    v_and_b32 v1, 3, v2
    v_lshl_add_u32 v251, v1, 5, v251
    v_bfe_u32 v1, v2, 3, 1
    v_lshl_add_u32 v251, v1, 4, v251
    v_bfe_u32 v1, v2, 4, 1
    v_lshl_add_u32 v251, v1, 3, v251
    v_xor_b32 v252, 16, v251
    v_xor_b32 v253, 8, v251
    v_xor_b32 v254, 24, v251
    v_cmp_gt_u32 vcc, 4, v2
    v_mov_b32 v1, 16384
    s_nop 0
    v_cndmask_b32 v1, v0, v1, vcc
    v_add_u32 v206, v253, v1
    v_add_u32 v207, v254, v1
    s_mov_b32 vcc_lo, 0x88888888
    s_mov_b32 vcc_hi, 0x88888888
    v_mov_b32 v1, 16544
    v_cndmask_b32 v1, 32, v1, vcc
    v_add_u32 v202, v251, v1
    v_add_u32 v203, v253, v1
    v_add_u32 v204, v206, v1
    s_waitcnt vmcnt(0)
L_stat_check:
    v_cmp_ne_u64 vcc, s[28:29], v[26:27]
    s_nop 0
    s_cbranch_vccz L_stat_got
    s_cmp_eq_u32 s35, 0
    s_cbranch_scc1 L_stat_got
    s_sub_u32 s35, s35, 1
    s_sleep 2
    s_mov_b64 exec, vcc
    buffer_load_dwordx4 v[24:27], v6, s[12:15], s49 offen sc1
    s_mov_b64 exec, -1
    s_waitcnt vmcnt(0)
    s_branch L_stat_check
L_stat_got:
    v_cndmask_b32 v24, v24, v25, s[88:89]
    v_mov_b32 v32, v24
    s_nop 1
    v_permlane32_swap_b32 v24, v32
    v_mov_b32 v28, v24
    v_mov_b32 v36, v32
    s_nop 0
    v_permlane16_swap_b32 v24, v28
    v_permlane16_swap_b32 v32, v36
    v_lshlrev_b32 v26, 16, v24
    v_and_b32 v24, 0xffff0000, v24
    v_rcp_f32 v24, v24
    v_lshlrev_b32 v30, 16, v28
    v_and_b32 v28, 0xffff0000, v28
    v_rcp_f32 v28, v28
    v_lshlrev_b32 v34, 16, v32
    v_and_b32 v32, 0xffff0000, v32
    v_rcp_f32 v32, v32
    v_lshlrev_b32 v38, 16, v36
    v_and_b32 v36, 0xffff0000, v36
    v_rcp_f32 v36, v36
    v_mul_f32 v24, 0xbfb8aa3b, v24
    v_mul_f32_e64 v26, -v26, v24
    v_mul_f32 v28, 0xbfb8aa3b, v28
    v_mul_f32_e64 v30, -v30, v28
    v_mul_f32 v32, 0xbfb8aa3b, v32
    v_mul_f32_e64 v34, -v34, v32
    v_mul_f32 v36, 0xbfb8aa3b, v36
    v_mul_f32_e64 v38, -v38, v36
    v_mov_b32 v212, v210
    v_mov_b32 v213, v210
    v_mov_b32 v214, v210
    v_mov_b32 v215, v210
    ds_read_b128 v[8:11], v208 offset:0
    ds_read_b128 v[12:15], v208 offset:1024
    s_waitcnt lgkmcnt(0)
    v_lshlrev_b32 v40, 16, v8
    v_and_b32 v41, 0xffff0000, v8
    v_lshlrev_b32 v42, 16, v9
    v_and_b32 v43, 0xffff0000, v9
    v_lshlrev_b32 v44, 16, v10
    v_and_b32 v45, 0xffff0000, v10
    v_lshlrev_b32 v46, 16, v11
    v_and_b32 v47, 0xffff0000, v11
    v_lshlrev_b32 v48, 16, v12
    v_and_b32 v55, 0xffff0000, v12
    v_lshlrev_b32 v54, 16, v13
    v_and_b32 v53, 0xffff0000, v13
    v_lshlrev_b32 v52, 16, v14
    v_and_b32 v51, 0xffff0000, v14
    v_lshlrev_b32 v50, 16, v15
    v_and_b32 v49, 0xffff0000, v15
    v_pk_fma_f32 v[120:121], v[40:41], v[24:25], v[26:27] op_sel_hi:[1,0,0]
    v_pk_fma_f32 v[122:123], v[42:43], v[24:25], v[26:27] op_sel_hi:[1,0,0]
    v_pk_fma_f32 v[124:125], v[44:45], v[24:25], v[26:27] op_sel_hi:[1,0,0]
    v_pk_fma_f32 v[126:127], v[46:47], v[24:25], v[26:27] op_sel_hi:[1,0,0]
    v_pk_fma_f32 v[128:129], v[48:49], v[28:29], v[30:31] op_sel_hi:[1,0,0]
    v_pk_fma_f32 v[130:131], v[50:51], v[28:29], v[30:31] op_sel_hi:[1,0,0]
    v_pk_fma_f32 v[132:133], v[52:53], v[28:29], v[30:31] op_sel_hi:[1,0,0]
    v_pk_fma_f32 v[134:135], v[54:55], v[28:29], v[30:31] op_sel_hi:[1,0,0]
    v_exp_f32 v216, v120
    v_exp_f32 v217, v121
    v_exp_f32 v218, v122
    v_exp_f32 v219, v123
    v_exp_f32 v220, v124
    v_exp_f32 v221, v125
    v_exp_f32 v222, v126
    v_exp_f32 v223, v127
    v_exp_f32 v224, v128
    v_exp_f32 v225, v129
    v_exp_f32 v226, v130
    v_exp_f32 v227, v131
    v_exp_f32 v228, v132
    v_exp_f32 v229, v133
    v_exp_f32 v230, v134
    v_exp_f32 v231, v135
    v_pk_add_f32 v[216:217], v[216:217], 1.0 op_sel_hi:[1,0]
    v_pk_add_f32 v[218:219], v[218:219], 1.0 op_sel_hi:[1,0]
    v_pk_add_f32 v[220:221], v[220:221], 1.0 op_sel_hi:[1,0]
    v_pk_add_f32 v[222:223], v[222:223], 1.0 op_sel_hi:[1,0]
    v_pk_add_f32 v[224:225], v[224:225], 1.0 op_sel_hi:[1,0]
    v_pk_add_f32 v[226:227], v[226:227], 1.0 op_sel_hi:[1,0]
    v_pk_add_f32 v[228:229], v[228:229], 1.0 op_sel_hi:[1,0]
    v_pk_add_f32 v[230:231], v[230:231], 1.0 op_sel_hi:[1,0]
    v_rcp_f32 v216, v216
    v_rcp_f32 v217, v217
    v_rcp_f32 v218, v218
    v_rcp_f32 v219, v219
    v_rcp_f32 v220, v220
    v_rcp_f32 v221, v221
    v_rcp_f32 v222, v222
    v_rcp_f32 v223, v223
    v_rcp_f32 v224, v224
    v_rcp_f32 v225, v225
    v_rcp_f32 v226, v226
    v_rcp_f32 v227, v227
    v_rcp_f32 v228, v228
    v_rcp_f32 v229, v229
    v_rcp_f32 v230, v230
    v_rcp_f32 v231, v231
    v_pk_mul_f32 v[120:121], v[120:121], v[216:217]
    v_pk_mul_f32 v[122:123], v[122:123], v[218:219]
    v_pk_mul_f32 v[124:125], v[124:125], v[220:221]
    v_pk_mul_f32 v[126:127], v[126:127], v[222:223]
    v_pk_mul_f32 v[128:129], v[128:129], v[224:225]
    v_pk_mul_f32 v[130:131], v[130:131], v[226:227]
    v_pk_mul_f32 v[132:133], v[132:133], v[228:229]
    v_pk_mul_f32 v[134:135], v[134:135], v[230:231]
L_sync6:
    ds_read_b32 v1, v0 offset:42848
    s_waitcnt lgkmcnt(0)
    v_readfirstlane_b32 s31, v1
    s_nop 0
    s_cmp_ge_u32 s31, 4
    s_cbranch_scc0 L_sync6
    s_add_u32 m0, s76, 2048
    s_nop 0
    buffer_load_dwordx4 v249, s[8:11], 0 offen lds
    s_add_u32 m0, s76, 3072
    s_nop 0
    buffer_load_dwordx4 v205, s[8:11], 0 offen lds
    s_waitcnt vmcnt(0)
    ds_read_b128 v[16:19], v208 offset:2048
    ds_read_b128 v[20:23], v208 offset:3072
    s_waitcnt lgkmcnt(0)
L_sync7:
    ds_read_b32 v1, v0 offset:42852
    s_waitcnt lgkmcnt(0)
    v_readfirstlane_b32 s31, v1
    s_nop 0
    s_cmp_ge_u32 s31, 4
    s_cbranch_scc0 L_sync7
    buffer_load_dwordx4 v[72:75], v3, s[12:15], s50 offen offset:0 sc1
    buffer_load_dwordx4 v[76:79], v3, s[12:15], s50 offen offset:1024 sc1
    buffer_load_dwordx4 v[80:83], v3, s[12:15], s50 offen offset:2048 sc1
    buffer_load_dwordx4 v[84:87], v3, s[12:15], s50 offen offset:3072 sc1
    s_mov_b32 exec_hi, 0x1ff
    buffer_load_dwordx4 v[212:215], v200, s[12:15], s51 offen sc1
    s_mov_b32 exec_hi, -1
    v_lshlrev_b32 v56, 16, v16
    v_and_b32 v57, 0xffff0000, v16
    v_lshlrev_b32 v58, 16, v17
    v_and_b32 v59, 0xffff0000, v17
    v_lshlrev_b32 v60, 16, v18
    v_and_b32 v61, 0xffff0000, v18
    v_lshlrev_b32 v62, 16, v19
    v_and_b32 v63, 0xffff0000, v19
    v_lshlrev_b32 v64, 16, v20
    v_and_b32 v71, 0xffff0000, v20
    v_lshlrev_b32 v70, 16, v21
    v_and_b32 v69, 0xffff0000, v21
    v_lshlrev_b32 v68, 16, v22
    v_and_b32 v67, 0xffff0000, v22
    v_lshlrev_b32 v66, 16, v23
    v_and_b32 v65, 0xffff0000, v23
    v_pk_fma_f32 v[136:137], v[56:57], v[32:33], v[34:35] op_sel_hi:[1,0,0]
    v_pk_fma_f32 v[138:139], v[58:59], v[32:33], v[34:35] op_sel_hi:[1,0,0]
    v_pk_fma_f32 v[140:141], v[60:61], v[32:33], v[34:35] op_sel_hi:[1,0,0]
    v_pk_fma_f32 v[142:143], v[62:63], v[32:33], v[34:35] op_sel_hi:[1,0,0]
    v_pk_fma_f32 v[144:145], v[64:65], v[36:37], v[38:39] op_sel_hi:[1,0,0]
    v_pk_fma_f32 v[146:147], v[66:67], v[36:37], v[38:39] op_sel_hi:[1,0,0]
    v_pk_fma_f32 v[148:149], v[68:69], v[36:37], v[38:39] op_sel_hi:[1,0,0]
    v_pk_fma_f32 v[150:151], v[70:71], v[36:37], v[38:39] op_sel_hi:[1,0,0]
    v_exp_f32 v232, v136
    v_exp_f32 v233, v137
    v_exp_f32 v234, v138
    v_exp_f32 v235, v139
    v_exp_f32 v236, v140
    v_exp_f32 v237, v141
    v_exp_f32 v238, v142
    v_exp_f32 v239, v143
    v_exp_f32 v240, v144
    v_exp_f32 v241, v145
    v_exp_f32 v242, v146
    v_exp_f32 v243, v147
    v_exp_f32 v244, v148
    v_exp_f32 v245, v149
    v_exp_f32 v246, v150
    v_exp_f32 v247, v151
    v_pk_add_f32 v[232:233], v[232:233], 1.0 op_sel_hi:[1,0]
    v_pk_add_f32 v[234:235], v[234:235], 1.0 op_sel_hi:[1,0]
    v_pk_add_f32 v[236:237], v[236:237], 1.0 op_sel_hi:[1,0]
    v_pk_add_f32 v[238:239], v[238:239], 1.0 op_sel_hi:[1,0]
    v_pk_add_f32 v[240:241], v[240:241], 1.0 op_sel_hi:[1,0]
    v_pk_add_f32 v[242:243], v[242:243], 1.0 op_sel_hi:[1,0]
    v_pk_add_f32 v[244:245], v[244:245], 1.0 op_sel_hi:[1,0]
    v_pk_add_f32 v[246:247], v[246:247], 1.0 op_sel_hi:[1,0]
    v_rcp_f32 v232, v232
    v_rcp_f32 v233, v233
    v_rcp_f32 v234, v234
    v_rcp_f32 v235, v235
    v_rcp_f32 v236, v236
    v_rcp_f32 v237, v237
    v_rcp_f32 v238, v238
    v_rcp_f32 v239, v239
    v_rcp_f32 v240, v240
    v_rcp_f32 v241, v241
    v_rcp_f32 v242, v242
    v_rcp_f32 v243, v243
    v_rcp_f32 v244, v244
    v_rcp_f32 v245, v245
    v_rcp_f32 v246, v246
    v_rcp_f32 v247, v247
    v_pk_mul_f32 v[136:137], v[136:137], v[232:233]
    v_pk_mul_f32 v[138:139], v[138:139], v[234:235]
    v_pk_mul_f32 v[140:141], v[140:141], v[236:237]
    v_pk_mul_f32 v[142:143], v[142:143], v[238:239]
    v_pk_mul_f32 v[144:145], v[144:145], v[240:241]
    v_pk_mul_f32 v[146:147], v[146:147], v[242:243]
    v_pk_mul_f32 v[148:149], v[148:149], v[244:245]
    v_pk_mul_f32 v[150:151], v[150:151], v[246:247]
L_sync8:
    ds_read_b32 v1, v0 offset:42844
    s_waitcnt lgkmcnt(0)
    v_readfirstlane_b32 s31, v1
    s_nop 0
    s_cmp_ge_u32 s31, 1
    s_cbranch_scc0 L_sync8
    ds_read_b32 v1, v0 offset:41556
    v_and_b32 v6, 48, v2
    v_lshlrev_b32 v6, 1, v6
    v_mov_b32 v209, 2147483392
    s_waitcnt lgkmcnt(0)
    v_readfirstlane_b32 s33, v1
    s_nop 0
    s_andn2_b32 s33, 0x7ff, s33
    s_sub_u32 s31, 0, s33
    s_and_b32 s31, s31, 2047
    s_sub_u32 s32, s48, s33
    s_sub_u32 s34, s48, s31
    v_cmp_eq_u32 vcc, s33, v7
    v_cmp_eq_u32 s[54:55], s33, v248
    s_nop 0
    v_cndmask_b32 v4, v4, v209, vcc
    v_cmp_eq_u32 vcc, s31, v7
    v_cmp_eq_u32 s[56:57], s31, v248
    s_nop 0
    v_cndmask_b32 v5, v5, v209, vcc
    v_cmp_eq_u32 vcc, s32, v7
    v_cmp_eq_u32 s[58:59], s32, v248
    s_nop 0
    v_cndmask_b32 v249, v249, v209, vcc
    v_cmp_eq_u32 vcc, s34, v7
    v_cmp_eq_u32 s[60:61], s34, v248
    s_nop 0
    v_cndmask_b32 v205, v205, v209, vcc
    s_or_b64 s[62:63], s[54:55], s[58:59]
    s_or_b64 s[64:65], s[56:57], s[60:61]
L_z_wait:
    s_setprio 1
    s_waitcnt vmcnt(4)
    v_xor_b32 v152, v210, v72
    v_xor_b32 v153, v210, v73
    v_xor_b32 v154, v210, v74
    v_xor_b32 v155, v210, v75
    ds_write_b128 v250, v[152:155] offset:0
    v_or3_b32 v1, v152, v153, v154
    v_or_b32 v1, v1, v155
    s_waitcnt vmcnt(3)
    v_xor_b32 v156, v210, v76
    v_xor_b32 v157, v210, v77
    v_xor_b32 v158, v210, v78
    v_xor_b32 v159, v210, v79
    ds_write_b128 v250, v[156:159] offset:1024
    v_or3_b32 v1, v1, v156, v157
    v_or3_b32 v1, v1, v158, v159
    s_waitcnt vmcnt(2)
    v_xor_b32 v160, v210, v80
    v_xor_b32 v161, v210, v81
    v_xor_b32 v162, v210, v82
    v_xor_b32 v163, v210, v83
    ds_write_b128 v250, v[160:163] offset:2048
    v_or3_b32 v1, v1, v160, v161
    v_or3_b32 v1, v1, v162, v163
    s_waitcnt vmcnt(1)
    v_xor_b32 v164, v210, v84
    v_xor_b32 v165, v210, v85
    v_xor_b32 v166, v210, v86
    v_xor_b32 v167, v210, v87
    ds_write_b128 v250, v[164:167] offset:3072
    v_or3_b32 v1, v1, v164, v165
    v_or3_b32 v1, v1, v166, v167
    s_waitcnt vmcnt(0)
    v_xor_b32 v168, v210, v212
    v_xor_b32 v169, v210, v213
    v_xor_b32 v170, v210, v214
    v_xor_b32 v171, v210, v215
    s_mov_b32 exec_hi, 0x1ff
    ds_write_b128 v201, v[168:171]
    s_mov_b32 exec_hi, -1
    v_or3_b32 v1, v1, v168, v169
    v_or3_b32 v1, v1, v170, v171
    v_and_b32 v1, 0x30003, v1
    v_cmp_ne_u32 vcc, 0, v1
    s_nop 0
    s_cbranch_vccz L_z_got
    s_cmp_eq_u32 s35, 0
    s_cbranch_scc1 L_z_got
    s_sub_u32 s35, s35, 1
    s_sleep 2
    s_mov_b64 exec, vcc
    buffer_load_dwordx4 v[72:75], v3, s[12:15], s50 offen offset:0 sc1
    buffer_load_dwordx4 v[76:79], v3, s[12:15], s50 offen offset:1024 sc1
    buffer_load_dwordx4 v[80:83], v3, s[12:15], s50 offen offset:2048 sc1
    buffer_load_dwordx4 v[84:87], v3, s[12:15], s50 offen offset:3072 sc1
    s_and_b32 exec_hi, exec_hi, 0x1ff
    s_or_b32 exec_lo, exec_lo, 1
    buffer_load_dwordx4 v[212:215], v200, s[12:15], s51 offen sc1
    s_mov_b64 exec, -1
    s_waitcnt lgkmcnt(0)
    s_branch L_z_wait
L_z_got:
    s_mov_b64 exec, 1
    ds_add_u32 v0, v255 offset:42832
    s_mov_b64 exec, -1
L_sync9:
    ds_read_b32 v1, v0 offset:42832
    s_waitcnt lgkmcnt(0)
    v_readfirstlane_b32 s31, v1
    s_nop 0
    s_cmp_ge_u32 s31, 4
    s_cbranch_scc0 L_sync9
    ds_read_b64_tr_b16 v[152:153], v251 offset:0
    ds_read_b64_tr_b16 v[154:155], v251 offset:1024
    ds_read_b64_tr_b16 v[156:157], v252 offset:0
    ds_read_b64_tr_b16 v[158:159], v252 offset:1024
    ds_read_b64_tr_b16 v[160:161], v251 offset:4096
    ds_read_b64_tr_b16 v[162:163], v251 offset:5120
    ds_read_b64_tr_b16 v[164:165], v252 offset:4096
    ds_read_b64_tr_b16 v[166:167], v252 offset:5120
    ds_read_b64_tr_b16 v[168:169], v251 offset:8192
    ds_read_b64_tr_b16 v[170:171], v251 offset:9216
    ds_read_b64_tr_b16 v[172:173], v252 offset:8192
    ds_read_b64_tr_b16 v[174:175], v252 offset:9216
    s_waitcnt lgkmcnt(8)
    v_mfma_f32_16x16x32_f16 v[216:219], v[152:155], v[88:91], 0
    v_mfma_f32_16x16x32_f16 v[220:223], v[156:159], v[88:91], 0
    ds_read_b64_tr_b16 v[176:177], v251 offset:12288
    ds_read_b64_tr_b16 v[178:179], v251 offset:13312
    ds_read_b64_tr_b16 v[180:181], v252 offset:12288
    ds_read_b64_tr_b16 v[182:183], v252 offset:13312
    s_waitcnt lgkmcnt(8)
    v_mfma_f32_16x16x32_f16 v[216:219], v[160:163], v[92:95], v[216:219]
    v_mfma_f32_16x16x32_f16 v[220:223], v[164:167], v[92:95], v[220:223]
    ds_read_b64_tr_b16 v[152:153], v206 offset:0
    ds_read_b64_tr_b16 v[154:155], v253 offset:1024
    ds_read_b64_tr_b16 v[156:157], v207 offset:0
    ds_read_b64_tr_b16 v[158:159], v254 offset:1024
    s_waitcnt lgkmcnt(8)
    v_mfma_f32_16x16x32_f16 v[216:219], v[168:171], v[96:99], v[216:219]
    v_mfma_f32_16x16x32_f16 v[220:223], v[172:175], v[96:99], v[220:223]
    ds_read_b64_tr_b16 v[160:161], v253 offset:4096
    ds_read_b64_tr_b16 v[162:163], v253 offset:5120
    ds_read_b64_tr_b16 v[164:165], v254 offset:4096
    ds_read_b64_tr_b16 v[166:167], v254 offset:5120
    s_waitcnt lgkmcnt(8)
    v_mfma_f32_16x16x32_f16 v[216:219], v[176:179], v[100:103], v[216:219]
    v_mfma_f32_16x16x32_f16 v[220:223], v[180:183], v[100:103], v[220:223]
    ds_read_b64_tr_b16 v[168:169], v253 offset:8192
    ds_read_b64_tr_b16 v[170:171], v253 offset:9216
    ds_read_b64_tr_b16 v[172:173], v254 offset:8192
    ds_read_b64_tr_b16 v[174:175], v254 offset:9216
    s_waitcnt lgkmcnt(8)
    v_mfma_f32_16x16x32_f16 v[224:227], v[152:155], v[104:107], 0
    v_mfma_f32_16x16x32_f16 v[228:231], v[156:159], v[104:107], 0
    ds_read_b64_tr_b16 v[176:177], v253 offset:12288
    ds_read_b64_tr_b16 v[178:179], v253 offset:13312
    ds_read_b64_tr_b16 v[180:181], v254 offset:12288
    ds_read_b64_tr_b16 v[182:183], v254 offset:13312
    s_waitcnt lgkmcnt(8)
    v_mfma_f32_16x16x32_f16 v[224:227], v[160:163], v[108:111], v[224:227]
    v_mfma_f32_16x16x32_f16 v[228:231], v[164:167], v[108:111], v[228:231]
    ds_read_b64_tr_b16 v[72:73], v202 offset:0
    ds_read_b64_tr_b16 v[74:75], v202 offset:1024
    ds_read_b64_tr_b16 v[76:77], v202 offset:4096
    ds_read_b64_tr_b16 v[78:79], v202 offset:5120
    s_waitcnt lgkmcnt(8)
    v_mfma_f32_16x16x32_f16 v[224:227], v[168:171], v[112:115], v[224:227]
    v_mfma_f32_16x16x32_f16 v[228:231], v[172:175], v[112:115], v[228:231]
    ds_read_b64_tr_b16 v[80:81], v202 offset:8192
    ds_read_b64_tr_b16 v[82:83], v202 offset:9216
    ds_read_b64_tr_b16 v[84:85], v202 offset:12288
    ds_read_b64_tr_b16 v[86:87], v202 offset:13312
    s_waitcnt lgkmcnt(8)
    v_mfma_f32_16x16x32_f16 v[224:227], v[176:179], v[116:119], v[224:227]
    v_mfma_f32_16x16x32_f16 v[228:231], v[180:183], v[116:119], v[228:231]
    ds_read_b64_tr_b16 v[240:241], v204 offset:0
    ds_read_b64_tr_b16 v[242:243], v203 offset:1024
    ds_read_b64_tr_b16 v[244:245], v203 offset:4096
    ds_read_b64_tr_b16 v[246:247], v203 offset:5120
    s_waitcnt lgkmcnt(8)
    ds_read_b64_tr_b16 v[184:185], v203 offset:8192
    ds_read_b64_tr_b16 v[186:187], v203 offset:9216
    ds_read_b64_tr_b16 v[188:189], v203 offset:12288
    ds_read_b64_tr_b16 v[190:191], v203 offset:13312
    v_mfma_f32_16x16x32_f16 v[232:235], v[72:75], v[88:91], 0
    v_mfma_f32_16x16x32_f16 v[232:235], v[76:79], v[92:95], v[232:235]
    s_waitcnt lgkmcnt(4)
    v_mfma_f32_16x16x32_f16 v[232:235], v[80:83], v[96:99], v[232:235]
    v_mfma_f32_16x16x32_f16 v[232:235], v[84:87], v[100:103], v[232:235]
    v_pk_add_f32 v[152:153], v[216:217], v[224:225]
    v_pk_add_f32 v[154:155], v[218:219], v[226:227]
    v_pk_add_f32 v[156:157], v[220:221], v[228:229]
    v_pk_add_f32 v[158:159], v[222:223], v[230:231]
    v_mfma_f32_16x16x32_f16 v[236:239], v[240:243], v[104:107], 0
    v_mfma_f32_16x16x32_f16 v[236:239], v[244:247], v[108:111], v[236:239]
    v_pk_fma_f32 v[40:41], v[152:153], v[120:121], v[40:41]
    v_pk_fma_f32 v[42:43], v[154:155], v[122:123], v[42:43]
    v_pk_fma_f32 v[44:45], v[156:157], v[124:125], v[44:45]
    v_pk_fma_f32 v[46:47], v[158:159], v[126:127], v[46:47]
    s_waitcnt lgkmcnt(0)
    v_mfma_f32_16x16x32_f16 v[236:239], v[184:187], v[112:115], v[236:239]
    v_mfma_f32_16x16x32_f16 v[236:239], v[188:191], v[116:119], v[236:239]
    v_cvt_pk_bf16_f32 v8, v40, v41
    v_cvt_pk_bf16_f32 v9, v42, v43
    v_cvt_pk_bf16_f32 v10, v44, v45
    v_cvt_pk_bf16_f32 v11, v46, v47
    ds_write_b128 v208, v[8:11] offset:0
    ds_read_b128 v[24:27], v199 offset:0
    v_pk_add_f32 v[160:161], v[216:217], v[224:225] neg_lo:[0,1] neg_hi:[0,1]
    v_pk_add_f32 v[162:163], v[218:219], v[226:227] neg_lo:[0,1] neg_hi:[0,1]
    v_pk_add_f32 v[164:165], v[220:221], v[228:229] neg_lo:[0,1] neg_hi:[0,1]
    v_pk_add_f32 v[166:167], v[222:223], v[230:231] neg_lo:[0,1] neg_hi:[0,1]
    s_cmp_eq_u64 s[62:63], 0
    s_cbranch_scc1 L_nodump0
    s_mov_b64 exec, s[54:55]
    ds_write_b128 v6, v[152:155] offset:42496
    ds_write_b128 v6, v[156:159] offset:42512
    s_mov_b64 exec, s[58:59]
    ds_write_b128 v6, v[160:163] offset:42496
    ds_write_b128 v6, v[164:167] offset:42512
    s_mov_b64 exec, 1
    ds_add_u32 v0, v255 offset:42836
    s_mov_b64 exec, -1
    s_waitcnt lgkmcnt(0)
L_nodump0:
    v_pk_fma_f32 v[56:57], v[160:161], v[136:137], v[56:57]
    v_pk_fma_f32 v[58:59], v[162:163], v[138:139], v[58:59]
    v_pk_fma_f32 v[60:61], v[164:165], v[140:141], v[60:61]
    v_pk_fma_f32 v[62:63], v[166:167], v[142:143], v[62:63]
    v_cvt_pk_bf16_f32 v16, v56, v57
    v_cvt_pk_bf16_f32 v17, v58, v59
    v_cvt_pk_bf16_f32 v18, v60, v61
    v_cvt_pk_bf16_f32 v19, v62, v63
    ds_write_b128 v208, v[16:19] offset:2048
    ds_read_b128 v[32:35], v199 offset:2048
    s_waitcnt lgkmcnt(2)
    buffer_store_dwordx4 v[24:27], v4, s[16:19], 0 offen sc1
    v_add_f32 v152, v232, v236
    v_sub_f32 v160, v232, v236
    s_cmp_eq_u64 s[64:65], 0
    s_cbranch_scc1 L_nodump1
    s_mov_b64 exec, s[56:57]
    ds_write_b128 v6, v[152:155] offset:42624
    ds_write_b128 v6, v[156:159] offset:42640
    s_mov_b64 exec, s[60:61]
    ds_write_b128 v6, v[160:163] offset:42624
    ds_write_b128 v6, v[164:167] offset:42640
    s_mov_b64 exec, 1
    ds_add_u32 v0, v255 offset:42864
    s_mov_b64 exec, -1
    s_waitcnt lgkmcnt(0)
L_nodump1:
    v_pk_fma_f32 v[48:49], v[152:153], v[128:129], v[48:49]
    v_pk_fma_f32 v[50:51], v[154:155], v[130:131], v[50:51]
    v_pk_fma_f32 v[52:53], v[156:157], v[132:133], v[52:53]
    v_pk_fma_f32 v[54:55], v[158:159], v[134:135], v[54:55]
    v_cvt_pk_bf16_f32 v12, v48, v55
    v_cvt_pk_bf16_f32 v13, v54, v53
    v_cvt_pk_bf16_f32 v14, v52, v51
    v_cvt_pk_bf16_f32 v15, v50, v49
    ds_write_b128 v208, v[12:15] offset:1024
    ds_read_b128 v[28:31], v199 offset:1024
    s_waitcnt lgkmcnt(2)
    buffer_store_dwordx4 v[32:35], v249, s[16:19], 0 offen sc1
    v_pk_fma_f32 v[64:65], v[160:161], v[144:145], v[64:65]
    v_pk_fma_f32 v[66:67], v[162:163], v[146:147], v[66:67]
    v_pk_fma_f32 v[68:69], v[164:165], v[148:149], v[68:69]
    v_pk_fma_f32 v[70:71], v[166:167], v[150:151], v[70:71]
    v_cvt_pk_bf16_f32 v20, v64, v71
    v_cvt_pk_bf16_f32 v21, v70, v69
    v_cvt_pk_bf16_f32 v22, v68, v67
    v_cvt_pk_bf16_f32 v23, v66, v65
    ds_write_b128 v208, v[20:23] offset:3072
    ds_read_b128 v[36:39], v199 offset:3072
    s_waitcnt lgkmcnt(2)
    buffer_store_dwordx4 v[28:31], v5, s[16:19], 0 offen sc1
    s_waitcnt lgkmcnt(0)
    buffer_store_dwordx4 v[36:39], v205, s[16:19], 0 offen sc1
    s_branch L_fin
L_dma_done:
    s_setprio 3
    s_lshr_b32 s31, s47, 2
    s_andn2_b32 s31, s31, s75
    s_add_u32 s50, s31, s46
    s_lshl_b32 s31, s50, 17
    s_bfe_u32 s32, s2, 0x20003
    s_lshl_b32 s32, s32, 2
    s_add_u32 s51, s32, s30
    s_lshl_b32 s32, s51, 7
    s_add_u32 s31, s31, s32
    v_lshrrev_b32 v6, 3, v2
    v_lshlrev_b32 v6, 14, v6
    v_and_b32 v7, 0x70, v3
    v_add3_u32 v6, v6, v7, s31
    s_mov_b32 s60, 4096
    s_mov_b32 s61, 8192
    s_mov_b32 s62, 12288
    v_bfe_u32 v8, v2, 2, 3
    v_lshlrev_b32 v9, 5, v8
    s_lshl_b32 s31, s30, 6
    v_xor_b32 v9, s31, v9
    v_bfe_u32 v8, v2, 2, 2
    v_lshl_add_u32 v9, v8, 8, v9
    v_lshrrev_b32 v8, 4, v2
    v_lshl_add_u32 v9, v8, 11, v9
    v_and_b32 v10, 3, v2
    v_lshl_add_u32 v9, v10, 3, v9
    v_add_u32 v9, 76800, v9
    v_xor_b32 v10, 32, v9
    v_lshlrev_b32 v8, 4, v8
    s_lshr_b32 s31, s30, 1
    s_and_b32 s32, s31, s75
    s_lshl_b32 s32, s32, 8
    v_add_u32 v8, s32, v8
    s_cmp_eq_u32 s75, 0
    s_cselect_b32 s32, 12, 9
    s_lshl_b32 s31, s31, s32
    s_lshl_b32 s32, s46, 3
    s_add_u32 s32, s32, s47
    s_lshl_b32 s32, s32, 9
    s_add_u32 s31, s31, s32
    s_and_b32 s32, s30, 1
    s_lshl_b32 s32, s32, 8
    s_add_u32 s31, s31, s32
    s_add_u32 s31, s31, 262144
    v_lshl_add_u32 v13, v2, 3, s31
    s_waitcnt lgkmcnt(0)
    s_add_u32 s28, s28, 0x7f4a7c15
    s_addc_u32 s29, s29, 0x9e3779b9
    s_and_b32 s31, s28, 0xff
    v_mov_b32 v14, s31
    s_mov_b32 s49, 0xffffff00
    s_cmp_lg_u32 s30, 2
    s_cbranch_scc1 L_no_tlb
    s_mov_b32 s52, s44
    s_mov_b32 s53, s45
    s_mov_b32 s54, 0x400000
    s_mov_b32 s55, 0x00020000
    v_lshlrev_b32 v250, 20, v2
    s_mov_b64 exec, 0xff
    buffer_load_dword v251, v250, s[12:15], 0 offen
    buffer_load_dword v252, v250, s[52:55], 0 offen
    buffer_load_dword v253, v250, s[24:27], 0 offen
    s_mov_b64 exec, -1
L_no_tlb:
    s_cmp_lg_u32 s66, 0
    s_cbranch_scc1 L_tagged
    s_mov_b64 exec, 1
    ds_add_u32 v0, v255 offset:42872
    s_mov_b64 exec, -1
L_tagged:
    s_cmp_eq_u32 s30, 3
    s_cbranch_scc1 L_h1
    s_cmp_eq_u32 s66, 0
    s_cbranch_scc1 L_key
    s_cmp_lg_u32 s30, 0
    s_cbranch_scc1 L_follower
    s_waitcnt vmcnt(16)
    s_mov_b64 exec, 1
    ds_add_u32 v0, v255 offset:42868
    s_mov_b64 exec, -1
    ds_read_b64_tr_b16 v[36:37], v9 offset:0
    ds_read_b64_tr_b16 v[38:39], v9 offset:1024
    ds_read_b64_tr_b16 v[40:41], v10 offset:0
    ds_read_b64_tr_b16 v[42:43], v10 offset:1024
    ds_read_b64_tr_b16 v[44:45], v9 offset:32768
    ds_read_b64_tr_b16 v[46:47], v9 offset:33792
    ds_read_b64_tr_b16 v[48:49], v10 offset:32768
    ds_read_b64_tr_b16 v[50:51], v10 offset:33792
    ds_read_b64_tr_b16 v[52:53], v9 offset:8192
    ds_read_b64_tr_b16 v[54:55], v9 offset:9216
    ds_read_b64_tr_b16 v[56:57], v10 offset:8192
    ds_read_b64_tr_b16 v[58:59], v10 offset:9216
    ds_read_b64_tr_b16 v[60:61], v9 offset:40960
    ds_read_b64_tr_b16 v[62:63], v9 offset:41984
    s_waitcnt lgkmcnt(12)
    ds_read_b64_tr_b16 v[64:65], v10 offset:40960
    ds_read_b64_tr_b16 v[66:67], v10 offset:41984
    s_waitcnt lgkmcnt(12)
    ds_read_b64_tr_b16 v[68:69], v9 offset:16384
    ds_read_b64_tr_b16 v[70:71], v9 offset:17408
    s_waitcnt lgkmcnt(12)
    ds_read_b64_tr_b16 v[72:73], v10 offset:16384
    ds_read_b64_tr_b16 v[74:75], v10 offset:17408
    s_waitcnt lgkmcnt(12)
    ds_read_b64_tr_b16 v[76:77], v9 offset:49152
    ds_read_b64_tr_b16 v[78:79], v9 offset:50176
    s_waitcnt lgkmcnt(12)
    ds_read_b64_tr_b16 v[80:81], v10 offset:49152
    ds_read_b64_tr_b16 v[82:83], v10 offset:50176
    s_waitcnt vmcnt(8)
    s_mov_b64 exec, 1
    ds_add_u32 v0, v255 offset:42868
    s_mov_b64 exec, -1
    s_branch L_key
L_follower:
    s_and_b32 s32, s30, 1
    s_lshl_b32 s32, s32, 8
    v_subrev_u32 v250, s32, v13
    buffer_load_dword v251, v250, s[12:15], 0 offen
    s_lshl_b32 s31, s50, 12
    s_sub_u32 s31, s31, s32
    s_lshl_b32 s32, s51, 8
    s_add_u32 s31, s31, s32
    s_add_u32 s31, s31, 524288
    v_lshl_add_u32 v250, v2, 3, s31
    buffer_load_dword v252, v250, s[12:15], 0 offen
L_sync10:
    ds_read_b32 v1, v0 offset:42868
    s_waitcnt lgkmcnt(0)
    v_readfirstlane_b32 s31, v1
    s_nop 0
    s_cmp_ge_u32 s31, 1
    s_cbranch_scc0 L_sync10
    ds_read_b64_tr_b16 v[36:37], v9 offset:0
    ds_read_b64_tr_b16 v[38:39], v9 offset:1024
    ds_read_b64_tr_b16 v[40:41], v10 offset:0
    ds_read_b64_tr_b16 v[42:43], v10 offset:1024
    ds_read_b64_tr_b16 v[44:45], v9 offset:32768
    ds_read_b64_tr_b16 v[46:47], v9 offset:33792
    ds_read_b64_tr_b16 v[48:49], v10 offset:32768
    ds_read_b64_tr_b16 v[50:51], v10 offset:33792
    ds_read_b64_tr_b16 v[52:53], v9 offset:8192
    ds_read_b64_tr_b16 v[54:55], v9 offset:9216
    ds_read_b64_tr_b16 v[56:57], v10 offset:8192
    ds_read_b64_tr_b16 v[58:59], v10 offset:9216
    ds_read_b64_tr_b16 v[60:61], v9 offset:40960
    ds_read_b64_tr_b16 v[62:63], v9 offset:41984
    s_waitcnt lgkmcnt(12)
    ds_read_b64_tr_b16 v[64:65], v10 offset:40960
    ds_read_b64_tr_b16 v[66:67], v10 offset:41984
    s_waitcnt lgkmcnt(12)
    ds_read_b64_tr_b16 v[68:69], v9 offset:16384
    ds_read_b64_tr_b16 v[70:71], v9 offset:17408
    s_waitcnt lgkmcnt(12)
    ds_read_b64_tr_b16 v[72:73], v10 offset:16384
    ds_read_b64_tr_b16 v[74:75], v10 offset:17408
    s_waitcnt lgkmcnt(12)
    ds_read_b64_tr_b16 v[76:77], v9 offset:49152
    ds_read_b64_tr_b16 v[78:79], v9 offset:50176
    s_waitcnt lgkmcnt(12)
    ds_read_b64_tr_b16 v[80:81], v10 offset:49152
    ds_read_b64_tr_b16 v[82:83], v10 offset:50176
    s_add_u32 s67, s30, 0
L_sync11:
    ds_read_b32 v1, v0 offset:42868
    s_waitcnt lgkmcnt(0)
    v_readfirstlane_b32 s31, v1
    s_nop 0
    s_cmp_ge_u32 s31, s67
    s_cbranch_scc0 L_sync11
L_d_first:
L_sync12:
    ds_read_b32 v1, v0 offset:42840
    s_waitcnt lgkmcnt(0)
    v_readfirstlane_b32 s31, v1
    s_nop 0
    s_cmp_ge_u32 s31, 1
    s_cbranch_scc0 L_sync12
    buffer_load_dwordx4 v[100:103], v6, s[24:27], 0 offen offset:0 nt
    buffer_load_dwordx4 v[104:107], v6, s[24:27], 0 offen offset:2048 nt
    buffer_load_dwordx4 v[108:111], v6, s[24:27], s60 offen offset:0 nt
    buffer_load_dwordx4 v[112:115], v6, s[24:27], s60 offen offset:2048 nt
    buffer_load_dwordx4 v[116:119], v6, s[24:27], s61 offen offset:0 nt
    buffer_load_dwordx4 v[120:123], v6, s[24:27], s61 offen offset:2048 nt
    buffer_load_dwordx4 v[124:127], v6, s[24:27], s62 offen offset:0 nt
    buffer_load_dwordx4 v[128:131], v6, s[24:27], s62 offen offset:2048 nt
L_key:
L_sync13:
    ds_read_b32 v1, v0 offset:42844
    s_waitcnt lgkmcnt(0)
    v_readfirstlane_b32 s31, v1
    s_nop 0
    s_cmp_ge_u32 s31, 1
    s_cbranch_scc0 L_sync13
    ds_read_b64 v[18:19], v0 offset:41552
    s_cmp_eq_u32 s66, 0
    s_cbranch_scc1 L_idle
    s_branch L_xs_ok
L_h1:
    s_mov_b32 s63, 4096
    s_lshl_b32 s31, s47, 8
    v_lshlrev_b32 v15, 3, v2
    v_add_u32 v16, s31, v15
    s_cmp_lg_u32 s66, 0
    s_cbranch_scc1 L_gate
L_sync14:
    ds_read_b32 v1, v0 offset:42828
    s_waitcnt lgkmcnt(0)
    v_readfirstlane_b32 s31, v1
    s_nop 0
    s_cmp_ge_u32 s31, 4
    s_cbranch_scc0 L_sync14
    s_branch L_gate_open
L_gate:
L_sync15:
    ds_read_b32 v1, v0 offset:42824
    s_waitcnt lgkmcnt(0)
    v_readfirstlane_b32 s31, v1
    s_nop 0
    s_cmp_ge_u32 s31, 4
    s_cbranch_scc0 L_sync15
L_gate_open:
    buffer_load_dwordx4 v[20:23], v3, s[12:15], s63 offen offset:0 sc1
    buffer_load_dwordx4 v[24:27], v3, s[12:15], s63 offen offset:1024 sc1
    buffer_load_dwordx4 v[28:31], v3, s[12:15], s63 offen offset:2048 sc1
    buffer_load_dwordx4 v[32:35], v3, s[12:15], s63 offen offset:3072 sc1
    s_mov_b64 exec, 1
    ds_add_u32 v0, v255 offset:42860
    s_mov_b64 exec, -1
    s_waitcnt vmcnt(0)
L_mi_check:
    v_cmp_ne_u64 s[52:53], s[28:29], v[22:23]
    v_cmp_ne_u64 s[54:55], s[28:29], v[26:27]
    v_cmp_ne_u64 s[56:57], s[28:29], v[30:31]
    v_cmp_ne_u64 s[58:59], s[28:29], v[34:35]
    v_max_u32 v18, v21, v25
    v_max3_u32 v18, v18, v29, v33
    s_or_b64 s[64:65], s[52:53], s[54:55]
    s_or_b64 vcc, s[56:57], s[58:59]
    s_or_b64 s[64:65], s[64:65], vcc
    s_cbranch_scc0 L_mi_got
    s_cmp_eq_u32 s35, 0
    s_cbranch_scc1 L_mi_got
    s_sub_u32 s35, s35, 1
    s_sleep 2
    s_mov_b64 exec, s[52:53]
    s_cbranch_execz L_mi_skip0
    buffer_load_dwordx4 v[20:23], v3, s[12:15], s63 offen offset:0 sc1
L_mi_skip0:
    s_mov_b64 exec, s[54:55]
    s_cbranch_execz L_mi_skip1
    buffer_load_dwordx4 v[24:27], v3, s[12:15], s63 offen offset:1024 sc1
L_mi_skip1:
    s_mov_b64 exec, s[56:57]
    s_cbranch_execz L_mi_skip2
    buffer_load_dwordx4 v[28:31], v3, s[12:15], s63 offen offset:2048 sc1
L_mi_skip2:
    s_mov_b64 exec, s[58:59]
    s_cbranch_execz L_mi_skip3
    buffer_load_dwordx4 v[32:35], v3, s[12:15], s63 offen offset:3072 sc1
L_mi_skip3:
    s_mov_b64 exec, -1
    s_waitcnt vmcnt(0)
    s_branch L_mi_check
L_mi_got:
    v_max_u32_dpp v19, v18, v18 row_ror:1 row_mask:0xf bank_mask:0xf
    s_nop 1
    v_max_u32_dpp v19, v19, v19 row_ror:2 row_mask:0xf bank_mask:0xf
    s_nop 1
    v_max_u32_dpp v19, v19, v19 row_ror:4 row_mask:0xf bank_mask:0xf
    s_nop 1
    v_max_u32_dpp v19, v19, v19 row_ror:8 row_mask:0xf bank_mask:0xf
    s_nop 0
    v_readlane_b32 s33, v19, 0
    v_readlane_b32 s31, v19, 16
    v_readlane_b32 s32, v19, 32
    v_readlane_b32 s34, v19, 48
    s_max_u32 s33, s33, s31
    s_max_u32 s32, s32, s34
    s_max_u32 s33, s33, s32
    s_andn2_b32 s31, 0x7ff, s33
    s_lshl_b32 s48, s31, 11
    buffer_load_dwordx2 v[150:151], v16, s[8:11], s48 offen
    s_mov_b64 exec, 1
    ds_add_u32 v0, v255 offset:42840
    s_mov_b64 exec, -1
    v_cmp_eq_u32 s[52:53], s33, v25
    v_cmp_eq_u32 s[54:55], s33, v29
    v_cmp_eq_u32 s[56:57], s33, v33
    v_cmp_eq_u32 vcc, s33, v18
    v_cndmask_b32 v19, v20, v24, s[52:53]
    v_cndmask_b32 v19, v19, v28, s[54:55]
    v_cndmask_b32 v19, v19, v32, s[56:57]
    s_ff1_i32_b64 s32, vcc
    v_readlane_b32 s34, v19, s32
    v_mov_b32 v19, s33
    s_nop 0
    v_mov_b32 v18, s34
    ds_write_b64 v0, v[18:19] offset:41552
    s_lshl_b32 s52, s34, 16
    s_and_b32 s32, s34, 0xffff0000
    v_rcp_f32 v148, s32
    s_waitcnt vmcnt(0)
    v_lshlrev_b32 v20, 16, v150
    v_and_b32 v21, 0xffff0000, v150
    v_lshlrev_b32 v22, 16, v151
    v_and_b32 v23, 0xffff0000, v151
    v_pk_add_f32 v[20:21], v[20:21], s[52:53] op_sel_hi:[1,0] neg_lo:[0,1] neg_hi:[0,1]
    v_pk_add_f32 v[22:23], v[22:23], s[52:53] op_sel_hi:[1,0] neg_lo:[0,1] neg_hi:[0,1]
    v_cvt_pk_bf16_f32 v150, v20, v21
    v_cvt_pk_bf16_f32 v151, v22, v23
    v_lshlrev_b32 v20, 16, v150
    v_and_b32 v21, 0xffff0000, v150
    v_lshlrev_b32 v22, 16, v151
    v_and_b32 v23, 0xffff0000, v151
    v_pk_mul_f32 v[20:21], v[20:21], v[148:149] op_sel_hi:[1,0]
    v_pk_mul_f32 v[22:23], v[22:23], v[148:149] op_sel_hi:[1,0]
    v_cvt_pk_bf16_f32 v150, v20, v21
    v_cvt_pk_bf16_f32 v151, v22, v23
    ds_write_b64 v15, v[150:151] offset:41600
    s_mov_b64 exec, 1
    ds_add_u32 v0, v255 offset:42844
    s_mov_b64 exec, -1
    s_cmp_eq_u32 s66, 0
    s_cbranch_scc1 L_idle
L_sync16:
    ds_read_b32 v1, v0 offset:42868
    s_waitcnt lgkmcnt(0)
    v_readfirstlane_b32 s31, v1
    s_nop 0
    s_cmp_ge_u32 s31, 1
    s_cbranch_scc0 L_sync16
    ds_read_b64_tr_b16 v[36:37], v9 offset:0
    ds_read_b64_tr_b16 v[38:39], v9 offset:1024
    ds_read_b64_tr_b16 v[40:41], v10 offset:0
    ds_read_b64_tr_b16 v[42:43], v10 offset:1024
    ds_read_b64_tr_b16 v[44:45], v9 offset:32768
    ds_read_b64_tr_b16 v[46:47], v9 offset:33792
    ds_read_b64_tr_b16 v[48:49], v10 offset:32768
    ds_read_b64_tr_b16 v[50:51], v10 offset:33792
    ds_read_b64_tr_b16 v[52:53], v9 offset:8192
    ds_read_b64_tr_b16 v[54:55], v9 offset:9216
    ds_read_b64_tr_b16 v[56:57], v10 offset:8192
    ds_read_b64_tr_b16 v[58:59], v10 offset:9216
    ds_read_b64_tr_b16 v[60:61], v9 offset:40960
    ds_read_b64_tr_b16 v[62:63], v9 offset:41984
    s_waitcnt lgkmcnt(12)
    ds_read_b64_tr_b16 v[64:65], v10 offset:40960
    ds_read_b64_tr_b16 v[66:67], v10 offset:41984
    s_waitcnt lgkmcnt(12)
    ds_read_b64_tr_b16 v[68:69], v9 offset:16384
    ds_read_b64_tr_b16 v[70:71], v9 offset:17408
    s_waitcnt lgkmcnt(12)
    ds_read_b64_tr_b16 v[72:73], v10 offset:16384
    ds_read_b64_tr_b16 v[74:75], v10 offset:17408
    s_waitcnt lgkmcnt(12)
    ds_read_b64_tr_b16 v[76:77], v9 offset:49152
    ds_read_b64_tr_b16 v[78:79], v9 offset:50176
    s_waitcnt lgkmcnt(12)
    ds_read_b64_tr_b16 v[80:81], v10 offset:49152
    ds_read_b64_tr_b16 v[82:83], v10 offset:50176
    s_waitcnt lgkmcnt(8)
L_xs_ok:
    ds_read_b128 v[20:23], v8 offset:41600
    ds_read_b128 v[24:27], v8 offset:41664
    ds_read_b128 v[28:31], v8 offset:41728
    ds_read_b128 v[32:35], v8 offset:41792
    s_waitcnt lgkmcnt(3)
    v_mfma_f32_16x16x32_bf16 v[132:135], v[20:23], v[36:39], 0
    v_mfma_f32_16x16x32_bf16 v[136:139], v[20:23], v[40:43], 0
    v_mfma_f32_16x16x32_bf16 v[140:143], v[20:23], v[44:47], 0
    v_mfma_f32_16x16x32_bf16 v[144:147], v[20:23], v[48:51], 0
    s_waitcnt lgkmcnt(2)
    v_mfma_f32_16x16x32_bf16 v[132:135], v[24:27], v[52:55], v[132:135]
    v_mfma_f32_16x16x32_bf16 v[136:139], v[24:27], v[56:59], v[136:139]
    v_mfma_f32_16x16x32_bf16 v[140:143], v[24:27], v[60:63], v[140:143]
    v_mfma_f32_16x16x32_bf16 v[144:147], v[24:27], v[64:67], v[144:147]
    s_waitcnt lgkmcnt(1)
    v_mfma_f32_16x16x32_bf16 v[132:135], v[28:31], v[68:71], v[132:135]
    v_mfma_f32_16x16x32_bf16 v[136:139], v[28:31], v[72:75], v[136:139]
    v_mfma_f32_16x16x32_bf16 v[140:143], v[28:31], v[76:79], v[140:143]
    v_mfma_f32_16x16x32_bf16 v[144:147], v[28:31], v[80:83], v[144:147]
    s_cmp_lg_u32 s30, 0
    s_cbranch_scc1 L_k3_wait
    s_waitcnt vmcnt(0)
    s_mov_b64 exec, 1
    ds_add_u32 v0, v255 offset:42868
    s_mov_b64 exec, -1
    s_branch L_k3_ok
L_k3_wait:
L_sync17:
    ds_read_b32 v1, v0 offset:42868
    s_waitcnt lgkmcnt(0)
    v_readfirstlane_b32 s31, v1
    s_nop 0
    s_cmp_ge_u32 s31, 3
    s_cbranch_scc0 L_sync17
L_k3_ok:
    ds_read_b64_tr_b16 v[84:85], v9 offset:24576
    ds_read_b64_tr_b16 v[86:87], v9 offset:25600
    ds_read_b64_tr_b16 v[88:89], v10 offset:24576
    ds_read_b64_tr_b16 v[90:91], v10 offset:25600
    ds_read_b64_tr_b16 v[92:93], v9 offset:57344
    ds_read_b64_tr_b16 v[94:95], v9 offset:58368
    ds_read_b64_tr_b16 v[96:97], v10 offset:57344
    ds_read_b64_tr_b16 v[98:99], v10 offset:58368
    v_readfirstlane_b32 s33, v19
    v_readfirstlane_b32 s34, v18
    s_waitcnt lgkmcnt(6)
    v_mfma_f32_16x16x32_bf16 v[132:135], v[32:35], v[84:87], v[132:135]
    s_waitcnt lgkmcnt(4)
    v_mfma_f32_16x16x32_bf16 v[136:139], v[32:35], v[88:91], v[136:139]
    s_waitcnt lgkmcnt(2)
    v_mfma_f32_16x16x32_bf16 v[140:143], v[32:35], v[92:95], v[140:143]
    s_waitcnt lgkmcnt(0)
    v_mfma_f32_16x16x32_bf16 v[144:147], v[32:35], v[96:99], v[144:147]
    s_mov_b32 vcc_lo, 0xffff0000
    s_mov_b32 vcc_hi, 0
    s_lshl_b32 s31, s50, 12
    s_lshl_b32 s32, s30, 7
    s_add_u32 s31, s31, s32
    s_add_u32 s31, s31, 262144
    v_lshrrev_b32 v15, 3, v2
    v_lshlrev_b32 v15, 9, v15
    v_add3_u32 v15, v15, v7, s31
    v_cndmask_b32 v26, v132, v136, vcc
    v_cndmask_b32 v27, v140, v144, vcc
    v_and_or_b32 v26, v26, s49, v14
    v_and_or_b32 v27, v27, s49, v14
    s_mov_b32 exec_hi, 0
    buffer_store_dwordx2 v[26:27], v13, s[12:15], 0 offen sc1
    s_mov_b64 exec, -1
    s_sub_u32 s31, s30, 1
    s_cmp_lt_u32 s31, 2
    s_cbranch_scc1 L_d_rest
    buffer_load_dwordx4 v[100:103], v6, s[24:27], 0 offen offset:0 nt
    buffer_load_dwordx4 v[104:107], v6, s[24:27], 0 offen offset:2048 nt
    buffer_load_dwordx4 v[108:111], v6, s[24:27], s60 offen offset:0 nt
    buffer_load_dwordx4 v[112:115], v6, s[24:27], s60 offen offset:2048 nt
    buffer_load_dwordx4 v[116:119], v6, s[24:27], s61 offen offset:0 nt
    buffer_load_dwordx4 v[120:123], v6, s[24:27], s61 offen offset:2048 nt
    buffer_load_dwordx4 v[124:127], v6, s[24:27], s62 offen offset:0 nt
    buffer_load_dwordx4 v[128:131], v6, s[24:27], s62 offen offset:2048 nt
L_d_rest:
    s_mov_b64 exec, 1
    ds_add_u32 v0, v255 offset:42848
    s_mov_b64 exec, -1
    s_mov_b32 s52, 0x05040100
    s_mov_b32 s53, 0x07060302
    v_mov_b32 v36, 0
    v_mov_b32 v37, 0
    v_mov_b32 v38, 0
    v_mov_b32 v39, 0
    v_mov_b32 v40, 0
    v_mov_b32 v41, 0
    v_mov_b32 v42, 0
    v_mov_b32 v43, 0
    v_and_b32 v16, 7, v2
    v_lshlrev_b32 v16, 2, v16
    v_lshrrev_b32 v17, 5, v2
    v_lshl_add_u32 v16, v17, 1, v16
    s_lshl_b32 s31, s30, 5
    v_add_u32 v16, s31, v16
    v_lshrrev_b32 v17, 3, v2
    v_lshlrev_b32 v17, 4, v17
    s_lshl_b32 s31, s50, 12
    s_lshl_b32 s32, s51, 8
    s_add_u32 s31, s31, s32
    s_add_u32 s31, s31, 524288
    v_lshlrev_b32 v18, 1, v7
    v_lshrrev_b32 v19, 4, v2
    v_lshl_add_u32 v18, v19, 3, v18
    v_add_u32 v18, s31, v18
    s_waitcnt vmcnt(6)
    v_perm_b32 v98, v104, v100, s52
    v_perm_b32 v104, v104, v100, s53
    v_perm_b32 v100, v105, v101, s52
    v_perm_b32 v105, v105, v101, s53
    v_perm_b32 v101, v106, v102, s52
    v_perm_b32 v106, v106, v102, s53
    v_perm_b32 v102, v107, v103, s52
    v_perm_b32 v107, v107, v103, s53
    s_waitcnt vmcnt(4)
    v_perm_b32 v103, v112, v108, s52
    v_perm_b32 v112, v112, v108, s53
    v_perm_b32 v108, v113, v109, s52
    v_perm_b32 v113, v113, v109, s53
    v_perm_b32 v109, v114, v110, s52
    v_perm_b32 v114, v114, v110, s53
    v_perm_b32 v110, v115, v111, s52
    v_perm_b32 v115, v115, v111, s53
    s_waitcnt vmcnt(2)
    v_perm_b32 v111, v120, v116, s52
    v_perm_b32 v120, v120, v116, s53
    v_perm_b32 v116, v121, v117, s52
    v_perm_b32 v121, v121, v117, s53
    v_perm_b32 v117, v122, v118, s52
    v_perm_b32 v122, v122, v118, s53
    v_perm_b32 v118, v123, v119, s52
    v_perm_b32 v123, v123, v119, s53
    s_waitcnt vmcnt(0)
    v_perm_b32 v119, v128, v124, s52
    v_perm_b32 v128, v128, v124, s53
    v_perm_b32 v124, v129, v125, s52
    v_perm_b32 v129, v129, v125, s53
    v_perm_b32 v125, v130, v126, s52
    v_perm_b32 v130, v130, v126, s53
    v_perm_b32 v126, v131, v127, s52
    v_perm_b32 v131, v131, v127, s53
    s_mov_b32 s54, 0
L_hp_poll:
    buffer_load_dwordx4 v[20:23], v15, s[12:15], 0 offen sc1
L_hp_wait:
    s_waitcnt vmcnt(0)
    v_xor_b32 v20, v14, v20
    v_xor_b32 v21, v14, v21
    v_xor_b32 v22, v14, v22
    v_xor_b32 v23, v14, v23
    v_or3_b32 v24, v20, v21, v22
    v_or_b32 v24, v24, v23
    v_and_b32 v24, 0xff, v24
    v_cmp_ne_u32 vcc, 0, v24
    v_permlane16_swap_b32 v20, v21
    v_permlane16_swap_b32 v22, v23
    s_cbranch_vccz L_hp_got
    s_cmp_eq_u32 s35, 0
    s_cbranch_scc1 L_hp_got
    s_sub_u32 s35, s35, 1
    s_branch L_hp_poll
L_hp_got:
    v_add_f32 v20, v20, v21
    v_add_f32 v22, v22, v23
    s_nop 1
    v_permlane32_swap_b32 v20, v22
    v_add_f32 v20, v20, v22
    s_nop 1
    v_add_f32_dpp v21, v20, v20 row_ror:8 row_mask:0xf bank_mask:0xf
    v_add_f32_dpp v20, v20, v20 row_ror:8 row_mask:0xf bank_mask:0xf
    s_nop 1
    v_permlane16_swap_b32 v20, v21
    v_cvt_pk_bf16_f32 v20, v20, v21
    v_and_b32 v21, 0xffff0000, v20
    v_lshlrev_b32 v20, 16, v20
    v_mul_f32 v22, 0xbfb8aa3b, v20
    v_exp_f32 v22, v22
    s_nop 0
    v_add_f32 v22, 1.0, v22
    v_rcp_f32 v22, v22
    s_nop 0
    v_mul_f32 v20, v20, v22
    v_cvt_pk_bf16_f32 v20, v20, v20
    v_lshlrev_b32 v20, 16, v20
    v_mul_f32 v20, v20, v21
    v_cvt_pk_bf16_f32 v20, v20, v20
    ds_write_b16 v16, v20 offset:42368
    s_mov_b64 exec, 1
    ds_add_u32 v0, v255 offset:42852
    s_mov_b64 exec, -1
L_sync18:
    ds_read_b32 v1, v0 offset:42852
    s_waitcnt lgkmcnt(0)
    v_readfirstlane_b32 s31, v1
    s_nop 0
    s_cmp_ge_u32 s31, 4
    s_cbranch_scc0 L_sync18
    ds_read_b128 v[20:23], v17 offset:42368
    s_waitcnt lgkmcnt(0)
    v_dot2c_f32_bf16 v36, v20, v98
    v_dot2c_f32_bf16 v37, v20, v104
    v_dot2c_f32_bf16 v38, v20, v100
    v_dot2c_f32_bf16 v39, v20, v105
    v_dot2c_f32_bf16 v40, v20, v101
    v_dot2c_f32_bf16 v41, v20, v106
    v_dot2c_f32_bf16 v42, v20, v102
    v_dot2c_f32_bf16 v43, v20, v107
    v_dot2c_f32_bf16 v36, v21, v103
    v_dot2c_f32_bf16 v37, v21, v112
    v_dot2c_f32_bf16 v38, v21, v108
    v_dot2c_f32_bf16 v39, v21, v113
    v_dot2c_f32_bf16 v40, v21, v109
    v_dot2c_f32_bf16 v41, v21, v114
    v_dot2c_f32_bf16 v42, v21, v110
    v_dot2c_f32_bf16 v43, v21, v115
    v_dot2c_f32_bf16 v36, v22, v111
    v_dot2c_f32_bf16 v37, v22, v120
    v_dot2c_f32_bf16 v38, v22, v116
    v_dot2c_f32_bf16 v39, v22, v121
    v_dot2c_f32_bf16 v40, v22, v117
    v_dot2c_f32_bf16 v41, v22, v122
    v_dot2c_f32_bf16 v42, v22, v118
    v_dot2c_f32_bf16 v43, v22, v123
    v_dot2c_f32_bf16 v36, v23, v119
    v_dot2c_f32_bf16 v37, v23, v128
    v_dot2c_f32_bf16 v38, v23, v124
    v_dot2c_f32_bf16 v39, v23, v129
    v_dot2c_f32_bf16 v40, v23, v125
    v_dot2c_f32_bf16 v41, v23, v130
    v_dot2c_f32_bf16 v42, v23, v126
    v_dot2c_f32_bf16 v43, v23, v131
    v_permlane32_swap_b32 v36, v40
    v_permlane32_swap_b32 v37, v41
    v_permlane32_swap_b32 v38, v42
    v_permlane32_swap_b32 v39, v43
    v_add_f32 v36, v36, v40
    v_add_f32 v37, v37, v41
    v_add_f32 v38, v38, v42
    v_add_f32 v39, v39, v43
    s_nop 0
    v_permlane16_swap_b32 v36, v38
    v_permlane16_swap_b32 v37, v39
    v_add_f32 v36, v36, v38
    v_add_f32 v37, v37, v39
    s_nop 0
    v_add_f32_dpp v36, v36, v36 row_ror:8 row_mask:0xf bank_mask:0xf
    v_add_f32_dpp v37, v37, v37 row_ror:8 row_mask:0xf bank_mask:0xf
    v_and_or_b32 v36, v36, s49, v14
    v_and_or_b32 v37, v37, s49, v14
    s_mov_b32 exec_lo, 0x00ff00ff
    s_mov_b32 exec_hi, 0x00ff00ff
    buffer_store_dwordx2 v[36:37], v18, s[12:15], 0 offen sc1
    s_mov_b64 exec, 1
    ds_add_u32 v0, v255 offset:42856
    s_mov_b64 exec, -1
    s_branch L_owner
L_idle:
    s_mov_b64 exec, 1
    ds_add_u32 v0, v255 offset:42868
    s_mov_b64 exec, -1
    s_mov_b64 exec, 1
    ds_add_u32 v0, v255 offset:42848
    s_mov_b64 exec, -1
    s_mov_b64 exec, 1
    ds_add_u32 v0, v255 offset:42852
    s_mov_b64 exec, -1
    s_mov_b64 exec, 1
    ds_add_u32 v0, v255 offset:42856
    s_mov_b64 exec, -1
    s_waitcnt lgkmcnt(0)
    v_readfirstlane_b32 s33, v19
    v_readfirstlane_b32 s34, v18
L_owner:
    s_and_b32 s31, s2, 7
    s_sub_u32 s32, 8, s31
    s_min_u32 s46, s31, s32
    s_cmp_gt_u32 s31, 4
    s_cselect_b32 s31, 16, 0
    s_lshr_b32 s47, s2, 4
    s_add_u32 s47, s47, s31
    s_bfe_u32 s53, s2, 0x10003
    s_lshl_b32 s53, s53, 7
    s_add_u32 s53, s53, s31
    s_lshl_b32 s53, s53, 3
    s_add_u32 s53, s53, s46
    s_andn2_b32 s51, 0x7ff, s33
    s_mov_b32 s54, s51
    s_mov_b32 s55, 0
    s_mov_b32 s56, 0
    s_mov_b32 s16, s44
    s_mov_b32 s17, s45
    s_mov_b32 s18, 0x400000
    v_and_b32 v8, 31, v2
    v_lshlrev_b32 v15, 2, v8
    v_lshlrev_b32 v8, 1, v8
    v_mov_b32 v16, 0
L_seg:
    s_xor_b32 s31, s54, s53
    s_and_b32 s31, s31, 0x487
    s_cbranch_scc0 L_seg_own
    s_cmpk_lg_u32 s31, 0x480
    s_cbranch_scc1 L_seg_next
L_seg_own:
    s_lshl_b32 s31, s51, 11
    s_lshl_b32 s32, s47, 6
    s_add_u32 s63, s31, s32
    buffer_load_ushort v9, v8, s[8:11], s63 offen
    v_lshrrev_b32 v4, 3, v2
    s_lshl_b32 s31, s30, 4
    v_add_u32 v4, s31, v4
    v_lshlrev_b32 v4, 12, v4
    s_lshl_b32 s31, s47, 7
    s_add_u32 s31, s31, 524288
    v_add3_u32 v4, v4, v7, s31
    s_mov_b32 s62, 32768
    v_mov_b32 v24, v14
    v_mov_b32 v25, v14
    v_mov_b32 v26, v14
    v_mov_b32 v27, v14
    v_lshrrev_b32 v5, 4, v2
    v_lshl_add_u32 v6, v5, 2, v7
    s_lshl_b32 s31, s30, 7
    s_add_u32 s31, s31, s55
    v_add_u32 v6, s31, v6
    s_ashr_i32 s31, s33, 31
    s_orn2_b32 s31, 0x80000000, s31
    s_xor_b32 s31, s31, s33
    s_and_b32 s31, s31, 0xfffff800
    v_cvt_pk_bf16_f32 v11, s31, s31
    v_lshlrev_b32 v11, 16, v11
    v_mul_f32 v11, 0xbfb8aa3b, v11
    v_exp_f32 v11, v11
    s_and_b32 s32, s34, 0xffff0000
    v_add_f32 v11, 1.0, v11
    v_rcp_f32 v11, v11
    v_rcp_f32 v12, s32
    v_cvt_pk_bf16_f32 v11, v11, v11
    v_lshlrev_b32 v11, 16, v11
    s_lshl_b32 s31, s34, 16
    s_waitcnt vmcnt(0)
    v_lshl_add_u32 v13, v8, 1, s55
    s_mov_b64 vcc, -1
    s_mov_b32 s56, 1
L_y_poll:
    s_mov_b64 exec, vcc
    buffer_load_dwordx4 v[20:23], v4, s[12:15], 0 offen sc1
    s_cmp_eq_u32 s30, 3
    s_cbranch_scc1 L_y_one
    buffer_load_dwordx4 v[24:27], v4, s[12:15], s62 offen sc1
L_y_one:
    s_mov_b64 exec, -1
    s_waitcnt vmcnt(0)
    v_xor_b32 v28, v14, v20
    v_xor_b32 v29, v14, v21
    v_xor_b32 v30, v14, v22
    v_xor_b32 v31, v14, v23
    v_xor_b32 v32, v14, v24
    v_xor_b32 v33, v14, v25
    v_xor_b32 v34, v14, v26
    v_xor_b32 v35, v14, v27
    v_or3_b32 v1, v28, v29, v30
    v_or3_b32 v1, v1, v31, v32
    v_or3_b32 v1, v1, v33, v34
    v_or_b32 v1, v1, v35
    v_and_b32 v1, 0xff, v1
    v_cmp_ne_u32 vcc, 0, v1
    v_pk_add_f32 v[28:29], v[28:29], v[32:33]
    v_pk_add_f32 v[30:31], v[30:31], v[34:35]
    s_cbranch_vccz L_y_got
    s_cmp_eq_u32 s35, 0
    s_cbranch_scc1 L_y_got
    s_sub_u32 s35, s35, 1
    s_branch L_y_poll
L_y_got:
    v_permlane16_swap_b32 v28, v29
    v_permlane16_swap_b32 v30, v31
    v_add_f32 v28, v28, v29
    v_add_f32 v30, v30, v31
    s_nop 1
    v_permlane32_swap_b32 v28, v30
    v_add_f32 v28, v28, v30
    s_nop 1
    v_add_f32_dpp v28, v28, v28 row_ror:8 row_mask:0xf bank_mask:0xf
    ds_write_b32 v6, v28 offset:43008
    s_mov_b64 exec, 1
    ds_add_u32 v16, v255 offset:42836
    s_mov_b64 exec, -1
    s_cmp_lg_u32 s30, 0
    s_cbranch_scc1 L_seg_next
    s_cmp_eq_u32 s47, 0
    s_cselect_b32 s32, 0, 2147483392
    v_mov_b32 v5, 2147483392
    v_writelane_b32 v5, s32, 0
    v_mov_b32 v18, s28
    v_mov_b32 v19, s29
    s_lshl_b32 s31, s34, 16
    v_lshlrev_b32 v9, 16, v9
    v_subrev_f32 v10, s31, v9
    v_cvt_pk_bf16_f32 v10, v10, v10
    v_lshlrev_b32 v10, 16, v10
    v_mul_f32 v10, v10, v12
    v_cvt_pk_bf16_f32 v10, v10, v10
    v_lshlrev_b32 v10, 16, v10
L_rowsync:
    ds_read_b32 v1, v16 offset:42836
    s_waitcnt lgkmcnt(0)
    v_readfirstlane_b32 s31, v1
    s_nop 0
    s_cmp_ge_u32 s31, 5
    s_cbranch_scc0 L_rowsync
    ds_read_b32 v20, v13 offset:43008
    ds_read_b32 v21, v13 offset:43136
    ds_read_b32 v22, v13 offset:43264
    ds_read_b32 v23, v13 offset:43392
    ds_read_b32 v24, v15 offset:42496
    s_waitcnt lgkmcnt(0)
    v_add_f32 v20, v20, v21
    v_add_f32 v22, v22, v23
    v_add_f32 v20, v20, v22
    v_cvt_pk_bf16_f32 v20, v20, v20
    v_lshlrev_b32 v20, 16, v20
    v_mul_f32 v20, v20, v11
    v_cvt_pk_bf16_f32 v20, v20, v20
    v_lshlrev_b32 v20, 16, v20
    v_add_f32 v20, v20, v10
    v_cvt_pk_bf16_f32 v20, v20, v20
    v_lshlrev_b32 v20, 16, v20
    v_mul_f32 v1, 0xbfb8aa3b, v20
    v_mul_f32 v20, v1, v24
    v_exp_f32 v1, v1
    s_nop 0
    v_add_f32 v1, 1.0, v1
    v_rcp_f32 v1, v1
    s_mov_b32 exec_hi, 0
    v_fma_f32 v20, v20, v1, v9
    v_cvt_pk_bf16_f32 v20, v20, v20
    buffer_store_short v20, v8, s[16:19], s63 offen sc1
    buffer_store_dwordx2 v[18:19], v5, s[12:15], 0 offen sc1
    s_mov_b64 exec, -1
L_seg_next:
    s_cmp_lg_u32 s55, 0
    s_cbranch_scc1 L_seg_end
    s_mov_b32 s55, 512
    s_sub_u32 s54, 0, s51
    s_sub_u32 s47, 31, s47
    v_mov_b32 v16, 28
    v_and_b32 v15, 24, v2
    v_xor_b32 v15, 24, v15
    v_sub_u32 v1, 0, v2
    v_and_b32 v1, 7, v1
    v_add_u32 v15, v15, v1
    v_lshlrev_b32 v15, 2, v15
    v_add_u32 v15, 128, v15
    s_branch L_seg
L_seg_end:
L_fin:
L_exit:
    s_endpgm
L_code_end:
.section .rodata,"a"
.p2align 6
.amdhsa_kernel recurrent_scan__spectral_fnet__moe_arch_mod__prompt_kernel
  .amdhsa_next_free_vgpr 256
  .amdhsa_next_free_sgpr 92
  .amdhsa_accum_offset 256
  .amdhsa_group_segment_fixed_size 0
  .amdhsa_kernarg_size 104
  .amdhsa_user_sgpr_count 2
  .amdhsa_user_sgpr_kernarg_segment_ptr 1
  .amdhsa_system_sgpr_workgroup_id_x 1
  .amdhsa_float_denorm_mode_32 3
.end_amdhsa_kernel
```

```asm
; @launch grid=(256,1,1) block=(512,1,1) lds=158720
.amdgcn_target "amdgcn-amd-amdhsa--gfx950"
.text
.globl recurrent_scan__spectral_fnet__moe_arch_mod__prompt_kernel
.p2align 8
.type recurrent_scan__spectral_fnet__moe_arch_mod__prompt_kernel,@function
recurrent_scan__spectral_fnet__moe_arch_mod__prompt_kernel:
    s_cmp_ge_u32 s2, 256
    s_cbranch_scc1 L_exit
    s_load_dwordx2 s[8:9], s[0:1], 0
    s_load_dwordx4 s[36:39], s[0:1], 48
    s_load_dwordx2 s[12:13], s[0:1], 96
    s_getpc_b64 s[32:33]
L_pc:
    s_bfe_u32 s31, s2, 0x30003
    v_subrev_u32 v3, 496, v0
    v_lshl_add_u32 v3, v3, 3, s31
    v_lshlrev_b32 v3, 7, v3
    v_cmp_gt_u32 vcc, L_code_end-L_pc, v3
    s_nop 0
    s_and_saveexec_b64 s[46:47], vcc
    s_cbranch_execz L_nopf
    global_load_dword v254, v3, s[32:33]
L_nopf:
    s_mov_b64 exec, -1
    v_lshrrev_b32 v1, 6, v0
    v_and_b32 v2, 63, v0
    v_readfirstlane_b32 s30, v1
    s_mov_b32 s10, 0x400000
    s_mov_b32 s11, 0x00020000
    s_mov_b32 s14, 0x10000000
    s_mov_b32 s15, 0x00020000
    s_mov_b32 s35, 65536
    v_lshlrev_b32 v3, 4, v2
    v_mov_b32 v0, 0
    v_mov_b32 v255, 1
    s_mov_b32 s3, s30
    s_and_b32 s30, s30, 3
    s_cmp_ge_u32 s3, 4
    s_cbranch_scc1 L_moe
    s_and_b32 s31, s2, 7
    s_lshr_b32 s32, s2, 4
    s_sub_u32 s32, 15, s32
    s_lshl_b32 s32, s32, 3
    s_add_u32 s46, s32, s31
    s_bfe_u32 s47, s2, 0x10003
    s_lshl_b32 s31, s47, 2
    s_add_u32 s51, s31, s30
    s_lshl_b32 s31, s51, 8
    s_add_u32 s52, s31, s46
    s_xor_b32 s54, s52, 1024
    s_sub_u32 s53, 2048, s52
    s_add_u32 s31, s52, 128
    s_cmp_eq_u32 s46, 0
    s_cselect_b32 s53, s31, s53
    s_cselect_b32 s50, 1, 0
    s_xor_b32 s55, s53, 1024
    s_lshl_b32 s56, s52, 11
    s_lshl_b32 s57, s53, 11
    s_lshl_b32 s58, s54, 11
    s_lshl_b32 s59, s55, 11
    s_mov_b32 s22, 2048
    s_mov_b32 s23, 0x00020000
    v_mov_b32 v1, 0
    v_and_b32 v6, 15, v2
    v_lshlrev_b32 v6, 2, v6
    ds_write_b64 v0, v[0:1] offset:41504
    ds_write_b32 v6, v0 offset:42816
    s_waitcnt lgkmcnt(0)
    s_load_dwordx2 s[28:29], s[12:13], 0
    s_load_dwordx2 s[16:17], s[0:1], 80
    buffer_load_dwordx4 v[120:123], v3, s[8:11], s56 offen
    buffer_load_dwordx4 v[124:127], v3, s[8:11], s56 offen offset:1024
    buffer_load_dwordx4 v[128:131], v3, s[8:11], s57 offen
    buffer_load_dwordx4 v[132:135], v3, s[8:11], s57 offen offset:1024
    s_mov_b32 s20, s36
    s_mov_b32 s21, s37
    buffer_load_dwordx4 v[152:155], v3, s[20:23], 0 offen
    buffer_load_dwordx4 v[156:159], v3, s[20:23], 0 offen offset:1024
    buffer_load_dwordx4 v[136:139], v3, s[8:11], s58 offen
    buffer_load_dwordx4 v[140:143], v3, s[8:11], s58 offen offset:1024
    buffer_load_dwordx4 v[144:147], v3, s[8:11], s59 offen
    buffer_load_dwordx4 v[148:151], v3, s[8:11], s59 offen offset:1024
    s_barrier
    s_branch L_dft_rest
L_moe:
    s_load_dwordx2 s[20:21], s[0:1], 64
    s_and_b32 s32, s2, 7
    s_mul_i32 s32, s32, 28
    s_lshr_b32 s31, s2, 3
    s_add_u32 s31, s31, s32
    s_lshr_b32 s46, s31, 3
    s_lshl_b32 s46, s46, 1
    s_and_b32 s47, s31, 7
    s_mov_b32 s75, 0
    s_mov_b32 s18, 7340032
    s_mov_b32 s19, 0x00020000
    s_mov_b32 s22, 7340032
    s_mov_b32 s23, 0x00020000
    s_mov_b32 s26, 7340032
    s_mov_b32 s27, 0x00020000
    v_lshrrev_b32 v4, 4, v2
    v_lshlrev_b32 v5, 5, v4
    v_and_b32 v6, 0x70, v3
    v_xor_b32 v5, v5, v6
    v_mul_u32_u24 v4, 7168, v4
    s_mul_i32 s31, s47, 917504
    s_lshl_b32 s32, s46, 7
    s_add_u32 s31, s31, s32
    v_add3_u32 v4, v4, v5, s31
    s_cmp_eq_u32 s75, 0
    s_mov_b32 s31, 917504
    s_cselect_b32 s31, 128, s31
    v_add_u32 v6, s31, v4
    s_mov_b32 vcc_lo, 0xff00ff00
    s_mov_b32 vcc_hi, 0xff00ff00
    v_cndmask_b32 v5, v6, v4, vcc
    v_cndmask_b32 v4, v4, v6, vcc
    s_mov_b32 s48, 0
    s_mov_b32 s49, 76800
    s_waitcnt lgkmcnt(0)
    s_mov_b32 s16, s38
    s_mov_b32 s17, s39
    s_load_dwordx2 s[28:29], s[12:13], 0
    s_load_dwordx2 s[24:25], s[0:1], 72
    s_load_dwordx2 s[44:45], s[0:1], 80
    s_barrier
    s_cmp_ge_u32 s2, 224
    s_cselect_b32 s66, 0, 1
    s_cbranch_scc1 L_dma_done
    s_cmp_lg_u32 s30, 0
    s_cbranch_scc1 L_dma_done
    s_setprio 3
L_dma:
    s_mov_b32 m0, s49
    s_waitcnt vmcnt(22)
    buffer_load_dwordx4 v4, s[16:19], s48 offen nt lds
    s_add_u32 m0, s49, 32768
    s_add_u32 s49, s49, 1024
    buffer_load_dwordx4 v4, s[20:23], s48 offen nt lds
    s_add_u32 s48, s48, 28672
    s_mov_b32 m0, s49
    s_waitcnt vmcnt(22)
    buffer_load_dwordx4 v4, s[16:19], s48 offen nt lds
    s_add_u32 m0, s49, 32768
    s_add_u32 s49, s49, 1024
    buffer_load_dwordx4 v4, s[20:23], s48 offen nt lds
    s_add_u32 s48, s48, 28672
    s_mov_b32 m0, s49
    s_waitcnt vmcnt(22)
    buffer_load_dwordx4 v5, s[16:19], s48 offen nt lds
    s_add_u32 m0, s49, 32768
    s_add_u32 s49, s49, 1024
    buffer_load_dwordx4 v5, s[20:23], s48 offen nt lds
    s_add_u32 s48, s48, 28672
    s_mov_b32 m0, s49
    s_waitcnt vmcnt(22)
    buffer_load_dwordx4 v5, s[16:19], s48 offen nt lds
    s_add_u32 m0, s49, 32768
    s_add_u32 s49, s49, 1024
    buffer_load_dwordx4 v5, s[20:23], s48 offen nt lds
    s_add_u32 s48, s48, 28672
    s_cmp_lt_u32 s48, 917504
    s_cbranch_scc1 L_dma
    s_branch L_dma_done
L_dft_rest:
    s_mov_b32 s18, 0x400000
    s_mov_b32 s19, 0x00020000
    s_sub_u32 s31, 2047, s52
    s_sub_u32 s32, 2047, s53
    v_mov_b32 v200, s31
    v_writelane_b32 v200, s32, 63
    s_lshl_b32 s31, s30, 2
    v_mov_b32 v201, s31
    s_bfe_u32 s31, s53, 0x20008
    s_lshl_b32 s31, s31, 2
    s_add_u32 s31, s31, 16
    v_writelane_b32 v201, s31, 63
    v_and_b32 v6, 32, v2
    s_lshl_b32 s31, s51, 2
    v_add_u32 v203, s31, v6
    v_lshrrev_b32 v202, 1, v203
    s_lshl_b32 s31, s2, 4
    s_add_u32 s31, s31, 4096
    v_mov_b32 v4, s31
    v_lshlrev_b32 v5, 3, v2
    s_and_b32 s31, s52, 7
    s_lshl_b32 s31, s31, 11
    s_and_b32 s32, s52, 1024
    s_add_u32 s31, s31, s32
    s_and_b32 s32, s52, 0xf8
    s_lshl_b32 s32, s32, 2
    s_add_u32 s31, s31, s32
    s_add_u32 s31, s31, 32768
    v_writelane_b32 v4, s31, 0
    s_add_u32 s31, s31, 16
    v_writelane_b32 v4, s31, 1
    s_and_b32 s31, s53, 7
    s_lshl_b32 s31, s31, 11
    s_and_b32 s32, s53, 1024
    s_add_u32 s31, s31, s32
    s_and_b32 s32, s53, 0xf8
    s_lshl_b32 s32, s32, 2
    s_add_u32 s31, s31, s32
    s_add_u32 s31, s31, 32768
    v_writelane_b32 v4, s31, 2
    s_add_u32 s31, s31, 16
    v_writelane_b32 v4, s31, 3
    s_mul_i32 s31, s51, 2592
    v_and_b32 v204, 32, v2
    v_lshlrev_b32 v204, 2, v204
    v_add3_u32 v204, v204, v3, s31
    s_lshl_b32 s32, s31, 1
    s_add_u32 s32, s32, 21872
    v_sub_u32 v205, s32, v204
    v_bfe_u32 v206, v2, 2, 2
    v_mul_u32_u24 v206, 2592, v206
    v_lshrrev_b32 v6, 4, v2
    v_mul_u32_u24 v7, 640, v6
    v_add_u32 v206, v206, v7
    v_and_b32 v7, 3, v2
    v_lshlrev_b32 v7, 3, v7
    s_lshl_b32 s31, s30, 7
    v_add3_u32 v206, v206, v7, s31
    v_lshlrev_b32 v6, 12, v6
    v_and_b32 v7, 15, v2
    v_lshl_add_u32 v6, v7, 4, v6
    s_lshl_b32 s31, s30, 8
    v_add_u32 v207, s31, v6
    v_bfe_i32 v208, v2, 4, 1
    v_and_b32 v208, 0x80008000, v208
    s_cmp_eq_u32 s47, 0
    s_movk_i32 s48, 0x7403
    s_cselect_b32 s48, 0x7721, s48
    v_and_b32 v250, 12, v2
    v_bfe_u32 v250, s48, v250, 4
    v_lshrrev_b32 v251, 4, v2
    v_bfe_u32 v252, v2, 1, 1
    v_mul_u32_u24 v251, v251, v252
    v_and_b32 v252, 1, v2
    v_add_u32 v251, v251, v252
    v_cvt_f32_u32 v250, v250
    v_cvt_f32_u32 v251, v251
    v_mul_f32 v250, 0x3e000000, v250
    v_mul_f32 v251, 0x3e800000, v251
    v_cos_f32 v8, v251
    v_add_f32 v251, v251, v250
    v_cos_f32 v9, v251
    v_add_f32 v251, v251, v250
    v_cos_f32 v10, v251
    v_add_f32 v251, v251, v250
    v_cos_f32 v11, v251
    v_add_f32 v251, v251, v250
    v_cos_f32 v12, v251
    v_add_f32 v251, v251, v250
    v_cos_f32 v13, v251
    v_add_f32 v251, v251, v250
    v_cos_f32 v14, v251
    v_add_f32 v251, v251, v250
    v_cos_f32 v15, v251
    v_mul_f32 v8, 0xbf317218, v8
    v_mul_f32 v9, 0xbf317218, v9
    v_mul_f32 v10, 0xbf317218, v10
    v_mul_f32 v11, 0xbf317218, v11
    v_mul_f32 v12, 0xbf317218, v12
    v_mul_f32 v13, 0xbf317218, v13
    v_mul_f32 v14, 0xbf317218, v14
    v_mul_f32 v15, 0xbf317218, v15
    v_lshrrev_b32 v250, 2, v2
    v_and_b32 v250, 12, v250
    v_and_b32 v251, 15, v2
    v_lshlrev_b32 v251, 2, v251
    v_cvt_f32_u32 v250, v250
    v_cvt_f32_u32 v251, v251
    v_mul_f32 v212, 0x3c800000, v250
    s_lshl_b32 s31, s30, 2
    s_lshr_b32 s48, s48, s31
    s_and_b32 s48, s48, 15
    s_sub_u32 s31, s48, 4
    s_mul_i32 s31, s31, s46
    v_cvt_f32_i32 v252, s31
    v_mul_f32 v252, 0x3a000000, v252
    v_add_f32 v213, 0x3c800000, v212
    v_add_f32 v214, 0x3d000000, v212
    v_add_f32 v215, 0x3d400000, v212
    s_and_b32 s31, s2, 7
    s_sub_u32 s32, 8, s31
    s_min_u32 s76, s31, s32
    s_cmp_gt_u32 s31, 4
    s_cselect_b32 s31, 16, 0
    s_lshr_b32 s77, s2, 4
    s_add_u32 s77, s77, s31
    s_bfe_u32 s78, s2, 0x10003
    s_lshl_b32 s78, s78, 7
    s_add_u32 s78, s78, s31
    s_lshl_b32 s31, s30, 5
    s_add_u32 s78, s78, s31
    s_lshl_b32 s78, s78, 3
    s_add_u32 s78, s78, s76
    s_lshl_b32 s77, s77, 6
    s_sub_u32 s79, 1984, s77
    s_lshl_b32 s76, s76, 1
    s_add_u32 s76, s76, 2040
    v_and_b32 v116, 15, v2
    v_lshl_add_u32 v116, v116, 3, s78
    s_mov_b32 vcc_lo, 0
    s_mov_b32 vcc_hi, -1
    v_sub_u32 v7, s76, v116
    v_cndmask_b32 v7, v116, v7, vcc
    s_mov_b32 vcc_lo, 0xffff0000
    s_mov_b32 vcc_hi, 0xffff0000
    v_sub_u32 v6, 0, v7
    v_cndmask_b32 v7, v7, v6, vcc
    v_and_b32 v6, 7, v7
    v_and_b32 v1, 1024, v7
    v_lshl_add_u32 v6, v6, 11, v1
    v_and_b32 v1, 0xf8, v7
    v_lshl_add_u32 v6, v1, 2, v6
    v_bfe_u32 v1, v7, 9, 1
    v_lshl_add_u32 v119, v1, 4, v6
    v_and_b32 v1, 256, v7
    v_cmp_ne_u32 s[88:89], 0, v1
    v_lshrrev_b32 v118, 2, v2
    v_lshl_add_u32 v118, v118, 3, s78
    v_lshlrev_b32 v1, 1, v2
    v_xor_b32 v1, v1, v3
    v_and_b32 v1, 48, v1
    v_sub_u32 v113, 0, v118
    v_sub_u32 v114, s76, v118
    v_and_b32 v113, 2047, v113
    v_sub_u32 v115, 2048, v114
    v_add_u32 v112, s77, v1
    v_lshl_add_u32 v114, v114, 11, v112
    v_lshl_add_u32 v112, v118, 11, v112
    v_xor_b32 v1, 48, v1
    v_add_u32 v1, s79, v1
    v_lshl_add_u32 v113, v113, 11, v1
    v_lshl_add_u32 v115, v115, 11, v1
    s_lshl_b32 s76, s30, 12
    s_add_u32 s76, s76, 142336
    v_and_b32 v1, 15, v2
    v_lshlrev_b32 v6, 6, v1
    v_lshlrev_b32 v1, 3, v2
    v_xor_b32 v1, v1, v2
    v_and_b32 v1, 48, v1
    v_add3_u32 v117, v6, v1, s76
    v_mul_f32 v250, v212, v251
    v_fmamk_f32 v52, v250, 0x3d800000, v252
    v_sin_f32 v20, v250
    v_cos_f32 v250, v250
    v_cos_f32 v48, v52
    v_sin_f32 v52, v52
    v_cvt_pk_f16_f32 v16, v250, v20
    v_cvt_pk_f16_f32 v20, -v20, v250
    v_mul_f32 v250, v213, v251
    v_fmamk_f32 v53, v250, 0x3d800000, v252
    v_sin_f32 v21, v250
    v_cos_f32 v250, v250
    v_cos_f32 v49, v53
    v_sin_f32 v53, v53
    v_cvt_pk_f16_f32 v17, v250, v21
    v_cvt_pk_f16_f32 v21, -v21, v250
    v_mul_f32 v250, v214, v251
    v_fmamk_f32 v54, v250, 0x3d800000, v252
    v_sin_f32 v22, v250
    v_cos_f32 v250, v250
    v_cos_f32 v50, v54
    v_sin_f32 v54, v54
    v_cvt_pk_f16_f32 v18, v250, v22
    v_cvt_pk_f16_f32 v22, -v22, v250
    v_mul_f32 v250, v215, v251
    v_fmamk_f32 v55, v250, 0x3d800000, v252
    v_sin_f32 v23, v250
    v_cos_f32 v250, v250
    v_cos_f32 v51, v55
    v_sin_f32 v55, v55
    v_cvt_pk_f16_f32 v19, v250, v23
    v_cvt_pk_f16_f32 v23, -v23, v250
    v_add_f32 v251, 1.0, v251
    v_mul_f32 v250, v212, v251
    v_fmamk_f32 v60, v250, 0x3d800000, v252
    v_sin_f32 v28, v250
    v_cos_f32 v250, v250
    v_cos_f32 v56, v60
    v_sin_f32 v60, v60
    v_cvt_pk_f16_f32 v24, v250, v28
    v_cvt_pk_f16_f32 v28, -v28, v250
    v_mul_f32 v250, v213, v251
    v_fmamk_f32 v61, v250, 0x3d800000, v252
    v_sin_f32 v29, v250
    v_cos_f32 v250, v250
    v_cos_f32 v57, v61
    v_sin_f32 v61, v61
    v_cvt_pk_f16_f32 v25, v250, v29
    v_cvt_pk_f16_f32 v29, -v29, v250
    v_mul_f32 v250, v214, v251
    v_fmamk_f32 v62, v250, 0x3d800000, v252
    v_sin_f32 v30, v250
    v_cos_f32 v250, v250
    v_cos_f32 v58, v62
    v_sin_f32 v62, v62
    v_cvt_pk_f16_f32 v26, v250, v30
    v_cvt_pk_f16_f32 v30, -v30, v250
    v_mul_f32 v250, v215, v251
    v_fmamk_f32 v63, v250, 0x3d800000, v252
    v_sin_f32 v31, v250
    v_cos_f32 v250, v250
    v_cos_f32 v59, v63
    v_sin_f32 v63, v63
    v_cvt_pk_f16_f32 v27, v250, v31
    v_cvt_pk_f16_f32 v31, -v31, v250
    v_add_f32 v251, 1.0, v251
    v_mov_b32 v160, 0
    v_mov_b32 v161, 0
    v_mov_b32 v162, 0
    v_mov_b32 v163, 0
    v_mov_b32 v164, 0
    v_mov_b32 v165, 0
    v_mov_b32 v166, 0
    v_mov_b32 v167, 0
    v_mov_b32 v168, 0
    v_mov_b32 v169, 0
    v_mov_b32 v170, 0
    s_mov_b32 s57, 0x3f803f80
    s_mov_b32 s59, 0xffff
    s_brev_b32 s67, 1
    s_mov_b32 s66, 0
    s_brev_b32 s64, 1
    s_brev_b32 s65, 1
    s_cmp_eq_u32 s47, 0
    s_movk_i32 s62, -10368
    s_cselect_b32 s62, 10368, s62
    s_waitcnt lgkmcnt(0)
    s_add_u32 s28, s28, 0x7f4a7c15
    s_addc_u32 s29, s29, 0x9e3779b9
    v_mov_b32 v174, s28
    v_mov_b32 v175, s29
    s_cmp_lt_u32 s2, 224
    s_cbranch_scc1 L_epoch_ok
L_sync1:
    ds_read_b32 v1, v0 offset:42872
    s_waitcnt lgkmcnt(0)
    v_readfirstlane_b32 s31, v1
    s_nop 0
    s_cmp_ge_u32 s31, 4
    s_cbranch_scc0 L_sync1
L_epoch_ok:
    s_setprio 2
    s_waitcnt vmcnt(8)
    v_dot2c_f32_bf16 v160, s57, v120
    v_dot2c_f32_bf16 v164, v120, v120
    v_dot2c_f32_bf16 v160, s57, v121
    v_dot2c_f32_bf16 v164, v121, v121
    v_dot2c_f32_bf16 v160, s57, v122
    v_dot2c_f32_bf16 v164, v122, v122
    v_dot2c_f32_bf16 v160, s57, v123
    v_dot2c_f32_bf16 v164, v123, v123
    v_dot2c_f32_bf16 v160, s57, v124
    v_dot2c_f32_bf16 v164, v124, v124
    v_dot2c_f32_bf16 v160, s57, v125
    v_dot2c_f32_bf16 v164, v125, v125
    v_dot2c_f32_bf16 v160, s57, v126
    v_dot2c_f32_bf16 v164, v126, v126
    v_dot2c_f32_bf16 v160, s57, v127
    v_dot2c_f32_bf16 v164, v127, v127
    s_waitcnt vmcnt(6)
    v_dot2c_f32_bf16 v161, s57, v128
    v_dot2c_f32_bf16 v165, v128, v128
    v_dot2c_f32_bf16 v161, s57, v129
    v_dot2c_f32_bf16 v165, v129, v129
    v_dot2c_f32_bf16 v161, s57, v130
    v_dot2c_f32_bf16 v165, v130, v130
    v_dot2c_f32_bf16 v161, s57, v131
    v_dot2c_f32_bf16 v165, v131, v131
    v_dot2c_f32_bf16 v161, s57, v132
    v_dot2c_f32_bf16 v165, v132, v132
    v_dot2c_f32_bf16 v161, s57, v133
    v_dot2c_f32_bf16 v165, v133, v133
    v_dot2c_f32_bf16 v161, s57, v134
    v_dot2c_f32_bf16 v165, v134, v134
    v_dot2c_f32_bf16 v161, s57, v135
    v_dot2c_f32_bf16 v165, v135, v135
    s_waitcnt vmcnt(4)
    v_dot2c_f32_bf16 v170, s57, v152
    v_dot2c_f32_bf16 v170, s57, v153
    v_dot2c_f32_bf16 v170, s57, v154
    v_dot2c_f32_bf16 v170, s57, v155
    v_dot2c_f32_bf16 v170, s57, v156
    v_dot2c_f32_bf16 v170, s57, v157
    v_dot2c_f32_bf16 v170, s57, v158
    v_dot2c_f32_bf16 v170, s57, v159
    v_dot2c_f32_bf16 v168, v152, v120
    v_dot2c_f32_bf16 v169, v152, v128
    v_dot2c_f32_bf16 v168, v153, v121
    v_dot2c_f32_bf16 v169, v153, v129
    v_dot2c_f32_bf16 v168, v154, v122
    v_dot2c_f32_bf16 v169, v154, v130
    v_dot2c_f32_bf16 v168, v155, v123
    v_dot2c_f32_bf16 v169, v155, v131
    v_mov_b32 v171, v170
    v_dot2c_f32_bf16 v168, v156, v124
    v_dot2c_f32_bf16 v169, v156, v132
    v_dot2c_f32_bf16 v168, v157, v125
    v_dot2c_f32_bf16 v169, v157, v133
    v_dot2c_f32_bf16 v168, v158, v126
    v_dot2c_f32_bf16 v169, v158, v134
    v_dot2c_f32_bf16 v168, v159, v127
    v_dot2c_f32_bf16 v169, v159, v135
    v_permlane32_swap_b32 v160, v161
    v_permlane32_swap_b32 v164, v165
    v_permlane32_swap_b32 v170, v171
    v_permlane32_swap_b32 v168, v169
    v_add_f32 v160, v160, v161
    v_add_f32 v164, v164, v165
    v_add_f32 v170, v170, v171
    v_add_f32 v168, v168, v169
    v_add_f32_dpp v160, v160, v160 row_shr:1 row_mask:0xf bank_mask:0xf
    v_add_f32_dpp v164, v164, v164 row_shr:1 row_mask:0xf bank_mask:0xf
    v_add_f32_dpp v170, v170, v170 row_shr:1 row_mask:0xf bank_mask:0xf
    v_add_f32_dpp v168, v168, v168 row_shr:1 row_mask:0xf bank_mask:0xf
    v_add_f32_dpp v160, v160, v160 row_shr:2 row_mask:0xf bank_mask:0xf
    v_add_f32_dpp v164, v164, v164 row_shr:2 row_mask:0xf bank_mask:0xf
    v_add_f32_dpp v170, v170, v170 row_shr:2 row_mask:0xf bank_mask:0xf
    v_add_f32_dpp v168, v168, v168 row_shr:2 row_mask:0xf bank_mask:0xf
    v_add_f32_dpp v160, v160, v160 row_shr:4 row_mask:0xf bank_mask:0xf
    v_add_f32_dpp v164, v164, v164 row_shr:4 row_mask:0xf bank_mask:0xf
    v_add_f32_dpp v170, v170, v170 row_shr:4 row_mask:0xf bank_mask:0xf
    v_add_f32_dpp v168, v168, v168 row_shr:4 row_mask:0xf bank_mask:0xf
    v_add_f32_dpp v160, v160, v160 row_shr:8 row_mask:0xf bank_mask:0xf
    v_add_f32_dpp v164, v164, v164 row_shr:8 row_mask:0xf bank_mask:0xf
    v_add_f32_dpp v170, v170, v170 row_shr:8 row_mask:0xf bank_mask:0xf
    v_add_f32_dpp v168, v168, v168 row_shr:8 row_mask:0xf bank_mask:0xf
    v_add_f32_dpp v160, v160, v160 row_bcast:15 row_mask:0xa bank_mask:0xf
    v_add_f32_dpp v164, v164, v164 row_bcast:15 row_mask:0xa bank_mask:0xf
    v_add_f32_dpp v170, v170, v170 row_bcast:15 row_mask:0xa bank_mask:0xf
    v_add_f32_dpp v168, v168, v168 row_bcast:15 row_mask:0xa bank_mask:0xf
    v_mul_f32 v160, 0x3a800000, v160
    v_mul_f32 v164, 0x3a800000, v164
    v_fma_f32 v164, -v160, v160, v164
    v_cvt_pk_bf16_f32 v161, -v160, -v160
    v_max_f32 v164, 0, v164
    v_cvt_pk_bf16_f32 v164, v164, v164
    v_and_b32 v164, 0xffff0000, v164
    v_add_f32 v164, 0x3727c5ac, v164
    v_cvt_pk_bf16_f32 v164, v164, v164
    v_and_b32 v164, 0xffff0000, v164
    v_sqrt_f32 v164, v164
    v_and_b32 v165, 0xffff0000, v161
    v_cvt_pk_bf16_f32 v248, v160, v164
    v_and_b32 v164, 0xffff0000, v248
    v_rcp_f32 v164, v164
    v_fmac_f32 v168, v170, v165
    v_mul_f32 v168, v168, v164
    v_ashrrev_i32 v170, 31, v168
    v_or_b32 v170, 0x80000000, v170
    v_xor_b32 v168, v168, v170
    v_and_b32 v168, 0xfffff800, v168
    v_or_b32 v249, v200, v168
    s_mov_b64 exec, s[64:65]
    ds_write_b32 v201, v248 offset:41472
    ds_max_u64 v0, v[248:249] offset:41504
    s_mov_b64 exec, 1
    ds_add_rtn_u32 v1, v0, v255 offset:42816
    s_mov_b64 exec, 31
    ds_read_b64 v[172:173], v5 offset:41472
    s_mov_b64 exec, s[64:65]
    ds_write_b16 v202, v161 offset:41568
    ds_write_b32 v203, v164 offset:42752
    s_mov_b64 exec, -1
    v_mov_b32_dpp v6, v128 wave_rol:1 row_mask:0xf bank_mask:0xf
    v_mov_b32_dpp v7, v132 wave_rol:1 row_mask:0xf bank_mask:0xf
    v_bfi_b32 v221, s59, v131, v130
    v_bfi_b32 v222, s59, v130, v129
    v_bfi_b32 v223, s59, v129, v128
    v_bfi_b32 v217, s59, v135, v134
    v_bfi_b32 v218, s59, v134, v133
    v_bfi_b32 v219, s59, v133, v132
    v_cndmask_b32 v220, v6, v7, s[66:67]
    v_cndmask_b32 v216, v7, v6, s[66:67]
    v_bfi_b32 v220, s59, v220, v131
    v_bfi_b32 v216, s59, v216, v135
    s_waitcnt lgkmcnt(2)
    v_readfirstlane_b32 s31, v1
    s_nop 0
    s_cmp_lg_u32 s31, 3
    s_cbranch_scc1 L_not_last
    s_mov_b64 exec, 31
    buffer_store_dwordx4 v[172:175], v4, s[12:15], 0 offen sc1
    s_mov_b64 exec, -1
    s_waitcnt vmcnt(1)
    s_branch L_b_ready
L_not_last:
    s_waitcnt vmcnt(0)
L_b_ready:
    s_setprio 1
    ds_write_b128 v204, v[120:123] offset:0
    ds_write_b128 v204, v[124:127] offset:1280
    s_cmp_lg_u32 s50, 0
    s_cbranch_scc1 L_plain1
    ds_write_b128 v205, v[216:219]
    ds_write_b128 v205, v[220:223] offset:1280
    s_branch L_second1
L_plain1:
    ds_write_b128 v204, v[128:131] offset:20736
    ds_write_b128 v204, v[132:135] offset:22016
L_second1:
    v_add_u32 v204, s62, v204
    v_add_u32 v205, s62, v205
    v_dot2c_f32_bf16 v162, s57, v136
    v_dot2c_f32_bf16 v166, v136, v136
    v_dot2c_f32_bf16 v162, s57, v137
    v_dot2c_f32_bf16 v166, v137, v137
    v_dot2c_f32_bf16 v162, s57, v138
    v_dot2c_f32_bf16 v166, v138, v138
    v_dot2c_f32_bf16 v162, s57, v139
    v_dot2c_f32_bf16 v166, v139, v139
    v_dot2c_f32_bf16 v162, s57, v140
    v_dot2c_f32_bf16 v166, v140, v140
    v_dot2c_f32_bf16 v162, s57, v141
    v_dot2c_f32_bf16 v166, v141, v141
    v_dot2c_f32_bf16 v162, s57, v142
    v_dot2c_f32_bf16 v166, v142, v142
    v_dot2c_f32_bf16 v162, s57, v143
    v_dot2c_f32_bf16 v166, v143, v143
    ds_write_b128 v204, v[136:139] offset:0
    ds_write_b128 v204, v[140:143] offset:1280
    v_dot2c_f32_bf16 v163, s57, v144
    v_dot2c_f32_bf16 v167, v144, v144
    v_dot2c_f32_bf16 v163, s57, v145
    v_dot2c_f32_bf16 v167, v145, v145
    v_dot2c_f32_bf16 v163, s57, v146
    v_dot2c_f32_bf16 v167, v146, v146
    v_dot2c_f32_bf16 v163, s57, v147
    v_dot2c_f32_bf16 v167, v147, v147
    v_dot2c_f32_bf16 v163, s57, v148
    v_dot2c_f32_bf16 v167, v148, v148
    v_dot2c_f32_bf16 v163, s57, v149
    v_dot2c_f32_bf16 v167, v149, v149
    v_dot2c_f32_bf16 v163, s57, v150
    v_dot2c_f32_bf16 v167, v150, v150
    v_dot2c_f32_bf16 v163, s57, v151
    v_dot2c_f32_bf16 v167, v151, v151
    v_xor_b32 v202, 8, v202
    v_xor_b32 v203, 16, v203
    s_waitcnt lgkmcnt(2)
    v_mov_b32_dpp v6, v144 wave_rol:1 row_mask:0xf bank_mask:0xf
    v_mov_b32_dpp v7, v148 wave_rol:1 row_mask:0xf bank_mask:0xf
    v_bfi_b32 v221, s59, v147, v146
    v_bfi_b32 v222, s59, v146, v145
    v_bfi_b32 v223, s59, v145, v144
    v_bfi_b32 v217, s59, v151, v150
    v_bfi_b32 v218, s59, v150, v149
    v_bfi_b32 v219, s59, v149, v148
    v_cndmask_b32 v220, v6, v7, s[66:67]
    v_cndmask_b32 v216, v7, v6, s[66:67]
    v_bfi_b32 v220, s59, v220, v147
    v_bfi_b32 v216, s59, v216, v151
    s_cmp_lg_u32 s50, 0
    s_cbranch_scc1 L_plain3
    ds_write_b128 v205, v[216:219]
    ds_write_b128 v205, v[220:223] offset:1280
    s_branch L_second3
L_plain3:
    ds_write_b128 v204, v[144:147] offset:20736
    ds_write_b128 v204, v[148:151] offset:22016
L_second3:
    v_permlane32_swap_b32 v162, v163
    v_permlane32_swap_b32 v166, v167
    v_add_f32 v162, v162, v163
    v_add_f32 v166, v166, v167
    s_nop 0
    v_add_f32_dpp v162, v162, v162 row_shr:1 row_mask:0xf bank_mask:0xf
    v_add_f32_dpp v166, v166, v166 row_shr:1 row_mask:0xf bank_mask:0xf
    s_nop 0
    v_add_f32_dpp v162, v162, v162 row_shr:2 row_mask:0xf bank_mask:0xf
    v_add_f32_dpp v166, v166, v166 row_shr:2 row_mask:0xf bank_mask:0xf
    s_nop 0
    v_add_f32_dpp v162, v162, v162 row_shr:4 row_mask:0xf bank_mask:0xf
    v_add_f32_dpp v166, v166, v166 row_shr:4 row_mask:0xf bank_mask:0xf
    s_nop 0
    v_add_f32_dpp v162, v162, v162 row_shr:8 row_mask:0xf bank_mask:0xf
    v_add_f32_dpp v166, v166, v166 row_shr:8 row_mask:0xf bank_mask:0xf
    s_nop 0
    v_add_f32_dpp v162, v162, v162 row_bcast:15 row_mask:0xa bank_mask:0xf
    v_add_f32_dpp v166, v166, v166 row_bcast:15 row_mask:0xa bank_mask:0xf
    v_mul_f32 v162, 0x3a800000, v162
    v_mul_f32 v166, 0x3a800000, v166
    v_fma_f32 v166, -v162, v162, v166
    v_cvt_pk_bf16_f32 v161, -v162, -v162
    v_max_f32 v166, 0, v166
    v_cvt_pk_bf16_f32 v166, v166, v166
    v_and_b32 v166, 0xffff0000, v166
    v_add_f32 v166, 0x3727c5ac, v166
    v_cvt_pk_bf16_f32 v166, v166, v166
    v_and_b32 v166, 0xffff0000, v166
    v_sqrt_f32 v166, v166
    v_and_b32 v167, 0xffff0000, v161
    v_cvt_pk_bf16_f32 v248, v162, v166
    v_and_b32 v166, 0xffff0000, v248
    v_rcp_f32 v166, v166
    s_mov_b64 exec, s[64:65]
    ds_write_b16 v202, v161 offset:41568
    ds_write_b32 v203, v166 offset:42752
    s_mov_b64 exec, 1
    ds_add_u32 v0, v255 offset:42820
    s_mov_b64 exec, -1
L_sync2:
    ds_read_b32 v1, v0 offset:42820
    ds_read_b128 v[176:179], v0 offset:42752
    ds_read_b128 v[180:183], v0 offset:42768
    ds_read_b128 v[184:187], v0 offset:42784
    ds_read_b128 v[188:191], v0 offset:42800
    ds_read_b128 v[192:195], v0 offset:41568
    ds_read_b128 v[196:199], v0 offset:41584
    s_waitcnt lgkmcnt(6)
    v_readfirstlane_b32 s31, v1
    s_nop 0
    s_cmp_ge_u32 s31, 4
    s_cbranch_scc0 L_sync2
    ds_read_b64_tr_b16 v[120:121], v206 offset:0
    ds_read_b64_tr_b16 v[122:123], v206 offset:10368
    ds_read_b64_tr_b16 v[124:125], v206 offset:20736
    ds_read_b64_tr_b16 v[126:127], v206 offset:31104
    ds_read_b64_tr_b16 v[128:129], v206 offset:32
    ds_read_b64_tr_b16 v[130:131], v206 offset:10400
    ds_read_b64_tr_b16 v[132:133], v206 offset:20768
    ds_read_b64_tr_b16 v[134:135], v206 offset:31136
    s_add_u32 m0, s76, 0
    s_nop 0
    buffer_load_dwordx4 v112, s[8:11], 0 offen lds
    s_add_u32 m0, s76, 1024
    s_nop 0
    buffer_load_dwordx4 v113, s[8:11], 0 offen lds
    s_waitcnt lgkmcnt(10)
    ds_read_b64_tr_b16 v[136:137], v206 offset:64
    ds_read_b64_tr_b16 v[138:139], v206 offset:10432
    ds_read_b64_tr_b16 v[140:141], v206 offset:20800
    ds_read_b64_tr_b16 v[142:143], v206 offset:31168
    v_pk_mul_f32 v[176:177], v[176:177], v[8:9]
    v_pk_mul_f32 v[178:179], v[178:179], v[10:11]
    v_pk_mul_f32 v[180:181], v[180:181], v[12:13]
    v_pk_mul_f32 v[182:183], v[182:183], v[14:15]
    v_pk_mul_f32 v[184:185], v[184:185], v[8:9]
    v_pk_mul_f32 v[186:187], v[186:187], v[10:11]
    v_pk_mul_f32 v[188:189], v[188:189], v[12:13]
    v_pk_mul_f32 v[190:191], v[190:191], v[14:15]
    v_cvt_pk_bf16_f32 v160, v176, v177
    v_cvt_pk_bf16_f32 v152, v184, v185
    v_cvt_pk_bf16_f32 v161, v178, v179
    v_cvt_pk_bf16_f32 v153, v186, v187
    v_cvt_pk_bf16_f32 v162, v180, v181
    v_cvt_pk_bf16_f32 v154, v188, v189
    v_cvt_pk_bf16_f32 v163, v182, v183
    v_cvt_pk_bf16_f32 v155, v190, v191
    v_xor_b32 v164, v208, v160
    v_xor_b32 v156, v208, v152
    v_xor_b32 v165, v208, v161
    v_xor_b32 v157, v208, v153
    v_xor_b32 v166, v208, v162
    v_xor_b32 v158, v208, v154
    v_xor_b32 v167, v208, v163
    v_xor_b32 v159, v208, v155
    s_waitcnt lgkmcnt(12)
    s_cmp_lg_u32 s50, 0
    s_cbranch_scc1 L_st1_split
    v_mfma_f32_16x16x32_bf16 v[168:171], v[160:163], v[192:195], 0
    v_mfma_f32_16x16x32_bf16 v[168:171], v[152:155], v[196:199], v[168:171]
    s_waitcnt lgkmcnt(10)
    ds_read_b64_tr_b16 v[144:145], v206 offset:96
    ds_read_b64_tr_b16 v[146:147], v206 offset:10464
    ds_read_b64_tr_b16 v[148:149], v206 offset:20832
    ds_read_b64_tr_b16 v[150:151], v206 offset:31200
    v_mfma_f32_16x16x32_bf16 v[216:219], v[160:163], v[120:123], v[168:171]
    s_waitcnt lgkmcnt(12)
    v_mfma_f32_16x16x32_bf16 v[216:219], v[152:155], v[124:127], v[216:219]
    s_waitcnt lgkmcnt(10)
    v_mfma_f32_16x16x32_bf16 v[224:227], v[160:163], v[128:131], v[168:171]
    s_waitcnt lgkmcnt(8)
    v_mfma_f32_16x16x32_bf16 v[224:227], v[152:155], v[132:135], v[224:227]
    s_waitcnt lgkmcnt(6)
    v_mfma_f32_16x16x32_bf16 v[232:235], v[160:163], v[136:139], v[168:171]
    s_waitcnt lgkmcnt(4)
    v_mfma_f32_16x16x32_bf16 v[232:235], v[152:155], v[140:143], v[232:235]
    s_waitcnt lgkmcnt(2)
    v_mfma_f32_16x16x32_bf16 v[240:243], v[160:163], v[144:147], v[168:171]
    s_waitcnt lgkmcnt(0)
    v_mfma_f32_16x16x32_bf16 v[240:243], v[152:155], v[148:151], v[240:243]
    v_mfma_f32_16x16x32_bf16 v[220:223], v[164:167], v[120:123], 0
    v_mfma_f32_16x16x32_bf16 v[220:223], v[156:159], v[124:127], v[220:223]
    v_mfma_f32_16x16x32_bf16 v[228:231], v[164:167], v[128:131], 0
    v_mfma_f32_16x16x32_bf16 v[228:231], v[156:159], v[132:135], v[228:231]
    v_cvt_pk_f16_f32 v176, v216, v217
    v_cvt_pk_f16_f32 v177, v224, v225
    v_cvt_pk_f16_f32 v178, v232, v233
    s_nop 0
    v_cvt_pk_f16_f32 v179, v240, v241
    ds_write_b128 v207, v[176:179] offset:44032
    v_mfma_f32_16x16x32_bf16 v[236:239], v[164:167], v[136:139], 0
    v_mfma_f32_16x16x32_bf16 v[236:239], v[156:159], v[140:143], v[236:239]
    v_cvt_pk_f16_f32 v180, v218, v219
    v_cvt_pk_f16_f32 v181, v226, v227
    v_cvt_pk_f16_f32 v182, v234, v235
    v_cvt_pk_f16_f32 v183, v242, v243
    ds_write_b128 v207, v[180:183] offset:45056
    v_mfma_f32_16x16x32_bf16 v[244:247], v[164:167], v[144:147], 0
    v_mfma_f32_16x16x32_bf16 v[244:247], v[156:159], v[148:151], v[244:247]
    v_cvt_pk_f16_f32 v184, v220, v221
    v_cvt_pk_f16_f32 v185, v228, v229
    v_cvt_pk_f16_f32 v186, v236, v237
    s_nop 4
    v_cvt_pk_f16_f32 v187, v244, v245
    ds_write_b128 v207, v[184:187] offset:46080
    v_cvt_pk_f16_f32 v188, v222, v223
    v_cvt_pk_f16_f32 v189, v230, v231
    v_cvt_pk_f16_f32 v190, v238, v239
    v_cvt_pk_f16_f32 v191, v246, v247
    ds_write_b128 v207, v[188:191] offset:47104
    s_branch L_st1_done
L_st1_split:
    s_waitcnt lgkmcnt(8)
    ds_read_b64_tr_b16 v[144:145], v206 offset:96
    ds_read_b64_tr_b16 v[146:147], v206 offset:10464
    ds_read_b64_tr_b16 v[148:149], v206 offset:20832
    ds_read_b64_tr_b16 v[150:151], v206 offset:31200
    s_waitcnt lgkmcnt(0)
    v_mfma_f32_16x16x32_bf16 v[168:171], v[160:163], v[192:195], 0
    v_mfma_f32_16x16x32_bf16 v[220:223], v[164:167], v[120:123], 0
    v_mfma_f32_16x16x32_bf16 v[216:219], v[160:163], v[120:123], v[168:171]
    v_mfma_f32_16x16x32_bf16 v[228:231], v[164:167], v[128:131], 0
    v_mfma_f32_16x16x32_bf16 v[224:227], v[160:163], v[128:131], v[168:171]
    v_mfma_f32_16x16x32_bf16 v[236:239], v[164:167], v[136:139], 0
    v_mfma_f32_16x16x32_bf16 v[232:235], v[160:163], v[136:139], v[168:171]
    v_mfma_f32_16x16x32_bf16 v[244:247], v[164:167], v[144:147], 0
    v_mfma_f32_16x16x32_bf16 v[240:243], v[160:163], v[144:147], v[168:171]
    s_nop 1
    v_cvt_pk_f16_f32 v176, v216, v217
    v_cvt_pk_f16_f32 v180, v218, v219
    v_cvt_pk_f16_f32 v184, v220, v221
    v_cvt_pk_f16_f32 v188, v222, v223
    v_cvt_pk_f16_f32 v177, v224, v225
    v_cvt_pk_f16_f32 v181, v226, v227
    v_cvt_pk_f16_f32 v185, v228, v229
    v_cvt_pk_f16_f32 v189, v230, v231
    v_cvt_pk_f16_f32 v178, v232, v233
    v_cvt_pk_f16_f32 v182, v234, v235
    v_cvt_pk_f16_f32 v186, v236, v237
    v_cvt_pk_f16_f32 v190, v238, v239
    v_cvt_pk_f16_f32 v179, v240, v241
    v_cvt_pk_f16_f32 v183, v242, v243
    v_cvt_pk_f16_f32 v187, v244, v245
    v_cvt_pk_f16_f32 v191, v246, v247
    ds_write_b128 v207, v[176:179] offset:44032
    ds_write_b128 v207, v[180:183] offset:45056
    ds_write_b128 v207, v[184:187] offset:46080
    ds_write_b128 v207, v[188:191] offset:47104
    v_mfma_f32_16x16x32_bf16 v[168:171], v[152:155], v[196:199], 0
    v_mfma_f32_16x16x32_bf16 v[220:223], v[156:159], v[124:127], 0
    v_mfma_f32_16x16x32_bf16 v[216:219], v[152:155], v[124:127], v[168:171]
    v_mfma_f32_16x16x32_bf16 v[228:231], v[156:159], v[132:135], 0
    v_mfma_f32_16x16x32_bf16 v[224:227], v[152:155], v[132:135], v[168:171]
    v_mfma_f32_16x16x32_bf16 v[236:239], v[156:159], v[140:143], 0
    v_mfma_f32_16x16x32_bf16 v[232:235], v[152:155], v[140:143], v[168:171]
    v_mfma_f32_16x16x32_bf16 v[244:247], v[156:159], v[148:151], 0
    v_mfma_f32_16x16x32_bf16 v[240:243], v[152:155], v[148:151], v[168:171]
    s_waitcnt lgkmcnt(0)
    s_nop 0
    v_cvt_pk_f16_f32 v176, v216, v217
    v_cvt_pk_f16_f32 v180, v218, v219
    v_cvt_pk_f16_f32 v184, v220, v221
    v_cvt_pk_f16_f32 v188, v222, v223
    v_cvt_pk_f16_f32 v177, v224, v225
    v_cvt_pk_f16_f32 v181, v226, v227
    v_cvt_pk_f16_f32 v185, v228, v229
    v_cvt_pk_f16_f32 v189, v230, v231
    v_cvt_pk_f16_f32 v178, v232, v233
    v_cvt_pk_f16_f32 v182, v234, v235
    v_cvt_pk_f16_f32 v186, v236, v237
    v_cvt_pk_f16_f32 v190, v238, v239
    v_cvt_pk_f16_f32 v179, v240, v241
    v_cvt_pk_f16_f32 v183, v242, v243
    v_cvt_pk_f16_f32 v187, v244, v245
    v_cvt_pk_f16_f32 v191, v246, v247
    ds_write_b128 v207, v[176:179] offset:60416
    ds_write_b128 v207, v[180:183] offset:61440
    ds_write_b128 v207, v[184:187] offset:62464
    ds_write_b128 v207, v[188:191] offset:63488
L_st1_done:
    s_mov_b64 exec, 1
    ds_add_u32 v0, v255 offset:42824
    s_mov_b64 exec, -1
    s_lshl_b32 s31, s30, 12
    v_add_u32 v5, s31, v3
    s_and_b32 s31, s28, 0x30003
    v_mov_b32 v210, s31
    s_mov_b32 s58, 0xfffcfffc
    s_and_b32 s32, s48, 3
    s_cselect_b32 s72, -1, 0xff
    s_cselect_b32 s73, -1, 0
    s_mov_b32 s74, s48
    v_mov_b32 v209, 2147483392
    s_cmp_eq_u32 s48, 7
    s_cbranch_scc1 L_no_consts
    v_mul_f32 v250, v212, v251
    v_fmamk_f32 v68, v250, 0x3d800000, v252
    v_sin_f32 v36, v250
    v_cos_f32 v250, v250
    v_cos_f32 v64, v68
    v_sin_f32 v68, v68
    v_cvt_pk_f16_f32 v32, v250, v36
    v_cvt_pk_f16_f32 v36, -v36, v250
    v_mul_f32 v250, v213, v251
    v_fmamk_f32 v69, v250, 0x3d800000, v252
    v_sin_f32 v37, v250
    v_cos_f32 v250, v250
    v_cos_f32 v65, v69
    v_sin_f32 v69, v69
    v_cvt_pk_f16_f32 v33, v250, v37
    v_cvt_pk_f16_f32 v37, -v37, v250
    v_mul_f32 v250, v214, v251
    v_fmamk_f32 v70, v250, 0x3d800000, v252
    v_sin_f32 v38, v250
    v_cos_f32 v250, v250
    v_cos_f32 v66, v70
    v_sin_f32 v70, v70
    v_cvt_pk_f16_f32 v34, v250, v38
    v_cvt_pk_f16_f32 v38, -v38, v250
    v_mul_f32 v250, v215, v251
    v_fmamk_f32 v71, v250, 0x3d800000, v252
    v_sin_f32 v39, v250
    v_cos_f32 v250, v250
    v_cos_f32 v67, v71
    v_sin_f32 v71, v71
    v_cvt_pk_f16_f32 v35, v250, v39
    v_cvt_pk_f16_f32 v39, -v39, v250
    v_add_f32 v251, 1.0, v251
    v_mul_f32 v250, v212, v251
    v_fmamk_f32 v76, v250, 0x3d800000, v252
    v_sin_f32 v44, v250
    v_cos_f32 v250, v250
    v_cos_f32 v72, v76
    v_sin_f32 v76, v76
    v_cvt_pk_f16_f32 v40, v250, v44
    v_cvt_pk_f16_f32 v44, -v44, v250
    v_mul_f32 v250, v213, v251
    v_fmamk_f32 v77, v250, 0x3d800000, v252
    v_sin_f32 v45, v250
    v_cos_f32 v250, v250
    v_cos_f32 v73, v77
    v_sin_f32 v77, v77
    v_cvt_pk_f16_f32 v41, v250, v45
    v_cvt_pk_f16_f32 v45, -v45, v250
    v_mul_f32 v250, v214, v251
    v_fmamk_f32 v78, v250, 0x3d800000, v252
    v_sin_f32 v46, v250
    v_cos_f32 v250, v250
    v_cos_f32 v74, v78
    v_sin_f32 v78, v78
    v_cvt_pk_f16_f32 v42, v250, v46
    v_cvt_pk_f16_f32 v46, -v46, v250
    v_mul_f32 v250, v215, v251
    v_fmamk_f32 v79, v250, 0x3d800000, v252
    v_sin_f32 v47, v250
    v_cos_f32 v250, v250
    v_cos_f32 v75, v79
    v_sin_f32 v79, v79
    v_cvt_pk_f16_f32 v43, v250, v47
    v_cvt_pk_f16_f32 v47, -v47, v250
    s_and_b32 s31, s46, 1
    s_lshl_b32 s31, s31, 6
    s_lshr_b32 s32, s46, 1
    s_add_u32 s49, s31, s32
    s_bitcmp1_b32 s49, 2
    s_cselect_b64 vcc, -1, 0
    v_cndmask_b32 v80, v16, v20, vcc
    v_cndmask_b32 v84, v20, v16, vcc
    v_cndmask_b32 v81, v17, v21, vcc
    v_cndmask_b32 v85, v21, v17, vcc
    v_cndmask_b32 v82, v18, v22, vcc
    v_cndmask_b32 v86, v22, v18, vcc
    v_cndmask_b32 v83, v19, v23, vcc
    v_cndmask_b32 v87, v23, v19, vcc
    s_bfe_u32 s31, s49, 0x10001
    v_and_b32 v6, 7, v2
    v_xor_b32 v6, s31, v6
    v_lshlrev_b32 v6, 4, v6
    v_lshrrev_b32 v7, 4, v2
    v_lshlrev_b32 v7, 3, v7
    v_bfe_u32 v209, v2, 3, 1
    v_add_u32 v7, v7, v209
    v_mul_u32_u24 v7, 16512, v7
    v_add_u32 v209, v6, v7
    s_mul_i32 s31, s48, 528384
    s_lshl_b32 s32, s49, 7
    s_add_u32 s31, s31, s32
    s_add_u32 s60, s31, 2097152
L_no_consts:
L_st23:
L_sync3:
    ds_read_b32 v1, v0 offset:42824
    ds_read_b128 v[120:123], v5 offset:44032
    ds_read_b128 v[124:127], v5 offset:45056
    ds_read_b128 v[128:131], v5 offset:46080
    ds_read_b128 v[132:135], v5 offset:47104
    s_waitcnt lgkmcnt(4)
    v_readfirstlane_b32 s31, v1
    s_nop 0
    s_cmp_ge_u32 s31, 4
    s_cbranch_scc0 L_sync3
    s_cmp_eq_u32 s48, 7
    s_cbranch_scc1 L_p1_done
    s_add_u32 s61, s60, 33024
    s_add_u32 s62, s61, 33024
    s_add_u32 s63, s62, 33024
    s_waitcnt lgkmcnt(3)
    v_mfma_f32_16x16x32_f16 v[136:139], v[120:123], v[16:19], 0
    v_mfma_f32_16x16x32_f16 v[140:143], v[120:123], v[20:23], 0
    s_waitcnt lgkmcnt(2)
    v_mfma_f32_16x16x32_f16 v[144:147], v[124:127], v[24:27], 0
    v_mfma_f32_16x16x32_f16 v[148:151], v[124:127], v[28:31], 0
    s_nop 3
    v_pk_mul_f32 v[152:153], v[48:49], v[136:137]
    v_pk_mul_f32 v[154:155], v[50:51], v[138:139]
    v_pk_mul_f32 v[156:157], v[52:53], v[136:137]
    v_pk_mul_f32 v[158:159], v[54:55], v[138:139]
    v_pk_fma_f32 v[152:153], v[52:53], v[140:141], v[152:153]
    v_pk_fma_f32 v[156:157], v[48:49], v[140:141], v[156:157] neg_lo:[0,0,1] neg_hi:[0,0,1]
    v_pk_fma_f32 v[154:155], v[54:55], v[142:143], v[154:155]
    v_pk_fma_f32 v[158:159], v[50:51], v[142:143], v[158:159] neg_lo:[0,0,1] neg_hi:[0,0,1]
    v_cvt_pk_f16_f32 v120, v152, v156
    v_cvt_pk_f16_f32 v121, v153, v157
    v_cvt_pk_f16_f32 v122, v154, v158
    v_cvt_pk_f16_f32 v123, v155, v159
    s_waitcnt lgkmcnt(1)
    v_mfma_f32_16x16x32_f16 v[136:139], v[128:131], v[32:35], 0
    v_mfma_f32_16x16x32_f16 v[140:143], v[128:131], v[36:39], 0
    v_mfma_f32_16x16x32_f16 v[216:219], v[80:83], v[120:123], 0
    v_mfma_f32_16x16x32_f16 v[220:223], v[84:87], v[120:123], 0
    v_pk_mul_f32 v[152:153], v[56:57], v[144:145]
    v_pk_mul_f32 v[154:155], v[58:59], v[146:147]
    v_pk_mul_f32 v[156:157], v[60:61], v[144:145]
    v_pk_mul_f32 v[158:159], v[62:63], v[146:147]
    v_pk_fma_f32 v[152:153], v[60:61], v[148:149], v[152:153]
    v_pk_fma_f32 v[156:157], v[56:57], v[148:149], v[156:157] neg_lo:[0,0,1] neg_hi:[0,0,1]
    v_pk_fma_f32 v[154:155], v[62:63], v[150:151], v[154:155]
    v_pk_fma_f32 v[158:159], v[58:59], v[150:151], v[158:159] neg_lo:[0,0,1] neg_hi:[0,0,1]
    v_cvt_pk_f16_f32 v124, v152, v156
    v_cvt_pk_f16_f32 v125, v153, v157
    v_cvt_pk_f16_f32 v126, v154, v158
    v_cvt_pk_f16_f32 v127, v155, v159
    s_waitcnt lgkmcnt(0)
    v_mfma_f32_16x16x32_f16 v[144:147], v[132:135], v[40:43], 0
    v_mfma_f32_16x16x32_f16 v[148:151], v[132:135], v[44:47], 0
    v_mfma_f32_16x16x32_f16 v[224:227], v[80:83], v[124:127], 0
    v_mfma_f32_16x16x32_f16 v[228:231], v[84:87], v[124:127], 0
    v_pk_mul_f32 v[152:153], v[64:65], v[136:137]
    v_pk_mul_f32 v[154:155], v[66:67], v[138:139]
    v_pk_mul_f32 v[156:157], v[68:69], v[136:137]
    v_pk_mul_f32 v[158:159], v[70:71], v[138:139]
    v_pk_fma_f32 v[152:153], v[68:69], v[140:141], v[152:153]
    v_pk_fma_f32 v[156:157], v[64:65], v[140:141], v[156:157] neg_lo:[0,0,1] neg_hi:[0,0,1]
    v_pk_fma_f32 v[154:155], v[70:71], v[142:143], v[154:155]
    v_pk_fma_f32 v[158:159], v[66:67], v[142:143], v[158:159] neg_lo:[0,0,1] neg_hi:[0,0,1]
    v_cvt_pk_f16_f32 v128, v152, v156
    v_cvt_pk_f16_f32 v129, v153, v157
    v_cvt_pk_f16_f32 v130, v154, v158
    v_cvt_pk_f16_f32 v131, v155, v159
    s_nop 1
    v_mfma_f32_16x16x32_f16 v[232:235], v[80:83], v[128:131], 0
    v_mfma_f32_16x16x32_f16 v[236:239], v[84:87], v[128:131], 0
    v_pk_mul_f32 v[152:153], v[72:73], v[144:145]
    v_pk_mul_f32 v[154:155], v[74:75], v[146:147]
    v_pk_mul_f32 v[156:157], v[76:77], v[144:145]
    v_pk_mul_f32 v[158:159], v[78:79], v[146:147]
    v_pk_fma_f32 v[152:153], v[76:77], v[148:149], v[152:153]
    v_pk_fma_f32 v[156:157], v[72:73], v[148:149], v[156:157] neg_lo:[0,0,1] neg_hi:[0,0,1]
    v_pk_fma_f32 v[154:155], v[78:79], v[150:151], v[154:155]
    v_pk_fma_f32 v[158:159], v[74:75], v[150:151], v[158:159] neg_lo:[0,0,1] neg_hi:[0,0,1]
    v_cvt_pk_f16_f32 v132, v152, v156
    v_cvt_pk_f16_f32 v133, v153, v157
    v_cvt_pk_f16_f32 v134, v154, v158
    v_cvt_pk_f16_f32 v135, v155, v159
    s_nop 1
    v_mfma_f32_16x16x32_f16 v[240:243], v[80:83], v[132:135], 0
    v_mfma_f32_16x16x32_f16 v[244:247], v[84:87], v[132:135], 0
    v_cvt_pk_f16_f32 v176, v216, v224
    v_cvt_pk_f16_f32 v178, v220, v228
    v_and_or_b32 v176, v176, s58, v210
    v_and_or_b32 v178, v178, s58, v210
    v_cvt_pk_f16_f32 v180, v217, v225
    v_cvt_pk_f16_f32 v182, v221, v229
    v_and_or_b32 v180, v180, s58, v210
    v_and_or_b32 v182, v182, s58, v210
    v_cvt_pk_f16_f32 v184, v218, v226
    v_cvt_pk_f16_f32 v186, v222, v230
    v_and_or_b32 v184, v184, s58, v210
    v_and_or_b32 v186, v186, s58, v210
    v_cvt_pk_f16_f32 v188, v219, v227
    v_cvt_pk_f16_f32 v190, v223, v231
    v_and_or_b32 v188, v188, s58, v210
    v_and_or_b32 v190, v190, s58, v210
    v_cvt_pk_f16_f32 v177, v232, v240
    v_cvt_pk_f16_f32 v179, v236, v244
    v_and_or_b32 v177, v177, s58, v210
    v_and_or_b32 v179, v179, s58, v210
    v_cvt_pk_f16_f32 v181, v233, v241
    v_cvt_pk_f16_f32 v183, v237, v245
    v_and_or_b32 v181, v181, s58, v210
    v_and_or_b32 v183, v183, s58, v210
    v_cvt_pk_f16_f32 v185, v234, v242
    v_cvt_pk_f16_f32 v187, v238, v246
    v_and_or_b32 v185, v185, s58, v210
    v_and_or_b32 v187, v187, s58, v210
    v_cvt_pk_f16_f32 v189, v235, v243
    v_cvt_pk_f16_f32 v191, v239, v247
    v_and_or_b32 v189, v189, s58, v210
    v_and_or_b32 v191, v191, s58, v210
    s_cmp_eq_u32 s50, 0
    s_cbranch_scc1 L_p1_done
    s_mov_b32 exec_hi, s72
    buffer_store_dwordx4 v[176:179], v209, s[12:15], s60 offen sc1
    s_mov_b32 exec_hi, s73
    buffer_store_dwordx4 v[180:183], v209, s[12:15], s61 offen sc1
    buffer_store_dwordx4 v[184:187], v209, s[12:15], s62 offen sc1
    buffer_store_dwordx4 v[188:191], v209, s[12:15], s63 offen sc1
    s_mov_b32 exec_hi, -1
    s_mov_b32 s50, 0
    s_add_u32 s60, s60, 16384
    v_add_u32 v5, 16384, v5
    s_sub_u32 s31, s48, 4
    v_cvt_f32_i32 v252, s31
    v_mul_f32 v252, 0x3d800000, v252
    v_and_b32 v251, 15, v2
    v_lshlrev_b32 v251, 2, v251
    v_cvt_f32_u32 v251, v251
    v_fma_f32 v250, v212, v251, v252
    v_sin_f32 v84, v250
    v_cos_f32 v250, v250
    s_nop 0
    v_cvt_pk_f16_f32 v80, v250, v84
    v_cvt_pk_f16_f32 v84, -v84, v250
    v_fma_f32 v250, v213, v251, v252
    v_sin_f32 v85, v250
    v_cos_f32 v250, v250
    s_nop 0
    v_cvt_pk_f16_f32 v81, v250, v85
    v_cvt_pk_f16_f32 v85, -v85, v250
    v_fma_f32 v250, v214, v251, v252
    v_sin_f32 v86, v250
    v_cos_f32 v250, v250
    s_nop 0
    v_cvt_pk_f16_f32 v82, v250, v86
    v_cvt_pk_f16_f32 v86, -v86, v250
    v_fma_f32 v250, v215, v251, v252
    v_sin_f32 v87, v250
    v_cos_f32 v250, v250
    s_nop 0
    v_cvt_pk_f16_f32 v83, v250, v87
    v_cvt_pk_f16_f32 v87, -v87, v250
    s_branch L_st23
L_p1_done:
    s_cmp_lt_u32 s2, 224
    s_cbranch_scc1 L_zst_later
    s_cmp_eq_u32 s74, 7
    s_cbranch_scc1 L_zst_later
    s_mov_b32 exec_hi, s72
    buffer_store_dwordx4 v[176:179], v209, s[12:15], s60 offen sc1
    s_mov_b32 exec_hi, s73
    buffer_store_dwordx4 v[180:183], v209, s[12:15], s61 offen sc1
    buffer_store_dwordx4 v[184:187], v209, s[12:15], s62 offen sc1
    buffer_store_dwordx4 v[188:191], v209, s[12:15], s63 offen sc1
    s_mov_b32 exec_hi, -1
    s_mov_b32 s74, 7
L_zst_later:
    s_mov_b64 exec, 1
    ds_add_u32 v0, v255 offset:42828
    s_mov_b64 exec, -1
    s_setprio 0
    v_mov_b32 v4, v112
    v_mov_b32 v5, v113
    v_mov_b32 v249, v114
    v_mov_b32 v205, v115
    v_mov_b32 v248, v116
    v_mov_b32 v208, v117
    v_mov_b32 v7, v118
    v_mov_b32 v6, v119
    s_and_b32 s31, s2, 7
    s_sub_u32 s32, 8, s31
    s_min_u32 s46, s31, s32
    s_cmp_gt_u32 s31, 4
    s_cselect_b32 s31, 16, 0
    s_lshr_b32 s47, s2, 4
    s_add_u32 s47, s47, s31
    s_bfe_u32 s53, s2, 0x10003
    s_lshl_b32 s53, s53, 7
    s_add_u32 s53, s53, s31
    s_lshl_b32 s31, s30, 5
    s_add_u32 s53, s53, s31
    s_lshl_b32 s48, s46, 1
    s_add_u32 s48, s48, 2040
    s_mov_b32 s49, 32768
    v_mov_b32 v212, v210
    v_mov_b32 v213, v210
    v_mov_b32 v214, v210
    v_mov_b32 v215, v210
L_sync4:
    ds_read_b32 v1, v0 offset:42860
    s_waitcnt lgkmcnt(0)
    v_readfirstlane_b32 s31, v1
    s_nop 0
    s_cmp_ge_u32 s31, 1
    s_cbranch_scc0 L_sync4
    buffer_load_dwordx4 v[24:27], v6, s[12:15], s49 offen
    s_cmp_eq_u32 s74, 7
    s_cbranch_scc1 L_no_zst
    s_cmp_ge_u32 s2, 224
    s_cbranch_scc1 L_zst_go
L_sync5:
    ds_read_b32 v1, v0 offset:42840
    s_waitcnt lgkmcnt(0)
    v_readfirstlane_b32 s31, v1
    s_nop 0
    s_cmp_ge_u32 s31, 1
    s_cbranch_scc0 L_sync5
L_zst_go:
    s_mov_b32 exec_hi, s72
    buffer_store_dwordx4 v[176:179], v209, s[12:15], s60 offen sc1
    s_mov_b32 exec_hi, s73
    buffer_store_dwordx4 v[180:183], v209, s[12:15], s61 offen sc1
    buffer_store_dwordx4 v[184:187], v209, s[12:15], s62 offen sc1
    buffer_store_dwordx4 v[188:191], v209, s[12:15], s63 offen sc1
    s_mov_b32 exec_hi, -1
L_no_zst:
    v_and_b32 v160, 15, v2
    v_add_u32 v160, s53, v160
    v_cvt_f32_u32 v160, v160
    v_add_f32 v160, 0.5, v160
    v_mul_f32 v160, 0x3b800000, v160
    v_and_b32 v161, 32, v2
    v_bfe_u32 v162, v2, 4, 1
    v_lshl_add_u32 v161, v162, 3, v161
    v_cvt_f32_u32 v161, v161
    v_mul_f32 v161, v161, v160
    v_fmamk_f32 v88, v160, 0x0, v161
    v_fmamk_f32 v162, v160, 0x40000000, v161
    v_sin_f32 v104, v88
    v_sin_f32 v163, v162
    v_cos_f32 v88, v88
    v_cos_f32 v162, v162
    v_cvt_pk_f16_f32 v104, v104, v163
    v_cvt_pk_f16_f32 v88, v88, v162
    v_fmamk_f32 v89, v160, 0x40800000, v161
    v_fmamk_f32 v162, v160, 0x40c00000, v161
    v_sin_f32 v105, v89
    v_sin_f32 v163, v162
    v_cos_f32 v89, v89
    v_cos_f32 v162, v162
    v_cvt_pk_f16_f32 v105, v105, v163
    v_cvt_pk_f16_f32 v89, v89, v162
    v_fmamk_f32 v90, v160, 0x41800000, v161
    v_fmamk_f32 v162, v160, 0x41900000, v161
    v_sin_f32 v106, v90
    v_sin_f32 v163, v162
    v_cos_f32 v90, v90
    v_cos_f32 v162, v162
    v_cvt_pk_f16_f32 v106, v106, v163
    v_cvt_pk_f16_f32 v90, v90, v162
    v_fmamk_f32 v91, v160, 0x41a00000, v161
    v_fmamk_f32 v162, v160, 0x41b00000, v161
    v_sin_f32 v107, v91
    v_sin_f32 v163, v162
    v_cos_f32 v91, v91
    v_cos_f32 v162, v162
    v_cvt_pk_f16_f32 v107, v107, v163
    v_cvt_pk_f16_f32 v91, v91, v162
    v_fmamk_f32 v92, v160, 0x42800000, v161
    v_fmamk_f32 v162, v160, 0x42840000, v161
    v_sin_f32 v108, v92
    v_sin_f32 v163, v162
    v_cos_f32 v92, v92
    v_cos_f32 v162, v162
    v_cvt_pk_f16_f32 v108, v108, v163
    v_cvt_pk_f16_f32 v92, v92, v162
    v_fmamk_f32 v93, v160, 0x42880000, v161
    v_fmamk_f32 v162, v160, 0x428c0000, v161
    v_sin_f32 v109, v93
    v_sin_f32 v163, v162
    v_cos_f32 v93, v93
    v_cos_f32 v162, v162
    v_cvt_pk_f16_f32 v109, v109, v163
    v_cvt_pk_f16_f32 v93, v93, v162
    v_fmamk_f32 v94, v160, 0x42a00000, v161
    v_fmamk_f32 v162, v160, 0x42a40000, v161
    v_sin_f32 v110, v94
    v_sin_f32 v163, v162
    v_cos_f32 v94, v94
    v_cos_f32 v162, v162
    v_cvt_pk_f16_f32 v110, v110, v163
    v_cvt_pk_f16_f32 v94, v94, v162
    v_fmamk_f32 v95, v160, 0x42a80000, v161
    v_fmamk_f32 v162, v160, 0x42ac0000, v161
    v_sin_f32 v111, v95
    v_sin_f32 v163, v162
    v_cos_f32 v95, v95
    v_cos_f32 v162, v162
    v_cvt_pk_f16_f32 v111, v111, v163
    v_cvt_pk_f16_f32 v95, v95, v162
    v_fmamk_f32 v96, v160, 0x3f800000, v161
    v_fmamk_f32 v162, v160, 0x40400000, v161
    v_sin_f32 v112, v96
    v_sin_f32 v163, v162
    v_cos_f32 v96, v96
    v_cos_f32 v162, v162
    v_cvt_pk_f16_f32 v112, v112, v163
    v_cvt_pk_f16_f32 v96, v96, v162
    v_fmamk_f32 v97, v160, 0x40a00000, v161
    v_fmamk_f32 v162, v160, 0x40e00000, v161
    v_sin_f32 v113, v97
    v_sin_f32 v163, v162
    v_cos_f32 v97, v97
    v_cos_f32 v162, v162
    v_cvt_pk_f16_f32 v113, v113, v163
    v_cvt_pk_f16_f32 v97, v97, v162
    v_fmamk_f32 v98, v160, 0x41880000, v161
    v_fmamk_f32 v162, v160, 0x41980000, v161
    v_sin_f32 v114, v98
    v_sin_f32 v163, v162
    v_cos_f32 v98, v98
    v_cos_f32 v162, v162
    v_cvt_pk_f16_f32 v114, v114, v163
    v_cvt_pk_f16_f32 v98, v98, v162
    v_fmamk_f32 v99, v160, 0x41a80000, v161
    v_fmamk_f32 v162, v160, 0x41b80000, v161
    v_sin_f32 v115, v99
    v_sin_f32 v163, v162
    v_cos_f32 v99, v99
    v_cos_f32 v162, v162
    v_cvt_pk_f16_f32 v115, v115, v163
    v_cvt_pk_f16_f32 v99, v99, v162
    v_fmamk_f32 v100, v160, 0x42820000, v161
    v_fmamk_f32 v162, v160, 0x42860000, v161
    v_sin_f32 v116, v100
    v_sin_f32 v163, v162
    v_cos_f32 v100, v100
    v_cos_f32 v162, v162
    v_cvt_pk_f16_f32 v116, v116, v163
    v_cvt_pk_f16_f32 v100, v100, v162
    v_fmamk_f32 v101, v160, 0x428a0000, v161
    v_fmamk_f32 v162, v160, 0x428e0000, v161
    v_sin_f32 v117, v101
    v_sin_f32 v163, v162
    v_cos_f32 v101, v101
    v_cos_f32 v162, v162
    v_cvt_pk_f16_f32 v117, v117, v163
    v_cvt_pk_f16_f32 v101, v101, v162
    v_fmamk_f32 v102, v160, 0x42a20000, v161
    v_fmamk_f32 v162, v160, 0x42a60000, v161
    v_sin_f32 v118, v102
    v_sin_f32 v163, v162
    v_cos_f32 v102, v102
    v_cos_f32 v162, v162
    v_cvt_pk_f16_f32 v118, v118, v163
    v_cvt_pk_f16_f32 v102, v102, v162
    v_fmamk_f32 v103, v160, 0x42aa0000, v161
    v_fmamk_f32 v162, v160, 0x42ae0000, v161
    v_sin_f32 v119, v103
    v_sin_f32 v163, v162
    v_cos_f32 v103, v103
    v_cos_f32 v162, v162
    v_cvt_pk_f16_f32 v119, v119, v163
    v_cvt_pk_f16_f32 v103, v103, v162
    v_cmp_gt_u32 vcc, 16, v2
    v_and_b32 v162, 1, v2
    v_lshlrev_b32 v162, 15, v162
    v_or_b32 v162, 0x3c00, v162
    v_and_b32 v160, 0xffff0000, v104
    v_or_b32 v162, v162, v160
    v_cndmask_b32 v104, v104, v162, vcc
    s_mul_i32 s51, s46, 528384
    s_add_u32 s51, s51, 2097152
    s_mul_i32 s54, s47, 16512
    s_lshl_b32 s32, s30, 12
    s_add_u32 s50, s51, s54
    s_add_u32 s50, s50, s32
    s_add_u32 s55, s47, 1
    s_and_b32 s55, s55, 31
    s_mul_i32 s55, s55, 16512
    v_add_u32 v250, s32, v3
    v_add_u32 v199, s76, v3
    v_lshl_add_u32 v200, v2, 7, s32
    v_and_b32 v1, 2, v2
    v_lshl_add_u32 v200, v1, 3, v200
    v_and_b32 v1, 0x70, v3
    v_add_u32 v1, 16384, v1
    s_mov_b32 vcc_lo, 0
    s_mov_b32 vcc_hi, -1
    v_cndmask_b32 v200, v200, v1, vcc
    s_mov_b32 vcc_hi, 0xff
    v_mov_b32 v1, s55
    v_mov_b32 v201, s54
    v_cndmask_b32 v1, v1, v201, vcc
    v_mov_b32 v201, 16640
    v_cndmask_b32 v201, v201, v0, vcc
    v_add_u32 v201, v201, v200
    v_add_u32 v200, v1, v200
    v_lshrrev_b32 v251, 5, v2
    v_lshlrev_b32 v251, 11, v251
    v_bfe_u32 v1, v2, 2, 3
    v_lshl_add_u32 v251, v1, 7, v251
    v_and_b32 v1, 3, v2
    v_lshl_add_u32 v251, v1, 5, v251
    v_bfe_u32 v1, v2, 3, 1
    v_lshl_add_u32 v251, v1, 4, v251
    v_bfe_u32 v1, v2, 4, 1
    v_lshl_add_u32 v251, v1, 3, v251
    v_xor_b32 v252, 16, v251
    v_xor_b32 v253, 8, v251
    v_xor_b32 v254, 24, v251
    v_cmp_gt_u32 vcc, 4, v2
    v_mov_b32 v1, 16384
    s_nop 0
    v_cndmask_b32 v1, v0, v1, vcc
    v_add_u32 v206, v253, v1
    v_add_u32 v207, v254, v1
    s_mov_b32 vcc_lo, 0x88888888
    s_mov_b32 vcc_hi, 0x88888888
    v_mov_b32 v1, 16544
    v_cndmask_b32 v1, 32, v1, vcc
    v_add_u32 v202, v251, v1
    v_add_u32 v203, v253, v1
    v_add_u32 v204, v206, v1
    s_waitcnt vmcnt(0)
L_stat_check:
    v_cmp_ne_u64 vcc, s[28:29], v[26:27]
    s_nop 0
    s_cbranch_vccz L_stat_got
    s_cmp_eq_u32 s35, 0
    s_cbranch_scc1 L_stat_got
    s_sub_u32 s35, s35, 1
    s_sleep 2
    s_mov_b64 exec, vcc
    buffer_load_dwordx4 v[24:27], v6, s[12:15], s49 offen sc1
    s_mov_b64 exec, -1
    s_waitcnt vmcnt(0)
    s_branch L_stat_check
L_stat_got:
    v_cndmask_b32 v24, v24, v25, s[88:89]
    v_mov_b32 v32, v24
    s_nop 1
    v_permlane32_swap_b32 v24, v32
    v_mov_b32 v28, v24
    v_mov_b32 v36, v32
    s_nop 0
    v_permlane16_swap_b32 v24, v28
    v_permlane16_swap_b32 v32, v36
    v_lshlrev_b32 v26, 16, v24
    v_and_b32 v24, 0xffff0000, v24
    v_rcp_f32 v24, v24
    v_lshlrev_b32 v30, 16, v28
    v_and_b32 v28, 0xffff0000, v28
    v_rcp_f32 v28, v28
    v_lshlrev_b32 v34, 16, v32
    v_and_b32 v32, 0xffff0000, v32
    v_rcp_f32 v32, v32
    v_lshlrev_b32 v38, 16, v36
    v_and_b32 v36, 0xffff0000, v36
    v_rcp_f32 v36, v36
    v_mul_f32 v24, 0xbfb8aa3b, v24
    v_mul_f32_e64 v26, -v26, v24
    v_mul_f32 v28, 0xbfb8aa3b, v28
    v_mul_f32_e64 v30, -v30, v28
    v_mul_f32 v32, 0xbfb8aa3b, v32
    v_mul_f32_e64 v34, -v34, v32
    v_mul_f32 v36, 0xbfb8aa3b, v36
    v_mul_f32_e64 v38, -v38, v36
    ds_read_b128 v[8:11], v208 offset:0
    ds_read_b128 v[12:15], v208 offset:1024
    s_waitcnt lgkmcnt(0)
    v_lshlrev_b32 v40, 16, v8
    v_and_b32 v41, 0xffff0000, v8
    v_lshlrev_b32 v42, 16, v9
    v_and_b32 v43, 0xffff0000, v9
    v_lshlrev_b32 v44, 16, v10
    v_and_b32 v45, 0xffff0000, v10
    v_lshlrev_b32 v46, 16, v11
    v_and_b32 v47, 0xffff0000, v11
    v_lshlrev_b32 v48, 16, v12
    v_and_b32 v55, 0xffff0000, v12
    v_lshlrev_b32 v54, 16, v13
    v_and_b32 v53, 0xffff0000, v13
    v_lshlrev_b32 v52, 16, v14
    v_and_b32 v51, 0xffff0000, v14
    v_lshlrev_b32 v50, 16, v15
    v_and_b32 v49, 0xffff0000, v15
    v_pk_fma_f32 v[120:121], v[40:41], v[24:25], v[26:27] op_sel_hi:[1,0,0]
    v_pk_fma_f32 v[122:123], v[42:43], v[24:25], v[26:27] op_sel_hi:[1,0,0]
    v_pk_fma_f32 v[124:125], v[44:45], v[24:25], v[26:27] op_sel_hi:[1,0,0]
    v_pk_fma_f32 v[126:127], v[46:47], v[24:25], v[26:27] op_sel_hi:[1,0,0]
    v_pk_fma_f32 v[128:129], v[48:49], v[28:29], v[30:31] op_sel_hi:[1,0,0]
    v_pk_fma_f32 v[130:131], v[50:51], v[28:29], v[30:31] op_sel_hi:[1,0,0]
    v_pk_fma_f32 v[132:133], v[52:53], v[28:29], v[30:31] op_sel_hi:[1,0,0]
    v_pk_fma_f32 v[134:135], v[54:55], v[28:29], v[30:31] op_sel_hi:[1,0,0]
    v_exp_f32 v216, v120
    v_exp_f32 v217, v121
    v_exp_f32 v218, v122
    v_exp_f32 v219, v123
    v_exp_f32 v220, v124
    v_exp_f32 v221, v125
    v_exp_f32 v222, v126
    v_exp_f32 v223, v127
    v_exp_f32 v224, v128
    v_exp_f32 v225, v129
    v_exp_f32 v226, v130
    v_exp_f32 v227, v131
    v_exp_f32 v228, v132
    v_exp_f32 v229, v133
    v_exp_f32 v230, v134
    v_exp_f32 v231, v135
    v_pk_add_f32 v[216:217], v[216:217], 1.0 op_sel_hi:[1,0]
    v_pk_add_f32 v[218:219], v[218:219], 1.0 op_sel_hi:[1,0]
    v_pk_add_f32 v[220:221], v[220:221], 1.0 op_sel_hi:[1,0]
    v_pk_add_f32 v[222:223], v[222:223], 1.0 op_sel_hi:[1,0]
    v_pk_add_f32 v[224:225], v[224:225], 1.0 op_sel_hi:[1,0]
    v_pk_add_f32 v[226:227], v[226:227], 1.0 op_sel_hi:[1,0]
    v_pk_add_f32 v[228:229], v[228:229], 1.0 op_sel_hi:[1,0]
    v_pk_add_f32 v[230:231], v[230:231], 1.0 op_sel_hi:[1,0]
    v_rcp_f32 v216, v216
    v_rcp_f32 v217, v217
    v_rcp_f32 v218, v218
    v_rcp_f32 v219, v219
    v_rcp_f32 v220, v220
    v_rcp_f32 v221, v221
    v_rcp_f32 v222, v222
    v_rcp_f32 v223, v223
    v_rcp_f32 v224, v224
    v_rcp_f32 v225, v225
    v_rcp_f32 v226, v226
    v_rcp_f32 v227, v227
    v_rcp_f32 v228, v228
    v_rcp_f32 v229, v229
    v_rcp_f32 v230, v230
    v_rcp_f32 v231, v231
    v_pk_mul_f32 v[120:121], v[120:121], v[216:217]
    v_pk_mul_f32 v[122:123], v[122:123], v[218:219]
    v_pk_mul_f32 v[124:125], v[124:125], v[220:221]
    v_pk_mul_f32 v[126:127], v[126:127], v[222:223]
    v_pk_mul_f32 v[128:129], v[128:129], v[224:225]
    v_pk_mul_f32 v[130:131], v[130:131], v[226:227]
    v_pk_mul_f32 v[132:133], v[132:133], v[228:229]
    v_pk_mul_f32 v[134:135], v[134:135], v[230:231]
L_sync6:
    ds_read_b32 v1, v0 offset:42848
    s_waitcnt lgkmcnt(0)
    v_readfirstlane_b32 s31, v1
    s_nop 0
    s_cmp_ge_u32 s31, 4
    s_cbranch_scc0 L_sync6
    s_add_u32 m0, s76, 2048
    s_nop 0
    buffer_load_dwordx4 v249, s[8:11], 0 offen lds
    s_add_u32 m0, s76, 3072
    s_nop 0
    buffer_load_dwordx4 v205, s[8:11], 0 offen lds
    s_waitcnt vmcnt(0)
    ds_read_b128 v[16:19], v208 offset:2048
    ds_read_b128 v[20:23], v208 offset:3072
    s_waitcnt lgkmcnt(0)
    buffer_load_dwordx4 v[72:75], v3, s[12:15], s50 offen offset:0 sc1
    buffer_load_dwordx4 v[76:79], v3, s[12:15], s50 offen offset:1024 sc1
    buffer_load_dwordx4 v[80:83], v3, s[12:15], s50 offen offset:2048 sc1
    buffer_load_dwordx4 v[84:87], v3, s[12:15], s50 offen offset:3072 sc1
    s_mov_b32 exec_hi, 0x1ff
    buffer_load_dwordx4 v[212:215], v200, s[12:15], s51 offen sc1
    s_mov_b32 exec_hi, -1
    v_lshlrev_b32 v56, 16, v16
    v_and_b32 v57, 0xffff0000, v16
    v_lshlrev_b32 v58, 16, v17
    v_and_b32 v59, 0xffff0000, v17
    v_lshlrev_b32 v60, 16, v18
    v_and_b32 v61, 0xffff0000, v18
    v_lshlrev_b32 v62, 16, v19
    v_and_b32 v63, 0xffff0000, v19
    v_lshlrev_b32 v64, 16, v20
    v_and_b32 v71, 0xffff0000, v20
    v_lshlrev_b32 v70, 16, v21
    v_and_b32 v69, 0xffff0000, v21
    v_lshlrev_b32 v68, 16, v22
    v_and_b32 v67, 0xffff0000, v22
    v_lshlrev_b32 v66, 16, v23
    v_and_b32 v65, 0xffff0000, v23
    v_pk_fma_f32 v[136:137], v[56:57], v[32:33], v[34:35] op_sel_hi:[1,0,0]
    v_pk_fma_f32 v[138:139], v[58:59], v[32:33], v[34:35] op_sel_hi:[1,0,0]
    v_pk_fma_f32 v[140:141], v[60:61], v[32:33], v[34:35] op_sel_hi:[1,0,0]
    v_pk_fma_f32 v[142:143], v[62:63], v[32:33], v[34:35] op_sel_hi:[1,0,0]
    v_pk_fma_f32 v[144:145], v[64:65], v[36:37], v[38:39] op_sel_hi:[1,0,0]
    v_pk_fma_f32 v[146:147], v[66:67], v[36:37], v[38:39] op_sel_hi:[1,0,0]
    v_pk_fma_f32 v[148:149], v[68:69], v[36:37], v[38:39] op_sel_hi:[1,0,0]
    v_pk_fma_f32 v[150:151], v[70:71], v[36:37], v[38:39] op_sel_hi:[1,0,0]
    v_exp_f32 v232, v136
    v_exp_f32 v233, v137
    v_exp_f32 v234, v138
    v_exp_f32 v235, v139
    v_exp_f32 v236, v140
    v_exp_f32 v237, v141
    v_exp_f32 v238, v142
    v_exp_f32 v239, v143
    v_exp_f32 v240, v144
    v_exp_f32 v241, v145
    v_exp_f32 v242, v146
    v_exp_f32 v243, v147
    v_exp_f32 v244, v148
    v_exp_f32 v245, v149
    v_exp_f32 v246, v150
    v_exp_f32 v247, v151
    v_pk_add_f32 v[232:233], v[232:233], 1.0 op_sel_hi:[1,0]
    v_pk_add_f32 v[234:235], v[234:235], 1.0 op_sel_hi:[1,0]
    v_pk_add_f32 v[236:237], v[236:237], 1.0 op_sel_hi:[1,0]
    v_pk_add_f32 v[238:239], v[238:239], 1.0 op_sel_hi:[1,0]
    v_pk_add_f32 v[240:241], v[240:241], 1.0 op_sel_hi:[1,0]
    v_pk_add_f32 v[242:243], v[242:243], 1.0 op_sel_hi:[1,0]
    v_pk_add_f32 v[244:245], v[244:245], 1.0 op_sel_hi:[1,0]
    v_pk_add_f32 v[246:247], v[246:247], 1.0 op_sel_hi:[1,0]
    v_rcp_f32 v232, v232
    v_rcp_f32 v233, v233
    v_rcp_f32 v234, v234
    v_rcp_f32 v235, v235
    v_rcp_f32 v236, v236
    v_rcp_f32 v237, v237
    v_rcp_f32 v238, v238
    v_rcp_f32 v239, v239
    v_rcp_f32 v240, v240
    v_rcp_f32 v241, v241
    v_rcp_f32 v242, v242
    v_rcp_f32 v243, v243
    v_rcp_f32 v244, v244
    v_rcp_f32 v245, v245
    v_rcp_f32 v246, v246
    v_rcp_f32 v247, v247
    v_pk_mul_f32 v[136:137], v[136:137], v[232:233]
    v_pk_mul_f32 v[138:139], v[138:139], v[234:235]
    v_pk_mul_f32 v[140:141], v[140:141], v[236:237]
    v_pk_mul_f32 v[142:143], v[142:143], v[238:239]
    v_pk_mul_f32 v[144:145], v[144:145], v[240:241]
    v_pk_mul_f32 v[146:147], v[146:147], v[242:243]
    v_pk_mul_f32 v[148:149], v[148:149], v[244:245]
    v_pk_mul_f32 v[150:151], v[150:151], v[246:247]
L_sync7:
    ds_read_b32 v1, v0 offset:42844
    s_waitcnt lgkmcnt(0)
    v_readfirstlane_b32 s31, v1
    s_nop 0
    s_cmp_ge_u32 s31, 1
    s_cbranch_scc0 L_sync7
    ds_read_b32 v1, v0 offset:41556
    v_and_b32 v6, 48, v2
    v_lshlrev_b32 v6, 1, v6
    v_mov_b32 v209, 2147483392
    s_waitcnt lgkmcnt(0)
    v_readfirstlane_b32 s33, v1
    s_nop 0
    s_andn2_b32 s33, 0x7ff, s33
    s_sub_u32 s31, 0, s33
    s_and_b32 s31, s31, 2047
    s_sub_u32 s32, s48, s33
    s_sub_u32 s34, s48, s31
    v_cmp_eq_u32 vcc, s33, v7
    v_cmp_eq_u32 s[54:55], s33, v248
    s_nop 0
    v_cndmask_b32 v4, v4, v209, vcc
    v_cmp_eq_u32 vcc, s31, v7
    v_cmp_eq_u32 s[56:57], s31, v248
    s_nop 0
    v_cndmask_b32 v5, v5, v209, vcc
    v_cmp_eq_u32 vcc, s32, v7
    v_cmp_eq_u32 s[58:59], s32, v248
    s_nop 0
    v_cndmask_b32 v249, v249, v209, vcc
    v_cmp_eq_u32 vcc, s34, v7
    v_cmp_eq_u32 s[60:61], s34, v248
    s_nop 0
    v_cndmask_b32 v205, v205, v209, vcc
    s_or_b64 s[62:63], s[54:55], s[58:59]
    s_or_b64 s[64:65], s[56:57], s[60:61]
L_z_wait:
    s_setprio 1
    s_waitcnt vmcnt(4)
    v_xor_b32 v160, v210, v72
    v_xor_b32 v161, v210, v73
    v_xor_b32 v162, v210, v74
    v_xor_b32 v163, v210, v75
    ds_write_b128 v250, v[160:163] offset:0
    v_or3_b32 v1, v160, v161, v162
    v_or_b32 v1, v1, v163
    s_waitcnt vmcnt(3)
    v_xor_b32 v164, v210, v76
    v_xor_b32 v165, v210, v77
    v_xor_b32 v166, v210, v78
    v_xor_b32 v167, v210, v79
    ds_write_b128 v250, v[164:167] offset:1024
    v_or3_b32 v1, v1, v164, v165
    v_or3_b32 v1, v1, v166, v167
    s_waitcnt vmcnt(2)
    v_xor_b32 v168, v210, v80
    v_xor_b32 v169, v210, v81
    v_xor_b32 v170, v210, v82
    v_xor_b32 v171, v210, v83
    ds_write_b128 v250, v[168:171] offset:2048
    v_or3_b32 v1, v1, v168, v169
    v_or3_b32 v1, v1, v170, v171
    s_waitcnt vmcnt(1)
    v_xor_b32 v172, v210, v84
    v_xor_b32 v173, v210, v85
    v_xor_b32 v174, v210, v86
    v_xor_b32 v175, v210, v87
    ds_write_b128 v250, v[172:175] offset:3072
    v_or3_b32 v1, v1, v172, v173
    v_or3_b32 v1, v1, v174, v175
    s_waitcnt vmcnt(0)
    v_xor_b32 v176, v210, v212
    v_xor_b32 v177, v210, v213
    v_xor_b32 v178, v210, v214
    v_xor_b32 v179, v210, v215
    s_mov_b32 exec_hi, 0x1ff
    ds_write_b128 v201, v[176:179]
    s_mov_b32 exec_hi, -1
    v_or3_b32 v1, v1, v176, v177
    v_or3_b32 v1, v1, v178, v179
    v_and_b32 v1, 0x30003, v1
    v_cmp_ne_u32 vcc, 0, v1
    s_nop 0
    s_cbranch_vccz L_z_got
    s_cmp_eq_u32 s35, 0
    s_cbranch_scc1 L_z_got
    s_sub_u32 s35, s35, 1
    s_sleep 2
    s_mov_b64 exec, vcc
    buffer_load_dwordx4 v[72:75], v3, s[12:15], s50 offen offset:0 sc1
    buffer_load_dwordx4 v[76:79], v3, s[12:15], s50 offen offset:1024 sc1
    buffer_load_dwordx4 v[80:83], v3, s[12:15], s50 offen offset:2048 sc1
    buffer_load_dwordx4 v[84:87], v3, s[12:15], s50 offen offset:3072 sc1
    s_and_b32 exec_hi, exec_hi, 0x1ff
    s_or_b32 exec_lo, exec_lo, 1
    buffer_load_dwordx4 v[212:215], v200, s[12:15], s51 offen sc1
    s_mov_b64 exec, -1
    s_waitcnt lgkmcnt(0)
    s_branch L_z_wait
L_z_got:
    s_mov_b64 exec, 1
    ds_add_u32 v0, v255 offset:42832
    s_mov_b64 exec, -1
L_sync8:
    ds_read_b32 v1, v0 offset:42832
    ds_read_b64_tr_b16 v[152:153], v251 offset:0
    ds_read_b64_tr_b16 v[154:155], v251 offset:1024
    ds_read_b64_tr_b16 v[156:157], v252 offset:0
    ds_read_b64_tr_b16 v[158:159], v252 offset:1024
    s_waitcnt lgkmcnt(4)
    v_readfirstlane_b32 s31, v1
    s_nop 0
    s_cmp_ge_u32 s31, 4
    s_cbranch_scc0 L_sync8
    ds_read_b64_tr_b16 v[160:161], v251 offset:4096
    ds_read_b64_tr_b16 v[162:163], v251 offset:5120
    ds_read_b64_tr_b16 v[164:165], v252 offset:4096
    ds_read_b64_tr_b16 v[166:167], v252 offset:5120
    ds_read_b64_tr_b16 v[168:169], v251 offset:8192
    ds_read_b64_tr_b16 v[170:171], v251 offset:9216
    ds_read_b64_tr_b16 v[172:173], v252 offset:8192
    ds_read_b64_tr_b16 v[174:175], v252 offset:9216
    s_waitcnt lgkmcnt(8)
    v_mfma_f32_16x16x32_f16 v[216:219], v[152:155], v[88:91], 0
    v_mfma_f32_16x16x32_f16 v[220:223], v[156:159], v[88:91], 0
    ds_read_b64_tr_b16 v[176:177], v251 offset:12288
    ds_read_b64_tr_b16 v[178:179], v251 offset:13312
    ds_read_b64_tr_b16 v[180:181], v252 offset:12288
    ds_read_b64_tr_b16 v[182:183], v252 offset:13312
    s_waitcnt lgkmcnt(8)
    v_mfma_f32_16x16x32_f16 v[216:219], v[160:163], v[92:95], v[216:219]
    v_mfma_f32_16x16x32_f16 v[220:223], v[164:167], v[92:95], v[220:223]
    ds_read_b64_tr_b16 v[152:153], v206 offset:0
    ds_read_b64_tr_b16 v[154:155], v253 offset:1024
    ds_read_b64_tr_b16 v[156:157], v207 offset:0
    ds_read_b64_tr_b16 v[158:159], v254 offset:1024
    s_waitcnt lgkmcnt(8)
    v_mfma_f32_16x16x32_f16 v[216:219], v[168:171], v[96:99], v[216:219]
    v_mfma_f32_16x16x32_f16 v[220:223], v[172:175], v[96:99], v[220:223]
    ds_read_b64_tr_b16 v[160:161], v253 offset:4096
    ds_read_b64_tr_b16 v[162:163], v253 offset:5120
    ds_read_b64_tr_b16 v[164:165], v254 offset:4096
    ds_read_b64_tr_b16 v[166:167], v254 offset:5120
    s_waitcnt lgkmcnt(8)
    v_mfma_f32_16x16x32_f16 v[216:219], v[176:179], v[100:103], v[216:219]
    v_mfma_f32_16x16x32_f16 v[220:223], v[180:183], v[100:103], v[220:223]
    ds_read_b64_tr_b16 v[168:169], v253 offset:8192
    ds_read_b64_tr_b16 v[170:171], v253 offset:9216
    ds_read_b64_tr_b16 v[172:173], v254 offset:8192
    ds_read_b64_tr_b16 v[174:175], v254 offset:9216
    s_waitcnt lgkmcnt(8)
    v_mfma_f32_16x16x32_f16 v[224:227], v[152:155], v[104:107], 0
    v_mfma_f32_16x16x32_f16 v[228:231], v[156:159], v[104:107], 0
    ds_read_b64_tr_b16 v[176:177], v253 offset:12288
    ds_read_b64_tr_b16 v[178:179], v253 offset:13312
    ds_read_b64_tr_b16 v[180:181], v254 offset:12288
    ds_read_b64_tr_b16 v[182:183], v254 offset:13312
    s_waitcnt lgkmcnt(8)
    v_mfma_f32_16x16x32_f16 v[224:227], v[160:163], v[108:111], v[224:227]
    v_mfma_f32_16x16x32_f16 v[228:231], v[164:167], v[108:111], v[228:231]
    ds_read_b64_tr_b16 v[72:73], v202 offset:0
    ds_read_b64_tr_b16 v[74:75], v202 offset:1024
    ds_read_b64_tr_b16 v[76:77], v202 offset:4096
    ds_read_b64_tr_b16 v[78:79], v202 offset:5120
    s_waitcnt lgkmcnt(8)
    v_mfma_f32_16x16x32_f16 v[224:227], v[168:171], v[112:115], v[224:227]
    v_mfma_f32_16x16x32_f16 v[228:231], v[172:175], v[112:115], v[228:231]
    ds_read_b64_tr_b16 v[80:81], v202 offset:8192
    ds_read_b64_tr_b16 v[82:83], v202 offset:9216
    ds_read_b64_tr_b16 v[84:85], v202 offset:12288
    ds_read_b64_tr_b16 v[86:87], v202 offset:13312
    s_waitcnt lgkmcnt(8)
    v_mfma_f32_16x16x32_f16 v[224:227], v[176:179], v[116:119], v[224:227]
    v_mfma_f32_16x16x32_f16 v[228:231], v[180:183], v[116:119], v[228:231]
    ds_read_b64_tr_b16 v[240:241], v204 offset:0
    ds_read_b64_tr_b16 v[242:243], v203 offset:1024
    ds_read_b64_tr_b16 v[244:245], v203 offset:4096
    ds_read_b64_tr_b16 v[246:247], v203 offset:5120
    s_waitcnt lgkmcnt(8)
    ds_read_b64_tr_b16 v[184:185], v203 offset:8192
    ds_read_b64_tr_b16 v[186:187], v203 offset:9216
    ds_read_b64_tr_b16 v[188:189], v203 offset:12288
    ds_read_b64_tr_b16 v[190:191], v203 offset:13312
    v_mfma_f32_16x16x32_f16 v[232:235], v[72:75], v[88:91], 0
    v_mfma_f32_16x16x32_f16 v[232:235], v[76:79], v[92:95], v[232:235]
    s_waitcnt lgkmcnt(4)
    v_mfma_f32_16x16x32_f16 v[232:235], v[80:83], v[96:99], v[232:235]
    v_mfma_f32_16x16x32_f16 v[232:235], v[84:87], v[100:103], v[232:235]
    v_pk_add_f32 v[152:153], v[216:217], v[224:225]
    v_pk_add_f32 v[154:155], v[218:219], v[226:227]
    v_pk_add_f32 v[156:157], v[220:221], v[228:229]
    v_pk_add_f32 v[158:159], v[222:223], v[230:231]
    v_mfma_f32_16x16x32_f16 v[236:239], v[240:243], v[104:107], 0
    v_mfma_f32_16x16x32_f16 v[236:239], v[244:247], v[108:111], v[236:239]
    v_pk_fma_f32 v[40:41], v[152:153], v[120:121], v[40:41]
    v_pk_fma_f32 v[42:43], v[154:155], v[122:123], v[42:43]
    v_pk_fma_f32 v[44:45], v[156:157], v[124:125], v[44:45]
    v_pk_fma_f32 v[46:47], v[158:159], v[126:127], v[46:47]
    s_waitcnt lgkmcnt(0)
    v_mfma_f32_16x16x32_f16 v[236:239], v[184:187], v[112:115], v[236:239]
    v_mfma_f32_16x16x32_f16 v[236:239], v[188:191], v[116:119], v[236:239]
    v_cvt_pk_bf16_f32 v8, v40, v41
    v_cvt_pk_bf16_f32 v9, v42, v43
    v_cvt_pk_bf16_f32 v10, v44, v45
    v_cvt_pk_bf16_f32 v11, v46, v47
    ds_write_b128 v208, v[8:11] offset:0
    ds_read_b128 v[24:27], v199 offset:0
    v_pk_add_f32 v[160:161], v[216:217], v[224:225] neg_lo:[0,1] neg_hi:[0,1]
    v_pk_add_f32 v[162:163], v[218:219], v[226:227] neg_lo:[0,1] neg_hi:[0,1]
    v_pk_add_f32 v[164:165], v[220:221], v[228:229] neg_lo:[0,1] neg_hi:[0,1]
    v_pk_add_f32 v[166:167], v[222:223], v[230:231] neg_lo:[0,1] neg_hi:[0,1]
    s_cmp_eq_u64 s[62:63], 0
    s_cbranch_scc1 L_nodump0
    s_mov_b64 exec, s[54:55]
    ds_write_b128 v6, v[152:155] offset:42496
    ds_write_b128 v6, v[156:159] offset:42512
    s_mov_b64 exec, s[58:59]
    ds_write_b128 v6, v[160:163] offset:42496
    ds_write_b128 v6, v[164:167] offset:42512
    s_mov_b64 exec, 1
    ds_add_u32 v0, v255 offset:42836
    s_mov_b64 exec, -1
    s_waitcnt lgkmcnt(0)
L_nodump0:
    v_pk_fma_f32 v[56:57], v[160:161], v[136:137], v[56:57]
    v_pk_fma_f32 v[58:59], v[162:163], v[138:139], v[58:59]
    v_pk_fma_f32 v[60:61], v[164:165], v[140:141], v[60:61]
    v_pk_fma_f32 v[62:63], v[166:167], v[142:143], v[62:63]
    v_cvt_pk_bf16_f32 v16, v56, v57
    v_cvt_pk_bf16_f32 v17, v58, v59
    v_cvt_pk_bf16_f32 v18, v60, v61
    v_cvt_pk_bf16_f32 v19, v62, v63
    ds_write_b128 v208, v[16:19] offset:2048
    ds_read_b128 v[32:35], v199 offset:2048
    s_waitcnt lgkmcnt(2)
    buffer_store_dwordx4 v[24:27], v4, s[16:19], 0 offen sc1
    v_add_f32 v152, v232, v236
    v_sub_f32 v160, v232, v236
    s_cmp_eq_u64 s[64:65], 0
    s_cbranch_scc1 L_nodump1
    s_mov_b64 exec, s[56:57]
    ds_write_b128 v6, v[152:155] offset:42624
    ds_write_b128 v6, v[156:159] offset:42640
    s_mov_b64 exec, s[60:61]
    ds_write_b128 v6, v[160:163] offset:42624
    ds_write_b128 v6, v[164:167] offset:42640
    s_mov_b64 exec, 1
    ds_add_u32 v0, v255 offset:42864
    s_mov_b64 exec, -1
    s_waitcnt lgkmcnt(0)
L_nodump1:
    v_pk_fma_f32 v[48:49], v[152:153], v[128:129], v[48:49]
    v_pk_fma_f32 v[50:51], v[154:155], v[130:131], v[50:51]
    v_pk_fma_f32 v[52:53], v[156:157], v[132:133], v[52:53]
    v_pk_fma_f32 v[54:55], v[158:159], v[134:135], v[54:55]
    v_cvt_pk_bf16_f32 v12, v48, v55
    v_cvt_pk_bf16_f32 v13, v54, v53
    v_cvt_pk_bf16_f32 v14, v52, v51
    v_cvt_pk_bf16_f32 v15, v50, v49
    ds_write_b128 v208, v[12:15] offset:1024
    ds_read_b128 v[28:31], v199 offset:1024
    s_waitcnt lgkmcnt(2)
    buffer_store_dwordx4 v[32:35], v249, s[16:19], 0 offen sc1
    v_pk_fma_f32 v[64:65], v[160:161], v[144:145], v[64:65]
    v_pk_fma_f32 v[66:67], v[162:163], v[146:147], v[66:67]
    v_pk_fma_f32 v[68:69], v[164:165], v[148:149], v[68:69]
    v_pk_fma_f32 v[70:71], v[166:167], v[150:151], v[70:71]
    v_cvt_pk_bf16_f32 v20, v64, v71
    v_cvt_pk_bf16_f32 v21, v70, v69
    v_cvt_pk_bf16_f32 v22, v68, v67
    v_cvt_pk_bf16_f32 v23, v66, v65
    ds_write_b128 v208, v[20:23] offset:3072
    ds_read_b128 v[36:39], v199 offset:3072
    s_waitcnt lgkmcnt(2)
    buffer_store_dwordx4 v[28:31], v5, s[16:19], 0 offen sc1
    s_waitcnt lgkmcnt(0)
    buffer_store_dwordx4 v[36:39], v205, s[16:19], 0 offen sc1
    s_branch L_fin
L_dma_done:
    s_setprio 3
    s_lshr_b32 s31, s47, 2
    s_andn2_b32 s31, s31, s75
    s_add_u32 s50, s31, s46
    s_lshl_b32 s31, s50, 17
    s_bfe_u32 s32, s2, 0x20003
    s_lshl_b32 s32, s32, 2
    s_add_u32 s51, s32, s30
    s_lshl_b32 s32, s51, 7
    s_add_u32 s31, s31, s32
    v_lshrrev_b32 v6, 3, v2
    v_lshlrev_b32 v6, 14, v6
    v_and_b32 v7, 0x70, v3
    v_add3_u32 v6, v6, v7, s31
    s_mov_b32 s60, 4096
    s_mov_b32 s61, 8192
    s_mov_b32 s62, 12288
    v_bfe_u32 v8, v2, 2, 3
    v_lshlrev_b32 v9, 5, v8
    s_lshl_b32 s31, s30, 6
    v_xor_b32 v9, s31, v9
    v_bfe_u32 v8, v2, 2, 2
    v_lshl_add_u32 v9, v8, 8, v9
    v_lshrrev_b32 v8, 4, v2
    v_lshl_add_u32 v9, v8, 11, v9
    v_and_b32 v10, 3, v2
    v_lshl_add_u32 v9, v10, 3, v9
    v_add_u32 v9, 76800, v9
    v_xor_b32 v10, 32, v9
    v_lshlrev_b32 v8, 4, v8
    s_lshr_b32 s31, s30, 1
    s_and_b32 s32, s31, s75
    s_lshl_b32 s32, s32, 8
    v_add_u32 v8, s32, v8
    s_cmp_eq_u32 s75, 0
    s_cselect_b32 s32, 12, 9
    s_lshl_b32 s31, s31, s32
    s_lshl_b32 s32, s46, 3
    s_add_u32 s32, s32, s47
    s_lshl_b32 s32, s32, 9
    s_add_u32 s31, s31, s32
    s_and_b32 s32, s30, 1
    s_lshl_b32 s32, s32, 8
    s_add_u32 s31, s31, s32
    s_add_u32 s31, s31, 262144
    v_lshl_add_u32 v13, v2, 3, s31
    s_waitcnt lgkmcnt(0)
    s_add_u32 s28, s28, 0x7f4a7c15
    s_addc_u32 s29, s29, 0x9e3779b9
    s_and_b32 s31, s28, 0xff
    v_mov_b32 v14, s31
    s_mov_b32 s49, 0xffffff00
    s_cmp_lg_u32 s30, 2
    s_cbranch_scc1 L_no_tlb
    s_mov_b32 s52, s44
    s_mov_b32 s53, s45
    s_mov_b32 s54, 0x400000
    s_mov_b32 s55, 0x00020000
    v_lshlrev_b32 v250, 20, v2
    s_mov_b64 exec, 0xff
    buffer_load_dword v251, v250, s[12:15], 0 offen
    buffer_load_dword v252, v250, s[52:55], 0 offen
    buffer_load_dword v253, v250, s[24:27], 0 offen
    s_mov_b64 exec, -1
L_no_tlb:
    s_cmp_lg_u32 s66, 0
    s_cbranch_scc1 L_tagged
    s_mov_b64 exec, 1
    ds_add_u32 v0, v255 offset:42872
    s_mov_b64 exec, -1
L_tagged:
    s_cmp_eq_u32 s30, 3
    s_cbranch_scc1 L_h1
    s_cmp_eq_u32 s66, 0
    s_cbranch_scc1 L_key
    s_cmp_lg_u32 s30, 0
    s_cbranch_scc1 L_follower
    s_waitcnt vmcnt(16)
    s_mov_b64 exec, 1
    ds_add_u32 v0, v255 offset:42868
    s_mov_b64 exec, -1
    ds_read_b64_tr_b16 v[36:37], v9 offset:0
    ds_read_b64_tr_b16 v[38:39], v9 offset:1024
    ds_read_b64_tr_b16 v[40:41], v10 offset:0
    ds_read_b64_tr_b16 v[42:43], v10 offset:1024
    ds_read_b64_tr_b16 v[44:45], v9 offset:32768
    ds_read_b64_tr_b16 v[46:47], v9 offset:33792
    ds_read_b64_tr_b16 v[48:49], v10 offset:32768
    ds_read_b64_tr_b16 v[50:51], v10 offset:33792
    ds_read_b64_tr_b16 v[52:53], v9 offset:8192
    ds_read_b64_tr_b16 v[54:55], v9 offset:9216
    ds_read_b64_tr_b16 v[56:57], v10 offset:8192
    ds_read_b64_tr_b16 v[58:59], v10 offset:9216
    ds_read_b64_tr_b16 v[60:61], v9 offset:40960
    ds_read_b64_tr_b16 v[62:63], v9 offset:41984
    s_waitcnt lgkmcnt(12)
    ds_read_b64_tr_b16 v[64:65], v10 offset:40960
    ds_read_b64_tr_b16 v[66:67], v10 offset:41984
    s_waitcnt lgkmcnt(12)
    ds_read_b64_tr_b16 v[68:69], v9 offset:16384
    ds_read_b64_tr_b16 v[70:71], v9 offset:17408
    s_waitcnt lgkmcnt(12)
    ds_read_b64_tr_b16 v[72:73], v10 offset:16384
    ds_read_b64_tr_b16 v[74:75], v10 offset:17408
    s_waitcnt lgkmcnt(12)
    ds_read_b64_tr_b16 v[76:77], v9 offset:49152
    ds_read_b64_tr_b16 v[78:79], v9 offset:50176
    s_waitcnt lgkmcnt(12)
    ds_read_b64_tr_b16 v[80:81], v10 offset:49152
    ds_read_b64_tr_b16 v[82:83], v10 offset:50176
    s_waitcnt vmcnt(8)
    s_mov_b64 exec, 1
    ds_add_u32 v0, v255 offset:42868
    s_mov_b64 exec, -1
    s_branch L_key
L_follower:
    s_and_b32 s32, s30, 1
    s_lshl_b32 s32, s32, 8
    v_subrev_u32 v250, s32, v13
    buffer_load_dword v251, v250, s[12:15], 0 offen
    s_lshl_b32 s31, s50, 12
    s_sub_u32 s31, s31, s32
    s_lshl_b32 s32, s51, 8
    s_add_u32 s31, s31, s32
    s_add_u32 s31, s31, 524288
    v_lshl_add_u32 v250, v2, 3, s31
    buffer_load_dword v252, v250, s[12:15], 0 offen
L_sync9:
    ds_read_b32 v1, v0 offset:42868
    s_waitcnt lgkmcnt(0)
    v_readfirstlane_b32 s31, v1
    s_nop 0
    s_cmp_ge_u32 s31, 1
    s_cbranch_scc0 L_sync9
    ds_read_b64_tr_b16 v[36:37], v9 offset:0
    ds_read_b64_tr_b16 v[38:39], v9 offset:1024
    ds_read_b64_tr_b16 v[40:41], v10 offset:0
    ds_read_b64_tr_b16 v[42:43], v10 offset:1024
    ds_read_b64_tr_b16 v[44:45], v9 offset:32768
    ds_read_b64_tr_b16 v[46:47], v9 offset:33792
    ds_read_b64_tr_b16 v[48:49], v10 offset:32768
    ds_read_b64_tr_b16 v[50:51], v10 offset:33792
    ds_read_b64_tr_b16 v[52:53], v9 offset:8192
    ds_read_b64_tr_b16 v[54:55], v9 offset:9216
    ds_read_b64_tr_b16 v[56:57], v10 offset:8192
    ds_read_b64_tr_b16 v[58:59], v10 offset:9216
    ds_read_b64_tr_b16 v[60:61], v9 offset:40960
    ds_read_b64_tr_b16 v[62:63], v9 offset:41984
    s_waitcnt lgkmcnt(12)
    ds_read_b64_tr_b16 v[64:65], v10 offset:40960
    ds_read_b64_tr_b16 v[66:67], v10 offset:41984
    s_waitcnt lgkmcnt(12)
    ds_read_b64_tr_b16 v[68:69], v9 offset:16384
    ds_read_b64_tr_b16 v[70:71], v9 offset:17408
    s_waitcnt lgkmcnt(12)
    ds_read_b64_tr_b16 v[72:73], v10 offset:16384
    ds_read_b64_tr_b16 v[74:75], v10 offset:17408
    s_waitcnt lgkmcnt(12)
    ds_read_b64_tr_b16 v[76:77], v9 offset:49152
    ds_read_b64_tr_b16 v[78:79], v9 offset:50176
    s_waitcnt lgkmcnt(12)
    ds_read_b64_tr_b16 v[80:81], v10 offset:49152
    ds_read_b64_tr_b16 v[82:83], v10 offset:50176
    s_add_u32 s67, s30, 0
L_sync10:
    ds_read_b32 v1, v0 offset:42868
    s_waitcnt lgkmcnt(0)
    v_readfirstlane_b32 s31, v1
    s_nop 0
    s_cmp_ge_u32 s31, s67
    s_cbranch_scc0 L_sync10
L_d_first:
L_sync11:
    ds_read_b32 v1, v0 offset:42840
    s_waitcnt lgkmcnt(0)
    v_readfirstlane_b32 s31, v1
    s_nop 0
    s_cmp_ge_u32 s31, 1
    s_cbranch_scc0 L_sync11
    buffer_load_dwordx4 v[100:103], v6, s[24:27], 0 offen offset:0 nt
    buffer_load_dwordx4 v[104:107], v6, s[24:27], 0 offen offset:2048 nt
    buffer_load_dwordx4 v[108:111], v6, s[24:27], s60 offen offset:0 nt
    buffer_load_dwordx4 v[112:115], v6, s[24:27], s60 offen offset:2048 nt
    buffer_load_dwordx4 v[116:119], v6, s[24:27], s61 offen offset:0 nt
    buffer_load_dwordx4 v[120:123], v6, s[24:27], s61 offen offset:2048 nt
    buffer_load_dwordx4 v[124:127], v6, s[24:27], s62 offen offset:0 nt
    buffer_load_dwordx4 v[128:131], v6, s[24:27], s62 offen offset:2048 nt
L_key:
    s_waitcnt lgkmcnt(0)
L_sync12:
    ds_read_b32 v1, v0 offset:42844
    ds_read_b64 v[18:19], v0 offset:41552
    ds_read_b128 v[20:23], v8 offset:41600
    ds_read_b128 v[24:27], v8 offset:41664
    ds_read_b128 v[28:31], v8 offset:41728
    ds_read_b128 v[32:35], v8 offset:41792
    s_waitcnt lgkmcnt(5)
    v_readfirstlane_b32 s31, v1
    s_nop 0
    s_cmp_ge_u32 s31, 1
    s_cbranch_scc0 L_sync12
    s_cmp_eq_u32 s66, 0
    s_cbranch_scc1 L_idle
    s_branch L_xs_ok
L_h1:
    s_mov_b32 s63, 4096
    s_lshl_b32 s31, s47, 8
    v_lshlrev_b32 v15, 3, v2
    v_add_u32 v16, s31, v15
    s_cmp_lg_u32 s66, 0
    s_cbranch_scc1 L_gate
L_sync13:
    ds_read_b32 v1, v0 offset:42828
    s_waitcnt lgkmcnt(0)
    v_readfirstlane_b32 s31, v1
    s_nop 0
    s_cmp_ge_u32 s31, 4
    s_cbranch_scc0 L_sync13
    s_branch L_gate_open
L_gate:
L_sync14:
    ds_read_b32 v1, v0 offset:42824
    s_waitcnt lgkmcnt(0)
    v_readfirstlane_b32 s31, v1
    s_nop 0
    s_cmp_ge_u32 s31, 4
    s_cbranch_scc0 L_sync14
L_gate_open:
    buffer_load_dwordx4 v[20:23], v3, s[12:15], s63 offen offset:0 sc1
    buffer_load_dwordx4 v[24:27], v3, s[12:15], s63 offen offset:1024 sc1
    buffer_load_dwordx4 v[28:31], v3, s[12:15], s63 offen offset:2048 sc1
    buffer_load_dwordx4 v[32:35], v3, s[12:15], s63 offen offset:3072 sc1
    s_mov_b64 exec, 1
    ds_add_u32 v0, v255 offset:42860
    s_mov_b64 exec, -1
    s_waitcnt vmcnt(0)
L_mi_check:
    v_cmp_ne_u64 s[52:53], s[28:29], v[22:23]
    v_cmp_ne_u64 s[54:55], s[28:29], v[26:27]
    v_cmp_ne_u64 s[56:57], s[28:29], v[30:31]
    v_cmp_ne_u64 s[58:59], s[28:29], v[34:35]
    v_max_u32 v18, v21, v25
    v_max3_u32 v18, v18, v29, v33
    s_or_b64 s[64:65], s[52:53], s[54:55]
    s_or_b64 vcc, s[56:57], s[58:59]
    s_or_b64 s[64:65], s[64:65], vcc
    s_cbranch_scc0 L_mi_got
    s_cmp_eq_u32 s35, 0
    s_cbranch_scc1 L_mi_got
    s_sub_u32 s35, s35, 1
    s_sleep 2
    s_mov_b64 exec, s[52:53]
    s_cbranch_execz L_mi_skip0
    buffer_load_dwordx4 v[20:23], v3, s[12:15], s63 offen offset:0 sc1
L_mi_skip0:
    s_mov_b64 exec, s[54:55]
    s_cbranch_execz L_mi_skip1
    buffer_load_dwordx4 v[24:27], v3, s[12:15], s63 offen offset:1024 sc1
L_mi_skip1:
    s_mov_b64 exec, s[56:57]
    s_cbranch_execz L_mi_skip2
    buffer_load_dwordx4 v[28:31], v3, s[12:15], s63 offen offset:2048 sc1
L_mi_skip2:
    s_mov_b64 exec, s[58:59]
    s_cbranch_execz L_mi_skip3
    buffer_load_dwordx4 v[32:35], v3, s[12:15], s63 offen offset:3072 sc1
L_mi_skip3:
    s_mov_b64 exec, -1
    s_waitcnt vmcnt(0)
    s_branch L_mi_check
L_mi_got:
    v_max_u32_dpp v19, v18, v18 row_ror:1 row_mask:0xf bank_mask:0xf
    s_nop 1
    v_max_u32_dpp v19, v19, v19 row_ror:2 row_mask:0xf bank_mask:0xf
    s_nop 1
    v_max_u32_dpp v19, v19, v19 row_ror:4 row_mask:0xf bank_mask:0xf
    s_nop 1
    v_max_u32_dpp v19, v19, v19 row_ror:8 row_mask:0xf bank_mask:0xf
    s_nop 0
    v_readlane_b32 s33, v19, 0
    v_readlane_b32 s31, v19, 16
    v_readlane_b32 s32, v19, 32
    v_readlane_b32 s34, v19, 48
    s_max_u32 s33, s33, s31
    s_max_u32 s32, s32, s34
    s_max_u32 s33, s33, s32
    s_andn2_b32 s31, 0x7ff, s33
    s_lshl_b32 s48, s31, 11
    buffer_load_dwordx2 v[150:151], v16, s[8:11], s48 offen
    s_mov_b64 exec, 1
    ds_add_u32 v0, v255 offset:42840
    s_mov_b64 exec, -1
    v_cmp_eq_u32 s[52:53], s33, v25
    v_cmp_eq_u32 s[54:55], s33, v29
    v_cmp_eq_u32 s[56:57], s33, v33
    v_cmp_eq_u32 vcc, s33, v18
    v_cndmask_b32 v19, v20, v24, s[52:53]
    v_cndmask_b32 v19, v19, v28, s[54:55]
    v_cndmask_b32 v19, v19, v32, s[56:57]
    s_ff1_i32_b64 s32, vcc
    v_readlane_b32 s34, v19, s32
    v_mov_b32 v19, s33
    s_nop 0
    v_mov_b32 v18, s34
    ds_write_b64 v0, v[18:19] offset:41552
    s_lshl_b32 s52, s34, 16
    s_and_b32 s32, s34, 0xffff0000
    v_rcp_f32 v148, s32
    s_waitcnt vmcnt(0)
    v_lshlrev_b32 v20, 16, v150
    v_and_b32 v21, 0xffff0000, v150
    v_lshlrev_b32 v22, 16, v151
    v_and_b32 v23, 0xffff0000, v151
    v_pk_add_f32 v[20:21], v[20:21], s[52:53] op_sel_hi:[1,0] neg_lo:[0,1] neg_hi:[0,1]
    v_pk_add_f32 v[22:23], v[22:23], s[52:53] op_sel_hi:[1,0] neg_lo:[0,1] neg_hi:[0,1]
    v_cvt_pk_bf16_f32 v150, v20, v21
    v_cvt_pk_bf16_f32 v151, v22, v23
    v_lshlrev_b32 v20, 16, v150
    v_and_b32 v21, 0xffff0000, v150
    v_lshlrev_b32 v22, 16, v151
    v_and_b32 v23, 0xffff0000, v151
    v_pk_mul_f32 v[20:21], v[20:21], v[148:149] op_sel_hi:[1,0]
    v_pk_mul_f32 v[22:23], v[22:23], v[148:149] op_sel_hi:[1,0]
    v_cvt_pk_bf16_f32 v150, v20, v21
    v_cvt_pk_bf16_f32 v151, v22, v23
    ds_write_b64 v15, v[150:151] offset:41600
    s_mov_b64 exec, 1
    ds_add_u32 v0, v255 offset:42844
    s_mov_b64 exec, -1
    s_cmp_eq_u32 s66, 0
    s_cbranch_scc1 L_idle
L_sync15:
    ds_read_b32 v1, v0 offset:42868
    s_waitcnt lgkmcnt(0)
    v_readfirstlane_b32 s31, v1
    s_nop 0
    s_cmp_ge_u32 s31, 1
    s_cbranch_scc0 L_sync15
    ds_read_b64_tr_b16 v[36:37], v9 offset:0
    ds_read_b64_tr_b16 v[38:39], v9 offset:1024
    ds_read_b64_tr_b16 v[40:41], v10 offset:0
    ds_read_b64_tr_b16 v[42:43], v10 offset:1024
    ds_read_b64_tr_b16 v[44:45], v9 offset:32768
    ds_read_b64_tr_b16 v[46:47], v9 offset:33792
    ds_read_b64_tr_b16 v[48:49], v10 offset:32768
    ds_read_b64_tr_b16 v[50:51], v10 offset:33792
    ds_read_b64_tr_b16 v[52:53], v9 offset:8192
    ds_read_b64_tr_b16 v[54:55], v9 offset:9216
    ds_read_b64_tr_b16 v[56:57], v10 offset:8192
    ds_read_b64_tr_b16 v[58:59], v10 offset:9216
    ds_read_b64_tr_b16 v[60:61], v9 offset:40960
    ds_read_b64_tr_b16 v[62:63], v9 offset:41984
    s_waitcnt lgkmcnt(12)
    ds_read_b64_tr_b16 v[64:65], v10 offset:40960
    ds_read_b64_tr_b16 v[66:67], v10 offset:41984
    s_waitcnt lgkmcnt(12)
    ds_read_b64_tr_b16 v[68:69], v9 offset:16384
    ds_read_b64_tr_b16 v[70:71], v9 offset:17408
    s_waitcnt lgkmcnt(12)
    ds_read_b64_tr_b16 v[72:73], v10 offset:16384
    ds_read_b64_tr_b16 v[74:75], v10 offset:17408
    s_waitcnt lgkmcnt(12)
    ds_read_b64_tr_b16 v[76:77], v9 offset:49152
    ds_read_b64_tr_b16 v[78:79], v9 offset:50176
    s_waitcnt lgkmcnt(12)
    ds_read_b64_tr_b16 v[80:81], v10 offset:49152
    ds_read_b64_tr_b16 v[82:83], v10 offset:50176
    s_waitcnt lgkmcnt(8)
    ds_read_b128 v[20:23], v8 offset:41600
    ds_read_b128 v[24:27], v8 offset:41664
    ds_read_b128 v[28:31], v8 offset:41728
    ds_read_b128 v[32:35], v8 offset:41792
L_xs_ok:
    s_waitcnt lgkmcnt(3)
    v_mfma_f32_16x16x32_bf16 v[132:135], v[20:23], v[36:39], 0
    v_mfma_f32_16x16x32_bf16 v[136:139], v[20:23], v[40:43], 0
    v_mfma_f32_16x16x32_bf16 v[140:143], v[20:23], v[44:47], 0
    v_mfma_f32_16x16x32_bf16 v[144:147], v[20:23], v[48:51], 0
    s_waitcnt lgkmcnt(2)
    v_mfma_f32_16x16x32_bf16 v[132:135], v[24:27], v[52:55], v[132:135]
    v_mfma_f32_16x16x32_bf16 v[136:139], v[24:27], v[56:59], v[136:139]
    v_mfma_f32_16x16x32_bf16 v[140:143], v[24:27], v[60:63], v[140:143]
    v_mfma_f32_16x16x32_bf16 v[144:147], v[24:27], v[64:67], v[144:147]
    s_waitcnt lgkmcnt(1)
    v_mfma_f32_16x16x32_bf16 v[132:135], v[28:31], v[68:71], v[132:135]
    v_mfma_f32_16x16x32_bf16 v[136:139], v[28:31], v[72:75], v[136:139]
    v_mfma_f32_16x16x32_bf16 v[140:143], v[28:31], v[76:79], v[140:143]
    v_mfma_f32_16x16x32_bf16 v[144:147], v[28:31], v[80:83], v[144:147]
    s_cmp_lg_u32 s30, 0
    s_cbranch_scc1 L_k3_wait
    s_waitcnt vmcnt(0)
    s_mov_b64 exec, 1
    ds_add_u32 v0, v255 offset:42868
    s_mov_b64 exec, -1
L_k3_wait:
    s_branch L_sync16a
L_sync16:
    s_waitcnt lgkmcnt(0)
L_sync16a:
    ds_read_b32 v1, v0 offset:42868
    ds_read_b64_tr_b16 v[84:85], v9 offset:24576
    ds_read_b64_tr_b16 v[86:87], v9 offset:25600
    ds_read_b64_tr_b16 v[88:89], v10 offset:24576
    ds_read_b64_tr_b16 v[90:91], v10 offset:25600
    ds_read_b64_tr_b16 v[92:93], v9 offset:57344
    ds_read_b64_tr_b16 v[94:95], v9 offset:58368
    ds_read_b64_tr_b16 v[96:97], v10 offset:57344
    ds_read_b64_tr_b16 v[98:99], v10 offset:58368
    s_waitcnt lgkmcnt(8)
    v_readfirstlane_b32 s31, v1
    s_nop 0
    s_cmp_ge_u32 s31, 3
    s_cbranch_scc0 L_sync16
    v_readfirstlane_b32 s33, v19
    v_readfirstlane_b32 s34, v18
    s_waitcnt lgkmcnt(6)
    v_mfma_f32_16x16x32_bf16 v[132:135], v[32:35], v[84:87], v[132:135]
    s_waitcnt lgkmcnt(4)
    v_mfma_f32_16x16x32_bf16 v[136:139], v[32:35], v[88:91], v[136:139]
    s_waitcnt lgkmcnt(2)
    v_mfma_f32_16x16x32_bf16 v[140:143], v[32:35], v[92:95], v[140:143]
    s_waitcnt lgkmcnt(0)
    v_mfma_f32_16x16x32_bf16 v[144:147], v[32:35], v[96:99], v[144:147]
    s_mov_b32 vcc_lo, 0xffff0000
    s_mov_b32 vcc_hi, 0
    s_lshl_b32 s31, s50, 12
    s_lshl_b32 s32, s30, 7
    s_add_u32 s31, s31, s32
    s_add_u32 s31, s31, 262144
    v_lshrrev_b32 v15, 3, v2
    v_lshlrev_b32 v15, 9, v15
    v_add3_u32 v15, v15, v7, s31
    v_cndmask_b32 v26, v132, v136, vcc
    v_cndmask_b32 v27, v140, v144, vcc
    v_and_or_b32 v26, v26, s49, v14
    v_and_or_b32 v27, v27, s49, v14
    s_mov_b32 exec_hi, 0
    buffer_store_dwordx2 v[26:27], v13, s[12:15], 0 offen sc1
    s_mov_b64 exec, -1
    s_sub_u32 s31, s30, 1
    s_cmp_lt_u32 s31, 2
    s_cbranch_scc1 L_d_rest
    buffer_load_dwordx4 v[100:103], v6, s[24:27], 0 offen offset:0 nt
    buffer_load_dwordx4 v[104:107], v6, s[24:27], 0 offen offset:2048 nt
    buffer_load_dwordx4 v[108:111], v6, s[24:27], s60 offen offset:0 nt
    buffer_load_dwordx4 v[112:115], v6, s[24:27], s60 offen offset:2048 nt
    buffer_load_dwordx4 v[116:119], v6, s[24:27], s61 offen offset:0 nt
    buffer_load_dwordx4 v[120:123], v6, s[24:27], s61 offen offset:2048 nt
    buffer_load_dwordx4 v[124:127], v6, s[24:27], s62 offen offset:0 nt
    buffer_load_dwordx4 v[128:131], v6, s[24:27], s62 offen offset:2048 nt
L_d_rest:
    s_mov_b64 exec, 1
    ds_add_u32 v0, v255 offset:42848
    s_mov_b64 exec, -1
    s_cmp_eq_u32 s30, 1
    s_cselect_b32 s31, s2, 0
    s_cmp_lt_u32 s31, 192
    s_cbranch_scc1 L_no_hint
    s_and_b32 s31, s2, 31
    s_lshl_b32 s31, s31, 7
    s_add_u32 s31, s31, 12288
    v_mov_b32 v250, s28
    v_mov_b32 v251, s29
    s_mov_b64 exec, 1
    buffer_store_dwordx2 v[250:251], v0, s[12:15], s31 offen sc1
    s_mov_b64 exec, -1
L_no_hint:
    s_mov_b32 s52, 0x05040100
    s_mov_b32 s53, 0x07060302
    v_mov_b32 v36, 0
    v_mov_b32 v37, 0
    v_mov_b32 v38, 0
    v_mov_b32 v39, 0
    v_mov_b32 v40, 0
    v_mov_b32 v41, 0
    v_mov_b32 v42, 0
    v_mov_b32 v43, 0
    v_and_b32 v16, 7, v2
    v_lshlrev_b32 v16, 2, v16
    v_lshrrev_b32 v17, 5, v2
    v_lshl_add_u32 v16, v17, 1, v16
    s_lshl_b32 s31, s30, 5
    v_add_u32 v16, s31, v16
    v_lshrrev_b32 v17, 3, v2
    v_lshlrev_b32 v17, 4, v17
    s_lshl_b32 s31, s50, 12
    s_lshl_b32 s32, s51, 8
    s_add_u32 s31, s31, s32
    s_add_u32 s31, s31, 524288
    v_lshlrev_b32 v18, 1, v7
    v_lshrrev_b32 v19, 4, v2
    v_lshl_add_u32 v18, v19, 3, v18
    v_add_u32 v18, s31, v18
    s_waitcnt vmcnt(6)
    v_perm_b32 v98, v104, v100, s52
    v_perm_b32 v104, v104, v100, s53
    v_perm_b32 v100, v105, v101, s52
    v_perm_b32 v105, v105, v101, s53
    v_perm_b32 v101, v106, v102, s52
    v_perm_b32 v106, v106, v102, s53
    v_perm_b32 v102, v107, v103, s52
    v_perm_b32 v107, v107, v103, s53
    s_waitcnt vmcnt(4)
    v_perm_b32 v103, v112, v108, s52
    v_perm_b32 v112, v112, v108, s53
    v_perm_b32 v108, v113, v109, s52
    v_perm_b32 v113, v113, v109, s53
    v_perm_b32 v109, v114, v110, s52
    v_perm_b32 v114, v114, v110, s53
    v_perm_b32 v110, v115, v111, s52
    v_perm_b32 v115, v115, v111, s53
    s_waitcnt vmcnt(2)
    v_perm_b32 v111, v120, v116, s52
    v_perm_b32 v120, v120, v116, s53
    v_perm_b32 v116, v121, v117, s52
    v_perm_b32 v121, v121, v117, s53
    v_perm_b32 v117, v122, v118, s52
    v_perm_b32 v122, v122, v118, s53
    v_perm_b32 v118, v123, v119, s52
    v_perm_b32 v123, v123, v119, s53
    s_waitcnt vmcnt(0)
    v_perm_b32 v119, v128, v124, s52
    v_perm_b32 v128, v128, v124, s53
    v_perm_b32 v124, v129, v125, s52
    v_perm_b32 v129, v129, v125, s53
    v_perm_b32 v125, v130, v126, s52
    v_perm_b32 v130, v130, v126, s53
    v_perm_b32 v126, v131, v127, s52
    v_perm_b32 v131, v131, v127, s53
    s_mov_b32 s54, 0
L_hp_poll:
    buffer_load_dwordx4 v[20:23], v15, s[12:15], 0 offen sc1
L_hp_wait:
    s_waitcnt vmcnt(0)
    v_xor_b32 v20, v14, v20
    v_xor_b32 v21, v14, v21
    v_xor_b32 v22, v14, v22
    v_xor_b32 v23, v14, v23
    v_or3_b32 v24, v20, v21, v22
    v_or_b32 v24, v24, v23
    v_and_b32 v24, 0xff, v24
    v_cmp_ne_u32 vcc, 0, v24
    v_permlane16_swap_b32 v20, v21
    v_permlane16_swap_b32 v22, v23
    s_cbranch_vccz L_hp_got
    s_cmp_eq_u32 s35, 0
    s_cbranch_scc1 L_hp_got
    s_sub_u32 s35, s35, 1
    s_branch L_hp_poll
L_hp_got:
    v_add_f32 v20, v20, v21
    v_add_f32 v22, v22, v23
    s_nop 1
    v_permlane32_swap_b32 v20, v22
    v_add_f32 v20, v20, v22
    s_nop 1
    v_add_f32_dpp v21, v20, v20 row_ror:8 row_mask:0xf bank_mask:0xf
    v_add_f32_dpp v20, v20, v20 row_ror:8 row_mask:0xf bank_mask:0xf
    s_nop 1
    v_permlane16_swap_b32 v20, v21
    v_cvt_pk_bf16_f32 v20, v20, v21
    v_and_b32 v21, 0xffff0000, v20
    v_lshlrev_b32 v20, 16, v20
    v_mul_f32 v22, 0xbfb8aa3b, v20
    v_exp_f32 v22, v22
    s_nop 0
    v_add_f32 v22, 1.0, v22
    v_rcp_f32 v22, v22
    s_nop 0
    v_mul_f32 v20, v20, v22
    v_cvt_pk_bf16_f32 v20, v20, v20
    v_lshlrev_b32 v20, 16, v20
    v_mul_f32 v20, v20, v21
    v_cvt_pk_bf16_f32 v20, v20, v20
    ds_write_b16 v16, v20 offset:42368
    s_mov_b64 exec, 1
    ds_add_u32 v0, v255 offset:42852
    s_mov_b64 exec, -1
L_sync17:
    ds_read_b32 v1, v0 offset:42852
    ds_read_b128 v[28:31], v17 offset:42368
    s_waitcnt lgkmcnt(1)
    v_readfirstlane_b32 s31, v1
    s_nop 0
    s_cmp_ge_u32 s31, 4
    s_cbranch_scc0 L_sync17
    s_waitcnt lgkmcnt(0)
    v_dot2c_f32_bf16 v36, v28, v98
    v_dot2c_f32_bf16 v37, v28, v104
    v_dot2c_f32_bf16 v38, v28, v100
    v_dot2c_f32_bf16 v39, v28, v105
    v_dot2c_f32_bf16 v40, v28, v101
    v_dot2c_f32_bf16 v41, v28, v106
    v_dot2c_f32_bf16 v42, v28, v102
    v_dot2c_f32_bf16 v43, v28, v107
    v_dot2c_f32_bf16 v36, v29, v103
    v_dot2c_f32_bf16 v37, v29, v112
    v_dot2c_f32_bf16 v38, v29, v108
    v_dot2c_f32_bf16 v39, v29, v113
    v_dot2c_f32_bf16 v40, v29, v109
    v_dot2c_f32_bf16 v41, v29, v114
    v_dot2c_f32_bf16 v42, v29, v110
    v_dot2c_f32_bf16 v43, v29, v115
    v_dot2c_f32_bf16 v36, v30, v111
    v_dot2c_f32_bf16 v37, v30, v120
    v_dot2c_f32_bf16 v38, v30, v116
    v_dot2c_f32_bf16 v39, v30, v121
    v_dot2c_f32_bf16 v40, v30, v117
    v_dot2c_f32_bf16 v41, v30, v122
    v_dot2c_f32_bf16 v42, v30, v118
    v_dot2c_f32_bf16 v43, v30, v123
    v_dot2c_f32_bf16 v36, v31, v119
    v_dot2c_f32_bf16 v37, v31, v128
    v_dot2c_f32_bf16 v38, v31, v124
    v_dot2c_f32_bf16 v39, v31, v129
    v_dot2c_f32_bf16 v40, v31, v125
    v_dot2c_f32_bf16 v41, v31, v130
    v_dot2c_f32_bf16 v42, v31, v126
    v_dot2c_f32_bf16 v43, v31, v131
    v_permlane32_swap_b32 v36, v40
    v_permlane32_swap_b32 v37, v41
    v_permlane32_swap_b32 v38, v42
    v_permlane32_swap_b32 v39, v43
    v_add_f32 v36, v36, v40
    v_add_f32 v37, v37, v41
    v_add_f32 v38, v38, v42
    v_add_f32 v39, v39, v43
    s_nop 0
    v_permlane16_swap_b32 v36, v38
    v_permlane16_swap_b32 v37, v39
    v_add_f32 v36, v36, v38
    v_add_f32 v37, v37, v39
    s_nop 0
    v_add_f32_dpp v36, v36, v36 row_ror:8 row_mask:0xf bank_mask:0xf
    v_add_f32_dpp v37, v37, v37 row_ror:8 row_mask:0xf bank_mask:0xf
    v_and_or_b32 v36, v36, s49, v14
    v_and_or_b32 v37, v37, s49, v14
    s_mov_b32 exec_lo, 0x00ff00ff
    s_mov_b32 exec_hi, 0x00ff00ff
    buffer_store_dwordx2 v[36:37], v18, s[12:15], 0 offen sc1
    s_mov_b64 exec, 1
    ds_add_u32 v0, v255 offset:42856
    s_mov_b64 exec, -1
    s_branch L_owner
L_idle:
    s_mov_b64 exec, 1
    ds_add_u32 v0, v255 offset:42868
    s_mov_b64 exec, -1
    s_and_b32 s52, s2, 31
    s_lshl_b32 s52, s52, 7
    s_add_u32 s52, s52, 12288
L_hint:
    s_load_dwordx2 s[54:55], s[12:13], s52 glc
    s_waitcnt lgkmcnt(0)
    s_cmp_eq_u64 s[54:55], s[28:29]
    s_cbranch_scc1 L_hint_ok
    s_cmp_eq_u32 s35, 0
    s_cbranch_scc1 L_hint_ok
    s_sub_u32 s35, s35, 1
    s_sleep 4
    s_branch L_hint
L_hint_ok:
    s_mov_b64 exec, 1
    ds_add_u32 v0, v255 offset:42848
    s_mov_b64 exec, -1
    s_mov_b64 exec, 1
    ds_add_u32 v0, v255 offset:42852
    s_mov_b64 exec, -1
    s_mov_b64 exec, 1
    ds_add_u32 v0, v255 offset:42856
    s_mov_b64 exec, -1
    s_waitcnt lgkmcnt(0)
    v_readfirstlane_b32 s33, v19
    v_readfirstlane_b32 s34, v18
L_owner:
    s_and_b32 s31, s2, 7
    s_sub_u32 s32, 8, s31
    s_min_u32 s46, s31, s32
    s_cmp_gt_u32 s31, 4
    s_cselect_b32 s31, 16, 0
    s_lshr_b32 s47, s2, 4
    s_add_u32 s47, s47, s31
    s_bfe_u32 s53, s2, 0x10003
    s_lshl_b32 s53, s53, 7
    s_add_u32 s53, s53, s31
    s_lshl_b32 s53, s53, 3
    s_add_u32 s53, s53, s46
    s_andn2_b32 s51, 0x7ff, s33
    s_mov_b32 s54, s51
    s_mov_b32 s55, 0
    s_mov_b32 s56, 0
    s_mov_b32 s16, s44
    s_mov_b32 s17, s45
    s_mov_b32 s18, 0x400000
    v_and_b32 v8, 31, v2
    v_lshlrev_b32 v15, 2, v8
    v_lshlrev_b32 v8, 1, v8
    v_mov_b32 v16, 0
L_seg:
    s_xor_b32 s31, s54, s53
    s_and_b32 s31, s31, 0x487
    s_cbranch_scc0 L_seg_own
    s_cmpk_lg_u32 s31, 0x480
    s_cbranch_scc1 L_seg_next
L_seg_own:
    s_lshl_b32 s31, s51, 11
    s_lshl_b32 s32, s47, 6
    s_add_u32 s63, s31, s32
    buffer_load_ushort v9, v8, s[8:11], s63 offen
    v_lshrrev_b32 v4, 3, v2
    s_lshl_b32 s31, s30, 4
    v_add_u32 v4, s31, v4
    v_lshlrev_b32 v4, 12, v4
    s_lshl_b32 s31, s47, 7
    s_add_u32 s31, s31, 524288
    v_add3_u32 v4, v4, v7, s31
    s_mov_b32 s62, 32768
    v_mov_b32 v24, v14
    v_mov_b32 v25, v14
    v_mov_b32 v26, v14
    v_mov_b32 v27, v14
    v_lshrrev_b32 v5, 4, v2
    v_lshl_add_u32 v6, v5, 2, v7
    s_lshl_b32 s31, s30, 7
    s_add_u32 s31, s31, s55
    v_add_u32 v6, s31, v6
    s_ashr_i32 s31, s33, 31
    s_orn2_b32 s31, 0x80000000, s31
    s_xor_b32 s31, s31, s33
    s_and_b32 s31, s31, 0xfffff800
    v_cvt_pk_bf16_f32 v11, s31, s31
    v_lshlrev_b32 v11, 16, v11
    v_mul_f32 v11, 0xbfb8aa3b, v11
    v_exp_f32 v11, v11
    s_and_b32 s32, s34, 0xffff0000
    v_add_f32 v11, 1.0, v11
    v_rcp_f32 v11, v11
    v_rcp_f32 v12, s32
    v_cvt_pk_bf16_f32 v11, v11, v11
    v_lshlrev_b32 v11, 16, v11
    s_lshl_b32 s31, s34, 16
    s_waitcnt vmcnt(0)
    v_lshl_add_u32 v13, v8, 1, s55
    s_mov_b64 vcc, -1
    s_mov_b32 s56, 1
L_y_poll:
    s_mov_b64 exec, vcc
    buffer_load_dwordx4 v[20:23], v4, s[12:15], 0 offen sc1
    s_cmp_eq_u32 s30, 3
    s_cbranch_scc1 L_y_one
    buffer_load_dwordx4 v[24:27], v4, s[12:15], s62 offen sc1
L_y_one:
    s_mov_b64 exec, -1
    s_waitcnt vmcnt(0)
    v_xor_b32 v28, v14, v20
    v_xor_b32 v29, v14, v21
    v_xor_b32 v30, v14, v22
    v_xor_b32 v31, v14, v23
    v_xor_b32 v32, v14, v24
    v_xor_b32 v33, v14, v25
    v_xor_b32 v34, v14, v26
    v_xor_b32 v35, v14, v27
    v_or3_b32 v1, v28, v29, v30
    v_or3_b32 v1, v1, v31, v32
    v_or3_b32 v1, v1, v33, v34
    v_or_b32 v1, v1, v35
    v_and_b32 v1, 0xff, v1
    v_cmp_ne_u32 vcc, 0, v1
    v_pk_add_f32 v[28:29], v[28:29], v[32:33]
    v_pk_add_f32 v[30:31], v[30:31], v[34:35]
    s_cbranch_vccz L_y_got
    s_cmp_eq_u32 s35, 0
    s_cbranch_scc1 L_y_got
    s_sub_u32 s35, s35, 1
    s_branch L_y_poll
L_y_got:
    v_permlane16_swap_b32 v28, v29
    v_permlane16_swap_b32 v30, v31
    v_add_f32 v28, v28, v29
    v_add_f32 v30, v30, v31
    s_nop 1
    v_permlane32_swap_b32 v28, v30
    v_add_f32 v28, v28, v30
    s_nop 1
    v_add_f32_dpp v28, v28, v28 row_ror:8 row_mask:0xf bank_mask:0xf
    ds_write_b32 v6, v28 offset:43008
    s_mov_b64 exec, 1
    ds_add_u32 v16, v255 offset:42836
    s_mov_b64 exec, -1
    s_cmp_lg_u32 s30, 0
    s_cbranch_scc1 L_seg_next
    s_cmp_eq_u32 s47, 0
    s_cselect_b32 s32, 0, 2147483392
    v_mov_b32 v5, 2147483392
    v_writelane_b32 v5, s32, 0
    v_mov_b32 v18, s28
    v_mov_b32 v19, s29
    s_lshl_b32 s31, s34, 16
    v_lshlrev_b32 v9, 16, v9
    v_subrev_f32 v10, s31, v9
    v_cvt_pk_bf16_f32 v10, v10, v10
    v_lshlrev_b32 v10, 16, v10
    v_mul_f32 v10, v10, v12
    v_cvt_pk_bf16_f32 v10, v10, v10
    v_lshlrev_b32 v10, 16, v10
L_sync18:
    ds_read_b32 v1, v16 offset:42836
    ds_read_b32 v20, v13 offset:43008
    ds_read_b32 v21, v13 offset:43136
    ds_read_b32 v22, v13 offset:43264
    ds_read_b32 v23, v13 offset:43392
    ds_read_b32 v24, v15 offset:42496
    s_waitcnt lgkmcnt(5)
    v_readfirstlane_b32 s31, v1
    s_nop 0
    s_cmp_ge_u32 s31, 5
    s_cbranch_scc0 L_sync18
    s_waitcnt lgkmcnt(0)
    v_add_f32 v20, v20, v21
    v_add_f32 v22, v22, v23
    v_add_f32 v20, v20, v22
    v_cvt_pk_bf16_f32 v20, v20, v20
    v_lshlrev_b32 v20, 16, v20
    v_mul_f32 v20, v20, v11
    v_cvt_pk_bf16_f32 v20, v20, v20
    v_lshlrev_b32 v20, 16, v20
    v_add_f32 v20, v20, v10
    v_cvt_pk_bf16_f32 v20, v20, v20
    v_lshlrev_b32 v20, 16, v20
    v_mul_f32 v1, 0xbfb8aa3b, v20
    v_mul_f32 v20, v1, v24
    v_exp_f32 v1, v1
    s_nop 0
    v_add_f32 v1, 1.0, v1
    v_rcp_f32 v1, v1
    s_mov_b32 exec_hi, 0
    v_fma_f32 v20, v20, v1, v9
    v_cvt_pk_bf16_f32 v20, v20, v20
    buffer_store_short v20, v8, s[16:19], s63 offen sc1
    buffer_store_dwordx2 v[18:19], v5, s[12:15], 0 offen sc1
    s_mov_b64 exec, -1
L_seg_next:
    s_cmp_lg_u32 s55, 0
    s_cbranch_scc1 L_seg_end
    s_mov_b32 s55, 512
    s_sub_u32 s54, 0, s51
    s_sub_u32 s47, 31, s47
    v_mov_b32 v16, 28
    v_and_b32 v15, 24, v2
    v_xor_b32 v15, 24, v15
    v_sub_u32 v1, 0, v2
    v_and_b32 v1, 7, v1
    v_add_u32 v15, v15, v1
    v_lshlrev_b32 v15, 2, v15
    v_add_u32 v15, 128, v15
    s_branch L_seg
L_seg_end:
L_fin:
L_exit:
    s_endpgm
L_code_end:
.section .rodata,"a"
.p2align 6
.amdhsa_kernel recurrent_scan__spectral_fnet__moe_arch_mod__prompt_kernel
  .amdhsa_next_free_vgpr 256
  .amdhsa_next_free_sgpr 92
  .amdhsa_accum_offset 256
  .amdhsa_group_segment_fixed_size 0
  .amdhsa_kernarg_size 104
  .amdhsa_user_sgpr_count 2
  .amdhsa_user_sgpr_kernarg_segment_ptr 1
  .amdhsa_system_sgpr_workgroup_id_x 1
  .amdhsa_float_denorm_mode_32 3
.end_amdhsa_kernel
```

```asm
; @launch grid=(256,1,1) block=(512,1,1) lds=158720
.amdgcn_target "amdgcn-amd-amdhsa--gfx950"
.text
.globl recurrent_scan__spectral_fnet__moe_arch_mod__prompt_kernel
.p2align 8
.type recurrent_scan__spectral_fnet__moe_arch_mod__prompt_kernel,@function
recurrent_scan__spectral_fnet__moe_arch_mod__prompt_kernel:
    s_cmp_ge_u32 s2, 256
    s_cbranch_scc1 L_exit
    s_load_dwordx2 s[8:9], s[0:1], 0
    s_load_dwordx4 s[36:39], s[0:1], 48
    s_load_dwordx2 s[12:13], s[0:1], 96
    s_getpc_b64 s[32:33]
L_pc:
    s_bfe_u32 s31, s2, 0x30003
    v_subrev_u32 v3, 496, v0
    v_lshl_add_u32 v3, v3, 3, s31
    v_lshlrev_b32 v3, 7, v3
    v_cmp_gt_u32 vcc, L_code_end-L_pc, v3
    s_nop 0
    s_and_saveexec_b64 s[46:47], vcc
    s_cbranch_execz L_nopf
    global_load_dword v254, v3, s[32:33]
L_nopf:
    s_mov_b64 exec, -1
    v_lshrrev_b32 v1, 6, v0
    v_and_b32 v2, 63, v0
    v_readfirstlane_b32 s30, v1
    s_mov_b32 s10, 0x400000
    s_mov_b32 s11, 0x00020000
    s_mov_b32 s14, 0x10000000
    s_mov_b32 s15, 0x00020000
    s_mov_b32 s35, 65536
    v_lshlrev_b32 v3, 4, v2
    v_mov_b32 v0, 0
    v_mov_b32 v255, 1
    s_mov_b32 s3, s30
    s_and_b32 s30, s30, 3
    s_cmp_ge_u32 s3, 4
    s_cbranch_scc1 L_moe
    s_and_b32 s31, s2, 7
    s_lshr_b32 s32, s2, 4
    s_sub_u32 s32, 15, s32
    s_lshl_b32 s32, s32, 3
    s_add_u32 s46, s32, s31
    s_bfe_u32 s47, s2, 0x10003
    s_lshl_b32 s31, s47, 2
    s_add_u32 s51, s31, s30
    s_lshl_b32 s31, s51, 8
    s_add_u32 s52, s31, s46
    s_xor_b32 s54, s52, 1024
    s_sub_u32 s53, 2048, s52
    s_add_u32 s31, s52, 128
    s_cmp_eq_u32 s46, 0
    s_cselect_b32 s53, s31, s53
    s_cselect_b32 s50, 1, 0
    s_xor_b32 s55, s53, 1024
    s_lshl_b32 s56, s52, 11
    s_lshl_b32 s57, s53, 11
    s_lshl_b32 s58, s54, 11
    s_lshl_b32 s59, s55, 11
    s_mov_b32 s22, 2048
    s_mov_b32 s23, 0x00020000
    v_mov_b32 v1, 0
    v_and_b32 v6, 15, v2
    v_lshlrev_b32 v6, 2, v6
    ds_write_b64 v0, v[0:1] offset:41504
    ds_write_b32 v6, v0 offset:42816
    s_waitcnt lgkmcnt(0)
    s_load_dwordx2 s[28:29], s[12:13], 0
    s_load_dwordx2 s[16:17], s[0:1], 80
    buffer_load_dwordx4 v[120:123], v3, s[8:11], s56 offen
    buffer_load_dwordx4 v[124:127], v3, s[8:11], s56 offen offset:1024
    buffer_load_dwordx4 v[128:131], v3, s[8:11], s57 offen
    buffer_load_dwordx4 v[132:135], v3, s[8:11], s57 offen offset:1024
    s_mov_b32 s20, s36
    s_mov_b32 s21, s37
    buffer_load_dwordx4 v[152:155], v3, s[20:23], 0 offen
    buffer_load_dwordx4 v[156:159], v3, s[20:23], 0 offen offset:1024
    buffer_load_dwordx4 v[136:139], v3, s[8:11], s58 offen
    buffer_load_dwordx4 v[140:143], v3, s[8:11], s58 offen offset:1024
    buffer_load_dwordx4 v[144:147], v3, s[8:11], s59 offen
    buffer_load_dwordx4 v[148:151], v3, s[8:11], s59 offen offset:1024
    s_barrier
    s_branch L_dft_rest
L_moe:
    s_load_dwordx2 s[20:21], s[0:1], 64
    s_and_b32 s32, s2, 7
    s_mul_i32 s32, s32, 28
    s_lshr_b32 s31, s2, 3
    s_add_u32 s31, s31, s32
    s_lshr_b32 s46, s31, 3
    s_lshl_b32 s46, s46, 1
    s_and_b32 s47, s31, 7
    s_mov_b32 s75, 0
    s_mov_b32 s18, 7340032
    s_mov_b32 s19, 0x00020000
    s_mov_b32 s22, 7340032
    s_mov_b32 s23, 0x00020000
    s_mov_b32 s26, 7340032
    s_mov_b32 s27, 0x00020000
    v_lshrrev_b32 v4, 4, v2
    v_lshlrev_b32 v5, 5, v4
    v_and_b32 v6, 0x70, v3
    v_xor_b32 v5, v5, v6
    v_mul_u32_u24 v4, 7168, v4
    s_mul_i32 s31, s47, 917504
    s_lshl_b32 s32, s46, 7
    s_add_u32 s31, s31, s32
    v_add3_u32 v4, v4, v5, s31
    s_cmp_eq_u32 s75, 0
    s_mov_b32 s31, 917504
    s_cselect_b32 s31, 128, s31
    v_add_u32 v6, s31, v4
    s_mov_b32 vcc_lo, 0xff00ff00
    s_mov_b32 vcc_hi, 0xff00ff00
    v_cndmask_b32 v5, v6, v4, vcc
    v_cndmask_b32 v4, v4, v6, vcc
    s_mov_b32 s48, 0
    s_mov_b32 s49, 76800
    s_waitcnt lgkmcnt(0)
    s_mov_b32 s16, s38
    s_mov_b32 s17, s39
    s_load_dwordx2 s[28:29], s[12:13], 0
    s_load_dwordx2 s[24:25], s[0:1], 72
    s_load_dwordx2 s[44:45], s[0:1], 80
    s_barrier
    s_cmp_ge_u32 s2, 224
    s_cselect_b32 s66, 0, 1
    s_cbranch_scc1 L_dma_done
    s_cmp_lg_u32 s30, 0
    s_cbranch_scc1 L_dma_done
    s_setprio 3
L_dma:
    s_mov_b32 m0, s49
    s_waitcnt vmcnt(22)
    buffer_load_dwordx4 v4, s[16:19], s48 offen nt lds
    s_add_u32 m0, s49, 32768
    s_add_u32 s49, s49, 1024
    buffer_load_dwordx4 v4, s[20:23], s48 offen nt lds
    s_add_u32 s48, s48, 28672
    s_mov_b32 m0, s49
    s_waitcnt vmcnt(22)
    buffer_load_dwordx4 v4, s[16:19], s48 offen nt lds
    s_add_u32 m0, s49, 32768
    s_add_u32 s49, s49, 1024
    buffer_load_dwordx4 v4, s[20:23], s48 offen nt lds
    s_add_u32 s48, s48, 28672
    s_mov_b32 m0, s49
    s_waitcnt vmcnt(22)
    buffer_load_dwordx4 v5, s[16:19], s48 offen nt lds
    s_add_u32 m0, s49, 32768
    s_add_u32 s49, s49, 1024
    buffer_load_dwordx4 v5, s[20:23], s48 offen nt lds
    s_add_u32 s48, s48, 28672
    s_mov_b32 m0, s49
    s_waitcnt vmcnt(22)
    buffer_load_dwordx4 v5, s[16:19], s48 offen nt lds
    s_add_u32 m0, s49, 32768
    s_add_u32 s49, s49, 1024
    buffer_load_dwordx4 v5, s[20:23], s48 offen nt lds
    s_add_u32 s48, s48, 28672
    s_cmp_lt_u32 s48, 917504
    s_cbranch_scc1 L_dma
    s_branch L_dma_done
L_dft_rest:
    s_mov_b32 s18, 0x400000
    s_mov_b32 s19, 0x00020000
    s_sub_u32 s31, 2047, s52
    s_sub_u32 s32, 2047, s53
    v_mov_b32 v200, s31
    v_writelane_b32 v200, s32, 63
    s_lshl_b32 s31, s30, 2
    v_mov_b32 v201, s31
    s_bfe_u32 s31, s53, 0x20008
    s_lshl_b32 s31, s31, 2
    s_add_u32 s31, s31, 16
    v_writelane_b32 v201, s31, 63
    v_and_b32 v6, 32, v2
    s_lshl_b32 s31, s51, 2
    v_add_u32 v203, s31, v6
    v_lshrrev_b32 v202, 1, v203
    s_lshl_b32 s31, s2, 4
    s_add_u32 s31, s31, 4096
    v_mov_b32 v4, s31
    v_lshlrev_b32 v5, 3, v2
    s_and_b32 s31, s52, 7
    s_lshl_b32 s31, s31, 11
    s_and_b32 s32, s52, 1024
    s_add_u32 s31, s31, s32
    s_and_b32 s32, s52, 0xf8
    s_lshl_b32 s32, s32, 2
    s_add_u32 s31, s31, s32
    s_add_u32 s31, s31, 32768
    v_writelane_b32 v4, s31, 0
    s_add_u32 s31, s31, 16
    v_writelane_b32 v4, s31, 1
    s_and_b32 s31, s53, 7
    s_lshl_b32 s31, s31, 11
    s_and_b32 s32, s53, 1024
    s_add_u32 s31, s31, s32
    s_and_b32 s32, s53, 0xf8
    s_lshl_b32 s32, s32, 2
    s_add_u32 s31, s31, s32
    s_add_u32 s31, s31, 32768
    v_writelane_b32 v4, s31, 2
    s_add_u32 s31, s31, 16
    v_writelane_b32 v4, s31, 3
    s_mul_i32 s31, s51, 2592
    v_and_b32 v204, 32, v2
    v_lshlrev_b32 v204, 2, v204
    v_add3_u32 v204, v204, v3, s31
    s_lshl_b32 s32, s31, 1
    s_add_u32 s32, s32, 21872
    v_sub_u32 v205, s32, v204
    v_bfe_u32 v206, v2, 2, 2
    v_mul_u32_u24 v206, 2592, v206
    v_lshrrev_b32 v6, 4, v2
    v_mul_u32_u24 v7, 640, v6
    v_add_u32 v206, v206, v7
    v_and_b32 v7, 3, v2
    v_lshlrev_b32 v7, 3, v7
    s_lshl_b32 s31, s30, 7
    v_add3_u32 v206, v206, v7, s31
    v_lshlrev_b32 v6, 12, v6
    v_and_b32 v7, 15, v2
    v_lshl_add_u32 v6, v7, 4, v6
    s_lshl_b32 s31, s30, 8
    v_add_u32 v207, s31, v6
    v_bfe_i32 v208, v2, 4, 1
    v_and_b32 v208, 0x80008000, v208
    s_cmp_eq_u32 s47, 0
    s_movk_i32 s48, 0x7403
    s_cselect_b32 s48, 0x7721, s48
    v_and_b32 v250, 12, v2
    v_bfe_u32 v250, s48, v250, 4
    v_lshrrev_b32 v251, 4, v2
    v_bfe_u32 v252, v2, 1, 1
    v_mul_u32_u24 v251, v251, v252
    v_and_b32 v252, 1, v2
    v_add_u32 v251, v251, v252
    v_cvt_f32_u32 v250, v250
    v_cvt_f32_u32 v251, v251
    v_mul_f32 v250, 0x3e000000, v250
    v_mul_f32 v251, 0x3e800000, v251
    v_cos_f32 v8, v251
    v_add_f32 v251, v251, v250
    v_cos_f32 v9, v251
    v_add_f32 v251, v251, v250
    v_cos_f32 v10, v251
    v_add_f32 v251, v251, v250
    v_cos_f32 v11, v251
    v_add_f32 v251, v251, v250
    v_cos_f32 v12, v251
    v_add_f32 v251, v251, v250
    v_cos_f32 v13, v251
    v_add_f32 v251, v251, v250
    v_cos_f32 v14, v251
    v_add_f32 v251, v251, v250
    v_cos_f32 v15, v251
    v_mul_f32 v8, 0xbf317218, v8
    v_mul_f32 v9, 0xbf317218, v9
    v_mul_f32 v10, 0xbf317218, v10
    v_mul_f32 v11, 0xbf317218, v11
    v_mul_f32 v12, 0xbf317218, v12
    v_mul_f32 v13, 0xbf317218, v13
    v_mul_f32 v14, 0xbf317218, v14
    v_mul_f32 v15, 0xbf317218, v15
    v_lshrrev_b32 v250, 2, v2
    v_and_b32 v250, 12, v250
    v_and_b32 v251, 15, v2
    v_lshlrev_b32 v251, 2, v251
    v_cvt_f32_u32 v250, v250
    v_cvt_f32_u32 v251, v251
    v_mul_f32 v212, 0x3c800000, v250
    s_lshl_b32 s31, s30, 2
    s_lshr_b32 s48, s48, s31
    s_and_b32 s48, s48, 15
    s_sub_u32 s31, s48, 4
    s_mul_i32 s31, s31, s46
    v_cvt_f32_i32 v252, s31
    v_mul_f32 v252, 0x3a000000, v252
    v_add_f32 v213, 0x3c800000, v212
    v_add_f32 v214, 0x3d000000, v212
    v_add_f32 v215, 0x3d400000, v212
    s_and_b32 s31, s2, 7
    s_sub_u32 s32, 8, s31
    s_min_u32 s76, s31, s32
    s_cmp_gt_u32 s31, 4
    s_cselect_b32 s31, 16, 0
    s_lshr_b32 s77, s2, 4
    s_add_u32 s77, s77, s31
    s_bfe_u32 s78, s2, 0x10003
    s_lshl_b32 s78, s78, 7
    s_add_u32 s78, s78, s31
    s_lshl_b32 s31, s30, 5
    s_add_u32 s78, s78, s31
    s_lshl_b32 s78, s78, 3
    s_add_u32 s78, s78, s76
    s_lshl_b32 s77, s77, 6
    s_sub_u32 s79, 1984, s77
    s_lshl_b32 s76, s76, 1
    s_add_u32 s76, s76, 2040
    v_and_b32 v116, 15, v2
    v_lshl_add_u32 v116, v116, 3, s78
    s_mov_b32 vcc_lo, 0
    s_mov_b32 vcc_hi, -1
    v_sub_u32 v7, s76, v116
    v_cndmask_b32 v7, v116, v7, vcc
    s_mov_b32 vcc_lo, 0xffff0000
    s_mov_b32 vcc_hi, 0xffff0000
    v_sub_u32 v6, 0, v7
    v_cndmask_b32 v7, v7, v6, vcc
    v_and_b32 v6, 7, v7
    v_and_b32 v1, 1024, v7
    v_lshl_add_u32 v6, v6, 11, v1
    v_and_b32 v1, 0xf8, v7
    v_lshl_add_u32 v6, v1, 2, v6
    v_bfe_u32 v1, v7, 9, 1
    v_lshl_add_u32 v119, v1, 4, v6
    v_and_b32 v1, 256, v7
    v_cmp_ne_u32 s[88:89], 0, v1
    v_lshrrev_b32 v118, 2, v2
    v_lshl_add_u32 v118, v118, 3, s78
    v_lshlrev_b32 v1, 1, v2
    v_xor_b32 v1, v1, v3
    v_and_b32 v1, 48, v1
    v_sub_u32 v114, s76, v118
    v_sub_u32 v113, 0, v118
    v_and_b32 v113, 2047, v113
    v_sub_u32 v115, 2048, v114
    v_add_u32 v112, s77, v1
    v_lshl_add_u32 v114, v114, 11, v112
    v_lshl_add_u32 v112, v118, 11, v112
    v_xor_b32 v1, 48, v1
    v_add_u32 v1, s79, v1
    v_lshl_add_u32 v113, v113, 11, v1
    v_lshl_add_u32 v115, v115, 11, v1
    s_lshl_b32 s76, s30, 12
    s_add_u32 s76, s76, 142336
    v_and_b32 v1, 15, v2
    v_lshlrev_b32 v6, 6, v1
    v_lshlrev_b32 v1, 3, v2
    v_xor_b32 v1, v1, v2
    v_and_b32 v1, 48, v1
    v_add3_u32 v117, v6, v1, s76
    v_mul_f32 v250, v212, v251
    v_fmamk_f32 v52, v250, 0x3d800000, v252
    v_sin_f32 v20, v250
    v_cos_f32 v250, v250
    v_cos_f32 v48, v52
    v_sin_f32 v52, v52
    v_cvt_pk_f16_f32 v16, v250, v20
    v_cvt_pk_f16_f32 v20, -v20, v250
    v_mul_f32 v250, v213, v251
    v_fmamk_f32 v53, v250, 0x3d800000, v252
    v_sin_f32 v21, v250
    v_cos_f32 v250, v250
    v_cos_f32 v49, v53
    v_sin_f32 v53, v53
    v_cvt_pk_f16_f32 v17, v250, v21
    v_cvt_pk_f16_f32 v21, -v21, v250
    v_mul_f32 v250, v214, v251
    v_fmamk_f32 v54, v250, 0x3d800000, v252
    v_sin_f32 v22, v250
    v_cos_f32 v250, v250
    v_cos_f32 v50, v54
    v_sin_f32 v54, v54
    v_cvt_pk_f16_f32 v18, v250, v22
    v_cvt_pk_f16_f32 v22, -v22, v250
    v_mul_f32 v250, v215, v251
    v_fmamk_f32 v55, v250, 0x3d800000, v252
    v_sin_f32 v23, v250
    v_cos_f32 v250, v250
    v_cos_f32 v51, v55
    v_sin_f32 v55, v55
    v_cvt_pk_f16_f32 v19, v250, v23
    v_cvt_pk_f16_f32 v23, -v23, v250
    v_add_f32 v251, 1.0, v251
    v_mul_f32 v250, v212, v251
    v_fmamk_f32 v60, v250, 0x3d800000, v252
    v_sin_f32 v28, v250
    v_cos_f32 v250, v250
    v_cos_f32 v56, v60
    v_sin_f32 v60, v60
    v_cvt_pk_f16_f32 v24, v250, v28
    v_cvt_pk_f16_f32 v28, -v28, v250
    v_mul_f32 v250, v213, v251
    v_fmamk_f32 v61, v250, 0x3d800000, v252
    v_sin_f32 v29, v250
    v_cos_f32 v250, v250
    v_cos_f32 v57, v61
    v_sin_f32 v61, v61
    v_cvt_pk_f16_f32 v25, v250, v29
    v_cvt_pk_f16_f32 v29, -v29, v250
    v_mul_f32 v250, v214, v251
    v_fmamk_f32 v62, v250, 0x3d800000, v252
    v_sin_f32 v30, v250
    v_cos_f32 v250, v250
    v_cos_f32 v58, v62
    v_sin_f32 v62, v62
    v_cvt_pk_f16_f32 v26, v250, v30
    v_cvt_pk_f16_f32 v30, -v30, v250
    v_mul_f32 v250, v215, v251
    v_fmamk_f32 v63, v250, 0x3d800000, v252
    v_sin_f32 v31, v250
    v_cos_f32 v250, v250
    v_cos_f32 v59, v63
    v_sin_f32 v63, v63
    v_cvt_pk_f16_f32 v27, v250, v31
    v_cvt_pk_f16_f32 v31, -v31, v250
    v_add_f32 v251, 1.0, v251
    v_mov_b32 v160, 0
    v_mov_b32 v161, 0
    v_mov_b32 v162, 0
    v_mov_b32 v163, 0
    v_mov_b32 v164, 0
    v_mov_b32 v165, 0
    v_mov_b32 v166, 0
    v_mov_b32 v167, 0
    v_mov_b32 v168, 0
    v_mov_b32 v169, 0
    v_mov_b32 v170, 0
    s_mov_b32 s57, 0x3f803f80
    s_mov_b32 s59, 0xffff
    s_brev_b32 s67, 1
    s_mov_b32 s66, 0
    s_brev_b32 s64, 1
    s_brev_b32 s65, 1
    s_cmp_eq_u32 s47, 0
    s_movk_i32 s62, -10368
    s_cselect_b32 s62, 10368, s62
    s_waitcnt lgkmcnt(0)
    s_add_u32 s28, s28, 0x7f4a7c15
    s_addc_u32 s29, s29, 0x9e3779b9
    v_mov_b32 v174, s28
    v_mov_b32 v175, s29
    s_cmp_lt_u32 s2, 224
    s_cbranch_scc1 L_epoch_ok
L_sync1:
    ds_read_b32 v1, v0 offset:42872
    s_waitcnt lgkmcnt(0)
    v_readfirstlane_b32 s31, v1
    s_nop 0
    s_cmp_ge_u32 s31, 4
    s_cbranch_scc0 L_sync1
L_epoch_ok:
    s_setprio 2
    s_waitcnt vmcnt(8)
    v_dot2c_f32_bf16 v160, s57, v120
    v_dot2c_f32_bf16 v164, v120, v120
    v_dot2c_f32_bf16 v160, s57, v121
    v_dot2c_f32_bf16 v164, v121, v121
    v_dot2c_f32_bf16 v160, s57, v122
    v_dot2c_f32_bf16 v164, v122, v122
    v_dot2c_f32_bf16 v160, s57, v123
    v_dot2c_f32_bf16 v164, v123, v123
    v_dot2c_f32_bf16 v160, s57, v124
    v_dot2c_f32_bf16 v164, v124, v124
    v_dot2c_f32_bf16 v160, s57, v125
    v_dot2c_f32_bf16 v164, v125, v125
    v_dot2c_f32_bf16 v160, s57, v126
    v_dot2c_f32_bf16 v164, v126, v126
    v_dot2c_f32_bf16 v160, s57, v127
    v_dot2c_f32_bf16 v164, v127, v127
    s_waitcnt vmcnt(6)
    v_dot2c_f32_bf16 v161, s57, v128
    v_dot2c_f32_bf16 v165, v128, v128
    v_dot2c_f32_bf16 v161, s57, v129
    v_dot2c_f32_bf16 v165, v129, v129
    v_dot2c_f32_bf16 v161, s57, v130
    v_dot2c_f32_bf16 v165, v130, v130
    v_dot2c_f32_bf16 v161, s57, v131
    v_dot2c_f32_bf16 v165, v131, v131
    v_dot2c_f32_bf16 v161, s57, v132
    v_dot2c_f32_bf16 v165, v132, v132
    v_dot2c_f32_bf16 v161, s57, v133
    v_dot2c_f32_bf16 v165, v133, v133
    v_dot2c_f32_bf16 v161, s57, v134
    v_dot2c_f32_bf16 v165, v134, v134
    v_dot2c_f32_bf16 v161, s57, v135
    v_dot2c_f32_bf16 v165, v135, v135
    s_waitcnt vmcnt(4)
    v_dot2c_f32_bf16 v170, s57, v152
    v_dot2c_f32_bf16 v170, s57, v153
    v_dot2c_f32_bf16 v170, s57, v154
    v_dot2c_f32_bf16 v170, s57, v155
    v_dot2c_f32_bf16 v170, s57, v156
    v_dot2c_f32_bf16 v170, s57, v157
    v_dot2c_f32_bf16 v170, s57, v158
    v_dot2c_f32_bf16 v170, s57, v159
    v_dot2c_f32_bf16 v168, v152, v120
    v_dot2c_f32_bf16 v169, v152, v128
    v_dot2c_f32_bf16 v168, v153, v121
    v_dot2c_f32_bf16 v169, v153, v129
    v_dot2c_f32_bf16 v168, v154, v122
    v_dot2c_f32_bf16 v169, v154, v130
    v_dot2c_f32_bf16 v168, v155, v123
    v_dot2c_f32_bf16 v169, v155, v131
    v_mov_b32 v171, v170
    v_dot2c_f32_bf16 v168, v156, v124
    v_dot2c_f32_bf16 v169, v156, v132
    v_dot2c_f32_bf16 v168, v157, v125
    v_dot2c_f32_bf16 v169, v157, v133
    v_dot2c_f32_bf16 v168, v158, v126
    v_dot2c_f32_bf16 v169, v158, v134
    v_dot2c_f32_bf16 v168, v159, v127
    v_dot2c_f32_bf16 v169, v159, v135
    v_permlane32_swap_b32 v160, v161
    v_permlane32_swap_b32 v164, v165
    v_permlane32_swap_b32 v170, v171
    v_permlane32_swap_b32 v168, v169
    v_add_f32 v160, v160, v161
    v_add_f32 v164, v164, v165
    v_add_f32 v170, v170, v171
    v_add_f32 v168, v168, v169
    v_add_f32_dpp v160, v160, v160 row_shr:1 row_mask:0xf bank_mask:0xf
    v_add_f32_dpp v164, v164, v164 row_shr:1 row_mask:0xf bank_mask:0xf
    v_add_f32_dpp v170, v170, v170 row_shr:1 row_mask:0xf bank_mask:0xf
    v_add_f32_dpp v168, v168, v168 row_shr:1 row_mask:0xf bank_mask:0xf
    v_add_f32_dpp v160, v160, v160 row_shr:2 row_mask:0xf bank_mask:0xf
    v_add_f32_dpp v164, v164, v164 row_shr:2 row_mask:0xf bank_mask:0xf
    v_add_f32_dpp v170, v170, v170 row_shr:2 row_mask:0xf bank_mask:0xf
    v_add_f32_dpp v168, v168, v168 row_shr:2 row_mask:0xf bank_mask:0xf
    v_add_f32_dpp v160, v160, v160 row_shr:4 row_mask:0xf bank_mask:0xf
    v_add_f32_dpp v164, v164, v164 row_shr:4 row_mask:0xf bank_mask:0xf
    v_add_f32_dpp v170, v170, v170 row_shr:4 row_mask:0xf bank_mask:0xf
    v_add_f32_dpp v168, v168, v168 row_shr:4 row_mask:0xf bank_mask:0xf
    v_add_f32_dpp v160, v160, v160 row_shr:8 row_mask:0xf bank_mask:0xf
    v_add_f32_dpp v164, v164, v164 row_shr:8 row_mask:0xf bank_mask:0xf
    v_add_f32_dpp v170, v170, v170 row_shr:8 row_mask:0xf bank_mask:0xf
    v_add_f32_dpp v168, v168, v168 row_shr:8 row_mask:0xf bank_mask:0xf
    v_add_f32_dpp v160, v160, v160 row_bcast:15 row_mask:0xa bank_mask:0xf
    v_add_f32_dpp v164, v164, v164 row_bcast:15 row_mask:0xa bank_mask:0xf
    v_add_f32_dpp v170, v170, v170 row_bcast:15 row_mask:0xa bank_mask:0xf
    v_add_f32_dpp v168, v168, v168 row_bcast:15 row_mask:0xa bank_mask:0xf
    v_mul_f32 v160, 0x3a800000, v160
    v_mul_f32 v164, 0x3a800000, v164
    v_fma_f32 v164, -v160, v160, v164
    v_cvt_pk_bf16_f32 v161, -v160, -v160
    v_max_f32 v164, 0, v164
    v_cvt_pk_bf16_f32 v164, v164, v164
    v_and_b32 v164, 0xffff0000, v164
    v_add_f32 v164, 0x3727c5ac, v164
    v_cvt_pk_bf16_f32 v164, v164, v164
    v_and_b32 v164, 0xffff0000, v164
    v_sqrt_f32 v164, v164
    v_and_b32 v165, 0xffff0000, v161
    v_cvt_pk_bf16_f32 v248, v160, v164
    v_and_b32 v164, 0xffff0000, v248
    v_rcp_f32 v164, v164
    v_fmac_f32 v168, v170, v165
    v_mul_f32 v168, v168, v164
    v_ashrrev_i32 v170, 31, v168
    v_or_b32 v170, 0x80000000, v170
    v_xor_b32 v168, v168, v170
    v_and_b32 v168, 0xfffff800, v168
    v_or_b32 v249, v200, v168
    s_mov_b64 exec, s[64:65]
    ds_write_b32 v201, v248 offset:41472
    ds_max_u64 v0, v[248:249] offset:41504
    s_mov_b64 exec, 1
    ds_add_rtn_u32 v1, v0, v255 offset:42816
    s_mov_b64 exec, 31
    ds_read_b64 v[172:173], v5 offset:41472
    s_mov_b64 exec, s[64:65]
    ds_write_b16 v202, v161 offset:41568
    ds_write_b32 v203, v164 offset:42752
    s_mov_b64 exec, -1
    v_mov_b32_dpp v6, v128 wave_rol:1 row_mask:0xf bank_mask:0xf
    v_mov_b32_dpp v7, v132 wave_rol:1 row_mask:0xf bank_mask:0xf
    v_bfi_b32 v221, s59, v131, v130
    v_bfi_b32 v222, s59, v130, v129
    v_bfi_b32 v223, s59, v129, v128
    v_bfi_b32 v217, s59, v135, v134
    v_bfi_b32 v218, s59, v134, v133
    v_bfi_b32 v219, s59, v133, v132
    v_cndmask_b32 v220, v6, v7, s[66:67]
    v_cndmask_b32 v216, v7, v6, s[66:67]
    v_bfi_b32 v220, s59, v220, v131
    v_bfi_b32 v216, s59, v216, v135
    s_waitcnt lgkmcnt(2)
    v_readfirstlane_b32 s31, v1
    s_nop 0
    s_cmp_lg_u32 s31, 3
    s_cbranch_scc1 L_not_last
    s_mov_b64 exec, 31
    buffer_store_dwordx4 v[172:175], v4, s[12:15], 0 offen sc1
    s_mov_b64 exec, -1
    s_waitcnt vmcnt(1)
    s_branch L_b_ready
L_not_last:
    s_waitcnt vmcnt(0)
L_b_ready:
    s_setprio 1
    ds_write_b128 v204, v[120:123] offset:0
    ds_write_b128 v204, v[124:127] offset:1280
    s_cmp_lg_u32 s50, 0
    s_cbranch_scc1 L_plain1
    ds_write_b128 v205, v[216:219]
    ds_write_b128 v205, v[220:223] offset:1280
    s_branch L_second1
L_plain1:
    ds_write_b128 v204, v[128:131] offset:20736
    ds_write_b128 v204, v[132:135] offset:22016
L_second1:
    v_add_u32 v204, s62, v204
    v_add_u32 v205, s62, v205
    v_dot2c_f32_bf16 v162, s57, v136
    v_dot2c_f32_bf16 v166, v136, v136
    v_dot2c_f32_bf16 v162, s57, v137
    v_dot2c_f32_bf16 v166, v137, v137
    v_dot2c_f32_bf16 v162, s57, v138
    v_dot2c_f32_bf16 v166, v138, v138
    v_dot2c_f32_bf16 v162, s57, v139
    v_dot2c_f32_bf16 v166, v139, v139
    v_dot2c_f32_bf16 v162, s57, v140
    v_dot2c_f32_bf16 v166, v140, v140
    v_dot2c_f32_bf16 v162, s57, v141
    v_dot2c_f32_bf16 v166, v141, v141
    v_dot2c_f32_bf16 v162, s57, v142
    v_dot2c_f32_bf16 v166, v142, v142
    v_dot2c_f32_bf16 v162, s57, v143
    v_dot2c_f32_bf16 v166, v143, v143
    ds_write_b128 v204, v[136:139] offset:0
    ds_write_b128 v204, v[140:143] offset:1280
    v_dot2c_f32_bf16 v163, s57, v144
    v_dot2c_f32_bf16 v167, v144, v144
    v_dot2c_f32_bf16 v163, s57, v145
    v_dot2c_f32_bf16 v167, v145, v145
    v_dot2c_f32_bf16 v163, s57, v146
    v_dot2c_f32_bf16 v167, v146, v146
    v_dot2c_f32_bf16 v163, s57, v147
    v_dot2c_f32_bf16 v167, v147, v147
    v_dot2c_f32_bf16 v163, s57, v148
    v_dot2c_f32_bf16 v167, v148, v148
    v_dot2c_f32_bf16 v163, s57, v149
    v_dot2c_f32_bf16 v167, v149, v149
    v_dot2c_f32_bf16 v163, s57, v150
    v_dot2c_f32_bf16 v167, v150, v150
    v_dot2c_f32_bf16 v163, s57, v151
    v_dot2c_f32_bf16 v167, v151, v151
    v_xor_b32 v202, 8, v202
    v_xor_b32 v203, 16, v203
    s_waitcnt lgkmcnt(2)
    v_mov_b32_dpp v6, v144 wave_rol:1 row_mask:0xf bank_mask:0xf
    v_mov_b32_dpp v7, v148 wave_rol:1 row_mask:0xf bank_mask:0xf
    v_bfi_b32 v221, s59, v147, v146
    v_bfi_b32 v222, s59, v146, v145
    v_bfi_b32 v223, s59, v145, v144
    v_bfi_b32 v217, s59, v151, v150
    v_bfi_b32 v218, s59, v150, v149
    v_bfi_b32 v219, s59, v149, v148
    v_cndmask_b32 v220, v6, v7, s[66:67]
    v_cndmask_b32 v216, v7, v6, s[66:67]
    v_bfi_b32 v220, s59, v220, v147
    v_bfi_b32 v216, s59, v216, v151
    s_cmp_lg_u32 s50, 0
    s_cbranch_scc1 L_plain3
    ds_write_b128 v205, v[216:219]
    ds_write_b128 v205, v[220:223] offset:1280
    s_branch L_second3
L_plain3:
    ds_write_b128 v204, v[144:147] offset:20736
    ds_write_b128 v204, v[148:151] offset:22016
L_second3:
    v_permlane32_swap_b32 v162, v163
    v_permlane32_swap_b32 v166, v167
    v_add_f32 v162, v162, v163
    v_add_f32 v166, v166, v167
    s_nop 0
    v_add_f32_dpp v162, v162, v162 row_shr:1 row_mask:0xf bank_mask:0xf
    v_add_f32_dpp v166, v166, v166 row_shr:1 row_mask:0xf bank_mask:0xf
    s_nop 0
    v_add_f32_dpp v162, v162, v162 row_shr:2 row_mask:0xf bank_mask:0xf
    v_add_f32_dpp v166, v166, v166 row_shr:2 row_mask:0xf bank_mask:0xf
    s_nop 0
    v_add_f32_dpp v162, v162, v162 row_shr:4 row_mask:0xf bank_mask:0xf
    v_add_f32_dpp v166, v166, v166 row_shr:4 row_mask:0xf bank_mask:0xf
    s_nop 0
    v_add_f32_dpp v162, v162, v162 row_shr:8 row_mask:0xf bank_mask:0xf
    v_add_f32_dpp v166, v166, v166 row_shr:8 row_mask:0xf bank_mask:0xf
    s_nop 0
    v_add_f32_dpp v162, v162, v162 row_bcast:15 row_mask:0xa bank_mask:0xf
    v_add_f32_dpp v166, v166, v166 row_bcast:15 row_mask:0xa bank_mask:0xf
    v_mul_f32 v162, 0x3a800000, v162
    v_mul_f32 v166, 0x3a800000, v166
    v_fma_f32 v166, -v162, v162, v166
    v_cvt_pk_bf16_f32 v161, -v162, -v162
    v_max_f32 v166, 0, v166
    v_cvt_pk_bf16_f32 v166, v166, v166
    v_and_b32 v166, 0xffff0000, v166
    v_add_f32 v166, 0x3727c5ac, v166
    v_cvt_pk_bf16_f32 v166, v166, v166
    v_and_b32 v166, 0xffff0000, v166
    v_sqrt_f32 v166, v166
    v_and_b32 v167, 0xffff0000, v161
    v_cvt_pk_bf16_f32 v248, v162, v166
    v_and_b32 v166, 0xffff0000, v248
    v_rcp_f32 v166, v166
    s_mov_b64 exec, s[64:65]
    ds_write_b16 v202, v161 offset:41568
    ds_write_b32 v203, v166 offset:42752
    s_mov_b64 exec, 1
    ds_add_u32 v0, v255 offset:42820
    s_mov_b64 exec, -1
L_sync2:
    ds_read_b32 v1, v0 offset:42820
    ds_read_b128 v[176:179], v0 offset:42752
    ds_read_b128 v[180:183], v0 offset:42768
    ds_read_b128 v[184:187], v0 offset:42784
    ds_read_b128 v[188:191], v0 offset:42800
    ds_read_b128 v[192:195], v0 offset:41568
    ds_read_b128 v[196:199], v0 offset:41584
    s_waitcnt lgkmcnt(6)
    v_readfirstlane_b32 s31, v1
    s_nop 0
    s_cmp_ge_u32 s31, 4
    s_cbranch_scc0 L_sync2
    ds_read_b64_tr_b16 v[120:121], v206 offset:0
    ds_read_b64_tr_b16 v[122:123], v206 offset:10368
    ds_read_b64_tr_b16 v[124:125], v206 offset:20736
    ds_read_b64_tr_b16 v[126:127], v206 offset:31104
    ds_read_b64_tr_b16 v[128:129], v206 offset:32
    ds_read_b64_tr_b16 v[130:131], v206 offset:10400
    ds_read_b64_tr_b16 v[132:133], v206 offset:20768
    ds_read_b64_tr_b16 v[134:135], v206 offset:31136
    s_add_u32 m0, s76, 0
    s_nop 0
    buffer_load_dwordx4 v112, s[8:11], 0 offen lds
    s_add_u32 m0, s76, 1024
    s_nop 0
    buffer_load_dwordx4 v113, s[8:11], 0 offen lds
    s_waitcnt lgkmcnt(10)
    ds_read_b64_tr_b16 v[136:137], v206 offset:64
    ds_read_b64_tr_b16 v[138:139], v206 offset:10432
    ds_read_b64_tr_b16 v[140:141], v206 offset:20800
    ds_read_b64_tr_b16 v[142:143], v206 offset:31168
    v_pk_mul_f32 v[176:177], v[176:177], v[8:9]
    v_pk_mul_f32 v[178:179], v[178:179], v[10:11]
    v_pk_mul_f32 v[180:181], v[180:181], v[12:13]
    v_pk_mul_f32 v[182:183], v[182:183], v[14:15]
    v_pk_mul_f32 v[184:185], v[184:185], v[8:9]
    v_pk_mul_f32 v[186:187], v[186:187], v[10:11]
    v_pk_mul_f32 v[188:189], v[188:189], v[12:13]
    v_pk_mul_f32 v[190:191], v[190:191], v[14:15]
    v_cvt_pk_bf16_f32 v160, v176, v177
    v_cvt_pk_bf16_f32 v152, v184, v185
    v_cvt_pk_bf16_f32 v161, v178, v179
    v_cvt_pk_bf16_f32 v153, v186, v187
    v_cvt_pk_bf16_f32 v162, v180, v181
    v_cvt_pk_bf16_f32 v154, v188, v189
    v_cvt_pk_bf16_f32 v163, v182, v183
    v_cvt_pk_bf16_f32 v155, v190, v191
    v_xor_b32 v164, v208, v160
    v_xor_b32 v156, v208, v152
    v_xor_b32 v165, v208, v161
    v_xor_b32 v157, v208, v153
    v_xor_b32 v166, v208, v162
    v_xor_b32 v158, v208, v154
    v_xor_b32 v167, v208, v163
    v_xor_b32 v159, v208, v155
    s_waitcnt lgkmcnt(12)
    s_cmp_lg_u32 s50, 0
    s_cbranch_scc1 L_st1_split
    v_mfma_f32_16x16x32_bf16 v[168:171], v[160:163], v[192:195], 0
    v_mfma_f32_16x16x32_bf16 v[168:171], v[152:155], v[196:199], v[168:171]
    s_waitcnt lgkmcnt(10)
    ds_read_b64_tr_b16 v[144:145], v206 offset:96
    ds_read_b64_tr_b16 v[146:147], v206 offset:10464
    ds_read_b64_tr_b16 v[148:149], v206 offset:20832
    ds_read_b64_tr_b16 v[150:151], v206 offset:31200
    v_mfma_f32_16x16x32_bf16 v[216:219], v[160:163], v[120:123], v[168:171]
    s_waitcnt lgkmcnt(12)
    v_mfma_f32_16x16x32_bf16 v[216:219], v[152:155], v[124:127], v[216:219]
    s_waitcnt lgkmcnt(10)
    v_mfma_f32_16x16x32_bf16 v[224:227], v[160:163], v[128:131], v[168:171]
    s_waitcnt lgkmcnt(8)
    v_mfma_f32_16x16x32_bf16 v[224:227], v[152:155], v[132:135], v[224:227]
    s_waitcnt lgkmcnt(6)
    v_mfma_f32_16x16x32_bf16 v[232:235], v[160:163], v[136:139], v[168:171]
    s_waitcnt lgkmcnt(4)
    v_mfma_f32_16x16x32_bf16 v[232:235], v[152:155], v[140:143], v[232:235]
    s_waitcnt lgkmcnt(2)
    v_mfma_f32_16x16x32_bf16 v[240:243], v[160:163], v[144:147], v[168:171]
    s_waitcnt lgkmcnt(0)
    v_mfma_f32_16x16x32_bf16 v[240:243], v[152:155], v[148:151], v[240:243]
    v_mfma_f32_16x16x32_bf16 v[220:223], v[164:167], v[120:123], 0
    v_mfma_f32_16x16x32_bf16 v[220:223], v[156:159], v[124:127], v[220:223]
    v_mfma_f32_16x16x32_bf16 v[228:231], v[164:167], v[128:131], 0
    v_mfma_f32_16x16x32_bf16 v[228:231], v[156:159], v[132:135], v[228:231]
    v_cvt_pk_f16_f32 v176, v216, v217
    v_cvt_pk_f16_f32 v177, v224, v225
    v_cvt_pk_f16_f32 v178, v232, v233
    s_nop 0
    v_cvt_pk_f16_f32 v179, v240, v241
    ds_write_b128 v207, v[176:179] offset:44032
    v_mfma_f32_16x16x32_bf16 v[236:239], v[164:167], v[136:139], 0
    v_mfma_f32_16x16x32_bf16 v[236:239], v[156:159], v[140:143], v[236:239]
    v_cvt_pk_f16_f32 v180, v218, v219
    v_cvt_pk_f16_f32 v181, v226, v227
    v_cvt_pk_f16_f32 v182, v234, v235
    v_cvt_pk_f16_f32 v183, v242, v243
    ds_write_b128 v207, v[180:183] offset:45056
    v_mfma_f32_16x16x32_bf16 v[244:247], v[164:167], v[144:147], 0
    v_mfma_f32_16x16x32_bf16 v[244:247], v[156:159], v[148:151], v[244:247]
    v_cvt_pk_f16_f32 v184, v220, v221
    v_cvt_pk_f16_f32 v185, v228, v229
    v_cvt_pk_f16_f32 v186, v236, v237
    s_nop 4
    v_cvt_pk_f16_f32 v187, v244, v245
    ds_write_b128 v207, v[184:187] offset:46080
    v_cvt_pk_f16_f32 v188, v222, v223
    v_cvt_pk_f16_f32 v189, v230, v231
    v_cvt_pk_f16_f32 v190, v238, v239
    v_cvt_pk_f16_f32 v191, v246, v247
    ds_write_b128 v207, v[188:191] offset:47104
    s_branch L_st1_done
L_st1_split:
    s_waitcnt lgkmcnt(8)
    ds_read_b64_tr_b16 v[144:145], v206 offset:96
    ds_read_b64_tr_b16 v[146:147], v206 offset:10464
    ds_read_b64_tr_b16 v[148:149], v206 offset:20832
    ds_read_b64_tr_b16 v[150:151], v206 offset:31200
    s_waitcnt lgkmcnt(0)
    v_mfma_f32_16x16x32_bf16 v[168:171], v[160:163], v[192:195], 0
    v_mfma_f32_16x16x32_bf16 v[220:223], v[164:167], v[120:123], 0
    v_mfma_f32_16x16x32_bf16 v[216:219], v[160:163], v[120:123], v[168:171]
    v_mfma_f32_16x16x32_bf16 v[228:231], v[164:167], v[128:131], 0
    v_mfma_f32_16x16x32_bf16 v[224:227], v[160:163], v[128:131], v[168:171]
    v_mfma_f32_16x16x32_bf16 v[236:239], v[164:167], v[136:139], 0
    v_mfma_f32_16x16x32_bf16 v[232:235], v[160:163], v[136:139], v[168:171]
    v_mfma_f32_16x16x32_bf16 v[244:247], v[164:167], v[144:147], 0
    v_mfma_f32_16x16x32_bf16 v[240:243], v[160:163], v[144:147], v[168:171]
    s_nop 1
    v_cvt_pk_f16_f32 v176, v216, v217
    v_cvt_pk_f16_f32 v180, v218, v219
    v_cvt_pk_f16_f32 v184, v220, v221
    v_cvt_pk_f16_f32 v188, v222, v223
    v_cvt_pk_f16_f32 v177, v224, v225
    v_cvt_pk_f16_f32 v181, v226, v227
    v_cvt_pk_f16_f32 v185, v228, v229
    v_cvt_pk_f16_f32 v189, v230, v231
    v_cvt_pk_f16_f32 v178, v232, v233
    v_cvt_pk_f16_f32 v182, v234, v235
    v_cvt_pk_f16_f32 v186, v236, v237
    v_cvt_pk_f16_f32 v190, v238, v239
    v_cvt_pk_f16_f32 v179, v240, v241
    v_cvt_pk_f16_f32 v183, v242, v243
    v_cvt_pk_f16_f32 v187, v244, v245
    v_cvt_pk_f16_f32 v191, v246, v247
    ds_write_b128 v207, v[176:179] offset:44032
    ds_write_b128 v207, v[180:183] offset:45056
    ds_write_b128 v207, v[184:187] offset:46080
    ds_write_b128 v207, v[188:191] offset:47104
    v_mfma_f32_16x16x32_bf16 v[168:171], v[152:155], v[196:199], 0
    v_mfma_f32_16x16x32_bf16 v[220:223], v[156:159], v[124:127], 0
    v_mfma_f32_16x16x32_bf16 v[216:219], v[152:155], v[124:127], v[168:171]
    v_mfma_f32_16x16x32_bf16 v[228:231], v[156:159], v[132:135], 0
    v_mfma_f32_16x16x32_bf16 v[224:227], v[152:155], v[132:135], v[168:171]
    v_mfma_f32_16x16x32_bf16 v[236:239], v[156:159], v[140:143], 0
    v_mfma_f32_16x16x32_bf16 v[232:235], v[152:155], v[140:143], v[168:171]
    v_mfma_f32_16x16x32_bf16 v[244:247], v[156:159], v[148:151], 0
    v_mfma_f32_16x16x32_bf16 v[240:243], v[152:155], v[148:151], v[168:171]
    s_waitcnt lgkmcnt(0)
    s_nop 0
    v_cvt_pk_f16_f32 v176, v216, v217
    v_cvt_pk_f16_f32 v180, v218, v219
    v_cvt_pk_f16_f32 v184, v220, v221
    v_cvt_pk_f16_f32 v188, v222, v223
    v_cvt_pk_f16_f32 v177, v224, v225
    v_cvt_pk_f16_f32 v181, v226, v227
    v_cvt_pk_f16_f32 v185, v228, v229
    v_cvt_pk_f16_f32 v189, v230, v231
    v_cvt_pk_f16_f32 v178, v232, v233
    v_cvt_pk_f16_f32 v182, v234, v235
    v_cvt_pk_f16_f32 v186, v236, v237
    v_cvt_pk_f16_f32 v190, v238, v239
    v_cvt_pk_f16_f32 v179, v240, v241
    v_cvt_pk_f16_f32 v183, v242, v243
    v_cvt_pk_f16_f32 v187, v244, v245
    v_cvt_pk_f16_f32 v191, v246, v247
    ds_write_b128 v207, v[176:179] offset:60416
    ds_write_b128 v207, v[180:183] offset:61440
    ds_write_b128 v207, v[184:187] offset:62464
    ds_write_b128 v207, v[188:191] offset:63488
L_st1_done:
    s_mov_b64 exec, 1
    ds_add_u32 v0, v255 offset:42824
    s_mov_b64 exec, -1
    s_lshl_b32 s31, s30, 12
    v_add_u32 v5, s31, v3
    s_and_b32 s31, s28, 0x30003
    v_mov_b32 v210, s31
    s_mov_b32 s58, 0xfffcfffc
    s_and_b32 s32, s48, 3
    s_cselect_b32 s72, -1, 0xff
    s_cselect_b32 s73, -1, 0
    s_mov_b32 s74, s48
    v_mov_b32 v209, 2147483392
    s_cmp_eq_u32 s48, 7
    s_cbranch_scc1 L_no_consts
    v_mul_f32 v250, v212, v251
    v_fmamk_f32 v68, v250, 0x3d800000, v252
    v_sin_f32 v36, v250
    v_cos_f32 v250, v250
    v_cos_f32 v64, v68
    v_sin_f32 v68, v68
    v_cvt_pk_f16_f32 v32, v250, v36
    v_cvt_pk_f16_f32 v36, -v36, v250
    v_mul_f32 v250, v213, v251
    v_fmamk_f32 v69, v250, 0x3d800000, v252
    v_sin_f32 v37, v250
    v_cos_f32 v250, v250
    v_cos_f32 v65, v69
    v_sin_f32 v69, v69
    v_cvt_pk_f16_f32 v33, v250, v37
    v_cvt_pk_f16_f32 v37, -v37, v250
    v_mul_f32 v250, v214, v251
    v_fmamk_f32 v70, v250, 0x3d800000, v252
    v_sin_f32 v38, v250
    v_cos_f32 v250, v250
    v_cos_f32 v66, v70
    v_sin_f32 v70, v70
    v_cvt_pk_f16_f32 v34, v250, v38
    v_cvt_pk_f16_f32 v38, -v38, v250
    v_mul_f32 v250, v215, v251
    v_fmamk_f32 v71, v250, 0x3d800000, v252
    v_sin_f32 v39, v250
    v_cos_f32 v250, v250
    v_cos_f32 v67, v71
    v_sin_f32 v71, v71
    v_cvt_pk_f16_f32 v35, v250, v39
    v_cvt_pk_f16_f32 v39, -v39, v250
    v_add_f32 v251, 1.0, v251
    v_mul_f32 v250, v212, v251
    v_fmamk_f32 v76, v250, 0x3d800000, v252
    v_sin_f32 v44, v250
    v_cos_f32 v250, v250
    v_cos_f32 v72, v76
    v_sin_f32 v76, v76
    v_cvt_pk_f16_f32 v40, v250, v44
    v_cvt_pk_f16_f32 v44, -v44, v250
    v_mul_f32 v250, v213, v251
    v_fmamk_f32 v77, v250, 0x3d800000, v252
    v_sin_f32 v45, v250
    v_cos_f32 v250, v250
    v_cos_f32 v73, v77
    v_sin_f32 v77, v77
    v_cvt_pk_f16_f32 v41, v250, v45
    v_cvt_pk_f16_f32 v45, -v45, v250
    v_mul_f32 v250, v214, v251
    v_fmamk_f32 v78, v250, 0x3d800000, v252
    v_sin_f32 v46, v250
    v_cos_f32 v250, v250
    v_cos_f32 v74, v78
    v_sin_f32 v78, v78
    v_cvt_pk_f16_f32 v42, v250, v46
    v_cvt_pk_f16_f32 v46, -v46, v250
    v_mul_f32 v250, v215, v251
    v_fmamk_f32 v79, v250, 0x3d800000, v252
    v_sin_f32 v47, v250
    v_cos_f32 v250, v250
    v_cos_f32 v75, v79
    v_sin_f32 v79, v79
    v_cvt_pk_f16_f32 v43, v250, v47
    v_cvt_pk_f16_f32 v47, -v47, v250
    s_and_b32 s31, s46, 1
    s_lshl_b32 s31, s31, 6
    s_lshr_b32 s32, s46, 1
    s_add_u32 s49, s31, s32
    s_bitcmp1_b32 s49, 2
    s_cselect_b64 vcc, -1, 0
    v_cndmask_b32 v80, v16, v20, vcc
    v_cndmask_b32 v84, v20, v16, vcc
    v_cndmask_b32 v81, v17, v21, vcc
    v_cndmask_b32 v85, v21, v17, vcc
    v_cndmask_b32 v82, v18, v22, vcc
    v_cndmask_b32 v86, v22, v18, vcc
    v_cndmask_b32 v83, v19, v23, vcc
    v_cndmask_b32 v87, v23, v19, vcc
    s_bfe_u32 s31, s49, 0x10001
    v_and_b32 v6, 7, v2
    v_xor_b32 v6, s31, v6
    v_lshlrev_b32 v6, 4, v6
    v_lshrrev_b32 v7, 4, v2
    v_lshlrev_b32 v7, 3, v7
    v_bfe_u32 v209, v2, 3, 1
    v_add_u32 v7, v7, v209
    v_mul_u32_u24 v7, 16512, v7
    v_add_u32 v209, v6, v7
    s_mul_i32 s31, s48, 528384
    s_lshl_b32 s32, s49, 7
    s_add_u32 s31, s31, s32
    s_add_u32 s60, s31, 2097152
L_no_consts:
L_st23:
L_sync3:
    ds_read_b32 v1, v0 offset:42824
    ds_read_b128 v[120:123], v5 offset:44032
    ds_read_b128 v[124:127], v5 offset:45056
    ds_read_b128 v[128:131], v5 offset:46080
    ds_read_b128 v[132:135], v5 offset:47104
    s_waitcnt lgkmcnt(4)
    v_readfirstlane_b32 s31, v1
    s_nop 0
    s_cmp_ge_u32 s31, 4
    s_cbranch_scc0 L_sync3
    s_cmp_eq_u32 s48, 7
    s_cbranch_scc1 L_p1_done
    s_add_u32 s61, s60, 33024
    s_add_u32 s62, s61, 33024
    s_add_u32 s63, s62, 33024
    s_waitcnt lgkmcnt(3)
    v_mfma_f32_16x16x32_f16 v[136:139], v[120:123], v[16:19], 0
    v_mfma_f32_16x16x32_f16 v[140:143], v[120:123], v[20:23], 0
    s_waitcnt lgkmcnt(2)
    v_mfma_f32_16x16x32_f16 v[144:147], v[124:127], v[24:27], 0
    v_mfma_f32_16x16x32_f16 v[148:151], v[124:127], v[28:31], 0
    s_nop 3
    v_pk_mul_f32 v[152:153], v[48:49], v[136:137]
    v_pk_mul_f32 v[154:155], v[50:51], v[138:139]
    v_pk_mul_f32 v[156:157], v[52:53], v[136:137]
    v_pk_mul_f32 v[158:159], v[54:55], v[138:139]
    v_pk_fma_f32 v[152:153], v[52:53], v[140:141], v[152:153]
    v_pk_fma_f32 v[156:157], v[48:49], v[140:141], v[156:157] neg_lo:[0,0,1] neg_hi:[0,0,1]
    v_pk_fma_f32 v[154:155], v[54:55], v[142:143], v[154:155]
    v_pk_fma_f32 v[158:159], v[50:51], v[142:143], v[158:159] neg_lo:[0,0,1] neg_hi:[0,0,1]
    v_cvt_pk_f16_f32 v120, v152, v156
    v_cvt_pk_f16_f32 v121, v153, v157
    v_cvt_pk_f16_f32 v122, v154, v158
    v_cvt_pk_f16_f32 v123, v155, v159
    s_waitcnt lgkmcnt(1)
    v_mfma_f32_16x16x32_f16 v[136:139], v[128:131], v[32:35], 0
    v_mfma_f32_16x16x32_f16 v[140:143], v[128:131], v[36:39], 0
    v_mfma_f32_16x16x32_f16 v[216:219], v[80:83], v[120:123], 0
    v_mfma_f32_16x16x32_f16 v[220:223], v[84:87], v[120:123], 0
    v_pk_mul_f32 v[152:153], v[56:57], v[144:145]
    v_pk_mul_f32 v[154:155], v[58:59], v[146:147]
    v_pk_mul_f32 v[156:157], v[60:61], v[144:145]
    v_pk_mul_f32 v[158:159], v[62:63], v[146:147]
    v_pk_fma_f32 v[152:153], v[60:61], v[148:149], v[152:153]
    v_pk_fma_f32 v[156:157], v[56:57], v[148:149], v[156:157] neg_lo:[0,0,1] neg_hi:[0,0,1]
    v_pk_fma_f32 v[154:155], v[62:63], v[150:151], v[154:155]
    v_pk_fma_f32 v[158:159], v[58:59], v[150:151], v[158:159] neg_lo:[0,0,1] neg_hi:[0,0,1]
    v_cvt_pk_f16_f32 v124, v152, v156
    v_cvt_pk_f16_f32 v125, v153, v157
    v_cvt_pk_f16_f32 v126, v154, v158
    v_cvt_pk_f16_f32 v127, v155, v159
    s_waitcnt lgkmcnt(0)
    v_mfma_f32_16x16x32_f16 v[144:147], v[132:135], v[40:43], 0
    v_mfma_f32_16x16x32_f16 v[148:151], v[132:135], v[44:47], 0
    v_mfma_f32_16x16x32_f16 v[224:227], v[80:83], v[124:127], 0
    v_mfma_f32_16x16x32_f16 v[228:231], v[84:87], v[124:127], 0
    v_pk_mul_f32 v[152:153], v[64:65], v[136:137]
    v_pk_mul_f32 v[154:155], v[66:67], v[138:139]
    v_pk_mul_f32 v[156:157], v[68:69], v[136:137]
    v_pk_mul_f32 v[158:159], v[70:71], v[138:139]
    v_pk_fma_f32 v[152:153], v[68:69], v[140:141], v[152:153]
    v_pk_fma_f32 v[156:157], v[64:65], v[140:141], v[156:157] neg_lo:[0,0,1] neg_hi:[0,0,1]
    v_pk_fma_f32 v[154:155], v[70:71], v[142:143], v[154:155]
    v_pk_fma_f32 v[158:159], v[66:67], v[142:143], v[158:159] neg_lo:[0,0,1] neg_hi:[0,0,1]
    v_cvt_pk_f16_f32 v128, v152, v156
    v_cvt_pk_f16_f32 v129, v153, v157
    v_cvt_pk_f16_f32 v130, v154, v158
    v_cvt_pk_f16_f32 v131, v155, v159
    s_nop 1
    v_mfma_f32_16x16x32_f16 v[232:235], v[80:83], v[128:131], 0
    v_mfma_f32_16x16x32_f16 v[236:239], v[84:87], v[128:131], 0
    v_pk_mul_f32 v[152:153], v[72:73], v[144:145]
    v_pk_mul_f32 v[154:155], v[74:75], v[146:147]
    v_pk_mul_f32 v[156:157], v[76:77], v[144:145]
    v_pk_mul_f32 v[158:159], v[78:79], v[146:147]
    v_pk_fma_f32 v[152:153], v[76:77], v[148:149], v[152:153]
    v_pk_fma_f32 v[156:157], v[72:73], v[148:149], v[156:157] neg_lo:[0,0,1] neg_hi:[0,0,1]
    v_pk_fma_f32 v[154:155], v[78:79], v[150:151], v[154:155]
    v_pk_fma_f32 v[158:159], v[74:75], v[150:151], v[158:159] neg_lo:[0,0,1] neg_hi:[0,0,1]
    v_cvt_pk_f16_f32 v132, v152, v156
    v_cvt_pk_f16_f32 v133, v153, v157
    v_cvt_pk_f16_f32 v134, v154, v158
    v_cvt_pk_f16_f32 v135, v155, v159
    s_nop 1
    v_mfma_f32_16x16x32_f16 v[240:243], v[80:83], v[132:135], 0
    v_mfma_f32_16x16x32_f16 v[244:247], v[84:87], v[132:135], 0
    v_cvt_pk_f16_f32 v176, v216, v224
    v_cvt_pk_f16_f32 v178, v220, v228
    v_and_or_b32 v176, v176, s58, v210
    v_and_or_b32 v178, v178, s58, v210
    v_cvt_pk_f16_f32 v180, v217, v225
    v_cvt_pk_f16_f32 v182, v221, v229
    v_and_or_b32 v180, v180, s58, v210
    v_and_or_b32 v182, v182, s58, v210
    v_cvt_pk_f16_f32 v184, v218, v226
    v_cvt_pk_f16_f32 v186, v222, v230
    v_and_or_b32 v184, v184, s58, v210
    v_and_or_b32 v186, v186, s58, v210
    v_cvt_pk_f16_f32 v188, v219, v227
    v_cvt_pk_f16_f32 v190, v223, v231
    v_and_or_b32 v188, v188, s58, v210
    v_and_or_b32 v190, v190, s58, v210
    v_cvt_pk_f16_f32 v177, v232, v240
    v_cvt_pk_f16_f32 v179, v236, v244
    v_and_or_b32 v177, v177, s58, v210
    v_and_or_b32 v179, v179, s58, v210
    v_cvt_pk_f16_f32 v181, v233, v241
    v_cvt_pk_f16_f32 v183, v237, v245
    v_and_or_b32 v181, v181, s58, v210
    v_and_or_b32 v183, v183, s58, v210
    v_cvt_pk_f16_f32 v185, v234, v242
    v_cvt_pk_f16_f32 v187, v238, v246
    v_and_or_b32 v185, v185, s58, v210
    v_and_or_b32 v187, v187, s58, v210
    v_cvt_pk_f16_f32 v189, v235, v243
    v_cvt_pk_f16_f32 v191, v239, v247
    v_and_or_b32 v189, v189, s58, v210
    v_and_or_b32 v191, v191, s58, v210
    s_cmp_eq_u32 s50, 0
    s_cbranch_scc1 L_p1_done
    s_mov_b32 exec_hi, s72
    buffer_store_dwordx4 v[176:179], v209, s[12:15], s60 offen sc1
    s_mov_b32 exec_hi, s73
    buffer_store_dwordx4 v[180:183], v209, s[12:15], s61 offen sc1
    buffer_store_dwordx4 v[184:187], v209, s[12:15], s62 offen sc1
    buffer_store_dwordx4 v[188:191], v209, s[12:15], s63 offen sc1
    s_mov_b32 exec_hi, -1
    s_mov_b32 s50, 0
    s_add_u32 s60, s60, 16384
    v_add_u32 v5, 16384, v5
    s_sub_u32 s31, s48, 4
    v_cvt_f32_i32 v252, s31
    v_mul_f32 v252, 0x3d800000, v252
    v_and_b32 v251, 15, v2
    v_lshlrev_b32 v251, 2, v251
    v_cvt_f32_u32 v251, v251
    v_fma_f32 v250, v212, v251, v252
    v_sin_f32 v84, v250
    v_cos_f32 v250, v250
    s_nop 0
    v_cvt_pk_f16_f32 v80, v250, v84
    v_cvt_pk_f16_f32 v84, -v84, v250
    v_fma_f32 v250, v213, v251, v252
    v_sin_f32 v85, v250
    v_cos_f32 v250, v250
    s_nop 0
    v_cvt_pk_f16_f32 v81, v250, v85
    v_cvt_pk_f16_f32 v85, -v85, v250
    v_fma_f32 v250, v214, v251, v252
    v_sin_f32 v86, v250
    v_cos_f32 v250, v250
    s_nop 0
    v_cvt_pk_f16_f32 v82, v250, v86
    v_cvt_pk_f16_f32 v86, -v86, v250
    v_fma_f32 v250, v215, v251, v252
    v_sin_f32 v87, v250
    v_cos_f32 v250, v250
    s_nop 0
    v_cvt_pk_f16_f32 v83, v250, v87
    v_cvt_pk_f16_f32 v87, -v87, v250
    s_branch L_st23
L_p1_done:
    s_cmp_lt_u32 s2, 224
    s_cbranch_scc1 L_zst_later
    s_cmp_eq_u32 s74, 7
    s_cbranch_scc1 L_zst_later
    s_mov_b32 exec_hi, s72
    buffer_store_dwordx4 v[176:179], v209, s[12:15], s60 offen sc1
    s_mov_b32 exec_hi, s73
    buffer_store_dwordx4 v[180:183], v209, s[12:15], s61 offen sc1
    buffer_store_dwordx4 v[184:187], v209, s[12:15], s62 offen sc1
    buffer_store_dwordx4 v[188:191], v209, s[12:15], s63 offen sc1
    s_mov_b32 exec_hi, -1
    s_mov_b32 s74, 7
L_zst_later:
    s_mov_b64 exec, 1
    ds_add_u32 v0, v255 offset:42828
    s_mov_b64 exec, -1
    s_setprio 0
    v_mov_b32 v4, v112
    v_mov_b32 v5, v113
    v_mov_b32 v249, v114
    v_mov_b32 v205, v115
    v_mov_b32 v248, v116
    v_mov_b32 v208, v117
    v_mov_b32 v7, v118
    v_mov_b32 v6, v119
    s_and_b32 s31, s2, 7
    s_sub_u32 s32, 8, s31
    s_min_u32 s46, s31, s32
    s_cmp_gt_u32 s31, 4
    s_cselect_b32 s31, 16, 0
    s_lshr_b32 s47, s2, 4
    s_add_u32 s47, s47, s31
    s_bfe_u32 s53, s2, 0x10003
    s_lshl_b32 s53, s53, 7
    s_add_u32 s53, s53, s31
    s_lshl_b32 s31, s30, 5
    s_add_u32 s53, s53, s31
    s_lshl_b32 s48, s46, 1
    s_add_u32 s48, s48, 2040
    s_mov_b32 s49, 32768
    v_mov_b32 v212, v210
    v_mov_b32 v213, v210
    v_mov_b32 v214, v210
    v_mov_b32 v215, v210
L_sync4:
    ds_read_b32 v1, v0 offset:42860
    s_waitcnt lgkmcnt(0)
    v_readfirstlane_b32 s31, v1
    s_nop 0
    s_cmp_ge_u32 s31, 1
    s_cbranch_scc0 L_sync4
    buffer_load_dwordx4 v[24:27], v6, s[12:15], s49 offen
    s_cmp_eq_u32 s74, 7
    s_cbranch_scc1 L_no_zst
    s_cmp_ge_u32 s2, 224
    s_cbranch_scc1 L_zst_go
L_sync5:
    ds_read_b32 v1, v0 offset:42840
    s_waitcnt lgkmcnt(0)
    v_readfirstlane_b32 s31, v1
    s_nop 0
    s_cmp_ge_u32 s31, 1
    s_cbranch_scc0 L_sync5
L_zst_go:
    s_mov_b32 exec_hi, s72
    buffer_store_dwordx4 v[176:179], v209, s[12:15], s60 offen sc1
    s_mov_b32 exec_hi, s73
    buffer_store_dwordx4 v[180:183], v209, s[12:15], s61 offen sc1
    buffer_store_dwordx4 v[184:187], v209, s[12:15], s62 offen sc1
    buffer_store_dwordx4 v[188:191], v209, s[12:15], s63 offen sc1
    s_mov_b32 exec_hi, -1
L_no_zst:
    v_and_b32 v160, 15, v2
    v_add_u32 v160, s53, v160
    v_cvt_f32_u32 v160, v160
    v_add_f32 v160, 0.5, v160
    v_mul_f32 v160, 0x3b800000, v160
    v_and_b32 v161, 32, v2
    v_bfe_u32 v162, v2, 4, 1
    v_lshl_add_u32 v161, v162, 3, v161
    v_cvt_f32_u32 v161, v161
    v_mul_f32 v161, v161, v160
    v_fmamk_f32 v88, v160, 0x0, v161
    v_fmamk_f32 v162, v160, 0x40000000, v161
    v_sin_f32 v104, v88
    v_sin_f32 v163, v162
    v_cos_f32 v88, v88
    v_cos_f32 v162, v162
    v_cvt_pk_f16_f32 v104, v104, v163
    v_cvt_pk_f16_f32 v88, v88, v162
    v_fmamk_f32 v89, v160, 0x40800000, v161
    v_fmamk_f32 v162, v160, 0x40c00000, v161
    v_sin_f32 v105, v89
    v_sin_f32 v163, v162
    v_cos_f32 v89, v89
    v_cos_f32 v162, v162
    v_cvt_pk_f16_f32 v105, v105, v163
    v_cvt_pk_f16_f32 v89, v89, v162
    v_fmamk_f32 v90, v160, 0x41800000, v161
    v_fmamk_f32 v162, v160, 0x41900000, v161
    v_sin_f32 v106, v90
    v_sin_f32 v163, v162
    v_cos_f32 v90, v90
    v_cos_f32 v162, v162
    v_cvt_pk_f16_f32 v106, v106, v163
    v_cvt_pk_f16_f32 v90, v90, v162
    v_fmamk_f32 v91, v160, 0x41a00000, v161
    v_fmamk_f32 v162, v160, 0x41b00000, v161
    v_sin_f32 v107, v91
    v_sin_f32 v163, v162
    v_cos_f32 v91, v91
    v_cos_f32 v162, v162
    v_cvt_pk_f16_f32 v107, v107, v163
    v_cvt_pk_f16_f32 v91, v91, v162
    v_fmamk_f32 v92, v160, 0x42800000, v161
    v_fmamk_f32 v162, v160, 0x42840000, v161
    v_sin_f32 v108, v92
    v_sin_f32 v163, v162
    v_cos_f32 v92, v92
    v_cos_f32 v162, v162
    v_cvt_pk_f16_f32 v108, v108, v163
    v_cvt_pk_f16_f32 v92, v92, v162
    v_fmamk_f32 v93, v160, 0x42880000, v161
    v_fmamk_f32 v162, v160, 0x428c0000, v161
    v_sin_f32 v109, v93
    v_sin_f32 v163, v162
    v_cos_f32 v93, v93
    v_cos_f32 v162, v162
    v_cvt_pk_f16_f32 v109, v109, v163
    v_cvt_pk_f16_f32 v93, v93, v162
    v_fmamk_f32 v94, v160, 0x42a00000, v161
    v_fmamk_f32 v162, v160, 0x42a40000, v161
    v_sin_f32 v110, v94
    v_sin_f32 v163, v162
    v_cos_f32 v94, v94
    v_cos_f32 v162, v162
    v_cvt_pk_f16_f32 v110, v110, v163
    v_cvt_pk_f16_f32 v94, v94, v162
    v_fmamk_f32 v95, v160, 0x42a80000, v161
    v_fmamk_f32 v162, v160, 0x42ac0000, v161
    v_sin_f32 v111, v95
    v_sin_f32 v163, v162
    v_cos_f32 v95, v95
    v_cos_f32 v162, v162
    v_cvt_pk_f16_f32 v111, v111, v163
    v_cvt_pk_f16_f32 v95, v95, v162
    v_fmamk_f32 v96, v160, 0x3f800000, v161
    v_fmamk_f32 v162, v160, 0x40400000, v161
    v_sin_f32 v112, v96
    v_sin_f32 v163, v162
    v_cos_f32 v96, v96
    v_cos_f32 v162, v162
    v_cvt_pk_f16_f32 v112, v112, v163
    v_cvt_pk_f16_f32 v96, v96, v162
    v_fmamk_f32 v97, v160, 0x40a00000, v161
    v_fmamk_f32 v162, v160, 0x40e00000, v161
    v_sin_f32 v113, v97
    v_sin_f32 v163, v162
    v_cos_f32 v97, v97
    v_cos_f32 v162, v162
    v_cvt_pk_f16_f32 v113, v113, v163
    v_cvt_pk_f16_f32 v97, v97, v162
    v_fmamk_f32 v98, v160, 0x41880000, v161
    v_fmamk_f32 v162, v160, 0x41980000, v161
    v_sin_f32 v114, v98
    v_sin_f32 v163, v162
    v_cos_f32 v98, v98
    v_cos_f32 v162, v162
    v_cvt_pk_f16_f32 v114, v114, v163
    v_cvt_pk_f16_f32 v98, v98, v162
    v_fmamk_f32 v99, v160, 0x41a80000, v161
    v_fmamk_f32 v162, v160, 0x41b80000, v161
    v_sin_f32 v115, v99
    v_sin_f32 v163, v162
    v_cos_f32 v99, v99
    v_cos_f32 v162, v162
    v_cvt_pk_f16_f32 v115, v115, v163
    v_cvt_pk_f16_f32 v99, v99, v162
    v_fmamk_f32 v100, v160, 0x42820000, v161
    v_fmamk_f32 v162, v160, 0x42860000, v161
    v_sin_f32 v116, v100
    v_sin_f32 v163, v162
    v_cos_f32 v100, v100
    v_cos_f32 v162, v162
    v_cvt_pk_f16_f32 v116, v116, v163
    v_cvt_pk_f16_f32 v100, v100, v162
    v_fmamk_f32 v101, v160, 0x428a0000, v161
    v_fmamk_f32 v162, v160, 0x428e0000, v161
    v_sin_f32 v117, v101
    v_sin_f32 v163, v162
    v_cos_f32 v101, v101
    v_cos_f32 v162, v162
    v_cvt_pk_f16_f32 v117, v117, v163
    v_cvt_pk_f16_f32 v101, v101, v162
    v_fmamk_f32 v102, v160, 0x42a20000, v161
    v_fmamk_f32 v162, v160, 0x42a60000, v161
    v_sin_f32 v118, v102
    v_sin_f32 v163, v162
    v_cos_f32 v102, v102
    v_cos_f32 v162, v162
    v_cvt_pk_f16_f32 v118, v118, v163
    v_cvt_pk_f16_f32 v102, v102, v162
    v_fmamk_f32 v103, v160, 0x42aa0000, v161
    v_fmamk_f32 v162, v160, 0x42ae0000, v161
    v_sin_f32 v119, v103
    v_sin_f32 v163, v162
    v_cos_f32 v103, v103
    v_cos_f32 v162, v162
    v_cvt_pk_f16_f32 v119, v119, v163
    v_cvt_pk_f16_f32 v103, v103, v162
    v_cmp_gt_u32 vcc, 16, v2
    v_and_b32 v162, 1, v2
    v_lshlrev_b32 v162, 15, v162
    v_or_b32 v162, 0x3c00, v162
    v_and_b32 v160, 0xffff0000, v104
    v_or_b32 v162, v162, v160
    v_cndmask_b32 v104, v104, v162, vcc
    s_mul_i32 s51, s46, 528384
    s_add_u32 s51, s51, 2097152
    s_mul_i32 s54, s47, 16512
    s_lshl_b32 s32, s30, 12
    s_add_u32 s50, s51, s54
    s_add_u32 s50, s50, s32
    s_add_u32 s55, s47, 1
    s_and_b32 s55, s55, 31
    s_mul_i32 s55, s55, 16512
    v_add_u32 v250, s32, v3
    v_add_u32 v199, s76, v3
    v_lshl_add_u32 v200, v2, 7, s32
    v_and_b32 v1, 2, v2
    v_lshl_add_u32 v200, v1, 3, v200
    v_and_b32 v1, 0x70, v3
    v_add_u32 v1, 16384, v1
    s_mov_b32 vcc_lo, 0
    s_mov_b32 vcc_hi, -1
    v_cndmask_b32 v200, v200, v1, vcc
    s_mov_b32 vcc_hi, 0xff
    v_mov_b32 v1, s55
    v_mov_b32 v201, s54
    v_cndmask_b32 v1, v1, v201, vcc
    v_mov_b32 v201, 16640
    v_cndmask_b32 v201, v201, v0, vcc
    v_add_u32 v201, v201, v200
    v_add_u32 v200, v1, v200
    v_lshrrev_b32 v251, 5, v2
    v_lshlrev_b32 v251, 11, v251
    v_bfe_u32 v1, v2, 2, 3
    v_lshl_add_u32 v251, v1, 7, v251
    v_and_b32 v1, 3, v2
    v_lshl_add_u32 v251, v1, 5, v251
    v_bfe_u32 v1, v2, 3, 1
    v_lshl_add_u32 v251, v1, 4, v251
    v_bfe_u32 v1, v2, 4, 1
    v_lshl_add_u32 v251, v1, 3, v251
    v_xor_b32 v252, 16, v251
    v_xor_b32 v253, 8, v251
    v_xor_b32 v254, 24, v251
    v_cmp_gt_u32 vcc, 4, v2
    v_mov_b32 v1, 16384
    s_nop 0
    v_cndmask_b32 v1, v0, v1, vcc
    v_add_u32 v206, v253, v1
    v_add_u32 v207, v254, v1
    s_mov_b32 vcc_lo, 0x88888888
    s_mov_b32 vcc_hi, 0x88888888
    v_mov_b32 v1, 16544
    v_cndmask_b32 v1, 32, v1, vcc
    v_add_u32 v202, v251, v1
    v_add_u32 v203, v253, v1
    v_add_u32 v204, v206, v1
    s_waitcnt vmcnt(0)
L_stat_check:
    v_cmp_ne_u64 vcc, s[28:29], v[26:27]
    s_nop 0
    s_cbranch_vccz L_stat_got
    s_cmp_eq_u32 s35, 0
    s_cbranch_scc1 L_stat_got
    s_sub_u32 s35, s35, 1
    s_sleep 2
    s_mov_b64 exec, vcc
    buffer_load_dwordx4 v[24:27], v6, s[12:15], s49 offen sc1
    s_mov_b64 exec, -1
    s_waitcnt vmcnt(0)
    s_branch L_stat_check
L_stat_got:
    v_cndmask_b32 v24, v24, v25, s[88:89]
    v_mov_b32 v32, v24
    s_nop 1
    v_permlane32_swap_b32 v24, v32
    v_mov_b32 v28, v24
    v_mov_b32 v36, v32
    s_nop 0
    v_permlane16_swap_b32 v24, v28
    v_permlane16_swap_b32 v32, v36
    v_lshlrev_b32 v26, 16, v24
    v_and_b32 v24, 0xffff0000, v24
    v_rcp_f32 v24, v24
    v_lshlrev_b32 v30, 16, v28
    v_and_b32 v28, 0xffff0000, v28
    v_rcp_f32 v28, v28
    v_lshlrev_b32 v34, 16, v32
    v_and_b32 v32, 0xffff0000, v32
    v_rcp_f32 v32, v32
    v_lshlrev_b32 v38, 16, v36
    v_and_b32 v36, 0xffff0000, v36
    v_rcp_f32 v36, v36
    v_mul_f32 v24, 0xbfb8aa3b, v24
    v_mul_f32_e64 v26, -v26, v24
    v_mul_f32 v28, 0xbfb8aa3b, v28
    v_mul_f32_e64 v30, -v30, v28
    v_mul_f32 v32, 0xbfb8aa3b, v32
    v_mul_f32_e64 v34, -v34, v32
    v_mul_f32 v36, 0xbfb8aa3b, v36
    v_mul_f32_e64 v38, -v38, v36
    ds_read_b128 v[8:11], v208 offset:0
    ds_read_b128 v[12:15], v208 offset:1024
    s_waitcnt lgkmcnt(0)
    v_lshlrev_b32 v40, 16, v8
    v_and_b32 v41, 0xffff0000, v8
    v_lshlrev_b32 v42, 16, v9
    v_and_b32 v43, 0xffff0000, v9
    v_lshlrev_b32 v44, 16, v10
    v_and_b32 v45, 0xffff0000, v10
    v_lshlrev_b32 v46, 16, v11
    v_and_b32 v47, 0xffff0000, v11
    v_lshlrev_b32 v48, 16, v12
    v_and_b32 v55, 0xffff0000, v12
    v_lshlrev_b32 v54, 16, v13
    v_and_b32 v53, 0xffff0000, v13
    v_lshlrev_b32 v52, 16, v14
    v_and_b32 v51, 0xffff0000, v14
    v_lshlrev_b32 v50, 16, v15
    v_and_b32 v49, 0xffff0000, v15
    v_pk_fma_f32 v[120:121], v[40:41], v[24:25], v[26:27] op_sel_hi:[1,0,0]
    v_pk_fma_f32 v[122:123], v[42:43], v[24:25], v[26:27] op_sel_hi:[1,0,0]
    v_pk_fma_f32 v[124:125], v[44:45], v[24:25], v[26:27] op_sel_hi:[1,0,0]
    v_pk_fma_f32 v[126:127], v[46:47], v[24:25], v[26:27] op_sel_hi:[1,0,0]
    v_pk_fma_f32 v[128:129], v[48:49], v[28:29], v[30:31] op_sel_hi:[1,0,0]
    v_pk_fma_f32 v[130:131], v[50:51], v[28:29], v[30:31] op_sel_hi:[1,0,0]
    v_pk_fma_f32 v[132:133], v[52:53], v[28:29], v[30:31] op_sel_hi:[1,0,0]
    v_pk_fma_f32 v[134:135], v[54:55], v[28:29], v[30:31] op_sel_hi:[1,0,0]
    v_exp_f32 v216, v120
    v_exp_f32 v217, v121
    v_exp_f32 v218, v122
    v_exp_f32 v219, v123
    v_exp_f32 v220, v124
    v_exp_f32 v221, v125
    v_exp_f32 v222, v126
    v_exp_f32 v223, v127
    v_exp_f32 v224, v128
    v_exp_f32 v225, v129
    v_exp_f32 v226, v130
    v_exp_f32 v227, v131
    v_exp_f32 v228, v132
    v_exp_f32 v229, v133
    v_exp_f32 v230, v134
    v_exp_f32 v231, v135
    v_pk_add_f32 v[216:217], v[216:217], 1.0 op_sel_hi:[1,0]
    v_pk_add_f32 v[218:219], v[218:219], 1.0 op_sel_hi:[1,0]
    v_pk_add_f32 v[220:221], v[220:221], 1.0 op_sel_hi:[1,0]
    v_pk_add_f32 v[222:223], v[222:223], 1.0 op_sel_hi:[1,0]
    v_pk_add_f32 v[224:225], v[224:225], 1.0 op_sel_hi:[1,0]
    v_pk_add_f32 v[226:227], v[226:227], 1.0 op_sel_hi:[1,0]
    v_pk_add_f32 v[228:229], v[228:229], 1.0 op_sel_hi:[1,0]
    v_pk_add_f32 v[230:231], v[230:231], 1.0 op_sel_hi:[1,0]
    v_rcp_f32 v216, v216
    v_rcp_f32 v217, v217
    v_rcp_f32 v218, v218
    v_rcp_f32 v219, v219
    v_rcp_f32 v220, v220
    v_rcp_f32 v221, v221
    v_rcp_f32 v222, v222
    v_rcp_f32 v223, v223
    v_rcp_f32 v224, v224
    v_rcp_f32 v225, v225
    v_rcp_f32 v226, v226
    v_rcp_f32 v227, v227
    v_rcp_f32 v228, v228
    v_rcp_f32 v229, v229
    v_rcp_f32 v230, v230
    v_rcp_f32 v231, v231
    v_pk_mul_f32 v[120:121], v[120:121], v[216:217]
    v_pk_mul_f32 v[122:123], v[122:123], v[218:219]
    v_pk_mul_f32 v[124:125], v[124:125], v[220:221]
    v_pk_mul_f32 v[126:127], v[126:127], v[222:223]
    v_pk_mul_f32 v[128:129], v[128:129], v[224:225]
    v_pk_mul_f32 v[130:131], v[130:131], v[226:227]
    v_pk_mul_f32 v[132:133], v[132:133], v[228:229]
    v_pk_mul_f32 v[134:135], v[134:135], v[230:231]
L_sync6:
    ds_read_b32 v1, v0 offset:42848
    s_waitcnt lgkmcnt(0)
    v_readfirstlane_b32 s31, v1
    s_nop 0
    s_cmp_ge_u32 s31, 4
    s_cbranch_scc0 L_sync6
    s_add_u32 m0, s76, 2048
    s_nop 0
    buffer_load_dwordx4 v249, s[8:11], 0 offen lds
    s_add_u32 m0, s76, 3072
    s_nop 0
    buffer_load_dwordx4 v205, s[8:11], 0 offen lds
L_sync7:
    ds_read_b32 v1, v0 offset:42844
    ds_read_b32 v198, v0 offset:41556
    s_waitcnt lgkmcnt(1)
    v_readfirstlane_b32 s31, v1
    s_nop 0
    s_cmp_ge_u32 s31, 1
    s_cbranch_scc0 L_sync7
    v_and_b32 v6, 48, v2
    v_lshlrev_b32 v6, 1, v6
    v_mov_b32 v209, 2147483392
    s_waitcnt lgkmcnt(0)
    v_readfirstlane_b32 s33, v198
    s_nop 0
    s_andn2_b32 s33, 0x7ff, s33
    s_sub_u32 s31, 0, s33
    s_and_b32 s31, s31, 2047
    s_sub_u32 s32, s48, s33
    s_sub_u32 s34, s48, s31
    v_cmp_eq_u32 vcc, s33, v7
    v_cmp_eq_u32 s[54:55], s33, v248
    s_nop 0
    v_cndmask_b32 v4, v4, v209, vcc
    v_cmp_eq_u32 vcc, s31, v7
    v_cmp_eq_u32 s[56:57], s31, v248
    s_nop 0
    v_cndmask_b32 v5, v5, v209, vcc
    v_cmp_eq_u32 vcc, s32, v7
    v_cmp_eq_u32 s[58:59], s32, v248
    s_nop 0
    v_cndmask_b32 v249, v249, v209, vcc
    v_cmp_eq_u32 vcc, s34, v7
    v_cmp_eq_u32 s[60:61], s34, v248
    s_nop 0
    v_cndmask_b32 v205, v205, v209, vcc
    s_or_b64 s[62:63], s[54:55], s[58:59]
    s_or_b64 s[64:65], s[56:57], s[60:61]
    s_waitcnt vmcnt(0)
    buffer_load_dwordx4 v[72:75], v3, s[12:15], s50 offen offset:0 sc1
    buffer_load_dwordx4 v[76:79], v3, s[12:15], s50 offen offset:1024 sc1
    buffer_load_dwordx4 v[80:83], v3, s[12:15], s50 offen offset:2048 sc1
    buffer_load_dwordx4 v[84:87], v3, s[12:15], s50 offen offset:3072 sc1
    s_mov_b32 exec_hi, 0x1ff
    buffer_load_dwordx4 v[212:215], v200, s[12:15], s51 offen sc1
    s_mov_b32 exec_hi, -1
    ds_read_b128 v[16:19], v208 offset:2048
    ds_read_b128 v[20:23], v208 offset:3072
    s_waitcnt lgkmcnt(0)
    v_lshlrev_b32 v56, 16, v16
    v_and_b32 v57, 0xffff0000, v16
    v_lshlrev_b32 v58, 16, v17
    v_and_b32 v59, 0xffff0000, v17
    v_lshlrev_b32 v60, 16, v18
    v_and_b32 v61, 0xffff0000, v18
    v_lshlrev_b32 v62, 16, v19
    v_and_b32 v63, 0xffff0000, v19
    v_lshlrev_b32 v64, 16, v20
    v_and_b32 v71, 0xffff0000, v20
    v_lshlrev_b32 v70, 16, v21
    v_and_b32 v69, 0xffff0000, v21
    v_lshlrev_b32 v68, 16, v22
    v_and_b32 v67, 0xffff0000, v22
    v_lshlrev_b32 v66, 16, v23
    v_and_b32 v65, 0xffff0000, v23
    v_pk_fma_f32 v[136:137], v[56:57], v[32:33], v[34:35] op_sel_hi:[1,0,0]
    v_pk_fma_f32 v[138:139], v[58:59], v[32:33], v[34:35] op_sel_hi:[1,0,0]
    v_pk_fma_f32 v[140:141], v[60:61], v[32:33], v[34:35] op_sel_hi:[1,0,0]
    v_pk_fma_f32 v[142:143], v[62:63], v[32:33], v[34:35] op_sel_hi:[1,0,0]
    v_pk_fma_f32 v[144:145], v[64:65], v[36:37], v[38:39] op_sel_hi:[1,0,0]
    v_pk_fma_f32 v[146:147], v[66:67], v[36:37], v[38:39] op_sel_hi:[1,0,0]
    v_pk_fma_f32 v[148:149], v[68:69], v[36:37], v[38:39] op_sel_hi:[1,0,0]
    v_pk_fma_f32 v[150:151], v[70:71], v[36:37], v[38:39] op_sel_hi:[1,0,0]
    v_exp_f32 v232, v136
    v_exp_f32 v233, v137
    v_exp_f32 v234, v138
    v_exp_f32 v235, v139
    v_exp_f32 v236, v140
    v_exp_f32 v237, v141
    v_exp_f32 v238, v142
    v_exp_f32 v239, v143
    v_exp_f32 v240, v144
    v_exp_f32 v241, v145
    v_exp_f32 v242, v146
    v_exp_f32 v243, v147
    v_exp_f32 v244, v148
    v_exp_f32 v245, v149
    v_exp_f32 v246, v150
    v_exp_f32 v247, v151
    v_pk_add_f32 v[232:233], v[232:233], 1.0 op_sel_hi:[1,0]
    v_pk_add_f32 v[234:235], v[234:235], 1.0 op_sel_hi:[1,0]
    v_pk_add_f32 v[236:237], v[236:237], 1.0 op_sel_hi:[1,0]
    v_pk_add_f32 v[238:239], v[238:239], 1.0 op_sel_hi:[1,0]
    v_pk_add_f32 v[240:241], v[240:241], 1.0 op_sel_hi:[1,0]
    v_pk_add_f32 v[242:243], v[242:243], 1.0 op_sel_hi:[1,0]
    v_pk_add_f32 v[244:245], v[244:245], 1.0 op_sel_hi:[1,0]
    v_pk_add_f32 v[246:247], v[246:247], 1.0 op_sel_hi:[1,0]
    v_rcp_f32 v232, v232
    v_rcp_f32 v233, v233
    v_rcp_f32 v234, v234
    v_rcp_f32 v235, v235
    v_rcp_f32 v236, v236
    v_rcp_f32 v237, v237
    v_rcp_f32 v238, v238
    v_rcp_f32 v239, v239
    v_rcp_f32 v240, v240
    v_rcp_f32 v241, v241
    v_rcp_f32 v242, v242
    v_rcp_f32 v243, v243
    v_rcp_f32 v244, v244
    v_rcp_f32 v245, v245
    v_rcp_f32 v246, v246
    v_rcp_f32 v247, v247
    v_pk_mul_f32 v[136:137], v[136:137], v[232:233]
    v_pk_mul_f32 v[138:139], v[138:139], v[234:235]
    v_pk_mul_f32 v[140:141], v[140:141], v[236:237]
    v_pk_mul_f32 v[142:143], v[142:143], v[238:239]
    v_pk_mul_f32 v[144:145], v[144:145], v[240:241]
    v_pk_mul_f32 v[146:147], v[146:147], v[242:243]
    v_pk_mul_f32 v[148:149], v[148:149], v[244:245]
    v_pk_mul_f32 v[150:151], v[150:151], v[246:247]
L_z_wait:
    s_setprio 1
    s_waitcnt vmcnt(4)
    v_xor_b32 v160, v210, v72
    v_xor_b32 v161, v210, v73
    v_xor_b32 v162, v210, v74
    v_xor_b32 v163, v210, v75
    ds_write_b128 v250, v[160:163] offset:0
    v_or3_b32 v1, v160, v161, v162
    v_or_b32 v1, v1, v163
    s_waitcnt vmcnt(3)
    v_xor_b32 v164, v210, v76
    v_xor_b32 v165, v210, v77
    v_xor_b32 v166, v210, v78
    v_xor_b32 v167, v210, v79
    ds_write_b128 v250, v[164:167] offset:1024
    v_or3_b32 v1, v1, v164, v165
    v_or3_b32 v1, v1, v166, v167
    s_waitcnt vmcnt(2)
    v_xor_b32 v168, v210, v80
    v_xor_b32 v169, v210, v81
    v_xor_b32 v170, v210, v82
    v_xor_b32 v171, v210, v83
    ds_write_b128 v250, v[168:171] offset:2048
    v_or3_b32 v1, v1, v168, v169
    v_or3_b32 v1, v1, v170, v171
    s_waitcnt vmcnt(1)
    v_xor_b32 v172, v210, v84
    v_xor_b32 v173, v210, v85
    v_xor_b32 v174, v210, v86
    v_xor_b32 v175, v210, v87
    ds_write_b128 v250, v[172:175] offset:3072
    v_or3_b32 v1, v1, v172, v173
    v_or3_b32 v1, v1, v174, v175
    s_waitcnt vmcnt(0)
    v_xor_b32 v176, v210, v212
    v_xor_b32 v177, v210, v213
    v_xor_b32 v178, v210, v214
    v_xor_b32 v179, v210, v215
    s_mov_b32 exec_hi, 0x1ff
    ds_write_b128 v201, v[176:179]
    s_mov_b32 exec_hi, -1
    v_or3_b32 v1, v1, v176, v177
    v_or3_b32 v1, v1, v178, v179
    v_and_b32 v1, 0x30003, v1
    v_cmp_ne_u32 vcc, 0, v1
    s_nop 0
    s_cbranch_vccz L_z_got
    s_cmp_eq_u32 s35, 0
    s_cbranch_scc1 L_z_got
    s_sub_u32 s35, s35, 1
    s_sleep 2
    s_mov_b64 exec, vcc
    buffer_load_dwordx4 v[72:75], v3, s[12:15], s50 offen offset:0 sc1
    buffer_load_dwordx4 v[76:79], v3, s[12:15], s50 offen offset:1024 sc1
    buffer_load_dwordx4 v[80:83], v3, s[12:15], s50 offen offset:2048 sc1
    buffer_load_dwordx4 v[84:87], v3, s[12:15], s50 offen offset:3072 sc1
    s_and_b32 exec_hi, exec_hi, 0x1ff
    s_or_b32 exec_lo, exec_lo, 1
    buffer_load_dwordx4 v[212:215], v200, s[12:15], s51 offen sc1
    s_mov_b64 exec, -1
    s_waitcnt lgkmcnt(0)
    s_branch L_z_wait
L_z_got:
    s_mov_b64 exec, 1
    ds_add_u32 v0, v255 offset:42832
    s_mov_b64 exec, -1
L_sync8:
    ds_read_b32 v1, v0 offset:42832
    ds_read_b64_tr_b16 v[152:153], v251 offset:0
    ds_read_b64_tr_b16 v[154:155], v251 offset:1024
    ds_read_b64_tr_b16 v[156:157], v252 offset:0
    ds_read_b64_tr_b16 v[158:159], v252 offset:1024
    s_waitcnt lgkmcnt(4)
    v_readfirstlane_b32 s31, v1
    s_nop 0
    s_cmp_ge_u32 s31, 4
    s_cbranch_scc0 L_sync8
    ds_read_b64_tr_b16 v[160:161], v251 offset:4096
    ds_read_b64_tr_b16 v[162:163], v251 offset:5120
    ds_read_b64_tr_b16 v[164:165], v252 offset:4096
    ds_read_b64_tr_b16 v[166:167], v252 offset:5120
    ds_read_b64_tr_b16 v[168:169], v251 offset:8192
    ds_read_b64_tr_b16 v[170:171], v251 offset:9216
    ds_read_b64_tr_b16 v[172:173], v252 offset:8192
    ds_read_b64_tr_b16 v[174:175], v252 offset:9216
    s_waitcnt lgkmcnt(8)
    v_mfma_f32_16x16x32_f16 v[216:219], v[152:155], v[88:91], 0
    v_mfma_f32_16x16x32_f16 v[220:223], v[156:159], v[88:91], 0
    ds_read_b64_tr_b16 v[176:177], v251 offset:12288
    ds_read_b64_tr_b16 v[178:179], v251 offset:13312
    ds_read_b64_tr_b16 v[180:181], v252 offset:12288
    ds_read_b64_tr_b16 v[182:183], v252 offset:13312
    s_waitcnt lgkmcnt(8)
    v_mfma_f32_16x16x32_f16 v[216:219], v[160:163], v[92:95], v[216:219]
    v_mfma_f32_16x16x32_f16 v[220:223], v[164:167], v[92:95], v[220:223]
    ds_read_b64_tr_b16 v[152:153], v206 offset:0
    ds_read_b64_tr_b16 v[154:155], v253 offset:1024
    ds_read_b64_tr_b16 v[156:157], v207 offset:0
    ds_read_b64_tr_b16 v[158:159], v254 offset:1024
    s_waitcnt lgkmcnt(8)
    v_mfma_f32_16x16x32_f16 v[216:219], v[168:171], v[96:99], v[216:219]
    v_mfma_f32_16x16x32_f16 v[220:223], v[172:175], v[96:99], v[220:223]
    ds_read_b64_tr_b16 v[160:161], v253 offset:4096
    ds_read_b64_tr_b16 v[162:163], v253 offset:5120
    ds_read_b64_tr_b16 v[164:165], v254 offset:4096
    ds_read_b64_tr_b16 v[166:167], v254 offset:5120
    s_waitcnt lgkmcnt(8)
    v_mfma_f32_16x16x32_f16 v[216:219], v[176:179], v[100:103], v[216:219]
    v_mfma_f32_16x16x32_f16 v[220:223], v[180:183], v[100:103], v[220:223]
    ds_read_b64_tr_b16 v[168:169], v253 offset:8192
    ds_read_b64_tr_b16 v[170:171], v253 offset:9216
    ds_read_b64_tr_b16 v[172:173], v254 offset:8192
    ds_read_b64_tr_b16 v[174:175], v254 offset:9216
    s_waitcnt lgkmcnt(8)
    v_mfma_f32_16x16x32_f16 v[224:227], v[152:155], v[104:107], 0
    v_mfma_f32_16x16x32_f16 v[228:231], v[156:159], v[104:107], 0
    ds_read_b64_tr_b16 v[176:177], v253 offset:12288
    ds_read_b64_tr_b16 v[178:179], v253 offset:13312
    ds_read_b64_tr_b16 v[180:181], v254 offset:12288
    ds_read_b64_tr_b16 v[182:183], v254 offset:13312
    s_waitcnt lgkmcnt(8)
    v_mfma_f32_16x16x32_f16 v[224:227], v[160:163], v[108:111], v[224:227]
    v_mfma_f32_16x16x32_f16 v[228:231], v[164:167], v[108:111], v[228:231]
    ds_read_b64_tr_b16 v[72:73], v202 offset:0
    ds_read_b64_tr_b16 v[74:75], v202 offset:1024
    ds_read_b64_tr_b16 v[76:77], v202 offset:4096
    ds_read_b64_tr_b16 v[78:79], v202 offset:5120
    s_waitcnt lgkmcnt(8)
    v_mfma_f32_16x16x32_f16 v[224:227], v[168:171], v[112:115], v[224:227]
    v_mfma_f32_16x16x32_f16 v[228:231], v[172:175], v[112:115], v[228:231]
    ds_read_b64_tr_b16 v[80:81], v202 offset:8192
    ds_read_b64_tr_b16 v[82:83], v202 offset:9216
    ds_read_b64_tr_b16 v[84:85], v202 offset:12288
    ds_read_b64_tr_b16 v[86:87], v202 offset:13312
    s_waitcnt lgkmcnt(8)
    v_mfma_f32_16x16x32_f16 v[224:227], v[176:179], v[116:119], v[224:227]
    v_mfma_f32_16x16x32_f16 v[228:231], v[180:183], v[116:119], v[228:231]
    ds_read_b64_tr_b16 v[240:241], v204 offset:0
    ds_read_b64_tr_b16 v[242:243], v203 offset:1024
    ds_read_b64_tr_b16 v[244:245], v203 offset:4096
    ds_read_b64_tr_b16 v[246:247], v203 offset:5120
    s_waitcnt lgkmcnt(8)
    ds_read_b64_tr_b16 v[184:185], v203 offset:8192
    ds_read_b64_tr_b16 v[186:187], v203 offset:9216
    ds_read_b64_tr_b16 v[188:189], v203 offset:12288
    ds_read_b64_tr_b16 v[190:191], v203 offset:13312
    v_mfma_f32_16x16x32_f16 v[232:235], v[72:75], v[88:91], 0
    v_mfma_f32_16x16x32_f16 v[232:235], v[76:79], v[92:95], v[232:235]
    s_waitcnt lgkmcnt(4)
    v_mfma_f32_16x16x32_f16 v[232:235], v[80:83], v[96:99], v[232:235]
    v_mfma_f32_16x16x32_f16 v[232:235], v[84:87], v[100:103], v[232:235]
    v_pk_add_f32 v[152:153], v[216:217], v[224:225]
    v_pk_add_f32 v[154:155], v[218:219], v[226:227]
    v_pk_add_f32 v[156:157], v[220:221], v[228:229]
    v_pk_add_f32 v[158:159], v[222:223], v[230:231]
    v_mfma_f32_16x16x32_f16 v[236:239], v[240:243], v[104:107], 0
    v_mfma_f32_16x16x32_f16 v[236:239], v[244:247], v[108:111], v[236:239]
    v_pk_fma_f32 v[40:41], v[152:153], v[120:121], v[40:41]
    v_pk_fma_f32 v[42:43], v[154:155], v[122:123], v[42:43]
    v_pk_fma_f32 v[44:45], v[156:157], v[124:125], v[44:45]
    v_pk_fma_f32 v[46:47], v[158:159], v[126:127], v[46:47]
    s_waitcnt lgkmcnt(0)
    v_mfma_f32_16x16x32_f16 v[236:239], v[184:187], v[112:115], v[236:239]
    v_mfma_f32_16x16x32_f16 v[236:239], v[188:191], v[116:119], v[236:239]
    v_cvt_pk_bf16_f32 v8, v40, v41
    v_cvt_pk_bf16_f32 v9, v42, v43
    v_cvt_pk_bf16_f32 v10, v44, v45
    v_cvt_pk_bf16_f32 v11, v46, v47
    ds_write_b128 v208, v[8:11] offset:0
    ds_read_b128 v[24:27], v199 offset:0
    v_pk_add_f32 v[160:161], v[216:217], v[224:225] neg_lo:[0,1] neg_hi:[0,1]
    v_pk_add_f32 v[162:163], v[218:219], v[226:227] neg_lo:[0,1] neg_hi:[0,1]
    v_pk_add_f32 v[164:165], v[220:221], v[228:229] neg_lo:[0,1] neg_hi:[0,1]
    v_pk_add_f32 v[166:167], v[222:223], v[230:231] neg_lo:[0,1] neg_hi:[0,1]
    s_cmp_eq_u64 s[62:63], 0
    s_cbranch_scc1 L_nodump0
    s_mov_b64 exec, s[54:55]
    ds_write_b128 v6, v[152:155] offset:42496
    ds_write_b128 v6, v[156:159] offset:42512
    s_mov_b64 exec, s[58:59]
    ds_write_b128 v6, v[160:163] offset:42496
    ds_write_b128 v6, v[164:167] offset:42512
    s_mov_b64 exec, 1
    ds_add_u32 v0, v255 offset:42836
    s_mov_b64 exec, -1
    s_waitcnt lgkmcnt(0)
L_nodump0:
    v_pk_fma_f32 v[56:57], v[160:161], v[136:137], v[56:57]
    v_pk_fma_f32 v[58:59], v[162:163], v[138:139], v[58:59]
    v_pk_fma_f32 v[60:61], v[164:165], v[140:141], v[60:61]
    v_pk_fma_f32 v[62:63], v[166:167], v[142:143], v[62:63]
    v_cvt_pk_bf16_f32 v16, v56, v57
    v_cvt_pk_bf16_f32 v17, v58, v59
    v_cvt_pk_bf16_f32 v18, v60, v61
    v_cvt_pk_bf16_f32 v19, v62, v63
    ds_write_b128 v208, v[16:19] offset:2048
    ds_read_b128 v[32:35], v199 offset:2048
    s_waitcnt lgkmcnt(2)
    buffer_store_dwordx4 v[24:27], v4, s[16:19], 0 offen sc1
    v_add_f32 v152, v232, v236
    v_sub_f32 v160, v232, v236
    s_cmp_eq_u64 s[64:65], 0
    s_cbranch_scc1 L_nodump1
    s_mov_b64 exec, s[56:57]
    ds_write_b128 v6, v[152:155] offset:42624
    ds_write_b128 v6, v[156:159] offset:42640
    s_mov_b64 exec, s[60:61]
    ds_write_b128 v6, v[160:163] offset:42624
    ds_write_b128 v6, v[164:167] offset:42640
    s_mov_b64 exec, 1
    ds_add_u32 v0, v255 offset:42864
    s_mov_b64 exec, -1
    s_waitcnt lgkmcnt(0)
L_nodump1:
    v_pk_fma_f32 v[48:49], v[152:153], v[128:129], v[48:49]
    v_pk_fma_f32 v[50:51], v[154:155], v[130:131], v[50:51]
    v_pk_fma_f32 v[52:53], v[156:157], v[132:133], v[52:53]
    v_pk_fma_f32 v[54:55], v[158:159], v[134:135], v[54:55]
    v_cvt_pk_bf16_f32 v12, v48, v55
    v_cvt_pk_bf16_f32 v13, v54, v53
    v_cvt_pk_bf16_f32 v14, v52, v51
    v_cvt_pk_bf16_f32 v15, v50, v49
    ds_write_b128 v208, v[12:15] offset:1024
    ds_read_b128 v[28:31], v199 offset:1024
    s_waitcnt lgkmcnt(2)
    buffer_store_dwordx4 v[32:35], v249, s[16:19], 0 offen sc1
    v_pk_fma_f32 v[64:65], v[160:161], v[144:145], v[64:65]
    v_pk_fma_f32 v[66:67], v[162:163], v[146:147], v[66:67]
    v_pk_fma_f32 v[68:69], v[164:165], v[148:149], v[68:69]
    v_pk_fma_f32 v[70:71], v[166:167], v[150:151], v[70:71]
    v_cvt_pk_bf16_f32 v20, v64, v71
    v_cvt_pk_bf16_f32 v21, v70, v69
    v_cvt_pk_bf16_f32 v22, v68, v67
    v_cvt_pk_bf16_f32 v23, v66, v65
    ds_write_b128 v208, v[20:23] offset:3072
    ds_read_b128 v[36:39], v199 offset:3072
    s_waitcnt lgkmcnt(2)
    buffer_store_dwordx4 v[28:31], v5, s[16:19], 0 offen sc1
    s_waitcnt lgkmcnt(0)
    buffer_store_dwordx4 v[36:39], v205, s[16:19], 0 offen sc1
    s_branch L_fin
L_dma_done:
    s_setprio 3
    s_lshr_b32 s31, s47, 2
    s_andn2_b32 s31, s31, s75
    s_add_u32 s50, s31, s46
    s_lshl_b32 s31, s50, 17
    s_bfe_u32 s32, s2, 0x20003
    s_lshl_b32 s32, s32, 2
    s_add_u32 s51, s32, s30
    s_lshl_b32 s32, s51, 7
    s_add_u32 s31, s31, s32
    v_lshrrev_b32 v6, 3, v2
    v_lshlrev_b32 v6, 14, v6
    v_and_b32 v7, 0x70, v3
    v_add3_u32 v6, v6, v7, s31
    s_mov_b32 s60, 4096
    s_mov_b32 s61, 8192
    s_mov_b32 s62, 12288
    v_bfe_u32 v8, v2, 2, 3
    v_lshlrev_b32 v9, 5, v8
    s_lshl_b32 s31, s30, 6
    v_xor_b32 v9, s31, v9
    v_bfe_u32 v8, v2, 2, 2
    v_lshl_add_u32 v9, v8, 8, v9
    v_lshrrev_b32 v8, 4, v2
    v_lshl_add_u32 v9, v8, 11, v9
    v_and_b32 v10, 3, v2
    v_lshl_add_u32 v9, v10, 3, v9
    v_add_u32 v9, 76800, v9
    v_xor_b32 v10, 32, v9
    v_lshlrev_b32 v8, 4, v8
    s_lshr_b32 s31, s30, 1
    s_and_b32 s32, s31, s75
    s_lshl_b32 s32, s32, 8
    v_add_u32 v8, s32, v8
    s_cmp_eq_u32 s75, 0
    s_cselect_b32 s32, 12, 9
    s_lshl_b32 s31, s31, s32
    s_lshl_b32 s32, s46, 3
    s_add_u32 s32, s32, s47
    s_lshl_b32 s32, s32, 9
    s_add_u32 s31, s31, s32
    s_and_b32 s32, s30, 1
    s_lshl_b32 s32, s32, 8
    s_add_u32 s31, s31, s32
    s_add_u32 s31, s31, 262144
    v_lshl_add_u32 v13, v2, 3, s31
    s_waitcnt lgkmcnt(0)
    s_add_u32 s28, s28, 0x7f4a7c15
    s_addc_u32 s29, s29, 0x9e3779b9
    s_and_b32 s31, s28, 0xff
    v_mov_b32 v14, s31
    s_mov_b32 s49, 0xffffff00
    s_cmp_lg_u32 s66, 0
    s_cbranch_scc1 L_tagged
    s_mov_b64 exec, 1
    ds_add_u32 v0, v255 offset:42872
    s_mov_b64 exec, -1
L_tagged:
    s_cmp_eq_u32 s30, 3
    s_cbranch_scc1 L_h1
    s_cmp_eq_u32 s66, 0
    s_cbranch_scc1 L_key
    s_cmp_lg_u32 s30, 0
    s_cbranch_scc1 L_follower
    s_waitcnt vmcnt(16)
    s_mov_b64 exec, 1
    ds_add_u32 v0, v255 offset:42868
    s_mov_b64 exec, -1
    ds_read_b64_tr_b16 v[36:37], v9 offset:0
    ds_read_b64_tr_b16 v[38:39], v9 offset:1024
    ds_read_b64_tr_b16 v[40:41], v10 offset:0
    ds_read_b64_tr_b16 v[42:43], v10 offset:1024
    ds_read_b64_tr_b16 v[44:45], v9 offset:32768
    ds_read_b64_tr_b16 v[46:47], v9 offset:33792
    ds_read_b64_tr_b16 v[48:49], v10 offset:32768
    ds_read_b64_tr_b16 v[50:51], v10 offset:33792
    ds_read_b64_tr_b16 v[52:53], v9 offset:8192
    ds_read_b64_tr_b16 v[54:55], v9 offset:9216
    ds_read_b64_tr_b16 v[56:57], v10 offset:8192
    ds_read_b64_tr_b16 v[58:59], v10 offset:9216
    ds_read_b64_tr_b16 v[60:61], v9 offset:40960
    ds_read_b64_tr_b16 v[62:63], v9 offset:41984
    s_waitcnt lgkmcnt(12)
    ds_read_b64_tr_b16 v[64:65], v10 offset:40960
    ds_read_b64_tr_b16 v[66:67], v10 offset:41984
    s_waitcnt lgkmcnt(12)
    ds_read_b64_tr_b16 v[68:69], v9 offset:16384
    ds_read_b64_tr_b16 v[70:71], v9 offset:17408
    s_waitcnt lgkmcnt(12)
    ds_read_b64_tr_b16 v[72:73], v10 offset:16384
    ds_read_b64_tr_b16 v[74:75], v10 offset:17408
    s_waitcnt lgkmcnt(12)
    ds_read_b64_tr_b16 v[76:77], v9 offset:49152
    ds_read_b64_tr_b16 v[78:79], v9 offset:50176
    s_waitcnt lgkmcnt(12)
    ds_read_b64_tr_b16 v[80:81], v10 offset:49152
    ds_read_b64_tr_b16 v[82:83], v10 offset:50176
    s_waitcnt vmcnt(8)
    s_mov_b64 exec, 1
    ds_add_u32 v0, v255 offset:42868
    s_mov_b64 exec, -1
    s_branch L_key
L_follower:
    s_and_b32 s32, s30, 1
    s_lshl_b32 s32, s32, 8
    v_subrev_u32 v250, s32, v13
    buffer_load_dword v251, v250, s[12:15], 0 offen
    s_lshl_b32 s31, s50, 12
    s_sub_u32 s31, s31, s32
    s_lshl_b32 s32, s51, 8
    s_add_u32 s31, s31, s32
    s_add_u32 s31, s31, 524288
    v_lshl_add_u32 v250, v2, 3, s31
    buffer_load_dword v252, v250, s[12:15], 0 offen
L_sync9:
    ds_read_b32 v1, v0 offset:42868
    s_waitcnt lgkmcnt(0)
    v_readfirstlane_b32 s31, v1
    s_nop 0
    s_cmp_ge_u32 s31, 1
    s_cbranch_scc0 L_sync9
    ds_read_b64_tr_b16 v[36:37], v9 offset:0
    ds_read_b64_tr_b16 v[38:39], v9 offset:1024
    ds_read_b64_tr_b16 v[40:41], v10 offset:0
    ds_read_b64_tr_b16 v[42:43], v10 offset:1024
    ds_read_b64_tr_b16 v[44:45], v9 offset:32768
    ds_read_b64_tr_b16 v[46:47], v9 offset:33792
    ds_read_b64_tr_b16 v[48:49], v10 offset:32768
    ds_read_b64_tr_b16 v[50:51], v10 offset:33792
    ds_read_b64_tr_b16 v[52:53], v9 offset:8192
    ds_read_b64_tr_b16 v[54:55], v9 offset:9216
    ds_read_b64_tr_b16 v[56:57], v10 offset:8192
    ds_read_b64_tr_b16 v[58:59], v10 offset:9216
    ds_read_b64_tr_b16 v[60:61], v9 offset:40960
    ds_read_b64_tr_b16 v[62:63], v9 offset:41984
    s_waitcnt lgkmcnt(12)
    ds_read_b64_tr_b16 v[64:65], v10 offset:40960
    ds_read_b64_tr_b16 v[66:67], v10 offset:41984
    s_waitcnt lgkmcnt(12)
    ds_read_b64_tr_b16 v[68:69], v9 offset:16384
    ds_read_b64_tr_b16 v[70:71], v9 offset:17408
    s_waitcnt lgkmcnt(12)
    ds_read_b64_tr_b16 v[72:73], v10 offset:16384
    ds_read_b64_tr_b16 v[74:75], v10 offset:17408
    s_waitcnt lgkmcnt(12)
    ds_read_b64_tr_b16 v[76:77], v9 offset:49152
    ds_read_b64_tr_b16 v[78:79], v9 offset:50176
    s_waitcnt lgkmcnt(12)
    ds_read_b64_tr_b16 v[80:81], v10 offset:49152
    ds_read_b64_tr_b16 v[82:83], v10 offset:50176
    s_add_u32 s67, s30, 0
L_sync10:
    ds_read_b32 v1, v0 offset:42868
    s_waitcnt lgkmcnt(0)
    v_readfirstlane_b32 s31, v1
    s_nop 0
    s_cmp_ge_u32 s31, s67
    s_cbranch_scc0 L_sync10
L_d_first:
L_sync11:
    ds_read_b32 v1, v0 offset:42840
    s_waitcnt lgkmcnt(0)
    v_readfirstlane_b32 s31, v1
    s_nop 0
    s_cmp_ge_u32 s31, 1
    s_cbranch_scc0 L_sync11
    buffer_load_dwordx4 v[100:103], v6, s[24:27], 0 offen offset:0 nt
    buffer_load_dwordx4 v[104:107], v6, s[24:27], 0 offen offset:2048 nt
    buffer_load_dwordx4 v[108:111], v6, s[24:27], s60 offen offset:0 nt
    buffer_load_dwordx4 v[112:115], v6, s[24:27], s60 offen offset:2048 nt
    buffer_load_dwordx4 v[116:119], v6, s[24:27], s61 offen offset:0 nt
    buffer_load_dwordx4 v[120:123], v6, s[24:27], s61 offen offset:2048 nt
    buffer_load_dwordx4 v[124:127], v6, s[24:27], s62 offen offset:0 nt
    buffer_load_dwordx4 v[128:131], v6, s[24:27], s62 offen offset:2048 nt
L_key:
    s_waitcnt lgkmcnt(0)
L_sync12:
    ds_read_b32 v1, v0 offset:42844
    ds_read_b64 v[18:19], v0 offset:41552
    ds_read_b128 v[20:23], v8 offset:41600
    ds_read_b128 v[24:27], v8 offset:41664
    ds_read_b128 v[28:31], v8 offset:41728
    ds_read_b128 v[32:35], v8 offset:41792
    s_waitcnt lgkmcnt(5)
    v_readfirstlane_b32 s31, v1
    s_nop 0
    s_cmp_ge_u32 s31, 1
    s_cbranch_scc0 L_sync12
    s_cmp_eq_u32 s66, 0
    s_cbranch_scc1 L_idle
    s_branch L_xs_ok
L_h1:
    s_mov_b32 s63, 4096
    s_lshl_b32 s31, s47, 8
    v_lshlrev_b32 v15, 3, v2
    v_add_u32 v16, s31, v15
    s_cmp_lg_u32 s66, 0
    s_cbranch_scc1 L_gate
L_sync13:
    ds_read_b32 v1, v0 offset:42828
    s_waitcnt lgkmcnt(0)
    v_readfirstlane_b32 s31, v1
    s_nop 0
    s_cmp_ge_u32 s31, 4
    s_cbranch_scc0 L_sync13
    s_branch L_gate_open
L_gate:
L_sync14:
    ds_read_b32 v1, v0 offset:42824
    s_waitcnt lgkmcnt(0)
    v_readfirstlane_b32 s31, v1
    s_nop 0
    s_cmp_ge_u32 s31, 4
    s_cbranch_scc0 L_sync14
L_gate_open:
    buffer_load_dwordx4 v[20:23], v3, s[12:15], s63 offen offset:0 sc1
    buffer_load_dwordx4 v[24:27], v3, s[12:15], s63 offen offset:1024 sc1
    buffer_load_dwordx4 v[28:31], v3, s[12:15], s63 offen offset:2048 sc1
    buffer_load_dwordx4 v[32:35], v3, s[12:15], s63 offen offset:3072 sc1
    s_mov_b64 exec, 1
    ds_add_u32 v0, v255 offset:42860
    s_mov_b64 exec, -1
    s_waitcnt vmcnt(0)
L_mi_check:
    v_cmp_ne_u64 s[52:53], s[28:29], v[22:23]
    v_cmp_ne_u64 s[54:55], s[28:29], v[26:27]
    v_cmp_ne_u64 s[56:57], s[28:29], v[30:31]
    v_cmp_ne_u64 s[58:59], s[28:29], v[34:35]
    v_max_u32 v18, v21, v25
    v_max3_u32 v18, v18, v29, v33
    s_or_b64 s[64:65], s[52:53], s[54:55]
    s_or_b64 vcc, s[56:57], s[58:59]
    s_or_b64 s[64:65], s[64:65], vcc
    s_cbranch_scc0 L_mi_got
    s_cmp_eq_u32 s35, 0
    s_cbranch_scc1 L_mi_got
    s_sub_u32 s35, s35, 1
    s_sleep 2
    s_mov_b64 exec, s[52:53]
    s_cbranch_execz L_mi_skip0
    buffer_load_dwordx4 v[20:23], v3, s[12:15], s63 offen offset:0 sc1
L_mi_skip0:
    s_mov_b64 exec, s[54:55]
    s_cbranch_execz L_mi_skip1
    buffer_load_dwordx4 v[24:27], v3, s[12:15], s63 offen offset:1024 sc1
L_mi_skip1:
    s_mov_b64 exec, s[56:57]
    s_cbranch_execz L_mi_skip2
    buffer_load_dwordx4 v[28:31], v3, s[12:15], s63 offen offset:2048 sc1
L_mi_skip2:
    s_mov_b64 exec, s[58:59]
    s_cbranch_execz L_mi_skip3
    buffer_load_dwordx4 v[32:35], v3, s[12:15], s63 offen offset:3072 sc1
L_mi_skip3:
    s_mov_b64 exec, -1
    s_waitcnt vmcnt(0)
    s_branch L_mi_check
L_mi_got:
    v_max_u32_dpp v19, v18, v18 row_ror:1 row_mask:0xf bank_mask:0xf
    s_nop 1
    v_max_u32_dpp v19, v19, v19 row_ror:2 row_mask:0xf bank_mask:0xf
    s_nop 1
    v_max_u32_dpp v19, v19, v19 row_ror:4 row_mask:0xf bank_mask:0xf
    s_nop 1
    v_max_u32_dpp v19, v19, v19 row_ror:8 row_mask:0xf bank_mask:0xf
    s_nop 0
    v_readlane_b32 s33, v19, 0
    v_readlane_b32 s31, v19, 16
    v_readlane_b32 s32, v19, 32
    v_readlane_b32 s34, v19, 48
    s_max_u32 s33, s33, s31
    s_max_u32 s32, s32, s34
    s_max_u32 s33, s33, s32
    s_andn2_b32 s31, 0x7ff, s33
    s_lshl_b32 s48, s31, 11
    buffer_load_dwordx2 v[150:151], v16, s[8:11], s48 offen
    s_mov_b64 exec, 1
    ds_add_u32 v0, v255 offset:42840
    s_mov_b64 exec, -1
    v_cmp_eq_u32 s[52:53], s33, v25
    v_cmp_eq_u32 s[54:55], s33, v29
    v_cmp_eq_u32 s[56:57], s33, v33
    v_cmp_eq_u32 vcc, s33, v18
    v_cndmask_b32 v19, v20, v24, s[52:53]
    v_cndmask_b32 v19, v19, v28, s[54:55]
    v_cndmask_b32 v19, v19, v32, s[56:57]
    s_ff1_i32_b64 s32, vcc
    v_readlane_b32 s34, v19, s32
    v_mov_b32 v19, s33
    s_nop 0
    v_mov_b32 v18, s34
    ds_write_b64 v0, v[18:19] offset:41552
    s_lshl_b32 s52, s34, 16
    s_and_b32 s32, s34, 0xffff0000
    v_rcp_f32 v148, s32
    s_waitcnt vmcnt(0)
    v_lshlrev_b32 v20, 16, v150
    v_and_b32 v21, 0xffff0000, v150
    v_lshlrev_b32 v22, 16, v151
    v_and_b32 v23, 0xffff0000, v151
    v_pk_add_f32 v[20:21], v[20:21], s[52:53] op_sel_hi:[1,0] neg_lo:[0,1] neg_hi:[0,1]
    v_pk_add_f32 v[22:23], v[22:23], s[52:53] op_sel_hi:[1,0] neg_lo:[0,1] neg_hi:[0,1]
    v_cvt_pk_bf16_f32 v150, v20, v21
    v_cvt_pk_bf16_f32 v151, v22, v23
    v_lshlrev_b32 v20, 16, v150
    v_and_b32 v21, 0xffff0000, v150
    v_lshlrev_b32 v22, 16, v151
    v_and_b32 v23, 0xffff0000, v151
    v_pk_mul_f32 v[20:21], v[20:21], v[148:149] op_sel_hi:[1,0]
    v_pk_mul_f32 v[22:23], v[22:23], v[148:149] op_sel_hi:[1,0]
    v_cvt_pk_bf16_f32 v150, v20, v21
    v_cvt_pk_bf16_f32 v151, v22, v23
    ds_write_b64 v15, v[150:151] offset:41600
    s_mov_b64 exec, 1
    ds_add_u32 v0, v255 offset:42844
    s_mov_b64 exec, -1
    s_cmp_eq_u32 s66, 0
    s_cbranch_scc1 L_idle
L_sync15:
    ds_read_b32 v1, v0 offset:42868
    s_waitcnt lgkmcnt(0)
    v_readfirstlane_b32 s31, v1
    s_nop 0
    s_cmp_ge_u32 s31, 1
    s_cbranch_scc0 L_sync15
    ds_read_b64_tr_b16 v[36:37], v9 offset:0
    ds_read_b64_tr_b16 v[38:39], v9 offset:1024
    ds_read_b64_tr_b16 v[40:41], v10 offset:0
    ds_read_b64_tr_b16 v[42:43], v10 offset:1024
    ds_read_b64_tr_b16 v[44:45], v9 offset:32768
    ds_read_b64_tr_b16 v[46:47], v9 offset:33792
    ds_read_b64_tr_b16 v[48:49], v10 offset:32768
    ds_read_b64_tr_b16 v[50:51], v10 offset:33792
    ds_read_b64_tr_b16 v[52:53], v9 offset:8192
    ds_read_b64_tr_b16 v[54:55], v9 offset:9216
    ds_read_b64_tr_b16 v[56:57], v10 offset:8192
    ds_read_b64_tr_b16 v[58:59], v10 offset:9216
    ds_read_b64_tr_b16 v[60:61], v9 offset:40960
    ds_read_b64_tr_b16 v[62:63], v9 offset:41984
    s_waitcnt lgkmcnt(12)
    ds_read_b64_tr_b16 v[64:65], v10 offset:40960
    ds_read_b64_tr_b16 v[66:67], v10 offset:41984
    s_waitcnt lgkmcnt(12)
    ds_read_b64_tr_b16 v[68:69], v9 offset:16384
    ds_read_b64_tr_b16 v[70:71], v9 offset:17408
    s_waitcnt lgkmcnt(12)
    ds_read_b64_tr_b16 v[72:73], v10 offset:16384
    ds_read_b64_tr_b16 v[74:75], v10 offset:17408
    s_waitcnt lgkmcnt(12)
    ds_read_b64_tr_b16 v[76:77], v9 offset:49152
    ds_read_b64_tr_b16 v[78:79], v9 offset:50176
    s_waitcnt lgkmcnt(12)
    ds_read_b64_tr_b16 v[80:81], v10 offset:49152
    ds_read_b64_tr_b16 v[82:83], v10 offset:50176
    s_waitcnt lgkmcnt(8)
    ds_read_b128 v[20:23], v8 offset:41600
    ds_read_b128 v[24:27], v8 offset:41664
    ds_read_b128 v[28:31], v8 offset:41728
    ds_read_b128 v[32:35], v8 offset:41792
L_xs_ok:
    s_waitcnt lgkmcnt(3)
    v_mfma_f32_16x16x32_bf16 v[132:135], v[20:23], v[36:39], 0
    v_mfma_f32_16x16x32_bf16 v[136:139], v[20:23], v[40:43], 0
    v_mfma_f32_16x16x32_bf16 v[140:143], v[20:23], v[44:47], 0
    v_mfma_f32_16x16x32_bf16 v[144:147], v[20:23], v[48:51], 0
    s_waitcnt lgkmcnt(2)
    v_mfma_f32_16x16x32_bf16 v[132:135], v[24:27], v[52:55], v[132:135]
    v_mfma_f32_16x16x32_bf16 v[136:139], v[24:27], v[56:59], v[136:139]
    v_mfma_f32_16x16x32_bf16 v[140:143], v[24:27], v[60:63], v[140:143]
    v_mfma_f32_16x16x32_bf16 v[144:147], v[24:27], v[64:67], v[144:147]
    s_waitcnt lgkmcnt(1)
    v_mfma_f32_16x16x32_bf16 v[132:135], v[28:31], v[68:71], v[132:135]
    v_mfma_f32_16x16x32_bf16 v[136:139], v[28:31], v[72:75], v[136:139]
    v_mfma_f32_16x16x32_bf16 v[140:143], v[28:31], v[76:79], v[140:143]
    v_mfma_f32_16x16x32_bf16 v[144:147], v[28:31], v[80:83], v[144:147]
    s_cmp_lg_u32 s30, 0
    s_cbranch_scc1 L_k3_wait
    s_waitcnt vmcnt(0)
    s_mov_b64 exec, 1
    ds_add_u32 v0, v255 offset:42868
    s_mov_b64 exec, -1
L_k3_wait:
    s_branch L_sync16a
L_sync16:
    s_waitcnt lgkmcnt(0)
L_sync16a:
    ds_read_b32 v1, v0 offset:42868
    ds_read_b64_tr_b16 v[84:85], v9 offset:24576
    ds_read_b64_tr_b16 v[86:87], v9 offset:25600
    ds_read_b64_tr_b16 v[88:89], v10 offset:24576
    ds_read_b64_tr_b16 v[90:91], v10 offset:25600
    ds_read_b64_tr_b16 v[92:93], v9 offset:57344
    ds_read_b64_tr_b16 v[94:95], v9 offset:58368
    ds_read_b64_tr_b16 v[96:97], v10 offset:57344
    ds_read_b64_tr_b16 v[98:99], v10 offset:58368
    s_waitcnt lgkmcnt(8)
    v_readfirstlane_b32 s31, v1
    s_nop 0
    s_cmp_ge_u32 s31, 3
    s_cbranch_scc0 L_sync16
    v_readfirstlane_b32 s33, v19
    v_readfirstlane_b32 s34, v18
    s_waitcnt lgkmcnt(6)
    v_mfma_f32_16x16x32_bf16 v[132:135], v[32:35], v[84:87], v[132:135]
    s_waitcnt lgkmcnt(4)
    v_mfma_f32_16x16x32_bf16 v[136:139], v[32:35], v[88:91], v[136:139]
    s_waitcnt lgkmcnt(2)
    v_mfma_f32_16x16x32_bf16 v[140:143], v[32:35], v[92:95], v[140:143]
    s_waitcnt lgkmcnt(0)
    v_mfma_f32_16x16x32_bf16 v[144:147], v[32:35], v[96:99], v[144:147]
    s_mov_b32 vcc_lo, 0xffff0000
    s_mov_b32 vcc_hi, 0
    s_lshl_b32 s31, s50, 12
    s_lshl_b32 s32, s30, 7
    s_add_u32 s31, s31, s32
    s_add_u32 s31, s31, 262144
    v_lshrrev_b32 v15, 3, v2
    v_lshlrev_b32 v15, 9, v15
    v_add3_u32 v15, v15, v7, s31
    v_cndmask_b32 v26, v132, v136, vcc
    v_cndmask_b32 v27, v140, v144, vcc
    v_and_or_b32 v26, v26, s49, v14
    v_and_or_b32 v27, v27, s49, v14
    s_mov_b32 exec_hi, 0
    buffer_store_dwordx2 v[26:27], v13, s[12:15], 0 offen sc1
    s_mov_b64 exec, -1
    s_sub_u32 s31, s30, 1
    s_cmp_lt_u32 s31, 2
    s_cbranch_scc1 L_d_rest
    buffer_load_dwordx4 v[100:103], v6, s[24:27], 0 offen offset:0 nt
    buffer_load_dwordx4 v[104:107], v6, s[24:27], 0 offen offset:2048 nt
    buffer_load_dwordx4 v[108:111], v6, s[24:27], s60 offen offset:0 nt
    buffer_load_dwordx4 v[112:115], v6, s[24:27], s60 offen offset:2048 nt
    buffer_load_dwordx4 v[116:119], v6, s[24:27], s61 offen offset:0 nt
    buffer_load_dwordx4 v[120:123], v6, s[24:27], s61 offen offset:2048 nt
    buffer_load_dwordx4 v[124:127], v6, s[24:27], s62 offen offset:0 nt
    buffer_load_dwordx4 v[128:131], v6, s[24:27], s62 offen offset:2048 nt
L_d_rest:
    s_mov_b64 exec, 1
    ds_add_u32 v0, v255 offset:42848
    s_mov_b64 exec, -1
    s_cmp_eq_u32 s30, 1
    s_cselect_b32 s31, s2, 0
    s_cmp_lt_u32 s31, 192
    s_cbranch_scc1 L_no_hint
    s_and_b32 s31, s2, 31
    s_lshl_b32 s31, s31, 7
    s_add_u32 s31, s31, 12288
    v_mov_b32 v250, s28
    v_mov_b32 v251, s29
    s_mov_b64 exec, 1
    buffer_store_dwordx2 v[250:251], v0, s[12:15], s31 offen sc1
    s_mov_b64 exec, -1
L_no_hint:
    s_mov_b32 s52, 0x05040100
    s_mov_b32 s53, 0x07060302
    v_mov_b32 v36, 0
    v_mov_b32 v37, 0
    v_mov_b32 v38, 0
    v_mov_b32 v39, 0
    v_mov_b32 v40, 0
    v_mov_b32 v41, 0
    v_mov_b32 v42, 0
    v_mov_b32 v43, 0
    v_and_b32 v16, 7, v2
    v_lshlrev_b32 v16, 2, v16
    v_lshrrev_b32 v17, 5, v2
    v_lshl_add_u32 v16, v17, 1, v16
    s_lshl_b32 s31, s30, 5
    v_add_u32 v16, s31, v16
    v_lshrrev_b32 v17, 3, v2
    v_lshlrev_b32 v17, 4, v17
    s_lshl_b32 s31, s50, 12
    s_lshl_b32 s32, s51, 8
    s_add_u32 s31, s31, s32
    s_add_u32 s31, s31, 524288
    v_lshlrev_b32 v18, 1, v7
    v_lshrrev_b32 v19, 4, v2
    v_lshl_add_u32 v18, v19, 3, v18
    v_add_u32 v18, s31, v18
    s_waitcnt vmcnt(6)
    v_perm_b32 v98, v104, v100, s52
    v_perm_b32 v104, v104, v100, s53
    v_perm_b32 v100, v105, v101, s52
    v_perm_b32 v105, v105, v101, s53
    v_perm_b32 v101, v106, v102, s52
    v_perm_b32 v106, v106, v102, s53
    v_perm_b32 v102, v107, v103, s52
    v_perm_b32 v107, v107, v103, s53
    s_waitcnt vmcnt(4)
    v_perm_b32 v103, v112, v108, s52
    v_perm_b32 v112, v112, v108, s53
    v_perm_b32 v108, v113, v109, s52
    v_perm_b32 v113, v113, v109, s53
    v_perm_b32 v109, v114, v110, s52
    v_perm_b32 v114, v114, v110, s53
    v_perm_b32 v110, v115, v111, s52
    v_perm_b32 v115, v115, v111, s53
    s_waitcnt vmcnt(2)
    v_perm_b32 v111, v120, v116, s52
    v_perm_b32 v120, v120, v116, s53
    v_perm_b32 v116, v121, v117, s52
    v_perm_b32 v121, v121, v117, s53
    v_perm_b32 v117, v122, v118, s52
    v_perm_b32 v122, v122, v118, s53
    v_perm_b32 v118, v123, v119, s52
    v_perm_b32 v123, v123, v119, s53
    s_waitcnt vmcnt(0)
    v_perm_b32 v119, v128, v124, s52
    v_perm_b32 v128, v128, v124, s53
    v_perm_b32 v124, v129, v125, s52
    v_perm_b32 v129, v129, v125, s53
    v_perm_b32 v125, v130, v126, s52
    v_perm_b32 v130, v130, v126, s53
    v_perm_b32 v126, v131, v127, s52
    v_perm_b32 v131, v131, v127, s53
    s_mov_b32 s54, 0
L_hp_poll:
    buffer_load_dwordx4 v[20:23], v15, s[12:15], 0 offen sc1
L_hp_wait:
    s_waitcnt vmcnt(0)
    v_xor_b32 v20, v14, v20
    v_xor_b32 v21, v14, v21
    v_xor_b32 v22, v14, v22
    v_xor_b32 v23, v14, v23
    v_or3_b32 v24, v20, v21, v22
    v_or_b32 v24, v24, v23
    v_and_b32 v24, 0xff, v24
    v_cmp_ne_u32 vcc, 0, v24
    v_permlane16_swap_b32 v20, v21
    v_permlane16_swap_b32 v22, v23
    s_cbranch_vccz L_hp_got
    s_cmp_eq_u32 s35, 0
    s_cbranch_scc1 L_hp_got
    s_sub_u32 s35, s35, 1
    s_branch L_hp_poll
L_hp_got:
    v_add_f32 v20, v20, v21
    v_add_f32 v22, v22, v23
    s_nop 1
    v_permlane32_swap_b32 v20, v22
    v_add_f32 v20, v20, v22
    s_nop 1
    v_add_f32_dpp v21, v20, v20 row_ror:8 row_mask:0xf bank_mask:0xf
    v_add_f32_dpp v20, v20, v20 row_ror:8 row_mask:0xf bank_mask:0xf
    s_nop 1
    v_permlane16_swap_b32 v20, v21
    v_cvt_pk_bf16_f32 v20, v20, v21
    v_and_b32 v21, 0xffff0000, v20
    v_lshlrev_b32 v20, 16, v20
    v_mul_f32 v22, 0xbfb8aa3b, v20
    v_exp_f32 v22, v22
    s_nop 0
    v_add_f32 v22, 1.0, v22
    v_rcp_f32 v22, v22
    s_nop 0
    v_mul_f32 v20, v20, v22
    v_cvt_pk_bf16_f32 v20, v20, v20
    v_lshlrev_b32 v20, 16, v20
    v_mul_f32 v20, v20, v21
    v_cvt_pk_bf16_f32 v20, v20, v20
    ds_write_b16 v16, v20 offset:42368
    s_mov_b64 exec, 1
    ds_add_u32 v0, v255 offset:42852
    s_mov_b64 exec, -1
L_sync17:
    ds_read_b32 v1, v0 offset:42852
    ds_read_b128 v[28:31], v17 offset:42368
    s_waitcnt lgkmcnt(1)
    v_readfirstlane_b32 s31, v1
    s_nop 0
    s_cmp_ge_u32 s31, 4
    s_cbranch_scc0 L_sync17
    s_waitcnt lgkmcnt(0)
    v_dot2c_f32_bf16 v36, v28, v98
    v_dot2c_f32_bf16 v37, v28, v104
    v_dot2c_f32_bf16 v38, v28, v100
    v_dot2c_f32_bf16 v39, v28, v105
    v_dot2c_f32_bf16 v40, v28, v101
    v_dot2c_f32_bf16 v41, v28, v106
    v_dot2c_f32_bf16 v42, v28, v102
    v_dot2c_f32_bf16 v43, v28, v107
    v_dot2c_f32_bf16 v36, v29, v103
    v_dot2c_f32_bf16 v37, v29, v112
    v_dot2c_f32_bf16 v38, v29, v108
    v_dot2c_f32_bf16 v39, v29, v113
    v_dot2c_f32_bf16 v40, v29, v109
    v_dot2c_f32_bf16 v41, v29, v114
    v_dot2c_f32_bf16 v42, v29, v110
    v_dot2c_f32_bf16 v43, v29, v115
    v_dot2c_f32_bf16 v36, v30, v111
    v_dot2c_f32_bf16 v37, v30, v120
    v_dot2c_f32_bf16 v38, v30, v116
    v_dot2c_f32_bf16 v39, v30, v121
    v_dot2c_f32_bf16 v40, v30, v117
    v_dot2c_f32_bf16 v41, v30, v122
    v_dot2c_f32_bf16 v42, v30, v118
    v_dot2c_f32_bf16 v43, v30, v123
    v_dot2c_f32_bf16 v36, v31, v119
    v_dot2c_f32_bf16 v37, v31, v128
    v_dot2c_f32_bf16 v38, v31, v124
    v_dot2c_f32_bf16 v39, v31, v129
    v_dot2c_f32_bf16 v40, v31, v125
    v_dot2c_f32_bf16 v41, v31, v130
    v_dot2c_f32_bf16 v42, v31, v126
    v_dot2c_f32_bf16 v43, v31, v131
    v_permlane32_swap_b32 v36, v40
    v_permlane32_swap_b32 v37, v41
    v_permlane32_swap_b32 v38, v42
    v_permlane32_swap_b32 v39, v43
    v_add_f32 v36, v36, v40
    v_add_f32 v37, v37, v41
    v_add_f32 v38, v38, v42
    v_add_f32 v39, v39, v43
    s_nop 0
    v_permlane16_swap_b32 v36, v38
    v_permlane16_swap_b32 v37, v39
    v_add_f32 v36, v36, v38
    v_add_f32 v37, v37, v39
    s_nop 0
    v_add_f32_dpp v36, v36, v36 row_ror:8 row_mask:0xf bank_mask:0xf
    v_add_f32_dpp v37, v37, v37 row_ror:8 row_mask:0xf bank_mask:0xf
    v_and_or_b32 v36, v36, s49, v14
    v_and_or_b32 v37, v37, s49, v14
    s_mov_b32 exec_lo, 0x00ff00ff
    s_mov_b32 exec_hi, 0x00ff00ff
    buffer_store_dwordx2 v[36:37], v18, s[12:15], 0 offen sc1
    s_mov_b64 exec, 1
    ds_add_u32 v0, v255 offset:42856
    s_mov_b64 exec, -1
    s_branch L_owner
L_idle:
    s_mov_b64 exec, 1
    ds_add_u32 v0, v255 offset:42868
    s_mov_b64 exec, -1
    s_and_b32 s52, s2, 31
    s_lshl_b32 s52, s52, 7
    s_add_u32 s52, s52, 12288
L_hint:
    s_load_dwordx2 s[54:55], s[12:13], s52 glc
    s_waitcnt lgkmcnt(0)
    s_cmp_eq_u64 s[54:55], s[28:29]
    s_cbranch_scc1 L_hint_ok
    s_cmp_eq_u32 s35, 0
    s_cbranch_scc1 L_hint_ok
    s_sub_u32 s35, s35, 1
    s_sleep 4
    s_branch L_hint
L_hint_ok:
    s_mov_b64 exec, 1
    ds_add_u32 v0, v255 offset:42848
    s_mov_b64 exec, -1
    s_mov_b64 exec, 1
    ds_add_u32 v0, v255 offset:42852
    s_mov_b64 exec, -1
    s_mov_b64 exec, 1
    ds_add_u32 v0, v255 offset:42856
    s_mov_b64 exec, -1
    s_waitcnt lgkmcnt(0)
    v_readfirstlane_b32 s33, v19
    v_readfirstlane_b32 s34, v18
L_owner:
    s_and_b32 s31, s2, 7
    s_sub_u32 s32, 8, s31
    s_min_u32 s46, s31, s32
    s_cmp_gt_u32 s31, 4
    s_cselect_b32 s31, 16, 0
    s_lshr_b32 s47, s2, 4
    s_add_u32 s47, s47, s31
    s_bfe_u32 s53, s2, 0x10003
    s_lshl_b32 s53, s53, 7
    s_add_u32 s53, s53, s31
    s_lshl_b32 s53, s53, 3
    s_add_u32 s53, s53, s46
    s_andn2_b32 s51, 0x7ff, s33
    s_mov_b32 s54, s51
    s_mov_b32 s55, 0
    s_mov_b32 s56, 0
    s_mov_b32 s16, s44
    s_mov_b32 s17, s45
    s_mov_b32 s18, 0x400000
    v_and_b32 v8, 31, v2
    v_lshlrev_b32 v15, 2, v8
    v_lshlrev_b32 v8, 1, v8
    v_mov_b32 v16, 0
L_seg:
    s_xor_b32 s31, s54, s53
    s_and_b32 s31, s31, 0x487
    s_cbranch_scc0 L_seg_own
    s_cmpk_lg_u32 s31, 0x480
    s_cbranch_scc1 L_seg_next
L_seg_own:
    s_lshl_b32 s31, s51, 11
    s_lshl_b32 s32, s47, 6
    s_add_u32 s63, s31, s32
    buffer_load_ushort v9, v8, s[8:11], s63 offen
    v_lshrrev_b32 v4, 3, v2
    s_lshl_b32 s31, s30, 4
    v_add_u32 v4, s31, v4
    v_lshlrev_b32 v4, 12, v4
    s_lshl_b32 s31, s47, 7
    s_add_u32 s31, s31, 524288
    v_add3_u32 v4, v4, v7, s31
    s_mov_b32 s62, 32768
    v_mov_b32 v24, v14
    v_mov_b32 v25, v14
    v_mov_b32 v26, v14
    v_mov_b32 v27, v14
    v_lshrrev_b32 v5, 4, v2
    v_lshl_add_u32 v6, v5, 2, v7
    s_lshl_b32 s31, s30, 7
    s_add_u32 s31, s31, s55
    v_add_u32 v6, s31, v6
    s_ashr_i32 s31, s33, 31
    s_orn2_b32 s31, 0x80000000, s31
    s_xor_b32 s31, s31, s33
    s_and_b32 s31, s31, 0xfffff800
    v_cvt_pk_bf16_f32 v11, s31, s31
    v_lshlrev_b32 v11, 16, v11
    v_mul_f32 v11, 0xbfb8aa3b, v11
    v_exp_f32 v11, v11
    s_and_b32 s32, s34, 0xffff0000
    v_add_f32 v11, 1.0, v11
    v_rcp_f32 v11, v11
    v_rcp_f32 v12, s32
    v_cvt_pk_bf16_f32 v11, v11, v11
    v_lshlrev_b32 v11, 16, v11
    s_lshl_b32 s31, s34, 16
    s_waitcnt vmcnt(0)
    v_lshl_add_u32 v13, v8, 1, s55
    s_mov_b64 vcc, -1
    s_mov_b32 s56, 1
L_y_poll:
    s_mov_b64 exec, vcc
    buffer_load_dwordx4 v[20:23], v4, s[12:15], 0 offen sc1
    s_cmp_eq_u32 s30, 3
    s_cbranch_scc1 L_y_one
    buffer_load_dwordx4 v[24:27], v4, s[12:15], s62 offen sc1
L_y_one:
    s_mov_b64 exec, -1
    s_waitcnt vmcnt(0)
    v_xor_b32 v28, v14, v20
    v_xor_b32 v29, v14, v21
    v_xor_b32 v30, v14, v22
    v_xor_b32 v31, v14, v23
    v_xor_b32 v32, v14, v24
    v_xor_b32 v33, v14, v25
    v_xor_b32 v34, v14, v26
    v_xor_b32 v35, v14, v27
    v_or3_b32 v1, v28, v29, v30
    v_or3_b32 v1, v1, v31, v32
    v_or3_b32 v1, v1, v33, v34
    v_or_b32 v1, v1, v35
    v_and_b32 v1, 0xff, v1
    v_cmp_ne_u32 vcc, 0, v1
    v_pk_add_f32 v[28:29], v[28:29], v[32:33]
    v_pk_add_f32 v[30:31], v[30:31], v[34:35]
    s_cbranch_vccz L_y_got
    s_cmp_eq_u32 s35, 0
    s_cbranch_scc1 L_y_got
    s_sub_u32 s35, s35, 1
    s_branch L_y_poll
L_y_got:
    v_permlane16_swap_b32 v28, v29
    v_permlane16_swap_b32 v30, v31
    v_add_f32 v28, v28, v29
    v_add_f32 v30, v30, v31
    s_nop 1
    v_permlane32_swap_b32 v28, v30
    v_add_f32 v28, v28, v30
    s_nop 1
    v_add_f32_dpp v28, v28, v28 row_ror:8 row_mask:0xf bank_mask:0xf
    ds_write_b32 v6, v28 offset:43008
    s_mov_b64 exec, 1
    ds_add_u32 v16, v255 offset:42836
    s_mov_b64 exec, -1
    s_cmp_lg_u32 s30, 0
    s_cbranch_scc1 L_seg_next
    s_cmp_eq_u32 s47, 0
    s_cselect_b32 s32, 0, 2147483392
    v_mov_b32 v5, 2147483392
    v_writelane_b32 v5, s32, 0
    v_mov_b32 v18, s28
    v_mov_b32 v19, s29
    s_lshl_b32 s31, s34, 16
    v_lshlrev_b32 v9, 16, v9
    v_subrev_f32 v10, s31, v9
    v_cvt_pk_bf16_f32 v10, v10, v10
    v_lshlrev_b32 v10, 16, v10
    v_mul_f32 v10, v10, v12
    v_cvt_pk_bf16_f32 v10, v10, v10
    v_lshlrev_b32 v10, 16, v10
L_sync18:
    ds_read_b32 v1, v16 offset:42836
    ds_read_b32 v20, v13 offset:43008
    ds_read_b32 v21, v13 offset:43136
    ds_read_b32 v22, v13 offset:43264
    ds_read_b32 v23, v13 offset:43392
    ds_read_b32 v24, v15 offset:42496
    s_waitcnt lgkmcnt(5)
    v_readfirstlane_b32 s31, v1
    s_nop 0
    s_cmp_ge_u32 s31, 5
    s_cbranch_scc0 L_sync18
    s_waitcnt lgkmcnt(0)
    v_add_f32 v20, v20, v21
    v_add_f32 v22, v22, v23
    v_add_f32 v20, v20, v22
    v_cvt_pk_bf16_f32 v20, v20, v20
    v_lshlrev_b32 v20, 16, v20
    v_mul_f32 v20, v20, v11
    v_cvt_pk_bf16_f32 v20, v20, v20
    v_lshlrev_b32 v20, 16, v20
    v_add_f32 v20, v20, v10
    v_cvt_pk_bf16_f32 v20, v20, v20
    v_lshlrev_b32 v20, 16, v20
    v_mul_f32 v1, 0xbfb8aa3b, v20
    v_mul_f32 v20, v1, v24
    v_exp_f32 v1, v1
    s_nop 0
    v_add_f32 v1, 1.0, v1
    v_rcp_f32 v1, v1
    s_mov_b32 exec_hi, 0
    v_fma_f32 v20, v20, v1, v9
    v_cvt_pk_bf16_f32 v20, v20, v20
    buffer_store_short v20, v8, s[16:19], s63 offen sc1
    buffer_store_dwordx2 v[18:19], v5, s[12:15], 0 offen sc1
    s_mov_b64 exec, -1
L_seg_next:
    s_cmp_lg_u32 s55, 0
    s_cbranch_scc1 L_seg_end
    s_mov_b32 s55, 512
    s_sub_u32 s54, 0, s51
    s_sub_u32 s47, 31, s47
    v_mov_b32 v16, 28
    v_and_b32 v15, 24, v2
    v_xor_b32 v15, 24, v15
    v_sub_u32 v1, 0, v2
    v_and_b32 v1, 7, v1
    v_add_u32 v15, v15, v1
    v_lshlrev_b32 v15, 2, v15
    v_add_u32 v15, 128, v15
    s_branch L_seg
L_seg_end:
L_fin:
L_exit:
    s_endpgm
L_code_end:
.section .rodata,"a"
.p2align 6
.amdhsa_kernel recurrent_scan__spectral_fnet__moe_arch_mod__prompt_kernel
  .amdhsa_next_free_vgpr 256
  .amdhsa_next_free_sgpr 92
  .amdhsa_accum_offset 256
  .amdhsa_group_segment_fixed_size 0
  .amdhsa_kernarg_size 104
  .amdhsa_user_sgpr_count 2
  .amdhsa_user_sgpr_kernarg_segment_ptr 1
  .amdhsa_system_sgpr_workgroup_id_x 1
  .amdhsa_float_denorm_mode_32 3
.end_amdhsa_kernel
```

```asm
; @launch grid=(256,1,1) block=(512,1,1) lds=158720
.amdgcn_target "amdgcn-amd-amdhsa--gfx950"
.text
.globl recurrent_scan__spectral_fnet__moe_arch_mod__prompt_kernel
.p2align 8
.type recurrent_scan__spectral_fnet__moe_arch_mod__prompt_kernel,@function
recurrent_scan__spectral_fnet__moe_arch_mod__prompt_kernel:
    s_cmp_ge_u32 s2, 256
    s_cbranch_scc1 L_exit
    s_load_dwordx2 s[8:9], s[0:1], 0
    s_load_dwordx4 s[36:39], s[0:1], 48
    s_load_dwordx2 s[12:13], s[0:1], 96
    s_getpc_b64 s[32:33]
L_pc:
    s_bfe_u32 s31, s2, 0x30003
    v_subrev_u32 v3, 496, v0
    v_lshl_add_u32 v3, v3, 3, s31
    v_lshlrev_b32 v3, 7, v3
    v_cmp_gt_u32 vcc, L_code_end-L_pc, v3
    s_nop 0
    s_and_saveexec_b64 s[46:47], vcc
    s_cbranch_execz L_nopf
    global_load_dword v254, v3, s[32:33]
L_nopf:
    s_mov_b64 exec, -1
    v_lshrrev_b32 v1, 6, v0
    v_and_b32 v2, 63, v0
    v_readfirstlane_b32 s30, v1
    s_mov_b32 s10, 0x400000
    s_mov_b32 s11, 0x00020000
    s_mov_b32 s14, 0x10000000
    s_mov_b32 s15, 0x00020000
    s_mov_b32 s35, 65536
    v_lshlrev_b32 v3, 4, v2
    v_mov_b32 v0, 0
    v_mov_b32 v255, 1
    s_mov_b32 s3, s30
    s_and_b32 s30, s30, 3
    s_cmp_ge_u32 s3, 4
    s_cbranch_scc1 L_moe
    s_and_b32 s31, s2, 7
    s_lshr_b32 s32, s2, 4
    s_sub_u32 s32, 15, s32
    s_lshl_b32 s32, s32, 3
    s_add_u32 s46, s32, s31
    s_bfe_u32 s47, s2, 0x10003
    s_lshl_b32 s31, s47, 2
    s_add_u32 s51, s31, s30
    s_lshl_b32 s31, s51, 8
    s_add_u32 s52, s31, s46
    s_xor_b32 s54, s52, 1024
    s_sub_u32 s53, 2048, s52
    s_add_u32 s31, s52, 128
    s_cmp_eq_u32 s46, 0
    s_cselect_b32 s53, s31, s53
    s_cselect_b32 s50, 1, 0
    s_xor_b32 s55, s53, 1024
    s_lshl_b32 s56, s52, 11
    s_lshl_b32 s57, s53, 11
    s_lshl_b32 s58, s54, 11
    s_lshl_b32 s59, s55, 11
    s_mov_b32 s22, 2048
    s_mov_b32 s23, 0x00020000
    v_mov_b32 v1, 0
    v_and_b32 v6, 15, v2
    v_lshlrev_b32 v6, 2, v6
    ds_write_b64 v0, v[0:1] offset:41504
    ds_write_b32 v6, v0 offset:42816
    s_waitcnt lgkmcnt(0)
    s_load_dwordx2 s[28:29], s[12:13], 0
    s_load_dwordx2 s[16:17], s[0:1], 80
    buffer_load_dwordx4 v[120:123], v3, s[8:11], s56 offen
    buffer_load_dwordx4 v[124:127], v3, s[8:11], s56 offen offset:1024
    buffer_load_dwordx4 v[128:131], v3, s[8:11], s57 offen
    buffer_load_dwordx4 v[132:135], v3, s[8:11], s57 offen offset:1024
    s_mov_b32 s20, s36
    s_mov_b32 s21, s37
    buffer_load_dwordx4 v[152:155], v3, s[20:23], 0 offen
    buffer_load_dwordx4 v[156:159], v3, s[20:23], 0 offen offset:1024
    buffer_load_dwordx4 v[136:139], v3, s[8:11], s58 offen
    buffer_load_dwordx4 v[140:143], v3, s[8:11], s58 offen offset:1024
    buffer_load_dwordx4 v[144:147], v3, s[8:11], s59 offen
    buffer_load_dwordx4 v[148:151], v3, s[8:11], s59 offen offset:1024
    s_barrier
    s_branch L_dft_rest
L_moe:
    s_load_dwordx2 s[20:21], s[0:1], 64
    s_and_b32 s32, s2, 7
    s_mul_i32 s32, s32, 28
    s_lshr_b32 s31, s2, 3
    s_add_u32 s31, s31, s32
    s_lshr_b32 s46, s31, 3
    s_lshl_b32 s46, s46, 1
    s_and_b32 s47, s31, 7
    s_mov_b32 s75, 0
    s_mov_b32 s18, 7340032
    s_mov_b32 s19, 0x00020000
    s_mov_b32 s22, 7340032
    s_mov_b32 s23, 0x00020000
    s_mov_b32 s26, 7340032
    s_mov_b32 s27, 0x00020000
    v_lshrrev_b32 v4, 4, v2
    v_lshlrev_b32 v5, 5, v4
    v_and_b32 v6, 0x70, v3
    v_xor_b32 v5, v5, v6
    v_mul_u32_u24 v4, 7168, v4
    s_mul_i32 s31, s47, 917504
    s_lshl_b32 s32, s46, 7
    s_add_u32 s31, s31, s32
    v_add3_u32 v4, v4, v5, s31
    s_cmp_eq_u32 s75, 0
    s_mov_b32 s31, 917504
    s_cselect_b32 s31, 128, s31
    v_add_u32 v6, s31, v4
    s_mov_b32 vcc_lo, 0xff00ff00
    s_mov_b32 vcc_hi, 0xff00ff00
    v_cndmask_b32 v5, v6, v4, vcc
    v_cndmask_b32 v4, v4, v6, vcc
    s_mov_b32 s48, 0
    s_mov_b32 s49, 76800
    s_waitcnt lgkmcnt(0)
    s_mov_b32 s16, s38
    s_mov_b32 s17, s39
    s_load_dwordx2 s[28:29], s[12:13], 0
    s_load_dwordx2 s[24:25], s[0:1], 72
    s_load_dwordx2 s[44:45], s[0:1], 80
    s_barrier
    s_cmp_ge_u32 s2, 224
    s_cselect_b32 s66, 0, 1
    s_cbranch_scc1 L_dma_done
    s_cmp_lg_u32 s30, 0
    s_cbranch_scc1 L_dma_done
    s_setprio 3
L_dma:
    s_mov_b32 m0, s49
    s_waitcnt vmcnt(22)
    buffer_load_dwordx4 v4, s[16:19], s48 offen nt lds
    s_add_u32 m0, s49, 32768
    s_add_u32 s49, s49, 1024
    buffer_load_dwordx4 v4, s[20:23], s48 offen nt lds
    s_add_u32 s48, s48, 28672
    s_mov_b32 m0, s49
    s_waitcnt vmcnt(22)
    buffer_load_dwordx4 v4, s[16:19], s48 offen nt lds
    s_add_u32 m0, s49, 32768
    s_add_u32 s49, s49, 1024
    buffer_load_dwordx4 v4, s[20:23], s48 offen nt lds
    s_add_u32 s48, s48, 28672
    s_mov_b32 m0, s49
    s_waitcnt vmcnt(22)
    buffer_load_dwordx4 v5, s[16:19], s48 offen nt lds
    s_add_u32 m0, s49, 32768
    s_add_u32 s49, s49, 1024
    buffer_load_dwordx4 v5, s[20:23], s48 offen nt lds
    s_add_u32 s48, s48, 28672
    s_mov_b32 m0, s49
    s_waitcnt vmcnt(22)
    buffer_load_dwordx4 v5, s[16:19], s48 offen nt lds
    s_add_u32 m0, s49, 32768
    s_add_u32 s49, s49, 1024
    buffer_load_dwordx4 v5, s[20:23], s48 offen nt lds
    s_add_u32 s48, s48, 28672
    s_cmp_lt_u32 s48, 917504
    s_cbranch_scc1 L_dma
    s_branch L_dma_done
L_dft_rest:
    s_mov_b32 s18, 0x400000
    s_mov_b32 s19, 0x00020000
    s_sub_u32 s31, 2047, s52
    s_sub_u32 s32, 2047, s53
    v_mov_b32 v200, s31
    v_writelane_b32 v200, s32, 63
    s_lshl_b32 s31, s30, 2
    v_mov_b32 v201, s31
    s_bfe_u32 s31, s53, 0x20008
    s_lshl_b32 s31, s31, 2
    s_add_u32 s31, s31, 16
    v_writelane_b32 v201, s31, 63
    v_and_b32 v6, 32, v2
    s_lshl_b32 s31, s51, 2
    v_add_u32 v203, s31, v6
    v_lshrrev_b32 v202, 1, v203
    s_lshl_b32 s31, s2, 4
    s_add_u32 s31, s31, 4096
    v_mov_b32 v4, s31
    v_lshlrev_b32 v5, 3, v2
    s_and_b32 s31, s52, 7
    s_lshl_b32 s31, s31, 11
    s_and_b32 s32, s52, 1024
    s_add_u32 s31, s31, s32
    s_and_b32 s32, s52, 0xf8
    s_lshl_b32 s32, s32, 2
    s_add_u32 s31, s31, s32
    s_add_u32 s31, s31, 32768
    v_writelane_b32 v4, s31, 0
    s_add_u32 s31, s31, 16
    v_writelane_b32 v4, s31, 1
    s_and_b32 s31, s53, 7
    s_lshl_b32 s31, s31, 11
    s_and_b32 s32, s53, 1024
    s_add_u32 s31, s31, s32
    s_and_b32 s32, s53, 0xf8
    s_lshl_b32 s32, s32, 2
    s_add_u32 s31, s31, s32
    s_add_u32 s31, s31, 32768
    v_writelane_b32 v4, s31, 2
    s_add_u32 s31, s31, 16
    v_writelane_b32 v4, s31, 3
    s_mul_i32 s31, s51, 2592
    v_and_b32 v204, 32, v2
    v_lshlrev_b32 v204, 2, v204
    v_add3_u32 v204, v204, v3, s31
    s_lshl_b32 s32, s31, 1
    s_add_u32 s32, s32, 21872
    v_sub_u32 v205, s32, v204
    v_bfe_u32 v206, v2, 2, 2
    v_mul_u32_u24 v206, 2592, v206
    v_lshrrev_b32 v6, 4, v2
    v_mul_u32_u24 v7, 640, v6
    v_add_u32 v206, v206, v7
    v_and_b32 v7, 3, v2
    v_lshlrev_b32 v7, 3, v7
    s_lshl_b32 s31, s30, 7
    v_add3_u32 v206, v206, v7, s31
    v_lshlrev_b32 v6, 12, v6
    v_and_b32 v7, 15, v2
    v_lshl_add_u32 v6, v7, 4, v6
    s_lshl_b32 s31, s30, 8
    v_add_u32 v207, s31, v6
    v_bfe_i32 v208, v2, 4, 1
    v_and_b32 v208, 0x80008000, v208
    s_cmp_eq_u32 s47, 0
    s_movk_i32 s48, 0x7403
    s_cselect_b32 s48, 0x7721, s48
    v_and_b32 v250, 12, v2
    v_bfe_u32 v250, s48, v250, 4
    v_lshrrev_b32 v251, 4, v2
    v_bfe_u32 v252, v2, 1, 1
    v_mul_u32_u24 v251, v251, v252
    v_and_b32 v252, 1, v2
    v_add_u32 v251, v251, v252
    v_cvt_f32_u32 v250, v250
    v_cvt_f32_u32 v251, v251
    v_mul_f32 v250, 0x3e000000, v250
    v_mul_f32 v251, 0x3e800000, v251
    v_cos_f32 v8, v251
    v_add_f32 v251, v251, v250
    v_cos_f32 v9, v251
    v_add_f32 v251, v251, v250
    v_cos_f32 v10, v251
    v_add_f32 v251, v251, v250
    v_cos_f32 v11, v251
    v_add_f32 v251, v251, v250
    v_cos_f32 v12, v251
    v_add_f32 v251, v251, v250
    v_cos_f32 v13, v251
    v_add_f32 v251, v251, v250
    v_cos_f32 v14, v251
    v_add_f32 v251, v251, v250
    v_cos_f32 v15, v251
    v_mul_f32 v8, 0xbf317218, v8
    v_mul_f32 v9, 0xbf317218, v9
    v_mul_f32 v10, 0xbf317218, v10
    v_mul_f32 v11, 0xbf317218, v11
    v_mul_f32 v12, 0xbf317218, v12
    v_mul_f32 v13, 0xbf317218, v13
    v_mul_f32 v14, 0xbf317218, v14
    v_mul_f32 v15, 0xbf317218, v15
    v_lshrrev_b32 v250, 2, v2
    v_and_b32 v250, 12, v250
    v_and_b32 v251, 15, v2
    v_lshlrev_b32 v251, 2, v251
    v_cvt_f32_u32 v250, v250
    v_cvt_f32_u32 v251, v251
    v_mul_f32 v212, 0x3c800000, v250
    s_lshl_b32 s31, s30, 2
    s_lshr_b32 s48, s48, s31
    s_and_b32 s48, s48, 15
    s_sub_u32 s31, s48, 4
    s_mul_i32 s31, s31, s46
    v_cvt_f32_i32 v252, s31
    v_mul_f32 v252, 0x3a000000, v252
    v_add_f32 v213, 0x3c800000, v212
    v_add_f32 v214, 0x3d000000, v212
    v_add_f32 v215, 0x3d400000, v212
    s_and_b32 s31, s2, 7
    s_sub_u32 s32, 8, s31
    s_min_u32 s76, s31, s32
    s_cmp_gt_u32 s31, 4
    s_cselect_b32 s31, 16, 0
    s_lshr_b32 s77, s2, 4
    s_add_u32 s77, s77, s31
    s_bfe_u32 s78, s2, 0x10003
    s_lshl_b32 s78, s78, 7
    s_add_u32 s78, s78, s31
    s_lshl_b32 s31, s30, 5
    s_add_u32 s78, s78, s31
    s_lshl_b32 s78, s78, 3
    s_add_u32 s78, s78, s76
    s_lshl_b32 s77, s77, 6
    s_sub_u32 s79, 1984, s77
    s_lshl_b32 s76, s76, 1
    s_add_u32 s76, s76, 2040
    v_and_b32 v116, 15, v2
    v_lshl_add_u32 v116, v116, 3, s78
    s_mov_b32 vcc_lo, 0
    s_mov_b32 vcc_hi, -1
    v_sub_u32 v7, s76, v116
    v_cndmask_b32 v7, v116, v7, vcc
    s_mov_b32 vcc_lo, 0xffff0000
    s_mov_b32 vcc_hi, 0xffff0000
    v_sub_u32 v6, 0, v7
    v_cndmask_b32 v7, v7, v6, vcc
    v_and_b32 v6, 7, v7
    v_and_b32 v1, 1024, v7
    v_lshl_add_u32 v6, v6, 11, v1
    v_and_b32 v1, 0xf8, v7
    v_lshl_add_u32 v6, v1, 2, v6
    v_bfe_u32 v1, v7, 9, 1
    v_lshl_add_u32 v119, v1, 4, v6
    v_and_b32 v1, 256, v7
    v_cmp_ne_u32 s[88:89], 0, v1
    v_lshrrev_b32 v118, 2, v2
    v_lshl_add_u32 v118, v118, 3, s78
    v_lshlrev_b32 v1, 1, v2
    v_xor_b32 v1, v1, v3
    v_and_b32 v1, 48, v1
    v_sub_u32 v114, s76, v118
    v_sub_u32 v113, 0, v118
    v_and_b32 v113, 2047, v113
    v_sub_u32 v115, 2048, v114
    v_add_u32 v112, s77, v1
    v_lshl_add_u32 v114, v114, 11, v112
    v_lshl_add_u32 v112, v118, 11, v112
    v_xor_b32 v1, 48, v1
    v_add_u32 v1, s79, v1
    v_lshl_add_u32 v113, v113, 11, v1
    v_lshl_add_u32 v115, v115, 11, v1
    s_lshl_b32 s76, s30, 12
    s_add_u32 s76, s76, 142336
    v_and_b32 v1, 15, v2
    v_lshlrev_b32 v6, 6, v1
    v_lshlrev_b32 v1, 3, v2
    v_xor_b32 v1, v1, v2
    v_and_b32 v1, 48, v1
    v_add3_u32 v117, v6, v1, s76
    v_mul_f32 v250, v212, v251
    v_fmamk_f32 v52, v250, 0x3d800000, v252
    v_sin_f32 v20, v250
    v_cos_f32 v250, v250
    v_cos_f32 v48, v52
    v_sin_f32 v52, v52
    v_cvt_pk_f16_f32 v16, v250, v20
    v_cvt_pk_f16_f32 v20, -v20, v250
    v_mul_f32 v250, v213, v251
    v_fmamk_f32 v53, v250, 0x3d800000, v252
    v_sin_f32 v21, v250
    v_cos_f32 v250, v250
    v_cos_f32 v49, v53
    v_sin_f32 v53, v53
    v_cvt_pk_f16_f32 v17, v250, v21
    v_cvt_pk_f16_f32 v21, -v21, v250
    v_mul_f32 v250, v214, v251
    v_fmamk_f32 v54, v250, 0x3d800000, v252
    v_sin_f32 v22, v250
    v_cos_f32 v250, v250
    v_cos_f32 v50, v54
    v_sin_f32 v54, v54
    v_cvt_pk_f16_f32 v18, v250, v22
    v_cvt_pk_f16_f32 v22, -v22, v250
    v_mul_f32 v250, v215, v251
    v_fmamk_f32 v55, v250, 0x3d800000, v252
    v_sin_f32 v23, v250
    v_cos_f32 v250, v250
    v_cos_f32 v51, v55
    v_sin_f32 v55, v55
    v_cvt_pk_f16_f32 v19, v250, v23
    v_cvt_pk_f16_f32 v23, -v23, v250
    v_add_f32 v251, 1.0, v251
    v_mul_f32 v250, v212, v251
    v_fmamk_f32 v60, v250, 0x3d800000, v252
    v_sin_f32 v28, v250
    v_cos_f32 v250, v250
    v_cos_f32 v56, v60
    v_sin_f32 v60, v60
    v_cvt_pk_f16_f32 v24, v250, v28
    v_cvt_pk_f16_f32 v28, -v28, v250
    v_mul_f32 v250, v213, v251
    v_fmamk_f32 v61, v250, 0x3d800000, v252
    v_sin_f32 v29, v250
    v_cos_f32 v250, v250
    v_cos_f32 v57, v61
    v_sin_f32 v61, v61
    v_cvt_pk_f16_f32 v25, v250, v29
    v_cvt_pk_f16_f32 v29, -v29, v250
    v_mul_f32 v250, v214, v251
    v_fmamk_f32 v62, v250, 0x3d800000, v252
    v_sin_f32 v30, v250
    v_cos_f32 v250, v250
    v_cos_f32 v58, v62
    v_sin_f32 v62, v62
    v_cvt_pk_f16_f32 v26, v250, v30
    v_cvt_pk_f16_f32 v30, -v30, v250
    v_mul_f32 v250, v215, v251
    v_fmamk_f32 v63, v250, 0x3d800000, v252
    v_sin_f32 v31, v250
    v_cos_f32 v250, v250
    v_cos_f32 v59, v63
    v_sin_f32 v63, v63
    v_cvt_pk_f16_f32 v27, v250, v31
    v_cvt_pk_f16_f32 v31, -v31, v250
    v_add_f32 v251, 1.0, v251
    v_mov_b32 v160, 0
    v_mov_b32 v161, 0
    v_mov_b32 v162, 0
    v_mov_b32 v163, 0
    v_mov_b32 v164, 0
    v_mov_b32 v165, 0
    v_mov_b32 v166, 0
    v_mov_b32 v167, 0
    v_mov_b32 v168, 0
    v_mov_b32 v169, 0
    v_mov_b32 v170, 0
    s_mov_b32 s57, 0x3f803f80
    s_mov_b32 s59, 0xffff
    s_brev_b32 s67, 1
    s_mov_b32 s66, 0
    s_brev_b32 s64, 1
    s_brev_b32 s65, 1
    s_cmp_eq_u32 s47, 0
    s_movk_i32 s62, -10368
    s_cselect_b32 s62, 10368, s62
    s_waitcnt lgkmcnt(0)
    s_add_u32 s28, s28, 0x7f4a7c15
    s_addc_u32 s29, s29, 0x9e3779b9
    v_mov_b32 v174, s28
    v_mov_b32 v175, s29
    s_cmp_lt_u32 s2, 224
    s_cbranch_scc1 L_epoch_ok
L_sync1:
    ds_read_b32 v1, v0 offset:42872
    s_waitcnt lgkmcnt(0)
    v_readfirstlane_b32 s31, v1
    s_nop 0
    s_cmp_ge_u32 s31, 4
    s_cbranch_scc0 L_sync1
L_epoch_ok:
    s_setprio 2
    s_waitcnt vmcnt(8)
    v_dot2c_f32_bf16 v160, s57, v120
    v_dot2c_f32_bf16 v164, v120, v120
    v_dot2c_f32_bf16 v160, s57, v121
    v_dot2c_f32_bf16 v164, v121, v121
    v_dot2c_f32_bf16 v160, s57, v122
    v_dot2c_f32_bf16 v164, v122, v122
    v_dot2c_f32_bf16 v160, s57, v123
    v_dot2c_f32_bf16 v164, v123, v123
    v_dot2c_f32_bf16 v160, s57, v124
    v_dot2c_f32_bf16 v164, v124, v124
    v_dot2c_f32_bf16 v160, s57, v125
    v_dot2c_f32_bf16 v164, v125, v125
    v_dot2c_f32_bf16 v160, s57, v126
    v_dot2c_f32_bf16 v164, v126, v126
    v_dot2c_f32_bf16 v160, s57, v127
    v_dot2c_f32_bf16 v164, v127, v127
    s_waitcnt vmcnt(6)
    v_dot2c_f32_bf16 v161, s57, v128
    v_dot2c_f32_bf16 v165, v128, v128
    v_dot2c_f32_bf16 v161, s57, v129
    v_dot2c_f32_bf16 v165, v129, v129
    v_dot2c_f32_bf16 v161, s57, v130
    v_dot2c_f32_bf16 v165, v130, v130
    v_dot2c_f32_bf16 v161, s57, v131
    v_dot2c_f32_bf16 v165, v131, v131
    v_dot2c_f32_bf16 v161, s57, v132
    v_dot2c_f32_bf16 v165, v132, v132
    v_dot2c_f32_bf16 v161, s57, v133
    v_dot2c_f32_bf16 v165, v133, v133
    v_dot2c_f32_bf16 v161, s57, v134
    v_dot2c_f32_bf16 v165, v134, v134
    v_dot2c_f32_bf16 v161, s57, v135
    v_dot2c_f32_bf16 v165, v135, v135
    s_waitcnt vmcnt(4)
    v_dot2c_f32_bf16 v170, s57, v152
    v_dot2c_f32_bf16 v170, s57, v153
    v_dot2c_f32_bf16 v170, s57, v154
    v_dot2c_f32_bf16 v170, s57, v155
    v_dot2c_f32_bf16 v170, s57, v156
    v_dot2c_f32_bf16 v170, s57, v157
    v_dot2c_f32_bf16 v170, s57, v158
    v_dot2c_f32_bf16 v170, s57, v159
    v_dot2c_f32_bf16 v168, v152, v120
    v_dot2c_f32_bf16 v169, v152, v128
    v_dot2c_f32_bf16 v168, v153, v121
    v_dot2c_f32_bf16 v169, v153, v129
    v_dot2c_f32_bf16 v168, v154, v122
    v_dot2c_f32_bf16 v169, v154, v130
    v_dot2c_f32_bf16 v168, v155, v123
    v_dot2c_f32_bf16 v169, v155, v131
    v_mov_b32 v171, v170
    v_dot2c_f32_bf16 v168, v156, v124
    v_dot2c_f32_bf16 v169, v156, v132
    v_dot2c_f32_bf16 v168, v157, v125
    v_dot2c_f32_bf16 v169, v157, v133
    v_dot2c_f32_bf16 v168, v158, v126
    v_dot2c_f32_bf16 v169, v158, v134
    v_dot2c_f32_bf16 v168, v159, v127
    v_dot2c_f32_bf16 v169, v159, v135
    v_permlane32_swap_b32 v160, v161
    v_permlane32_swap_b32 v164, v165
    v_permlane32_swap_b32 v170, v171
    v_permlane32_swap_b32 v168, v169
    v_add_f32 v160, v160, v161
    v_add_f32 v164, v164, v165
    v_add_f32 v170, v170, v171
    v_add_f32 v168, v168, v169
    v_add_f32_dpp v160, v160, v160 row_shr:1 row_mask:0xf bank_mask:0xf
    v_add_f32_dpp v164, v164, v164 row_shr:1 row_mask:0xf bank_mask:0xf
    v_add_f32_dpp v170, v170, v170 row_shr:1 row_mask:0xf bank_mask:0xf
    v_add_f32_dpp v168, v168, v168 row_shr:1 row_mask:0xf bank_mask:0xf
    v_add_f32_dpp v160, v160, v160 row_shr:2 row_mask:0xf bank_mask:0xf
    v_add_f32_dpp v164, v164, v164 row_shr:2 row_mask:0xf bank_mask:0xf
    v_add_f32_dpp v170, v170, v170 row_shr:2 row_mask:0xf bank_mask:0xf
    v_add_f32_dpp v168, v168, v168 row_shr:2 row_mask:0xf bank_mask:0xf
    v_add_f32_dpp v160, v160, v160 row_shr:4 row_mask:0xf bank_mask:0xf
    v_add_f32_dpp v164, v164, v164 row_shr:4 row_mask:0xf bank_mask:0xf
    v_add_f32_dpp v170, v170, v170 row_shr:4 row_mask:0xf bank_mask:0xf
    v_add_f32_dpp v168, v168, v168 row_shr:4 row_mask:0xf bank_mask:0xf
    v_add_f32_dpp v160, v160, v160 row_shr:8 row_mask:0xf bank_mask:0xf
    v_add_f32_dpp v164, v164, v164 row_shr:8 row_mask:0xf bank_mask:0xf
    v_add_f32_dpp v170, v170, v170 row_shr:8 row_mask:0xf bank_mask:0xf
    v_add_f32_dpp v168, v168, v168 row_shr:8 row_mask:0xf bank_mask:0xf
    v_add_f32_dpp v160, v160, v160 row_bcast:15 row_mask:0xa bank_mask:0xf
    v_add_f32_dpp v164, v164, v164 row_bcast:15 row_mask:0xa bank_mask:0xf
    v_add_f32_dpp v170, v170, v170 row_bcast:15 row_mask:0xa bank_mask:0xf
    v_add_f32_dpp v168, v168, v168 row_bcast:15 row_mask:0xa bank_mask:0xf
    v_mul_f32 v160, 0x3a800000, v160
    v_mul_f32 v164, 0x3a800000, v164
    v_fma_f32 v164, -v160, v160, v164
    v_cvt_pk_bf16_f32 v161, -v160, -v160
    v_max_f32 v164, 0, v164
    v_cvt_pk_bf16_f32 v164, v164, v164
    v_and_b32 v164, 0xffff0000, v164
    v_add_f32 v164, 0x3727c5ac, v164
    v_cvt_pk_bf16_f32 v164, v164, v164
    v_and_b32 v164, 0xffff0000, v164
    v_sqrt_f32 v164, v164
    v_and_b32 v165, 0xffff0000, v161
    v_cvt_pk_bf16_f32 v248, v160, v164
    v_and_b32 v164, 0xffff0000, v248
    v_rcp_f32 v164, v164
    v_fmac_f32 v168, v170, v165
    v_mul_f32 v168, v168, v164
    v_ashrrev_i32 v170, 31, v168
    v_or_b32 v170, 0x80000000, v170
    v_xor_b32 v168, v168, v170
    v_and_b32 v168, 0xfffff800, v168
    v_or_b32 v249, v200, v168
    s_mov_b64 exec, s[64:65]
    ds_write_b32 v201, v248 offset:41472
    ds_max_u64 v0, v[248:249] offset:41504
    s_mov_b64 exec, 1
    ds_add_rtn_u32 v1, v0, v255 offset:42816
    s_mov_b64 exec, 31
    ds_read_b64 v[172:173], v5 offset:41472
    s_mov_b64 exec, s[64:65]
    ds_write_b16 v202, v161 offset:41568
    ds_write_b32 v203, v164 offset:42752
    s_mov_b64 exec, -1
    v_mov_b32_dpp v6, v128 wave_rol:1 row_mask:0xf bank_mask:0xf
    v_mov_b32_dpp v7, v132 wave_rol:1 row_mask:0xf bank_mask:0xf
    v_bfi_b32 v221, s59, v131, v130
    v_bfi_b32 v222, s59, v130, v129
    v_bfi_b32 v223, s59, v129, v128
    v_bfi_b32 v217, s59, v135, v134
    v_bfi_b32 v218, s59, v134, v133
    v_bfi_b32 v219, s59, v133, v132
    v_cndmask_b32 v220, v6, v7, s[66:67]
    v_cndmask_b32 v216, v7, v6, s[66:67]
    v_bfi_b32 v220, s59, v220, v131
    v_bfi_b32 v216, s59, v216, v135
    s_waitcnt lgkmcnt(2)
    v_readfirstlane_b32 s31, v1
    s_nop 0
    s_cmp_lg_u32 s31, 3
    s_cbranch_scc1 L_not_last
    s_mov_b64 exec, 31
    buffer_store_dwordx4 v[172:175], v4, s[12:15], 0 offen sc1
    s_mov_b64 exec, -1
    s_waitcnt vmcnt(1)
    s_branch L_b_ready
L_not_last:
    s_waitcnt vmcnt(0)
L_b_ready:
    s_setprio 1
    ds_write_b128 v204, v[120:123] offset:0
    ds_write_b128 v204, v[124:127] offset:1280
    s_cmp_lg_u32 s50, 0
    s_cbranch_scc1 L_plain1
    ds_write_b128 v205, v[216:219]
    ds_write_b128 v205, v[220:223] offset:1280
    s_branch L_second1
L_plain1:
    ds_write_b128 v204, v[128:131] offset:20736
    ds_write_b128 v204, v[132:135] offset:22016
L_second1:
    v_add_u32 v204, s62, v204
    v_add_u32 v205, s62, v205
    v_dot2c_f32_bf16 v162, s57, v136
    v_dot2c_f32_bf16 v166, v136, v136
    v_dot2c_f32_bf16 v162, s57, v137
    v_dot2c_f32_bf16 v166, v137, v137
    v_dot2c_f32_bf16 v162, s57, v138
    v_dot2c_f32_bf16 v166, v138, v138
    v_dot2c_f32_bf16 v162, s57, v139
    v_dot2c_f32_bf16 v166, v139, v139
    v_dot2c_f32_bf16 v162, s57, v140
    v_dot2c_f32_bf16 v166, v140, v140
    v_dot2c_f32_bf16 v162, s57, v141
    v_dot2c_f32_bf16 v166, v141, v141
    v_dot2c_f32_bf16 v162, s57, v142
    v_dot2c_f32_bf16 v166, v142, v142
    v_dot2c_f32_bf16 v162, s57, v143
    v_dot2c_f32_bf16 v166, v143, v143
    ds_write_b128 v204, v[136:139] offset:0
    ds_write_b128 v204, v[140:143] offset:1280
    v_dot2c_f32_bf16 v163, s57, v144
    v_dot2c_f32_bf16 v167, v144, v144
    v_dot2c_f32_bf16 v163, s57, v145
    v_dot2c_f32_bf16 v167, v145, v145
    v_dot2c_f32_bf16 v163, s57, v146
    v_dot2c_f32_bf16 v167, v146, v146
    v_dot2c_f32_bf16 v163, s57, v147
    v_dot2c_f32_bf16 v167, v147, v147
    v_dot2c_f32_bf16 v163, s57, v148
    v_dot2c_f32_bf16 v167, v148, v148
    v_dot2c_f32_bf16 v163, s57, v149
    v_dot2c_f32_bf16 v167, v149, v149
    v_dot2c_f32_bf16 v163, s57, v150
    v_dot2c_f32_bf16 v167, v150, v150
    v_dot2c_f32_bf16 v163, s57, v151
    v_dot2c_f32_bf16 v167, v151, v151
    v_xor_b32 v202, 8, v202
    v_xor_b32 v203, 16, v203
    s_waitcnt lgkmcnt(2)
    v_mov_b32_dpp v6, v144 wave_rol:1 row_mask:0xf bank_mask:0xf
    v_mov_b32_dpp v7, v148 wave_rol:1 row_mask:0xf bank_mask:0xf
    v_bfi_b32 v221, s59, v147, v146
    v_bfi_b32 v222, s59, v146, v145
    v_bfi_b32 v223, s59, v145, v144
    v_bfi_b32 v217, s59, v151, v150
    v_bfi_b32 v218, s59, v150, v149
    v_bfi_b32 v219, s59, v149, v148
    v_cndmask_b32 v220, v6, v7, s[66:67]
    v_cndmask_b32 v216, v7, v6, s[66:67]
    v_bfi_b32 v220, s59, v220, v147
    v_bfi_b32 v216, s59, v216, v151
    s_cmp_lg_u32 s50, 0
    s_cbranch_scc1 L_plain3
    ds_write_b128 v205, v[216:219]
    ds_write_b128 v205, v[220:223] offset:1280
    s_branch L_second3
L_plain3:
    ds_write_b128 v204, v[144:147] offset:20736
    ds_write_b128 v204, v[148:151] offset:22016
L_second3:
    v_permlane32_swap_b32 v162, v163
    v_permlane32_swap_b32 v166, v167
    v_add_f32 v162, v162, v163
    v_add_f32 v166, v166, v167
    s_nop 0
    v_add_f32_dpp v162, v162, v162 row_shr:1 row_mask:0xf bank_mask:0xf
    v_add_f32_dpp v166, v166, v166 row_shr:1 row_mask:0xf bank_mask:0xf
    s_nop 0
    v_add_f32_dpp v162, v162, v162 row_shr:2 row_mask:0xf bank_mask:0xf
    v_add_f32_dpp v166, v166, v166 row_shr:2 row_mask:0xf bank_mask:0xf
    s_nop 0
    v_add_f32_dpp v162, v162, v162 row_shr:4 row_mask:0xf bank_mask:0xf
    v_add_f32_dpp v166, v166, v166 row_shr:4 row_mask:0xf bank_mask:0xf
    s_nop 0
    v_add_f32_dpp v162, v162, v162 row_shr:8 row_mask:0xf bank_mask:0xf
    v_add_f32_dpp v166, v166, v166 row_shr:8 row_mask:0xf bank_mask:0xf
    s_nop 0
    v_add_f32_dpp v162, v162, v162 row_bcast:15 row_mask:0xa bank_mask:0xf
    v_add_f32_dpp v166, v166, v166 row_bcast:15 row_mask:0xa bank_mask:0xf
    v_mul_f32 v162, 0x3a800000, v162
    v_mul_f32 v166, 0x3a800000, v166
    v_fma_f32 v166, -v162, v162, v166
    v_cvt_pk_bf16_f32 v161, -v162, -v162
    v_max_f32 v166, 0, v166
    v_cvt_pk_bf16_f32 v166, v166, v166
    v_and_b32 v166, 0xffff0000, v166
    v_add_f32 v166, 0x3727c5ac, v166
    v_cvt_pk_bf16_f32 v166, v166, v166
    v_and_b32 v166, 0xffff0000, v166
    v_sqrt_f32 v166, v166
    v_and_b32 v167, 0xffff0000, v161
    v_cvt_pk_bf16_f32 v248, v162, v166
    v_and_b32 v166, 0xffff0000, v248
    v_rcp_f32 v166, v166
    s_mov_b64 exec, s[64:65]
    ds_write_b16 v202, v161 offset:41568
    ds_write_b32 v203, v166 offset:42752
    s_mov_b64 exec, 1
    ds_add_u32 v0, v255 offset:42820
    s_mov_b64 exec, -1
L_sync2:
    ds_read_b32 v1, v0 offset:42820
    ds_read_b128 v[176:179], v0 offset:42752
    ds_read_b128 v[180:183], v0 offset:42768
    ds_read_b128 v[184:187], v0 offset:42784
    ds_read_b128 v[188:191], v0 offset:42800
    ds_read_b128 v[192:195], v0 offset:41568
    ds_read_b128 v[196:199], v0 offset:41584
    s_waitcnt lgkmcnt(6)
    v_readfirstlane_b32 s31, v1
    s_nop 0
    s_cmp_ge_u32 s31, 4
    s_cbranch_scc0 L_sync2
    ds_read_b64_tr_b16 v[120:121], v206 offset:0
    ds_read_b64_tr_b16 v[122:123], v206 offset:10368
    ds_read_b64_tr_b16 v[124:125], v206 offset:20736
    ds_read_b64_tr_b16 v[126:127], v206 offset:31104
    ds_read_b64_tr_b16 v[128:129], v206 offset:32
    ds_read_b64_tr_b16 v[130:131], v206 offset:10400
    ds_read_b64_tr_b16 v[132:133], v206 offset:20768
    ds_read_b64_tr_b16 v[134:135], v206 offset:31136
    s_add_u32 m0, s76, 0
    s_nop 0
    buffer_load_dwordx4 v112, s[8:11], 0 offen lds
    s_add_u32 m0, s76, 1024
    s_nop 0
    buffer_load_dwordx4 v113, s[8:11], 0 offen lds
    s_waitcnt lgkmcnt(10)
    ds_read_b64_tr_b16 v[136:137], v206 offset:64
    ds_read_b64_tr_b16 v[138:139], v206 offset:10432
    ds_read_b64_tr_b16 v[140:141], v206 offset:20800
    ds_read_b64_tr_b16 v[142:143], v206 offset:31168
    v_pk_mul_f32 v[176:177], v[176:177], v[8:9]
    v_pk_mul_f32 v[178:179], v[178:179], v[10:11]
    v_pk_mul_f32 v[180:181], v[180:181], v[12:13]
    v_pk_mul_f32 v[182:183], v[182:183], v[14:15]
    v_pk_mul_f32 v[184:185], v[184:185], v[8:9]
    v_pk_mul_f32 v[186:187], v[186:187], v[10:11]
    v_pk_mul_f32 v[188:189], v[188:189], v[12:13]
    v_pk_mul_f32 v[190:191], v[190:191], v[14:15]
    v_cvt_pk_bf16_f32 v160, v176, v177
    v_cvt_pk_bf16_f32 v152, v184, v185
    v_cvt_pk_bf16_f32 v161, v178, v179
    v_cvt_pk_bf16_f32 v153, v186, v187
    v_cvt_pk_bf16_f32 v162, v180, v181
    v_cvt_pk_bf16_f32 v154, v188, v189
    v_cvt_pk_bf16_f32 v163, v182, v183
    v_cvt_pk_bf16_f32 v155, v190, v191
    v_xor_b32 v164, v208, v160
    v_xor_b32 v156, v208, v152
    v_xor_b32 v165, v208, v161
    v_xor_b32 v157, v208, v153
    v_xor_b32 v166, v208, v162
    v_xor_b32 v158, v208, v154
    v_xor_b32 v167, v208, v163
    v_xor_b32 v159, v208, v155
    s_waitcnt lgkmcnt(12)
    s_cmp_lg_u32 s50, 0
    s_cbranch_scc1 L_st1_split
    v_mfma_f32_16x16x32_bf16 v[168:171], v[160:163], v[192:195], 0
    v_mfma_f32_16x16x32_bf16 v[168:171], v[152:155], v[196:199], v[168:171]
    s_waitcnt lgkmcnt(10)
    ds_read_b64_tr_b16 v[144:145], v206 offset:96
    ds_read_b64_tr_b16 v[146:147], v206 offset:10464
    ds_read_b64_tr_b16 v[148:149], v206 offset:20832
    ds_read_b64_tr_b16 v[150:151], v206 offset:31200
    v_mfma_f32_16x16x32_bf16 v[216:219], v[160:163], v[120:123], v[168:171]
    s_waitcnt lgkmcnt(12)
    v_mfma_f32_16x16x32_bf16 v[216:219], v[152:155], v[124:127], v[216:219]
    s_waitcnt lgkmcnt(10)
    v_mfma_f32_16x16x32_bf16 v[224:227], v[160:163], v[128:131], v[168:171]
    s_waitcnt lgkmcnt(8)
    v_mfma_f32_16x16x32_bf16 v[224:227], v[152:155], v[132:135], v[224:227]
    s_waitcnt lgkmcnt(6)
    v_mfma_f32_16x16x32_bf16 v[232:235], v[160:163], v[136:139], v[168:171]
    s_waitcnt lgkmcnt(4)
    v_mfma_f32_16x16x32_bf16 v[232:235], v[152:155], v[140:143], v[232:235]
    s_waitcnt lgkmcnt(2)
    v_mfma_f32_16x16x32_bf16 v[240:243], v[160:163], v[144:147], v[168:171]
    s_waitcnt lgkmcnt(0)
    v_mfma_f32_16x16x32_bf16 v[240:243], v[152:155], v[148:151], v[240:243]
    v_mfma_f32_16x16x32_bf16 v[220:223], v[164:167], v[120:123], 0
    v_mfma_f32_16x16x32_bf16 v[220:223], v[156:159], v[124:127], v[220:223]
    v_mfma_f32_16x16x32_bf16 v[228:231], v[164:167], v[128:131], 0
    v_mfma_f32_16x16x32_bf16 v[228:231], v[156:159], v[132:135], v[228:231]
    v_cvt_pk_f16_f32 v176, v216, v217
    v_cvt_pk_f16_f32 v177, v224, v225
    v_cvt_pk_f16_f32 v178, v232, v233
    s_nop 0
    v_cvt_pk_f16_f32 v179, v240, v241
    ds_write_b128 v207, v[176:179] offset:44032
    v_mfma_f32_16x16x32_bf16 v[236:239], v[164:167], v[136:139], 0
    v_mfma_f32_16x16x32_bf16 v[236:239], v[156:159], v[140:143], v[236:239]
    v_cvt_pk_f16_f32 v180, v218, v219
    v_cvt_pk_f16_f32 v181, v226, v227
    v_cvt_pk_f16_f32 v182, v234, v235
    v_cvt_pk_f16_f32 v183, v242, v243
    ds_write_b128 v207, v[180:183] offset:45056
    v_mfma_f32_16x16x32_bf16 v[244:247], v[164:167], v[144:147], 0
    v_mfma_f32_16x16x32_bf16 v[244:247], v[156:159], v[148:151], v[244:247]
    v_cvt_pk_f16_f32 v184, v220, v221
    v_cvt_pk_f16_f32 v185, v228, v229
    v_cvt_pk_f16_f32 v186, v236, v237
    s_nop 4
    v_cvt_pk_f16_f32 v187, v244, v245
    ds_write_b128 v207, v[184:187] offset:46080
    v_cvt_pk_f16_f32 v188, v222, v223
    v_cvt_pk_f16_f32 v189, v230, v231
    v_cvt_pk_f16_f32 v190, v238, v239
    v_cvt_pk_f16_f32 v191, v246, v247
    ds_write_b128 v207, v[188:191] offset:47104
    s_branch L_st1_done
L_st1_split:
    s_waitcnt lgkmcnt(8)
    ds_read_b64_tr_b16 v[144:145], v206 offset:96
    ds_read_b64_tr_b16 v[146:147], v206 offset:10464
    ds_read_b64_tr_b16 v[148:149], v206 offset:20832
    ds_read_b64_tr_b16 v[150:151], v206 offset:31200
    s_waitcnt lgkmcnt(0)
    v_mfma_f32_16x16x32_bf16 v[168:171], v[160:163], v[192:195], 0
    v_mfma_f32_16x16x32_bf16 v[220:223], v[164:167], v[120:123], 0
    v_mfma_f32_16x16x32_bf16 v[216:219], v[160:163], v[120:123], v[168:171]
    v_mfma_f32_16x16x32_bf16 v[228:231], v[164:167], v[128:131], 0
    v_mfma_f32_16x16x32_bf16 v[224:227], v[160:163], v[128:131], v[168:171]
    v_mfma_f32_16x16x32_bf16 v[236:239], v[164:167], v[136:139], 0
    v_mfma_f32_16x16x32_bf16 v[232:235], v[160:163], v[136:139], v[168:171]
    v_mfma_f32_16x16x32_bf16 v[244:247], v[164:167], v[144:147], 0
    v_mfma_f32_16x16x32_bf16 v[240:243], v[160:163], v[144:147], v[168:171]
    s_nop 1
    v_cvt_pk_f16_f32 v176, v216, v217
    v_cvt_pk_f16_f32 v180, v218, v219
    v_cvt_pk_f16_f32 v184, v220, v221
    v_cvt_pk_f16_f32 v188, v222, v223
    v_cvt_pk_f16_f32 v177, v224, v225
    v_cvt_pk_f16_f32 v181, v226, v227
    v_cvt_pk_f16_f32 v185, v228, v229
    v_cvt_pk_f16_f32 v189, v230, v231
    v_cvt_pk_f16_f32 v178, v232, v233
    v_cvt_pk_f16_f32 v182, v234, v235
    v_cvt_pk_f16_f32 v186, v236, v237
    v_cvt_pk_f16_f32 v190, v238, v239
    v_cvt_pk_f16_f32 v179, v240, v241
    v_cvt_pk_f16_f32 v183, v242, v243
    v_cvt_pk_f16_f32 v187, v244, v245
    v_cvt_pk_f16_f32 v191, v246, v247
    ds_write_b128 v207, v[176:179] offset:44032
    ds_write_b128 v207, v[180:183] offset:45056
    ds_write_b128 v207, v[184:187] offset:46080
    ds_write_b128 v207, v[188:191] offset:47104
    v_mfma_f32_16x16x32_bf16 v[168:171], v[152:155], v[196:199], 0
    v_mfma_f32_16x16x32_bf16 v[220:223], v[156:159], v[124:127], 0
    v_mfma_f32_16x16x32_bf16 v[216:219], v[152:155], v[124:127], v[168:171]
    v_mfma_f32_16x16x32_bf16 v[228:231], v[156:159], v[132:135], 0
    v_mfma_f32_16x16x32_bf16 v[224:227], v[152:155], v[132:135], v[168:171]
    v_mfma_f32_16x16x32_bf16 v[236:239], v[156:159], v[140:143], 0
    v_mfma_f32_16x16x32_bf16 v[232:235], v[152:155], v[140:143], v[168:171]
    v_mfma_f32_16x16x32_bf16 v[244:247], v[156:159], v[148:151], 0
    v_mfma_f32_16x16x32_bf16 v[240:243], v[152:155], v[148:151], v[168:171]
    s_waitcnt lgkmcnt(0)
    s_nop 0
    v_cvt_pk_f16_f32 v176, v216, v217
    v_cvt_pk_f16_f32 v180, v218, v219
    v_cvt_pk_f16_f32 v184, v220, v221
    v_cvt_pk_f16_f32 v188, v222, v223
    v_cvt_pk_f16_f32 v177, v224, v225
    v_cvt_pk_f16_f32 v181, v226, v227
    v_cvt_pk_f16_f32 v185, v228, v229
    v_cvt_pk_f16_f32 v189, v230, v231
    v_cvt_pk_f16_f32 v178, v232, v233
    v_cvt_pk_f16_f32 v182, v234, v235
    v_cvt_pk_f16_f32 v186, v236, v237
    v_cvt_pk_f16_f32 v190, v238, v239
    v_cvt_pk_f16_f32 v179, v240, v241
    v_cvt_pk_f16_f32 v183, v242, v243
    v_cvt_pk_f16_f32 v187, v244, v245
    v_cvt_pk_f16_f32 v191, v246, v247
    ds_write_b128 v207, v[176:179] offset:60416
    ds_write_b128 v207, v[180:183] offset:61440
    ds_write_b128 v207, v[184:187] offset:62464
    ds_write_b128 v207, v[188:191] offset:63488
L_st1_done:
    s_mov_b64 exec, 1
    ds_add_u32 v0, v255 offset:42824
    s_mov_b64 exec, -1
    s_lshl_b32 s31, s30, 12
    v_add_u32 v5, s31, v3
    s_and_b32 s31, s28, 0x30003
    v_mov_b32 v210, s31
    s_mov_b32 s58, 0xfffcfffc
    s_and_b32 s32, s48, 3
    s_cselect_b32 s72, -1, 0xff
    s_cselect_b32 s73, -1, 0
    s_mov_b32 s74, s48
    v_mov_b32 v209, 2147483392
    s_cmp_eq_u32 s48, 7
    s_cbranch_scc1 L_no_consts
    v_mul_f32 v250, v212, v251
    v_fmamk_f32 v68, v250, 0x3d800000, v252
    v_sin_f32 v36, v250
    v_cos_f32 v250, v250
    v_cos_f32 v64, v68
    v_sin_f32 v68, v68
    v_cvt_pk_f16_f32 v32, v250, v36
    v_cvt_pk_f16_f32 v36, -v36, v250
    v_mul_f32 v250, v213, v251
    v_fmamk_f32 v69, v250, 0x3d800000, v252
    v_sin_f32 v37, v250
    v_cos_f32 v250, v250
    v_cos_f32 v65, v69
    v_sin_f32 v69, v69
    v_cvt_pk_f16_f32 v33, v250, v37
    v_cvt_pk_f16_f32 v37, -v37, v250
    v_mul_f32 v250, v214, v251
    v_fmamk_f32 v70, v250, 0x3d800000, v252
    v_sin_f32 v38, v250
    v_cos_f32 v250, v250
    v_cos_f32 v66, v70
    v_sin_f32 v70, v70
    v_cvt_pk_f16_f32 v34, v250, v38
    v_cvt_pk_f16_f32 v38, -v38, v250
    v_mul_f32 v250, v215, v251
    v_fmamk_f32 v71, v250, 0x3d800000, v252
    v_sin_f32 v39, v250
    v_cos_f32 v250, v250
    v_cos_f32 v67, v71
    v_sin_f32 v71, v71
    v_cvt_pk_f16_f32 v35, v250, v39
    v_cvt_pk_f16_f32 v39, -v39, v250
    v_add_f32 v251, 1.0, v251
    v_mul_f32 v250, v212, v251
    v_fmamk_f32 v76, v250, 0x3d800000, v252
    v_sin_f32 v44, v250
    v_cos_f32 v250, v250
    v_cos_f32 v72, v76
    v_sin_f32 v76, v76
    v_cvt_pk_f16_f32 v40, v250, v44
    v_cvt_pk_f16_f32 v44, -v44, v250
    v_mul_f32 v250, v213, v251
    v_fmamk_f32 v77, v250, 0x3d800000, v252
    v_sin_f32 v45, v250
    v_cos_f32 v250, v250
    v_cos_f32 v73, v77
    v_sin_f32 v77, v77
    v_cvt_pk_f16_f32 v41, v250, v45
    v_cvt_pk_f16_f32 v45, -v45, v250
    v_mul_f32 v250, v214, v251
    v_fmamk_f32 v78, v250, 0x3d800000, v252
    v_sin_f32 v46, v250
    v_cos_f32 v250, v250
    v_cos_f32 v74, v78
    v_sin_f32 v78, v78
    v_cvt_pk_f16_f32 v42, v250, v46
    v_cvt_pk_f16_f32 v46, -v46, v250
    v_mul_f32 v250, v215, v251
    v_fmamk_f32 v79, v250, 0x3d800000, v252
    v_sin_f32 v47, v250
    v_cos_f32 v250, v250
    v_cos_f32 v75, v79
    v_sin_f32 v79, v79
    v_cvt_pk_f16_f32 v43, v250, v47
    v_cvt_pk_f16_f32 v47, -v47, v250
    s_and_b32 s31, s46, 1
    s_lshl_b32 s31, s31, 6
    s_lshr_b32 s32, s46, 1
    s_add_u32 s49, s31, s32
    s_bitcmp1_b32 s49, 2
    s_cselect_b64 vcc, -1, 0
    v_cndmask_b32 v80, v16, v20, vcc
    v_cndmask_b32 v84, v20, v16, vcc
    v_cndmask_b32 v81, v17, v21, vcc
    v_cndmask_b32 v85, v21, v17, vcc
    v_cndmask_b32 v82, v18, v22, vcc
    v_cndmask_b32 v86, v22, v18, vcc
    v_cndmask_b32 v83, v19, v23, vcc
    v_cndmask_b32 v87, v23, v19, vcc
    s_bfe_u32 s31, s49, 0x10001
    v_and_b32 v6, 7, v2
    v_xor_b32 v6, s31, v6
    v_lshlrev_b32 v6, 4, v6
    v_lshrrev_b32 v7, 4, v2
    v_lshlrev_b32 v7, 3, v7
    v_bfe_u32 v209, v2, 3, 1
    v_add_u32 v7, v7, v209
    v_mul_u32_u24 v7, 16512, v7
    v_add_u32 v209, v6, v7
    s_mul_i32 s31, s48, 528384
    s_lshl_b32 s32, s49, 7
    s_add_u32 s31, s31, s32
    s_add_u32 s60, s31, 2097152
L_no_consts:
L_st23:
L_sync3:
    ds_read_b32 v1, v0 offset:42824
    ds_read_b128 v[120:123], v5 offset:44032
    ds_read_b128 v[124:127], v5 offset:45056
    ds_read_b128 v[128:131], v5 offset:46080
    ds_read_b128 v[132:135], v5 offset:47104
    s_waitcnt lgkmcnt(4)
    v_readfirstlane_b32 s31, v1
    s_nop 0
    s_cmp_ge_u32 s31, 4
    s_cbranch_scc0 L_sync3
    s_cmp_eq_u32 s48, 7
    s_cbranch_scc1 L_p1_done
    s_add_u32 s61, s60, 33024
    s_add_u32 s62, s61, 33024
    s_add_u32 s63, s62, 33024
    s_waitcnt lgkmcnt(3)
    v_mfma_f32_16x16x32_f16 v[136:139], v[120:123], v[16:19], 0
    v_mfma_f32_16x16x32_f16 v[140:143], v[120:123], v[20:23], 0
    s_waitcnt lgkmcnt(2)
    v_mfma_f32_16x16x32_f16 v[144:147], v[124:127], v[24:27], 0
    v_mfma_f32_16x16x32_f16 v[148:151], v[124:127], v[28:31], 0
    s_nop 3
    v_pk_mul_f32 v[152:153], v[48:49], v[136:137]
    v_pk_mul_f32 v[154:155], v[50:51], v[138:139]
    v_pk_mul_f32 v[156:157], v[52:53], v[136:137]
    v_pk_mul_f32 v[158:159], v[54:55], v[138:139]
    v_pk_fma_f32 v[152:153], v[52:53], v[140:141], v[152:153]
    v_pk_fma_f32 v[156:157], v[48:49], v[140:141], v[156:157] neg_lo:[0,0,1] neg_hi:[0,0,1]
    v_pk_fma_f32 v[154:155], v[54:55], v[142:143], v[154:155]
    v_pk_fma_f32 v[158:159], v[50:51], v[142:143], v[158:159] neg_lo:[0,0,1] neg_hi:[0,0,1]
    v_cvt_pk_f16_f32 v120, v152, v156
    v_cvt_pk_f16_f32 v121, v153, v157
    v_cvt_pk_f16_f32 v122, v154, v158
    v_cvt_pk_f16_f32 v123, v155, v159
    s_waitcnt lgkmcnt(1)
    v_mfma_f32_16x16x32_f16 v[136:139], v[128:131], v[32:35], 0
    v_mfma_f32_16x16x32_f16 v[140:143], v[128:131], v[36:39], 0
    v_mfma_f32_16x16x32_f16 v[216:219], v[80:83], v[120:123], 0
    v_mfma_f32_16x16x32_f16 v[220:223], v[84:87], v[120:123], 0
    v_pk_mul_f32 v[152:153], v[56:57], v[144:145]
    v_pk_mul_f32 v[154:155], v[58:59], v[146:147]
    v_pk_mul_f32 v[156:157], v[60:61], v[144:145]
    v_pk_mul_f32 v[158:159], v[62:63], v[146:147]
    v_pk_fma_f32 v[152:153], v[60:61], v[148:149], v[152:153]
    v_pk_fma_f32 v[156:157], v[56:57], v[148:149], v[156:157] neg_lo:[0,0,1] neg_hi:[0,0,1]
    v_pk_fma_f32 v[154:155], v[62:63], v[150:151], v[154:155]
    v_pk_fma_f32 v[158:159], v[58:59], v[150:151], v[158:159] neg_lo:[0,0,1] neg_hi:[0,0,1]
    v_cvt_pk_f16_f32 v124, v152, v156
    v_cvt_pk_f16_f32 v125, v153, v157
    v_cvt_pk_f16_f32 v126, v154, v158
    v_cvt_pk_f16_f32 v127, v155, v159
    s_waitcnt lgkmcnt(0)
    v_mfma_f32_16x16x32_f16 v[144:147], v[132:135], v[40:43], 0
    v_mfma_f32_16x16x32_f16 v[148:151], v[132:135], v[44:47], 0
    v_mfma_f32_16x16x32_f16 v[224:227], v[80:83], v[124:127], 0
    v_mfma_f32_16x16x32_f16 v[228:231], v[84:87], v[124:127], 0
    v_pk_mul_f32 v[152:153], v[64:65], v[136:137]
    v_pk_mul_f32 v[154:155], v[66:67], v[138:139]
    v_pk_mul_f32 v[156:157], v[68:69], v[136:137]
    v_pk_mul_f32 v[158:159], v[70:71], v[138:139]
    v_pk_fma_f32 v[152:153], v[68:69], v[140:141], v[152:153]
    v_pk_fma_f32 v[156:157], v[64:65], v[140:141], v[156:157] neg_lo:[0,0,1] neg_hi:[0,0,1]
    v_pk_fma_f32 v[154:155], v[70:71], v[142:143], v[154:155]
    v_pk_fma_f32 v[158:159], v[66:67], v[142:143], v[158:159] neg_lo:[0,0,1] neg_hi:[0,0,1]
    v_cvt_pk_f16_f32 v128, v152, v156
    v_cvt_pk_f16_f32 v129, v153, v157
    v_cvt_pk_f16_f32 v130, v154, v158
    v_cvt_pk_f16_f32 v131, v155, v159
    s_nop 1
    v_mfma_f32_16x16x32_f16 v[232:235], v[80:83], v[128:131], 0
    v_mfma_f32_16x16x32_f16 v[236:239], v[84:87], v[128:131], 0
    v_pk_mul_f32 v[152:153], v[72:73], v[144:145]
    v_pk_mul_f32 v[154:155], v[74:75], v[146:147]
    v_pk_mul_f32 v[156:157], v[76:77], v[144:145]
    v_pk_mul_f32 v[158:159], v[78:79], v[146:147]
    v_pk_fma_f32 v[152:153], v[76:77], v[148:149], v[152:153]
    v_pk_fma_f32 v[156:157], v[72:73], v[148:149], v[156:157] neg_lo:[0,0,1] neg_hi:[0,0,1]
    v_pk_fma_f32 v[154:155], v[78:79], v[150:151], v[154:155]
    v_pk_fma_f32 v[158:159], v[74:75], v[150:151], v[158:159] neg_lo:[0,0,1] neg_hi:[0,0,1]
    v_cvt_pk_f16_f32 v132, v152, v156
    v_cvt_pk_f16_f32 v133, v153, v157
    v_cvt_pk_f16_f32 v134, v154, v158
    v_cvt_pk_f16_f32 v135, v155, v159
    s_nop 1
    v_mfma_f32_16x16x32_f16 v[240:243], v[80:83], v[132:135], 0
    v_mfma_f32_16x16x32_f16 v[244:247], v[84:87], v[132:135], 0
    v_cvt_pk_f16_f32 v176, v216, v224
    v_cvt_pk_f16_f32 v178, v220, v228
    v_and_or_b32 v176, v176, s58, v210
    v_and_or_b32 v178, v178, s58, v210
    v_cvt_pk_f16_f32 v180, v217, v225
    v_cvt_pk_f16_f32 v182, v221, v229
    v_and_or_b32 v180, v180, s58, v210
    v_and_or_b32 v182, v182, s58, v210
    v_cvt_pk_f16_f32 v184, v218, v226
    v_cvt_pk_f16_f32 v186, v222, v230
    v_and_or_b32 v184, v184, s58, v210
    v_and_or_b32 v186, v186, s58, v210
    v_cvt_pk_f16_f32 v188, v219, v227
    v_cvt_pk_f16_f32 v190, v223, v231
    v_and_or_b32 v188, v188, s58, v210
    v_and_or_b32 v190, v190, s58, v210
    v_cvt_pk_f16_f32 v177, v232, v240
    v_cvt_pk_f16_f32 v179, v236, v244
    v_and_or_b32 v177, v177, s58, v210
    v_and_or_b32 v179, v179, s58, v210
    v_cvt_pk_f16_f32 v181, v233, v241
    v_cvt_pk_f16_f32 v183, v237, v245
    v_and_or_b32 v181, v181, s58, v210
    v_and_or_b32 v183, v183, s58, v210
    v_cvt_pk_f16_f32 v185, v234, v242
    v_cvt_pk_f16_f32 v187, v238, v246
    v_and_or_b32 v185, v185, s58, v210
    v_and_or_b32 v187, v187, s58, v210
    v_cvt_pk_f16_f32 v189, v235, v243
    v_cvt_pk_f16_f32 v191, v239, v247
    v_and_or_b32 v189, v189, s58, v210
    v_and_or_b32 v191, v191, s58, v210
    s_cmp_eq_u32 s50, 0
    s_cbranch_scc1 L_p1_done
    s_mov_b32 exec_hi, s72
    buffer_store_dwordx4 v[176:179], v209, s[12:15], s60 offen sc1
    s_mov_b32 exec_hi, s73
    buffer_store_dwordx4 v[180:183], v209, s[12:15], s61 offen sc1
    buffer_store_dwordx4 v[184:187], v209, s[12:15], s62 offen sc1
    buffer_store_dwordx4 v[188:191], v209, s[12:15], s63 offen sc1
    s_mov_b32 exec_hi, -1
    s_mov_b32 s50, 0
    s_add_u32 s60, s60, 16384
    v_add_u32 v5, 16384, v5
    s_sub_u32 s31, s48, 4
    v_cvt_f32_i32 v252, s31
    v_mul_f32 v252, 0x3d800000, v252
    v_and_b32 v251, 15, v2
    v_lshlrev_b32 v251, 2, v251
    v_cvt_f32_u32 v251, v251
    v_fma_f32 v250, v212, v251, v252
    v_sin_f32 v84, v250
    v_cos_f32 v250, v250
    s_nop 0
    v_cvt_pk_f16_f32 v80, v250, v84
    v_cvt_pk_f16_f32 v84, -v84, v250
    v_fma_f32 v250, v213, v251, v252
    v_sin_f32 v85, v250
    v_cos_f32 v250, v250
    s_nop 0
    v_cvt_pk_f16_f32 v81, v250, v85
    v_cvt_pk_f16_f32 v85, -v85, v250
    v_fma_f32 v250, v214, v251, v252
    v_sin_f32 v86, v250
    v_cos_f32 v250, v250
    s_nop 0
    v_cvt_pk_f16_f32 v82, v250, v86
    v_cvt_pk_f16_f32 v86, -v86, v250
    v_fma_f32 v250, v215, v251, v252
    v_sin_f32 v87, v250
    v_cos_f32 v250, v250
    s_nop 0
    v_cvt_pk_f16_f32 v83, v250, v87
    v_cvt_pk_f16_f32 v87, -v87, v250
    s_branch L_st23
L_p1_done:
    s_cmp_lt_u32 s2, 224
    s_cbranch_scc1 L_zst_later
    s_cmp_eq_u32 s74, 7
    s_cbranch_scc1 L_zst_later
    s_mov_b32 exec_hi, s72
    buffer_store_dwordx4 v[176:179], v209, s[12:15], s60 offen sc1
    s_mov_b32 exec_hi, s73
    buffer_store_dwordx4 v[180:183], v209, s[12:15], s61 offen sc1
    buffer_store_dwordx4 v[184:187], v209, s[12:15], s62 offen sc1
    buffer_store_dwordx4 v[188:191], v209, s[12:15], s63 offen sc1
    s_mov_b32 exec_hi, -1
    s_mov_b32 s74, 7
L_zst_later:
    s_mov_b64 exec, 1
    ds_add_u32 v0, v255 offset:42828
    s_mov_b64 exec, -1
    s_setprio 0
    v_mov_b32 v4, v112
    v_mov_b32 v5, v113
    v_mov_b32 v249, v114
    v_mov_b32 v205, v115
    v_mov_b32 v248, v116
    v_mov_b32 v208, v117
    v_mov_b32 v7, v118
    v_mov_b32 v6, v119
    s_and_b32 s31, s2, 7
    s_sub_u32 s32, 8, s31
    s_min_u32 s46, s31, s32
    s_cmp_gt_u32 s31, 4
    s_cselect_b32 s31, 16, 0
    s_lshr_b32 s47, s2, 4
    s_add_u32 s47, s47, s31
    s_bfe_u32 s53, s2, 0x10003
    s_lshl_b32 s53, s53, 7
    s_add_u32 s53, s53, s31
    s_lshl_b32 s31, s30, 5
    s_add_u32 s53, s53, s31
    s_lshl_b32 s48, s46, 1
    s_add_u32 s48, s48, 2040
    s_mov_b32 s49, 32768
    v_mov_b32 v212, v210
    v_mov_b32 v213, v210
    v_mov_b32 v214, v210
    v_mov_b32 v215, v210
L_sync4:
    ds_read_b32 v1, v0 offset:42860
    s_waitcnt lgkmcnt(0)
    v_readfirstlane_b32 s31, v1
    s_nop 0
    s_cmp_ge_u32 s31, 1
    s_cbranch_scc0 L_sync4
    buffer_load_dwordx4 v[24:27], v6, s[12:15], s49 offen
    s_cmp_eq_u32 s74, 7
    s_cbranch_scc1 L_no_zst
    s_cmp_ge_u32 s2, 224
    s_cbranch_scc1 L_zst_go
L_sync5:
    ds_read_b32 v1, v0 offset:42840
    s_waitcnt lgkmcnt(0)
    v_readfirstlane_b32 s31, v1
    s_nop 0
    s_cmp_ge_u32 s31, 1
    s_cbranch_scc0 L_sync5
L_zst_go:
    s_mov_b32 exec_hi, s72
    buffer_store_dwordx4 v[176:179], v209, s[12:15], s60 offen sc1
    s_mov_b32 exec_hi, s73
    buffer_store_dwordx4 v[180:183], v209, s[12:15], s61 offen sc1
    buffer_store_dwordx4 v[184:187], v209, s[12:15], s62 offen sc1
    buffer_store_dwordx4 v[188:191], v209, s[12:15], s63 offen sc1
    s_mov_b32 exec_hi, -1
L_no_zst:
    v_and_b32 v160, 15, v2
    v_add_u32 v160, s53, v160
    v_cvt_f32_u32 v160, v160
    v_add_f32 v160, 0.5, v160
    v_mul_f32 v160, 0x3b800000, v160
    v_and_b32 v161, 32, v2
    v_bfe_u32 v162, v2, 4, 1
    v_lshl_add_u32 v161, v162, 3, v161
    v_cvt_f32_u32 v161, v161
    v_mul_f32 v161, v161, v160
    v_fmamk_f32 v88, v160, 0x0, v161
    v_fmamk_f32 v162, v160, 0x40000000, v161
    v_sin_f32 v104, v88
    v_sin_f32 v163, v162
    v_cos_f32 v88, v88
    v_cos_f32 v162, v162
    v_cvt_pk_f16_f32 v104, v104, v163
    v_cvt_pk_f16_f32 v88, v88, v162
    v_fmamk_f32 v89, v160, 0x40800000, v161
    v_fmamk_f32 v162, v160, 0x40c00000, v161
    v_sin_f32 v105, v89
    v_sin_f32 v163, v162
    v_cos_f32 v89, v89
    v_cos_f32 v162, v162
    v_cvt_pk_f16_f32 v105, v105, v163
    v_cvt_pk_f16_f32 v89, v89, v162
    v_fmamk_f32 v90, v160, 0x41800000, v161
    v_fmamk_f32 v162, v160, 0x41900000, v161
    v_sin_f32 v106, v90
    v_sin_f32 v163, v162
    v_cos_f32 v90, v90
    v_cos_f32 v162, v162
    v_cvt_pk_f16_f32 v106, v106, v163
    v_cvt_pk_f16_f32 v90, v90, v162
    v_fmamk_f32 v91, v160, 0x41a00000, v161
    v_fmamk_f32 v162, v160, 0x41b00000, v161
    v_sin_f32 v107, v91
    v_sin_f32 v163, v162
    v_cos_f32 v91, v91
    v_cos_f32 v162, v162
    v_cvt_pk_f16_f32 v107, v107, v163
    v_cvt_pk_f16_f32 v91, v91, v162
    v_fmamk_f32 v92, v160, 0x42800000, v161
    v_fmamk_f32 v162, v160, 0x42840000, v161
    v_sin_f32 v108, v92
    v_sin_f32 v163, v162
    v_cos_f32 v92, v92
    v_cos_f32 v162, v162
    v_cvt_pk_f16_f32 v108, v108, v163
    v_cvt_pk_f16_f32 v92, v92, v162
    v_fmamk_f32 v93, v160, 0x42880000, v161
    v_fmamk_f32 v162, v160, 0x428c0000, v161
    v_sin_f32 v109, v93
    v_sin_f32 v163, v162
    v_cos_f32 v93, v93
    v_cos_f32 v162, v162
    v_cvt_pk_f16_f32 v109, v109, v163
    v_cvt_pk_f16_f32 v93, v93, v162
    v_fmamk_f32 v94, v160, 0x42a00000, v161
    v_fmamk_f32 v162, v160, 0x42a40000, v161
    v_sin_f32 v110, v94
    v_sin_f32 v163, v162
    v_cos_f32 v94, v94
    v_cos_f32 v162, v162
    v_cvt_pk_f16_f32 v110, v110, v163
    v_cvt_pk_f16_f32 v94, v94, v162
    v_fmamk_f32 v95, v160, 0x42a80000, v161
    v_fmamk_f32 v162, v160, 0x42ac0000, v161
    v_sin_f32 v111, v95
    v_sin_f32 v163, v162
    v_cos_f32 v95, v95
    v_cos_f32 v162, v162
    v_cvt_pk_f16_f32 v111, v111, v163
    v_cvt_pk_f16_f32 v95, v95, v162
    v_fmamk_f32 v96, v160, 0x3f800000, v161
    v_fmamk_f32 v162, v160, 0x40400000, v161
    v_sin_f32 v112, v96
    v_sin_f32 v163, v162
    v_cos_f32 v96, v96
    v_cos_f32 v162, v162
    v_cvt_pk_f16_f32 v112, v112, v163
    v_cvt_pk_f16_f32 v96, v96, v162
    v_fmamk_f32 v97, v160, 0x40a00000, v161
    v_fmamk_f32 v162, v160, 0x40e00000, v161
    v_sin_f32 v113, v97
    v_sin_f32 v163, v162
    v_cos_f32 v97, v97
    v_cos_f32 v162, v162
    v_cvt_pk_f16_f32 v113, v113, v163
    v_cvt_pk_f16_f32 v97, v97, v162
    v_fmamk_f32 v98, v160, 0x41880000, v161
    v_fmamk_f32 v162, v160, 0x41980000, v161
    v_sin_f32 v114, v98
    v_sin_f32 v163, v162
    v_cos_f32 v98, v98
    v_cos_f32 v162, v162
    v_cvt_pk_f16_f32 v114, v114, v163
    v_cvt_pk_f16_f32 v98, v98, v162
    v_fmamk_f32 v99, v160, 0x41a80000, v161
    v_fmamk_f32 v162, v160, 0x41b80000, v161
    v_sin_f32 v115, v99
    v_sin_f32 v163, v162
    v_cos_f32 v99, v99
    v_cos_f32 v162, v162
    v_cvt_pk_f16_f32 v115, v115, v163
    v_cvt_pk_f16_f32 v99, v99, v162
    v_fmamk_f32 v100, v160, 0x42820000, v161
    v_fmamk_f32 v162, v160, 0x42860000, v161
    v_sin_f32 v116, v100
    v_sin_f32 v163, v162
    v_cos_f32 v100, v100
    v_cos_f32 v162, v162
    v_cvt_pk_f16_f32 v116, v116, v163
    v_cvt_pk_f16_f32 v100, v100, v162
    v_fmamk_f32 v101, v160, 0x428a0000, v161
    v_fmamk_f32 v162, v160, 0x428e0000, v161
    v_sin_f32 v117, v101
    v_sin_f32 v163, v162
    v_cos_f32 v101, v101
    v_cos_f32 v162, v162
    v_cvt_pk_f16_f32 v117, v117, v163
    v_cvt_pk_f16_f32 v101, v101, v162
    v_fmamk_f32 v102, v160, 0x42a20000, v161
    v_fmamk_f32 v162, v160, 0x42a60000, v161
    v_sin_f32 v118, v102
    v_sin_f32 v163, v162
    v_cos_f32 v102, v102
    v_cos_f32 v162, v162
    v_cvt_pk_f16_f32 v118, v118, v163
    v_cvt_pk_f16_f32 v102, v102, v162
    v_fmamk_f32 v103, v160, 0x42aa0000, v161
    v_fmamk_f32 v162, v160, 0x42ae0000, v161
    v_sin_f32 v119, v103
    v_sin_f32 v163, v162
    v_cos_f32 v103, v103
    v_cos_f32 v162, v162
    v_cvt_pk_f16_f32 v119, v119, v163
    v_cvt_pk_f16_f32 v103, v103, v162
    v_cmp_gt_u32 vcc, 16, v2
    v_and_b32 v162, 1, v2
    v_lshlrev_b32 v162, 15, v162
    v_or_b32 v162, 0x3c00, v162
    v_and_b32 v160, 0xffff0000, v104
    v_or_b32 v162, v162, v160
    v_cndmask_b32 v104, v104, v162, vcc
    s_mul_i32 s51, s46, 528384
    s_add_u32 s51, s51, 2097152
    s_mul_i32 s54, s47, 16512
    s_lshl_b32 s32, s30, 12
    s_add_u32 s50, s51, s54
    s_add_u32 s50, s50, s32
    s_add_u32 s55, s47, 1
    s_and_b32 s55, s55, 31
    s_mul_i32 s55, s55, 16512
    v_add_u32 v250, s32, v3
    v_add_u32 v199, s76, v3
    v_lshl_add_u32 v200, v2, 7, s32
    v_and_b32 v1, 2, v2
    v_lshl_add_u32 v200, v1, 3, v200
    v_and_b32 v1, 0x70, v3
    v_add_u32 v1, 16384, v1
    s_mov_b32 vcc_lo, 0
    s_mov_b32 vcc_hi, -1
    v_cndmask_b32 v200, v200, v1, vcc
    s_mov_b32 vcc_hi, 0xff
    v_mov_b32 v1, s55
    v_mov_b32 v201, s54
    v_cndmask_b32 v1, v1, v201, vcc
    v_mov_b32 v201, 16640
    v_cndmask_b32 v201, v201, v0, vcc
    v_add_u32 v201, v201, v200
    v_add_u32 v200, v1, v200
    v_lshrrev_b32 v251, 5, v2
    v_lshlrev_b32 v251, 11, v251
    v_bfe_u32 v1, v2, 2, 3
    v_lshl_add_u32 v251, v1, 7, v251
    v_and_b32 v1, 3, v2
    v_lshl_add_u32 v251, v1, 5, v251
    v_bfe_u32 v1, v2, 3, 1
    v_lshl_add_u32 v251, v1, 4, v251
    v_bfe_u32 v1, v2, 4, 1
    v_lshl_add_u32 v251, v1, 3, v251
    v_xor_b32 v252, 16, v251
    v_xor_b32 v253, 8, v251
    v_xor_b32 v254, 24, v251
    v_cmp_gt_u32 vcc, 4, v2
    v_mov_b32 v1, 16384
    s_nop 0
    v_cndmask_b32 v1, v0, v1, vcc
    v_add_u32 v206, v253, v1
    v_add_u32 v207, v254, v1
    s_mov_b32 vcc_lo, 0x88888888
    s_mov_b32 vcc_hi, 0x88888888
    v_mov_b32 v1, 16544
    v_cndmask_b32 v1, 32, v1, vcc
    v_add_u32 v202, v251, v1
    v_add_u32 v203, v253, v1
    v_add_u32 v204, v206, v1
    s_waitcnt vmcnt(0)
L_stat_check:
    v_cmp_ne_u64 vcc, s[28:29], v[26:27]
    s_nop 0
    s_cbranch_vccz L_stat_got
    s_cmp_eq_u32 s35, 0
    s_cbranch_scc1 L_stat_got
    s_sub_u32 s35, s35, 1
    s_sleep 2
    s_mov_b64 exec, vcc
    buffer_load_dwordx4 v[24:27], v6, s[12:15], s49 offen sc1
    s_mov_b64 exec, -1
    s_waitcnt vmcnt(0)
    s_branch L_stat_check
L_stat_got:
    v_cndmask_b32 v24, v24, v25, s[88:89]
    v_mov_b32 v32, v24
    s_nop 1
    v_permlane32_swap_b32 v24, v32
    v_mov_b32 v28, v24
    v_mov_b32 v36, v32
    s_nop 0
    v_permlane16_swap_b32 v24, v28
    v_permlane16_swap_b32 v32, v36
    v_lshlrev_b32 v26, 16, v24
    v_and_b32 v24, 0xffff0000, v24
    v_rcp_f32 v24, v24
    v_lshlrev_b32 v30, 16, v28
    v_and_b32 v28, 0xffff0000, v28
    v_rcp_f32 v28, v28
    v_lshlrev_b32 v34, 16, v32
    v_and_b32 v32, 0xffff0000, v32
    v_rcp_f32 v32, v32
    v_lshlrev_b32 v38, 16, v36
    v_and_b32 v36, 0xffff0000, v36
    v_rcp_f32 v36, v36
    v_mul_f32 v24, 0xbfb8aa3b, v24
    v_mul_f32_e64 v26, -v26, v24
    v_mul_f32 v28, 0xbfb8aa3b, v28
    v_mul_f32_e64 v30, -v30, v28
    v_mul_f32 v32, 0xbfb8aa3b, v32
    v_mul_f32_e64 v34, -v34, v32
    v_mul_f32 v36, 0xbfb8aa3b, v36
    v_mul_f32_e64 v38, -v38, v36
    ds_read_b128 v[8:11], v208 offset:0
    ds_read_b128 v[12:15], v208 offset:1024
    s_waitcnt lgkmcnt(0)
    v_lshlrev_b32 v40, 16, v8
    v_and_b32 v41, 0xffff0000, v8
    v_lshlrev_b32 v42, 16, v9
    v_and_b32 v43, 0xffff0000, v9
    v_lshlrev_b32 v44, 16, v10
    v_and_b32 v45, 0xffff0000, v10
    v_lshlrev_b32 v46, 16, v11
    v_and_b32 v47, 0xffff0000, v11
    v_lshlrev_b32 v48, 16, v12
    v_and_b32 v55, 0xffff0000, v12
    v_lshlrev_b32 v54, 16, v13
    v_and_b32 v53, 0xffff0000, v13
    v_lshlrev_b32 v52, 16, v14
    v_and_b32 v51, 0xffff0000, v14
    v_lshlrev_b32 v50, 16, v15
    v_and_b32 v49, 0xffff0000, v15
    v_pk_fma_f32 v[120:121], v[40:41], v[24:25], v[26:27] op_sel_hi:[1,0,0]
    v_pk_fma_f32 v[122:123], v[42:43], v[24:25], v[26:27] op_sel_hi:[1,0,0]
    v_pk_fma_f32 v[124:125], v[44:45], v[24:25], v[26:27] op_sel_hi:[1,0,0]
    v_pk_fma_f32 v[126:127], v[46:47], v[24:25], v[26:27] op_sel_hi:[1,0,0]
    v_pk_fma_f32 v[128:129], v[48:49], v[28:29], v[30:31] op_sel_hi:[1,0,0]
    v_pk_fma_f32 v[130:131], v[50:51], v[28:29], v[30:31] op_sel_hi:[1,0,0]
    v_pk_fma_f32 v[132:133], v[52:53], v[28:29], v[30:31] op_sel_hi:[1,0,0]
    v_pk_fma_f32 v[134:135], v[54:55], v[28:29], v[30:31] op_sel_hi:[1,0,0]
    v_exp_f32 v216, v120
    v_exp_f32 v217, v121
    v_exp_f32 v218, v122
    v_exp_f32 v219, v123
    v_exp_f32 v220, v124
    v_exp_f32 v221, v125
    v_exp_f32 v222, v126
    v_exp_f32 v223, v127
    v_exp_f32 v224, v128
    v_exp_f32 v225, v129
    v_exp_f32 v226, v130
    v_exp_f32 v227, v131
    v_exp_f32 v228, v132
    v_exp_f32 v229, v133
    v_exp_f32 v230, v134
    v_exp_f32 v231, v135
    v_pk_add_f32 v[216:217], v[216:217], 1.0 op_sel_hi:[1,0]
    v_pk_add_f32 v[218:219], v[218:219], 1.0 op_sel_hi:[1,0]
    v_pk_add_f32 v[220:221], v[220:221], 1.0 op_sel_hi:[1,0]
    v_pk_add_f32 v[222:223], v[222:223], 1.0 op_sel_hi:[1,0]
    v_pk_add_f32 v[224:225], v[224:225], 1.0 op_sel_hi:[1,0]
    v_pk_add_f32 v[226:227], v[226:227], 1.0 op_sel_hi:[1,0]
    v_pk_add_f32 v[228:229], v[228:229], 1.0 op_sel_hi:[1,0]
    v_pk_add_f32 v[230:231], v[230:231], 1.0 op_sel_hi:[1,0]
    v_rcp_f32 v216, v216
    v_rcp_f32 v217, v217
    v_rcp_f32 v218, v218
    v_rcp_f32 v219, v219
    v_rcp_f32 v220, v220
    v_rcp_f32 v221, v221
    v_rcp_f32 v222, v222
    v_rcp_f32 v223, v223
    v_rcp_f32 v224, v224
    v_rcp_f32 v225, v225
    v_rcp_f32 v226, v226
    v_rcp_f32 v227, v227
    v_rcp_f32 v228, v228
    v_rcp_f32 v229, v229
    v_rcp_f32 v230, v230
    v_rcp_f32 v231, v231
    v_pk_mul_f32 v[120:121], v[120:121], v[216:217]
    v_pk_mul_f32 v[122:123], v[122:123], v[218:219]
    v_pk_mul_f32 v[124:125], v[124:125], v[220:221]
    v_pk_mul_f32 v[126:127], v[126:127], v[222:223]
    v_pk_mul_f32 v[128:129], v[128:129], v[224:225]
    v_pk_mul_f32 v[130:131], v[130:131], v[226:227]
    v_pk_mul_f32 v[132:133], v[132:133], v[228:229]
    v_pk_mul_f32 v[134:135], v[134:135], v[230:231]
L_sync6:
    ds_read_b32 v1, v0 offset:42848
    s_waitcnt lgkmcnt(0)
    v_readfirstlane_b32 s31, v1
    s_nop 0
    s_cmp_ge_u32 s31, 4
    s_cbranch_scc0 L_sync6
    s_add_u32 m0, s76, 2048
    s_nop 0
    buffer_load_dwordx4 v249, s[8:11], 0 offen lds
    s_add_u32 m0, s76, 3072
    s_nop 0
    buffer_load_dwordx4 v205, s[8:11], 0 offen lds
L_sync7:
    ds_read_b32 v1, v0 offset:42844
    ds_read_b32 v198, v0 offset:41556
    s_waitcnt lgkmcnt(1)
    v_readfirstlane_b32 s31, v1
    s_nop 0
    s_cmp_ge_u32 s31, 1
    s_cbranch_scc0 L_sync7
    v_and_b32 v6, 48, v2
    v_lshlrev_b32 v6, 1, v6
    v_mov_b32 v209, 2147483392
    s_waitcnt lgkmcnt(0)
    v_readfirstlane_b32 s33, v198
    s_nop 0
    s_andn2_b32 s33, 0x7ff, s33
    s_sub_u32 s31, 0, s33
    s_and_b32 s31, s31, 2047
    s_sub_u32 s32, s48, s33
    s_sub_u32 s34, s48, s31
    v_cmp_eq_u32 vcc, s33, v7
    v_cmp_eq_u32 s[54:55], s33, v248
    s_nop 0
    v_cndmask_b32 v4, v4, v209, vcc
    v_cmp_eq_u32 vcc, s31, v7
    v_cmp_eq_u32 s[56:57], s31, v248
    s_nop 0
    v_cndmask_b32 v5, v5, v209, vcc
    v_cmp_eq_u32 vcc, s32, v7
    v_cmp_eq_u32 s[58:59], s32, v248
    s_nop 0
    v_cndmask_b32 v249, v249, v209, vcc
    v_cmp_eq_u32 vcc, s34, v7
    v_cmp_eq_u32 s[60:61], s34, v248
    s_nop 0
    v_cndmask_b32 v205, v205, v209, vcc
    s_or_b64 s[62:63], s[54:55], s[58:59]
    s_or_b64 s[64:65], s[56:57], s[60:61]
    s_waitcnt vmcnt(0)
    buffer_load_dwordx4 v[72:75], v3, s[12:15], s50 offen offset:0 sc1
    buffer_load_dwordx4 v[76:79], v3, s[12:15], s50 offen offset:1024 sc1
    buffer_load_dwordx4 v[80:83], v3, s[12:15], s50 offen offset:2048 sc1
    buffer_load_dwordx4 v[84:87], v3, s[12:15], s50 offen offset:3072 sc1
    s_mov_b32 exec_hi, 0x1ff
    buffer_load_dwordx4 v[212:215], v200, s[12:15], s51 offen sc1
    s_mov_b32 exec_hi, -1
    ds_read_b128 v[16:19], v208 offset:2048
    ds_read_b128 v[20:23], v208 offset:3072
    s_waitcnt lgkmcnt(0)
    v_lshlrev_b32 v56, 16, v16
    v_and_b32 v57, 0xffff0000, v16
    v_lshlrev_b32 v58, 16, v17
    v_and_b32 v59, 0xffff0000, v17
    v_lshlrev_b32 v60, 16, v18
    v_and_b32 v61, 0xffff0000, v18
    v_lshlrev_b32 v62, 16, v19
    v_and_b32 v63, 0xffff0000, v19
    v_lshlrev_b32 v64, 16, v20
    v_and_b32 v71, 0xffff0000, v20
    v_lshlrev_b32 v70, 16, v21
    v_and_b32 v69, 0xffff0000, v21
    v_lshlrev_b32 v68, 16, v22
    v_and_b32 v67, 0xffff0000, v22
    v_lshlrev_b32 v66, 16, v23
    v_and_b32 v65, 0xffff0000, v23
    v_pk_fma_f32 v[136:137], v[56:57], v[32:33], v[34:35] op_sel_hi:[1,0,0]
    v_pk_fma_f32 v[138:139], v[58:59], v[32:33], v[34:35] op_sel_hi:[1,0,0]
    v_pk_fma_f32 v[140:141], v[60:61], v[32:33], v[34:35] op_sel_hi:[1,0,0]
    v_pk_fma_f32 v[142:143], v[62:63], v[32:33], v[34:35] op_sel_hi:[1,0,0]
    v_pk_fma_f32 v[144:145], v[64:65], v[36:37], v[38:39] op_sel_hi:[1,0,0]
    v_pk_fma_f32 v[146:147], v[66:67], v[36:37], v[38:39] op_sel_hi:[1,0,0]
    v_pk_fma_f32 v[148:149], v[68:69], v[36:37], v[38:39] op_sel_hi:[1,0,0]
    v_pk_fma_f32 v[150:151], v[70:71], v[36:37], v[38:39] op_sel_hi:[1,0,0]
    v_exp_f32 v232, v136
    v_exp_f32 v233, v137
    v_exp_f32 v234, v138
    v_exp_f32 v235, v139
    v_exp_f32 v236, v140
    v_exp_f32 v237, v141
    v_exp_f32 v238, v142
    v_exp_f32 v239, v143
    v_exp_f32 v240, v144
    v_exp_f32 v241, v145
    v_exp_f32 v242, v146
    v_exp_f32 v243, v147
    v_exp_f32 v244, v148
    v_exp_f32 v245, v149
    v_exp_f32 v246, v150
    v_exp_f32 v247, v151
    v_pk_add_f32 v[232:233], v[232:233], 1.0 op_sel_hi:[1,0]
    v_pk_add_f32 v[234:235], v[234:235], 1.0 op_sel_hi:[1,0]
    v_pk_add_f32 v[236:237], v[236:237], 1.0 op_sel_hi:[1,0]
    v_pk_add_f32 v[238:239], v[238:239], 1.0 op_sel_hi:[1,0]
    v_pk_add_f32 v[240:241], v[240:241], 1.0 op_sel_hi:[1,0]
    v_pk_add_f32 v[242:243], v[242:243], 1.0 op_sel_hi:[1,0]
    v_pk_add_f32 v[244:245], v[244:245], 1.0 op_sel_hi:[1,0]
    v_pk_add_f32 v[246:247], v[246:247], 1.0 op_sel_hi:[1,0]
    v_rcp_f32 v232, v232
    v_rcp_f32 v233, v233
    v_rcp_f32 v234, v234
    v_rcp_f32 v235, v235
    v_rcp_f32 v236, v236
    v_rcp_f32 v237, v237
    v_rcp_f32 v238, v238
    v_rcp_f32 v239, v239
    v_rcp_f32 v240, v240
    v_rcp_f32 v241, v241
    v_rcp_f32 v242, v242
    v_rcp_f32 v243, v243
    v_rcp_f32 v244, v244
    v_rcp_f32 v245, v245
    v_rcp_f32 v246, v246
    v_rcp_f32 v247, v247
    v_pk_mul_f32 v[136:137], v[136:137], v[232:233]
    v_pk_mul_f32 v[138:139], v[138:139], v[234:235]
    v_pk_mul_f32 v[140:141], v[140:141], v[236:237]
    v_pk_mul_f32 v[142:143], v[142:143], v[238:239]
    v_pk_mul_f32 v[144:145], v[144:145], v[240:241]
    v_pk_mul_f32 v[146:147], v[146:147], v[242:243]
    v_pk_mul_f32 v[148:149], v[148:149], v[244:245]
    v_pk_mul_f32 v[150:151], v[150:151], v[246:247]
L_z_wait:
    s_setprio 1
    s_waitcnt vmcnt(4)
    v_xor_b32 v160, v210, v72
    v_xor_b32 v161, v210, v73
    v_xor_b32 v162, v210, v74
    v_xor_b32 v163, v210, v75
    ds_write_b128 v250, v[160:163] offset:0
    v_or3_b32 v1, v160, v161, v162
    v_or_b32 v1, v1, v163
    s_waitcnt vmcnt(3)
    v_xor_b32 v164, v210, v76
    v_xor_b32 v165, v210, v77
    v_xor_b32 v166, v210, v78
    v_xor_b32 v167, v210, v79
    ds_write_b128 v250, v[164:167] offset:1024
    v_or3_b32 v1, v1, v164, v165
    v_or3_b32 v1, v1, v166, v167
    s_waitcnt vmcnt(2)
    v_xor_b32 v168, v210, v80
    v_xor_b32 v169, v210, v81
    v_xor_b32 v170, v210, v82
    v_xor_b32 v171, v210, v83
    ds_write_b128 v250, v[168:171] offset:2048
    v_or3_b32 v1, v1, v168, v169
    v_or3_b32 v1, v1, v170, v171
    s_waitcnt vmcnt(1)
    v_xor_b32 v172, v210, v84
    v_xor_b32 v173, v210, v85
    v_xor_b32 v174, v210, v86
    v_xor_b32 v175, v210, v87
    ds_write_b128 v250, v[172:175] offset:3072
    v_or3_b32 v1, v1, v172, v173
    v_or3_b32 v1, v1, v174, v175
    s_waitcnt vmcnt(0)
    v_xor_b32 v176, v210, v212
    v_xor_b32 v177, v210, v213
    v_xor_b32 v178, v210, v214
    v_xor_b32 v179, v210, v215
    s_mov_b32 exec_hi, 0x1ff
    ds_write_b128 v201, v[176:179]
    s_mov_b32 exec_hi, -1
    v_or3_b32 v1, v1, v176, v177
    v_or3_b32 v1, v1, v178, v179
    v_and_b32 v1, 0x30003, v1
    v_cmp_ne_u32 vcc, 0, v1
    s_nop 0
    s_cbranch_vccz L_z_got
    s_cmp_eq_u32 s35, 0
    s_cbranch_scc1 L_z_got
    s_sub_u32 s35, s35, 1
    s_sleep 2
    s_mov_b64 exec, vcc
    buffer_load_dwordx4 v[72:75], v3, s[12:15], s50 offen offset:0 sc1
    buffer_load_dwordx4 v[76:79], v3, s[12:15], s50 offen offset:1024 sc1
    buffer_load_dwordx4 v[80:83], v3, s[12:15], s50 offen offset:2048 sc1
    buffer_load_dwordx4 v[84:87], v3, s[12:15], s50 offen offset:3072 sc1
    s_and_b32 exec_hi, exec_hi, 0x1ff
    s_or_b32 exec_lo, exec_lo, 1
    buffer_load_dwordx4 v[212:215], v200, s[12:15], s51 offen sc1
    s_mov_b64 exec, -1
    s_waitcnt lgkmcnt(0)
    s_branch L_z_wait
L_z_got:
    s_mov_b64 exec, 1
    ds_add_u32 v0, v255 offset:42832
    s_mov_b64 exec, -1
L_sync8:
    ds_read_b32 v1, v0 offset:42832
    ds_read_b64_tr_b16 v[152:153], v251 offset:0
    ds_read_b64_tr_b16 v[154:155], v251 offset:1024
    ds_read_b64_tr_b16 v[156:157], v252 offset:0
    ds_read_b64_tr_b16 v[158:159], v252 offset:1024
    s_waitcnt lgkmcnt(4)
    v_readfirstlane_b32 s31, v1
    s_nop 0
    s_cmp_ge_u32 s31, 4
    s_cbranch_scc0 L_sync8
    ds_read_b64_tr_b16 v[160:161], v251 offset:4096
    ds_read_b64_tr_b16 v[162:163], v251 offset:5120
    ds_read_b64_tr_b16 v[164:165], v252 offset:4096
    ds_read_b64_tr_b16 v[166:167], v252 offset:5120
    ds_read_b64_tr_b16 v[168:169], v251 offset:8192
    ds_read_b64_tr_b16 v[170:171], v251 offset:9216
    ds_read_b64_tr_b16 v[172:173], v252 offset:8192
    ds_read_b64_tr_b16 v[174:175], v252 offset:9216
    s_waitcnt lgkmcnt(8)
    v_mfma_f32_16x16x32_f16 v[216:219], v[152:155], v[88:91], 0
    v_mfma_f32_16x16x32_f16 v[220:223], v[156:159], v[88:91], 0
    ds_read_b64_tr_b16 v[176:177], v251 offset:12288
    ds_read_b64_tr_b16 v[178:179], v251 offset:13312
    ds_read_b64_tr_b16 v[180:181], v252 offset:12288
    ds_read_b64_tr_b16 v[182:183], v252 offset:13312
    s_waitcnt lgkmcnt(8)
    v_mfma_f32_16x16x32_f16 v[216:219], v[160:163], v[92:95], v[216:219]
    v_mfma_f32_16x16x32_f16 v[220:223], v[164:167], v[92:95], v[220:223]
    ds_read_b64_tr_b16 v[152:153], v206 offset:0
    ds_read_b64_tr_b16 v[154:155], v253 offset:1024
    ds_read_b64_tr_b16 v[156:157], v207 offset:0
    ds_read_b64_tr_b16 v[158:159], v254 offset:1024
    s_waitcnt lgkmcnt(8)
    v_mfma_f32_16x16x32_f16 v[216:219], v[168:171], v[96:99], v[216:219]
    v_mfma_f32_16x16x32_f16 v[220:223], v[172:175], v[96:99], v[220:223]
    ds_read_b64_tr_b16 v[160:161], v253 offset:4096
    ds_read_b64_tr_b16 v[162:163], v253 offset:5120
    ds_read_b64_tr_b16 v[164:165], v254 offset:4096
    ds_read_b64_tr_b16 v[166:167], v254 offset:5120
    s_waitcnt lgkmcnt(8)
    v_mfma_f32_16x16x32_f16 v[216:219], v[176:179], v[100:103], v[216:219]
    v_mfma_f32_16x16x32_f16 v[220:223], v[180:183], v[100:103], v[220:223]
    ds_read_b64_tr_b16 v[168:169], v253 offset:8192
    ds_read_b64_tr_b16 v[170:171], v253 offset:9216
    ds_read_b64_tr_b16 v[172:173], v254 offset:8192
    ds_read_b64_tr_b16 v[174:175], v254 offset:9216
    s_waitcnt lgkmcnt(8)
    v_mfma_f32_16x16x32_f16 v[224:227], v[152:155], v[104:107], 0
    v_mfma_f32_16x16x32_f16 v[228:231], v[156:159], v[104:107], 0
    ds_read_b64_tr_b16 v[176:177], v253 offset:12288
    ds_read_b64_tr_b16 v[178:179], v253 offset:13312
    ds_read_b64_tr_b16 v[180:181], v254 offset:12288
    ds_read_b64_tr_b16 v[182:183], v254 offset:13312
    s_waitcnt lgkmcnt(8)
    v_mfma_f32_16x16x32_f16 v[224:227], v[160:163], v[108:111], v[224:227]
    v_mfma_f32_16x16x32_f16 v[228:231], v[164:167], v[108:111], v[228:231]
    ds_read_b64_tr_b16 v[72:73], v202 offset:0
    ds_read_b64_tr_b16 v[74:75], v202 offset:1024
    ds_read_b64_tr_b16 v[76:77], v202 offset:4096
    ds_read_b64_tr_b16 v[78:79], v202 offset:5120
    s_waitcnt lgkmcnt(8)
    v_mfma_f32_16x16x32_f16 v[224:227], v[168:171], v[112:115], v[224:227]
    v_mfma_f32_16x16x32_f16 v[228:231], v[172:175], v[112:115], v[228:231]
    ds_read_b64_tr_b16 v[80:81], v202 offset:8192
    ds_read_b64_tr_b16 v[82:83], v202 offset:9216
    ds_read_b64_tr_b16 v[84:85], v202 offset:12288
    ds_read_b64_tr_b16 v[86:87], v202 offset:13312
    s_waitcnt lgkmcnt(8)
    v_mfma_f32_16x16x32_f16 v[224:227], v[176:179], v[116:119], v[224:227]
    v_mfma_f32_16x16x32_f16 v[228:231], v[180:183], v[116:119], v[228:231]
    ds_read_b64_tr_b16 v[240:241], v204 offset:0
    ds_read_b64_tr_b16 v[242:243], v203 offset:1024
    ds_read_b64_tr_b16 v[244:245], v203 offset:4096
    ds_read_b64_tr_b16 v[246:247], v203 offset:5120
    s_waitcnt lgkmcnt(8)
    ds_read_b64_tr_b16 v[184:185], v203 offset:8192
    ds_read_b64_tr_b16 v[186:187], v203 offset:9216
    ds_read_b64_tr_b16 v[188:189], v203 offset:12288
    ds_read_b64_tr_b16 v[190:191], v203 offset:13312
    v_mfma_f32_16x16x32_f16 v[232:235], v[72:75], v[88:91], 0
    v_mfma_f32_16x16x32_f16 v[232:235], v[76:79], v[92:95], v[232:235]
    s_waitcnt lgkmcnt(4)
    v_mfma_f32_16x16x32_f16 v[232:235], v[80:83], v[96:99], v[232:235]
    v_mfma_f32_16x16x32_f16 v[232:235], v[84:87], v[100:103], v[232:235]
    v_pk_add_f32 v[152:153], v[216:217], v[224:225]
    v_pk_add_f32 v[154:155], v[218:219], v[226:227]
    v_pk_add_f32 v[156:157], v[220:221], v[228:229]
    v_pk_add_f32 v[158:159], v[222:223], v[230:231]
    v_mfma_f32_16x16x32_f16 v[236:239], v[240:243], v[104:107], 0
    v_mfma_f32_16x16x32_f16 v[236:239], v[244:247], v[108:111], v[236:239]
    v_pk_fma_f32 v[40:41], v[152:153], v[120:121], v[40:41]
    v_pk_fma_f32 v[42:43], v[154:155], v[122:123], v[42:43]
    v_pk_fma_f32 v[44:45], v[156:157], v[124:125], v[44:45]
    v_pk_fma_f32 v[46:47], v[158:159], v[126:127], v[46:47]
    s_waitcnt lgkmcnt(0)
    v_mfma_f32_16x16x32_f16 v[236:239], v[184:187], v[112:115], v[236:239]
    v_mfma_f32_16x16x32_f16 v[236:239], v[188:191], v[116:119], v[236:239]
    v_cvt_pk_bf16_f32 v8, v40, v41
    v_cvt_pk_bf16_f32 v9, v42, v43
    v_cvt_pk_bf16_f32 v10, v44, v45
    v_cvt_pk_bf16_f32 v11, v46, v47
    ds_write_b128 v208, v[8:11] offset:0
    ds_read_b128 v[24:27], v199 offset:0
    v_pk_add_f32 v[160:161], v[216:217], v[224:225] neg_lo:[0,1] neg_hi:[0,1]
    v_pk_add_f32 v[162:163], v[218:219], v[226:227] neg_lo:[0,1] neg_hi:[0,1]
    v_pk_add_f32 v[164:165], v[220:221], v[228:229] neg_lo:[0,1] neg_hi:[0,1]
    v_pk_add_f32 v[166:167], v[222:223], v[230:231] neg_lo:[0,1] neg_hi:[0,1]
    s_cmp_eq_u64 s[62:63], 0
    s_cbranch_scc1 L_nodump0
    s_mov_b64 exec, s[54:55]
    ds_write_b128 v6, v[152:155] offset:42496
    ds_write_b128 v6, v[156:159] offset:42512
    s_mov_b64 exec, s[58:59]
    ds_write_b128 v6, v[160:163] offset:42496
    ds_write_b128 v6, v[164:167] offset:42512
    s_mov_b64 exec, 1
    ds_add_u32 v0, v255 offset:42836
    s_mov_b64 exec, -1
    s_waitcnt lgkmcnt(0)
L_nodump0:
    v_pk_fma_f32 v[56:57], v[160:161], v[136:137], v[56:57]
    v_pk_fma_f32 v[58:59], v[162:163], v[138:139], v[58:59]
    v_pk_fma_f32 v[60:61], v[164:165], v[140:141], v[60:61]
    v_pk_fma_f32 v[62:63], v[166:167], v[142:143], v[62:63]
    v_cvt_pk_bf16_f32 v16, v56, v57
    v_cvt_pk_bf16_f32 v17, v58, v59
    v_cvt_pk_bf16_f32 v18, v60, v61
    v_cvt_pk_bf16_f32 v19, v62, v63
    ds_write_b128 v208, v[16:19] offset:2048
    ds_read_b128 v[32:35], v199 offset:2048
    s_waitcnt lgkmcnt(2)
    buffer_store_dwordx4 v[24:27], v4, s[16:19], 0 offen sc1
    v_add_f32 v152, v232, v236
    v_sub_f32 v160, v232, v236
    s_cmp_eq_u64 s[64:65], 0
    s_cbranch_scc1 L_nodump1
    s_mov_b64 exec, s[56:57]
    ds_write_b128 v6, v[152:155] offset:42624
    ds_write_b128 v6, v[156:159] offset:42640
    s_mov_b64 exec, s[60:61]
    ds_write_b128 v6, v[160:163] offset:42624
    ds_write_b128 v6, v[164:167] offset:42640
    s_mov_b64 exec, 1
    ds_add_u32 v0, v255 offset:42864
    s_mov_b64 exec, -1
    s_waitcnt lgkmcnt(0)
L_nodump1:
    v_pk_fma_f32 v[48:49], v[152:153], v[128:129], v[48:49]
    v_pk_fma_f32 v[50:51], v[154:155], v[130:131], v[50:51]
    v_pk_fma_f32 v[52:53], v[156:157], v[132:133], v[52:53]
    v_pk_fma_f32 v[54:55], v[158:159], v[134:135], v[54:55]
    v_cvt_pk_bf16_f32 v12, v48, v55
    v_cvt_pk_bf16_f32 v13, v54, v53
    v_cvt_pk_bf16_f32 v14, v52, v51
    v_cvt_pk_bf16_f32 v15, v50, v49
    ds_write_b128 v208, v[12:15] offset:1024
    ds_read_b128 v[28:31], v199 offset:1024
    s_waitcnt lgkmcnt(2)
    buffer_store_dwordx4 v[32:35], v249, s[16:19], 0 offen sc1
    v_pk_fma_f32 v[64:65], v[160:161], v[144:145], v[64:65]
    v_pk_fma_f32 v[66:67], v[162:163], v[146:147], v[66:67]
    v_pk_fma_f32 v[68:69], v[164:165], v[148:149], v[68:69]
    v_pk_fma_f32 v[70:71], v[166:167], v[150:151], v[70:71]
    v_cvt_pk_bf16_f32 v20, v64, v71
    v_cvt_pk_bf16_f32 v21, v70, v69
    v_cvt_pk_bf16_f32 v22, v68, v67
    v_cvt_pk_bf16_f32 v23, v66, v65
    ds_write_b128 v208, v[20:23] offset:3072
    ds_read_b128 v[36:39], v199 offset:3072
    s_waitcnt lgkmcnt(2)
    buffer_store_dwordx4 v[28:31], v5, s[16:19], 0 offen sc1
    s_waitcnt lgkmcnt(0)
    buffer_store_dwordx4 v[36:39], v205, s[16:19], 0 offen sc1
    s_branch L_fin
L_dma_done:
    s_setprio 3
    s_lshr_b32 s31, s47, 2
    s_andn2_b32 s31, s31, s75
    s_add_u32 s50, s31, s46
    s_lshl_b32 s31, s50, 17
    s_bfe_u32 s32, s2, 0x20003
    s_lshl_b32 s32, s32, 2
    s_add_u32 s51, s32, s30
    s_lshl_b32 s32, s51, 7
    s_add_u32 s31, s31, s32
    v_lshrrev_b32 v6, 3, v2
    v_lshlrev_b32 v6, 14, v6
    v_and_b32 v7, 0x70, v3
    v_add3_u32 v6, v6, v7, s31
    s_mov_b32 s60, 4096
    s_mov_b32 s61, 8192
    s_mov_b32 s62, 12288
    v_bfe_u32 v8, v2, 2, 3
    v_lshlrev_b32 v9, 5, v8
    s_lshl_b32 s31, s30, 6
    v_xor_b32 v9, s31, v9
    v_bfe_u32 v8, v2, 2, 2
    v_lshl_add_u32 v9, v8, 8, v9
    v_lshrrev_b32 v8, 4, v2
    v_lshl_add_u32 v9, v8, 11, v9
    v_and_b32 v10, 3, v2
    v_lshl_add_u32 v9, v10, 3, v9
    v_add_u32 v9, 76800, v9
    v_xor_b32 v10, 32, v9
    v_lshlrev_b32 v8, 4, v8
    s_lshr_b32 s31, s30, 1
    s_and_b32 s32, s31, s75
    s_lshl_b32 s32, s32, 8
    v_add_u32 v8, s32, v8
    s_cmp_eq_u32 s75, 0
    s_cselect_b32 s32, 12, 9
    s_lshl_b32 s31, s31, s32
    s_lshl_b32 s32, s46, 3
    s_add_u32 s32, s32, s47
    s_lshl_b32 s32, s32, 9
    s_add_u32 s31, s31, s32
    s_and_b32 s32, s30, 1
    s_lshl_b32 s32, s32, 8
    s_add_u32 s31, s31, s32
    s_add_u32 s31, s31, 262144
    v_lshl_add_u32 v13, v2, 3, s31
    s_waitcnt lgkmcnt(0)
    s_add_u32 s28, s28, 0x7f4a7c15
    s_addc_u32 s29, s29, 0x9e3779b9
    s_and_b32 s31, s28, 0xff
    v_mov_b32 v14, s31
    s_mov_b32 s49, 0xffffff00
    s_cmp_lg_u32 s30, 2
    s_cbranch_scc1 L_no_tlb
    s_mov_b32 s52, s44
    s_mov_b32 s53, s45
    s_mov_b32 s54, 0x400000
    s_mov_b32 s55, 0x00020000
    v_lshlrev_b32 v250, 20, v2
    s_mov_b64 exec, 0xff
    buffer_load_dword v251, v250, s[12:15], 0 offen
    buffer_load_dword v252, v250, s[52:55], 0 offen
    buffer_load_dword v253, v250, s[24:27], 0 offen
    s_mov_b64 exec, -1
L_no_tlb:
    s_cmp_lg_u32 s66, 0
    s_cbranch_scc1 L_tagged
    s_mov_b64 exec, 1
    ds_add_u32 v0, v255 offset:42872
    s_mov_b64 exec, -1
L_tagged:
    s_cmp_eq_u32 s30, 3
    s_cbranch_scc1 L_h1
    s_cmp_eq_u32 s66, 0
    s_cbranch_scc1 L_key
    s_cmp_lg_u32 s30, 0
    s_cbranch_scc1 L_follower
    s_waitcnt vmcnt(16)
    s_mov_b64 exec, 1
    ds_add_u32 v0, v255 offset:42868
    s_mov_b64 exec, -1
    ds_read_b64_tr_b16 v[36:37], v9 offset:0
    ds_read_b64_tr_b16 v[38:39], v9 offset:1024
    ds_read_b64_tr_b16 v[40:41], v10 offset:0
    ds_read_b64_tr_b16 v[42:43], v10 offset:1024
    ds_read_b64_tr_b16 v[44:45], v9 offset:32768
    ds_read_b64_tr_b16 v[46:47], v9 offset:33792
    ds_read_b64_tr_b16 v[48:49], v10 offset:32768
    ds_read_b64_tr_b16 v[50:51], v10 offset:33792
    ds_read_b64_tr_b16 v[52:53], v9 offset:8192
    ds_read_b64_tr_b16 v[54:55], v9 offset:9216
    ds_read_b64_tr_b16 v[56:57], v10 offset:8192
    ds_read_b64_tr_b16 v[58:59], v10 offset:9216
    ds_read_b64_tr_b16 v[60:61], v9 offset:40960
    ds_read_b64_tr_b16 v[62:63], v9 offset:41984
    s_waitcnt lgkmcnt(12)
    ds_read_b64_tr_b16 v[64:65], v10 offset:40960
    ds_read_b64_tr_b16 v[66:67], v10 offset:41984
    s_waitcnt lgkmcnt(12)
    ds_read_b64_tr_b16 v[68:69], v9 offset:16384
    ds_read_b64_tr_b16 v[70:71], v9 offset:17408
    s_waitcnt lgkmcnt(12)
    ds_read_b64_tr_b16 v[72:73], v10 offset:16384
    ds_read_b64_tr_b16 v[74:75], v10 offset:17408
    s_waitcnt lgkmcnt(12)
    ds_read_b64_tr_b16 v[76:77], v9 offset:49152
    ds_read_b64_tr_b16 v[78:79], v9 offset:50176
    s_waitcnt lgkmcnt(12)
    ds_read_b64_tr_b16 v[80:81], v10 offset:49152
    ds_read_b64_tr_b16 v[82:83], v10 offset:50176
    s_waitcnt vmcnt(8)
    s_mov_b64 exec, 1
    ds_add_u32 v0, v255 offset:42868
    s_mov_b64 exec, -1
    s_branch L_key
L_follower:
    s_and_b32 s32, s30, 1
    s_lshl_b32 s32, s32, 8
    v_subrev_u32 v250, s32, v13
    buffer_load_dword v251, v250, s[12:15], 0 offen
    s_lshl_b32 s31, s50, 12
    s_sub_u32 s31, s31, s32
    s_lshl_b32 s32, s51, 8
    s_add_u32 s31, s31, s32
    s_add_u32 s31, s31, 524288
    v_lshl_add_u32 v250, v2, 3, s31
    buffer_load_dword v252, v250, s[12:15], 0 offen
L_sync9:
    ds_read_b32 v1, v0 offset:42868
    s_waitcnt lgkmcnt(0)
    v_readfirstlane_b32 s31, v1
    s_nop 0
    s_cmp_ge_u32 s31, 1
    s_cbranch_scc0 L_sync9
    ds_read_b64_tr_b16 v[36:37], v9 offset:0
    ds_read_b64_tr_b16 v[38:39], v9 offset:1024
    ds_read_b64_tr_b16 v[40:41], v10 offset:0
    ds_read_b64_tr_b16 v[42:43], v10 offset:1024
    ds_read_b64_tr_b16 v[44:45], v9 offset:32768
    ds_read_b64_tr_b16 v[46:47], v9 offset:33792
    ds_read_b64_tr_b16 v[48:49], v10 offset:32768
    ds_read_b64_tr_b16 v[50:51], v10 offset:33792
    ds_read_b64_tr_b16 v[52:53], v9 offset:8192
    ds_read_b64_tr_b16 v[54:55], v9 offset:9216
    ds_read_b64_tr_b16 v[56:57], v10 offset:8192
    ds_read_b64_tr_b16 v[58:59], v10 offset:9216
    ds_read_b64_tr_b16 v[60:61], v9 offset:40960
    ds_read_b64_tr_b16 v[62:63], v9 offset:41984
    s_waitcnt lgkmcnt(12)
    ds_read_b64_tr_b16 v[64:65], v10 offset:40960
    ds_read_b64_tr_b16 v[66:67], v10 offset:41984
    s_waitcnt lgkmcnt(12)
    ds_read_b64_tr_b16 v[68:69], v9 offset:16384
    ds_read_b64_tr_b16 v[70:71], v9 offset:17408
    s_waitcnt lgkmcnt(12)
    ds_read_b64_tr_b16 v[72:73], v10 offset:16384
    ds_read_b64_tr_b16 v[74:75], v10 offset:17408
    s_waitcnt lgkmcnt(12)
    ds_read_b64_tr_b16 v[76:77], v9 offset:49152
    ds_read_b64_tr_b16 v[78:79], v9 offset:50176
    s_waitcnt lgkmcnt(12)
    ds_read_b64_tr_b16 v[80:81], v10 offset:49152
    ds_read_b64_tr_b16 v[82:83], v10 offset:50176
    s_add_u32 s67, s30, 0
L_sync10:
    ds_read_b32 v1, v0 offset:42868
    s_waitcnt lgkmcnt(0)
    v_readfirstlane_b32 s31, v1
    s_nop 0
    s_cmp_ge_u32 s31, s67
    s_cbranch_scc0 L_sync10
L_d_first:
L_sync11:
    ds_read_b32 v1, v0 offset:42840
    s_waitcnt lgkmcnt(0)
    v_readfirstlane_b32 s31, v1
    s_nop 0
    s_cmp_ge_u32 s31, 1
    s_cbranch_scc0 L_sync11
    buffer_load_dwordx4 v[100:103], v6, s[24:27], 0 offen offset:0 nt
    buffer_load_dwordx4 v[104:107], v6, s[24:27], 0 offen offset:2048 nt
    buffer_load_dwordx4 v[108:111], v6, s[24:27], s60 offen offset:0 nt
    buffer_load_dwordx4 v[112:115], v6, s[24:27], s60 offen offset:2048 nt
    buffer_load_dwordx4 v[116:119], v6, s[24:27], s61 offen offset:0 nt
    buffer_load_dwordx4 v[120:123], v6, s[24:27], s61 offen offset:2048 nt
    buffer_load_dwordx4 v[124:127], v6, s[24:27], s62 offen offset:0 nt
    buffer_load_dwordx4 v[128:131], v6, s[24:27], s62 offen offset:2048 nt
L_key:
    s_waitcnt lgkmcnt(0)
L_sync12:
    ds_read_b32 v1, v0 offset:42844
    ds_read_b64 v[18:19], v0 offset:41552
    ds_read_b128 v[20:23], v8 offset:41600
    ds_read_b128 v[24:27], v8 offset:41664
    ds_read_b128 v[28:31], v8 offset:41728
    ds_read_b128 v[32:35], v8 offset:41792
    s_waitcnt lgkmcnt(5)
    v_readfirstlane_b32 s31, v1
    s_nop 0
    s_cmp_ge_u32 s31, 1
    s_cbranch_scc0 L_sync12
    s_cmp_eq_u32 s66, 0
    s_cbranch_scc1 L_idle
    s_branch L_xs_ok
L_h1:
    s_mov_b32 s63, 4096
    s_lshl_b32 s31, s47, 8
    v_lshlrev_b32 v15, 3, v2
    v_add_u32 v16, s31, v15
    s_cmp_lg_u32 s66, 0
    s_cbranch_scc1 L_gate
L_sync13:
    ds_read_b32 v1, v0 offset:42828
    s_waitcnt lgkmcnt(0)
    v_readfirstlane_b32 s31, v1
    s_nop 0
    s_cmp_ge_u32 s31, 4
    s_cbranch_scc0 L_sync13
    s_branch L_gate_open
L_gate:
L_sync14:
    ds_read_b32 v1, v0 offset:42824
    s_waitcnt lgkmcnt(0)
    v_readfirstlane_b32 s31, v1
    s_nop 0
    s_cmp_ge_u32 s31, 4
    s_cbranch_scc0 L_sync14
L_gate_open:
    buffer_load_dwordx4 v[20:23], v3, s[12:15], s63 offen offset:0 sc1
    buffer_load_dwordx4 v[24:27], v3, s[12:15], s63 offen offset:1024 sc1
    buffer_load_dwordx4 v[28:31], v3, s[12:15], s63 offen offset:2048 sc1
    buffer_load_dwordx4 v[32:35], v3, s[12:15], s63 offen offset:3072 sc1
    s_mov_b64 exec, 1
    ds_add_u32 v0, v255 offset:42860
    s_mov_b64 exec, -1
    s_waitcnt vmcnt(0)
L_mi_check:
    v_cmp_ne_u64 s[52:53], s[28:29], v[22:23]
    v_cmp_ne_u64 s[54:55], s[28:29], v[26:27]
    v_cmp_ne_u64 s[56:57], s[28:29], v[30:31]
    v_cmp_ne_u64 s[58:59], s[28:29], v[34:35]
    v_max_u32 v18, v21, v25
    v_max3_u32 v18, v18, v29, v33
    s_or_b64 s[64:65], s[52:53], s[54:55]
    s_or_b64 vcc, s[56:57], s[58:59]
    s_or_b64 s[64:65], s[64:65], vcc
    s_cbranch_scc0 L_mi_got
    s_cmp_eq_u32 s35, 0
    s_cbranch_scc1 L_mi_got
    s_sub_u32 s35, s35, 1
    s_sleep 2
    s_mov_b64 exec, s[52:53]
    s_cbranch_execz L_mi_skip0
    buffer_load_dwordx4 v[20:23], v3, s[12:15], s63 offen offset:0 sc1
L_mi_skip0:
    s_mov_b64 exec, s[54:55]
    s_cbranch_execz L_mi_skip1
    buffer_load_dwordx4 v[24:27], v3, s[12:15], s63 offen offset:1024 sc1
L_mi_skip1:
    s_mov_b64 exec, s[56:57]
    s_cbranch_execz L_mi_skip2
    buffer_load_dwordx4 v[28:31], v3, s[12:15], s63 offen offset:2048 sc1
L_mi_skip2:
    s_mov_b64 exec, s[58:59]
    s_cbranch_execz L_mi_skip3
    buffer_load_dwordx4 v[32:35], v3, s[12:15], s63 offen offset:3072 sc1
L_mi_skip3:
    s_mov_b64 exec, -1
    s_waitcnt vmcnt(0)
    s_branch L_mi_check
L_mi_got:
    v_max_u32_dpp v19, v18, v18 row_ror:1 row_mask:0xf bank_mask:0xf
    s_nop 1
    v_max_u32_dpp v19, v19, v19 row_ror:2 row_mask:0xf bank_mask:0xf
    s_nop 1
    v_max_u32_dpp v19, v19, v19 row_ror:4 row_mask:0xf bank_mask:0xf
    s_nop 1
    v_max_u32_dpp v19, v19, v19 row_ror:8 row_mask:0xf bank_mask:0xf
    s_nop 0
    v_readlane_b32 s33, v19, 0
    v_readlane_b32 s31, v19, 16
    v_readlane_b32 s32, v19, 32
    v_readlane_b32 s34, v19, 48
    s_max_u32 s33, s33, s31
    s_max_u32 s32, s32, s34
    s_max_u32 s33, s33, s32
    s_andn2_b32 s31, 0x7ff, s33
    s_lshl_b32 s48, s31, 11
    buffer_load_dwordx2 v[150:151], v16, s[8:11], s48 offen
    s_mov_b64 exec, 1
    ds_add_u32 v0, v255 offset:42840
    s_mov_b64 exec, -1
    v_cmp_eq_u32 s[52:53], s33, v25
    v_cmp_eq_u32 s[54:55], s33, v29
    v_cmp_eq_u32 s[56:57], s33, v33
    v_cmp_eq_u32 vcc, s33, v18
    v_cndmask_b32 v19, v20, v24, s[52:53]
    v_cndmask_b32 v19, v19, v28, s[54:55]
    v_cndmask_b32 v19, v19, v32, s[56:57]
    s_ff1_i32_b64 s32, vcc
    v_readlane_b32 s34, v19, s32
    v_mov_b32 v19, s33
    s_nop 0
    v_mov_b32 v18, s34
    ds_write_b64 v0, v[18:19] offset:41552
    s_lshl_b32 s52, s34, 16
    s_and_b32 s32, s34, 0xffff0000
    v_rcp_f32 v148, s32
    s_waitcnt vmcnt(0)
    v_lshlrev_b32 v20, 16, v150
    v_and_b32 v21, 0xffff0000, v150
    v_lshlrev_b32 v22, 16, v151
    v_and_b32 v23, 0xffff0000, v151
    v_pk_add_f32 v[20:21], v[20:21], s[52:53] op_sel_hi:[1,0] neg_lo:[0,1] neg_hi:[0,1]
    v_pk_add_f32 v[22:23], v[22:23], s[52:53] op_sel_hi:[1,0] neg_lo:[0,1] neg_hi:[0,1]
    v_cvt_pk_bf16_f32 v150, v20, v21
    v_cvt_pk_bf16_f32 v151, v22, v23
    v_lshlrev_b32 v20, 16, v150
    v_and_b32 v21, 0xffff0000, v150
    v_lshlrev_b32 v22, 16, v151
    v_and_b32 v23, 0xffff0000, v151
    v_pk_mul_f32 v[20:21], v[20:21], v[148:149] op_sel_hi:[1,0]
    v_pk_mul_f32 v[22:23], v[22:23], v[148:149] op_sel_hi:[1,0]
    v_cvt_pk_bf16_f32 v150, v20, v21
    v_cvt_pk_bf16_f32 v151, v22, v23
    ds_write_b64 v15, v[150:151] offset:41600
    s_mov_b64 exec, 1
    ds_add_u32 v0, v255 offset:42844
    s_mov_b64 exec, -1
    s_cmp_eq_u32 s66, 0
    s_cbranch_scc1 L_idle
L_sync15:
    ds_read_b32 v1, v0 offset:42868
    s_waitcnt lgkmcnt(0)
    v_readfirstlane_b32 s31, v1
    s_nop 0
    s_cmp_ge_u32 s31, 1
    s_cbranch_scc0 L_sync15
    ds_read_b64_tr_b16 v[36:37], v9 offset:0
    ds_read_b64_tr_b16 v[38:39], v9 offset:1024
    ds_read_b64_tr_b16 v[40:41], v10 offset:0
    ds_read_b64_tr_b16 v[42:43], v10 offset:1024
    ds_read_b64_tr_b16 v[44:45], v9 offset:32768
    ds_read_b64_tr_b16 v[46:47], v9 offset:33792
    ds_read_b64_tr_b16 v[48:49], v10 offset:32768
    ds_read_b64_tr_b16 v[50:51], v10 offset:33792
    ds_read_b64_tr_b16 v[52:53], v9 offset:8192
    ds_read_b64_tr_b16 v[54:55], v9 offset:9216
    ds_read_b64_tr_b16 v[56:57], v10 offset:8192
    ds_read_b64_tr_b16 v[58:59], v10 offset:9216
    ds_read_b64_tr_b16 v[60:61], v9 offset:40960
    ds_read_b64_tr_b16 v[62:63], v9 offset:41984
    s_waitcnt lgkmcnt(12)
    ds_read_b64_tr_b16 v[64:65], v10 offset:40960
    ds_read_b64_tr_b16 v[66:67], v10 offset:41984
    s_waitcnt lgkmcnt(12)
    ds_read_b64_tr_b16 v[68:69], v9 offset:16384
    ds_read_b64_tr_b16 v[70:71], v9 offset:17408
    s_waitcnt lgkmcnt(12)
    ds_read_b64_tr_b16 v[72:73], v10 offset:16384
    ds_read_b64_tr_b16 v[74:75], v10 offset:17408
    s_waitcnt lgkmcnt(12)
    ds_read_b64_tr_b16 v[76:77], v9 offset:49152
    ds_read_b64_tr_b16 v[78:79], v9 offset:50176
    s_waitcnt lgkmcnt(12)
    ds_read_b64_tr_b16 v[80:81], v10 offset:49152
    ds_read_b64_tr_b16 v[82:83], v10 offset:50176
    s_waitcnt lgkmcnt(8)
    ds_read_b128 v[20:23], v8 offset:41600
    ds_read_b128 v[24:27], v8 offset:41664
    ds_read_b128 v[28:31], v8 offset:41728
    ds_read_b128 v[32:35], v8 offset:41792
L_xs_ok:
    s_waitcnt lgkmcnt(3)
    v_mfma_f32_16x16x32_bf16 v[132:135], v[20:23], v[36:39], 0
    v_mfma_f32_16x16x32_bf16 v[136:139], v[20:23], v[40:43], 0
    v_mfma_f32_16x16x32_bf16 v[140:143], v[20:23], v[44:47], 0
    v_mfma_f32_16x16x32_bf16 v[144:147], v[20:23], v[48:51], 0
    s_waitcnt lgkmcnt(2)
    v_mfma_f32_16x16x32_bf16 v[132:135], v[24:27], v[52:55], v[132:135]
    v_mfma_f32_16x16x32_bf16 v[136:139], v[24:27], v[56:59], v[136:139]
    v_mfma_f32_16x16x32_bf16 v[140:143], v[24:27], v[60:63], v[140:143]
    v_mfma_f32_16x16x32_bf16 v[144:147], v[24:27], v[64:67], v[144:147]
    s_waitcnt lgkmcnt(1)
    v_mfma_f32_16x16x32_bf16 v[132:135], v[28:31], v[68:71], v[132:135]
    v_mfma_f32_16x16x32_bf16 v[136:139], v[28:31], v[72:75], v[136:139]
    v_mfma_f32_16x16x32_bf16 v[140:143], v[28:31], v[76:79], v[140:143]
    v_mfma_f32_16x16x32_bf16 v[144:147], v[28:31], v[80:83], v[144:147]
    s_cmp_lg_u32 s30, 0
    s_cbranch_scc1 L_k3_wait
    s_waitcnt vmcnt(0)
    s_mov_b64 exec, 1
    ds_add_u32 v0, v255 offset:42868
    s_mov_b64 exec, -1
L_k3_wait:
    s_branch L_sync16a
L_sync16:
    s_waitcnt lgkmcnt(0)
L_sync16a:
    ds_read_b32 v1, v0 offset:42868
    ds_read_b64_tr_b16 v[84:85], v9 offset:24576
    ds_read_b64_tr_b16 v[86:87], v9 offset:25600
    ds_read_b64_tr_b16 v[88:89], v10 offset:24576
    ds_read_b64_tr_b16 v[90:91], v10 offset:25600
    ds_read_b64_tr_b16 v[92:93], v9 offset:57344
    ds_read_b64_tr_b16 v[94:95], v9 offset:58368
    ds_read_b64_tr_b16 v[96:97], v10 offset:57344
    ds_read_b64_tr_b16 v[98:99], v10 offset:58368
    s_waitcnt lgkmcnt(8)
    v_readfirstlane_b32 s31, v1
    s_nop 0
    s_cmp_ge_u32 s31, 3
    s_cbranch_scc0 L_sync16
    v_readfirstlane_b32 s33, v19
    v_readfirstlane_b32 s34, v18
    s_waitcnt lgkmcnt(6)
    v_mfma_f32_16x16x32_bf16 v[132:135], v[32:35], v[84:87], v[132:135]
    s_waitcnt lgkmcnt(4)
    v_mfma_f32_16x16x32_bf16 v[136:139], v[32:35], v[88:91], v[136:139]
    s_waitcnt lgkmcnt(2)
    v_mfma_f32_16x16x32_bf16 v[140:143], v[32:35], v[92:95], v[140:143]
    s_waitcnt lgkmcnt(0)
    v_mfma_f32_16x16x32_bf16 v[144:147], v[32:35], v[96:99], v[144:147]
    s_mov_b32 vcc_lo, 0xffff0000
    s_mov_b32 vcc_hi, 0
    s_lshl_b32 s31, s50, 12
    s_lshl_b32 s32, s30, 7
    s_add_u32 s31, s31, s32
    s_add_u32 s31, s31, 262144
    v_lshrrev_b32 v15, 3, v2
    v_lshlrev_b32 v15, 9, v15
    v_add3_u32 v15, v15, v7, s31
    v_cndmask_b32 v26, v132, v136, vcc
    v_cndmask_b32 v27, v140, v144, vcc
    v_and_or_b32 v26, v26, s49, v14
    v_and_or_b32 v27, v27, s49, v14
    s_mov_b32 exec_hi, 0
    buffer_store_dwordx2 v[26:27], v13, s[12:15], 0 offen sc1
    s_mov_b64 exec, -1
    s_sub_u32 s31, s30, 1
    s_cmp_lt_u32 s31, 2
    s_cbranch_scc1 L_d_rest
    buffer_load_dwordx4 v[100:103], v6, s[24:27], 0 offen offset:0 nt
    buffer_load_dwordx4 v[104:107], v6, s[24:27], 0 offen offset:2048 nt
    buffer_load_dwordx4 v[108:111], v6, s[24:27], s60 offen offset:0 nt
    buffer_load_dwordx4 v[112:115], v6, s[24:27], s60 offen offset:2048 nt
    buffer_load_dwordx4 v[116:119], v6, s[24:27], s61 offen offset:0 nt
    buffer_load_dwordx4 v[120:123], v6, s[24:27], s61 offen offset:2048 nt
    buffer_load_dwordx4 v[124:127], v6, s[24:27], s62 offen offset:0 nt
    buffer_load_dwordx4 v[128:131], v6, s[24:27], s62 offen offset:2048 nt
L_d_rest:
    s_mov_b64 exec, 1
    ds_add_u32 v0, v255 offset:42848
    s_mov_b64 exec, -1
    s_cmp_eq_u32 s30, 1
    s_cselect_b32 s31, s2, 0
    s_cmp_lt_u32 s31, 192
    s_cbranch_scc1 L_no_hint
    s_and_b32 s31, s2, 31
    s_lshl_b32 s31, s31, 7
    s_add_u32 s31, s31, 12288
    v_mov_b32 v250, s28
    v_mov_b32 v251, s29
    s_mov_b64 exec, 1
    buffer_store_dwordx2 v[250:251], v0, s[12:15], s31 offen sc1
    s_mov_b64 exec, -1
L_no_hint:
    s_mov_b32 s52, 0x05040100
    s_mov_b32 s53, 0x07060302
    v_mov_b32 v36, 0
    v_mov_b32 v37, 0
    v_mov_b32 v38, 0
    v_mov_b32 v39, 0
    v_mov_b32 v40, 0
    v_mov_b32 v41, 0
    v_mov_b32 v42, 0
    v_mov_b32 v43, 0
    v_and_b32 v16, 7, v2
    v_lshlrev_b32 v16, 2, v16
    v_lshrrev_b32 v17, 5, v2
    v_lshl_add_u32 v16, v17, 1, v16
    s_lshl_b32 s31, s30, 5
    v_add_u32 v16, s31, v16
    v_lshrrev_b32 v17, 3, v2
    v_lshlrev_b32 v17, 4, v17
    s_lshl_b32 s31, s50, 12
    s_lshl_b32 s32, s51, 8
    s_add_u32 s31, s31, s32
    s_add_u32 s31, s31, 524288
    v_lshlrev_b32 v18, 1, v7
    v_lshrrev_b32 v19, 4, v2
    v_lshl_add_u32 v18, v19, 3, v18
    v_add_u32 v18, s31, v18
    s_waitcnt vmcnt(6)
    v_perm_b32 v98, v104, v100, s52
    v_perm_b32 v104, v104, v100, s53
    v_perm_b32 v100, v105, v101, s52
    v_perm_b32 v105, v105, v101, s53
    v_perm_b32 v101, v106, v102, s52
    v_perm_b32 v106, v106, v102, s53
    v_perm_b32 v102, v107, v103, s52
    v_perm_b32 v107, v107, v103, s53
    s_waitcnt vmcnt(4)
    v_perm_b32 v103, v112, v108, s52
    v_perm_b32 v112, v112, v108, s53
    v_perm_b32 v108, v113, v109, s52
    v_perm_b32 v113, v113, v109, s53
    v_perm_b32 v109, v114, v110, s52
    v_perm_b32 v114, v114, v110, s53
    v_perm_b32 v110, v115, v111, s52
    v_perm_b32 v115, v115, v111, s53
    s_waitcnt vmcnt(2)
    v_perm_b32 v111, v120, v116, s52
    v_perm_b32 v120, v120, v116, s53
    v_perm_b32 v116, v121, v117, s52
    v_perm_b32 v121, v121, v117, s53
    v_perm_b32 v117, v122, v118, s52
    v_perm_b32 v122, v122, v118, s53
    v_perm_b32 v118, v123, v119, s52
    v_perm_b32 v123, v123, v119, s53
    s_waitcnt vmcnt(0)
    v_perm_b32 v119, v128, v124, s52
    v_perm_b32 v128, v128, v124, s53
    v_perm_b32 v124, v129, v125, s52
    v_perm_b32 v129, v129, v125, s53
    v_perm_b32 v125, v130, v126, s52
    v_perm_b32 v130, v130, v126, s53
    v_perm_b32 v126, v131, v127, s52
    v_perm_b32 v131, v131, v127, s53
    s_mov_b32 s54, 0
L_hp_poll:
    buffer_load_dwordx4 v[20:23], v15, s[12:15], 0 offen sc1
L_hp_wait:
    s_waitcnt vmcnt(0)
    v_xor_b32 v20, v14, v20
    v_xor_b32 v21, v14, v21
    v_xor_b32 v22, v14, v22
    v_xor_b32 v23, v14, v23
    v_or3_b32 v24, v20, v21, v22
    v_or_b32 v24, v24, v23
    v_and_b32 v24, 0xff, v24
    v_cmp_ne_u32 vcc, 0, v24
    v_permlane16_swap_b32 v20, v21
    v_permlane16_swap_b32 v22, v23
    s_cbranch_vccz L_hp_got
    s_cmp_eq_u32 s35, 0
    s_cbranch_scc1 L_hp_got
    s_sub_u32 s35, s35, 1
    s_branch L_hp_poll
L_hp_got:
    v_add_f32 v20, v20, v21
    v_add_f32 v22, v22, v23
    s_nop 1
    v_permlane32_swap_b32 v20, v22
    v_add_f32 v20, v20, v22
    s_nop 1
    v_add_f32_dpp v21, v20, v20 row_ror:8 row_mask:0xf bank_mask:0xf
    v_add_f32_dpp v20, v20, v20 row_ror:8 row_mask:0xf bank_mask:0xf
    s_nop 1
    v_permlane16_swap_b32 v20, v21
    v_cvt_pk_bf16_f32 v20, v20, v21
    v_and_b32 v21, 0xffff0000, v20
    v_lshlrev_b32 v20, 16, v20
    v_mul_f32 v22, 0xbfb8aa3b, v20
    v_exp_f32 v22, v22
    s_nop 0
    v_add_f32 v22, 1.0, v22
    v_rcp_f32 v22, v22
    s_nop 0
    v_mul_f32 v20, v20, v22
    v_cvt_pk_bf16_f32 v20, v20, v20
    v_lshlrev_b32 v20, 16, v20
    v_mul_f32 v20, v20, v21
    v_cvt_pk_bf16_f32 v20, v20, v20
    ds_write_b16 v16, v20 offset:42368
    s_mov_b64 exec, 1
    ds_add_u32 v0, v255 offset:42852
    s_mov_b64 exec, -1
L_sync17:
    ds_read_b32 v1, v0 offset:42852
    ds_read_b128 v[28:31], v17 offset:42368
    s_waitcnt lgkmcnt(1)
    v_readfirstlane_b32 s31, v1
    s_nop 0
    s_cmp_ge_u32 s31, 4
    s_cbranch_scc0 L_sync17
    s_waitcnt lgkmcnt(0)
    v_dot2c_f32_bf16 v36, v28, v98
    v_dot2c_f32_bf16 v37, v28, v104
    v_dot2c_f32_bf16 v38, v28, v100
    v_dot2c_f32_bf16 v39, v28, v105
    v_dot2c_f32_bf16 v40, v28, v101
    v_dot2c_f32_bf16 v41, v28, v106
    v_dot2c_f32_bf16 v42, v28, v102
    v_dot2c_f32_bf16 v43, v28, v107
    v_dot2c_f32_bf16 v36, v29, v103
    v_dot2c_f32_bf16 v37, v29, v112
    v_dot2c_f32_bf16 v38, v29, v108
    v_dot2c_f32_bf16 v39, v29, v113
    v_dot2c_f32_bf16 v40, v29, v109
    v_dot2c_f32_bf16 v41, v29, v114
    v_dot2c_f32_bf16 v42, v29, v110
    v_dot2c_f32_bf16 v43, v29, v115
    v_dot2c_f32_bf16 v36, v30, v111
    v_dot2c_f32_bf16 v37, v30, v120
    v_dot2c_f32_bf16 v38, v30, v116
    v_dot2c_f32_bf16 v39, v30, v121
    v_dot2c_f32_bf16 v40, v30, v117
    v_dot2c_f32_bf16 v41, v30, v122
    v_dot2c_f32_bf16 v42, v30, v118
    v_dot2c_f32_bf16 v43, v30, v123
    v_dot2c_f32_bf16 v36, v31, v119
    v_dot2c_f32_bf16 v37, v31, v128
    v_dot2c_f32_bf16 v38, v31, v124
    v_dot2c_f32_bf16 v39, v31, v129
    v_dot2c_f32_bf16 v40, v31, v125
    v_dot2c_f32_bf16 v41, v31, v130
    v_dot2c_f32_bf16 v42, v31, v126
    v_dot2c_f32_bf16 v43, v31, v131
    v_permlane32_swap_b32 v36, v40
    v_permlane32_swap_b32 v37, v41
    v_permlane32_swap_b32 v38, v42
    v_permlane32_swap_b32 v39, v43
    v_add_f32 v36, v36, v40
    v_add_f32 v37, v37, v41
    v_add_f32 v38, v38, v42
    v_add_f32 v39, v39, v43
    s_nop 0
    v_permlane16_swap_b32 v36, v38
    v_permlane16_swap_b32 v37, v39
    v_add_f32 v36, v36, v38
    v_add_f32 v37, v37, v39
    s_nop 0
    v_add_f32_dpp v36, v36, v36 row_ror:8 row_mask:0xf bank_mask:0xf
    v_add_f32_dpp v37, v37, v37 row_ror:8 row_mask:0xf bank_mask:0xf
    v_and_or_b32 v36, v36, s49, v14
    v_and_or_b32 v37, v37, s49, v14
    s_mov_b32 exec_lo, 0x00ff00ff
    s_mov_b32 exec_hi, 0x00ff00ff
    buffer_store_dwordx2 v[36:37], v18, s[12:15], 0 offen sc1
    s_mov_b64 exec, 1
    ds_add_u32 v0, v255 offset:42856
    s_mov_b64 exec, -1
    s_branch L_owner
L_idle:
    s_mov_b64 exec, 1
    ds_add_u32 v0, v255 offset:42868
    s_mov_b64 exec, -1
    s_and_b32 s52, s2, 31
    s_lshl_b32 s52, s52, 7
    s_add_u32 s52, s52, 12288
L_hint:
    s_load_dwordx2 s[54:55], s[12:13], s52 glc
    s_waitcnt lgkmcnt(0)
    s_cmp_eq_u64 s[54:55], s[28:29]
    s_cbranch_scc1 L_hint_ok
    s_cmp_eq_u32 s35, 0
    s_cbranch_scc1 L_hint_ok
    s_sub_u32 s35, s35, 1
    s_sleep 4
    s_branch L_hint
L_hint_ok:
    s_mov_b64 exec, 1
    ds_add_u32 v0, v255 offset:42848
    s_mov_b64 exec, -1
    s_mov_b64 exec, 1
    ds_add_u32 v0, v255 offset:42852
    s_mov_b64 exec, -1
    s_mov_b64 exec, 1
    ds_add_u32 v0, v255 offset:42856
    s_mov_b64 exec, -1
    s_waitcnt lgkmcnt(0)
    v_readfirstlane_b32 s33, v19
    v_readfirstlane_b32 s34, v18
L_owner:
    s_and_b32 s31, s2, 7
    s_sub_u32 s32, 8, s31
    s_min_u32 s46, s31, s32
    s_cmp_gt_u32 s31, 4
    s_cselect_b32 s31, 16, 0
    s_lshr_b32 s47, s2, 4
    s_add_u32 s47, s47, s31
    s_bfe_u32 s53, s2, 0x10003
    s_lshl_b32 s53, s53, 7
    s_add_u32 s53, s53, s31
    s_lshl_b32 s53, s53, 3
    s_add_u32 s53, s53, s46
    s_andn2_b32 s51, 0x7ff, s33
    s_mov_b32 s54, s51
    s_mov_b32 s55, 0
    s_mov_b32 s56, 0
    s_mov_b32 s16, s44
    s_mov_b32 s17, s45
    s_mov_b32 s18, 0x400000
    v_and_b32 v8, 31, v2
    v_lshlrev_b32 v15, 2, v8
    v_lshlrev_b32 v8, 1, v8
    v_mov_b32 v16, 0
L_seg:
    s_xor_b32 s31, s54, s53
    s_and_b32 s31, s31, 0x487
    s_cbranch_scc0 L_seg_own
    s_cmpk_lg_u32 s31, 0x480
    s_cbranch_scc1 L_seg_next
L_seg_own:
    s_lshl_b32 s31, s51, 11
    s_lshl_b32 s32, s47, 6
    s_add_u32 s63, s31, s32
    buffer_load_ushort v9, v8, s[8:11], s63 offen
    v_lshrrev_b32 v4, 3, v2
    s_lshl_b32 s31, s30, 4
    v_add_u32 v4, s31, v4
    v_lshlrev_b32 v4, 12, v4
    s_lshl_b32 s31, s47, 7
    s_add_u32 s31, s31, 524288
    v_add3_u32 v4, v4, v7, s31
    s_mov_b32 s62, 32768
    v_mov_b32 v24, v14
    v_mov_b32 v25, v14
    v_mov_b32 v26, v14
    v_mov_b32 v27, v14
    v_lshrrev_b32 v5, 4, v2
    v_lshl_add_u32 v6, v5, 2, v7
    s_lshl_b32 s31, s30, 7
    s_add_u32 s31, s31, s55
    v_add_u32 v6, s31, v6
    s_ashr_i32 s31, s33, 31
    s_orn2_b32 s31, 0x80000000, s31
    s_xor_b32 s31, s31, s33
    s_and_b32 s31, s31, 0xfffff800
    v_cvt_pk_bf16_f32 v11, s31, s31
    v_lshlrev_b32 v11, 16, v11
    v_mul_f32 v11, 0xbfb8aa3b, v11
    v_exp_f32 v11, v11
    s_and_b32 s32, s34, 0xffff0000
    v_add_f32 v11, 1.0, v11
    v_rcp_f32 v11, v11
    v_rcp_f32 v12, s32
    v_cvt_pk_bf16_f32 v11, v11, v11
    v_lshlrev_b32 v11, 16, v11
    s_lshl_b32 s31, s34, 16
    s_waitcnt vmcnt(0)
    v_lshl_add_u32 v13, v8, 1, s55
    s_mov_b64 vcc, -1
    s_mov_b32 s56, 1
L_y_poll:
    s_mov_b64 exec, vcc
    buffer_load_dwordx4 v[20:23], v4, s[12:15], 0 offen sc1
    s_cmp_eq_u32 s30, 3
    s_cbranch_scc1 L_y_one
    buffer_load_dwordx4 v[24:27], v4, s[12:15], s62 offen sc1
L_y_one:
    s_mov_b64 exec, -1
    s_waitcnt vmcnt(0)
    v_xor_b32 v28, v14, v20
    v_xor_b32 v29, v14, v21
    v_xor_b32 v30, v14, v22
    v_xor_b32 v31, v14, v23
    v_xor_b32 v32, v14, v24
    v_xor_b32 v33, v14, v25
    v_xor_b32 v34, v14, v26
    v_xor_b32 v35, v14, v27
    v_or3_b32 v1, v28, v29, v30
    v_or3_b32 v1, v1, v31, v32
    v_or3_b32 v1, v1, v33, v34
    v_or_b32 v1, v1, v35
    v_and_b32 v1, 0xff, v1
    v_cmp_ne_u32 vcc, 0, v1
    v_pk_add_f32 v[28:29], v[28:29], v[32:33]
    v_pk_add_f32 v[30:31], v[30:31], v[34:35]
    s_cbranch_vccz L_y_got
    s_cmp_eq_u32 s35, 0
    s_cbranch_scc1 L_y_got
    s_sub_u32 s35, s35, 1
    s_branch L_y_poll
L_y_got:
    v_permlane16_swap_b32 v28, v29
    v_permlane16_swap_b32 v30, v31
    v_add_f32 v28, v28, v29
    v_add_f32 v30, v30, v31
    s_nop 1
    v_permlane32_swap_b32 v28, v30
    v_add_f32 v28, v28, v30
    s_nop 1
    v_add_f32_dpp v28, v28, v28 row_ror:8 row_mask:0xf bank_mask:0xf
    ds_write_b32 v6, v28 offset:43008
    s_mov_b64 exec, 1
    ds_add_u32 v16, v255 offset:42836
    s_mov_b64 exec, -1
    s_cmp_lg_u32 s30, 0
    s_cbranch_scc1 L_seg_next
    s_cmp_eq_u32 s47, 0
    s_cselect_b32 s32, 0, 2147483392
    v_mov_b32 v5, 2147483392
    v_writelane_b32 v5, s32, 0
    v_mov_b32 v18, s28
    v_mov_b32 v19, s29
    s_lshl_b32 s31, s34, 16
    v_lshlrev_b32 v9, 16, v9
    v_subrev_f32 v10, s31, v9
    v_cvt_pk_bf16_f32 v10, v10, v10
    v_lshlrev_b32 v10, 16, v10
    v_mul_f32 v10, v10, v12
    v_cvt_pk_bf16_f32 v10, v10, v10
    v_lshlrev_b32 v10, 16, v10
L_sync18:
    ds_read_b32 v1, v16 offset:42836
    ds_read_b32 v20, v13 offset:43008
    ds_read_b32 v21, v13 offset:43136
    ds_read_b32 v22, v13 offset:43264
    ds_read_b32 v23, v13 offset:43392
    ds_read_b32 v24, v15 offset:42496
    s_waitcnt lgkmcnt(5)
    v_readfirstlane_b32 s31, v1
    s_nop 0
    s_cmp_ge_u32 s31, 5
    s_cbranch_scc0 L_sync18
    s_waitcnt lgkmcnt(0)
    v_add_f32 v20, v20, v21
    v_add_f32 v22, v22, v23
    v_add_f32 v20, v20, v22
    v_cvt_pk_bf16_f32 v20, v20, v20
    v_lshlrev_b32 v20, 16, v20
    v_mul_f32 v20, v20, v11
    v_cvt_pk_bf16_f32 v20, v20, v20
    v_lshlrev_b32 v20, 16, v20
    v_add_f32 v20, v20, v10
    v_cvt_pk_bf16_f32 v20, v20, v20
    v_lshlrev_b32 v20, 16, v20
    v_mul_f32 v1, 0xbfb8aa3b, v20
    v_mul_f32 v20, v1, v24
    v_exp_f32 v1, v1
    s_nop 0
    v_add_f32 v1, 1.0, v1
    v_rcp_f32 v1, v1
    s_mov_b32 exec_hi, 0
    v_fma_f32 v20, v20, v1, v9
    v_cvt_pk_bf16_f32 v20, v20, v20
    buffer_store_short v20, v8, s[16:19], s63 offen sc1
    buffer_store_dwordx2 v[18:19], v5, s[12:15], 0 offen sc1
    s_mov_b64 exec, -1
L_seg_next:
    s_cmp_lg_u32 s55, 0
    s_cbranch_scc1 L_seg_end
    s_mov_b32 s55, 512
    s_sub_u32 s54, 0, s51
    s_sub_u32 s47, 31, s47
    v_mov_b32 v16, 28
    v_and_b32 v15, 24, v2
    v_xor_b32 v15, 24, v15
    v_sub_u32 v1, 0, v2
    v_and_b32 v1, 7, v1
    v_add_u32 v15, v15, v1
    v_lshlrev_b32 v15, 2, v15
    v_add_u32 v15, 128, v15
    s_branch L_seg
L_seg_end:
L_fin:
L_exit:
    s_endpgm
L_code_end:
.section .rodata,"a"
.p2align 6
.amdhsa_kernel recurrent_scan__spectral_fnet__moe_arch_mod__prompt_kernel
  .amdhsa_next_free_vgpr 256
  .amdhsa_next_free_sgpr 92
  .amdhsa_accum_offset 256
  .amdhsa_group_segment_fixed_size 0
  .amdhsa_kernarg_size 104
  .amdhsa_user_sgpr_count 2
  .amdhsa_user_sgpr_kernarg_segment_ptr 1
  .amdhsa_system_sgpr_workgroup_id_x 1
  .amdhsa_float_denorm_mode_32 3
.end_amdhsa_kernel
```

```asm
; @launch grid=(256,1,1) block=(512,1,1) lds=158720
.amdgcn_target "amdgcn-amd-amdhsa--gfx950"
.text
.globl recurrent_scan__spectral_fnet__moe_arch_mod__prompt_kernel
.p2align 8
.type recurrent_scan__spectral_fnet__moe_arch_mod__prompt_kernel,@function
recurrent_scan__spectral_fnet__moe_arch_mod__prompt_kernel:
    s_cmp_ge_u32 s2, 256
    s_cbranch_scc1 L_exit
    s_load_dwordx2 s[8:9], s[0:1], 0
    s_load_dwordx4 s[36:39], s[0:1], 48
    s_load_dwordx2 s[12:13], s[0:1], 96
    s_getpc_b64 s[32:33]
L_pc:
    s_bfe_u32 s31, s2, 0x30003
    v_subrev_u32 v3, 496, v0
    v_lshl_add_u32 v3, v3, 3, s31
    v_lshlrev_b32 v3, 7, v3
    v_cmp_gt_u32 vcc, L_code_end-L_pc, v3
    s_nop 0
    s_and_saveexec_b64 s[46:47], vcc
    s_cbranch_execz L_nopf
    global_load_dword v254, v3, s[32:33]
L_nopf:
    s_mov_b64 exec, -1
    v_lshrrev_b32 v1, 6, v0
    v_and_b32 v2, 63, v0
    v_readfirstlane_b32 s30, v1
    s_mov_b32 s10, 0x400000
    s_mov_b32 s11, 0x00020000
    s_mov_b32 s14, 0x10000000
    s_mov_b32 s15, 0x00020000
    s_mov_b32 s35, 65536
    v_lshlrev_b32 v3, 4, v2
    v_mov_b32 v0, 0
    v_mov_b32 v255, 1
    s_mov_b32 s3, s30
    s_and_b32 s30, s30, 3
    s_cmp_ge_u32 s3, 4
    s_cbranch_scc1 L_moe
    s_and_b32 s31, s2, 7
    s_lshr_b32 s32, s2, 4
    s_sub_u32 s32, 15, s32
    s_lshl_b32 s32, s32, 3
    s_add_u32 s46, s32, s31
    s_bfe_u32 s47, s2, 0x10003
    s_lshl_b32 s31, s47, 2
    s_add_u32 s51, s31, s30
    s_lshl_b32 s31, s51, 8
    s_add_u32 s52, s31, s46
    s_xor_b32 s54, s52, 1024
    s_sub_u32 s53, 2048, s52
    s_add_u32 s31, s52, 128
    s_cmp_eq_u32 s46, 0
    s_cselect_b32 s53, s31, s53
    s_cselect_b32 s50, 1, 0
    s_xor_b32 s55, s53, 1024
    s_lshl_b32 s56, s52, 11
    s_lshl_b32 s57, s53, 11
    s_lshl_b32 s58, s54, 11
    s_lshl_b32 s59, s55, 11
    s_mov_b32 s22, 2048
    s_mov_b32 s23, 0x00020000
    v_mov_b32 v1, 0
    v_and_b32 v6, 15, v2
    v_lshlrev_b32 v6, 2, v6
    ds_write_b64 v0, v[0:1] offset:41504
    ds_write_b32 v6, v0 offset:42816
    s_waitcnt lgkmcnt(0)
    s_load_dwordx2 s[28:29], s[12:13], 0
    s_load_dwordx2 s[16:17], s[0:1], 80
    buffer_load_dwordx4 v[120:123], v3, s[8:11], s56 offen
    buffer_load_dwordx4 v[124:127], v3, s[8:11], s56 offen offset:1024
    buffer_load_dwordx4 v[128:131], v3, s[8:11], s57 offen
    buffer_load_dwordx4 v[132:135], v3, s[8:11], s57 offen offset:1024
    s_mov_b32 s20, s36
    s_mov_b32 s21, s37
    buffer_load_dwordx4 v[152:155], v3, s[20:23], 0 offen
    buffer_load_dwordx4 v[156:159], v3, s[20:23], 0 offen offset:1024
    buffer_load_dwordx4 v[136:139], v3, s[8:11], s58 offen
    buffer_load_dwordx4 v[140:143], v3, s[8:11], s58 offen offset:1024
    buffer_load_dwordx4 v[144:147], v3, s[8:11], s59 offen
    buffer_load_dwordx4 v[148:151], v3, s[8:11], s59 offen offset:1024
    s_barrier
    s_branch L_dft_rest
L_moe:
    s_load_dwordx2 s[20:21], s[0:1], 64
    s_and_b32 s32, s2, 7
    s_mul_i32 s32, s32, 28
    s_lshr_b32 s31, s2, 3
    s_add_u32 s31, s31, s32
    s_lshr_b32 s46, s31, 3
    s_lshl_b32 s46, s46, 1
    s_and_b32 s47, s31, 7
    s_mov_b32 s75, 0
    s_mov_b32 s18, 7340032
    s_mov_b32 s19, 0x00020000
    s_mov_b32 s22, 7340032
    s_mov_b32 s23, 0x00020000
    s_mov_b32 s26, 7340032
    s_mov_b32 s27, 0x00020000
    v_lshrrev_b32 v4, 4, v2
    v_lshlrev_b32 v5, 5, v4
    v_and_b32 v6, 0x70, v3
    v_xor_b32 v5, v5, v6
    v_mul_u32_u24 v4, 7168, v4
    s_mul_i32 s31, s47, 917504
    s_lshl_b32 s32, s46, 7
    s_add_u32 s31, s31, s32
    v_add3_u32 v4, v4, v5, s31
    s_cmp_eq_u32 s75, 0
    s_mov_b32 s31, 917504
    s_cselect_b32 s31, 128, s31
    v_add_u32 v6, s31, v4
    s_mov_b32 vcc_lo, 0xff00ff00
    s_mov_b32 vcc_hi, 0xff00ff00
    v_cndmask_b32 v5, v6, v4, vcc
    v_cndmask_b32 v4, v4, v6, vcc
    s_mov_b32 s48, 0
    s_mov_b32 s49, 76800
    s_waitcnt lgkmcnt(0)
    s_mov_b32 s16, s38
    s_mov_b32 s17, s39
    s_load_dwordx2 s[28:29], s[12:13], 0
    s_load_dwordx2 s[24:25], s[0:1], 72
    s_load_dwordx2 s[44:45], s[0:1], 80
    s_barrier
    s_cmp_ge_u32 s2, 224
    s_cselect_b32 s66, 0, 1
    s_cbranch_scc1 L_dma_done
    s_cmp_lg_u32 s30, 0
    s_cbranch_scc1 L_dma_done
    s_setprio 3
L_dma:
    s_mov_b32 m0, s49
    s_waitcnt vmcnt(19)
    buffer_load_dwordx4 v4, s[16:19], s48 offen nt lds
    s_add_u32 m0, s49, 32768
    s_add_u32 s49, s49, 1024
    s_waitcnt vmcnt(19)
    buffer_load_dwordx4 v4, s[20:23], s48 offen nt lds
    s_add_u32 s48, s48, 28672
    s_mov_b32 m0, s49
    s_waitcnt vmcnt(19)
    buffer_load_dwordx4 v4, s[16:19], s48 offen nt lds
    s_add_u32 m0, s49, 32768
    s_add_u32 s49, s49, 1024
    s_waitcnt vmcnt(19)
    buffer_load_dwordx4 v4, s[20:23], s48 offen nt lds
    s_add_u32 s48, s48, 28672
    s_mov_b32 m0, s49
    s_waitcnt vmcnt(19)
    buffer_load_dwordx4 v5, s[16:19], s48 offen nt lds
    s_add_u32 m0, s49, 32768
    s_add_u32 s49, s49, 1024
    s_waitcnt vmcnt(19)
    buffer_load_dwordx4 v5, s[20:23], s48 offen nt lds
    s_add_u32 s48, s48, 28672
    s_mov_b32 m0, s49
    s_waitcnt vmcnt(19)
    buffer_load_dwordx4 v5, s[16:19], s48 offen nt lds
    s_add_u32 m0, s49, 32768
    s_add_u32 s49, s49, 1024
    s_waitcnt vmcnt(19)
    buffer_load_dwordx4 v5, s[20:23], s48 offen nt lds
    s_add_u32 s48, s48, 28672
    s_cmp_lt_u32 s48, 917504
    s_cbranch_scc1 L_dma
    s_branch L_dma_done
L_dft_rest:
    s_mov_b32 s18, 0x400000
    s_mov_b32 s19, 0x00020000
    s_sub_u32 s31, 2047, s52
    s_sub_u32 s32, 2047, s53
    v_mov_b32 v200, s31
    v_writelane_b32 v200, s32, 63
    s_lshl_b32 s31, s30, 2
    v_mov_b32 v201, s31
    s_bfe_u32 s31, s53, 0x20008
    s_lshl_b32 s31, s31, 2
    s_add_u32 s31, s31, 16
    v_writelane_b32 v201, s31, 63
    v_and_b32 v6, 32, v2
    s_lshl_b32 s31, s51, 2
    v_add_u32 v203, s31, v6
    v_lshrrev_b32 v202, 1, v203
    s_lshl_b32 s31, s2, 4
    s_add_u32 s31, s31, 4096
    v_mov_b32 v4, s31
    v_lshlrev_b32 v5, 3, v2
    s_and_b32 s31, s52, 7
    s_lshl_b32 s31, s31, 11
    s_and_b32 s32, s52, 1024
    s_add_u32 s31, s31, s32
    s_and_b32 s32, s52, 0xf8
    s_lshl_b32 s32, s32, 2
    s_add_u32 s31, s31, s32
    s_add_u32 s31, s31, 32768
    v_writelane_b32 v4, s31, 0
    s_add_u32 s31, s31, 16
    v_writelane_b32 v4, s31, 1
    s_and_b32 s31, s53, 7
    s_lshl_b32 s31, s31, 11
    s_and_b32 s32, s53, 1024
    s_add_u32 s31, s31, s32
    s_and_b32 s32, s53, 0xf8
    s_lshl_b32 s32, s32, 2
    s_add_u32 s31, s31, s32
    s_add_u32 s31, s31, 32768
    v_writelane_b32 v4, s31, 2
    s_add_u32 s31, s31, 16
    v_writelane_b32 v4, s31, 3
    s_mul_i32 s31, s51, 2592
    v_and_b32 v204, 32, v2
    v_lshlrev_b32 v204, 2, v204
    v_add3_u32 v204, v204, v3, s31
    s_lshl_b32 s32, s31, 1
    s_add_u32 s32, s32, 21872
    v_sub_u32 v205, s32, v204
    v_bfe_u32 v206, v2, 2, 2
    v_mul_u32_u24 v206, 2592, v206
    v_lshrrev_b32 v6, 4, v2
    v_mul_u32_u24 v7, 640, v6
    v_add_u32 v206, v206, v7
    v_and_b32 v7, 3, v2
    v_lshlrev_b32 v7, 3, v7
    s_lshl_b32 s31, s30, 7
    v_add3_u32 v206, v206, v7, s31
    v_lshlrev_b32 v6, 12, v6
    v_and_b32 v7, 15, v2
    v_lshl_add_u32 v6, v7, 4, v6
    s_lshl_b32 s31, s30, 8
    v_add_u32 v207, s31, v6
    v_bfe_i32 v208, v2, 4, 1
    v_and_b32 v208, 0x80008000, v208
    s_cmp_eq_u32 s47, 0
    s_movk_i32 s48, 0x7403
    s_cselect_b32 s48, 0x7721, s48
    v_and_b32 v250, 12, v2
    v_bfe_u32 v250, s48, v250, 4
    v_lshrrev_b32 v251, 4, v2
    v_bfe_u32 v252, v2, 1, 1
    v_mul_u32_u24 v251, v251, v252
    v_and_b32 v252, 1, v2
    v_add_u32 v251, v251, v252
    v_cvt_f32_u32 v250, v250
    v_cvt_f32_u32 v251, v251
    v_mul_f32 v250, 0x3e000000, v250
    v_mul_f32 v251, 0x3e800000, v251
    v_cos_f32 v8, v251
    v_add_f32 v251, v251, v250
    v_cos_f32 v9, v251
    v_add_f32 v251, v251, v250
    v_cos_f32 v10, v251
    v_add_f32 v251, v251, v250
    v_cos_f32 v11, v251
    v_add_f32 v251, v251, v250
    v_cos_f32 v12, v251
    v_add_f32 v251, v251, v250
    v_cos_f32 v13, v251
    v_add_f32 v251, v251, v250
    v_cos_f32 v14, v251
    v_add_f32 v251, v251, v250
    v_cos_f32 v15, v251
    v_mul_f32 v8, 0xbf317218, v8
    v_mul_f32 v9, 0xbf317218, v9
    v_mul_f32 v10, 0xbf317218, v10
    v_mul_f32 v11, 0xbf317218, v11
    v_mul_f32 v12, 0xbf317218, v12
    v_mul_f32 v13, 0xbf317218, v13
    v_mul_f32 v14, 0xbf317218, v14
    v_mul_f32 v15, 0xbf317218, v15
    v_lshrrev_b32 v250, 2, v2
    v_and_b32 v250, 12, v250
    v_and_b32 v251, 15, v2
    v_lshlrev_b32 v251, 2, v251
    v_cvt_f32_u32 v250, v250
    v_cvt_f32_u32 v251, v251
    v_mul_f32 v212, 0x3c800000, v250
    s_lshl_b32 s31, s30, 2
    s_lshr_b32 s48, s48, s31
    s_and_b32 s48, s48, 15
    s_sub_u32 s31, s48, 4
    s_mul_i32 s31, s31, s46
    v_cvt_f32_i32 v252, s31
    v_mul_f32 v252, 0x3a000000, v252
    v_add_f32 v213, 0x3c800000, v212
    v_add_f32 v214, 0x3d000000, v212
    v_add_f32 v215, 0x3d400000, v212
    s_and_b32 s31, s2, 7
    s_sub_u32 s32, 8, s31
    s_min_u32 s76, s31, s32
    s_cmp_gt_u32 s31, 4
    s_cselect_b32 s31, 16, 0
    s_lshr_b32 s77, s2, 4
    s_add_u32 s77, s77, s31
    s_bfe_u32 s78, s2, 0x10003
    s_lshl_b32 s78, s78, 7
    s_add_u32 s78, s78, s31
    s_lshl_b32 s31, s30, 5
    s_add_u32 s78, s78, s31
    s_lshl_b32 s78, s78, 3
    s_add_u32 s78, s78, s76
    s_lshl_b32 s77, s77, 6
    s_sub_u32 s79, 1984, s77
    s_lshl_b32 s76, s76, 1
    s_add_u32 s76, s76, 2040
    v_and_b32 v116, 15, v2
    v_lshl_add_u32 v116, v116, 3, s78
    s_mov_b32 vcc_lo, 0
    s_mov_b32 vcc_hi, -1
    v_sub_u32 v7, s76, v116
    v_cndmask_b32 v7, v116, v7, vcc
    s_mov_b32 vcc_lo, 0xffff0000
    s_mov_b32 vcc_hi, 0xffff0000
    v_sub_u32 v6, 0, v7
    v_cndmask_b32 v7, v7, v6, vcc
    v_and_b32 v6, 7, v7
    v_and_b32 v1, 1024, v7
    v_lshl_add_u32 v6, v6, 11, v1
    v_and_b32 v1, 0xf8, v7
    v_lshl_add_u32 v6, v1, 2, v6
    v_bfe_u32 v1, v7, 9, 1
    v_lshl_add_u32 v119, v1, 4, v6
    v_and_b32 v1, 256, v7
    v_cmp_ne_u32 s[88:89], 0, v1
    v_lshrrev_b32 v118, 2, v2
    v_lshl_add_u32 v118, v118, 3, s78
    v_lshlrev_b32 v1, 1, v2
    v_xor_b32 v1, v1, v3
    v_and_b32 v1, 48, v1
    v_sub_u32 v114, s76, v118
    v_sub_u32 v113, 0, v118
    v_and_b32 v113, 2047, v113
    v_sub_u32 v115, 2048, v114
    v_add_u32 v112, s77, v1
    v_lshl_add_u32 v114, v114, 11, v112
    v_lshl_add_u32 v112, v118, 11, v112
    v_xor_b32 v1, 48, v1
    v_add_u32 v1, s79, v1
    v_lshl_add_u32 v113, v113, 11, v1
    v_lshl_add_u32 v115, v115, 11, v1
    s_lshl_b32 s76, s30, 12
    s_add_u32 s76, s76, 142336
    v_and_b32 v1, 15, v2
    v_lshlrev_b32 v6, 6, v1
    v_lshlrev_b32 v1, 3, v2
    v_xor_b32 v1, v1, v2
    v_and_b32 v1, 48, v1
    v_add3_u32 v117, v6, v1, s76
    v_mul_f32 v250, v212, v251
    v_fmamk_f32 v52, v250, 0x3d800000, v252
    v_sin_f32 v20, v250
    v_cos_f32 v250, v250
    v_cos_f32 v48, v52
    v_sin_f32 v52, v52
    v_cvt_pk_f16_f32 v16, v250, v20
    v_cvt_pk_f16_f32 v20, -v20, v250
    v_mul_f32 v250, v213, v251
    v_fmamk_f32 v53, v250, 0x3d800000, v252
    v_sin_f32 v21, v250
    v_cos_f32 v250, v250
    v_cos_f32 v49, v53
    v_sin_f32 v53, v53
    v_cvt_pk_f16_f32 v17, v250, v21
    v_cvt_pk_f16_f32 v21, -v21, v250
    v_mul_f32 v250, v214, v251
    v_fmamk_f32 v54, v250, 0x3d800000, v252
    v_sin_f32 v22, v250
    v_cos_f32 v250, v250
    v_cos_f32 v50, v54
    v_sin_f32 v54, v54
    v_cvt_pk_f16_f32 v18, v250, v22
    v_cvt_pk_f16_f32 v22, -v22, v250
    v_mul_f32 v250, v215, v251
    v_fmamk_f32 v55, v250, 0x3d800000, v252
    v_sin_f32 v23, v250
    v_cos_f32 v250, v250
    v_cos_f32 v51, v55
    v_sin_f32 v55, v55
    v_cvt_pk_f16_f32 v19, v250, v23
    v_cvt_pk_f16_f32 v23, -v23, v250
    v_add_f32 v251, 1.0, v251
    v_mul_f32 v250, v212, v251
    v_fmamk_f32 v60, v250, 0x3d800000, v252
    v_sin_f32 v28, v250
    v_cos_f32 v250, v250
    v_cos_f32 v56, v60
    v_sin_f32 v60, v60
    v_cvt_pk_f16_f32 v24, v250, v28
    v_cvt_pk_f16_f32 v28, -v28, v250
    v_mul_f32 v250, v213, v251
    v_fmamk_f32 v61, v250, 0x3d800000, v252
    v_sin_f32 v29, v250
    v_cos_f32 v250, v250
    v_cos_f32 v57, v61
    v_sin_f32 v61, v61
    v_cvt_pk_f16_f32 v25, v250, v29
    v_cvt_pk_f16_f32 v29, -v29, v250
    v_mul_f32 v250, v214, v251
    v_fmamk_f32 v62, v250, 0x3d800000, v252
    v_sin_f32 v30, v250
    v_cos_f32 v250, v250
    v_cos_f32 v58, v62
    v_sin_f32 v62, v62
    v_cvt_pk_f16_f32 v26, v250, v30
    v_cvt_pk_f16_f32 v30, -v30, v250
    v_mul_f32 v250, v215, v251
    v_fmamk_f32 v63, v250, 0x3d800000, v252
    v_sin_f32 v31, v250
    v_cos_f32 v250, v250
    v_cos_f32 v59, v63
    v_sin_f32 v63, v63
    v_cvt_pk_f16_f32 v27, v250, v31
    v_cvt_pk_f16_f32 v31, -v31, v250
    v_add_f32 v251, 1.0, v251
    v_mov_b32 v160, 0
    v_mov_b32 v161, 0
    v_mov_b32 v162, 0
    v_mov_b32 v163, 0
    v_mov_b32 v164, 0
    v_mov_b32 v165, 0
    v_mov_b32 v166, 0
    v_mov_b32 v167, 0
    v_mov_b32 v168, 0
    v_mov_b32 v169, 0
    v_mov_b32 v170, 0
    s_mov_b32 s57, 0x3f803f80
    s_mov_b32 s59, 0xffff
    s_brev_b32 s67, 1
    s_mov_b32 s66, 0
    s_brev_b32 s64, 1
    s_brev_b32 s65, 1
    s_cmp_eq_u32 s47, 0
    s_movk_i32 s62, -10368
    s_cselect_b32 s62, 10368, s62
    s_waitcnt lgkmcnt(0)
    s_add_u32 s28, s28, 0x7f4a7c15
    s_addc_u32 s29, s29, 0x9e3779b9
    v_mov_b32 v174, s28
    v_mov_b32 v175, s29
    s_cmp_lt_u32 s2, 224
    s_cbranch_scc1 L_epoch_ok
L_sync1:
    ds_read_b32 v1, v0 offset:42872
    s_waitcnt lgkmcnt(0)
    v_readfirstlane_b32 s31, v1
    s_nop 0
    s_cmp_ge_u32 s31, 4
    s_cbranch_scc0 L_sync1
L_epoch_ok:
    s_setprio 2
    s_waitcnt vmcnt(8)
    v_dot2c_f32_bf16 v160, s57, v120
    v_dot2c_f32_bf16 v164, v120, v120
    v_dot2c_f32_bf16 v160, s57, v121
    v_dot2c_f32_bf16 v164, v121, v121
    v_dot2c_f32_bf16 v160, s57, v122
    v_dot2c_f32_bf16 v164, v122, v122
    v_dot2c_f32_bf16 v160, s57, v123
    v_dot2c_f32_bf16 v164, v123, v123
    v_dot2c_f32_bf16 v160, s57, v124
    v_dot2c_f32_bf16 v164, v124, v124
    v_dot2c_f32_bf16 v160, s57, v125
    v_dot2c_f32_bf16 v164, v125, v125
    v_dot2c_f32_bf16 v160, s57, v126
    v_dot2c_f32_bf16 v164, v126, v126
    v_dot2c_f32_bf16 v160, s57, v127
    v_dot2c_f32_bf16 v164, v127, v127
    s_waitcnt vmcnt(6)
    v_dot2c_f32_bf16 v161, s57, v128
    v_dot2c_f32_bf16 v165, v128, v128
    v_dot2c_f32_bf16 v161, s57, v129
    v_dot2c_f32_bf16 v165, v129, v129
    v_dot2c_f32_bf16 v161, s57, v130
    v_dot2c_f32_bf16 v165, v130, v130
    v_dot2c_f32_bf16 v161, s57, v131
    v_dot2c_f32_bf16 v165, v131, v131
    v_dot2c_f32_bf16 v161, s57, v132
    v_dot2c_f32_bf16 v165, v132, v132
    v_dot2c_f32_bf16 v161, s57, v133
    v_dot2c_f32_bf16 v165, v133, v133
    v_dot2c_f32_bf16 v161, s57, v134
    v_dot2c_f32_bf16 v165, v134, v134
    v_dot2c_f32_bf16 v161, s57, v135
    v_dot2c_f32_bf16 v165, v135, v135
    s_waitcnt vmcnt(4)
    v_dot2c_f32_bf16 v170, s57, v152
    v_dot2c_f32_bf16 v170, s57, v153
    v_dot2c_f32_bf16 v170, s57, v154
    v_dot2c_f32_bf16 v170, s57, v155
    v_dot2c_f32_bf16 v170, s57, v156
    v_dot2c_f32_bf16 v170, s57, v157
    v_dot2c_f32_bf16 v170, s57, v158
    v_dot2c_f32_bf16 v170, s57, v159
    v_dot2c_f32_bf16 v168, v152, v120
    v_dot2c_f32_bf16 v169, v152, v128
    v_dot2c_f32_bf16 v168, v153, v121
    v_dot2c_f32_bf16 v169, v153, v129
    v_dot2c_f32_bf16 v168, v154, v122
    v_dot2c_f32_bf16 v169, v154, v130
    v_dot2c_f32_bf16 v168, v155, v123
    v_dot2c_f32_bf16 v169, v155, v131
    v_mov_b32 v171, v170
    v_dot2c_f32_bf16 v168, v156, v124
    v_dot2c_f32_bf16 v169, v156, v132
    v_dot2c_f32_bf16 v168, v157, v125
    v_dot2c_f32_bf16 v169, v157, v133
    v_dot2c_f32_bf16 v168, v158, v126
    v_dot2c_f32_bf16 v169, v158, v134
    v_dot2c_f32_bf16 v168, v159, v127
    v_dot2c_f32_bf16 v169, v159, v135
    v_permlane32_swap_b32 v160, v161
    v_permlane32_swap_b32 v164, v165
    v_permlane32_swap_b32 v170, v171
    v_permlane32_swap_b32 v168, v169
    v_add_f32 v160, v160, v161
    v_add_f32 v164, v164, v165
    v_add_f32 v170, v170, v171
    v_add_f32 v168, v168, v169
    v_add_f32_dpp v160, v160, v160 row_shr:1 row_mask:0xf bank_mask:0xf
    v_add_f32_dpp v164, v164, v164 row_shr:1 row_mask:0xf bank_mask:0xf
    v_add_f32_dpp v170, v170, v170 row_shr:1 row_mask:0xf bank_mask:0xf
    v_add_f32_dpp v168, v168, v168 row_shr:1 row_mask:0xf bank_mask:0xf
    v_add_f32_dpp v160, v160, v160 row_shr:2 row_mask:0xf bank_mask:0xf
    v_add_f32_dpp v164, v164, v164 row_shr:2 row_mask:0xf bank_mask:0xf
    v_add_f32_dpp v170, v170, v170 row_shr:2 row_mask:0xf bank_mask:0xf
    v_add_f32_dpp v168, v168, v168 row_shr:2 row_mask:0xf bank_mask:0xf
    v_add_f32_dpp v160, v160, v160 row_shr:4 row_mask:0xf bank_mask:0xf
    v_add_f32_dpp v164, v164, v164 row_shr:4 row_mask:0xf bank_mask:0xf
    v_add_f32_dpp v170, v170, v170 row_shr:4 row_mask:0xf bank_mask:0xf
    v_add_f32_dpp v168, v168, v168 row_shr:4 row_mask:0xf bank_mask:0xf
    v_add_f32_dpp v160, v160, v160 row_shr:8 row_mask:0xf bank_mask:0xf
    v_add_f32_dpp v164, v164, v164 row_shr:8 row_mask:0xf bank_mask:0xf
    v_add_f32_dpp v170, v170, v170 row_shr:8 row_mask:0xf bank_mask:0xf
    v_add_f32_dpp v168, v168, v168 row_shr:8 row_mask:0xf bank_mask:0xf
    v_add_f32_dpp v160, v160, v160 row_bcast:15 row_mask:0xa bank_mask:0xf
    v_add_f32_dpp v164, v164, v164 row_bcast:15 row_mask:0xa bank_mask:0xf
    v_add_f32_dpp v170, v170, v170 row_bcast:15 row_mask:0xa bank_mask:0xf
    v_add_f32_dpp v168, v168, v168 row_bcast:15 row_mask:0xa bank_mask:0xf
    v_mul_f32 v160, 0x3a800000, v160
    v_mul_f32 v164, 0x3a800000, v164
    v_fma_f32 v164, -v160, v160, v164
    v_cvt_pk_bf16_f32 v161, -v160, -v160
    v_max_f32 v164, 0, v164
    v_cvt_pk_bf16_f32 v164, v164, v164
    v_and_b32 v164, 0xffff0000, v164
    v_add_f32 v164, 0x3727c5ac, v164
    v_cvt_pk_bf16_f32 v164, v164, v164
    v_and_b32 v164, 0xffff0000, v164
    v_sqrt_f32 v164, v164
    v_and_b32 v165, 0xffff0000, v161
    v_cvt_pk_bf16_f32 v248, v160, v164
    v_and_b32 v164, 0xffff0000, v248
    v_rcp_f32 v164, v164
    v_fmac_f32 v168, v170, v165
    v_mul_f32 v168, v168, v164
    v_ashrrev_i32 v170, 31, v168
    v_or_b32 v170, 0x80000000, v170
    v_xor_b32 v168, v168, v170
    v_and_b32 v168, 0xfffff800, v168
    v_or_b32 v249, v200, v168
    s_mov_b64 exec, s[64:65]
    ds_write_b32 v201, v248 offset:41472
    ds_max_u64 v0, v[248:249] offset:41504
    s_mov_b64 exec, 1
    ds_add_rtn_u32 v1, v0, v255 offset:42816
    s_mov_b64 exec, 31
    ds_read_b64 v[172:173], v5 offset:41472
    s_mov_b64 exec, s[64:65]
    ds_write_b16 v202, v161 offset:41568
    ds_write_b32 v203, v164 offset:42752
    s_mov_b64 exec, -1
    s_nop 0
    v_mov_b32_dpp v6, v128 wave_rol:1 row_mask:0xf bank_mask:0xf
    v_mov_b32_dpp v7, v132 wave_rol:1 row_mask:0xf bank_mask:0xf
    v_bfi_b32 v221, s59, v131, v130
    v_bfi_b32 v222, s59, v130, v129
    v_bfi_b32 v223, s59, v129, v128
    v_bfi_b32 v217, s59, v135, v134
    v_bfi_b32 v218, s59, v134, v133
    v_bfi_b32 v219, s59, v133, v132
    v_cndmask_b32 v220, v6, v7, s[66:67]
    v_cndmask_b32 v216, v7, v6, s[66:67]
    v_bfi_b32 v220, s59, v220, v131
    v_bfi_b32 v216, s59, v216, v135
    s_waitcnt lgkmcnt(2)
    v_readfirstlane_b32 s31, v1
    s_nop 0
    s_cmp_lg_u32 s31, 3
    s_cbranch_scc1 L_not_last
    s_mov_b64 exec, 31
    buffer_store_dwordx4 v[172:175], v4, s[12:15], 0 offen sc1
    s_mov_b64 exec, -1
    s_waitcnt vmcnt(1)
    s_branch L_b_ready
L_not_last:
    s_waitcnt vmcnt(0)
L_b_ready:
    s_setprio 1
    ds_write_b128 v204, v[120:123] offset:0
    ds_write_b128 v204, v[124:127] offset:1280
    s_cmp_lg_u32 s50, 0
    s_cbranch_scc1 L_plain1
    ds_write_b128 v205, v[216:219]
    ds_write_b128 v205, v[220:223] offset:1280
    s_branch L_second1
L_plain1:
    ds_write_b128 v204, v[128:131] offset:20736
    ds_write_b128 v204, v[132:135] offset:22016
L_second1:
    v_add_u32 v204, s62, v204
    v_add_u32 v205, s62, v205
    v_dot2c_f32_bf16 v162, s57, v136
    v_dot2c_f32_bf16 v166, v136, v136
    v_dot2c_f32_bf16 v162, s57, v137
    v_dot2c_f32_bf16 v166, v137, v137
    v_dot2c_f32_bf16 v162, s57, v138
    v_dot2c_f32_bf16 v166, v138, v138
    v_dot2c_f32_bf16 v162, s57, v139
    v_dot2c_f32_bf16 v166, v139, v139
    v_dot2c_f32_bf16 v162, s57, v140
    v_dot2c_f32_bf16 v166, v140, v140
    v_dot2c_f32_bf16 v162, s57, v141
    v_dot2c_f32_bf16 v166, v141, v141
    v_dot2c_f32_bf16 v162, s57, v142
    v_dot2c_f32_bf16 v166, v142, v142
    v_dot2c_f32_bf16 v162, s57, v143
    v_dot2c_f32_bf16 v166, v143, v143
    ds_write_b128 v204, v[136:139] offset:0
    ds_write_b128 v204, v[140:143] offset:1280
    v_dot2c_f32_bf16 v163, s57, v144
    v_dot2c_f32_bf16 v167, v144, v144
    v_dot2c_f32_bf16 v163, s57, v145
    v_dot2c_f32_bf16 v167, v145, v145
    v_dot2c_f32_bf16 v163, s57, v146
    v_dot2c_f32_bf16 v167, v146, v146
    v_dot2c_f32_bf16 v163, s57, v147
    v_dot2c_f32_bf16 v167, v147, v147
    v_dot2c_f32_bf16 v163, s57, v148
    v_dot2c_f32_bf16 v167, v148, v148
    v_dot2c_f32_bf16 v163, s57, v149
    v_dot2c_f32_bf16 v167, v149, v149
    v_dot2c_f32_bf16 v163, s57, v150
    v_dot2c_f32_bf16 v167, v150, v150
    v_dot2c_f32_bf16 v163, s57, v151
    v_dot2c_f32_bf16 v167, v151, v151
    v_xor_b32 v202, 8, v202
    v_xor_b32 v203, 16, v203
    s_waitcnt lgkmcnt(2)
    s_nop 0
    v_mov_b32_dpp v6, v144 wave_rol:1 row_mask:0xf bank_mask:0xf
    v_mov_b32_dpp v7, v148 wave_rol:1 row_mask:0xf bank_mask:0xf
    v_bfi_b32 v221, s59, v147, v146
    v_bfi_b32 v222, s59, v146, v145
    v_bfi_b32 v223, s59, v145, v144
    v_bfi_b32 v217, s59, v151, v150
    v_bfi_b32 v218, s59, v150, v149
    v_bfi_b32 v219, s59, v149, v148
    v_cndmask_b32 v220, v6, v7, s[66:67]
    v_cndmask_b32 v216, v7, v6, s[66:67]
    v_bfi_b32 v220, s59, v220, v147
    v_bfi_b32 v216, s59, v216, v151
    s_cmp_lg_u32 s50, 0
    s_cbranch_scc1 L_plain3
    ds_write_b128 v205, v[216:219]
    ds_write_b128 v205, v[220:223] offset:1280
    s_branch L_second3
L_plain3:
    ds_write_b128 v204, v[144:147] offset:20736
    ds_write_b128 v204, v[148:151] offset:22016
L_second3:
    v_permlane32_swap_b32 v162, v163
    v_permlane32_swap_b32 v166, v167
    v_add_f32 v162, v162, v163
    v_add_f32 v166, v166, v167
    s_nop 0
    v_add_f32_dpp v162, v162, v162 row_shr:1 row_mask:0xf bank_mask:0xf
    v_add_f32_dpp v166, v166, v166 row_shr:1 row_mask:0xf bank_mask:0xf
    s_nop 0
    v_add_f32_dpp v162, v162, v162 row_shr:2 row_mask:0xf bank_mask:0xf
    v_add_f32_dpp v166, v166, v166 row_shr:2 row_mask:0xf bank_mask:0xf
    s_nop 0
    v_add_f32_dpp v162, v162, v162 row_shr:4 row_mask:0xf bank_mask:0xf
    v_add_f32_dpp v166, v166, v166 row_shr:4 row_mask:0xf bank_mask:0xf
    s_nop 0
    v_add_f32_dpp v162, v162, v162 row_shr:8 row_mask:0xf bank_mask:0xf
    v_add_f32_dpp v166, v166, v166 row_shr:8 row_mask:0xf bank_mask:0xf
    s_nop 0
    v_add_f32_dpp v162, v162, v162 row_bcast:15 row_mask:0xa bank_mask:0xf
    v_add_f32_dpp v166, v166, v166 row_bcast:15 row_mask:0xa bank_mask:0xf
    v_mul_f32 v162, 0x3a800000, v162
    v_mul_f32 v166, 0x3a800000, v166
    v_fma_f32 v166, -v162, v162, v166
    v_cvt_pk_bf16_f32 v161, -v162, -v162
    v_max_f32 v166, 0, v166
    v_cvt_pk_bf16_f32 v166, v166, v166
    v_and_b32 v166, 0xffff0000, v166
    v_add_f32 v166, 0x3727c5ac, v166
    v_cvt_pk_bf16_f32 v166, v166, v166
    v_and_b32 v166, 0xffff0000, v166
    v_sqrt_f32 v166, v166
    v_and_b32 v167, 0xffff0000, v161
    v_cvt_pk_bf16_f32 v248, v162, v166
    v_and_b32 v166, 0xffff0000, v248
    v_rcp_f32 v166, v166
    s_mov_b64 exec, s[64:65]
    ds_write_b16 v202, v161 offset:41568
    ds_write_b32 v203, v166 offset:42752
    s_mov_b64 exec, 1
    ds_add_u32 v0, v255 offset:42820
    s_mov_b64 exec, -1
L_sync2:
    ds_read_b32 v1, v0 offset:42820
    ds_read_b128 v[176:179], v0 offset:42752
    ds_read_b128 v[180:183], v0 offset:42768
    ds_read_b128 v[184:187], v0 offset:42784
    ds_read_b128 v[188:191], v0 offset:42800
    ds_read_b128 v[192:195], v0 offset:41568
    ds_read_b128 v[196:199], v0 offset:41584
    s_waitcnt lgkmcnt(6)
    v_readfirstlane_b32 s31, v1
    s_nop 0
    s_cmp_ge_u32 s31, 4
    s_cbranch_scc0 L_sync2
    ds_read_b64_tr_b16 v[120:121], v206 offset:0
    ds_read_b64_tr_b16 v[122:123], v206 offset:10368
    ds_read_b64_tr_b16 v[124:125], v206 offset:20736
    ds_read_b64_tr_b16 v[126:127], v206 offset:31104
    ds_read_b64_tr_b16 v[128:129], v206 offset:32
    ds_read_b64_tr_b16 v[130:131], v206 offset:10400
    ds_read_b64_tr_b16 v[132:133], v206 offset:20768
    ds_read_b64_tr_b16 v[134:135], v206 offset:31136
    s_waitcnt lgkmcnt(10)
    ds_read_b64_tr_b16 v[136:137], v206 offset:64
    ds_read_b64_tr_b16 v[138:139], v206 offset:10432
    ds_read_b64_tr_b16 v[140:141], v206 offset:20800
    ds_read_b64_tr_b16 v[142:143], v206 offset:31168
    v_pk_mul_f32 v[176:177], v[176:177], v[8:9]
    v_pk_mul_f32 v[178:179], v[178:179], v[10:11]
    v_pk_mul_f32 v[180:181], v[180:181], v[12:13]
    v_pk_mul_f32 v[182:183], v[182:183], v[14:15]
    v_pk_mul_f32 v[184:185], v[184:185], v[8:9]
    v_pk_mul_f32 v[186:187], v[186:187], v[10:11]
    v_pk_mul_f32 v[188:189], v[188:189], v[12:13]
    v_pk_mul_f32 v[190:191], v[190:191], v[14:15]
    v_cvt_pk_bf16_f32 v160, v176, v177
    v_cvt_pk_bf16_f32 v152, v184, v185
    v_cvt_pk_bf16_f32 v161, v178, v179
    v_cvt_pk_bf16_f32 v153, v186, v187
    v_cvt_pk_bf16_f32 v162, v180, v181
    v_cvt_pk_bf16_f32 v154, v188, v189
    v_cvt_pk_bf16_f32 v163, v182, v183
    v_cvt_pk_bf16_f32 v155, v190, v191
    v_xor_b32 v164, v208, v160
    v_xor_b32 v156, v208, v152
    v_xor_b32 v165, v208, v161
    v_xor_b32 v157, v208, v153
    v_xor_b32 v166, v208, v162
    v_xor_b32 v158, v208, v154
    v_xor_b32 v167, v208, v163
    v_xor_b32 v159, v208, v155
    s_waitcnt lgkmcnt(12)
    s_cmp_lg_u32 s50, 0
    s_cbranch_scc1 L_st1_split
    v_mfma_f32_16x16x32_bf16 v[168:171], v[160:163], v[192:195], 0
    v_mfma_f32_16x16x32_bf16 v[168:171], v[152:155], v[196:199], v[168:171]
    s_waitcnt lgkmcnt(10)
    ds_read_b64_tr_b16 v[144:145], v206 offset:96
    ds_read_b64_tr_b16 v[146:147], v206 offset:10464
    ds_read_b64_tr_b16 v[148:149], v206 offset:20832
    ds_read_b64_tr_b16 v[150:151], v206 offset:31200
    v_mfma_f32_16x16x32_bf16 v[216:219], v[160:163], v[120:123], v[168:171]
    s_waitcnt lgkmcnt(12)
    v_mfma_f32_16x16x32_bf16 v[216:219], v[152:155], v[124:127], v[216:219]
    s_waitcnt lgkmcnt(10)
    v_mfma_f32_16x16x32_bf16 v[224:227], v[160:163], v[128:131], v[168:171]
    s_waitcnt lgkmcnt(8)
    v_mfma_f32_16x16x32_bf16 v[224:227], v[152:155], v[132:135], v[224:227]
    s_waitcnt lgkmcnt(6)
    v_mfma_f32_16x16x32_bf16 v[232:235], v[160:163], v[136:139], v[168:171]
    s_waitcnt lgkmcnt(4)
    v_mfma_f32_16x16x32_bf16 v[232:235], v[152:155], v[140:143], v[232:235]
    s_waitcnt lgkmcnt(2)
    v_mfma_f32_16x16x32_bf16 v[240:243], v[160:163], v[144:147], v[168:171]
    s_waitcnt lgkmcnt(0)
    v_mfma_f32_16x16x32_bf16 v[240:243], v[152:155], v[148:151], v[240:243]
    v_mfma_f32_16x16x32_bf16 v[220:223], v[164:167], v[120:123], 0
    v_mfma_f32_16x16x32_bf16 v[220:223], v[156:159], v[124:127], v[220:223]
    v_mfma_f32_16x16x32_bf16 v[228:231], v[164:167], v[128:131], 0
    v_mfma_f32_16x16x32_bf16 v[228:231], v[156:159], v[132:135], v[228:231]
    v_cvt_pk_f16_f32 v176, v216, v217
    v_cvt_pk_f16_f32 v177, v224, v225
    v_cvt_pk_f16_f32 v178, v232, v233
    s_nop 0
    v_cvt_pk_f16_f32 v179, v240, v241
    ds_write_b128 v207, v[176:179] offset:44032
    v_mfma_f32_16x16x32_bf16 v[236:239], v[164:167], v[136:139], 0
    v_mfma_f32_16x16x32_bf16 v[236:239], v[156:159], v[140:143], v[236:239]
    v_cvt_pk_f16_f32 v180, v218, v219
    v_cvt_pk_f16_f32 v181, v226, v227
    v_cvt_pk_f16_f32 v182, v234, v235
    v_cvt_pk_f16_f32 v183, v242, v243
    ds_write_b128 v207, v[180:183] offset:45056
    v_mfma_f32_16x16x32_bf16 v[244:247], v[164:167], v[144:147], 0
    v_mfma_f32_16x16x32_bf16 v[244:247], v[156:159], v[148:151], v[244:247]
    v_cvt_pk_f16_f32 v184, v220, v221
    v_cvt_pk_f16_f32 v185, v228, v229
    v_cvt_pk_f16_f32 v186, v236, v237
    s_nop 4
    v_cvt_pk_f16_f32 v187, v244, v245
    ds_write_b128 v207, v[184:187] offset:46080
    v_cvt_pk_f16_f32 v188, v222, v223
    v_cvt_pk_f16_f32 v189, v230, v231
    v_cvt_pk_f16_f32 v190, v238, v239
    v_cvt_pk_f16_f32 v191, v246, v247
    ds_write_b128 v207, v[188:191] offset:47104
    s_branch L_st1_done
L_st1_split:
    s_waitcnt lgkmcnt(8)
    ds_read_b64_tr_b16 v[144:145], v206 offset:96
    ds_read_b64_tr_b16 v[146:147], v206 offset:10464
    ds_read_b64_tr_b16 v[148:149], v206 offset:20832
    ds_read_b64_tr_b16 v[150:151], v206 offset:31200
    s_waitcnt lgkmcnt(0)
    v_mfma_f32_16x16x32_bf16 v[168:171], v[160:163], v[192:195], 0
    v_mfma_f32_16x16x32_bf16 v[220:223], v[164:167], v[120:123], 0
    v_mfma_f32_16x16x32_bf16 v[216:219], v[160:163], v[120:123], v[168:171]
    v_mfma_f32_16x16x32_bf16 v[228:231], v[164:167], v[128:131], 0
    v_mfma_f32_16x16x32_bf16 v[224:227], v[160:163], v[128:131], v[168:171]
    v_mfma_f32_16x16x32_bf16 v[236:239], v[164:167], v[136:139], 0
    v_mfma_f32_16x16x32_bf16 v[232:235], v[160:163], v[136:139], v[168:171]
    v_mfma_f32_16x16x32_bf16 v[244:247], v[164:167], v[144:147], 0
    v_mfma_f32_16x16x32_bf16 v[240:243], v[160:163], v[144:147], v[168:171]
    s_nop 1
    s_nop 0
    v_cvt_pk_f16_f32 v176, v216, v217
    v_cvt_pk_f16_f32 v180, v218, v219
    v_cvt_pk_f16_f32 v184, v220, v221
    v_cvt_pk_f16_f32 v188, v222, v223
    v_cvt_pk_f16_f32 v177, v224, v225
    v_cvt_pk_f16_f32 v181, v226, v227
    v_cvt_pk_f16_f32 v185, v228, v229
    v_cvt_pk_f16_f32 v189, v230, v231
    v_cvt_pk_f16_f32 v178, v232, v233
    v_cvt_pk_f16_f32 v182, v234, v235
    v_cvt_pk_f16_f32 v186, v236, v237
    v_cvt_pk_f16_f32 v190, v238, v239
    v_cvt_pk_f16_f32 v179, v240, v241
    v_cvt_pk_f16_f32 v183, v242, v243
    v_cvt_pk_f16_f32 v187, v244, v245
    v_cvt_pk_f16_f32 v191, v246, v247
    ds_write_b128 v207, v[176:179] offset:44032
    ds_write_b128 v207, v[180:183] offset:45056
    ds_write_b128 v207, v[184:187] offset:46080
    ds_write_b128 v207, v[188:191] offset:47104
    v_mfma_f32_16x16x32_bf16 v[168:171], v[152:155], v[196:199], 0
    v_mfma_f32_16x16x32_bf16 v[220:223], v[156:159], v[124:127], 0
    v_mfma_f32_16x16x32_bf16 v[216:219], v[152:155], v[124:127], v[168:171]
    v_mfma_f32_16x16x32_bf16 v[228:231], v[156:159], v[132:135], 0
    v_mfma_f32_16x16x32_bf16 v[224:227], v[152:155], v[132:135], v[168:171]
    v_mfma_f32_16x16x32_bf16 v[236:239], v[156:159], v[140:143], 0
    v_mfma_f32_16x16x32_bf16 v[232:235], v[152:155], v[140:143], v[168:171]
    v_mfma_f32_16x16x32_bf16 v[244:247], v[156:159], v[148:151], 0
    v_mfma_f32_16x16x32_bf16 v[240:243], v[152:155], v[148:151], v[168:171]
    s_waitcnt lgkmcnt(0)
    s_nop 0
    v_cvt_pk_f16_f32 v176, v216, v217
    v_cvt_pk_f16_f32 v180, v218, v219
    v_cvt_pk_f16_f32 v184, v220, v221
    v_cvt_pk_f16_f32 v188, v222, v223
    v_cvt_pk_f16_f32 v177, v224, v225
    v_cvt_pk_f16_f32 v181, v226, v227
    v_cvt_pk_f16_f32 v185, v228, v229
    v_cvt_pk_f16_f32 v189, v230, v231
    v_cvt_pk_f16_f32 v178, v232, v233
    v_cvt_pk_f16_f32 v182, v234, v235
    v_cvt_pk_f16_f32 v186, v236, v237
    v_cvt_pk_f16_f32 v190, v238, v239
    v_cvt_pk_f16_f32 v179, v240, v241
    v_cvt_pk_f16_f32 v183, v242, v243
    v_cvt_pk_f16_f32 v187, v244, v245
    v_cvt_pk_f16_f32 v191, v246, v247
    ds_write_b128 v207, v[176:179] offset:60416
    ds_write_b128 v207, v[180:183] offset:61440
    ds_write_b128 v207, v[184:187] offset:62464
    ds_write_b128 v207, v[188:191] offset:63488
L_st1_done:
    s_mov_b64 exec, 1
    ds_add_u32 v0, v255 offset:42824
    s_mov_b64 exec, -1
    s_lshl_b32 s31, s30, 12
    v_add_u32 v5, s31, v3
    s_and_b32 s31, s28, 0x30003
    v_mov_b32 v210, s31
    s_mov_b32 s58, 0xfffcfffc
    s_and_b32 s32, s48, 3
    s_cselect_b32 s72, -1, 0xff
    s_cselect_b32 s73, -1, 0
    s_mov_b32 s74, s48
    v_mov_b32 v209, 2147483392
    s_cmp_eq_u32 s48, 7
    s_cbranch_scc1 L_no_consts
    v_mul_f32 v250, v212, v251
    v_fmamk_f32 v68, v250, 0x3d800000, v252
    v_sin_f32 v36, v250
    v_cos_f32 v250, v250
    v_cos_f32 v64, v68
    v_sin_f32 v68, v68
    v_cvt_pk_f16_f32 v32, v250, v36
    v_cvt_pk_f16_f32 v36, -v36, v250
    v_mul_f32 v250, v213, v251
    v_fmamk_f32 v69, v250, 0x3d800000, v252
    v_sin_f32 v37, v250
    v_cos_f32 v250, v250
    v_cos_f32 v65, v69
    v_sin_f32 v69, v69
    v_cvt_pk_f16_f32 v33, v250, v37
    v_cvt_pk_f16_f32 v37, -v37, v250
    v_mul_f32 v250, v214, v251
    v_fmamk_f32 v70, v250, 0x3d800000, v252
    v_sin_f32 v38, v250
    v_cos_f32 v250, v250
    v_cos_f32 v66, v70
    v_sin_f32 v70, v70
    v_cvt_pk_f16_f32 v34, v250, v38
    v_cvt_pk_f16_f32 v38, -v38, v250
    v_mul_f32 v250, v215, v251
    v_fmamk_f32 v71, v250, 0x3d800000, v252
    v_sin_f32 v39, v250
    v_cos_f32 v250, v250
    v_cos_f32 v67, v71
    v_sin_f32 v71, v71
    v_cvt_pk_f16_f32 v35, v250, v39
    v_cvt_pk_f16_f32 v39, -v39, v250
    v_add_f32 v251, 1.0, v251
    v_mul_f32 v250, v212, v251
    v_fmamk_f32 v76, v250, 0x3d800000, v252
    v_sin_f32 v44, v250
    v_cos_f32 v250, v250
    v_cos_f32 v72, v76
    v_sin_f32 v76, v76
    v_cvt_pk_f16_f32 v40, v250, v44
    v_cvt_pk_f16_f32 v44, -v44, v250
    v_mul_f32 v250, v213, v251
    v_fmamk_f32 v77, v250, 0x3d800000, v252
    v_sin_f32 v45, v250
    v_cos_f32 v250, v250
    v_cos_f32 v73, v77
    v_sin_f32 v77, v77
    v_cvt_pk_f16_f32 v41, v250, v45
    v_cvt_pk_f16_f32 v45, -v45, v250
    v_mul_f32 v250, v214, v251
    v_fmamk_f32 v78, v250, 0x3d800000, v252
    v_sin_f32 v46, v250
    v_cos_f32 v250, v250
    v_cos_f32 v74, v78
    v_sin_f32 v78, v78
    v_cvt_pk_f16_f32 v42, v250, v46
    v_cvt_pk_f16_f32 v46, -v46, v250
    v_mul_f32 v250, v215, v251
    v_fmamk_f32 v79, v250, 0x3d800000, v252
    v_sin_f32 v47, v250
    v_cos_f32 v250, v250
    v_cos_f32 v75, v79
    v_sin_f32 v79, v79
    v_cvt_pk_f16_f32 v43, v250, v47
    v_cvt_pk_f16_f32 v47, -v47, v250
    s_and_b32 s31, s46, 1
    s_lshl_b32 s31, s31, 6
    s_lshr_b32 s32, s46, 1
    s_add_u32 s49, s31, s32
    s_bitcmp1_b32 s49, 2
    s_cselect_b64 vcc, -1, 0
    v_cndmask_b32 v80, v16, v20, vcc
    v_cndmask_b32 v84, v20, v16, vcc
    v_cndmask_b32 v81, v17, v21, vcc
    v_cndmask_b32 v85, v21, v17, vcc
    v_cndmask_b32 v82, v18, v22, vcc
    v_cndmask_b32 v86, v22, v18, vcc
    v_cndmask_b32 v83, v19, v23, vcc
    v_cndmask_b32 v87, v23, v19, vcc
    s_bfe_u32 s31, s49, 0x10001
    v_and_b32 v6, 7, v2
    v_xor_b32 v6, s31, v6
    v_lshlrev_b32 v6, 4, v6
    v_lshrrev_b32 v7, 4, v2
    v_lshlrev_b32 v7, 3, v7
    v_bfe_u32 v209, v2, 3, 1
    v_add_u32 v7, v7, v209
    v_mul_u32_u24 v7, 16512, v7
    v_add_u32 v209, v6, v7
    s_mul_i32 s31, s48, 528384
    s_lshl_b32 s32, s49, 7
    s_add_u32 s31, s31, s32
    s_add_u32 s60, s31, 2097152
L_no_consts:
L_st23:
L_sync3:
    ds_read_b32 v1, v0 offset:42824
    ds_read_b128 v[120:123], v5 offset:44032
    ds_read_b128 v[124:127], v5 offset:45056
    ds_read_b128 v[128:131], v5 offset:46080
    ds_read_b128 v[132:135], v5 offset:47104
    s_waitcnt lgkmcnt(4)
    v_readfirstlane_b32 s31, v1
    s_nop 0
    s_cmp_ge_u32 s31, 4
    s_cbranch_scc0 L_sync3
    s_cmp_eq_u32 s48, 7
    s_cbranch_scc1 L_p1_done
    s_add_u32 s61, s60, 33024
    s_add_u32 s62, s61, 33024
    s_add_u32 s63, s62, 33024
    s_waitcnt lgkmcnt(3)
    v_mfma_f32_16x16x32_f16 v[136:139], v[120:123], v[16:19], 0
    v_mfma_f32_16x16x32_f16 v[140:143], v[120:123], v[20:23], 0
    s_waitcnt lgkmcnt(2)
    v_mfma_f32_16x16x32_f16 v[144:147], v[124:127], v[24:27], 0
    v_mfma_f32_16x16x32_f16 v[148:151], v[124:127], v[28:31], 0
    s_nop 3
    v_pk_mul_f32 v[152:153], v[48:49], v[136:137]
    v_pk_mul_f32 v[154:155], v[50:51], v[138:139]
    v_pk_mul_f32 v[156:157], v[52:53], v[136:137]
    v_pk_mul_f32 v[158:159], v[54:55], v[138:139]
    v_pk_fma_f32 v[152:153], v[52:53], v[140:141], v[152:153]
    v_pk_fma_f32 v[156:157], v[48:49], v[140:141], v[156:157] neg_lo:[0,0,1] neg_hi:[0,0,1]
    v_pk_fma_f32 v[154:155], v[54:55], v[142:143], v[154:155]
    v_pk_fma_f32 v[158:159], v[50:51], v[142:143], v[158:159] neg_lo:[0,0,1] neg_hi:[0,0,1]
    v_cvt_pk_f16_f32 v120, v152, v156
    v_cvt_pk_f16_f32 v121, v153, v157
    v_cvt_pk_f16_f32 v122, v154, v158
    v_cvt_pk_f16_f32 v123, v155, v159
    s_waitcnt lgkmcnt(1)
    s_nop 0
    v_mfma_f32_16x16x32_f16 v[136:139], v[128:131], v[32:35], 0
    v_mfma_f32_16x16x32_f16 v[140:143], v[128:131], v[36:39], 0
    v_mfma_f32_16x16x32_f16 v[216:219], v[80:83], v[120:123], 0
    v_mfma_f32_16x16x32_f16 v[220:223], v[84:87], v[120:123], 0
    v_pk_mul_f32 v[152:153], v[56:57], v[144:145]
    v_pk_mul_f32 v[154:155], v[58:59], v[146:147]
    v_pk_mul_f32 v[156:157], v[60:61], v[144:145]
    v_pk_mul_f32 v[158:159], v[62:63], v[146:147]
    v_pk_fma_f32 v[152:153], v[60:61], v[148:149], v[152:153]
    v_pk_fma_f32 v[156:157], v[56:57], v[148:149], v[156:157] neg_lo:[0,0,1] neg_hi:[0,0,1]
    v_pk_fma_f32 v[154:155], v[62:63], v[150:151], v[154:155]
    v_pk_fma_f32 v[158:159], v[58:59], v[150:151], v[158:159] neg_lo:[0,0,1] neg_hi:[0,0,1]
    v_cvt_pk_f16_f32 v124, v152, v156
    v_cvt_pk_f16_f32 v125, v153, v157
    v_cvt_pk_f16_f32 v126, v154, v158
    v_cvt_pk_f16_f32 v127, v155, v159
    s_waitcnt lgkmcnt(0)
    s_nop 0
    v_mfma_f32_16x16x32_f16 v[144:147], v[132:135], v[40:43], 0
    v_mfma_f32_16x16x32_f16 v[148:151], v[132:135], v[44:47], 0
    v_mfma_f32_16x16x32_f16 v[224:227], v[80:83], v[124:127], 0
    v_mfma_f32_16x16x32_f16 v[228:231], v[84:87], v[124:127], 0
    v_pk_mul_f32 v[152:153], v[64:65], v[136:137]
    v_pk_mul_f32 v[154:155], v[66:67], v[138:139]
    v_pk_mul_f32 v[156:157], v[68:69], v[136:137]
    v_pk_mul_f32 v[158:159], v[70:71], v[138:139]
    v_pk_fma_f32 v[152:153], v[68:69], v[140:141], v[152:153]
    v_pk_fma_f32 v[156:157], v[64:65], v[140:141], v[156:157] neg_lo:[0,0,1] neg_hi:[0,0,1]
    v_pk_fma_f32 v[154:155], v[70:71], v[142:143], v[154:155]
    v_pk_fma_f32 v[158:159], v[66:67], v[142:143], v[158:159] neg_lo:[0,0,1] neg_hi:[0,0,1]
    v_cvt_pk_f16_f32 v128, v152, v156
    v_cvt_pk_f16_f32 v129, v153, v157
    v_cvt_pk_f16_f32 v130, v154, v158
    v_cvt_pk_f16_f32 v131, v155, v159
    s_nop 1
    s_nop 0
    v_mfma_f32_16x16x32_f16 v[232:235], v[80:83], v[128:131], 0
    v_mfma_f32_16x16x32_f16 v[236:239], v[84:87], v[128:131], 0
    v_pk_mul_f32 v[152:153], v[72:73], v[144:145]
    v_pk_mul_f32 v[154:155], v[74:75], v[146:147]
    v_pk_mul_f32 v[156:157], v[76:77], v[144:145]
    v_pk_mul_f32 v[158:159], v[78:79], v[146:147]
    v_pk_fma_f32 v[152:153], v[76:77], v[148:149], v[152:153]
    v_pk_fma_f32 v[156:157], v[72:73], v[148:149], v[156:157] neg_lo:[0,0,1] neg_hi:[0,0,1]
    v_pk_fma_f32 v[154:155], v[78:79], v[150:151], v[154:155]
    v_pk_fma_f32 v[158:159], v[74:75], v[150:151], v[158:159] neg_lo:[0,0,1] neg_hi:[0,0,1]
    v_cvt_pk_f16_f32 v132, v152, v156
    v_cvt_pk_f16_f32 v133, v153, v157
    v_cvt_pk_f16_f32 v134, v154, v158
    v_cvt_pk_f16_f32 v135, v155, v159
    s_nop 1
    s_nop 0
    v_mfma_f32_16x16x32_f16 v[240:243], v[80:83], v[132:135], 0
    v_mfma_f32_16x16x32_f16 v[244:247], v[84:87], v[132:135], 0
    v_cvt_pk_f16_f32 v176, v216, v224
    v_cvt_pk_f16_f32 v178, v220, v228
    v_and_or_b32 v176, v176, s58, v210
    v_and_or_b32 v178, v178, s58, v210
    v_cvt_pk_f16_f32 v180, v217, v225
    v_cvt_pk_f16_f32 v182, v221, v229
    v_and_or_b32 v180, v180, s58, v210
    v_and_or_b32 v182, v182, s58, v210
    v_cvt_pk_f16_f32 v184, v218, v226
    v_cvt_pk_f16_f32 v186, v222, v230
    v_and_or_b32 v184, v184, s58, v210
    v_and_or_b32 v186, v186, s58, v210
    v_cvt_pk_f16_f32 v188, v219, v227
    v_cvt_pk_f16_f32 v190, v223, v231
    v_and_or_b32 v188, v188, s58, v210
    v_and_or_b32 v190, v190, s58, v210
    v_cvt_pk_f16_f32 v177, v232, v240
    v_cvt_pk_f16_f32 v179, v236, v244
    v_and_or_b32 v177, v177, s58, v210
    v_and_or_b32 v179, v179, s58, v210
    v_cvt_pk_f16_f32 v181, v233, v241
    v_cvt_pk_f16_f32 v183, v237, v245
    v_and_or_b32 v181, v181, s58, v210
    v_and_or_b32 v183, v183, s58, v210
    v_cvt_pk_f16_f32 v185, v234, v242
    v_cvt_pk_f16_f32 v187, v238, v246
    v_and_or_b32 v185, v185, s58, v210
    v_and_or_b32 v187, v187, s58, v210
    v_cvt_pk_f16_f32 v189, v235, v243
    v_cvt_pk_f16_f32 v191, v239, v247
    v_and_or_b32 v189, v189, s58, v210
    v_and_or_b32 v191, v191, s58, v210
    s_cmp_eq_u32 s50, 0
    s_cbranch_scc1 L_p1_done
    s_mov_b32 exec_hi, s72
    buffer_store_dwordx4 v[176:179], v209, s[12:15], s60 offen sc1
    s_mov_b32 exec_hi, s73
    buffer_store_dwordx4 v[180:183], v209, s[12:15], s61 offen sc1
    buffer_store_dwordx4 v[184:187], v209, s[12:15], s62 offen sc1
    buffer_store_dwordx4 v[188:191], v209, s[12:15], s63 offen sc1
    s_mov_b32 exec_hi, -1
    s_mov_b32 s50, 0
    s_add_u32 s60, s60, 16384
    v_add_u32 v5, 16384, v5
    s_sub_u32 s31, s48, 4
    v_cvt_f32_i32 v252, s31
    v_mul_f32 v252, 0x3d800000, v252
    v_and_b32 v251, 15, v2
    v_lshlrev_b32 v251, 2, v251
    v_cvt_f32_u32 v251, v251
    v_fma_f32 v250, v212, v251, v252
    v_sin_f32 v84, v250
    v_cos_f32 v250, v250
    s_nop 0
    v_cvt_pk_f16_f32 v80, v250, v84
    v_cvt_pk_f16_f32 v84, -v84, v250
    v_fma_f32 v250, v213, v251, v252
    v_sin_f32 v85, v250
    v_cos_f32 v250, v250
    s_nop 0
    v_cvt_pk_f16_f32 v81, v250, v85
    v_cvt_pk_f16_f32 v85, -v85, v250
    v_fma_f32 v250, v214, v251, v252
    v_sin_f32 v86, v250
    v_cos_f32 v250, v250
    s_nop 0
    v_cvt_pk_f16_f32 v82, v250, v86
    v_cvt_pk_f16_f32 v86, -v86, v250
    v_fma_f32 v250, v215, v251, v252
    v_sin_f32 v87, v250
    v_cos_f32 v250, v250
    s_nop 0
    v_cvt_pk_f16_f32 v83, v250, v87
    v_cvt_pk_f16_f32 v87, -v87, v250
    s_branch L_st23
L_p1_done:
    s_cmp_lt_u32 s2, 224
    s_cbranch_scc1 L_zst_later
    s_cmp_eq_u32 s74, 7
    s_cbranch_scc1 L_zst_later
    s_mov_b32 exec_hi, s72
    buffer_store_dwordx4 v[176:179], v209, s[12:15], s60 offen sc1
    s_mov_b32 exec_hi, s73
    buffer_store_dwordx4 v[180:183], v209, s[12:15], s61 offen sc1
    buffer_store_dwordx4 v[184:187], v209, s[12:15], s62 offen sc1
    buffer_store_dwordx4 v[188:191], v209, s[12:15], s63 offen sc1
    s_mov_b32 exec_hi, -1
    s_mov_b32 s74, 7
L_zst_later:
    s_mov_b64 exec, 1
    ds_add_u32 v0, v255 offset:42828
    s_mov_b64 exec, -1
    s_setprio 0
    v_mov_b32 v4, v112
    v_mov_b32 v5, v113
    v_mov_b32 v249, v114
    v_mov_b32 v205, v115
    v_mov_b32 v248, v116
    v_mov_b32 v208, v117
    v_mov_b32 v7, v118
    v_mov_b32 v6, v119
    s_and_b32 s31, s2, 7
    s_sub_u32 s32, 8, s31
    s_min_u32 s46, s31, s32
    s_cmp_gt_u32 s31, 4
    s_cselect_b32 s31, 16, 0
    s_lshr_b32 s47, s2, 4
    s_add_u32 s47, s47, s31
    s_bfe_u32 s53, s2, 0x10003
    s_lshl_b32 s53, s53, 7
    s_add_u32 s53, s53, s31
    s_lshl_b32 s31, s30, 5
    s_add_u32 s53, s53, s31
    s_lshl_b32 s48, s46, 1
    s_add_u32 s48, s48, 2040
    s_mov_b32 s49, 32768
    v_mov_b32 v212, v210
    v_mov_b32 v213, v210
    v_mov_b32 v214, v210
    v_mov_b32 v215, v210
L_sync4:
    ds_read_b32 v1, v0 offset:42860
    s_waitcnt lgkmcnt(0)
    v_readfirstlane_b32 s31, v1
    s_nop 0
    s_cmp_ge_u32 s31, 1
    s_cbranch_scc0 L_sync4
    buffer_load_dwordx4 v[24:27], v6, s[12:15], s49 offen
    s_cmp_eq_u32 s74, 7
    s_cbranch_scc1 L_no_zst
    s_cmp_ge_u32 s2, 224
    s_cbranch_scc1 L_zst_go
L_sync5:
    ds_read_b32 v1, v0 offset:42840
    s_waitcnt lgkmcnt(0)
    v_readfirstlane_b32 s31, v1
    s_nop 0
    s_cmp_ge_u32 s31, 1
    s_cbranch_scc0 L_sync5
L_zst_go:
    s_mov_b32 exec_hi, s72
    buffer_store_dwordx4 v[176:179], v209, s[12:15], s60 offen sc1
    s_mov_b32 exec_hi, s73
    buffer_store_dwordx4 v[180:183], v209, s[12:15], s61 offen sc1
    buffer_store_dwordx4 v[184:187], v209, s[12:15], s62 offen sc1
    buffer_store_dwordx4 v[188:191], v209, s[12:15], s63 offen sc1
    s_mov_b32 exec_hi, -1
L_no_zst:
    v_and_b32 v160, 15, v2
    v_add_u32 v160, s53, v160
    v_cvt_f32_u32 v160, v160
    v_add_f32 v160, 0.5, v160
    v_mul_f32 v160, 0x3b800000, v160
    v_and_b32 v161, 32, v2
    v_bfe_u32 v162, v2, 4, 1
    v_lshl_add_u32 v161, v162, 3, v161
    v_cvt_f32_u32 v161, v161
    v_mul_f32 v161, v161, v160
    v_fmamk_f32 v88, v160, 0x0, v161
    v_fmamk_f32 v162, v160, 0x40000000, v161
    v_sin_f32 v104, v88
    v_sin_f32 v163, v162
    v_cos_f32 v88, v88
    v_cos_f32 v162, v162
    v_cvt_pk_f16_f32 v104, v104, v163
    v_cvt_pk_f16_f32 v88, v88, v162
    v_fmamk_f32 v89, v160, 0x40800000, v161
    v_fmamk_f32 v162, v160, 0x40c00000, v161
    v_sin_f32 v105, v89
    v_sin_f32 v163, v162
    v_cos_f32 v89, v89
    v_cos_f32 v162, v162
    v_cvt_pk_f16_f32 v105, v105, v163
    v_cvt_pk_f16_f32 v89, v89, v162
    v_fmamk_f32 v90, v160, 0x41800000, v161
    v_fmamk_f32 v162, v160, 0x41900000, v161
    v_sin_f32 v106, v90
    v_sin_f32 v163, v162
    v_cos_f32 v90, v90
    v_cos_f32 v162, v162
    v_cvt_pk_f16_f32 v106, v106, v163
    v_cvt_pk_f16_f32 v90, v90, v162
    v_fmamk_f32 v91, v160, 0x41a00000, v161
    v_fmamk_f32 v162, v160, 0x41b00000, v161
    v_sin_f32 v107, v91
    v_sin_f32 v163, v162
    v_cos_f32 v91, v91
    v_cos_f32 v162, v162
    v_cvt_pk_f16_f32 v107, v107, v163
    v_cvt_pk_f16_f32 v91, v91, v162
    v_fmamk_f32 v92, v160, 0x42800000, v161
    v_fmamk_f32 v162, v160, 0x42840000, v161
    v_sin_f32 v108, v92
    v_sin_f32 v163, v162
    v_cos_f32 v92, v92
    v_cos_f32 v162, v162
    v_cvt_pk_f16_f32 v108, v108, v163
    v_cvt_pk_f16_f32 v92, v92, v162
    v_fmamk_f32 v93, v160, 0x42880000, v161
    v_fmamk_f32 v162, v160, 0x428c0000, v161
    v_sin_f32 v109, v93
    v_sin_f32 v163, v162
    v_cos_f32 v93, v93
    v_cos_f32 v162, v162
    v_cvt_pk_f16_f32 v109, v109, v163
    v_cvt_pk_f16_f32 v93, v93, v162
    v_fmamk_f32 v94, v160, 0x42a00000, v161
    v_fmamk_f32 v162, v160, 0x42a40000, v161
    v_sin_f32 v110, v94
    v_sin_f32 v163, v162
    v_cos_f32 v94, v94
    v_cos_f32 v162, v162
    v_cvt_pk_f16_f32 v110, v110, v163
    v_cvt_pk_f16_f32 v94, v94, v162
    v_fmamk_f32 v95, v160, 0x42a80000, v161
    v_fmamk_f32 v162, v160, 0x42ac0000, v161
    v_sin_f32 v111, v95
    v_sin_f32 v163, v162
    v_cos_f32 v95, v95
    v_cos_f32 v162, v162
    v_cvt_pk_f16_f32 v111, v111, v163
    v_cvt_pk_f16_f32 v95, v95, v162
    v_fmamk_f32 v96, v160, 0x3f800000, v161
    v_fmamk_f32 v162, v160, 0x40400000, v161
    v_sin_f32 v112, v96
    v_sin_f32 v163, v162
    v_cos_f32 v96, v96
    v_cos_f32 v162, v162
    v_cvt_pk_f16_f32 v112, v112, v163
    v_cvt_pk_f16_f32 v96, v96, v162
    v_fmamk_f32 v97, v160, 0x40a00000, v161
    v_fmamk_f32 v162, v160, 0x40e00000, v161
    v_sin_f32 v113, v97
    v_sin_f32 v163, v162
    v_cos_f32 v97, v97
    v_cos_f32 v162, v162
    v_cvt_pk_f16_f32 v113, v113, v163
    v_cvt_pk_f16_f32 v97, v97, v162
    v_fmamk_f32 v98, v160, 0x41880000, v161
    v_fmamk_f32 v162, v160, 0x41980000, v161
    v_sin_f32 v114, v98
    v_sin_f32 v163, v162
    v_cos_f32 v98, v98
    v_cos_f32 v162, v162
    v_cvt_pk_f16_f32 v114, v114, v163
    v_cvt_pk_f16_f32 v98, v98, v162
    v_fmamk_f32 v99, v160, 0x41a80000, v161
    v_fmamk_f32 v162, v160, 0x41b80000, v161
    v_sin_f32 v115, v99
    v_sin_f32 v163, v162
    v_cos_f32 v99, v99
    v_cos_f32 v162, v162
    v_cvt_pk_f16_f32 v115, v115, v163
    v_cvt_pk_f16_f32 v99, v99, v162
    v_fmamk_f32 v100, v160, 0x42820000, v161
    v_fmamk_f32 v162, v160, 0x42860000, v161
    v_sin_f32 v116, v100
    v_sin_f32 v163, v162
    v_cos_f32 v100, v100
    v_cos_f32 v162, v162
    v_cvt_pk_f16_f32 v116, v116, v163
    v_cvt_pk_f16_f32 v100, v100, v162
    v_fmamk_f32 v101, v160, 0x428a0000, v161
    v_fmamk_f32 v162, v160, 0x428e0000, v161
    v_sin_f32 v117, v101
    v_sin_f32 v163, v162
    v_cos_f32 v101, v101
    v_cos_f32 v162, v162
    v_cvt_pk_f16_f32 v117, v117, v163
    v_cvt_pk_f16_f32 v101, v101, v162
    v_fmamk_f32 v102, v160, 0x42a20000, v161
    v_fmamk_f32 v162, v160, 0x42a60000, v161
    v_sin_f32 v118, v102
    v_sin_f32 v163, v162
    v_cos_f32 v102, v102
    v_cos_f32 v162, v162
    v_cvt_pk_f16_f32 v118, v118, v163
    v_cvt_pk_f16_f32 v102, v102, v162
    v_fmamk_f32 v103, v160, 0x42aa0000, v161
    v_fmamk_f32 v162, v160, 0x42ae0000, v161
    v_sin_f32 v119, v103
    v_sin_f32 v163, v162
    v_cos_f32 v103, v103
    v_cos_f32 v162, v162
    v_cvt_pk_f16_f32 v119, v119, v163
    v_cvt_pk_f16_f32 v103, v103, v162
    v_cmp_gt_u32 vcc, 16, v2
    v_and_b32 v162, 1, v2
    v_lshlrev_b32 v162, 15, v162
    v_or_b32 v162, 0x3c00, v162
    v_and_b32 v160, 0xffff0000, v104
    v_or_b32 v162, v162, v160
    v_cndmask_b32 v104, v104, v162, vcc
    s_mul_i32 s51, s46, 528384
    s_add_u32 s51, s51, 2097152
    s_mul_i32 s54, s47, 16512
    s_lshl_b32 s32, s30, 12
    s_add_u32 s50, s51, s54
    s_add_u32 s50, s50, s32
    s_add_u32 s55, s47, 1
    s_and_b32 s55, s55, 31
    s_mul_i32 s55, s55, 16512
    v_add_u32 v250, s32, v3
    v_add_u32 v199, s76, v3
    v_lshl_add_u32 v200, v2, 7, s32
    v_and_b32 v1, 2, v2
    v_lshl_add_u32 v200, v1, 3, v200
    v_and_b32 v1, 0x70, v3
    v_add_u32 v1, 16384, v1
    s_mov_b32 vcc_lo, 0
    s_mov_b32 vcc_hi, -1
    v_cndmask_b32 v200, v200, v1, vcc
    s_mov_b32 vcc_hi, 0xff
    v_mov_b32 v1, s55
    v_mov_b32 v201, s54
    v_cndmask_b32 v1, v1, v201, vcc
    v_mov_b32 v201, 16640
    v_cndmask_b32 v201, v201, v0, vcc
    v_add_u32 v201, v201, v200
    v_add_u32 v200, v1, v200
    v_lshrrev_b32 v251, 5, v2
    v_lshlrev_b32 v251, 11, v251
    v_bfe_u32 v1, v2, 2, 3
    v_lshl_add_u32 v251, v1, 7, v251
    v_and_b32 v1, 3, v2
    v_lshl_add_u32 v251, v1, 5, v251
    v_bfe_u32 v1, v2, 3, 1
    v_lshl_add_u32 v251, v1, 4, v251
    v_bfe_u32 v1, v2, 4, 1
    v_lshl_add_u32 v251, v1, 3, v251
    v_xor_b32 v252, 16, v251
    v_xor_b32 v253, 8, v251
    v_xor_b32 v254, 24, v251
    v_cmp_gt_u32 vcc, 4, v2
    v_mov_b32 v1, 16384
    s_nop 0
    v_cndmask_b32 v1, v0, v1, vcc
    v_add_u32 v206, v253, v1
    v_add_u32 v207, v254, v1
    s_mov_b32 vcc_lo, 0x88888888
    s_mov_b32 vcc_hi, 0x88888888
    v_mov_b32 v1, 16544
    v_cndmask_b32 v1, 32, v1, vcc
    v_add_u32 v202, v251, v1
    v_add_u32 v203, v253, v1
    v_add_u32 v204, v206, v1
    s_waitcnt vmcnt(0)
L_stat_check:
    v_cmp_ne_u64 vcc, s[28:29], v[26:27]
    s_nop 0
    s_cbranch_vccz L_stat_got
    s_cmp_eq_u32 s35, 0
    s_cbranch_scc1 L_stat_got
    s_sub_u32 s35, s35, 1
    s_sleep 2
    s_mov_b64 exec, vcc
    buffer_load_dwordx4 v[24:27], v6, s[12:15], s49 offen sc1
    s_mov_b64 exec, -1
    s_waitcnt vmcnt(0)
    s_branch L_stat_check
L_stat_got:
    v_cndmask_b32 v24, v24, v25, s[88:89]
    v_mov_b32 v32, v24
    s_nop 1
    v_permlane32_swap_b32 v24, v32
    v_mov_b32 v28, v24
    v_mov_b32 v36, v32
    s_nop 0
    v_permlane16_swap_b32 v24, v28
    v_permlane16_swap_b32 v32, v36
    v_lshlrev_b32 v26, 16, v24
    v_and_b32 v24, 0xffff0000, v24
    v_rcp_f32 v24, v24
    v_lshlrev_b32 v30, 16, v28
    v_and_b32 v28, 0xffff0000, v28
    v_rcp_f32 v28, v28
    v_lshlrev_b32 v34, 16, v32
    v_and_b32 v32, 0xffff0000, v32
    v_rcp_f32 v32, v32
    v_lshlrev_b32 v38, 16, v36
    v_and_b32 v36, 0xffff0000, v36
    v_rcp_f32 v36, v36
    v_mul_f32 v24, 0xbfb8aa3b, v24
    v_mul_f32_e64 v26, -v26, v24
    v_mul_f32 v28, 0xbfb8aa3b, v28
    v_mul_f32_e64 v30, -v30, v28
    v_mul_f32 v32, 0xbfb8aa3b, v32
    v_mul_f32_e64 v34, -v34, v32
    v_mul_f32 v36, 0xbfb8aa3b, v36
    v_mul_f32_e64 v38, -v38, v36
    s_waitcnt lgkmcnt(0)
L_sync6:
    ds_read_b32 v1, v0 offset:42848
    s_waitcnt lgkmcnt(0)
    v_readfirstlane_b32 s31, v1
    s_nop 0
    s_cmp_ge_u32 s31, 4
    s_cbranch_scc0 L_sync6
    s_add_u32 m0, s76, 0
    s_nop 0
    buffer_load_dwordx4 v4, s[8:11], 0 offen lds
    s_add_u32 m0, s76, 1024
    s_nop 0
    buffer_load_dwordx4 v5, s[8:11], 0 offen lds
    s_add_u32 m0, s76, 2048
    s_nop 0
    buffer_load_dwordx4 v249, s[8:11], 0 offen lds
    s_add_u32 m0, s76, 3072
    s_nop 0
    buffer_load_dwordx4 v205, s[8:11], 0 offen lds
L_sync7:
    ds_read_b32 v1, v0 offset:42844
    ds_read_b32 v198, v0 offset:41556
    s_waitcnt lgkmcnt(1)
    v_readfirstlane_b32 s31, v1
    s_nop 0
    s_cmp_ge_u32 s31, 1
    s_cbranch_scc0 L_sync7
    v_and_b32 v6, 48, v2
    v_lshlrev_b32 v6, 1, v6
    v_mov_b32 v209, 2147483392
    s_waitcnt lgkmcnt(0)
    v_readfirstlane_b32 s33, v198
    s_nop 0
    s_andn2_b32 s33, 0x7ff, s33
    s_sub_u32 s31, 0, s33
    s_and_b32 s31, s31, 2047
    s_sub_u32 s32, s48, s33
    s_sub_u32 s34, s48, s31
    v_cmp_eq_u32 vcc, s33, v7
    v_cmp_eq_u32 s[54:55], s33, v248
    s_nop 0
    v_cndmask_b32 v4, v4, v209, vcc
    v_cmp_eq_u32 vcc, s31, v7
    v_cmp_eq_u32 s[56:57], s31, v248
    s_nop 0
    v_cndmask_b32 v5, v5, v209, vcc
    v_cmp_eq_u32 vcc, s32, v7
    v_cmp_eq_u32 s[58:59], s32, v248
    s_nop 0
    v_cndmask_b32 v249, v249, v209, vcc
    v_cmp_eq_u32 vcc, s34, v7
    v_cmp_eq_u32 s[60:61], s34, v248
    s_nop 0
    v_cndmask_b32 v205, v205, v209, vcc
    s_or_b64 s[62:63], s[54:55], s[58:59]
    s_or_b64 s[64:65], s[56:57], s[60:61]
    s_waitcnt vmcnt(0)
    buffer_load_dwordx4 v[72:75], v3, s[12:15], s50 offen offset:0 sc1
    buffer_load_dwordx4 v[76:79], v3, s[12:15], s50 offen offset:1024 sc1
    buffer_load_dwordx4 v[80:83], v3, s[12:15], s50 offen offset:2048 sc1
    buffer_load_dwordx4 v[84:87], v3, s[12:15], s50 offen offset:3072 sc1
    s_mov_b32 exec_hi, 0x1ff
    buffer_load_dwordx4 v[212:215], v200, s[12:15], s51 offen sc1
    s_mov_b32 exec_hi, -1
    ds_read_b128 v[8:11], v208 offset:0
    ds_read_b128 v[12:15], v208 offset:1024
    ds_read_b128 v[16:19], v208 offset:2048
    ds_read_b128 v[20:23], v208 offset:3072
    s_waitcnt lgkmcnt(0)
    v_lshlrev_b32 v40, 16, v8
    v_and_b32 v41, 0xffff0000, v8
    v_lshlrev_b32 v42, 16, v9
    v_and_b32 v43, 0xffff0000, v9
    v_lshlrev_b32 v44, 16, v10
    v_and_b32 v45, 0xffff0000, v10
    v_lshlrev_b32 v46, 16, v11
    v_and_b32 v47, 0xffff0000, v11
    v_lshlrev_b32 v48, 16, v12
    v_and_b32 v55, 0xffff0000, v12
    v_lshlrev_b32 v54, 16, v13
    v_and_b32 v53, 0xffff0000, v13
    v_lshlrev_b32 v52, 16, v14
    v_and_b32 v51, 0xffff0000, v14
    v_lshlrev_b32 v50, 16, v15
    v_and_b32 v49, 0xffff0000, v15
    v_lshlrev_b32 v56, 16, v16
    v_and_b32 v57, 0xffff0000, v16
    v_lshlrev_b32 v58, 16, v17
    v_and_b32 v59, 0xffff0000, v17
    v_lshlrev_b32 v60, 16, v18
    v_and_b32 v61, 0xffff0000, v18
    v_lshlrev_b32 v62, 16, v19
    v_and_b32 v63, 0xffff0000, v19
    v_lshlrev_b32 v64, 16, v20
    v_and_b32 v71, 0xffff0000, v20
    v_lshlrev_b32 v70, 16, v21
    v_and_b32 v69, 0xffff0000, v21
    v_lshlrev_b32 v68, 16, v22
    v_and_b32 v67, 0xffff0000, v22
    v_lshlrev_b32_e64 v66, 16, v23
    v_and_b32 v65, 0xffff0000, v23
    v_pk_fma_f32 v[120:121], v[40:41], v[24:25], v[26:27] op_sel_hi:[1,0,0]
    v_pk_fma_f32 v[122:123], v[42:43], v[24:25], v[26:27] op_sel_hi:[1,0,0]
    v_pk_fma_f32 v[124:125], v[44:45], v[24:25], v[26:27] op_sel_hi:[1,0,0]
    v_pk_fma_f32 v[126:127], v[46:47], v[24:25], v[26:27] op_sel_hi:[1,0,0]
    v_pk_fma_f32 v[128:129], v[48:49], v[28:29], v[30:31] op_sel_hi:[1,0,0]
    v_pk_fma_f32 v[130:131], v[50:51], v[28:29], v[30:31] op_sel_hi:[1,0,0]
    v_pk_fma_f32 v[132:133], v[52:53], v[28:29], v[30:31] op_sel_hi:[1,0,0]
    v_pk_fma_f32 v[134:135], v[54:55], v[28:29], v[30:31] op_sel_hi:[1,0,0]
    v_pk_fma_f32 v[136:137], v[56:57], v[32:33], v[34:35] op_sel_hi:[1,0,0]
    v_pk_fma_f32 v[138:139], v[58:59], v[32:33], v[34:35] op_sel_hi:[1,0,0]
    v_pk_fma_f32 v[140:141], v[60:61], v[32:33], v[34:35] op_sel_hi:[1,0,0]
    v_pk_fma_f32 v[142:143], v[62:63], v[32:33], v[34:35] op_sel_hi:[1,0,0]
    v_pk_fma_f32 v[144:145], v[64:65], v[36:37], v[38:39] op_sel_hi:[1,0,0]
    v_pk_fma_f32 v[146:147], v[66:67], v[36:37], v[38:39] op_sel_hi:[1,0,0]
    v_pk_fma_f32 v[148:149], v[68:69], v[36:37], v[38:39] op_sel_hi:[1,0,0]
    v_pk_fma_f32 v[150:151], v[70:71], v[36:37], v[38:39] op_sel_hi:[1,0,0]
    v_exp_f32 v216, v120
    v_exp_f32 v217, v121
    v_exp_f32 v218, v122
    v_exp_f32 v219, v123
    v_exp_f32 v220, v124
    v_exp_f32 v221, v125
    v_exp_f32 v222, v126
    v_exp_f32 v223, v127
    v_exp_f32 v224, v128
    v_exp_f32 v225, v129
    v_exp_f32 v226, v130
    v_exp_f32 v227, v131
    v_exp_f32 v228, v132
    v_exp_f32 v229, v133
    v_exp_f32 v230, v134
    v_exp_f32 v231, v135
    v_exp_f32 v232, v136
    v_exp_f32 v233, v137
    v_exp_f32 v234, v138
    v_exp_f32 v235, v139
    v_exp_f32 v236, v140
    v_exp_f32 v237, v141
    v_exp_f32 v238, v142
    v_exp_f32 v239, v143
    v_exp_f32 v240, v144
    v_exp_f32 v241, v145
    v_exp_f32 v242, v146
    v_exp_f32 v243, v147
    v_exp_f32 v244, v148
    v_exp_f32 v245, v149
    v_exp_f32 v246, v150
    v_exp_f32 v247, v151
    v_pk_add_f32 v[216:217], v[216:217], 1.0 op_sel_hi:[1,0]
    v_pk_add_f32 v[218:219], v[218:219], 1.0 op_sel_hi:[1,0]
    v_pk_add_f32 v[220:221], v[220:221], 1.0 op_sel_hi:[1,0]
    v_pk_add_f32 v[222:223], v[222:223], 1.0 op_sel_hi:[1,0]
    v_pk_add_f32 v[224:225], v[224:225], 1.0 op_sel_hi:[1,0]
    v_pk_add_f32 v[226:227], v[226:227], 1.0 op_sel_hi:[1,0]
    v_pk_add_f32 v[228:229], v[228:229], 1.0 op_sel_hi:[1,0]
    v_pk_add_f32 v[230:231], v[230:231], 1.0 op_sel_hi:[1,0]
    v_pk_add_f32 v[232:233], v[232:233], 1.0 op_sel_hi:[1,0]
    v_pk_add_f32 v[234:235], v[234:235], 1.0 op_sel_hi:[1,0]
    v_pk_add_f32 v[236:237], v[236:237], 1.0 op_sel_hi:[1,0]
    v_pk_add_f32 v[238:239], v[238:239], 1.0 op_sel_hi:[1,0]
    v_pk_add_f32 v[240:241], v[240:241], 1.0 op_sel_hi:[1,0]
    v_pk_add_f32 v[242:243], v[242:243], 1.0 op_sel_hi:[1,0]
    v_pk_add_f32 v[244:245], v[244:245], 1.0 op_sel_hi:[1,0]
    v_pk_add_f32 v[246:247], v[246:247], 1.0 op_sel_hi:[1,0]
    v_rcp_f32 v216, v216
    v_rcp_f32 v217, v217
    v_rcp_f32 v218, v218
    v_rcp_f32 v219, v219
    v_rcp_f32 v220, v220
    v_rcp_f32 v221, v221
    v_rcp_f32 v222, v222
    v_rcp_f32 v223, v223
    v_rcp_f32 v224, v224
    v_rcp_f32 v225, v225
    v_rcp_f32 v226, v226
    v_rcp_f32 v227, v227
    v_rcp_f32 v228, v228
    v_rcp_f32 v229, v229
    v_rcp_f32 v230, v230
    v_rcp_f32 v231, v231
    v_rcp_f32 v232, v232
    v_rcp_f32 v233, v233
    v_rcp_f32 v234, v234
    v_rcp_f32 v235, v235
    v_rcp_f32 v236, v236
    v_rcp_f32 v237, v237
    v_rcp_f32 v238, v238
    v_rcp_f32 v239, v239
    v_rcp_f32 v240, v240
    v_rcp_f32 v241, v241
    v_rcp_f32 v242, v242
    v_rcp_f32 v243, v243
    v_rcp_f32 v244, v244
    v_rcp_f32 v245, v245
    v_rcp_f32 v246, v246
    v_rcp_f32 v247, v247
    v_pk_mul_f32 v[120:121], v[120:121], v[216:217]
    v_pk_mul_f32 v[122:123], v[122:123], v[218:219]
    v_pk_mul_f32 v[124:125], v[124:125], v[220:221]
    v_pk_mul_f32 v[126:127], v[126:127], v[222:223]
    v_pk_mul_f32 v[128:129], v[128:129], v[224:225]
    v_pk_mul_f32 v[130:131], v[130:131], v[226:227]
    v_pk_mul_f32 v[132:133], v[132:133], v[228:229]
    v_pk_mul_f32 v[134:135], v[134:135], v[230:231]
    v_pk_mul_f32 v[136:137], v[136:137], v[232:233]
    v_pk_mul_f32 v[138:139], v[138:139], v[234:235]
    v_pk_mul_f32 v[140:141], v[140:141], v[236:237]
    v_pk_mul_f32 v[142:143], v[142:143], v[238:239]
    v_pk_mul_f32 v[144:145], v[144:145], v[240:241]
    v_pk_mul_f32 v[146:147], v[146:147], v[242:243]
    v_pk_mul_f32 v[148:149], v[148:149], v[244:245]
    v_pk_mul_f32 v[150:151], v[150:151], v[246:247]
L_z_wait:
    s_setprio 1
    s_waitcnt vmcnt(4)
    v_xor_b32 v160, v210, v72
    v_xor_b32 v161, v210, v73
    v_xor_b32 v162, v210, v74
    v_xor_b32 v163, v210, v75
    ds_write_b128 v250, v[160:163] offset:0
    v_or3_b32 v1, v160, v161, v162
    v_or_b32 v1, v1, v163
    s_waitcnt vmcnt(3)
    v_xor_b32 v164, v210, v76
    v_xor_b32 v165, v210, v77
    v_xor_b32 v166, v210, v78
    v_xor_b32 v167, v210, v79
    ds_write_b128 v250, v[164:167] offset:1024
    v_or3_b32 v1, v1, v164, v165
    v_or3_b32 v1, v1, v166, v167
    s_waitcnt vmcnt(2)
    v_xor_b32 v168, v210, v80
    v_xor_b32 v169, v210, v81
    v_xor_b32 v170, v210, v82
    v_xor_b32 v171, v210, v83
    ds_write_b128 v250, v[168:171] offset:2048
    v_or3_b32 v1, v1, v168, v169
    v_or3_b32 v1, v1, v170, v171
    s_waitcnt vmcnt(1)
    v_xor_b32 v172, v210, v84
    v_xor_b32 v173, v210, v85
    v_xor_b32 v174, v210, v86
    v_xor_b32 v175, v210, v87
    ds_write_b128 v250, v[172:175] offset:3072
    v_or3_b32 v1, v1, v172, v173
    v_or3_b32 v1, v1, v174, v175
    s_waitcnt vmcnt(0)
    v_xor_b32 v176, v210, v212
    v_xor_b32 v177, v210, v213
    v_xor_b32 v178, v210, v214
    v_xor_b32 v179, v210, v215
    s_mov_b32 exec_hi, 0x1ff
    ds_write_b128 v201, v[176:179]
    s_mov_b32 exec_hi, -1
    v_or3_b32 v1, v1, v176, v177
    v_or3_b32 v1, v1, v178, v179
    v_and_b32 v1, 0x30003, v1
    v_cmp_ne_u32 vcc, 0, v1
    s_nop 0
    s_cbranch_vccz L_z_got
    s_cmp_eq_u32 s35, 0
    s_cbranch_scc1 L_z_got
    s_sub_u32 s35, s35, 1
    s_sleep 2
    s_mov_b64 exec, vcc
    buffer_load_dwordx4 v[72:75], v3, s[12:15], s50 offen offset:0 sc1
    buffer_load_dwordx4 v[76:79], v3, s[12:15], s50 offen offset:1024 sc1
    buffer_load_dwordx4 v[80:83], v3, s[12:15], s50 offen offset:2048 sc1
    buffer_load_dwordx4 v[84:87], v3, s[12:15], s50 offen offset:3072 sc1
    s_and_b32 exec_hi, exec_hi, 0x1ff
    s_or_b32 exec_lo, exec_lo, 1
    buffer_load_dwordx4 v[212:215], v200, s[12:15], s51 offen sc1
    s_mov_b64 exec, -1
    s_waitcnt lgkmcnt(0)
    s_branch L_z_wait
L_z_got:
    s_mov_b64 exec, 1
    ds_add_u32 v0, v255 offset:42832
    s_mov_b64 exec, -1
L_sync8:
    ds_read_b32 v1, v0 offset:42832
    ds_read_b64_tr_b16 v[152:153], v251 offset:0
    ds_read_b64_tr_b16 v[154:155], v251 offset:1024
    ds_read_b64_tr_b16 v[156:157], v252 offset:0
    ds_read_b64_tr_b16 v[158:159], v252 offset:1024
    s_waitcnt lgkmcnt(4)
    v_readfirstlane_b32 s31, v1
    s_nop 0
    s_cmp_ge_u32 s31, 4
    s_cbranch_scc0 L_sync8
    ds_read_b64_tr_b16 v[160:161], v251 offset:4096
    ds_read_b64_tr_b16 v[162:163], v251 offset:5120
    ds_read_b64_tr_b16 v[164:165], v252 offset:4096
    ds_read_b64_tr_b16 v[166:167], v252 offset:5120
    ds_read_b64_tr_b16 v[168:169], v251 offset:8192
    ds_read_b64_tr_b16 v[170:171], v251 offset:9216
    ds_read_b64_tr_b16 v[172:173], v252 offset:8192
    ds_read_b64_tr_b16 v[174:175], v252 offset:9216
    s_waitcnt lgkmcnt(8)
    v_mfma_f32_16x16x32_f16 v[216:219], v[152:155], v[88:91], 0
    v_mfma_f32_16x16x32_f16 v[220:223], v[156:159], v[88:91], 0
    ds_read_b64_tr_b16 v[176:177], v251 offset:12288
    ds_read_b64_tr_b16 v[178:179], v251 offset:13312
    ds_read_b64_tr_b16 v[180:181], v252 offset:12288
    ds_read_b64_tr_b16 v[182:183], v252 offset:13312
    s_waitcnt lgkmcnt(8)
    v_mfma_f32_16x16x32_f16 v[216:219], v[160:163], v[92:95], v[216:219]
    v_mfma_f32_16x16x32_f16 v[220:223], v[164:167], v[92:95], v[220:223]
    ds_read_b64_tr_b16 v[152:153], v206 offset:0
    ds_read_b64_tr_b16 v[154:155], v253 offset:1024
    ds_read_b64_tr_b16 v[156:157], v207 offset:0
    ds_read_b64_tr_b16 v[158:159], v254 offset:1024
    s_waitcnt lgkmcnt(8)
    v_mfma_f32_16x16x32_f16 v[216:219], v[168:171], v[96:99], v[216:219]
    v_mfma_f32_16x16x32_f16 v[220:223], v[172:175], v[96:99], v[220:223]
    ds_read_b64_tr_b16 v[160:161], v253 offset:4096
    ds_read_b64_tr_b16 v[162:163], v253 offset:5120
    ds_read_b64_tr_b16 v[164:165], v254 offset:4096
    ds_read_b64_tr_b16 v[166:167], v254 offset:5120
    s_waitcnt lgkmcnt(8)
    v_mfma_f32_16x16x32_f16 v[216:219], v[176:179], v[100:103], v[216:219]
    v_mfma_f32_16x16x32_f16 v[220:223], v[180:183], v[100:103], v[220:223]
    ds_read_b64_tr_b16 v[168:169], v253 offset:8192
    ds_read_b64_tr_b16 v[170:171], v253 offset:9216
    ds_read_b64_tr_b16 v[172:173], v254 offset:8192
    ds_read_b64_tr_b16 v[174:175], v254 offset:9216
    s_waitcnt lgkmcnt(8)
    v_mfma_f32_16x16x32_f16 v[224:227], v[152:155], v[104:107], 0
    v_mfma_f32_16x16x32_f16 v[228:231], v[156:159], v[104:107], 0
    ds_read_b64_tr_b16 v[176:177], v253 offset:12288
    ds_read_b64_tr_b16 v[178:179], v253 offset:13312
    ds_read_b64_tr_b16 v[180:181], v254 offset:12288
    ds_read_b64_tr_b16 v[182:183], v254 offset:13312
    s_waitcnt lgkmcnt(8)
    v_mfma_f32_16x16x32_f16 v[224:227], v[160:163], v[108:111], v[224:227]
    v_mfma_f32_16x16x32_f16 v[228:231], v[164:167], v[108:111], v[228:231]
    ds_read_b64_tr_b16 v[72:73], v202 offset:0
    ds_read_b64_tr_b16 v[74:75], v202 offset:1024
    ds_read_b64_tr_b16 v[76:77], v202 offset:4096
    ds_read_b64_tr_b16 v[78:79], v202 offset:5120
    s_waitcnt lgkmcnt(8)
    v_mfma_f32_16x16x32_f16 v[224:227], v[168:171], v[112:115], v[224:227]
    v_mfma_f32_16x16x32_f16 v[228:231], v[172:175], v[112:115], v[228:231]
    ds_read_b64_tr_b16 v[80:81], v202 offset:8192
    ds_read_b64_tr_b16 v[82:83], v202 offset:9216
    ds_read_b64_tr_b16 v[84:85], v202 offset:12288
    ds_read_b64_tr_b16 v[86:87], v202 offset:13312
    s_waitcnt lgkmcnt(8)
    v_mfma_f32_16x16x32_f16 v[224:227], v[176:179], v[116:119], v[224:227]
    v_mfma_f32_16x16x32_f16 v[228:231], v[180:183], v[116:119], v[228:231]
    ds_read_b64_tr_b16 v[240:241], v204 offset:0
    ds_read_b64_tr_b16 v[242:243], v203 offset:1024
    ds_read_b64_tr_b16 v[244:245], v203 offset:4096
    ds_read_b64_tr_b16 v[246:247], v203 offset:5120
    s_waitcnt lgkmcnt(8)
    ds_read_b64_tr_b16 v[184:185], v203 offset:8192
    ds_read_b64_tr_b16 v[186:187], v203 offset:9216
    ds_read_b64_tr_b16 v[188:189], v203 offset:12288
    ds_read_b64_tr_b16 v[190:191], v203 offset:13312
    v_mfma_f32_16x16x32_f16 v[232:235], v[72:75], v[88:91], 0
    v_mfma_f32_16x16x32_f16 v[232:235], v[76:79], v[92:95], v[232:235]
    s_waitcnt lgkmcnt(4)
    s_nop 0
    v_mfma_f32_16x16x32_f16 v[232:235], v[80:83], v[96:99], v[232:235]
    v_mfma_f32_16x16x32_f16 v[232:235], v[84:87], v[100:103], v[232:235]
    v_pk_add_f32 v[152:153], v[216:217], v[224:225]
    v_pk_add_f32 v[154:155], v[218:219], v[226:227]
    v_pk_add_f32 v[156:157], v[220:221], v[228:229]
    v_pk_add_f32 v[158:159], v[222:223], v[230:231]
    v_mfma_f32_16x16x32_f16 v[236:239], v[240:243], v[104:107], 0
    v_mfma_f32_16x16x32_f16 v[236:239], v[244:247], v[108:111], v[236:239]
    v_pk_fma_f32 v[40:41], v[152:153], v[120:121], v[40:41]
    v_pk_fma_f32 v[42:43], v[154:155], v[122:123], v[42:43]
    v_pk_fma_f32 v[44:45], v[156:157], v[124:125], v[44:45]
    v_pk_fma_f32 v[46:47], v[158:159], v[126:127], v[46:47]
    s_waitcnt lgkmcnt(0)
    s_nop 0
    v_mfma_f32_16x16x32_f16 v[236:239], v[184:187], v[112:115], v[236:239]
    v_mfma_f32_16x16x32_f16 v[236:239], v[188:191], v[116:119], v[236:239]
    v_cvt_pk_bf16_f32 v8, v40, v41
    v_cvt_pk_bf16_f32 v9, v42, v43
    v_cvt_pk_bf16_f32 v10, v44, v45
    v_cvt_pk_bf16_f32 v11, v46, v47
    ds_write_b128 v208, v[8:11] offset:0
    ds_read_b128 v[24:27], v199 offset:0
    v_pk_add_f32 v[160:161], v[216:217], v[224:225] neg_lo:[0,1] neg_hi:[0,1]
    v_pk_add_f32 v[162:163], v[218:219], v[226:227] neg_lo:[0,1] neg_hi:[0,1]
    v_pk_add_f32 v[164:165], v[220:221], v[228:229] neg_lo:[0,1] neg_hi:[0,1]
    v_pk_add_f32 v[166:167], v[222:223], v[230:231] neg_lo:[0,1] neg_hi:[0,1]
    s_cmp_eq_u64 s[62:63], 0
    s_cbranch_scc1 L_nodump0
    s_mov_b64 exec, s[54:55]
    ds_write_b128 v6, v[152:155] offset:42496
    ds_write_b128 v6, v[156:159] offset:42512
    s_mov_b64 exec, s[58:59]
    ds_write_b128 v6, v[160:163] offset:42496
    ds_write_b128 v6, v[164:167] offset:42512
    s_mov_b64 exec, 1
    ds_add_u32 v0, v255 offset:42836
    s_mov_b64 exec, -1
    s_waitcnt lgkmcnt(0)
L_nodump0:
    s_nop 0
    v_pk_fma_f32 v[56:57], v[160:161], v[136:137], v[56:57]
    v_pk_fma_f32 v[58:59], v[162:163], v[138:139], v[58:59]
    v_pk_fma_f32 v[60:61], v[164:165], v[140:141], v[60:61]
    v_pk_fma_f32 v[62:63], v[166:167], v[142:143], v[62:63]
    v_cvt_pk_bf16_f32 v16, v56, v57
    v_cvt_pk_bf16_f32 v17, v58, v59
    v_cvt_pk_bf16_f32 v18, v60, v61
    v_cvt_pk_bf16_f32 v19, v62, v63
    ds_write_b128 v208, v[16:19] offset:2048
    ds_read_b128 v[32:35], v199 offset:2048
    s_waitcnt lgkmcnt(2)
    buffer_store_dwordx4 v[24:27], v4, s[16:19], 0 offen sc1
    v_add_f32 v152, v232, v236
    v_sub_f32 v160, v232, v236
    s_cmp_eq_u64 s[64:65], 0
    s_cbranch_scc1 L_nodump1
    s_mov_b64 exec, s[56:57]
    ds_write_b128 v6, v[152:155] offset:42624
    ds_write_b128 v6, v[156:159] offset:42640
    s_mov_b64 exec, s[60:61]
    ds_write_b128 v6, v[160:163] offset:42624
    ds_write_b128 v6, v[164:167] offset:42640
    s_mov_b64 exec, 1
    ds_add_u32 v0, v255 offset:42864
    s_mov_b64 exec, -1
    s_waitcnt lgkmcnt(0)
L_nodump1:
    v_pk_fma_f32 v[48:49], v[152:153], v[128:129], v[48:49]
    v_pk_fma_f32 v[50:51], v[154:155], v[130:131], v[50:51]
    v_pk_fma_f32 v[52:53], v[156:157], v[132:133], v[52:53]
    v_pk_fma_f32 v[54:55], v[158:159], v[134:135], v[54:55]
    v_cvt_pk_bf16_f32 v12, v48, v55
    v_cvt_pk_bf16_f32 v13, v54, v53
    v_cvt_pk_bf16_f32 v14, v52, v51
    v_cvt_pk_bf16_f32 v15, v50, v49
    ds_write_b128 v208, v[12:15] offset:1024
    ds_read_b128 v[28:31], v199 offset:1024
    s_waitcnt lgkmcnt(2)
    s_nop 0
    buffer_store_dwordx4 v[32:35], v249, s[16:19], 0 offen sc1
    v_pk_fma_f32 v[64:65], v[160:161], v[144:145], v[64:65]
    v_pk_fma_f32 v[66:67], v[162:163], v[146:147], v[66:67]
    v_pk_fma_f32 v[68:69], v[164:165], v[148:149], v[68:69]
    v_pk_fma_f32 v[70:71], v[166:167], v[150:151], v[70:71]
    v_cvt_pk_bf16_f32 v20, v64, v71
    v_cvt_pk_bf16_f32 v21, v70, v69
    v_cvt_pk_bf16_f32 v22, v68, v67
    v_cvt_pk_bf16_f32 v23, v66, v65
    ds_write_b128 v208, v[20:23] offset:3072
    ds_read_b128 v[36:39], v199 offset:3072
    s_waitcnt lgkmcnt(2)
    buffer_store_dwordx4 v[28:31], v5, s[16:19], 0 offen sc1
    s_waitcnt lgkmcnt(0)
    buffer_store_dwordx4 v[36:39], v205, s[16:19], 0 offen sc1
    s_branch L_fin
L_dma_done:
    s_setprio 3
    s_lshr_b32 s31, s47, 2
    s_andn2_b32 s31, s31, s75
    s_add_u32 s50, s31, s46
    s_lshl_b32 s31, s50, 17
    s_bfe_u32 s32, s2, 0x20003
    s_lshl_b32 s32, s32, 2
    s_add_u32 s51, s32, s30
    s_lshl_b32 s32, s51, 7
    s_add_u32 s31, s31, s32
    v_lshrrev_b32 v6, 3, v2
    v_lshlrev_b32 v6, 14, v6
    v_and_b32 v7, 0x70, v3
    v_add3_u32 v6, v6, v7, s31
    s_mov_b32 s60, 4096
    s_mov_b32 s61, 8192
    s_mov_b32 s62, 12288
    v_bfe_u32 v8, v2, 2, 3
    v_lshlrev_b32 v9, 5, v8
    s_lshl_b32 s31, s30, 6
    v_xor_b32 v9, s31, v9
    v_bfe_u32 v8, v2, 2, 2
    v_lshl_add_u32 v9, v8, 8, v9
    v_lshrrev_b32 v8, 4, v2
    v_lshl_add_u32 v9, v8, 11, v9
    v_and_b32 v10, 3, v2
    v_lshl_add_u32 v9, v10, 3, v9
    v_add_u32 v9, 76800, v9
    v_xor_b32 v10, 32, v9
    v_lshlrev_b32 v8, 4, v8
    s_lshr_b32 s31, s30, 1
    s_and_b32 s32, s31, s75
    s_lshl_b32 s32, s32, 8
    v_add_u32 v8, s32, v8
    s_cmp_eq_u32 s75, 0
    s_cselect_b32 s32, 12, 9
    s_lshl_b32 s31, s31, s32
    s_lshl_b32 s32, s46, 3
    s_add_u32 s32, s32, s47
    s_lshl_b32 s32, s32, 9
    s_add_u32 s31, s31, s32
    s_and_b32 s32, s30, 1
    s_lshl_b32 s32, s32, 8
    s_add_u32 s31, s31, s32
    s_add_u32 s31, s31, 262144
    v_lshl_add_u32 v13, v2, 3, s31
    s_waitcnt lgkmcnt(0)
    s_add_u32 s28, s28, 0x7f4a7c15
    s_addc_u32 s29, s29, 0x9e3779b9
    s_and_b32 s31, s28, 0xff
    v_mov_b32 v14, s31
    s_mov_b32 s49, 0xffffff00
    s_cmp_lg_u32 s30, 2
    s_cbranch_scc1 L_no_tlb
    s_mov_b32 s52, s44
    s_mov_b32 s53, s45
    s_mov_b32 s54, 0x400000
    s_mov_b32 s55, 0x00020000
    v_lshlrev_b32 v250, 20, v2
    s_mov_b64 exec, 0xff
    buffer_load_dword v251, v250, s[12:15], 0 offen
    buffer_load_dword v252, v250, s[52:55], 0 offen
    buffer_load_dword v253, v250, s[24:27], 0 offen
    s_mov_b64 exec, -1
L_no_tlb:
    s_cmp_lg_u32 s66, 0
    s_cbranch_scc1 L_tagged
    s_mov_b64 exec, 1
    ds_add_u32 v0, v255 offset:42872
    s_mov_b64 exec, -1
L_tagged:
    s_cmp_eq_u32 s30, 3
    s_cbranch_scc1 L_h1
    s_cmp_eq_u32 s66, 0
    s_cbranch_scc1 L_key
    s_cmp_lg_u32 s30, 0
    s_cbranch_scc1 L_follower
    s_waitcnt vmcnt(16)
    s_mov_b64 exec, 1
    ds_add_u32 v0, v255 offset:42868
    s_mov_b64 exec, -1
    ds_read_b64_tr_b16 v[36:37], v9 offset:0
    ds_read_b64_tr_b16 v[38:39], v9 offset:1024
    ds_read_b64_tr_b16 v[40:41], v10 offset:0
    ds_read_b64_tr_b16 v[42:43], v10 offset:1024
    ds_read_b64_tr_b16 v[44:45], v9 offset:32768
    ds_read_b64_tr_b16 v[46:47], v9 offset:33792
    ds_read_b64_tr_b16 v[48:49], v10 offset:32768
    ds_read_b64_tr_b16 v[50:51], v10 offset:33792
    ds_read_b64_tr_b16 v[52:53], v9 offset:8192
    ds_read_b64_tr_b16 v[54:55], v9 offset:9216
    ds_read_b64_tr_b16 v[56:57], v10 offset:8192
    ds_read_b64_tr_b16 v[58:59], v10 offset:9216
    ds_read_b64_tr_b16 v[60:61], v9 offset:40960
    ds_read_b64_tr_b16 v[62:63], v9 offset:41984
    s_waitcnt lgkmcnt(12)
    ds_read_b64_tr_b16 v[64:65], v10 offset:40960
    ds_read_b64_tr_b16 v[66:67], v10 offset:41984
    s_waitcnt lgkmcnt(12)
    ds_read_b64_tr_b16 v[68:69], v9 offset:16384
    ds_read_b64_tr_b16 v[70:71], v9 offset:17408
    s_waitcnt lgkmcnt(12)
    ds_read_b64_tr_b16 v[72:73], v10 offset:16384
    ds_read_b64_tr_b16 v[74:75], v10 offset:17408
    s_waitcnt lgkmcnt(12)
    ds_read_b64_tr_b16 v[76:77], v9 offset:49152
    ds_read_b64_tr_b16 v[78:79], v9 offset:50176
    s_waitcnt lgkmcnt(12)
    ds_read_b64_tr_b16 v[80:81], v10 offset:49152
    ds_read_b64_tr_b16 v[82:83], v10 offset:50176
    s_waitcnt vmcnt(8)
    s_mov_b64 exec, 1
    ds_add_u32 v0, v255 offset:42868
    s_mov_b64 exec, -1
    s_branch L_d_first
L_follower:
    s_and_b32 s32, s30, 1
    s_lshl_b32 s32, s32, 8
    v_subrev_u32 v250, s32, v13
    buffer_load_dword v251, v250, s[12:15], 0 offen
    s_lshl_b32 s31, s50, 12
    s_sub_u32 s31, s31, s32
    s_lshl_b32 s32, s51, 8
    s_add_u32 s31, s31, s32
    s_add_u32 s31, s31, 524288
    v_lshl_add_u32 v250, v2, 3, s31
    buffer_load_dword v252, v250, s[12:15], 0 offen
L_sync9:
    ds_read_b32 v1, v0 offset:42868
    s_waitcnt lgkmcnt(0)
    v_readfirstlane_b32 s31, v1
    s_nop 0
    s_cmp_ge_u32 s31, 1
    s_cbranch_scc0 L_sync9
    s_nop 0
    ds_read_b64_tr_b16 v[36:37], v9 offset:0
    ds_read_b64_tr_b16 v[38:39], v9 offset:1024
    ds_read_b64_tr_b16 v[40:41], v10 offset:0
    ds_read_b64_tr_b16 v[42:43], v10 offset:1024
    ds_read_b64_tr_b16 v[44:45], v9 offset:32768
    ds_read_b64_tr_b16 v[46:47], v9 offset:33792
    ds_read_b64_tr_b16 v[48:49], v10 offset:32768
    ds_read_b64_tr_b16 v[50:51], v10 offset:33792
    ds_read_b64_tr_b16 v[52:53], v9 offset:8192
    ds_read_b64_tr_b16 v[54:55], v9 offset:9216
    ds_read_b64_tr_b16 v[56:57], v10 offset:8192
    ds_read_b64_tr_b16 v[58:59], v10 offset:9216
    ds_read_b64_tr_b16 v[60:61], v9 offset:40960
    ds_read_b64_tr_b16 v[62:63], v9 offset:41984
    s_waitcnt lgkmcnt(12)
    ds_read_b64_tr_b16 v[64:65], v10 offset:40960
    ds_read_b64_tr_b16 v[66:67], v10 offset:41984
    s_waitcnt lgkmcnt(12)
    ds_read_b64_tr_b16 v[68:69], v9 offset:16384
    ds_read_b64_tr_b16 v[70:71], v9 offset:17408
    s_waitcnt lgkmcnt(12)
    ds_read_b64_tr_b16 v[72:73], v10 offset:16384
    ds_read_b64_tr_b16 v[74:75], v10 offset:17408
    s_waitcnt lgkmcnt(12)
    ds_read_b64_tr_b16 v[76:77], v9 offset:49152
    ds_read_b64_tr_b16 v[78:79], v9 offset:50176
    s_waitcnt lgkmcnt(12)
    ds_read_b64_tr_b16 v[80:81], v10 offset:49152
    ds_read_b64_tr_b16 v[82:83], v10 offset:50176
    s_add_u32 s67, s30, 0
L_sync10:
    ds_read_b32 v1, v0 offset:42868
    s_waitcnt lgkmcnt(0)
    v_readfirstlane_b32 s31, v1
    s_nop 0
    s_cmp_ge_u32 s31, s67
    s_cbranch_scc0 L_sync10
L_d_first:
L_sync11:
    ds_read_b32 v1, v0 offset:42840
    s_waitcnt lgkmcnt(0)
    v_readfirstlane_b32 s31, v1
    s_nop 0
    s_cmp_ge_u32 s31, 1
    s_cbranch_scc0 L_sync11
    buffer_load_dwordx4 v[100:103], v6, s[24:27], 0 offen offset:0 nt
    buffer_load_dwordx4 v[104:107], v6, s[24:27], 0 offen offset:2048 nt
    buffer_load_dwordx4 v[108:111], v6, s[24:27], s60 offen offset:0 nt
    buffer_load_dwordx4 v[112:115], v6, s[24:27], s60 offen offset:2048 nt
    buffer_load_dwordx4 v[116:119], v6, s[24:27], s61 offen offset:0 nt
L_key:
    s_waitcnt lgkmcnt(0)
L_sync12:
    ds_read_b32 v1, v0 offset:42844
    ds_read_b64 v[18:19], v0 offset:41552
    ds_read_b128 v[20:23], v8 offset:41600
    ds_read_b128 v[24:27], v8 offset:41664
    ds_read_b128 v[28:31], v8 offset:41728
    ds_read_b128 v[32:35], v8 offset:41792
    s_waitcnt lgkmcnt(5)
    v_readfirstlane_b32 s31, v1
    s_nop 0
    s_cmp_ge_u32 s31, 1
    s_cbranch_scc0 L_sync12
    s_cmp_eq_u32 s66, 0
    s_cbranch_scc1 L_idle
    s_branch L_xs_ok
L_h1:
    s_mov_b32 s63, 4096
    s_lshl_b32 s31, s47, 8
    v_lshlrev_b32 v15, 3, v2
    v_add_u32 v16, s31, v15
    s_cmp_lg_u32 s66, 0
    s_cbranch_scc1 L_gate
L_sync13:
    ds_read_b32 v1, v0 offset:42828
    s_waitcnt lgkmcnt(0)
    v_readfirstlane_b32 s31, v1
    s_nop 0
    s_cmp_ge_u32 s31, 4
    s_cbranch_scc0 L_sync13
    s_branch L_gate_open
L_gate:
L_sync14:
    ds_read_b32 v1, v0 offset:42824
    s_waitcnt lgkmcnt(0)
    v_readfirstlane_b32 s31, v1
    s_nop 0
    s_cmp_ge_u32 s31, 4
    s_cbranch_scc0 L_sync14
L_gate_open:
    buffer_load_dwordx4 v[20:23], v3, s[12:15], s63 offen offset:0 sc1
    buffer_load_dwordx4 v[24:27], v3, s[12:15], s63 offen offset:1024 sc1
    buffer_load_dwordx4 v[28:31], v3, s[12:15], s63 offen offset:2048 sc1
    buffer_load_dwordx4 v[32:35], v3, s[12:15], s63 offen offset:3072 sc1
    s_mov_b64 exec, 1
    ds_add_u32 v0, v255 offset:42860
    s_mov_b64 exec, -1
    s_waitcnt vmcnt(0)
L_mi_check:
    v_cmp_ne_u64 s[52:53], s[28:29], v[22:23]
    v_cmp_ne_u64 s[54:55], s[28:29], v[26:27]
    v_cmp_ne_u64 s[56:57], s[28:29], v[30:31]
    v_cmp_ne_u64 s[58:59], s[28:29], v[34:35]
    v_max_u32 v18, v21, v25
    v_max3_u32 v18, v18, v29, v33
    s_or_b64 s[64:65], s[52:53], s[54:55]
    s_or_b64 vcc, s[56:57], s[58:59]
    s_or_b64 s[64:65], s[64:65], vcc
    s_cbranch_scc0 L_mi_got
    s_cmp_eq_u32 s35, 0
    s_cbranch_scc1 L_mi_got
    s_sub_u32 s35, s35, 1
    s_sleep 2
    s_mov_b64 exec, s[52:53]
    s_cbranch_execz L_mi_skip0
    buffer_load_dwordx4 v[20:23], v3, s[12:15], s63 offen offset:0 sc1
L_mi_skip0:
    s_mov_b64 exec, s[54:55]
    s_cbranch_execz L_mi_skip1
    buffer_load_dwordx4 v[24:27], v3, s[12:15], s63 offen offset:1024 sc1
L_mi_skip1:
    s_mov_b64 exec, s[56:57]
    s_cbranch_execz L_mi_skip2
    buffer_load_dwordx4 v[28:31], v3, s[12:15], s63 offen offset:2048 sc1
L_mi_skip2:
    s_mov_b64 exec, s[58:59]
    s_cbranch_execz L_mi_skip3
    buffer_load_dwordx4 v[32:35], v3, s[12:15], s63 offen offset:3072 sc1
L_mi_skip3:
    s_mov_b64 exec, -1
    s_waitcnt vmcnt(0)
    s_branch L_mi_check
L_mi_got:
    v_max_u32_dpp v19, v18, v18 row_ror:1 row_mask:0xf bank_mask:0xf
    s_nop 1
    v_max_u32_dpp v19, v19, v19 row_ror:2 row_mask:0xf bank_mask:0xf
    s_nop 1
    v_max_u32_dpp v19, v19, v19 row_ror:4 row_mask:0xf bank_mask:0xf
    s_nop 1
    v_max_u32_dpp v19, v19, v19 row_ror:8 row_mask:0xf bank_mask:0xf
    s_nop 0
    v_readlane_b32 s33, v19, 0
    v_readlane_b32 s31, v19, 16
    v_readlane_b32 s32, v19, 32
    v_readlane_b32 s34, v19, 48
    s_max_u32 s33, s33, s31
    s_max_u32 s32, s32, s34
    s_max_u32 s33, s33, s32
    s_andn2_b32 s31, 0x7ff, s33
    s_lshl_b32 s48, s31, 11
    buffer_load_dwordx2 v[150:151], v16, s[8:11], s48 offen
    s_mov_b64 exec, 1
    ds_add_u32 v0, v255 offset:42840
    s_mov_b64 exec, -1
    v_cmp_eq_u32 s[52:53], s33, v25
    v_cmp_eq_u32 s[54:55], s33, v29
    v_cmp_eq_u32 s[56:57], s33, v33
    v_cmp_eq_u32 vcc, s33, v18
    v_cndmask_b32 v19, v20, v24, s[52:53]
    v_cndmask_b32 v19, v19, v28, s[54:55]
    v_cndmask_b32 v19, v19, v32, s[56:57]
    s_ff1_i32_b64 s32, vcc
    v_readlane_b32 s34, v19, s32
    v_mov_b32 v19, s33
    s_nop 0
    v_mov_b32 v18, s34
    ds_write_b64 v0, v[18:19] offset:41552
    s_lshl_b32 s52, s34, 16
    s_and_b32 s32, s34, 0xffff0000
    v_rcp_f32 v148, s32
    s_waitcnt vmcnt(0)
    v_lshlrev_b32 v20, 16, v150
    v_and_b32 v21, 0xffff0000, v150
    v_lshlrev_b32 v22, 16, v151
    v_and_b32 v23, 0xffff0000, v151
    v_pk_add_f32 v[20:21], v[20:21], s[52:53] op_sel_hi:[1,0] neg_lo:[0,1] neg_hi:[0,1]
    v_pk_add_f32 v[22:23], v[22:23], s[52:53] op_sel_hi:[1,0] neg_lo:[0,1] neg_hi:[0,1]
    v_cvt_pk_bf16_f32 v150, v20, v21
    v_cvt_pk_bf16_f32 v151, v22, v23
    v_lshlrev_b32 v20, 16, v150
    v_and_b32 v21, 0xffff0000, v150
    v_lshlrev_b32 v22, 16, v151
    v_and_b32 v23, 0xffff0000, v151
    v_pk_mul_f32 v[20:21], v[20:21], v[148:149] op_sel_hi:[1,0]
    v_pk_mul_f32 v[22:23], v[22:23], v[148:149] op_sel_hi:[1,0]
    v_cvt_pk_bf16_f32 v150, v20, v21
    v_cvt_pk_bf16_f32 v151, v22, v23
    ds_write_b64 v15, v[150:151] offset:41600
    s_mov_b64 exec, 1
    ds_add_u32 v0, v255 offset:42844
    s_mov_b64 exec, -1
    s_cmp_eq_u32 s66, 0
    s_cbranch_scc1 L_idle
L_sync15:
    ds_read_b32 v1, v0 offset:42868
    s_waitcnt lgkmcnt(0)
    v_readfirstlane_b32 s31, v1
    s_nop 0
    s_cmp_ge_u32 s31, 1
    s_cbranch_scc0 L_sync15
    s_nop 0
    ds_read_b64_tr_b16 v[36:37], v9 offset:0
    ds_read_b64_tr_b16 v[38:39], v9 offset:1024
    ds_read_b64_tr_b16 v[40:41], v10 offset:0
    ds_read_b64_tr_b16 v[42:43], v10 offset:1024
    ds_read_b64_tr_b16 v[44:45], v9 offset:32768
    ds_read_b64_tr_b16 v[46:47], v9 offset:33792
    ds_read_b64_tr_b16 v[48:49], v10 offset:32768
    ds_read_b64_tr_b16 v[50:51], v10 offset:33792
    ds_read_b64_tr_b16 v[52:53], v9 offset:8192
    ds_read_b64_tr_b16 v[54:55], v9 offset:9216
    ds_read_b64_tr_b16 v[56:57], v10 offset:8192
    ds_read_b64_tr_b16 v[58:59], v10 offset:9216
    ds_read_b64_tr_b16 v[60:61], v9 offset:40960
    ds_read_b64_tr_b16 v[62:63], v9 offset:41984
    s_waitcnt lgkmcnt(12)
    ds_read_b64_tr_b16 v[64:65], v10 offset:40960
    ds_read_b64_tr_b16 v[66:67], v10 offset:41984
    s_waitcnt lgkmcnt(12)
    ds_read_b64_tr_b16 v[68:69], v9 offset:16384
    ds_read_b64_tr_b16 v[70:71], v9 offset:17408
    s_waitcnt lgkmcnt(12)
    ds_read_b64_tr_b16 v[72:73], v10 offset:16384
    ds_read_b64_tr_b16 v[74:75], v10 offset:17408
    s_waitcnt lgkmcnt(12)
    ds_read_b64_tr_b16 v[76:77], v9 offset:49152
    ds_read_b64_tr_b16 v[78:79], v9 offset:50176
    s_waitcnt lgkmcnt(12)
    ds_read_b64_tr_b16 v[80:81], v10 offset:49152
    ds_read_b64_tr_b16 v[82:83], v10 offset:50176
    buffer_load_dwordx4 v[100:103], v6, s[24:27], 0 offen offset:0 nt
    buffer_load_dwordx4 v[104:107], v6, s[24:27], 0 offen offset:2048 nt
    buffer_load_dwordx4 v[108:111], v6, s[24:27], s60 offen offset:0 nt
    buffer_load_dwordx4 v[112:115], v6, s[24:27], s60 offen offset:2048 nt
    buffer_load_dwordx4 v[116:119], v6, s[24:27], s61 offen offset:0 nt
    s_waitcnt lgkmcnt(8)
    ds_read_b128 v[20:23], v8 offset:41600
    ds_read_b128 v[24:27], v8 offset:41664
    ds_read_b128 v[28:31], v8 offset:41728
    ds_read_b128 v[32:35], v8 offset:41792
L_xs_ok:
    s_waitcnt lgkmcnt(3)
    v_mfma_f32_16x16x32_bf16 v[132:135], v[20:23], v[36:39], 0
    v_mfma_f32_16x16x32_bf16 v[136:139], v[20:23], v[40:43], 0
    v_mfma_f32_16x16x32_bf16 v[140:143], v[20:23], v[44:47], 0
    v_mfma_f32_16x16x32_bf16 v[144:147], v[20:23], v[48:51], 0
    s_waitcnt lgkmcnt(2)
    v_mfma_f32_16x16x32_bf16 v[132:135], v[24:27], v[52:55], v[132:135]
    v_mfma_f32_16x16x32_bf16 v[136:139], v[24:27], v[56:59], v[136:139]
    v_mfma_f32_16x16x32_bf16 v[140:143], v[24:27], v[60:63], v[140:143]
    v_mfma_f32_16x16x32_bf16 v[144:147], v[24:27], v[64:67], v[144:147]
    s_waitcnt lgkmcnt(1)
    v_mfma_f32_16x16x32_bf16 v[132:135], v[28:31], v[68:71], v[132:135]
    v_mfma_f32_16x16x32_bf16 v[136:139], v[28:31], v[72:75], v[136:139]
    v_mfma_f32_16x16x32_bf16 v[140:143], v[28:31], v[76:79], v[140:143]
    v_mfma_f32_16x16x32_bf16 v[144:147], v[28:31], v[80:83], v[144:147]
    s_cmp_lg_u32 s30, 0
    s_cbranch_scc1 L_k3_wait
    s_waitcnt vmcnt(5)
    s_mov_b64 exec, 1
    ds_add_u32 v0, v255 offset:42868
    s_mov_b64 exec, -1
L_k3_wait:
    s_branch L_sync16a
L_sync16:
    s_waitcnt lgkmcnt(0)
L_sync16a:
    ds_read_b32 v1, v0 offset:42868
    ds_read_b64_tr_b16 v[84:85], v9 offset:24576
    ds_read_b64_tr_b16 v[86:87], v9 offset:25600
    ds_read_b64_tr_b16 v[88:89], v10 offset:24576
    ds_read_b64_tr_b16 v[90:91], v10 offset:25600
    ds_read_b64_tr_b16 v[92:93], v9 offset:57344
    ds_read_b64_tr_b16 v[94:95], v9 offset:58368
    ds_read_b64_tr_b16 v[96:97], v10 offset:57344
    ds_read_b64_tr_b16 v[98:99], v10 offset:58368
    s_waitcnt lgkmcnt(8)
    v_readfirstlane_b32 s31, v1
    s_nop 0
    s_cmp_ge_u32 s31, 3
    s_cbranch_scc0 L_sync16
    v_readfirstlane_b32 s33, v19
    v_readfirstlane_b32 s34, v18
    s_waitcnt lgkmcnt(6)
    v_mfma_f32_16x16x32_bf16 v[132:135], v[32:35], v[84:87], v[132:135]
    s_waitcnt lgkmcnt(4)
    v_mfma_f32_16x16x32_bf16 v[136:139], v[32:35], v[88:91], v[136:139]
    s_waitcnt lgkmcnt(2)
    v_mfma_f32_16x16x32_bf16 v[140:143], v[32:35], v[92:95], v[140:143]
    s_waitcnt lgkmcnt(0)
    v_mfma_f32_16x16x32_bf16 v[144:147], v[32:35], v[96:99], v[144:147]
    s_mov_b32 vcc_lo, 0xffff0000
    s_mov_b32 vcc_hi, 0
    s_lshl_b32 s31, s50, 12
    s_lshl_b32 s32, s30, 7
    s_add_u32 s31, s31, s32
    s_add_u32 s31, s31, 262144
    v_lshrrev_b32 v15, 3, v2
    v_lshlrev_b32 v15, 9, v15
    v_add3_u32 v15, v15, v7, s31
    v_cndmask_b32 v26, v132, v136, vcc
    v_cndmask_b32 v27, v140, v144, vcc
    v_and_or_b32 v26, v26, s49, v14
    v_and_or_b32 v27, v27, s49, v14
    s_mov_b32 exec_hi, 0
    buffer_store_dwordx2 v[26:27], v13, s[12:15], 0 offen sc1
    s_mov_b64 exec, -1
    buffer_load_dwordx4 v[120:123], v6, s[24:27], s61 offen offset:2048 nt
    buffer_load_dwordx4 v[124:127], v6, s[24:27], s62 offen offset:0 nt
    buffer_load_dwordx4 v[128:131], v6, s[24:27], s62 offen offset:2048 nt
    s_mov_b64 exec, 1
    ds_add_u32 v0, v255 offset:42848
    s_mov_b64 exec, -1
    s_mov_b32 s52, 0x05040100
    s_mov_b32 s53, 0x07060302
    v_mov_b32 v36, 0
    v_mov_b32 v37, 0
    v_mov_b32 v38, 0
    v_mov_b32 v39, 0
    v_mov_b32 v40, 0
    v_mov_b32 v41, 0
    v_mov_b32 v42, 0
    v_mov_b32 v43, 0
    v_and_b32 v16, 7, v2
    v_lshlrev_b32 v16, 2, v16
    v_lshrrev_b32 v17, 5, v2
    v_lshl_add_u32 v16, v17, 1, v16
    s_lshl_b32 s31, s30, 5
    v_add_u32 v16, s31, v16
    v_lshrrev_b32 v17, 3, v2
    v_lshlrev_b32 v17, 4, v17
    s_lshl_b32 s31, s50, 12
    s_lshl_b32 s32, s51, 8
    s_add_u32 s31, s31, s32
    s_add_u32 s31, s31, 524288
    v_lshlrev_b32 v18, 1, v7
    v_lshrrev_b32 v19, 4, v2
    v_lshl_add_u32 v18, v19, 3, v18
    v_add_u32 v18, s31, v18
    s_waitcnt vmcnt(7)
    v_perm_b32 v98, v104, v100, s52
    v_perm_b32 v104, v104, v100, s53
    v_perm_b32 v100, v105, v101, s52
    v_perm_b32 v105, v105, v101, s53
    v_perm_b32 v101, v106, v102, s52
    v_perm_b32 v106, v106, v102, s53
    v_perm_b32 v102, v107, v103, s52
    v_perm_b32 v107, v107, v103, s53
    s_waitcnt vmcnt(5)
    v_perm_b32 v103, v112, v108, s52
    v_perm_b32 v112, v112, v108, s53
    v_perm_b32 v108, v113, v109, s52
    v_perm_b32 v113, v113, v109, s53
    v_perm_b32 v109, v114, v110, s52
    v_perm_b32 v114, v114, v110, s53
    v_perm_b32 v110, v115, v111, s52
    v_perm_b32 v115, v115, v111, s53
    s_waitcnt vmcnt(2)
    v_perm_b32 v111, v120, v116, s52
    v_perm_b32 v120, v120, v116, s53
    v_perm_b32 v116, v121, v117, s52
    v_perm_b32 v121, v121, v117, s53
    v_perm_b32 v117, v122, v118, s52
    v_perm_b32 v122, v122, v118, s53
    v_perm_b32 v118, v123, v119, s52
    v_perm_b32 v123, v123, v119, s53
    s_waitcnt vmcnt(0)
    v_perm_b32 v119, v128, v124, s52
    v_perm_b32 v128, v128, v124, s53
    v_perm_b32 v124, v129, v125, s52
    v_perm_b32 v129, v129, v125, s53
    v_perm_b32 v125, v130, v126, s52
    v_perm_b32 v130, v130, v126, s53
    v_perm_b32 v126, v131, v127, s52
    v_perm_b32 v131, v131, v127, s53
    s_mov_b32 s54, 0
L_hp_poll:
    buffer_load_dwordx4 v[20:23], v15, s[12:15], 0 offen sc1
L_hp_wait:
    s_waitcnt vmcnt(0)
    v_xor_b32 v20, v14, v20
    v_xor_b32 v21, v14, v21
    v_xor_b32 v22, v14, v22
    v_xor_b32 v23, v14, v23
    v_or3_b32 v24, v20, v21, v22
    v_or_b32 v24, v24, v23
    v_and_b32 v24, 0xff, v24
    v_cmp_ne_u32 vcc, 0, v24
    v_permlane16_swap_b32 v20, v21
    v_permlane16_swap_b32 v22, v23
    s_cbranch_vccz L_hp_got
    s_cmp_eq_u32 s35, 0
    s_cbranch_scc1 L_hp_got
    s_sub_u32 s35, s35, 1
    s_branch L_hp_poll
L_hp_got:
    v_add_f32 v20, v20, v21
    v_add_f32 v22, v22, v23
    s_nop 1
    v_permlane32_swap_b32 v20, v22
    v_add_f32 v20, v20, v22
    s_nop 1
    v_add_f32_dpp v21, v20, v20 row_ror:8 row_mask:0xf bank_mask:0xf
    v_add_f32_dpp v20, v20, v20 row_ror:8 row_mask:0xf bank_mask:0xf
    s_nop 1
    v_permlane16_swap_b32 v20, v21
    v_cvt_pk_bf16_f32 v20, v20, v21
    v_and_b32 v21, 0xffff0000, v20
    v_lshlrev_b32 v20, 16, v20
    v_mul_f32 v22, 0xbfb8aa3b, v20
    v_exp_f32 v22, v22
    s_nop 0
    v_add_f32 v22, 1.0, v22
    v_rcp_f32 v22, v22
    s_nop 0
    v_mul_f32 v20, v20, v22
    v_cvt_pk_bf16_f32 v20, v20, v20
    v_lshlrev_b32 v20, 16, v20
    v_mul_f32 v20, v20, v21
    v_cvt_pk_bf16_f32 v20, v20, v20
    ds_write_b16 v16, v20 offset:42368
    s_mov_b64 exec, 1
    ds_add_u32 v0, v255 offset:42852
    s_mov_b64 exec, -1
L_sync17:
    ds_read_b32 v1, v0 offset:42852
    ds_read_b128 v[28:31], v17 offset:42368
    s_waitcnt lgkmcnt(1)
    v_readfirstlane_b32 s31, v1
    s_nop 0
    s_cmp_ge_u32 s31, 4
    s_cbranch_scc0 L_sync17
    s_waitcnt lgkmcnt(0)
    v_dot2c_f32_bf16 v36, v28, v98
    v_dot2c_f32_bf16 v37, v28, v104
    v_dot2c_f32_bf16 v38, v28, v100
    v_dot2c_f32_bf16 v39, v28, v105
    v_dot2c_f32_bf16 v40, v28, v101
    v_dot2c_f32_bf16 v41, v28, v106
    v_dot2c_f32_bf16 v42, v28, v102
    v_dot2c_f32_bf16 v43, v28, v107
    v_dot2c_f32_bf16 v36, v29, v103
    v_dot2c_f32_bf16 v37, v29, v112
    v_dot2c_f32_bf16 v38, v29, v108
    v_dot2c_f32_bf16 v39, v29, v113
    v_dot2c_f32_bf16 v40, v29, v109
    v_dot2c_f32_bf16 v41, v29, v114
    v_dot2c_f32_bf16 v42, v29, v110
    v_dot2c_f32_bf16 v43, v29, v115
    v_dot2c_f32_bf16 v36, v30, v111
    v_dot2c_f32_bf16 v37, v30, v120
    v_dot2c_f32_bf16 v38, v30, v116
    v_dot2c_f32_bf16 v39, v30, v121
    v_dot2c_f32_bf16 v40, v30, v117
    v_dot2c_f32_bf16 v41, v30, v122
    v_dot2c_f32_bf16 v42, v30, v118
    v_dot2c_f32_bf16 v43, v30, v123
    v_dot2c_f32_bf16 v36, v31, v119
    v_dot2c_f32_bf16 v37, v31, v128
    v_dot2c_f32_bf16 v38, v31, v124
    v_dot2c_f32_bf16 v39, v31, v129
    v_dot2c_f32_bf16 v40, v31, v125
    v_dot2c_f32_bf16 v41, v31, v130
    v_dot2c_f32_bf16 v42, v31, v126
    v_dot2c_f32_bf16 v43, v31, v131
    v_permlane32_swap_b32 v36, v40
    v_permlane32_swap_b32 v37, v41
    v_permlane32_swap_b32 v38, v42
    v_permlane32_swap_b32 v39, v43
    v_add_f32 v36, v36, v40
    v_add_f32 v37, v37, v41
    v_add_f32 v38, v38, v42
    v_add_f32 v39, v39, v43
    s_nop 0
    v_permlane16_swap_b32 v36, v38
    v_permlane16_swap_b32 v37, v39
    v_add_f32 v36, v36, v38
    v_add_f32 v37, v37, v39
    s_nop 0
    v_add_f32_dpp v36, v36, v36 row_ror:8 row_mask:0xf bank_mask:0xf
    v_add_f32_dpp v37, v37, v37 row_ror:8 row_mask:0xf bank_mask:0xf
    v_and_or_b32 v36, v36, s49, v14
    v_and_or_b32 v37, v37, s49, v14
    s_mov_b32 exec_lo, 0x00ff00ff
    s_mov_b32 exec_hi, 0x00ff00ff
    buffer_store_dwordx2 v[36:37], v18, s[12:15], 0 offen sc1
    s_mov_b64 exec, 1
    ds_add_u32 v0, v255 offset:42856
    s_mov_b64 exec, -1
    s_branch L_owner
L_idle:
    s_mov_b64 exec, 1
    ds_add_u32 v0, v255 offset:42868
    s_mov_b64 exec, -1
    s_mov_b64 exec, 1
    ds_add_u32 v0, v255 offset:42848
    s_mov_b64 exec, -1
    s_mov_b64 exec, 1
    ds_add_u32 v0, v255 offset:42852
    s_mov_b64 exec, -1
    s_mov_b64 exec, 1
    ds_add_u32 v0, v255 offset:42856
    s_mov_b64 exec, -1
    s_waitcnt lgkmcnt(0)
    v_readfirstlane_b32 s33, v19
    v_readfirstlane_b32 s34, v18
L_owner:
    s_and_b32 s31, s2, 7
    s_sub_u32 s32, 8, s31
    s_min_u32 s46, s31, s32
    s_cmp_gt_u32 s31, 4
    s_cselect_b32 s31, 16, 0
    s_lshr_b32 s47, s2, 4
    s_add_u32 s47, s47, s31
    s_bfe_u32 s53, s2, 0x10003
    s_lshl_b32 s53, s53, 7
    s_add_u32 s53, s53, s31
    s_lshl_b32 s53, s53, 3
    s_add_u32 s53, s53, s46
    s_andn2_b32 s51, 0x7ff, s33
    s_mov_b32 s54, s51
    s_mov_b32 s55, 0
    s_mov_b32 s56, 0
    s_mov_b32 s16, s44
    s_mov_b32 s17, s45
    s_mov_b32 s18, 0x400000
    v_and_b32 v8, 31, v2
    v_lshlrev_b32 v15, 2, v8
    v_lshlrev_b32 v8, 1, v8
    v_mov_b32 v16, 0
L_seg:
    s_xor_b32 s31, s54, s53
    s_and_b32 s31, s31, 0x487
    s_cbranch_scc0 L_seg_own
    s_cmpk_lg_u32 s31, 0x480
    s_cbranch_scc1 L_seg_next
L_seg_own:
    s_lshl_b32 s31, s51, 11
    s_lshl_b32 s32, s47, 6
    s_add_u32 s63, s31, s32
    buffer_load_ushort v9, v8, s[8:11], s63 offen
    v_lshrrev_b32 v4, 3, v2
    s_lshl_b32 s31, s30, 4
    v_add_u32 v4, s31, v4
    v_lshlrev_b32 v4, 12, v4
    s_lshl_b32 s31, s47, 7
    s_add_u32 s31, s31, 524288
    v_add3_u32 v4, v4, v7, s31
    s_mov_b32 s62, 32768
    v_mov_b32 v24, v14
    v_mov_b32 v25, v14
    v_mov_b32 v26, v14
    v_mov_b32 v27, v14
    v_lshrrev_b32 v5, 4, v2
    v_lshl_add_u32 v6, v5, 2, v7
    s_lshl_b32 s31, s30, 7
    s_add_u32 s31, s31, s55
    v_add_u32 v6, s31, v6
    s_ashr_i32 s31, s33, 31
    s_orn2_b32 s31, 0x80000000, s31
    s_xor_b32 s31, s31, s33
    s_and_b32 s31, s31, 0xfffff800
    v_cvt_pk_bf16_f32 v11, s31, s31
    v_lshlrev_b32 v11, 16, v11
    v_mul_f32 v11, 0xbfb8aa3b, v11
    v_exp_f32 v11, v11
    s_and_b32 s32, s34, 0xffff0000
    v_add_f32 v11, 1.0, v11
    v_rcp_f32 v11, v11
    v_rcp_f32 v12, s32
    v_cvt_pk_bf16_f32 v11, v11, v11
    v_lshlrev_b32 v11, 16, v11
    s_lshl_b32 s31, s34, 16
    s_waitcnt vmcnt(0)
    v_lshl_add_u32 v13, v8, 1, s55
    s_mov_b64 vcc, -1
    s_mov_b32 s56, 1
    s_sleep 4
L_y_poll:
    s_mov_b64 exec, vcc
    buffer_load_dwordx4 v[20:23], v4, s[12:15], 0 offen sc1
    s_cmp_eq_u32 s30, 3
    s_cbranch_scc1 L_y_one
    buffer_load_dwordx4 v[24:27], v4, s[12:15], s62 offen sc1
L_y_one:
    s_mov_b64 exec, -1
    s_waitcnt vmcnt(0)
    v_xor_b32 v28, v14, v20
    v_xor_b32 v29, v14, v21
    v_xor_b32 v30, v14, v22
    v_xor_b32 v31, v14, v23
    v_xor_b32 v32, v14, v24
    v_xor_b32 v33, v14, v25
    v_xor_b32 v34, v14, v26
    v_xor_b32 v35, v14, v27
    v_or3_b32 v1, v28, v29, v30
    v_or3_b32 v1, v1, v31, v32
    v_or3_b32 v1, v1, v33, v34
    v_or_b32 v1, v1, v35
    v_and_b32 v1, 0xff, v1
    v_cmp_ne_u32 vcc, 0, v1
    v_pk_add_f32 v[28:29], v[28:29], v[32:33]
    v_pk_add_f32 v[30:31], v[30:31], v[34:35]
    s_cbranch_vccz L_y_got
    s_cmp_eq_u32 s35, 0
    s_cbranch_scc1 L_y_got
    s_sub_u32 s35, s35, 1
    s_branch L_y_poll
L_y_got:
    v_permlane16_swap_b32 v28, v29
    v_permlane16_swap_b32 v30, v31
    v_add_f32 v28, v28, v29
    v_add_f32 v30, v30, v31
    s_nop 1
    v_permlane32_swap_b32 v28, v30
    v_add_f32 v28, v28, v30
    s_nop 1
    v_add_f32_dpp v28, v28, v28 row_ror:8 row_mask:0xf bank_mask:0xf
    ds_write_b32 v6, v28 offset:43008
    s_mov_b64 exec, 1
    ds_add_u32 v16, v255 offset:42836
    s_mov_b64 exec, -1
    s_cmp_lg_u32 s30, 0
    s_cbranch_scc1 L_seg_next
    s_cmp_eq_u32 s47, 0
    s_cselect_b32 s32, 0, 2147483392
    v_mov_b32 v5, 2147483392
    v_writelane_b32 v5, s32, 0
    v_mov_b32 v18, s28
    v_mov_b32 v19, s29
    s_lshl_b32 s31, s34, 16
    v_lshlrev_b32 v9, 16, v9
    v_subrev_f32 v10, s31, v9
    v_cvt_pk_bf16_f32 v10, v10, v10
    v_lshlrev_b32 v10, 16, v10
    v_mul_f32 v10, v10, v12
    v_cvt_pk_bf16_f32 v10, v10, v10
    v_lshlrev_b32 v10, 16, v10
L_sync18:
    ds_read_b32 v1, v16 offset:42836
    ds_read_b32 v20, v13 offset:43008
    ds_read_b32 v21, v13 offset:43136
    ds_read_b32 v22, v13 offset:43264
    ds_read_b32 v23, v13 offset:43392
    ds_read_b32 v24, v15 offset:42496
    s_waitcnt lgkmcnt(5)
    v_readfirstlane_b32 s31, v1
    s_nop 0
    s_cmp_ge_u32 s31, 5
    s_cbranch_scc0 L_sync18
    s_waitcnt lgkmcnt(0)
    v_add_f32 v20, v20, v21
    v_add_f32 v22, v22, v23
    v_add_f32 v20, v20, v22
    v_cvt_pk_bf16_f32 v20, v20, v20
    v_lshlrev_b32 v20, 16, v20
    v_mul_f32 v20, v20, v11
    v_cvt_pk_bf16_f32 v20, v20, v20
    v_lshlrev_b32 v20, 16, v20
    v_add_f32 v20, v20, v10
    v_cvt_pk_bf16_f32 v20, v20, v20
    v_lshlrev_b32 v20, 16, v20
    v_mul_f32 v1, 0xbfb8aa3b, v20
    v_mul_f32 v20, v1, v24
    v_exp_f32 v1, v1
    s_nop 0
    v_add_f32 v1, 1.0, v1
    v_rcp_f32 v1, v1
    s_mov_b32 exec_hi, 0
    v_fma_f32 v20, v20, v1, v9
    v_cvt_pk_bf16_f32 v20, v20, v20
    buffer_store_short v20, v8, s[16:19], s63 offen sc1
    buffer_store_dwordx2 v[18:19], v5, s[12:15], 0 offen sc1
    s_mov_b64 exec, -1
L_seg_next:
    s_cmp_lg_u32 s55, 0
    s_cbranch_scc1 L_seg_end
    s_mov_b32 s55, 512
    s_sub_u32 s54, 0, s51
    s_sub_u32 s47, 31, s47
    v_mov_b32 v16, 28
    v_and_b32 v15, 24, v2
    v_xor_b32 v15, 24, v15
    v_sub_u32 v1, 0, v2
    v_and_b32 v1, 7, v1
    v_add_u32 v15, v15, v1
    v_lshlrev_b32 v15, 2, v15
    v_add_u32 v15, 128, v15
    s_branch L_seg
L_seg_end:
L_fin:
L_exit:
    s_endpgm
L_code_end:
.section .rodata,"a"
.p2align 6
.amdhsa_kernel recurrent_scan__spectral_fnet__moe_arch_mod__prompt_kernel
  .amdhsa_next_free_vgpr 256
  .amdhsa_next_free_sgpr 92
  .amdhsa_accum_offset 256
  .amdhsa_group_segment_fixed_size 0
  .amdhsa_kernarg_size 104
  .amdhsa_user_sgpr_count 2
  .amdhsa_user_sgpr_kernarg_segment_ptr 1
  .amdhsa_system_sgpr_workgroup_id_x 1
  .amdhsa_float_denorm_mode_32 3
.end_amdhsa_kernel
```

```asm
; @launch grid=(256,1,1) block=(512,1,1) lds=158720
.amdgcn_target "amdgcn-amd-amdhsa--gfx950"
.text
.globl recurrent_scan__spectral_fnet__moe_arch_mod__prompt_kernel
.p2align 8
.type recurrent_scan__spectral_fnet__moe_arch_mod__prompt_kernel,@function
recurrent_scan__spectral_fnet__moe_arch_mod__prompt_kernel:
    s_cmp_ge_u32 s2, 256
    s_cbranch_scc1 L_exit
    s_load_dwordx2 s[8:9], s[0:1], 0
    s_load_dwordx4 s[36:39], s[0:1], 48
    s_load_dwordx2 s[12:13], s[0:1], 96
    s_getpc_b64 s[32:33]
L_pc:
    s_bfe_u32 s31, s2, 0x30003
    v_subrev_u32 v3, 496, v0
    v_lshl_add_u32 v3, v3, 3, s31
    v_lshlrev_b32 v3, 7, v3
    v_cmp_gt_u32 vcc, L_code_end-L_pc, v3
    s_nop 0
    s_and_saveexec_b64 s[46:47], vcc
    s_cbranch_execz L_nopf
    global_load_dword v254, v3, s[32:33]
L_nopf:
    s_mov_b64 exec, -1
    v_lshrrev_b32 v1, 6, v0
    v_and_b32 v2, 63, v0
    v_readfirstlane_b32 s30, v1
    s_mov_b32 s10, 0x400000
    s_mov_b32 s11, 0x00020000
    s_mov_b32 s14, 0x10000000
    s_mov_b32 s15, 0x00020000
    s_mov_b32 s35, 65536
    v_lshlrev_b32 v3, 4, v2
    v_mov_b32 v0, 0
    v_mov_b32 v255, 1
    s_mov_b32 s3, s30
    s_and_b32 s30, s30, 3
    s_cmp_ge_u32 s3, 4
    s_cbranch_scc1 L_moe
    s_and_b32 s31, s2, 7
    s_lshr_b32 s32, s2, 4
    s_sub_u32 s32, 15, s32
    s_lshl_b32 s32, s32, 3
    s_add_u32 s46, s32, s31
    s_bfe_u32 s47, s2, 0x10003
    s_lshl_b32 s31, s47, 2
    s_add_u32 s51, s31, s30
    s_lshl_b32 s31, s51, 8
    s_add_u32 s52, s31, s46
    s_xor_b32 s54, s52, 1024
    s_sub_u32 s53, 2048, s52
    s_add_u32 s31, s52, 128
    s_cmp_eq_u32 s46, 0
    s_cselect_b32 s53, s31, s53
    s_cselect_b32 s50, 1, 0
    s_xor_b32 s55, s53, 1024
    s_lshl_b32 s56, s52, 11
    s_lshl_b32 s57, s53, 11
    s_lshl_b32 s58, s54, 11
    s_lshl_b32 s59, s55, 11
    s_mov_b32 s22, 2048
    s_mov_b32 s23, 0x00020000
    v_mov_b32 v1, 0
    v_and_b32 v6, 15, v2
    v_lshlrev_b32 v6, 2, v6
    ds_write_b64 v0, v[0:1] offset:41504
    ds_write_b32 v6, v0 offset:42816
    s_waitcnt lgkmcnt(0)
    s_load_dwordx2 s[28:29], s[12:13], 0
    s_load_dwordx2 s[16:17], s[0:1], 80
    buffer_load_dwordx4 v[120:123], v3, s[8:11], s56 offen
    buffer_load_dwordx4 v[124:127], v3, s[8:11], s56 offen offset:1024
    buffer_load_dwordx4 v[128:131], v3, s[8:11], s57 offen
    buffer_load_dwordx4 v[132:135], v3, s[8:11], s57 offen offset:1024
    s_mov_b32 s20, s36
    s_mov_b32 s21, s37
    buffer_load_dwordx4 v[152:155], v3, s[20:23], 0 offen
    buffer_load_dwordx4 v[156:159], v3, s[20:23], 0 offen offset:1024
    buffer_load_dwordx4 v[136:139], v3, s[8:11], s58 offen
    buffer_load_dwordx4 v[140:143], v3, s[8:11], s58 offen offset:1024
    buffer_load_dwordx4 v[144:147], v3, s[8:11], s59 offen
    buffer_load_dwordx4 v[148:151], v3, s[8:11], s59 offen offset:1024
    s_barrier
    s_branch L_dft_rest
L_moe:
    s_load_dwordx2 s[20:21], s[0:1], 64
    s_and_b32 s32, s2, 7
    s_mul_i32 s32, s32, 28
    s_lshr_b32 s31, s2, 3
    s_add_u32 s31, s31, s32
    s_lshr_b32 s46, s31, 3
    s_lshl_b32 s46, s46, 1
    s_and_b32 s47, s31, 7
    s_mov_b32 s75, 0
    s_mov_b32 s18, 7340032
    s_mov_b32 s19, 0x00020000
    s_mov_b32 s22, 7340032
    s_mov_b32 s23, 0x00020000
    s_mov_b32 s26, 7340032
    s_mov_b32 s27, 0x00020000
    v_lshrrev_b32 v4, 4, v2
    v_lshlrev_b32 v5, 5, v4
    v_and_b32 v6, 0x70, v3
    v_xor_b32 v5, v5, v6
    v_mul_u32_u24 v4, 7168, v4
    s_mul_i32 s31, s47, 917504
    s_lshl_b32 s32, s46, 7
    s_add_u32 s31, s31, s32
    v_add3_u32 v4, v4, v5, s31
    s_cmp_eq_u32 s75, 0
    s_mov_b32 s31, 917504
    s_cselect_b32 s31, 128, s31
    v_add_u32 v6, s31, v4
    s_mov_b32 vcc_lo, 0xff00ff00
    s_mov_b32 vcc_hi, 0xff00ff00
    v_cndmask_b32 v5, v6, v4, vcc
    v_cndmask_b32 v4, v4, v6, vcc
    s_mov_b32 s48, 0
    s_mov_b32 s49, 76800
    s_waitcnt lgkmcnt(0)
    s_mov_b32 s16, s38
    s_mov_b32 s17, s39
    s_load_dwordx2 s[28:29], s[12:13], 0
    s_load_dwordx2 s[24:25], s[0:1], 72
    s_load_dwordx2 s[44:45], s[0:1], 80
    s_barrier
    s_cmp_ge_u32 s2, 224
    s_cselect_b32 s66, 0, 1
    s_cbranch_scc1 L_dma_done
    s_cmp_lg_u32 s30, 0
    s_cbranch_scc1 L_dma_done
    s_setprio 3
L_dma:
    s_mov_b32 m0, s49
    s_waitcnt vmcnt(19)
    buffer_load_dwordx4 v4, s[16:19], s48 offen nt lds
    s_add_u32 m0, s49, 32768
    s_add_u32 s49, s49, 1024
    s_waitcnt vmcnt(19)
    buffer_load_dwordx4 v4, s[20:23], s48 offen nt lds
    s_add_u32 s48, s48, 28672
    s_mov_b32 m0, s49
    s_waitcnt vmcnt(19)
    buffer_load_dwordx4 v4, s[16:19], s48 offen nt lds
    s_add_u32 m0, s49, 32768
    s_add_u32 s49, s49, 1024
    s_waitcnt vmcnt(19)
    buffer_load_dwordx4 v4, s[20:23], s48 offen nt lds
    s_add_u32 s48, s48, 28672
    s_mov_b32 m0, s49
    s_waitcnt vmcnt(19)
    buffer_load_dwordx4 v5, s[16:19], s48 offen nt lds
    s_add_u32 m0, s49, 32768
    s_add_u32 s49, s49, 1024
    s_waitcnt vmcnt(19)
    buffer_load_dwordx4 v5, s[20:23], s48 offen nt lds
    s_add_u32 s48, s48, 28672
    s_mov_b32 m0, s49
    s_waitcnt vmcnt(19)
    buffer_load_dwordx4 v5, s[16:19], s48 offen nt lds
    s_add_u32 m0, s49, 32768
    s_add_u32 s49, s49, 1024
    s_waitcnt vmcnt(19)
    buffer_load_dwordx4 v5, s[20:23], s48 offen nt lds
    s_add_u32 s48, s48, 28672
    s_cmp_lt_u32 s48, 917504
    s_cbranch_scc1 L_dma
    s_branch L_dma_done
L_dft_rest:
    s_mov_b32 s18, 0x400000
    s_mov_b32 s19, 0x00020000
    s_sub_u32 s31, 2047, s52
    s_sub_u32 s32, 2047, s53
    v_mov_b32 v200, s31
    v_writelane_b32 v200, s32, 63
    s_lshl_b32 s31, s30, 2
    v_mov_b32 v201, s31
    s_bfe_u32 s31, s53, 0x20008
    s_lshl_b32 s31, s31, 2
    s_add_u32 s31, s31, 16
    v_writelane_b32 v201, s31, 63
    v_and_b32 v6, 32, v2
    s_lshl_b32 s31, s51, 2
    v_add_u32 v203, s31, v6
    v_lshrrev_b32 v202, 1, v203
    s_lshl_b32 s31, s2, 4
    s_add_u32 s31, s31, 4096
    v_mov_b32 v4, s31
    v_lshlrev_b32 v5, 3, v2
    s_and_b32 s31, s52, 7
    s_lshl_b32 s31, s31, 11
    s_and_b32 s32, s52, 1024
    s_add_u32 s31, s31, s32
    s_and_b32 s32, s52, 0xf8
    s_lshl_b32 s32, s32, 2
    s_add_u32 s31, s31, s32
    s_add_u32 s31, s31, 32768
    v_writelane_b32 v4, s31, 0
    s_add_u32 s31, s31, 16
    v_writelane_b32 v4, s31, 1
    s_and_b32 s31, s53, 7
    s_lshl_b32 s31, s31, 11
    s_and_b32 s32, s53, 1024
    s_add_u32 s31, s31, s32
    s_and_b32 s32, s53, 0xf8
    s_lshl_b32 s32, s32, 2
    s_add_u32 s31, s31, s32
    s_add_u32 s31, s31, 32768
    v_writelane_b32 v4, s31, 2
    s_add_u32 s31, s31, 16
    v_writelane_b32 v4, s31, 3
    s_mul_i32 s31, s51, 2592
    v_and_b32 v204, 32, v2
    v_lshlrev_b32 v204, 2, v204
    v_add3_u32 v204, v204, v3, s31
    s_lshl_b32 s32, s31, 1
    s_add_u32 s32, s32, 21872
    v_sub_u32 v205, s32, v204
    v_bfe_u32 v206, v2, 2, 2
    v_mul_u32_u24 v206, 2592, v206
    v_lshrrev_b32 v6, 4, v2
    v_mul_u32_u24 v7, 640, v6
    v_add_u32 v206, v206, v7
    v_and_b32 v7, 3, v2
    v_lshlrev_b32 v7, 3, v7
    s_lshl_b32 s31, s30, 7
    v_add3_u32 v206, v206, v7, s31
    v_lshlrev_b32 v6, 12, v6
    v_and_b32 v7, 15, v2
    v_lshl_add_u32 v6, v7, 4, v6
    s_lshl_b32 s31, s30, 8
    v_add_u32 v207, s31, v6
    v_bfe_i32 v208, v2, 4, 1
    v_and_b32 v208, 0x80008000, v208
    s_cmp_eq_u32 s47, 0
    s_movk_i32 s48, 0x7403
    s_cselect_b32 s48, 0x7721, s48
    v_and_b32 v250, 12, v2
    v_bfe_u32 v250, s48, v250, 4
    v_lshrrev_b32 v251, 4, v2
    v_bfe_u32 v252, v2, 1, 1
    v_mul_u32_u24 v251, v251, v252
    v_and_b32 v252, 1, v2
    v_add_u32 v251, v251, v252
    v_cvt_f32_u32 v250, v250
    v_cvt_f32_u32 v251, v251
    v_mul_f32 v250, 0x3e000000, v250
    v_mul_f32 v251, 0x3e800000, v251
    v_cos_f32 v8, v251
    v_add_f32 v251, v251, v250
    v_cos_f32 v9, v251
    v_add_f32 v251, v251, v250
    v_cos_f32 v10, v251
    v_add_f32 v251, v251, v250
    v_cos_f32 v11, v251
    v_add_f32 v251, v251, v250
    v_cos_f32 v12, v251
    v_add_f32 v251, v251, v250
    v_cos_f32 v13, v251
    v_add_f32 v251, v251, v250
    v_cos_f32 v14, v251
    v_add_f32 v251, v251, v250
    v_cos_f32 v15, v251
    v_mul_f32 v8, 0xbf317218, v8
    v_mul_f32 v9, 0xbf317218, v9
    v_mul_f32 v10, 0xbf317218, v10
    v_mul_f32 v11, 0xbf317218, v11
    v_mul_f32 v12, 0xbf317218, v12
    v_mul_f32 v13, 0xbf317218, v13
    v_mul_f32 v14, 0xbf317218, v14
    v_mul_f32 v15, 0xbf317218, v15
    v_lshrrev_b32 v250, 2, v2
    v_and_b32 v250, 12, v250
    v_and_b32 v251, 15, v2
    v_lshlrev_b32 v251, 2, v251
    v_cvt_f32_u32 v250, v250
    v_cvt_f32_u32 v251, v251
    v_mul_f32 v212, 0x3c800000, v250
    s_lshl_b32 s31, s30, 2
    s_lshr_b32 s48, s48, s31
    s_and_b32 s48, s48, 15
    s_sub_u32 s31, s48, 4
    s_mul_i32 s31, s31, s46
    v_cvt_f32_i32 v252, s31
    v_mul_f32 v252, 0x3a000000, v252
    v_add_f32 v213, 0x3c800000, v212
    v_add_f32 v214, 0x3d000000, v212
    v_add_f32 v215, 0x3d400000, v212
    s_and_b32 s31, s2, 7
    s_sub_u32 s32, 8, s31
    s_min_u32 s76, s31, s32
    s_lshr_b32 s78, s31, 2
    s_lshr_b32 s77, s2, 3
    s_and_b32 s32, s77, 1
    s_and_b32 s31, s31, 3
    s_cselect_b32 s78, s78, s32
    s_cselect_b32 s31, 0, 1
    s_lshr_b32 s77, s77, s31
    s_lshl_b32 s78, s78, 4
    s_lshl_b32 s31, s30, 5
    s_add_u32 s78, s78, s31
    s_lshl_b32 s78, s78, 3
    s_add_u32 s78, s78, s76
    s_lshl_b32 s77, s77, 6
    s_sub_u32 s79, 1984, s77
    s_lshl_b32 s76, s76, 1
    s_add_u32 s76, s76, 2040
    v_and_b32 v116, 15, v2
    v_lshl_add_u32 v116, v116, 3, s78
    v_and_b32 v7, 32, v2
    v_lshl_add_u32 v7, v7, 5, v116
    s_mov_b32 vcc_lo, 0xffff0000
    s_mov_b32 vcc_hi, 0xffff0000
    v_sub_u32 v6, 0, v7
    v_cndmask_b32 v7, v7, v6, vcc
    v_and_b32 v6, 7, v7
    v_and_b32 v1, 1024, v7
    v_lshl_add_u32 v6, v6, 11, v1
    v_and_b32 v1, 0xf8, v7
    v_lshl_add_u32 v6, v1, 2, v6
    v_bfe_u32 v1, v7, 9, 1
    v_lshl_add_u32 v119, v1, 4, v6
    v_and_b32 v1, 256, v7
    v_cmp_ne_u32 s[88:89], 0, v1
    v_lshrrev_b32 v118, 2, v2
    v_lshl_add_u32 v118, v118, 3, s78
    v_lshlrev_b32 v1, 1, v2
    v_xor_b32 v1, v1, v3
    v_and_b32 v1, 48, v1
    v_add_u32 v114, 1024, v118
    v_sub_u32 v113, 0, v118
    v_and_b32 v113, 2047, v113
    v_sub_u32 v115, 2048, v114
    v_add_u32 v112, s77, v1
    v_lshl_add_u32 v114, v114, 11, v112
    v_lshl_add_u32 v112, v118, 11, v112
    v_xor_b32 v1, 48, v1
    v_add_u32 v1, s79, v1
    v_lshl_add_u32 v113, v113, 11, v1
    v_lshl_add_u32 v115, v115, 11, v1
    s_lshl_b32 s76, s30, 12
    s_add_u32 s76, s76, 44032
    v_and_b32 v1, 15, v2
    v_lshlrev_b32 v6, 6, v1
    v_lshlrev_b32 v1, 3, v2
    v_xor_b32 v1, v1, v2
    v_and_b32 v1, 48, v1
    v_add3_u32 v117, v6, v1, s76
    v_mul_f32 v250, v212, v251
    v_fmamk_f32 v52, v250, 0x3d800000, v252
    v_sin_f32 v20, v250
    v_cos_f32 v250, v250
    v_cos_f32 v48, v52
    v_sin_f32 v52, v52
    v_cvt_pk_f16_f32 v16, v250, v20
    v_cvt_pk_f16_f32 v20, -v20, v250
    v_mul_f32 v250, v213, v251
    v_fmamk_f32 v53, v250, 0x3d800000, v252
    v_sin_f32 v21, v250
    v_cos_f32 v250, v250
    v_cos_f32 v49, v53
    v_sin_f32 v53, v53
    v_cvt_pk_f16_f32 v17, v250, v21
    v_cvt_pk_f16_f32 v21, -v21, v250
    v_mul_f32 v250, v214, v251
    v_fmamk_f32 v54, v250, 0x3d800000, v252
    v_sin_f32 v22, v250
    v_cos_f32 v250, v250
    v_cos_f32 v50, v54
    v_sin_f32 v54, v54
    v_cvt_pk_f16_f32 v18, v250, v22
    v_cvt_pk_f16_f32 v22, -v22, v250
    v_mul_f32 v250, v215, v251
    v_fmamk_f32 v55, v250, 0x3d800000, v252
    v_sin_f32 v23, v250
    v_cos_f32 v250, v250
    v_cos_f32 v51, v55
    v_sin_f32 v55, v55
    v_cvt_pk_f16_f32 v19, v250, v23
    v_cvt_pk_f16_f32 v23, -v23, v250
    v_add_f32 v251, 1.0, v251
    v_mul_f32 v250, v212, v251
    v_fmamk_f32 v60, v250, 0x3d800000, v252
    v_sin_f32 v28, v250
    v_cos_f32 v250, v250
    v_cos_f32 v56, v60
    v_sin_f32 v60, v60
    v_cvt_pk_f16_f32 v24, v250, v28
    v_cvt_pk_f16_f32 v28, -v28, v250
    v_mul_f32 v250, v213, v251
    v_fmamk_f32 v61, v250, 0x3d800000, v252
    v_sin_f32 v29, v250
    v_cos_f32 v250, v250
    v_cos_f32 v57, v61
    v_sin_f32 v61, v61
    v_cvt_pk_f16_f32 v25, v250, v29
    v_cvt_pk_f16_f32 v29, -v29, v250
    v_mul_f32 v250, v214, v251
    v_fmamk_f32 v62, v250, 0x3d800000, v252
    v_sin_f32 v30, v250
    v_cos_f32 v250, v250
    v_cos_f32 v58, v62
    v_sin_f32 v62, v62
    v_cvt_pk_f16_f32 v26, v250, v30
    v_cvt_pk_f16_f32 v30, -v30, v250
    v_mul_f32 v250, v215, v251
    v_fmamk_f32 v63, v250, 0x3d800000, v252
    v_sin_f32 v31, v250
    v_cos_f32 v250, v250
    v_cos_f32 v59, v63
    v_sin_f32 v63, v63
    v_cvt_pk_f16_f32 v27, v250, v31
    v_cvt_pk_f16_f32 v31, -v31, v250
    v_add_f32 v251, 1.0, v251
    v_mov_b32 v160, 0
    v_mov_b32 v161, 0
    v_mov_b32 v162, 0
    v_mov_b32 v163, 0
    v_mov_b32 v164, 0
    v_mov_b32 v165, 0
    v_mov_b32 v166, 0
    v_mov_b32 v167, 0
    v_mov_b32 v168, 0
    v_mov_b32 v169, 0
    v_mov_b32 v170, 0
    s_mov_b32 s57, 0x3f803f80
    s_mov_b32 s59, 0xffff
    s_brev_b32 s67, 1
    s_mov_b32 s66, 0
    s_brev_b32 s64, 1
    s_brev_b32 s65, 1
    s_cmp_eq_u32 s47, 0
    s_movk_i32 s62, -10368
    s_cselect_b32 s62, 10368, s62
    s_waitcnt lgkmcnt(0)
    s_add_u32 s28, s28, 0x7f4a7c15
    s_addc_u32 s29, s29, 0x9e3779b9
    v_mov_b32 v174, s28
    v_mov_b32 v175, s29
    s_cmp_lt_u32 s2, 224
    s_cbranch_scc1 L_epoch_ok
L_sync1:
    ds_read_b32 v1, v0 offset:42872
    s_waitcnt lgkmcnt(0)
    v_readfirstlane_b32 s31, v1
    s_nop 0
    s_cmp_ge_u32 s31, 4
    s_cbranch_scc0 L_sync1
L_epoch_ok:
    s_setprio 3
    s_waitcnt vmcnt(8)
    v_dot2c_f32_bf16 v160, s57, v120
    v_dot2c_f32_bf16 v164, v120, v120
    v_dot2c_f32_bf16 v160, s57, v121
    v_dot2c_f32_bf16 v164, v121, v121
    v_dot2c_f32_bf16 v160, s57, v122
    v_dot2c_f32_bf16 v164, v122, v122
    v_dot2c_f32_bf16 v160, s57, v123
    v_dot2c_f32_bf16 v164, v123, v123
    v_dot2c_f32_bf16 v160, s57, v124
    v_dot2c_f32_bf16 v164, v124, v124
    v_dot2c_f32_bf16 v160, s57, v125
    v_dot2c_f32_bf16 v164, v125, v125
    v_dot2c_f32_bf16 v160, s57, v126
    v_dot2c_f32_bf16 v164, v126, v126
    v_dot2c_f32_bf16 v160, s57, v127
    v_dot2c_f32_bf16 v164, v127, v127
    s_waitcnt vmcnt(6)
    v_dot2c_f32_bf16 v161, s57, v128
    v_dot2c_f32_bf16 v165, v128, v128
    v_dot2c_f32_bf16 v161, s57, v129
    v_dot2c_f32_bf16 v165, v129, v129
    v_dot2c_f32_bf16 v161, s57, v130
    v_dot2c_f32_bf16 v165, v130, v130
    v_dot2c_f32_bf16 v161, s57, v131
    v_dot2c_f32_bf16 v165, v131, v131
    v_dot2c_f32_bf16 v161, s57, v132
    v_dot2c_f32_bf16 v165, v132, v132
    v_dot2c_f32_bf16 v161, s57, v133
    v_dot2c_f32_bf16 v165, v133, v133
    v_dot2c_f32_bf16 v161, s57, v134
    v_dot2c_f32_bf16 v165, v134, v134
    v_dot2c_f32_bf16 v161, s57, v135
    v_dot2c_f32_bf16 v165, v135, v135
    s_waitcnt vmcnt(4)
    v_dot2c_f32_bf16 v170, s57, v152
    v_dot2c_f32_bf16 v170, s57, v153
    v_dot2c_f32_bf16 v170, s57, v154
    v_dot2c_f32_bf16 v170, s57, v155
    v_dot2c_f32_bf16 v170, s57, v156
    v_dot2c_f32_bf16 v170, s57, v157
    v_dot2c_f32_bf16 v170, s57, v158
    v_dot2c_f32_bf16 v170, s57, v159
    v_dot2c_f32_bf16 v168, v152, v120
    v_dot2c_f32_bf16 v169, v152, v128
    v_dot2c_f32_bf16 v168, v153, v121
    v_dot2c_f32_bf16 v169, v153, v129
    v_dot2c_f32_bf16 v168, v154, v122
    v_dot2c_f32_bf16 v169, v154, v130
    v_dot2c_f32_bf16 v168, v155, v123
    v_dot2c_f32_bf16 v169, v155, v131
    v_mov_b32 v171, v170
    v_dot2c_f32_bf16 v168, v156, v124
    v_dot2c_f32_bf16 v169, v156, v132
    v_dot2c_f32_bf16 v168, v157, v125
    v_dot2c_f32_bf16 v169, v157, v133
    v_dot2c_f32_bf16 v168, v158, v126
    v_dot2c_f32_bf16 v169, v158, v134
    v_dot2c_f32_bf16 v168, v159, v127
    v_dot2c_f32_bf16 v169, v159, v135
    v_permlane32_swap_b32 v160, v161
    v_permlane32_swap_b32 v164, v165
    v_permlane32_swap_b32 v170, v171
    v_permlane32_swap_b32 v168, v169
    v_add_f32 v160, v160, v161
    v_add_f32 v164, v164, v165
    v_add_f32 v170, v170, v171
    v_add_f32 v168, v168, v169
    v_add_f32_dpp v160, v160, v160 row_shr:1 row_mask:0xf bank_mask:0xf
    v_add_f32_dpp v164, v164, v164 row_shr:1 row_mask:0xf bank_mask:0xf
    v_add_f32_dpp v170, v170, v170 row_shr:1 row_mask:0xf bank_mask:0xf
    v_add_f32_dpp v168, v168, v168 row_shr:1 row_mask:0xf bank_mask:0xf
    v_add_f32_dpp v160, v160, v160 row_shr:2 row_mask:0xf bank_mask:0xf
    v_add_f32_dpp v164, v164, v164 row_shr:2 row_mask:0xf bank_mask:0xf
    v_add_f32_dpp v170, v170, v170 row_shr:2 row_mask:0xf bank_mask:0xf
    v_add_f32_dpp v168, v168, v168 row_shr:2 row_mask:0xf bank_mask:0xf
    v_add_f32_dpp v160, v160, v160 row_shr:4 row_mask:0xf bank_mask:0xf
    v_add_f32_dpp v164, v164, v164 row_shr:4 row_mask:0xf bank_mask:0xf
    v_add_f32_dpp v170, v170, v170 row_shr:4 row_mask:0xf bank_mask:0xf
    v_add_f32_dpp v168, v168, v168 row_shr:4 row_mask:0xf bank_mask:0xf
    v_add_f32_dpp v160, v160, v160 row_shr:8 row_mask:0xf bank_mask:0xf
    v_add_f32_dpp v164, v164, v164 row_shr:8 row_mask:0xf bank_mask:0xf
    v_add_f32_dpp v170, v170, v170 row_shr:8 row_mask:0xf bank_mask:0xf
    v_add_f32_dpp v168, v168, v168 row_shr:8 row_mask:0xf bank_mask:0xf
    v_add_f32_dpp v160, v160, v160 row_bcast:15 row_mask:0xa bank_mask:0xf
    v_add_f32_dpp v164, v164, v164 row_bcast:15 row_mask:0xa bank_mask:0xf
    v_add_f32_dpp v170, v170, v170 row_bcast:15 row_mask:0xa bank_mask:0xf
    v_add_f32_dpp v168, v168, v168 row_bcast:15 row_mask:0xa bank_mask:0xf
    v_mul_f32 v160, 0x3a800000, v160
    v_mul_f32 v164, 0x3a800000, v164
    v_fma_f32 v164, -v160, v160, v164
    v_cvt_pk_bf16_f32 v161, -v160, -v160
    v_max_f32 v164, 0, v164
    v_cvt_pk_bf16_f32 v164, v164, v164
    v_and_b32 v164, 0xffff0000, v164
    v_add_f32 v164, 0x3727c5ac, v164
    v_cvt_pk_bf16_f32 v164, v164, v164
    v_and_b32 v164, 0xffff0000, v164
    v_sqrt_f32 v164, v164
    v_and_b32 v165, 0xffff0000, v161
    v_cvt_pk_bf16_f32 v248, v160, v164
    v_and_b32 v164, 0xffff0000, v248
    v_rcp_f32 v164, v164
    v_fmac_f32 v168, v170, v165
    v_mul_f32 v168, v168, v164
    v_ashrrev_i32 v170, 31, v168
    v_or_b32 v170, 0x80000000, v170
    v_xor_b32 v168, v168, v170
    v_and_b32 v168, 0xfffff800, v168
    v_or_b32 v249, v200, v168
    s_mov_b64 exec, s[64:65]
    ds_write_b32 v201, v248 offset:41472
    ds_max_u64 v0, v[248:249] offset:41504
    s_mov_b64 exec, 1
    ds_add_rtn_u32 v1, v0, v255 offset:42816
    s_mov_b64 exec, 31
    ds_read_b64 v[172:173], v5 offset:41472
    s_mov_b64 exec, s[64:65]
    ds_write_b16 v202, v161 offset:41568
    ds_write_b32 v203, v164 offset:42752
    s_mov_b64 exec, -1
    s_nop 0
    v_mov_b32_dpp v6, v128 wave_rol:1 row_mask:0xf bank_mask:0xf
    v_mov_b32_dpp v7, v132 wave_rol:1 row_mask:0xf bank_mask:0xf
    v_bfi_b32 v221, s59, v131, v130
    v_bfi_b32 v222, s59, v130, v129
    v_bfi_b32 v223, s59, v129, v128
    v_bfi_b32 v217, s59, v135, v134
    v_bfi_b32 v218, s59, v134, v133
    v_bfi_b32 v219, s59, v133, v132
    v_cndmask_b32 v220, v6, v7, s[66:67]
    v_cndmask_b32 v216, v7, v6, s[66:67]
    v_bfi_b32 v220, s59, v220, v131
    v_bfi_b32 v216, s59, v216, v135
    s_waitcnt lgkmcnt(2)
    v_readfirstlane_b32 s31, v1
    s_nop 0
    s_cmp_lg_u32 s31, 3
    s_cbranch_scc1 L_not_last
    s_mov_b64 exec, 31
    buffer_store_dwordx4 v[172:175], v4, s[12:15], 0 offen sc1
    s_mov_b64 exec, -1
    s_waitcnt vmcnt(1)
    s_branch L_b_ready
L_not_last:
    s_waitcnt vmcnt(0)
L_b_ready:
    s_setprio 3
    ds_write_b128 v204, v[120:123] offset:0
    ds_write_b128 v204, v[124:127] offset:1280
    s_cmp_lg_u32 s50, 0
    s_cbranch_scc1 L_plain1
    ds_write_b128 v205, v[216:219]
    ds_write_b128 v205, v[220:223] offset:1280
    s_branch L_second1
L_plain1:
    ds_write_b128 v204, v[128:131] offset:20736
    ds_write_b128 v204, v[132:135] offset:22016
L_second1:
    v_add_u32 v204, s62, v204
    v_add_u32 v205, s62, v205
    v_dot2c_f32_bf16 v162, s57, v136
    v_dot2c_f32_bf16 v166, v136, v136
    v_dot2c_f32_bf16 v162, s57, v137
    v_dot2c_f32_bf16 v166, v137, v137
    v_dot2c_f32_bf16 v162, s57, v138
    v_dot2c_f32_bf16 v166, v138, v138
    v_dot2c_f32_bf16 v162, s57, v139
    v_dot2c_f32_bf16 v166, v139, v139
    v_dot2c_f32_bf16 v162, s57, v140
    v_dot2c_f32_bf16 v166, v140, v140
    v_dot2c_f32_bf16 v162, s57, v141
    v_dot2c_f32_bf16 v166, v141, v141
    v_dot2c_f32_bf16 v162, s57, v142
    v_dot2c_f32_bf16 v166, v142, v142
    v_dot2c_f32_bf16 v162, s57, v143
    v_dot2c_f32_bf16 v166, v143, v143
    ds_write_b128 v204, v[136:139] offset:0
    ds_write_b128 v204, v[140:143] offset:1280
    v_dot2c_f32_bf16 v163, s57, v144
    v_dot2c_f32_bf16 v167, v144, v144
    v_dot2c_f32_bf16 v163, s57, v145
    v_dot2c_f32_bf16 v167, v145, v145
    v_dot2c_f32_bf16 v163, s57, v146
    v_dot2c_f32_bf16 v167, v146, v146
    v_dot2c_f32_bf16 v163, s57, v147
    v_dot2c_f32_bf16 v167, v147, v147
    v_dot2c_f32_bf16 v163, s57, v148
    v_dot2c_f32_bf16 v167, v148, v148
    v_dot2c_f32_bf16 v163, s57, v149
    v_dot2c_f32_bf16 v167, v149, v149
    v_dot2c_f32_bf16 v163, s57, v150
    v_dot2c_f32_bf16 v167, v150, v150
    v_dot2c_f32_bf16 v163, s57, v151
    v_dot2c_f32_bf16 v167, v151, v151
    v_xor_b32 v202, 8, v202
    v_xor_b32 v203, 16, v203
    s_waitcnt lgkmcnt(2)
    s_nop 0
    v_mov_b32_dpp v6, v144 wave_rol:1 row_mask:0xf bank_mask:0xf
    v_mov_b32_dpp v7, v148 wave_rol:1 row_mask:0xf bank_mask:0xf
    v_bfi_b32 v221, s59, v147, v146
    v_bfi_b32 v222, s59, v146, v145
    v_bfi_b32 v223, s59, v145, v144
    v_bfi_b32 v217, s59, v151, v150
    v_bfi_b32 v218, s59, v150, v149
    v_bfi_b32 v219, s59, v149, v148
    v_cndmask_b32 v220, v6, v7, s[66:67]
    v_cndmask_b32 v216, v7, v6, s[66:67]
    v_bfi_b32 v220, s59, v220, v147
    v_bfi_b32 v216, s59, v216, v151
    s_cmp_lg_u32 s50, 0
    s_cbranch_scc1 L_plain3
    ds_write_b128 v205, v[216:219]
    ds_write_b128 v205, v[220:223] offset:1280
    s_branch L_second3
L_plain3:
    ds_write_b128 v204, v[144:147] offset:20736
    ds_write_b128 v204, v[148:151] offset:22016
L_second3:
    v_permlane32_swap_b32 v162, v163
    v_permlane32_swap_b32 v166, v167
    v_add_f32 v162, v162, v163
    v_add_f32 v166, v166, v167
    s_nop 0
    v_add_f32_dpp v162, v162, v162 row_shr:1 row_mask:0xf bank_mask:0xf
    v_add_f32_dpp v166, v166, v166 row_shr:1 row_mask:0xf bank_mask:0xf
    s_nop 0
    v_add_f32_dpp v162, v162, v162 row_shr:2 row_mask:0xf bank_mask:0xf
    v_add_f32_dpp v166, v166, v166 row_shr:2 row_mask:0xf bank_mask:0xf
    s_nop 0
    v_add_f32_dpp v162, v162, v162 row_shr:4 row_mask:0xf bank_mask:0xf
    v_add_f32_dpp v166, v166, v166 row_shr:4 row_mask:0xf bank_mask:0xf
    s_nop 0
    v_add_f32_dpp v162, v162, v162 row_shr:8 row_mask:0xf bank_mask:0xf
    v_add_f32_dpp v166, v166, v166 row_shr:8 row_mask:0xf bank_mask:0xf
    s_nop 0
    v_add_f32_dpp v162, v162, v162 row_bcast:15 row_mask:0xa bank_mask:0xf
    v_add_f32_dpp v166, v166, v166 row_bcast:15 row_mask:0xa bank_mask:0xf
    v_mul_f32 v162, 0x3a800000, v162
    v_mul_f32 v166, 0x3a800000, v166
    v_fma_f32 v166, -v162, v162, v166
    v_cvt_pk_bf16_f32 v161, -v162, -v162
    v_max_f32 v166, 0, v166
    v_cvt_pk_bf16_f32 v166, v166, v166
    v_and_b32 v166, 0xffff0000, v166
    v_add_f32 v166, 0x3727c5ac, v166
    v_cvt_pk_bf16_f32 v166, v166, v166
    v_and_b32 v166, 0xffff0000, v166
    v_sqrt_f32 v166, v166
    v_and_b32 v167, 0xffff0000, v161
    v_cvt_pk_bf16_f32 v248, v162, v166
    v_and_b32 v166, 0xffff0000, v248
    v_rcp_f32 v166, v166
    s_mov_b64 exec, s[64:65]
    ds_write_b16 v202, v161 offset:41568
    ds_write_b32 v203, v166 offset:42752
    s_mov_b64 exec, 1
    ds_add_u32 v0, v255 offset:42820
    s_mov_b64 exec, -1
L_sync2:
    ds_read_b32 v1, v0 offset:42820
    ds_read_b128 v[176:179], v0 offset:42752
    ds_read_b128 v[180:183], v0 offset:42768
    ds_read_b128 v[184:187], v0 offset:42784
    ds_read_b128 v[188:191], v0 offset:42800
    ds_read_b128 v[192:195], v0 offset:41568
    ds_read_b128 v[196:199], v0 offset:41584
    s_waitcnt lgkmcnt(6)
    v_readfirstlane_b32 s31, v1
    s_nop 0
    s_cmp_ge_u32 s31, 4
    s_cbranch_scc0 L_sync2
    ds_read_b64_tr_b16 v[120:121], v206 offset:0
    ds_read_b64_tr_b16 v[122:123], v206 offset:10368
    ds_read_b64_tr_b16 v[124:125], v206 offset:20736
    ds_read_b64_tr_b16 v[126:127], v206 offset:31104
    ds_read_b64_tr_b16 v[128:129], v206 offset:32
    ds_read_b64_tr_b16 v[130:131], v206 offset:10400
    ds_read_b64_tr_b16 v[132:133], v206 offset:20768
    ds_read_b64_tr_b16 v[134:135], v206 offset:31136
    s_waitcnt lgkmcnt(10)
    ds_read_b64_tr_b16 v[136:137], v206 offset:64
    ds_read_b64_tr_b16 v[138:139], v206 offset:10432
    ds_read_b64_tr_b16 v[140:141], v206 offset:20800
    ds_read_b64_tr_b16 v[142:143], v206 offset:31168
    v_pk_mul_f32 v[176:177], v[176:177], v[8:9]
    v_pk_mul_f32 v[178:179], v[178:179], v[10:11]
    v_pk_mul_f32 v[180:181], v[180:181], v[12:13]
    v_pk_mul_f32 v[182:183], v[182:183], v[14:15]
    v_pk_mul_f32 v[184:185], v[184:185], v[8:9]
    v_pk_mul_f32 v[186:187], v[186:187], v[10:11]
    v_pk_mul_f32 v[188:189], v[188:189], v[12:13]
    v_pk_mul_f32 v[190:191], v[190:191], v[14:15]
    v_cvt_pk_bf16_f32 v160, v176, v177
    v_cvt_pk_bf16_f32 v152, v184, v185
    v_cvt_pk_bf16_f32 v161, v178, v179
    v_cvt_pk_bf16_f32 v153, v186, v187
    v_cvt_pk_bf16_f32 v162, v180, v181
    v_cvt_pk_bf16_f32 v154, v188, v189
    v_cvt_pk_bf16_f32 v163, v182, v183
    v_cvt_pk_bf16_f32 v155, v190, v191
    v_xor_b32 v164, v208, v160
    v_xor_b32 v156, v208, v152
    v_xor_b32 v165, v208, v161
    v_xor_b32 v157, v208, v153
    v_xor_b32 v166, v208, v162
    v_xor_b32 v158, v208, v154
    v_xor_b32 v167, v208, v163
    v_xor_b32 v159, v208, v155
    s_waitcnt lgkmcnt(12)
    s_cmp_lg_u32 s50, 0
    s_cbranch_scc1 L_st1_split
    v_mfma_f32_16x16x32_bf16 v[168:171], v[160:163], v[192:195], 0
    v_mfma_f32_16x16x32_bf16 v[168:171], v[152:155], v[196:199], v[168:171]
    s_waitcnt lgkmcnt(10)
    ds_read_b64_tr_b16 v[144:145], v206 offset:96
    ds_read_b64_tr_b16 v[146:147], v206 offset:10464
    ds_read_b64_tr_b16 v[148:149], v206 offset:20832
    ds_read_b64_tr_b16 v[150:151], v206 offset:31200
    v_mfma_f32_16x16x32_bf16 v[216:219], v[160:163], v[120:123], v[168:171]
    s_waitcnt lgkmcnt(12)
    v_mfma_f32_16x16x32_bf16 v[216:219], v[152:155], v[124:127], v[216:219]
    s_waitcnt lgkmcnt(10)
    v_mfma_f32_16x16x32_bf16 v[224:227], v[160:163], v[128:131], v[168:171]
    s_waitcnt lgkmcnt(8)
    v_mfma_f32_16x16x32_bf16 v[224:227], v[152:155], v[132:135], v[224:227]
    s_waitcnt lgkmcnt(6)
    v_mfma_f32_16x16x32_bf16 v[232:235], v[160:163], v[136:139], v[168:171]
    s_waitcnt lgkmcnt(4)
    v_mfma_f32_16x16x32_bf16 v[232:235], v[152:155], v[140:143], v[232:235]
    s_waitcnt lgkmcnt(2)
    v_mfma_f32_16x16x32_bf16 v[240:243], v[160:163], v[144:147], v[168:171]
    s_waitcnt lgkmcnt(0)
    v_mfma_f32_16x16x32_bf16 v[240:243], v[152:155], v[148:151], v[240:243]
    v_mfma_f32_16x16x32_bf16 v[220:223], v[164:167], v[120:123], 0
    v_mfma_f32_16x16x32_bf16 v[220:223], v[156:159], v[124:127], v[220:223]
    v_mfma_f32_16x16x32_bf16 v[228:231], v[164:167], v[128:131], 0
    v_mfma_f32_16x16x32_bf16 v[228:231], v[156:159], v[132:135], v[228:231]
    v_cvt_pk_f16_f32 v176, v216, v217
    v_cvt_pk_f16_f32 v177, v224, v225
    v_cvt_pk_f16_f32 v178, v232, v233
    s_nop 0
    v_cvt_pk_f16_f32 v179, v240, v241
    ds_write_b128 v207, v[176:179] offset:44032
    v_mfma_f32_16x16x32_bf16 v[236:239], v[164:167], v[136:139], 0
    v_mfma_f32_16x16x32_bf16 v[236:239], v[156:159], v[140:143], v[236:239]
    v_cvt_pk_f16_f32 v180, v218, v219
    v_cvt_pk_f16_f32 v181, v226, v227
    v_cvt_pk_f16_f32 v182, v234, v235
    v_cvt_pk_f16_f32 v183, v242, v243
    ds_write_b128 v207, v[180:183] offset:45056
    v_mfma_f32_16x16x32_bf16 v[244:247], v[164:167], v[144:147], 0
    v_mfma_f32_16x16x32_bf16 v[244:247], v[156:159], v[148:151], v[244:247]
    v_cvt_pk_f16_f32 v184, v220, v221
    v_cvt_pk_f16_f32 v185, v228, v229
    v_cvt_pk_f16_f32 v186, v236, v237
    s_nop 4
    v_cvt_pk_f16_f32 v187, v244, v245
    ds_write_b128 v207, v[184:187] offset:46080
    v_cvt_pk_f16_f32 v188, v222, v223
    v_cvt_pk_f16_f32 v189, v230, v231
    v_cvt_pk_f16_f32 v190, v238, v239
    v_cvt_pk_f16_f32 v191, v246, v247
    ds_write_b128 v207, v[188:191] offset:47104
    s_branch L_st1_done
L_st1_split:
    s_waitcnt lgkmcnt(8)
    ds_read_b64_tr_b16 v[144:145], v206 offset:96
    ds_read_b64_tr_b16 v[146:147], v206 offset:10464
    ds_read_b64_tr_b16 v[148:149], v206 offset:20832
    ds_read_b64_tr_b16 v[150:151], v206 offset:31200
    s_waitcnt lgkmcnt(0)
    v_mfma_f32_16x16x32_bf16 v[168:171], v[160:163], v[192:195], 0
    v_mfma_f32_16x16x32_bf16 v[220:223], v[164:167], v[120:123], 0
    v_mfma_f32_16x16x32_bf16 v[216:219], v[160:163], v[120:123], v[168:171]
    v_mfma_f32_16x16x32_bf16 v[228:231], v[164:167], v[128:131], 0
    v_mfma_f32_16x16x32_bf16 v[224:227], v[160:163], v[128:131], v[168:171]
    v_mfma_f32_16x16x32_bf16 v[236:239], v[164:167], v[136:139], 0
    v_mfma_f32_16x16x32_bf16 v[232:235], v[160:163], v[136:139], v[168:171]
    v_mfma_f32_16x16x32_bf16 v[244:247], v[164:167], v[144:147], 0
    v_mfma_f32_16x16x32_bf16 v[240:243], v[160:163], v[144:147], v[168:171]
    s_nop 1
    s_nop 0
    v_cvt_pk_f16_f32 v176, v216, v217
    v_cvt_pk_f16_f32 v180, v218, v219
    v_cvt_pk_f16_f32 v184, v220, v221
    v_cvt_pk_f16_f32 v188, v222, v223
    v_cvt_pk_f16_f32 v177, v224, v225
    v_cvt_pk_f16_f32 v181, v226, v227
    v_cvt_pk_f16_f32 v185, v228, v229
    v_cvt_pk_f16_f32 v189, v230, v231
    v_cvt_pk_f16_f32 v178, v232, v233
    v_cvt_pk_f16_f32 v182, v234, v235
    v_cvt_pk_f16_f32 v186, v236, v237
    v_cvt_pk_f16_f32 v190, v238, v239
    v_cvt_pk_f16_f32 v179, v240, v241
    v_cvt_pk_f16_f32 v183, v242, v243
    v_cvt_pk_f16_f32 v187, v244, v245
    v_cvt_pk_f16_f32 v191, v246, v247
    ds_write_b128 v207, v[176:179] offset:44032
    ds_write_b128 v207, v[180:183] offset:45056
    ds_write_b128 v207, v[184:187] offset:46080
    ds_write_b128 v207, v[188:191] offset:47104
    v_mfma_f32_16x16x32_bf16 v[168:171], v[152:155], v[196:199], 0
    v_mfma_f32_16x16x32_bf16 v[220:223], v[156:159], v[124:127], 0
    v_mfma_f32_16x16x32_bf16 v[216:219], v[152:155], v[124:127], v[168:171]
    v_mfma_f32_16x16x32_bf16 v[228:231], v[156:159], v[132:135], 0
    v_mfma_f32_16x16x32_bf16 v[224:227], v[152:155], v[132:135], v[168:171]
    v_mfma_f32_16x16x32_bf16 v[236:239], v[156:159], v[140:143], 0
    v_mfma_f32_16x16x32_bf16 v[232:235], v[152:155], v[140:143], v[168:171]
    v_mfma_f32_16x16x32_bf16 v[244:247], v[156:159], v[148:151], 0
    v_mfma_f32_16x16x32_bf16 v[240:243], v[152:155], v[148:151], v[168:171]
    s_waitcnt lgkmcnt(0)
    s_nop 0
    v_cvt_pk_f16_f32 v176, v216, v217
    v_cvt_pk_f16_f32 v180, v218, v219
    v_cvt_pk_f16_f32 v184, v220, v221
    v_cvt_pk_f16_f32 v188, v222, v223
    v_cvt_pk_f16_f32 v177, v224, v225
    v_cvt_pk_f16_f32 v181, v226, v227
    v_cvt_pk_f16_f32 v185, v228, v229
    v_cvt_pk_f16_f32 v189, v230, v231
    v_cvt_pk_f16_f32 v178, v232, v233
    v_cvt_pk_f16_f32 v182, v234, v235
    v_cvt_pk_f16_f32 v186, v236, v237
    v_cvt_pk_f16_f32 v190, v238, v239
    v_cvt_pk_f16_f32 v179, v240, v241
    v_cvt_pk_f16_f32 v183, v242, v243
    v_cvt_pk_f16_f32 v187, v244, v245
    v_cvt_pk_f16_f32 v191, v246, v247
    ds_write_b128 v207, v[176:179] offset:60416
    ds_write_b128 v207, v[180:183] offset:61440
    ds_write_b128 v207, v[184:187] offset:62464
    ds_write_b128 v207, v[188:191] offset:63488
L_st1_done:
    s_mov_b64 exec, 1
    ds_add_u32 v0, v255 offset:42824
    s_mov_b64 exec, -1
    s_lshl_b32 s31, s30, 12
    v_add_u32 v5, s31, v3
    s_and_b32 s31, s28, 0x30003
    v_mov_b32 v210, s31
    s_mov_b32 s58, 0xfffcfffc
    s_and_b32 s32, s48, 3
    s_cselect_b32 s72, -1, 0xff
    s_cselect_b32 s73, -1, 0
    s_mov_b32 s74, s48
    s_mov_b64 s[60:61], 0
    s_mov_b64 s[62:63], 0
    v_mov_b32 v209, 2147483392
    s_cmp_eq_u32 s48, 7
    s_cbranch_scc1 L_no_consts
    v_mul_f32 v250, v212, v251
    v_fmamk_f32 v68, v250, 0x3d800000, v252
    v_sin_f32 v36, v250
    v_cos_f32 v250, v250
    v_cos_f32 v64, v68
    v_sin_f32 v68, v68
    v_cvt_pk_f16_f32 v32, v250, v36
    v_cvt_pk_f16_f32 v36, -v36, v250
    v_mul_f32 v250, v213, v251
    v_fmamk_f32 v69, v250, 0x3d800000, v252
    v_sin_f32 v37, v250
    v_cos_f32 v250, v250
    v_cos_f32 v65, v69
    v_sin_f32 v69, v69
    v_cvt_pk_f16_f32 v33, v250, v37
    v_cvt_pk_f16_f32 v37, -v37, v250
    v_mul_f32 v250, v214, v251
    v_fmamk_f32 v70, v250, 0x3d800000, v252
    v_sin_f32 v38, v250
    v_cos_f32 v250, v250
    v_cos_f32 v66, v70
    v_sin_f32 v70, v70
    v_cvt_pk_f16_f32 v34, v250, v38
    v_cvt_pk_f16_f32 v38, -v38, v250
    v_mul_f32 v250, v215, v251
    v_fmamk_f32 v71, v250, 0x3d800000, v252
    v_sin_f32 v39, v250
    v_cos_f32 v250, v250
    v_cos_f32 v67, v71
    v_sin_f32 v71, v71
    v_cvt_pk_f16_f32 v35, v250, v39
    v_cvt_pk_f16_f32 v39, -v39, v250
    v_add_f32 v251, 1.0, v251
    v_mul_f32 v250, v212, v251
    v_fmamk_f32 v76, v250, 0x3d800000, v252
    v_sin_f32 v44, v250
    v_cos_f32 v250, v250
    v_cos_f32 v72, v76
    v_sin_f32 v76, v76
    v_cvt_pk_f16_f32 v40, v250, v44
    v_cvt_pk_f16_f32 v44, -v44, v250
    v_mul_f32 v250, v213, v251
    v_fmamk_f32 v77, v250, 0x3d800000, v252
    v_sin_f32 v45, v250
    v_cos_f32 v250, v250
    v_cos_f32 v73, v77
    v_sin_f32 v77, v77
    v_cvt_pk_f16_f32 v41, v250, v45
    v_cvt_pk_f16_f32 v45, -v45, v250
    v_mul_f32 v250, v214, v251
    v_fmamk_f32 v78, v250, 0x3d800000, v252
    v_sin_f32 v46, v250
    v_cos_f32 v250, v250
    v_cos_f32 v74, v78
    v_sin_f32 v78, v78
    v_cvt_pk_f16_f32 v42, v250, v46
    v_cvt_pk_f16_f32 v46, -v46, v250
    v_mul_f32 v250, v215, v251
    v_fmamk_f32 v79, v250, 0x3d800000, v252
    v_sin_f32 v47, v250
    v_cos_f32 v250, v250
    v_cos_f32 v75, v79
    v_sin_f32 v79, v79
    v_cvt_pk_f16_f32 v43, v250, v47
    v_cvt_pk_f16_f32 v47, -v47, v250
    s_and_b32 s31, s46, 1
    s_lshl_b32 s31, s31, 6
    s_lshr_b32 s32, s46, 1
    s_add_u32 s49, s31, s32
    s_bitcmp1_b32 s49, 2
    s_cselect_b64 vcc, -1, 0
    v_cndmask_b32 v80, v16, v20, vcc
    v_cndmask_b32 v84, v20, v16, vcc
    v_cndmask_b32 v81, v17, v21, vcc
    v_cndmask_b32 v85, v21, v17, vcc
    v_cndmask_b32 v82, v18, v22, vcc
    v_cndmask_b32 v86, v22, v18, vcc
    v_cndmask_b32 v83, v19, v23, vcc
    v_cndmask_b32 v87, v23, v19, vcc
    s_bfe_u32 s31, s49, 0x10001
    v_and_b32 v6, 7, v2
    v_xor_b32 v6, s31, v6
    v_lshlrev_b32 v6, 4, v6
    v_lshrrev_b32 v7, 4, v2
    v_lshlrev_b32 v7, 3, v7
    v_bfe_u32 v209, v2, 3, 1
    v_add_u32 v7, v7, v209
    v_mul_u32_u24 v7, 16512, v7
    v_add_u32 v209, v6, v7
    s_mul_i32 s31, s48, 528384
    s_lshl_b32 s32, s49, 7
    s_add_u32 s31, s31, s32
    s_add_u32 s60, s31, 2097152
L_no_consts:
L_st23:
L_sync3:
    ds_read_b32 v1, v0 offset:42824
    ds_read_b128 v[120:123], v5 offset:44032
    ds_read_b128 v[124:127], v5 offset:45056
    ds_read_b128 v[128:131], v5 offset:46080
    ds_read_b128 v[132:135], v5 offset:47104
    s_waitcnt lgkmcnt(4)
    v_readfirstlane_b32 s31, v1
    s_nop 0
    s_cmp_ge_u32 s31, 4
    s_cbranch_scc0 L_sync3
    s_cmp_eq_u32 s48, 7
    s_cbranch_scc1 L_p1_done
    s_add_u32 s61, s60, 33024
    s_add_u32 s62, s61, 33024
    s_add_u32 s63, s62, 33024
    s_waitcnt lgkmcnt(3)
    v_mfma_f32_16x16x32_f16 v[136:139], v[120:123], v[16:19], 0
    v_mfma_f32_16x16x32_f16 v[140:143], v[120:123], v[20:23], 0
    s_waitcnt lgkmcnt(2)
    v_mfma_f32_16x16x32_f16 v[144:147], v[124:127], v[24:27], 0
    v_mfma_f32_16x16x32_f16 v[148:151], v[124:127], v[28:31], 0
    s_nop 3
    v_pk_mul_f32 v[152:153], v[48:49], v[136:137]
    v_pk_mul_f32 v[154:155], v[50:51], v[138:139]
    v_pk_mul_f32 v[156:157], v[52:53], v[136:137]
    v_pk_mul_f32 v[158:159], v[54:55], v[138:139]
    v_pk_fma_f32 v[152:153], v[52:53], v[140:141], v[152:153]
    v_pk_fma_f32 v[156:157], v[48:49], v[140:141], v[156:157] neg_lo:[0,0,1] neg_hi:[0,0,1]
    v_pk_fma_f32 v[154:155], v[54:55], v[142:143], v[154:155]
    v_pk_fma_f32 v[158:159], v[50:51], v[142:143], v[158:159] neg_lo:[0,0,1] neg_hi:[0,0,1]
    v_cvt_pk_f16_f32 v120, v152, v156
    v_cvt_pk_f16_f32 v121, v153, v157
    v_cvt_pk_f16_f32 v122, v154, v158
    v_cvt_pk_f16_f32 v123, v155, v159
    s_waitcnt lgkmcnt(1)
    s_nop 0
    v_mfma_f32_16x16x32_f16 v[136:139], v[128:131], v[32:35], 0
    v_mfma_f32_16x16x32_f16 v[140:143], v[128:131], v[36:39], 0
    v_mfma_f32_16x16x32_f16 v[216:219], v[80:83], v[120:123], 0
    v_mfma_f32_16x16x32_f16 v[220:223], v[84:87], v[120:123], 0
    v_pk_mul_f32 v[152:153], v[56:57], v[144:145]
    v_pk_mul_f32 v[154:155], v[58:59], v[146:147]
    v_pk_mul_f32 v[156:157], v[60:61], v[144:145]
    v_pk_mul_f32 v[158:159], v[62:63], v[146:147]
    v_pk_fma_f32 v[152:153], v[60:61], v[148:149], v[152:153]
    v_pk_fma_f32 v[156:157], v[56:57], v[148:149], v[156:157] neg_lo:[0,0,1] neg_hi:[0,0,1]
    v_pk_fma_f32 v[154:155], v[62:63], v[150:151], v[154:155]
    v_pk_fma_f32 v[158:159], v[58:59], v[150:151], v[158:159] neg_lo:[0,0,1] neg_hi:[0,0,1]
    v_cvt_pk_f16_f32 v124, v152, v156
    v_cvt_pk_f16_f32 v125, v153, v157
    v_cvt_pk_f16_f32 v126, v154, v158
    v_cvt_pk_f16_f32 v127, v155, v159
    s_waitcnt lgkmcnt(0)
    s_nop 0
    v_mfma_f32_16x16x32_f16 v[144:147], v[132:135], v[40:43], 0
    v_mfma_f32_16x16x32_f16 v[148:151], v[132:135], v[44:47], 0
    v_mfma_f32_16x16x32_f16 v[224:227], v[80:83], v[124:127], 0
    v_mfma_f32_16x16x32_f16 v[228:231], v[84:87], v[124:127], 0
    v_pk_mul_f32 v[152:153], v[64:65], v[136:137]
    v_pk_mul_f32 v[154:155], v[66:67], v[138:139]
    v_pk_mul_f32 v[156:157], v[68:69], v[136:137]
    v_pk_mul_f32 v[158:159], v[70:71], v[138:139]
    v_pk_fma_f32 v[152:153], v[68:69], v[140:141], v[152:153]
    v_pk_fma_f32 v[156:157], v[64:65], v[140:141], v[156:157] neg_lo:[0,0,1] neg_hi:[0,0,1]
    v_pk_fma_f32 v[154:155], v[70:71], v[142:143], v[154:155]
    v_pk_fma_f32 v[158:159], v[66:67], v[142:143], v[158:159] neg_lo:[0,0,1] neg_hi:[0,0,1]
    v_cvt_pk_f16_f32 v128, v152, v156
    v_cvt_pk_f16_f32 v129, v153, v157
    v_cvt_pk_f16_f32 v130, v154, v158
    v_cvt_pk_f16_f32 v131, v155, v159
    s_nop 1
    s_nop 0
    v_mfma_f32_16x16x32_f16 v[232:235], v[80:83], v[128:131], 0
    v_mfma_f32_16x16x32_f16 v[236:239], v[84:87], v[128:131], 0
    v_pk_mul_f32 v[152:153], v[72:73], v[144:145]
    v_pk_mul_f32 v[154:155], v[74:75], v[146:147]
    v_pk_mul_f32 v[156:157], v[76:77], v[144:145]
    v_pk_mul_f32 v[158:159], v[78:79], v[146:147]
    v_pk_fma_f32 v[152:153], v[76:77], v[148:149], v[152:153]
    v_pk_fma_f32 v[156:157], v[72:73], v[148:149], v[156:157] neg_lo:[0,0,1] neg_hi:[0,0,1]
    v_pk_fma_f32 v[154:155], v[78:79], v[150:151], v[154:155]
    v_pk_fma_f32 v[158:159], v[74:75], v[150:151], v[158:159] neg_lo:[0,0,1] neg_hi:[0,0,1]
    v_cvt_pk_f16_f32 v132, v152, v156
    v_cvt_pk_f16_f32 v133, v153, v157
    v_cvt_pk_f16_f32 v134, v154, v158
    v_cvt_pk_f16_f32 v135, v155, v159
    s_nop 1
    s_nop 0
    v_mfma_f32_16x16x32_f16 v[240:243], v[80:83], v[132:135], 0
    v_mfma_f32_16x16x32_f16 v[244:247], v[84:87], v[132:135], 0
    v_cvt_pk_f16_f32 v176, v216, v224
    v_cvt_pk_f16_f32 v178, v220, v228
    v_and_or_b32 v176, v176, s58, v210
    v_and_or_b32 v178, v178, s58, v210
    v_cvt_pk_f16_f32 v180, v217, v225
    v_cvt_pk_f16_f32 v182, v221, v229
    v_and_or_b32 v180, v180, s58, v210
    v_and_or_b32 v182, v182, s58, v210
    v_cvt_pk_f16_f32 v184, v218, v226
    v_cvt_pk_f16_f32 v186, v222, v230
    v_and_or_b32 v184, v184, s58, v210
    v_and_or_b32 v186, v186, s58, v210
    v_cvt_pk_f16_f32 v188, v219, v227
    v_cvt_pk_f16_f32 v190, v223, v231
    v_and_or_b32 v188, v188, s58, v210
    v_and_or_b32 v190, v190, s58, v210
    v_cvt_pk_f16_f32 v177, v232, v240
    v_cvt_pk_f16_f32 v179, v236, v244
    v_and_or_b32 v177, v177, s58, v210
    v_and_or_b32 v179, v179, s58, v210
    v_cvt_pk_f16_f32 v181, v233, v241
    v_cvt_pk_f16_f32 v183, v237, v245
    v_and_or_b32 v181, v181, s58, v210
    v_and_or_b32 v183, v183, s58, v210
    v_cvt_pk_f16_f32 v185, v234, v242
    v_cvt_pk_f16_f32 v187, v238, v246
    v_and_or_b32 v185, v185, s58, v210
    v_and_or_b32 v187, v187, s58, v210
    v_cvt_pk_f16_f32 v189, v235, v243
    v_cvt_pk_f16_f32 v191, v239, v247
    v_and_or_b32 v189, v189, s58, v210
    v_and_or_b32 v191, v191, s58, v210
    s_cmp_eq_u32 s50, 0
    s_cbranch_scc1 L_p1_done
    s_mov_b32 exec_hi, s72
    buffer_store_dwordx4 v[176:179], v209, s[12:15], s60 offen sc1
    s_mov_b32 exec_hi, s73
    buffer_store_dwordx4 v[180:183], v209, s[12:15], s61 offen sc1
    buffer_store_dwordx4 v[184:187], v209, s[12:15], s62 offen sc1
    buffer_store_dwordx4 v[188:191], v209, s[12:15], s63 offen sc1
    s_mov_b32 exec_hi, -1
    s_mov_b32 s50, 0
    s_add_u32 s60, s60, 16384
    v_add_u32 v5, 16384, v5
    s_sub_u32 s31, s48, 4
    v_cvt_f32_i32 v252, s31
    v_mul_f32 v252, 0x3d800000, v252
    v_and_b32 v251, 15, v2
    v_lshlrev_b32 v251, 2, v251
    v_cvt_f32_u32 v251, v251
    v_fma_f32 v250, v212, v251, v252
    v_sin_f32 v84, v250
    v_cos_f32 v250, v250
    s_nop 0
    v_cvt_pk_f16_f32 v80, v250, v84
    v_cvt_pk_f16_f32 v84, -v84, v250
    v_fma_f32 v250, v213, v251, v252
    v_sin_f32 v85, v250
    v_cos_f32 v250, v250
    s_nop 0
    v_cvt_pk_f16_f32 v81, v250, v85
    v_cvt_pk_f16_f32 v85, -v85, v250
    v_fma_f32 v250, v214, v251, v252
    v_sin_f32 v86, v250
    v_cos_f32 v250, v250
    s_nop 0
    v_cvt_pk_f16_f32 v82, v250, v86
    v_cvt_pk_f16_f32 v86, -v86, v250
    v_fma_f32 v250, v215, v251, v252
    v_sin_f32 v87, v250
    v_cos_f32 v250, v250
    s_nop 0
    v_cvt_pk_f16_f32 v83, v250, v87
    v_cvt_pk_f16_f32 v87, -v87, v250
    s_branch L_st23
L_p1_done:
    s_mov_b64 exec, 1
    ds_add_u32 v0, v255 offset:42828
    s_mov_b64 exec, -1
    s_setprio 0
    v_mov_b32 v4, v112
    v_mov_b32 v5, v113
    v_mov_b32 v249, v114
    v_mov_b32 v205, v115
    v_mov_b32 v248, v116
    v_mov_b32 v208, v117
    v_mov_b32 v7, v118
    v_mov_b32 v6, v119
    s_and_b32 s31, s2, 7
    s_sub_u32 s32, 8, s31
    s_min_u32 s46, s31, s32
    s_lshr_b32 s53, s31, 2
    s_lshr_b32 s47, s2, 3
    s_and_b32 s32, s47, 1
    s_and_b32 s31, s31, 3
    s_cselect_b32 s53, s53, s32
    s_cselect_b32 s31, 0, 1
    s_lshr_b32 s47, s47, s31
    s_lshl_b32 s53, s53, 4
    s_lshl_b32 s31, s30, 5
    s_add_u32 s53, s53, s31
    s_lshl_b32 s48, s46, 1
    s_add_u32 s48, s48, 2040
    s_mov_b32 s49, 32768
    v_mov_b32 v212, v210
    v_mov_b32 v213, v210
    v_mov_b32 v214, v210
    v_mov_b32 v215, v210
    s_cmp_ge_u32 s2, 224
    s_cbranch_scc1 L_zst_go
L_sync4:
    ds_read_b32 v1, v0 offset:42840
    s_waitcnt lgkmcnt(0)
    v_readfirstlane_b32 s31, v1
    s_nop 0
    s_cmp_ge_u32 s31, 1
    s_cbranch_scc0 L_sync4
L_zst_go:
    s_mov_b32 exec_hi, s72
    buffer_store_dwordx4 v[176:179], v209, s[12:15], s60 offen sc1
    s_mov_b32 exec_hi, s73
    buffer_store_dwordx4 v[180:183], v209, s[12:15], s61 offen sc1
    buffer_store_dwordx4 v[184:187], v209, s[12:15], s62 offen sc1
    buffer_store_dwordx4 v[188:191], v209, s[12:15], s63 offen sc1
    s_mov_b32 exec_hi, -1
L_sync5:
    ds_read_b32 v1, v0 offset:42860
    s_waitcnt lgkmcnt(0)
    v_readfirstlane_b32 s31, v1
    s_nop 0
    s_cmp_ge_u32 s31, 1
    s_cbranch_scc0 L_sync5
    buffer_load_dwordx4 v[24:27], v6, s[12:15], s49 offen
    s_add_u32 m0, s76, 0
    s_nop 0
    buffer_load_dwordx4 v4, s[8:11], 0 offen lds
    s_add_u32 m0, s76, 1024
    s_nop 0
    buffer_load_dwordx4 v5, s[8:11], 0 offen lds
    v_and_b32 v160, 15, v2
    v_add_u32 v160, s53, v160
    v_cvt_f32_u32 v160, v160
    v_add_f32 v160, 0.5, v160
    v_mul_f32 v160, 0x3b800000, v160
    v_and_b32 v161, 32, v2
    v_bfe_u32 v162, v2, 4, 1
    v_lshl_add_u32 v161, v162, 3, v161
    v_cvt_f32_u32 v161, v161
    v_mul_f32 v161, v161, v160
    v_fmamk_f32 v88, v160, 0x0, v161
    v_fmamk_f32 v162, v160, 0x40000000, v161
    v_sin_f32 v104, v88
    v_sin_f32 v163, v162
    v_cos_f32 v88, v88
    v_cos_f32 v162, v162
    v_cvt_pk_f16_f32 v104, v104, v163
    v_cvt_pk_f16_f32 v88, v88, v162
    v_fmamk_f32 v89, v160, 0x40800000, v161
    v_fmamk_f32 v162, v160, 0x40c00000, v161
    v_sin_f32 v105, v89
    v_sin_f32 v163, v162
    v_cos_f32 v89, v89
    v_cos_f32 v162, v162
    v_cvt_pk_f16_f32 v105, v105, v163
    v_cvt_pk_f16_f32 v89, v89, v162
    v_fmamk_f32 v90, v160, 0x41800000, v161
    v_fmamk_f32 v162, v160, 0x41900000, v161
    v_sin_f32 v106, v90
    v_sin_f32 v163, v162
    v_cos_f32 v90, v90
    v_cos_f32 v162, v162
    v_cvt_pk_f16_f32 v106, v106, v163
    v_cvt_pk_f16_f32 v90, v90, v162
    v_fmamk_f32 v91, v160, 0x41a00000, v161
    v_fmamk_f32 v162, v160, 0x41b00000, v161
    v_sin_f32 v107, v91
    v_sin_f32 v163, v162
    v_cos_f32 v91, v91
    v_cos_f32 v162, v162
    v_cvt_pk_f16_f32 v107, v107, v163
    v_cvt_pk_f16_f32 v91, v91, v162
    v_fmamk_f32 v92, v160, 0x42800000, v161
    v_fmamk_f32 v162, v160, 0x42840000, v161
    v_sin_f32 v108, v92
    v_sin_f32 v163, v162
    v_cos_f32 v92, v92
    v_cos_f32 v162, v162
    v_cvt_pk_f16_f32 v108, v108, v163
    v_cvt_pk_f16_f32 v92, v92, v162
    v_fmamk_f32 v93, v160, 0x42880000, v161
    v_fmamk_f32 v162, v160, 0x428c0000, v161
    v_sin_f32 v109, v93
    v_sin_f32 v163, v162
    v_cos_f32 v93, v93
    v_cos_f32 v162, v162
    v_cvt_pk_f16_f32 v109, v109, v163
    v_cvt_pk_f16_f32 v93, v93, v162
    v_fmamk_f32 v94, v160, 0x42a00000, v161
    v_fmamk_f32 v162, v160, 0x42a40000, v161
    v_sin_f32 v110, v94
    v_sin_f32 v163, v162
    v_cos_f32 v94, v94
    v_cos_f32 v162, v162
    v_cvt_pk_f16_f32 v110, v110, v163
    v_cvt_pk_f16_f32 v94, v94, v162
    v_fmamk_f32 v95, v160, 0x42a80000, v161
    v_fmamk_f32 v162, v160, 0x42ac0000, v161
    v_sin_f32 v111, v95
    v_sin_f32 v163, v162
    v_cos_f32 v95, v95
    v_cos_f32 v162, v162
    v_cvt_pk_f16_f32 v111, v111, v163
    v_cvt_pk_f16_f32 v95, v95, v162
    v_fmamk_f32 v96, v160, 0x3f800000, v161
    v_fmamk_f32 v162, v160, 0x40400000, v161
    v_sin_f32 v112, v96
    v_sin_f32 v163, v162
    v_cos_f32 v96, v96
    v_cos_f32 v162, v162
    v_cvt_pk_f16_f32 v112, v112, v163
    v_cvt_pk_f16_f32 v96, v96, v162
    v_fmamk_f32 v97, v160, 0x40a00000, v161
    v_fmamk_f32 v162, v160, 0x40e00000, v161
    v_sin_f32 v113, v97
    v_sin_f32 v163, v162
    v_cos_f32 v97, v97
    v_cos_f32 v162, v162
    v_cvt_pk_f16_f32 v113, v113, v163
    v_cvt_pk_f16_f32 v97, v97, v162
    v_fmamk_f32 v98, v160, 0x41880000, v161
    v_fmamk_f32 v162, v160, 0x41980000, v161
    v_sin_f32 v114, v98
    v_sin_f32 v163, v162
    v_cos_f32 v98, v98
    v_cos_f32 v162, v162
    v_cvt_pk_f16_f32 v114, v114, v163
    v_cvt_pk_f16_f32 v98, v98, v162
    v_fmamk_f32 v99, v160, 0x41a80000, v161
    v_fmamk_f32 v162, v160, 0x41b80000, v161
    v_sin_f32 v115, v99
    v_sin_f32 v163, v162
    v_cos_f32 v99, v99
    v_cos_f32 v162, v162
    v_cvt_pk_f16_f32 v115, v115, v163
    v_cvt_pk_f16_f32 v99, v99, v162
    v_fmamk_f32 v100, v160, 0x42820000, v161
    v_fmamk_f32 v162, v160, 0x42860000, v161
    v_sin_f32 v116, v100
    v_sin_f32 v163, v162
    v_cos_f32 v100, v100
    v_cos_f32 v162, v162
    v_cvt_pk_f16_f32 v116, v116, v163
    v_cvt_pk_f16_f32 v100, v100, v162
    v_fmamk_f32 v101, v160, 0x428a0000, v161
    v_fmamk_f32 v162, v160, 0x428e0000, v161
    v_sin_f32 v117, v101
    v_sin_f32 v163, v162
    v_cos_f32 v101, v101
    v_cos_f32 v162, v162
    v_cvt_pk_f16_f32 v117, v117, v163
    v_cvt_pk_f16_f32 v101, v101, v162
    v_fmamk_f32 v102, v160, 0x42a20000, v161
    v_fmamk_f32 v162, v160, 0x42a60000, v161
    v_sin_f32 v118, v102
    v_sin_f32 v163, v162
    v_cos_f32 v102, v102
    v_cos_f32 v162, v162
    v_cvt_pk_f16_f32 v118, v118, v163
    v_cvt_pk_f16_f32 v102, v102, v162
    v_fmamk_f32 v103, v160, 0x42aa0000, v161
    v_fmamk_f32 v162, v160, 0x42ae0000, v161
    v_sin_f32 v119, v103
    v_sin_f32 v163, v162
    v_cos_f32 v103, v103
    v_cos_f32 v162, v162
    v_cvt_pk_f16_f32 v119, v119, v163
    v_cvt_pk_f16_f32 v103, v103, v162
    v_cmp_gt_u32 vcc, 16, v2
    v_and_b32 v162, 1, v2
    v_lshlrev_b32 v162, 15, v162
    v_or_b32 v162, 0x3c00, v162
    v_and_b32 v160, 0xffff0000, v104
    v_or_b32 v162, v162, v160
    v_cndmask_b32 v104, v104, v162, vcc
    s_mul_i32 s51, s46, 528384
    s_add_u32 s51, s51, 2097152
    s_mul_i32 s54, s47, 16512
    s_lshl_b32 s32, s30, 12
    s_add_u32 s50, s51, s54
    s_add_u32 s50, s50, s32
    s_add_u32 s55, s47, 1
    s_and_b32 s55, s55, 31
    s_mul_i32 s55, s55, 16512
    v_add_u32 v250, s32, v3
    v_add_u32 v199, s76, v3
    v_lshl_add_u32 v200, v2, 7, s32
    v_and_b32 v1, 2, v2
    v_lshl_add_u32 v200, v1, 3, v200
    v_and_b32 v1, 0x70, v3
    v_add_u32 v1, 16384, v1
    s_mov_b32 vcc_lo, 0
    s_mov_b32 vcc_hi, -1
    v_cndmask_b32 v200, v200, v1, vcc
    s_mov_b32 vcc_hi, 0xff
    v_mov_b32 v1, s55
    v_mov_b32 v201, s54
    v_cndmask_b32 v1, v1, v201, vcc
    v_mov_b32 v201, 16640
    v_cndmask_b32 v201, v201, v0, vcc
    v_add_u32 v201, v201, v200
    v_add_u32 v200, v1, v200
    v_lshrrev_b32 v251, 5, v2
    v_lshlrev_b32 v251, 11, v251
    v_bfe_u32 v1, v2, 2, 3
    v_lshl_add_u32 v251, v1, 7, v251
    v_and_b32 v1, 3, v2
    v_lshl_add_u32 v251, v1, 5, v251
    v_bfe_u32 v1, v2, 3, 1
    v_lshl_add_u32 v251, v1, 4, v251
    v_bfe_u32 v1, v2, 4, 1
    v_lshl_add_u32 v251, v1, 3, v251
    v_xor_b32 v252, 16, v251
    v_xor_b32 v253, 8, v251
    v_xor_b32 v254, 24, v251
    v_cmp_gt_u32 vcc, 4, v2
    v_mov_b32 v1, 16384
    s_nop 0
    v_cndmask_b32 v1, v0, v1, vcc
    v_add_u32 v206, v253, v1
    v_add_u32 v207, v254, v1
    s_mov_b32 vcc_lo, 0x88888888
    s_mov_b32 vcc_hi, 0x88888888
    v_mov_b32 v1, 16544
    v_cndmask_b32 v1, 32, v1, vcc
    v_add_u32 v202, v251, v1
    v_add_u32 v203, v253, v1
    v_add_u32 v204, v206, v1
    s_waitcnt vmcnt(0)
L_stat_check:
    v_cmp_ne_u64 vcc, s[28:29], v[26:27]
    s_nop 0
    s_cbranch_vccz L_stat_got
    s_cmp_eq_u32 s35, 0
    s_cbranch_scc1 L_stat_got
    s_sub_u32 s35, s35, 1
    s_sleep 2
    s_mov_b64 exec, vcc
    buffer_load_dwordx4 v[24:27], v6, s[12:15], s49 offen sc1
    s_mov_b64 exec, -1
    s_waitcnt vmcnt(0)
    s_branch L_stat_check
L_stat_got:
    v_cndmask_b32 v24, v24, v25, s[88:89]
    v_mov_b32 v32, v24
    s_nop 1
    v_permlane32_swap_b32 v24, v32
    v_mov_b32 v28, v24
    v_mov_b32 v36, v32
    s_nop 0
    v_permlane16_swap_b32 v24, v28
    v_permlane16_swap_b32 v32, v36
    v_lshlrev_b32 v26, 16, v24
    v_and_b32 v24, 0xffff0000, v24
    v_rcp_f32 v24, v24
    v_lshlrev_b32 v30, 16, v28
    v_and_b32 v28, 0xffff0000, v28
    v_rcp_f32 v28, v28
    v_lshlrev_b32 v34, 16, v32
    v_and_b32 v32, 0xffff0000, v32
    v_rcp_f32 v32, v32
    v_lshlrev_b32 v38, 16, v36
    v_and_b32 v36, 0xffff0000, v36
    v_rcp_f32 v36, v36
    v_mul_f32 v24, 0xbfb8aa3b, v24
    v_mul_f32_e64 v26, -v26, v24
    v_mul_f32 v28, 0xbfb8aa3b, v28
    v_mul_f32_e64 v30, -v30, v28
    v_mul_f32 v32, 0xbfb8aa3b, v32
    v_mul_f32_e64 v34, -v34, v32
    v_mul_f32 v36, 0xbfb8aa3b, v36
    v_mul_f32_e64 v38, -v38, v36
    ds_read_b128 v[8:11], v208 offset:0
    ds_read_b128 v[12:15], v208 offset:1024
    s_waitcnt lgkmcnt(0)
    v_lshlrev_b32 v40, 16, v8
    v_and_b32 v41, 0xffff0000, v8
    v_lshlrev_b32 v42, 16, v9
    v_and_b32 v43, 0xffff0000, v9
    v_lshlrev_b32 v44, 16, v10
    v_and_b32 v45, 0xffff0000, v10
    v_lshlrev_b32 v46, 16, v11
    v_and_b32 v47, 0xffff0000, v11
    v_lshlrev_b32 v48, 16, v12
    v_and_b32 v55, 0xffff0000, v12
    v_lshlrev_b32 v54, 16, v13
    v_and_b32 v53, 0xffff0000, v13
    v_lshlrev_b32 v52, 16, v14
    v_and_b32 v51, 0xffff0000, v14
    v_lshlrev_b32_e64 v50, 16, v15
    v_and_b32 v49, 0xffff0000, v15
    v_pk_fma_f32 v[120:121], v[40:41], v[24:25], v[26:27] op_sel_hi:[1,0,0]
    v_pk_fma_f32 v[122:123], v[42:43], v[24:25], v[26:27] op_sel_hi:[1,0,0]
    v_pk_fma_f32 v[124:125], v[44:45], v[24:25], v[26:27] op_sel_hi:[1,0,0]
    v_pk_fma_f32 v[126:127], v[46:47], v[24:25], v[26:27] op_sel_hi:[1,0,0]
    v_pk_fma_f32 v[128:129], v[48:49], v[28:29], v[30:31] op_sel_hi:[1,0,0]
    v_pk_fma_f32 v[130:131], v[50:51], v[28:29], v[30:31] op_sel_hi:[1,0,0]
    v_pk_fma_f32 v[132:133], v[52:53], v[28:29], v[30:31] op_sel_hi:[1,0,0]
    v_pk_fma_f32 v[134:135], v[54:55], v[28:29], v[30:31] op_sel_hi:[1,0,0]
    v_exp_f32 v216, v120
    v_exp_f32 v217, v121
    v_exp_f32 v218, v122
    v_exp_f32 v219, v123
    v_exp_f32 v220, v124
    v_exp_f32 v221, v125
    v_exp_f32 v222, v126
    v_exp_f32 v223, v127
    v_exp_f32 v224, v128
    v_exp_f32 v225, v129
    v_exp_f32 v226, v130
    v_exp_f32 v227, v131
    v_exp_f32 v228, v132
    v_exp_f32 v229, v133
    v_exp_f32 v230, v134
    v_exp_f32 v231, v135
    v_pk_add_f32 v[216:217], v[216:217], 1.0 op_sel_hi:[1,0]
    v_pk_add_f32 v[218:219], v[218:219], 1.0 op_sel_hi:[1,0]
    v_pk_add_f32 v[220:221], v[220:221], 1.0 op_sel_hi:[1,0]
    v_pk_add_f32 v[222:223], v[222:223], 1.0 op_sel_hi:[1,0]
    v_pk_add_f32 v[224:225], v[224:225], 1.0 op_sel_hi:[1,0]
    v_pk_add_f32 v[226:227], v[226:227], 1.0 op_sel_hi:[1,0]
    v_pk_add_f32 v[228:229], v[228:229], 1.0 op_sel_hi:[1,0]
    v_pk_add_f32 v[230:231], v[230:231], 1.0 op_sel_hi:[1,0]
    v_rcp_f32 v216, v216
    v_rcp_f32 v217, v217
    v_rcp_f32 v218, v218
    v_rcp_f32 v219, v219
    v_rcp_f32 v220, v220
    v_rcp_f32 v221, v221
    v_rcp_f32 v222, v222
    v_rcp_f32 v223, v223
    v_rcp_f32 v224, v224
    v_rcp_f32 v225, v225
    v_rcp_f32 v226, v226
    v_rcp_f32 v227, v227
    v_rcp_f32 v228, v228
    v_rcp_f32 v229, v229
    v_rcp_f32 v230, v230
    v_rcp_f32 v231, v231
    v_pk_mul_f32 v[120:121], v[120:121], v[216:217]
    v_pk_mul_f32 v[122:123], v[122:123], v[218:219]
    v_pk_mul_f32 v[124:125], v[124:125], v[220:221]
    v_pk_mul_f32 v[126:127], v[126:127], v[222:223]
    v_pk_mul_f32 v[128:129], v[128:129], v[224:225]
    v_pk_mul_f32 v[130:131], v[130:131], v[226:227]
    v_pk_mul_f32 v[132:133], v[132:133], v[228:229]
    v_pk_mul_f32 v[134:135], v[134:135], v[230:231]
L_sync6:
    ds_read_b32 v1, v0 offset:42848
    s_waitcnt lgkmcnt(0)
    v_readfirstlane_b32 s31, v1
    s_nop 0
    s_cmp_ge_u32 s31, 4
    s_cbranch_scc0 L_sync6
    s_add_u32 m0, s76, 2048
    s_nop 0
    buffer_load_dwordx4 v249, s[8:11], 0 offen lds
    s_add_u32 m0, s76, 3072
    s_nop 0
    buffer_load_dwordx4 v205, s[8:11], 0 offen lds
L_sync7:
    ds_read_b32 v1, v0 offset:42844
    ds_read_b32 v198, v0 offset:41556
    s_waitcnt lgkmcnt(1)
    v_readfirstlane_b32 s31, v1
    s_nop 0
    s_cmp_ge_u32 s31, 1
    s_cbranch_scc0 L_sync7
    v_and_b32 v6, 48, v2
    v_lshlrev_b32 v6, 1, v6
    v_mov_b32 v209, 2147483392
    s_waitcnt lgkmcnt(0)
    v_readfirstlane_b32 s33, v198
    s_nop 0
    s_andn2_b32 s33, 0x7ff, s33
    s_sub_u32 s31, 0, s33
    s_and_b32 s31, s31, 2047
    s_sub_u32 s32, s33, 1024
    s_sub_u32 s34, s31, 1024
    v_cmp_eq_u32 vcc, s33, v7
    v_cmp_eq_u32 s[54:55], s33, v248
    s_nop 0
    v_cndmask_b32 v4, v4, v209, vcc
    v_cmp_eq_u32 vcc, s31, v7
    v_cmp_eq_u32 s[56:57], s31, v248
    s_nop 0
    v_cndmask_b32 v5, v5, v209, vcc
    v_cmp_eq_u32 vcc, s32, v7
    v_cmp_eq_u32 s[58:59], s32, v248
    s_nop 0
    v_cndmask_b32 v249, v249, v209, vcc
    v_cmp_eq_u32 vcc, s34, v7
    v_cmp_eq_u32 s[60:61], s34, v248
    s_nop 0
    v_cndmask_b32 v205, v205, v209, vcc
    s_or_b64 s[62:63], s[54:55], s[58:59]
    s_or_b64 s[64:65], s[56:57], s[60:61]
    s_waitcnt vmcnt(0)
    buffer_load_dwordx4 v[72:75], v3, s[12:15], s50 offen offset:0 sc1
    buffer_load_dwordx4 v[76:79], v3, s[12:15], s50 offen offset:1024 sc1
    buffer_load_dwordx4 v[80:83], v3, s[12:15], s50 offen offset:2048 sc1
    buffer_load_dwordx4 v[84:87], v3, s[12:15], s50 offen offset:3072 sc1
    s_mov_b32 exec_hi, 0x1ff
    buffer_load_dwordx4 v[212:215], v200, s[12:15], s51 offen sc1
    s_mov_b32 exec_hi, -1
    s_setprio 2
    ds_read_b128 v[16:19], v208 offset:2048
    ds_read_b128 v[20:23], v208 offset:3072
    s_waitcnt lgkmcnt(0)
    v_lshlrev_b32 v56, 16, v16
    v_and_b32 v57, 0xffff0000, v16
    v_lshlrev_b32 v58, 16, v17
    v_and_b32 v59, 0xffff0000, v17
    v_lshlrev_b32 v60, 16, v18
    v_and_b32 v61, 0xffff0000, v18
    v_lshlrev_b32 v62, 16, v19
    v_and_b32 v63, 0xffff0000, v19
    v_lshlrev_b32 v64, 16, v20
    v_and_b32 v71, 0xffff0000, v20
    v_lshlrev_b32 v70, 16, v21
    v_and_b32 v69, 0xffff0000, v21
    v_lshlrev_b32 v68, 16, v22
    v_and_b32 v67, 0xffff0000, v22
    v_lshlrev_b32 v66, 16, v23
    v_and_b32 v65, 0xffff0000, v23
    v_pk_fma_f32 v[136:137], v[56:57], v[32:33], v[34:35] op_sel_hi:[1,0,0]
    v_pk_fma_f32 v[138:139], v[58:59], v[32:33], v[34:35] op_sel_hi:[1,0,0]
    v_pk_fma_f32 v[140:141], v[60:61], v[32:33], v[34:35] op_sel_hi:[1,0,0]
    v_pk_fma_f32 v[142:143], v[62:63], v[32:33], v[34:35] op_sel_hi:[1,0,0]
    v_pk_fma_f32 v[144:145], v[64:65], v[36:37], v[38:39] op_sel_hi:[1,0,0]
    v_pk_fma_f32 v[146:147], v[66:67], v[36:37], v[38:39] op_sel_hi:[1,0,0]
    v_pk_fma_f32 v[148:149], v[68:69], v[36:37], v[38:39] op_sel_hi:[1,0,0]
    v_pk_fma_f32 v[150:151], v[70:71], v[36:37], v[38:39] op_sel_hi:[1,0,0]
    v_exp_f32 v232, v136
    v_exp_f32 v233, v137
    v_exp_f32 v234, v138
    v_exp_f32 v235, v139
    v_exp_f32 v236, v140
    v_exp_f32 v237, v141
    v_exp_f32 v238, v142
    v_exp_f32 v239, v143
    v_exp_f32 v240, v144
    v_exp_f32 v241, v145
    v_exp_f32 v242, v146
    v_exp_f32 v243, v147
    v_exp_f32 v244, v148
    v_exp_f32 v245, v149
    v_exp_f32 v246, v150
    v_exp_f32 v247, v151
    v_pk_add_f32 v[232:233], v[232:233], 1.0 op_sel_hi:[1,0]
    v_pk_add_f32 v[234:235], v[234:235], 1.0 op_sel_hi:[1,0]
    v_pk_add_f32 v[236:237], v[236:237], 1.0 op_sel_hi:[1,0]
    v_pk_add_f32 v[238:239], v[238:239], 1.0 op_sel_hi:[1,0]
    v_pk_add_f32 v[240:241], v[240:241], 1.0 op_sel_hi:[1,0]
    v_pk_add_f32 v[242:243], v[242:243], 1.0 op_sel_hi:[1,0]
    v_pk_add_f32 v[244:245], v[244:245], 1.0 op_sel_hi:[1,0]
    v_pk_add_f32 v[246:247], v[246:247], 1.0 op_sel_hi:[1,0]
    v_rcp_f32 v232, v232
    v_rcp_f32 v233, v233
    v_rcp_f32 v234, v234
    v_rcp_f32 v235, v235
    v_rcp_f32 v236, v236
    v_rcp_f32 v237, v237
    v_rcp_f32 v238, v238
    v_rcp_f32 v239, v239
    v_rcp_f32 v240, v240
    v_rcp_f32 v241, v241
    v_rcp_f32 v242, v242
    v_rcp_f32 v243, v243
    v_rcp_f32 v244, v244
    v_rcp_f32 v245, v245
    v_rcp_f32 v246, v246
    v_rcp_f32 v247, v247
    v_pk_mul_f32 v[136:137], v[136:137], v[232:233]
    v_pk_mul_f32 v[138:139], v[138:139], v[234:235]
    v_pk_mul_f32 v[140:141], v[140:141], v[236:237]
    v_pk_mul_f32 v[142:143], v[142:143], v[238:239]
    v_pk_mul_f32 v[144:145], v[144:145], v[240:241]
    v_pk_mul_f32 v[146:147], v[146:147], v[242:243]
    v_pk_mul_f32 v[148:149], v[148:149], v[244:245]
    v_pk_mul_f32 v[150:151], v[150:151], v[246:247]
L_z_wait:
    s_setprio 2
    s_waitcnt vmcnt(4)
    v_xor_b32 v160, v210, v72
    v_xor_b32 v161, v210, v73
    v_xor_b32 v162, v210, v74
    v_xor_b32 v163, v210, v75
    ds_write_b128 v250, v[160:163] offset:0
    v_or3_b32 v1, v160, v161, v162
    v_or_b32 v1, v1, v163
    s_waitcnt vmcnt(3)
    v_xor_b32 v164, v210, v76
    v_xor_b32 v165, v210, v77
    v_xor_b32 v166, v210, v78
    v_xor_b32 v167, v210, v79
    ds_write_b128 v250, v[164:167] offset:1024
    v_or3_b32 v1, v1, v164, v165
    v_or3_b32 v1, v1, v166, v167
    s_waitcnt vmcnt(2)
    v_xor_b32 v168, v210, v80
    v_xor_b32 v169, v210, v81
    v_xor_b32 v170, v210, v82
    v_xor_b32 v171, v210, v83
    ds_write_b128 v250, v[168:171] offset:2048
    v_or3_b32 v1, v1, v168, v169
    v_or3_b32 v1, v1, v170, v171
    s_waitcnt vmcnt(1)
    v_xor_b32 v172, v210, v84
    v_xor_b32 v173, v210, v85
    v_xor_b32 v174, v210, v86
    v_xor_b32 v175, v210, v87
    ds_write_b128 v250, v[172:175] offset:3072
    v_or3_b32 v1, v1, v172, v173
    v_or3_b32 v1, v1, v174, v175
    s_waitcnt vmcnt(0)
    v_xor_b32 v176, v210, v212
    v_xor_b32 v177, v210, v213
    v_xor_b32 v178, v210, v214
    v_xor_b32 v179, v210, v215
    s_mov_b32 exec_hi, 0x1ff
    ds_write_b128 v201, v[176:179]
    s_mov_b32 exec_hi, -1
    v_or3_b32 v1, v1, v176, v177
    v_or3_b32 v1, v1, v178, v179
    v_and_b32 v1, 0x30003, v1
    v_cmp_ne_u32 vcc, 0, v1
    s_nop 0
    s_cbranch_vccz L_z_got
    s_cmp_eq_u32 s35, 0
    s_cbranch_scc1 L_z_got
    s_sub_u32 s35, s35, 1
    s_sleep 2
    s_mov_b64 exec, vcc
    buffer_load_dwordx4 v[72:75], v3, s[12:15], s50 offen offset:0 sc1
    buffer_load_dwordx4 v[76:79], v3, s[12:15], s50 offen offset:1024 sc1
    buffer_load_dwordx4 v[80:83], v3, s[12:15], s50 offen offset:2048 sc1
    buffer_load_dwordx4 v[84:87], v3, s[12:15], s50 offen offset:3072 sc1
    s_and_b32 exec_hi, exec_hi, 0x1ff
    s_or_b32 exec_lo, exec_lo, 1
    buffer_load_dwordx4 v[212:215], v200, s[12:15], s51 offen sc1
    s_mov_b64 exec, -1
    s_waitcnt lgkmcnt(0)
    s_branch L_z_wait
L_z_got:
    s_mov_b64 exec, 1
    ds_add_u32 v0, v255 offset:42832
    s_mov_b64 exec, -1
L_sync8:
    ds_read_b32 v1, v0 offset:42832
    ds_read_b64_tr_b16 v[152:153], v251 offset:0
    ds_read_b64_tr_b16 v[154:155], v251 offset:1024
    ds_read_b64_tr_b16 v[156:157], v252 offset:0
    ds_read_b64_tr_b16 v[158:159], v252 offset:1024
    s_waitcnt lgkmcnt(4)
    v_readfirstlane_b32 s31, v1
    s_nop 0
    s_cmp_ge_u32 s31, 4
    s_cbranch_scc0 L_sync8
    ds_read_b64_tr_b16 v[160:161], v251 offset:4096
    ds_read_b64_tr_b16 v[162:163], v251 offset:5120
    ds_read_b64_tr_b16 v[164:165], v252 offset:4096
    ds_read_b64_tr_b16 v[166:167], v252 offset:5120
    ds_read_b64_tr_b16 v[168:169], v251 offset:8192
    ds_read_b64_tr_b16 v[170:171], v251 offset:9216
    ds_read_b64_tr_b16 v[172:173], v252 offset:8192
    ds_read_b64_tr_b16 v[174:175], v252 offset:9216
    s_waitcnt lgkmcnt(8)
    v_mfma_f32_16x16x32_f16 v[216:219], v[152:155], v[88:91], 0
    v_mfma_f32_16x16x32_f16 v[220:223], v[156:159], v[88:91], 0
    ds_read_b64_tr_b16 v[176:177], v251 offset:12288
    ds_read_b64_tr_b16 v[178:179], v251 offset:13312
    ds_read_b64_tr_b16 v[180:181], v252 offset:12288
    ds_read_b64_tr_b16 v[182:183], v252 offset:13312
    s_waitcnt lgkmcnt(8)
    v_mfma_f32_16x16x32_f16 v[216:219], v[160:163], v[92:95], v[216:219]
    v_mfma_f32_16x16x32_f16 v[220:223], v[164:167], v[92:95], v[220:223]
    ds_read_b64_tr_b16 v[152:153], v206 offset:0
    ds_read_b64_tr_b16 v[154:155], v253 offset:1024
    ds_read_b64_tr_b16 v[156:157], v207 offset:0
    ds_read_b64_tr_b16 v[158:159], v254 offset:1024
    s_waitcnt lgkmcnt(8)
    v_mfma_f32_16x16x32_f16 v[224:227], v[168:171], v[96:99], 0
    v_mfma_f32_16x16x32_f16 v[228:231], v[172:175], v[96:99], 0
    ds_read_b64_tr_b16 v[160:161], v253 offset:4096
    ds_read_b64_tr_b16 v[162:163], v253 offset:5120
    ds_read_b64_tr_b16 v[164:165], v254 offset:4096
    ds_read_b64_tr_b16 v[166:167], v254 offset:5120
    s_waitcnt lgkmcnt(8)
    v_mfma_f32_16x16x32_f16 v[224:227], v[176:179], v[100:103], v[224:227]
    v_mfma_f32_16x16x32_f16 v[228:231], v[180:183], v[100:103], v[228:231]
    ds_read_b64_tr_b16 v[168:169], v253 offset:8192
    ds_read_b64_tr_b16 v[170:171], v253 offset:9216
    ds_read_b64_tr_b16 v[172:173], v254 offset:8192
    ds_read_b64_tr_b16 v[174:175], v254 offset:9216
    s_waitcnt lgkmcnt(8)
    v_mfma_f32_16x16x32_f16 v[216:219], v[152:155], v[104:107], v[216:219]
    v_mfma_f32_16x16x32_f16 v[220:223], v[156:159], v[104:107], v[220:223]
    ds_read_b64_tr_b16 v[176:177], v253 offset:12288
    ds_read_b64_tr_b16 v[178:179], v253 offset:13312
    ds_read_b64_tr_b16 v[180:181], v254 offset:12288
    ds_read_b64_tr_b16 v[182:183], v254 offset:13312
    s_waitcnt lgkmcnt(8)
    v_mfma_f32_16x16x32_f16 v[216:219], v[160:163], v[108:111], v[216:219]
    v_mfma_f32_16x16x32_f16 v[220:223], v[164:167], v[108:111], v[220:223]
    ds_read_b64_tr_b16 v[72:73], v202 offset:0
    ds_read_b64_tr_b16 v[74:75], v202 offset:1024
    ds_read_b64_tr_b16 v[76:77], v202 offset:4096
    ds_read_b64_tr_b16 v[78:79], v202 offset:5120
    s_waitcnt lgkmcnt(8)
    v_mfma_f32_16x16x32_f16 v[224:227], v[168:171], v[112:115], v[224:227]
    v_mfma_f32_16x16x32_f16 v[228:231], v[172:175], v[112:115], v[228:231]
    ds_read_b64_tr_b16 v[80:81], v202 offset:8192
    ds_read_b64_tr_b16 v[82:83], v202 offset:9216
    ds_read_b64_tr_b16 v[84:85], v202 offset:12288
    ds_read_b64_tr_b16 v[86:87], v202 offset:13312
    s_waitcnt lgkmcnt(8)
    v_mfma_f32_16x16x32_f16 v[224:227], v[176:179], v[116:119], v[224:227]
    v_mfma_f32_16x16x32_f16 v[228:231], v[180:183], v[116:119], v[228:231]
    ds_read_b64_tr_b16 v[240:241], v204 offset:0
    ds_read_b64_tr_b16 v[242:243], v203 offset:1024
    ds_read_b64_tr_b16 v[244:245], v203 offset:4096
    ds_read_b64_tr_b16 v[246:247], v203 offset:5120
    s_waitcnt lgkmcnt(8)
    ds_read_b64_tr_b16 v[184:185], v203 offset:8192
    ds_read_b64_tr_b16 v[186:187], v203 offset:9216
    ds_read_b64_tr_b16 v[188:189], v203 offset:12288
    ds_read_b64_tr_b16 v[190:191], v203 offset:13312
    v_mfma_f32_16x16x32_f16 v[232:235], v[72:75], v[88:91], 0
    v_mfma_f32_16x16x32_f16 v[232:235], v[76:79], v[92:95], v[232:235]
    s_waitcnt lgkmcnt(4)
    s_nop 0
    v_mfma_f32_16x16x32_f16 v[236:239], v[80:83], v[96:99], 0
    v_mfma_f32_16x16x32_f16 v[236:239], v[84:87], v[100:103], v[236:239]
    v_pk_add_f32 v[152:153], v[216:217], v[224:225]
    v_pk_add_f32 v[154:155], v[218:219], v[226:227]
    v_pk_add_f32 v[156:157], v[220:221], v[228:229]
    v_pk_add_f32 v[158:159], v[222:223], v[230:231]
    v_mfma_f32_16x16x32_f16 v[232:235], v[240:243], v[104:107], v[232:235]
    v_mfma_f32_16x16x32_f16 v[232:235], v[244:247], v[108:111], v[232:235]
    v_pk_fma_f32 v[40:41], v[152:153], v[120:121], v[40:41]
    v_pk_fma_f32 v[42:43], v[154:155], v[122:123], v[42:43]
    v_pk_fma_f32 v[44:45], v[156:157], v[124:125], v[44:45]
    v_pk_fma_f32 v[46:47], v[158:159], v[126:127], v[46:47]
    s_waitcnt lgkmcnt(0)
    s_nop 0
    v_mfma_f32_16x16x32_f16 v[236:239], v[184:187], v[112:115], v[236:239]
    v_mfma_f32_16x16x32_f16 v[236:239], v[188:191], v[116:119], v[236:239]
    v_cvt_pk_bf16_f32 v8, v40, v41
    v_cvt_pk_bf16_f32 v9, v42, v43
    v_cvt_pk_bf16_f32 v10, v44, v45
    v_cvt_pk_bf16_f32 v11, v46, v47
    ds_write_b128 v208, v[8:11] offset:0
    ds_read_b128 v[24:27], v199 offset:0
    v_pk_add_f32 v[160:161], v[216:217], v[224:225] neg_lo:[0,1] neg_hi:[0,1]
    v_pk_add_f32 v[162:163], v[218:219], v[226:227] neg_lo:[0,1] neg_hi:[0,1]
    v_pk_add_f32 v[164:165], v[220:221], v[228:229] neg_lo:[0,1] neg_hi:[0,1]
    v_pk_add_f32 v[166:167], v[222:223], v[230:231] neg_lo:[0,1] neg_hi:[0,1]
    s_cmp_eq_u64 s[62:63], 0
    s_cbranch_scc1 L_nodump0
    s_mov_b64 exec, s[54:55]
    ds_write_b128 v6, v[152:155] offset:42496
    ds_write_b128 v6, v[156:159] offset:42512
    s_mov_b64 exec, s[58:59]
    ds_write_b128 v6, v[160:163] offset:42496
    ds_write_b128 v6, v[164:167] offset:42512
    s_mov_b64 exec, 1
    ds_add_u32 v0, v255 offset:42836
    s_mov_b64 exec, -1
    s_waitcnt lgkmcnt(0)
L_nodump0:
    s_nop 0
    v_pk_fma_f32 v[56:57], v[160:161], v[136:137], v[56:57]
    v_pk_fma_f32 v[58:59], v[162:163], v[138:139], v[58:59]
    v_pk_fma_f32 v[60:61], v[164:165], v[140:141], v[60:61]
    v_pk_fma_f32 v[62:63], v[166:167], v[142:143], v[62:63]
    v_cvt_pk_bf16_f32 v16, v56, v57
    v_cvt_pk_bf16_f32 v17, v58, v59
    v_cvt_pk_bf16_f32 v18, v60, v61
    v_cvt_pk_bf16_f32 v19, v62, v63
    ds_write_b128 v208, v[16:19] offset:2048
    ds_read_b128 v[32:35], v199 offset:2048
    s_waitcnt lgkmcnt(2)
    buffer_store_dwordx4 v[24:27], v4, s[16:19], 0 offen sc1
    v_add_f32 v152, v232, v236
    v_sub_f32 v160, v232, v236
    s_cmp_eq_u64 s[64:65], 0
    s_cbranch_scc1 L_nodump1
    s_mov_b64 exec, s[56:57]
    ds_write_b128 v6, v[152:155] offset:42624
    ds_write_b128 v6, v[156:159] offset:42640
    s_mov_b64 exec, s[60:61]
    ds_write_b128 v6, v[160:163] offset:42624
    ds_write_b128 v6, v[164:167] offset:42640
    s_mov_b64 exec, 1
    ds_add_u32 v0, v255 offset:42864
    s_mov_b64 exec, -1
    s_waitcnt lgkmcnt(0)
L_nodump1:
    v_pk_fma_f32 v[48:49], v[152:153], v[128:129], v[48:49]
    v_pk_fma_f32 v[50:51], v[154:155], v[130:131], v[50:51]
    v_pk_fma_f32 v[52:53], v[156:157], v[132:133], v[52:53]
    v_pk_fma_f32 v[54:55], v[158:159], v[134:135], v[54:55]
    v_cvt_pk_bf16_f32 v12, v48, v55
    v_cvt_pk_bf16_f32 v13, v54, v53
    v_cvt_pk_bf16_f32 v14, v52, v51
    v_cvt_pk_bf16_f32 v15, v50, v49
    ds_write_b128 v208, v[12:15] offset:1024
    ds_read_b128 v[28:31], v199 offset:1024
    s_waitcnt lgkmcnt(2)
    s_nop 0
    buffer_store_dwordx4 v[32:35], v249, s[16:19], 0 offen sc1
    v_pk_fma_f32 v[64:65], v[160:161], v[144:145], v[64:65]
    v_pk_fma_f32 v[66:67], v[162:163], v[146:147], v[66:67]
    v_pk_fma_f32 v[68:69], v[164:165], v[148:149], v[68:69]
    v_pk_fma_f32 v[70:71], v[166:167], v[150:151], v[70:71]
    v_cvt_pk_bf16_f32 v20, v64, v71
    v_cvt_pk_bf16_f32 v21, v70, v69
    v_cvt_pk_bf16_f32 v22, v68, v67
    v_cvt_pk_bf16_f32 v23, v66, v65
    ds_write_b128 v208, v[20:23] offset:3072
    ds_read_b128 v[36:39], v199 offset:3072
    s_waitcnt lgkmcnt(2)
    buffer_store_dwordx4 v[28:31], v5, s[16:19], 0 offen sc1
    s_waitcnt lgkmcnt(0)
    buffer_store_dwordx4 v[36:39], v205, s[16:19], 0 offen sc1
    s_branch L_fin
L_dma_done:
    s_setprio 0
    s_lshr_b32 s31, s47, 2
    s_andn2_b32 s31, s31, s75
    s_add_u32 s50, s31, s46
    s_lshl_b32 s31, s50, 17
    s_bfe_u32 s32, s2, 0x20003
    s_lshl_b32 s32, s32, 2
    s_add_u32 s51, s32, s30
    s_lshl_b32 s32, s51, 7
    s_add_u32 s31, s31, s32
    v_lshrrev_b32 v6, 3, v2
    v_lshlrev_b32 v6, 11, v6
    v_and_b32 v7, 0x70, v3
    v_and_b32 v11, 16, v2
    v_lshlrev_b32 v11, 1, v11
    v_xor_b32 v11, v11, v7
    v_add3_u32 v6, v6, v11, s31
    v_xor_b32 v11, 64, v6
    s_lshl_b32 s74, s30, 13
    s_cmp_lt_u32 s30, 2
    s_mov_b32 s31, 125952
    s_cselect_b32 s31, 60416, s31
    s_add_u32 s74, s74, s31
    s_mov_b32 s60, 4096
    s_mov_b32 s61, 8192
    s_mov_b32 s62, 12288
    v_bfe_u32 v8, v2, 2, 3
    v_lshlrev_b32 v9, 5, v8
    s_lshl_b32 s31, s30, 6
    v_xor_b32 v9, s31, v9
    v_bfe_u32 v8, v2, 2, 2
    v_lshl_add_u32 v9, v8, 8, v9
    v_lshrrev_b32 v8, 4, v2
    v_lshl_add_u32 v9, v8, 11, v9
    v_and_b32 v10, 3, v2
    v_lshl_add_u32 v9, v10, 3, v9
    v_add_u32 v9, 76800, v9
    v_xor_b32 v10, 32, v9
    v_lshlrev_b32 v8, 4, v8
    s_lshr_b32 s31, s30, 1
    s_and_b32 s32, s31, s75
    s_lshl_b32 s32, s32, 8
    v_add_u32 v8, s32, v8
    s_cmp_eq_u32 s75, 0
    s_cselect_b32 s32, 12, 9
    s_lshl_b32 s31, s31, s32
    s_lshl_b32 s32, s46, 3
    s_add_u32 s32, s32, s47
    s_lshl_b32 s32, s32, 9
    s_add_u32 s31, s31, s32
    s_and_b32 s32, s30, 1
    s_lshl_b32 s32, s32, 8
    s_add_u32 s31, s31, s32
    s_add_u32 s31, s31, 262144
    v_lshl_add_u32 v13, v2, 3, s31
    s_waitcnt lgkmcnt(0)
    s_add_u32 s28, s28, 0x7f4a7c15
    s_addc_u32 s29, s29, 0x9e3779b9
    s_and_b32 s31, s28, 0xff
    v_mov_b32 v14, s31
    s_mov_b32 s49, 0xffffff00
    s_cmp_lg_u32 s30, 2
    s_cbranch_scc1 L_no_tlb
    s_mov_b32 s52, s44
    s_mov_b32 s53, s45
    s_mov_b32 s54, 0x400000
    s_mov_b32 s55, 0x00020000
    v_lshlrev_b32 v250, 20, v2
    s_mov_b64 exec, 0xff
    buffer_load_dword v251, v250, s[12:15], 0 offen
    buffer_load_dword v252, v250, s[52:55], 0 offen
    buffer_load_dword v253, v250, s[24:27], 0 offen
    s_mov_b64 exec, -1
L_no_tlb:
    s_cmp_lg_u32 s66, 0
    s_cbranch_scc1 L_tagged
    s_mov_b64 exec, 1
    ds_add_u32 v0, v255 offset:42872
    s_mov_b64 exec, -1
L_tagged:
    s_cmp_eq_u32 s30, 3
    s_cbranch_scc1 L_h1
    s_cmp_eq_u32 s66, 0
    s_cbranch_scc1 L_key
    s_cmp_lg_u32 s30, 0
    s_cbranch_scc1 L_follower
    s_setprio 3
    s_waitcnt vmcnt(16)
    s_mov_b64 exec, 1
    ds_add_u32 v0, v255 offset:42868
    s_mov_b64 exec, -1
    ds_read_b64_tr_b16 v[36:37], v9 offset:0
    ds_read_b64_tr_b16 v[38:39], v9 offset:1024
    ds_read_b64_tr_b16 v[40:41], v10 offset:0
    ds_read_b64_tr_b16 v[42:43], v10 offset:1024
    ds_read_b64_tr_b16 v[44:45], v9 offset:32768
    ds_read_b64_tr_b16 v[46:47], v9 offset:33792
    ds_read_b64_tr_b16 v[48:49], v10 offset:32768
    ds_read_b64_tr_b16 v[50:51], v10 offset:33792
    ds_read_b64_tr_b16 v[52:53], v9 offset:8192
    ds_read_b64_tr_b16 v[54:55], v9 offset:9216
    ds_read_b64_tr_b16 v[56:57], v10 offset:8192
    ds_read_b64_tr_b16 v[58:59], v10 offset:9216
    ds_read_b64_tr_b16 v[60:61], v9 offset:40960
    ds_read_b64_tr_b16 v[62:63], v9 offset:41984
    s_waitcnt lgkmcnt(12)
    ds_read_b64_tr_b16 v[64:65], v10 offset:40960
    ds_read_b64_tr_b16 v[66:67], v10 offset:41984
    s_waitcnt lgkmcnt(12)
    ds_read_b64_tr_b16 v[68:69], v9 offset:16384
    ds_read_b64_tr_b16 v[70:71], v9 offset:17408
    s_waitcnt lgkmcnt(12)
    ds_read_b64_tr_b16 v[72:73], v10 offset:16384
    ds_read_b64_tr_b16 v[74:75], v10 offset:17408
    s_waitcnt lgkmcnt(12)
    ds_read_b64_tr_b16 v[76:77], v9 offset:49152
    ds_read_b64_tr_b16 v[78:79], v9 offset:50176
    s_waitcnt lgkmcnt(12)
    ds_read_b64_tr_b16 v[80:81], v10 offset:49152
    ds_read_b64_tr_b16 v[82:83], v10 offset:50176
    s_waitcnt vmcnt(8)
    s_mov_b64 exec, 1
    ds_add_u32 v0, v255 offset:42868
    s_mov_b64 exec, -1
    s_branch L_d_first
L_follower:
    v_readfirstlane_b32 s52, v13
    s_and_b32 s32, s30, 1
    s_lshl_b32 s32, s32, 8
    s_sub_u32 s52, s52, s32
    s_lshl_b32 s31, s50, 12
    s_sub_u32 s31, s31, s32
    s_lshl_b32 s32, s51, 8
    s_add_u32 s31, s31, s32
    s_add_u32 s53, s31, 524288
    s_load_dword s54, s[12:13], s52
    s_load_dword s54, s[12:13], s53
    s_add_u32 s52, s52, 64
    s_add_u32 s53, s53, 64
    s_load_dword s54, s[12:13], s52
    s_load_dword s54, s[12:13], s53
    s_add_u32 s52, s52, 64
    s_add_u32 s53, s53, 64
    s_load_dword s54, s[12:13], s52
    s_load_dword s54, s[12:13], s53
    s_add_u32 s52, s52, 64
    s_add_u32 s53, s53, 64
    s_load_dword s54, s[12:13], s52
    s_load_dword s54, s[12:13], s53
    s_add_u32 s52, s52, 64
    s_add_u32 s53, s53, 64
    s_waitcnt lgkmcnt(0)
    s_load_dword s54, s[12:13], s52
    s_load_dword s54, s[12:13], s53
    s_add_u32 s52, s52, 64
    s_add_u32 s53, s53, 64
    s_load_dword s54, s[12:13], s52
    s_load_dword s54, s[12:13], s53
    s_add_u32 s52, s52, 64
    s_add_u32 s53, s53, 64
    s_load_dword s54, s[12:13], s52
    s_load_dword s54, s[12:13], s53
    s_add_u32 s52, s52, 64
    s_add_u32 s53, s53, 64
    s_load_dword s54, s[12:13], s52
    s_load_dword s54, s[12:13], s53
L_sync9:
    ds_read_b32 v1, v0 offset:42868
    s_waitcnt lgkmcnt(0)
    v_readfirstlane_b32 s31, v1
    s_nop 0
    s_cmp_ge_u32 s31, 1
    s_cbranch_scc0 L_sync9
    s_setprio 3
    ds_read_b64_tr_b16 v[36:37], v9 offset:0
    ds_read_b64_tr_b16 v[38:39], v9 offset:1024
    ds_read_b64_tr_b16 v[40:41], v10 offset:0
    ds_read_b64_tr_b16 v[42:43], v10 offset:1024
    ds_read_b64_tr_b16 v[44:45], v9 offset:32768
    ds_read_b64_tr_b16 v[46:47], v9 offset:33792
    ds_read_b64_tr_b16 v[48:49], v10 offset:32768
    ds_read_b64_tr_b16 v[50:51], v10 offset:33792
    ds_read_b64_tr_b16 v[52:53], v9 offset:8192
    ds_read_b64_tr_b16 v[54:55], v9 offset:9216
    ds_read_b64_tr_b16 v[56:57], v10 offset:8192
    ds_read_b64_tr_b16 v[58:59], v10 offset:9216
    ds_read_b64_tr_b16 v[60:61], v9 offset:40960
    ds_read_b64_tr_b16 v[62:63], v9 offset:41984
    s_waitcnt lgkmcnt(12)
    ds_read_b64_tr_b16 v[64:65], v10 offset:40960
    ds_read_b64_tr_b16 v[66:67], v10 offset:41984
    s_waitcnt lgkmcnt(12)
    ds_read_b64_tr_b16 v[68:69], v9 offset:16384
    ds_read_b64_tr_b16 v[70:71], v9 offset:17408
    s_waitcnt lgkmcnt(12)
    ds_read_b64_tr_b16 v[72:73], v10 offset:16384
    ds_read_b64_tr_b16 v[74:75], v10 offset:17408
    s_waitcnt lgkmcnt(12)
    ds_read_b64_tr_b16 v[76:77], v9 offset:49152
    ds_read_b64_tr_b16 v[78:79], v9 offset:50176
    s_waitcnt lgkmcnt(12)
    ds_read_b64_tr_b16 v[80:81], v10 offset:49152
    ds_read_b64_tr_b16 v[82:83], v10 offset:50176
    s_add_u32 s67, s30, 0
L_sync10:
    ds_read_b32 v1, v0 offset:42868
    s_waitcnt lgkmcnt(0)
    v_readfirstlane_b32 s31, v1
    s_nop 0
    s_cmp_ge_u32 s31, s67
    s_cbranch_scc0 L_sync10
L_d_first:
    s_add_u32 m0, s74, 0
    s_mov_b32 s31, 0
    s_nop 0
    buffer_load_dwordx4 v6, s[24:27], s31 offen nt lds
    s_add_u32 m0, s74, 1024
    s_mov_b32 s31, 16384
    buffer_load_dwordx4 v11, s[24:27], s31 offen nt lds
    s_add_u32 m0, s74, 2048
    s_mov_b32 s31, 32768
    buffer_load_dwordx4 v6, s[24:27], s31 offen nt lds
    s_add_u32 m0, s74, 3072
    s_mov_b32 s31, 49152
    buffer_load_dwordx4 v11, s[24:27], s31 offen nt lds
    s_add_u32 m0, s74, 4096
    s_mov_b32 s31, 65536
    buffer_load_dwordx4 v6, s[24:27], s31 offen nt lds
L_key:
    s_waitcnt lgkmcnt(0)
L_sync11:
    ds_read_b32 v1, v0 offset:42844
    ds_read_b64 v[18:19], v0 offset:41552
    ds_read_b128 v[20:23], v8 offset:41600
    ds_read_b128 v[24:27], v8 offset:41664
    ds_read_b128 v[28:31], v8 offset:41728
    ds_read_b128 v[32:35], v8 offset:41792
    s_waitcnt lgkmcnt(5)
    v_readfirstlane_b32 s31, v1
    s_nop 0
    s_cmp_ge_u32 s31, 1
    s_cbranch_scc0 L_sync11
    s_cmp_eq_u32 s66, 0
    s_cbranch_scc1 L_idle
    s_branch L_xs_ok
L_h1:
    s_mov_b32 s63, 4096
    s_lshl_b32 s31, s47, 8
    v_lshlrev_b32 v15, 3, v2
    v_add_u32 v16, s31, v15
    s_cmp_lg_u32 s66, 0
    s_cbranch_scc1 L_gate
L_sync12:
    ds_read_b32 v1, v0 offset:42828
    s_waitcnt lgkmcnt(0)
    v_readfirstlane_b32 s31, v1
    s_nop 0
    s_cmp_ge_u32 s31, 4
    s_cbranch_scc0 L_sync12
    s_branch L_gate_open
L_gate:
L_sync13:
    ds_read_b32 v1, v0 offset:42824
    s_waitcnt lgkmcnt(0)
    v_readfirstlane_b32 s31, v1
    s_nop 0
    s_cmp_ge_u32 s31, 4
    s_cbranch_scc0 L_sync13
L_gate_open:
    s_setprio 3
    buffer_load_dwordx4 v[20:23], v3, s[12:15], s63 offen offset:0 sc1
    buffer_load_dwordx4 v[24:27], v3, s[12:15], s63 offen offset:1024 sc1
    buffer_load_dwordx4 v[28:31], v3, s[12:15], s63 offen offset:2048 sc1
    buffer_load_dwordx4 v[32:35], v3, s[12:15], s63 offen offset:3072 sc1
    s_mov_b64 exec, 1
    ds_add_u32 v0, v255 offset:42860
    s_mov_b64 exec, -1
    s_waitcnt vmcnt(0)
L_mi_check:
    v_cmp_ne_u64 s[52:53], s[28:29], v[22:23]
    v_cmp_ne_u64 s[54:55], s[28:29], v[26:27]
    v_cmp_ne_u64 s[56:57], s[28:29], v[30:31]
    v_cmp_ne_u64 s[58:59], s[28:29], v[34:35]
    v_max_u32 v18, v21, v25
    v_max3_u32 v18, v18, v29, v33
    s_or_b64 s[64:65], s[52:53], s[54:55]
    s_or_b64 vcc, s[56:57], s[58:59]
    s_or_b64 s[64:65], s[64:65], vcc
    s_cbranch_scc0 L_mi_got
    s_cmp_eq_u32 s35, 0
    s_cbranch_scc1 L_mi_got
    s_sub_u32 s35, s35, 1
    s_sleep 2
    s_mov_b64 exec, s[52:53]
    s_cbranch_execz L_mi_skip0
    buffer_load_dwordx4 v[20:23], v3, s[12:15], s63 offen offset:0 sc1
L_mi_skip0:
    s_mov_b64 exec, s[54:55]
    s_cbranch_execz L_mi_skip1
    buffer_load_dwordx4 v[24:27], v3, s[12:15], s63 offen offset:1024 sc1
L_mi_skip1:
    s_mov_b64 exec, s[56:57]
    s_cbranch_execz L_mi_skip2
    buffer_load_dwordx4 v[28:31], v3, s[12:15], s63 offen offset:2048 sc1
L_mi_skip2:
    s_mov_b64 exec, s[58:59]
    s_cbranch_execz L_mi_skip3
    buffer_load_dwordx4 v[32:35], v3, s[12:15], s63 offen offset:3072 sc1
L_mi_skip3:
    s_mov_b64 exec, -1
    s_waitcnt vmcnt(0)
    s_branch L_mi_check
L_mi_got:
    v_max_u32_dpp v19, v18, v18 row_ror:1 row_mask:0xf bank_mask:0xf
    s_nop 1
    v_max_u32_dpp v19, v19, v19 row_ror:2 row_mask:0xf bank_mask:0xf
    s_nop 1
    v_max_u32_dpp v19, v19, v19 row_ror:4 row_mask:0xf bank_mask:0xf
    s_nop 1
    v_max_u32_dpp v19, v19, v19 row_ror:8 row_mask:0xf bank_mask:0xf
    s_nop 0
    v_readlane_b32 s33, v19, 0
    v_readlane_b32 s31, v19, 16
    v_readlane_b32 s32, v19, 32
    v_readlane_b32 s34, v19, 48
    s_max_u32 s33, s33, s31
    s_max_u32 s32, s32, s34
    s_max_u32 s33, s33, s32
    s_andn2_b32 s31, 0x7ff, s33
    s_lshl_b32 s48, s31, 11
    buffer_load_dwordx2 v[150:151], v16, s[8:11], s48 offen
    s_mov_b64 exec, 1
    ds_add_u32 v0, v255 offset:42840
    s_mov_b64 exec, -1
    v_cmp_eq_u32 s[52:53], s33, v25
    v_cmp_eq_u32 s[54:55], s33, v29
    v_cmp_eq_u32 s[56:57], s33, v33
    v_cmp_eq_u32 vcc, s33, v18
    v_cndmask_b32 v19, v20, v24, s[52:53]
    v_cndmask_b32 v19, v19, v28, s[54:55]
    v_cndmask_b32 v19, v19, v32, s[56:57]
    s_ff1_i32_b64 s32, vcc
    v_readlane_b32 s34, v19, s32
    v_mov_b32 v19, s33
    s_nop 0
    v_mov_b32 v18, s34
    ds_write_b64 v0, v[18:19] offset:41552
    s_lshl_b32 s52, s34, 16
    s_and_b32 s32, s34, 0xffff0000
    v_rcp_f32 v148, s32
    s_waitcnt vmcnt(0)
    v_lshlrev_b32 v20, 16, v150
    v_and_b32 v21, 0xffff0000, v150
    v_lshlrev_b32 v22, 16, v151
    v_and_b32 v23, 0xffff0000, v151
    v_pk_add_f32 v[20:21], v[20:21], s[52:53] op_sel_hi:[1,0] neg_lo:[0,1] neg_hi:[0,1]
    v_pk_add_f32 v[22:23], v[22:23], s[52:53] op_sel_hi:[1,0] neg_lo:[0,1] neg_hi:[0,1]
    v_cvt_pk_bf16_f32 v150, v20, v21
    v_cvt_pk_bf16_f32 v151, v22, v23
    v_lshlrev_b32 v20, 16, v150
    v_and_b32 v21, 0xffff0000, v150
    v_lshlrev_b32 v22, 16, v151
    v_and_b32 v23, 0xffff0000, v151
    v_pk_mul_f32 v[20:21], v[20:21], v[148:149] op_sel_hi:[1,0]
    v_pk_mul_f32 v[22:23], v[22:23], v[148:149] op_sel_hi:[1,0]
    v_cvt_pk_bf16_f32 v150, v20, v21
    v_cvt_pk_bf16_f32 v151, v22, v23
    ds_write_b64 v15, v[150:151] offset:41600
    s_mov_b64 exec, 1
    ds_add_u32 v0, v255 offset:42844
    s_mov_b64 exec, -1
    s_cmp_eq_u32 s66, 0
    s_cbranch_scc1 L_idle
L_sync14:
    ds_read_b32 v1, v0 offset:42868
    s_waitcnt lgkmcnt(0)
    v_readfirstlane_b32 s31, v1
    s_nop 0
    s_cmp_ge_u32 s31, 1
    s_cbranch_scc0 L_sync14
    ds_read_b64_tr_b16 v[36:37], v9 offset:0
    ds_read_b64_tr_b16 v[38:39], v9 offset:1024
    ds_read_b64_tr_b16 v[40:41], v10 offset:0
    ds_read_b64_tr_b16 v[42:43], v10 offset:1024
    ds_read_b64_tr_b16 v[44:45], v9 offset:32768
    ds_read_b64_tr_b16 v[46:47], v9 offset:33792
    ds_read_b64_tr_b16 v[48:49], v10 offset:32768
    ds_read_b64_tr_b16 v[50:51], v10 offset:33792
    ds_read_b64_tr_b16 v[52:53], v9 offset:8192
    ds_read_b64_tr_b16 v[54:55], v9 offset:9216
    ds_read_b64_tr_b16 v[56:57], v10 offset:8192
    ds_read_b64_tr_b16 v[58:59], v10 offset:9216
    ds_read_b64_tr_b16 v[60:61], v9 offset:40960
    ds_read_b64_tr_b16 v[62:63], v9 offset:41984
    s_waitcnt lgkmcnt(12)
    ds_read_b64_tr_b16 v[64:65], v10 offset:40960
    ds_read_b64_tr_b16 v[66:67], v10 offset:41984
    s_waitcnt lgkmcnt(12)
    ds_read_b64_tr_b16 v[68:69], v9 offset:16384
    ds_read_b64_tr_b16 v[70:71], v9 offset:17408
    s_waitcnt lgkmcnt(12)
    ds_read_b64_tr_b16 v[72:73], v10 offset:16384
    ds_read_b64_tr_b16 v[74:75], v10 offset:17408
    s_waitcnt lgkmcnt(12)
    ds_read_b64_tr_b16 v[76:77], v9 offset:49152
    ds_read_b64_tr_b16 v[78:79], v9 offset:50176
    s_waitcnt lgkmcnt(12)
    ds_read_b64_tr_b16 v[80:81], v10 offset:49152
    ds_read_b64_tr_b16 v[82:83], v10 offset:50176
    s_add_u32 m0, s74, 0
    s_mov_b32 s31, 0
    s_nop 0
    buffer_load_dwordx4 v6, s[24:27], s31 offen nt lds
    s_add_u32 m0, s74, 1024
    s_mov_b32 s31, 16384
    buffer_load_dwordx4 v11, s[24:27], s31 offen nt lds
    s_add_u32 m0, s74, 2048
    s_mov_b32 s31, 32768
    buffer_load_dwordx4 v6, s[24:27], s31 offen nt lds
    s_add_u32 m0, s74, 3072
    s_mov_b32 s31, 49152
    buffer_load_dwordx4 v11, s[24:27], s31 offen nt lds
    s_add_u32 m0, s74, 4096
    s_mov_b32 s31, 65536
    buffer_load_dwordx4 v6, s[24:27], s31 offen nt lds
    s_waitcnt lgkmcnt(8)
    ds_read_b128 v[20:23], v8 offset:41600
    ds_read_b128 v[24:27], v8 offset:41664
    ds_read_b128 v[28:31], v8 offset:41728
    ds_read_b128 v[32:35], v8 offset:41792
L_xs_ok:
    s_waitcnt lgkmcnt(3)
    v_mfma_f32_16x16x32_bf16 v[132:135], v[20:23], v[36:39], 0
    v_mfma_f32_16x16x32_bf16 v[136:139], v[20:23], v[40:43], 0
    v_mfma_f32_16x16x32_bf16 v[140:143], v[20:23], v[44:47], 0
    v_mfma_f32_16x16x32_bf16 v[144:147], v[20:23], v[48:51], 0
    s_waitcnt lgkmcnt(2)
    v_mfma_f32_16x16x32_bf16 v[132:135], v[24:27], v[52:55], v[132:135]
    v_mfma_f32_16x16x32_bf16 v[136:139], v[24:27], v[56:59], v[136:139]
    v_mfma_f32_16x16x32_bf16 v[140:143], v[24:27], v[60:63], v[140:143]
    v_mfma_f32_16x16x32_bf16 v[144:147], v[24:27], v[64:67], v[144:147]
    s_waitcnt lgkmcnt(1)
    v_mfma_f32_16x16x32_bf16 v[132:135], v[28:31], v[68:71], v[132:135]
    v_mfma_f32_16x16x32_bf16 v[136:139], v[28:31], v[72:75], v[136:139]
    v_mfma_f32_16x16x32_bf16 v[140:143], v[28:31], v[76:79], v[140:143]
    v_mfma_f32_16x16x32_bf16 v[144:147], v[28:31], v[80:83], v[144:147]
    s_cmp_lg_u32 s30, 0
    s_cbranch_scc1 L_k3_wait
    s_waitcnt vmcnt(5)
    s_mov_b64 exec, 1
    ds_add_u32 v0, v255 offset:42868
    s_mov_b64 exec, -1
L_k3_wait:
    s_branch L_sync15a
L_sync15:
    s_waitcnt lgkmcnt(0)
L_sync15a:
    s_nop 0
    ds_read_b32 v1, v0 offset:42868
    ds_read_b64_tr_b16 v[84:85], v9 offset:24576
    ds_read_b64_tr_b16 v[86:87], v9 offset:25600
    ds_read_b64_tr_b16 v[88:89], v10 offset:24576
    ds_read_b64_tr_b16 v[90:91], v10 offset:25600
    ds_read_b64_tr_b16 v[92:93], v9 offset:57344
    ds_read_b64_tr_b16 v[94:95], v9 offset:58368
    ds_read_b64_tr_b16 v[96:97], v10 offset:57344
    ds_read_b64_tr_b16 v[98:99], v10 offset:58368
    s_waitcnt lgkmcnt(8)
    v_readfirstlane_b32 s31, v1
    s_nop 0
    s_cmp_ge_u32 s31, 3
    s_cbranch_scc0 L_sync15
    v_readfirstlane_b32 s33, v19
    v_readfirstlane_b32 s34, v18
    s_waitcnt lgkmcnt(6)
    v_mfma_f32_16x16x32_bf16 v[132:135], v[32:35], v[84:87], v[132:135]
    s_waitcnt lgkmcnt(4)
    v_mfma_f32_16x16x32_bf16 v[136:139], v[32:35], v[88:91], v[136:139]
    s_waitcnt lgkmcnt(2)
    v_mfma_f32_16x16x32_bf16 v[140:143], v[32:35], v[92:95], v[140:143]
    s_waitcnt lgkmcnt(0)
    v_mfma_f32_16x16x32_bf16 v[144:147], v[32:35], v[96:99], v[144:147]
    s_mov_b32 vcc_lo, 0xffff0000
    s_mov_b32 vcc_hi, 0
    s_lshl_b32 s31, s50, 12
    s_lshl_b32 s32, s30, 7
    s_add_u32 s31, s31, s32
    s_add_u32 s31, s31, 262144
    v_lshrrev_b32 v15, 3, v2
    v_lshlrev_b32 v15, 9, v15
    v_add3_u32 v15, v15, v7, s31
    v_cndmask_b32 v26, v132, v136, vcc
    v_cndmask_b32 v27, v140, v144, vcc
    v_and_or_b32 v26, v26, s49, v14
    v_and_or_b32 v27, v27, s49, v14
    s_mov_b32 exec_hi, 0
    buffer_store_dwordx2 v[26:27], v13, s[12:15], 0 offen sc1
    s_mov_b64 exec, -1
    s_nop 0
    s_add_u32 m0, s74, 5120
    s_mov_b32 s31, 81920
    buffer_load_dwordx4 v11, s[24:27], s31 offen nt lds
    s_add_u32 m0, s74, 6144
    s_mov_b32 s31, 98304
    buffer_load_dwordx4 v6, s[24:27], s31 offen nt lds
    s_add_u32 m0, s74, 7168
    s_mov_b32 s31, 114688
    buffer_load_dwordx4 v11, s[24:27], s31 offen nt lds
    s_mov_b64 exec, 1
    ds_add_u32 v0, v255 offset:42848
    s_mov_b64 exec, -1
    s_setprio 3
    v_and_b32 v16, 7, v2
    v_lshlrev_b32 v16, 2, v16
    v_lshrrev_b32 v17, 5, v2
    v_lshl_add_u32 v16, v17, 1, v16
    s_lshl_b32 s31, s30, 5
    v_add_u32 v16, s31, v16
    v_and_b32 v17, 48, v2
    v_bfe_u32 v9, v2, 3, 2
    v_lshlrev_b32 v9, 5, v9
    v_bfe_u32 v10, v2, 2, 2
    v_lshl_add_u32 v9, v10, 7, v9
    v_lshl_add_u32 v9, v17, 6, v9
    v_and_b32 v10, 3, v2
    v_lshlrev_b32 v10, 3, v10
    v_add3_u32 v9, v9, v10, s74
    v_xor_b32 v10, 32, v9
    v_xor_b32 v12, 96, v9
    v_xor_b32 v8, 64, v9
    s_lshl_b32 s31, s50, 12
    s_lshl_b32 s32, s51, 8
    s_add_u32 s31, s31, s32
    s_add_u32 s31, s31, 524288
    v_lshl_add_u32 v18, v2, 2, s31
    s_waitcnt vmcnt(5)
    s_waitcnt lgkmcnt(4)
    ds_read_b64_tr_b16 v[100:101], v9 offset:0
    ds_read_b64_tr_b16 v[102:103], v9 offset:512
    ds_read_b64_tr_b16 v[104:105], v10 offset:0
    ds_read_b64_tr_b16 v[106:107], v10 offset:512
    ds_read_b64_tr_b16 v[108:109], v8 offset:0
    ds_read_b64_tr_b16 v[110:111], v8 offset:512
    ds_read_b64_tr_b16 v[112:113], v12 offset:0
    ds_read_b64_tr_b16 v[114:115], v12 offset:512
    s_waitcnt vmcnt(0)
    buffer_load_dwordx4 v[20:23], v15, s[12:15], 0 offen sc1
    s_waitcnt lgkmcnt(4)
    ds_read_b64_tr_b16 v[116:117], v9 offset:4096
    ds_read_b64_tr_b16 v[118:119], v9 offset:4608
    ds_read_b64_tr_b16 v[120:121], v10 offset:4096
    ds_read_b64_tr_b16 v[122:123], v10 offset:4608
    ds_read_b64_tr_b16 v[124:125], v8 offset:4096
    ds_read_b64_tr_b16 v[126:127], v8 offset:4608
    ds_read_b64_tr_b16 v[128:129], v12 offset:4096
    ds_read_b64_tr_b16 v[130:131], v12 offset:4608
    s_mov_b32 s54, 0
    s_branch L_hp_wait
L_hp_poll:
    buffer_load_dwordx4 v[20:23], v15, s[12:15], 0 offen sc1
L_hp_wait:
    s_waitcnt vmcnt(0)
    v_xor_b32 v20, v14, v20
    v_xor_b32 v21, v14, v21
    v_xor_b32 v22, v14, v22
    v_xor_b32 v23, v14, v23
    v_or3_b32 v24, v20, v21, v22
    v_or_b32 v24, v24, v23
    v_and_b32 v24, 0xff, v24
    v_cmp_ne_u32 vcc, 0, v24
    v_permlane16_swap_b32 v20, v21
    v_permlane16_swap_b32 v22, v23
    s_cbranch_vccz L_hp_got
    s_cmp_eq_u32 s35, 0
    s_cbranch_scc1 L_hp_got
    s_sub_u32 s35, s35, 1
    s_branch L_hp_poll
L_hp_got:
    v_add_f32 v20, v20, v21
    v_add_f32 v22, v22, v23
    s_nop 1
    v_permlane32_swap_b32 v20, v22
    v_add_f32 v20, v20, v22
    s_nop 1
    v_add_f32_dpp v21, v20, v20 row_ror:8 row_mask:0xf bank_mask:0xf
    v_add_f32_dpp v20, v20, v20 row_ror:8 row_mask:0xf bank_mask:0xf
    s_nop 1
    v_permlane16_swap_b32 v20, v21
    v_cvt_pk_bf16_f32 v20, v20, v21
    v_and_b32 v21, 0xffff0000, v20
    v_lshlrev_b32 v20, 16, v20
    v_mul_f32 v22, 0xbfb8aa3b, v20
    v_exp_f32 v22, v22
    s_nop 0
    v_add_f32 v22, 1.0, v22
    v_rcp_f32 v22, v22
    s_nop 0
    v_mul_f32 v20, v20, v22
    v_cvt_pk_bf16_f32 v20, v20, v20
    v_lshlrev_b32 v20, 16, v20
    v_mul_f32 v20, v20, v21
    v_cvt_pk_bf16_f32 v20, v20, v20
    ds_write_b16 v16, v20 offset:42368
    s_mov_b64 exec, 1
    ds_add_u32 v0, v255 offset:42852
    s_mov_b64 exec, -1
L_sync16:
    ds_read_b32 v1, v0 offset:42852
    ds_read_b128 v[28:31], v17 offset:42368
    ds_read_b128 v[32:35], v17 offset:42432
    s_waitcnt lgkmcnt(2)
    v_readfirstlane_b32 s31, v1
    s_nop 0
    s_cmp_ge_u32 s31, 4
    s_cbranch_scc0 L_sync16
    s_waitcnt lgkmcnt(1)
    v_mfma_f32_16x16x32_bf16 v[36:39], v[28:31], v[100:103], 0
    v_mfma_f32_16x16x32_bf16 v[40:43], v[28:31], v[104:107], 0
    v_mfma_f32_16x16x32_bf16 v[44:47], v[28:31], v[108:111], 0
    v_mfma_f32_16x16x32_bf16 v[48:51], v[28:31], v[112:115], 0
    s_waitcnt lgkmcnt(0)
    v_mfma_f32_16x16x32_bf16 v[36:39], v[32:35], v[116:119], v[36:39]
    v_mfma_f32_16x16x32_bf16 v[40:43], v[32:35], v[120:123], v[40:43]
    v_mfma_f32_16x16x32_bf16 v[44:47], v[32:35], v[124:127], v[44:47]
    v_mfma_f32_16x16x32_bf16 v[48:51], v[32:35], v[128:131], v[48:51]
    s_mov_b32 vcc_lo, 0xffff0000
    s_mov_b32 vcc_hi, 0xffff0000
    s_mov_b32 s52, 0
    s_mov_b32 s53, -1
    s_nop 1
    v_cndmask_b32 v36, v36, v40, vcc
    s_nop 0
    v_cndmask_b32 v44, v44, v48, vcc
    v_cndmask_b32 v36, v36, v44, s[52:53]
    v_and_or_b32 v36, v36, s49, v14
    buffer_store_dword v36, v18, s[12:15], 0 offen sc1
    s_mov_b64 exec, 1
    ds_add_u32 v0, v255 offset:42856
    s_mov_b64 exec, -1
    s_branch L_owner
L_idle:
    s_mov_b64 exec, 1
    ds_add_u32 v0, v255 offset:42868
    s_mov_b64 exec, -1
    s_mov_b64 exec, 1
    ds_add_u32 v0, v255 offset:42848
    s_mov_b64 exec, -1
    s_mov_b64 exec, 1
    ds_add_u32 v0, v255 offset:42852
    s_mov_b64 exec, -1
    s_mov_b64 exec, 1
    ds_add_u32 v0, v255 offset:42856
    s_mov_b64 exec, -1
    s_waitcnt lgkmcnt(0)
    v_readfirstlane_b32 s33, v19
    v_readfirstlane_b32 s34, v18
L_owner:
    s_setprio 1
    s_and_b32 s31, s2, 7
    s_sub_u32 s32, 8, s31
    s_min_u32 s46, s31, s32
    s_lshr_b32 s53, s31, 2
    s_lshr_b32 s47, s2, 3
    s_and_b32 s32, s47, 1
    s_and_b32 s31, s31, 3
    s_cselect_b32 s53, s53, s32
    s_cselect_b32 s31, 0, 1
    s_lshr_b32 s47, s47, s31
    s_lshl_b32 s53, s53, 4
    s_lshl_b32 s53, s53, 3
    s_add_u32 s53, s53, s46
    s_andn2_b32 s51, 0x7ff, s33
    s_mov_b32 s54, s51
    s_mov_b32 s55, 0
    s_mov_b32 s56, 0
    s_mov_b32 s16, s44
    s_mov_b32 s17, s45
    s_mov_b32 s18, 0x400000
    v_and_b32 v8, 31, v2
    v_lshlrev_b32 v15, 2, v8
    v_lshlrev_b32 v8, 1, v8
    v_mov_b32 v16, 0
L_seg:
    s_xor_b32 s31, s54, s53
    s_and_b32 s31, s31, 0x87
    s_cbranch_scc1 L_seg_next
    s_lshl_b32 s31, s51, 11
    s_lshl_b32 s32, s47, 6
    s_add_u32 s63, s31, s32
    buffer_load_ushort v9, v8, s[8:11], s63 offen
    v_lshrrev_b32 v4, 3, v2
    s_lshl_b32 s31, s30, 4
    v_add_u32 v4, s31, v4
    v_lshlrev_b32 v4, 12, v4
    s_lshl_b32 s31, s47, 7
    s_add_u32 s31, s31, 524288
    v_add3_u32 v4, v4, v7, s31
    s_mov_b32 s62, 32768
    v_mov_b32 v24, v14
    v_mov_b32 v25, v14
    v_mov_b32 v26, v14
    v_mov_b32 v27, v14
    v_lshrrev_b32 v5, 4, v2
    v_lshl_add_u32 v6, v5, 2, v7
    s_lshl_b32 s31, s30, 7
    s_add_u32 s31, s31, s55
    v_add_u32 v6, s31, v6
    s_ashr_i32 s31, s33, 31
    s_orn2_b32 s31, 0x80000000, s31
    s_xor_b32 s31, s31, s33
    s_and_b32 s31, s31, 0xfffff800
    v_cvt_pk_bf16_f32 v11, s31, s31
    v_lshlrev_b32 v11, 16, v11
    v_mul_f32 v11, 0xbfb8aa3b, v11
    v_exp_f32 v11, v11
    s_and_b32 s32, s34, 0xffff0000
    v_add_f32 v11, 1.0, v11
    v_rcp_f32 v11, v11
    v_rcp_f32 v12, s32
    v_cvt_pk_bf16_f32 v11, v11, v11
    v_lshlrev_b32 v11, 16, v11
    s_lshl_b32 s31, s34, 16
    s_waitcnt vmcnt(0)
    v_lshl_add_u32 v13, v8, 1, s55
    s_mov_b64 vcc, -1
    s_mov_b32 s56, 1
L_y_poll:
    s_mov_b64 exec, vcc
    buffer_load_dwordx4 v[20:23], v4, s[12:15], 0 offen sc1
    s_cmp_eq_u32 s30, 3
    s_cbranch_scc1 L_y_one
    buffer_load_dwordx4 v[24:27], v4, s[12:15], s62 offen sc1
L_y_one:
    s_mov_b64 exec, -1
    s_waitcnt vmcnt(0)
    v_xor_b32 v28, v14, v20
    v_xor_b32 v29, v14, v21
    v_xor_b32 v30, v14, v22
    v_xor_b32 v31, v14, v23
    v_xor_b32 v32, v14, v24
    v_xor_b32 v33, v14, v25
    v_xor_b32 v34, v14, v26
    v_xor_b32 v35, v14, v27
    v_or3_b32 v1, v28, v29, v30
    v_or3_b32 v1, v1, v31, v32
    v_or3_b32 v1, v1, v33, v34
    v_or_b32 v1, v1, v35
    v_and_b32 v1, 0xff, v1
    v_cmp_ne_u32 vcc, 0, v1
    v_pk_add_f32 v[28:29], v[28:29], v[32:33]
    v_pk_add_f32 v[30:31], v[30:31], v[34:35]
    s_cbranch_vccz L_y_got
    s_cmp_eq_u32 s35, 0
    s_cbranch_scc1 L_y_got
    s_sub_u32 s35, s35, 1
    s_branch L_y_poll
L_y_got:
    v_permlane16_swap_b32 v28, v29
    v_permlane16_swap_b32 v30, v31
    v_add_f32 v28, v28, v29
    v_add_f32 v30, v30, v31
    s_nop 1
    v_permlane32_swap_b32 v28, v30
    v_add_f32 v28, v28, v30
    s_nop 1
    v_add_f32_dpp v28, v28, v28 row_ror:8 row_mask:0xf bank_mask:0xf
    ds_write_b32 v6, v28 offset:43008
    s_mov_b64 exec, 1
    ds_add_u32 v16, v255 offset:42836
    s_mov_b64 exec, -1
    s_cmp_lg_u32 s30, 0
    s_cbranch_scc1 L_seg_next
    s_cmp_eq_u32 s47, 0
    s_cselect_b32 s32, 0, 2147483392
    v_mov_b32 v5, 2147483392
    v_writelane_b32 v5, s32, 0
    v_mov_b32 v18, s28
    v_mov_b32 v19, s29
    s_lshl_b32 s31, s34, 16
    v_lshlrev_b32 v9, 16, v9
    v_subrev_f32 v10, s31, v9
    v_cvt_pk_bf16_f32 v10, v10, v10
    v_lshlrev_b32 v10, 16, v10
    v_mul_f32 v10, v10, v12
    v_cvt_pk_bf16_f32 v10, v10, v10
    v_lshlrev_b32 v10, 16, v10
L_sync17:
    ds_read_b32 v1, v16 offset:42836
    ds_read_b32 v20, v13 offset:43008
    ds_read_b32 v21, v13 offset:43136
    ds_read_b32 v22, v13 offset:43264
    ds_read_b32 v23, v13 offset:43392
    ds_read_b32 v24, v15 offset:42496
    s_waitcnt lgkmcnt(5)
    v_readfirstlane_b32 s31, v1
    s_nop 0
    s_cmp_ge_u32 s31, 5
    s_cbranch_scc0 L_sync17
    s_waitcnt lgkmcnt(0)
    v_add_f32 v20, v20, v21
    v_add_f32 v22, v22, v23
    v_add_f32 v20, v20, v22
    v_cvt_pk_bf16_f32 v20, v20, v20
    v_lshlrev_b32 v20, 16, v20
    v_mul_f32 v20, v20, v11
    v_cvt_pk_bf16_f32 v20, v20, v20
    v_lshlrev_b32 v20, 16, v20
    v_add_f32 v20, v20, v10
    v_cvt_pk_bf16_f32 v20, v20, v20
    v_lshlrev_b32 v20, 16, v20
    v_mul_f32 v1, 0xbfb8aa3b, v20
    v_mul_f32 v20, v1, v24
    v_exp_f32 v1, v1
    s_nop 0
    v_add_f32 v1, 1.0, v1
    v_rcp_f32 v1, v1
    s_mov_b32 exec_hi, 0
    v_fma_f32 v20, v20, v1, v9
    v_cvt_pk_bf16_f32 v20, v20, v20
    buffer_store_short v20, v8, s[16:19], s63 offen sc1
    buffer_store_dwordx2 v[18:19], v5, s[12:15], 0 offen sc1
    s_mov_b64 exec, -1
L_seg_next:
    s_cmp_lg_u32 s55, 0
    s_cbranch_scc1 L_seg_end
    s_mov_b32 s55, 512
    s_sub_u32 s54, 0, s51
    s_sub_u32 s47, 31, s47
    v_mov_b32 v16, 28
    v_and_b32 v15, 24, v2
    v_xor_b32 v15, 24, v15
    v_sub_u32 v1, 0, v2
    v_and_b32 v1, 7, v1
    v_add_u32 v15, v15, v1
    v_lshlrev_b32 v15, 2, v15
    v_add_u32 v15, 128, v15
    s_branch L_seg
L_seg_end:
L_fin:
L_exit:
    s_endpgm
L_code_end:
.section .rodata,"a"
.p2align 6
.amdhsa_kernel recurrent_scan__spectral_fnet__moe_arch_mod__prompt_kernel
  .amdhsa_next_free_vgpr 256
  .amdhsa_next_free_sgpr 92
  .amdhsa_accum_offset 256
  .amdhsa_group_segment_fixed_size 0
  .amdhsa_kernarg_size 104
  .amdhsa_user_sgpr_count 2
  .amdhsa_user_sgpr_kernarg_segment_ptr 1
  .amdhsa_system_sgpr_workgroup_id_x 1
  .amdhsa_float_denorm_mode_32 3
.end_amdhsa_kernel
```

```asm
; @launch grid=(256,1,1) block=(512,1,1) lds=158720
.amdgcn_target "amdgcn-amd-amdhsa--gfx950"
.text
.globl recurrent_scan__spectral_fnet__moe_arch_mod__prompt_kernel
.p2align 8
.type recurrent_scan__spectral_fnet__moe_arch_mod__prompt_kernel,@function
recurrent_scan__spectral_fnet__moe_arch_mod__prompt_kernel:
    s_cmp_ge_u32 s2, 256
    s_cbranch_scc1 L_exit
    s_load_dwordx2 s[8:9], s[0:1], 0
    s_load_dwordx4 s[36:39], s[0:1], 48
    s_load_dwordx2 s[12:13], s[0:1], 96
    s_getpc_b64 s[32:33]
L_pc:
    s_bfe_u32 s31, s2, 0x30003
    v_subrev_u32 v3, 492, v0
    v_lshl_add_u32 v3, v3, 3, s31
    v_lshlrev_b32 v3, 7, v3
    v_cmp_gt_u32 vcc, L_code_end-L_pc, v3
    s_nop 0
    s_and_saveexec_b64 s[46:47], vcc
    s_cbranch_execz L_nopf
    global_load_dword v254, v3, s[32:33]
L_nopf:
    s_mov_b64 exec, -1
    v_lshrrev_b32 v1, 6, v0
    v_and_b32 v2, 63, v0
    v_readfirstlane_b32 s30, v1
    s_mov_b32 s10, 0x400000
    s_mov_b32 s11, 0x00020000
    s_mov_b32 s14, 0x10000000
    s_mov_b32 s15, 0x00020000
    s_mov_b32 s35, 65536
    s_mov_b32 s92, 0
    v_lshlrev_b32 v3, 4, v2
    v_mov_b32 v0, 0
    v_mov_b32 v255, 1
    s_mov_b32 s3, s30
    s_and_b32 s30, s30, 3
    s_cmp_ge_u32 s3, 4
    s_cbranch_scc1 L_moe
    s_and_b32 s31, s2, 7
    s_lshr_b32 s32, s2, 4
    s_sub_u32 s32, 15, s32
    s_lshl_b32 s32, s32, 3
    s_add_u32 s46, s32, s31
    s_bfe_u32 s47, s2, 0x10003
    s_lshl_b32 s31, s47, 2
    s_add_u32 s51, s31, s30
    s_lshl_b32 s31, s51, 8
    s_add_u32 s52, s31, s46
    s_xor_b32 s54, s52, 1024
    s_sub_u32 s53, 2048, s52
    s_add_u32 s31, s52, 128
    s_cmp_eq_u32 s46, 0
    s_cselect_b32 s53, s31, s53
    s_cselect_b32 s50, 1, 0
    s_xor_b32 s55, s53, 1024
    s_lshl_b32 s56, s52, 11
    s_lshl_b32 s57, s53, 11
    s_lshl_b32 s58, s54, 11
    s_lshl_b32 s59, s55, 11
    s_mov_b32 s22, 2048
    s_mov_b32 s23, 0x00020000
    v_mov_b32 v1, 0
    v_and_b32 v6, 15, v2
    v_lshlrev_b32 v6, 2, v6
    ds_write_b64 v0, v[0:1] offset:41504
    ds_write_b32 v6, v0 offset:42816
    s_waitcnt lgkmcnt(0)
    s_load_dwordx2 s[28:29], s[12:13], 0
    s_load_dwordx2 s[16:17], s[0:1], 80
    buffer_load_dwordx4 v[120:123], v3, s[8:11], s56 offen
    buffer_load_dwordx4 v[124:127], v3, s[8:11], s56 offen offset:1024
    buffer_load_dwordx4 v[128:131], v3, s[8:11], s57 offen
    buffer_load_dwordx4 v[132:135], v3, s[8:11], s57 offen offset:1024
    s_mov_b32 s20, s36
    s_mov_b32 s21, s37
    buffer_load_dwordx4 v[152:155], v3, s[20:23], 0 offen
    buffer_load_dwordx4 v[156:159], v3, s[20:23], 0 offen offset:1024
    buffer_load_dwordx4 v[136:139], v3, s[8:11], s58 offen
    buffer_load_dwordx4 v[140:143], v3, s[8:11], s58 offen offset:1024
    buffer_load_dwordx4 v[144:147], v3, s[8:11], s59 offen
    buffer_load_dwordx4 v[148:151], v3, s[8:11], s59 offen offset:1024
    s_barrier
    s_branch L_dft_rest
L_moe:
    s_load_dwordx2 s[20:21], s[0:1], 64
    s_and_b32 s32, s2, 7
    s_mul_i32 s32, s32, 28
    s_lshr_b32 s31, s2, 3
    s_add_u32 s31, s31, s32
    s_lshr_b32 s46, s31, 3
    s_lshl_b32 s46, s46, 1
    s_and_b32 s47, s31, 7
    s_mov_b32 s75, 0
    s_mov_b32 s18, 7340032
    s_mov_b32 s19, 0x00020000
    s_mov_b32 s22, 7340032
    s_mov_b32 s23, 0x00020000
    s_mov_b32 s26, 7340032
    s_mov_b32 s27, 0x00020000
    v_lshrrev_b32 v4, 4, v2
    v_lshlrev_b32 v5, 5, v4
    v_and_b32 v6, 0x70, v3
    v_xor_b32 v5, v5, v6
    v_mul_u32_u24 v4, 7168, v4
    s_mul_i32 s31, s47, 917504
    s_lshl_b32 s32, s46, 7
    s_add_u32 s31, s31, s32
    v_add3_u32 v4, v4, v5, s31
    s_cmp_eq_u32 s75, 0
    s_mov_b32 s31, 917504
    s_cselect_b32 s31, 128, s31
    v_add_u32 v6, s31, v4
    s_mov_b32 vcc_lo, 0xff00ff00
    s_mov_b32 vcc_hi, 0xff00ff00
    v_cndmask_b32 v5, v6, v4, vcc
    v_cndmask_b32 v4, v4, v6, vcc
    s_mov_b32 s48, 0
    s_mov_b32 s49, 76800
    s_waitcnt lgkmcnt(0)
    s_mov_b32 s16, s38
    s_mov_b32 s17, s39
    s_load_dwordx2 s[28:29], s[12:13], 0
    s_load_dwordx2 s[24:25], s[0:1], 72
    s_load_dwordx2 s[44:45], s[0:1], 80
    s_barrier
    s_cmp_ge_u32 s2, 224
    s_cselect_b32 s66, 0, 1
    s_cbranch_scc1 L_dma_done
    s_cmp_lg_u32 s30, 0
    s_cbranch_scc1 L_dma_done
    s_setprio 3
L_dma0:
    s_mov_b32 m0, s49
    s_waitcnt vmcnt(19)
    buffer_load_dwordx4 v4, s[16:19], s48 offen nt lds
    s_add_u32 m0, s49, 32768
    s_add_u32 s49, s49, 1024
    s_waitcnt vmcnt(19)
    buffer_load_dwordx4 v4, s[20:23], s48 offen nt lds
    s_add_u32 s48, s48, 28672
    s_mov_b32 m0, s49
    s_waitcnt vmcnt(19)
    buffer_load_dwordx4 v4, s[16:19], s48 offen nt lds
    s_add_u32 m0, s49, 32768
    s_add_u32 s49, s49, 1024
    s_waitcnt vmcnt(19)
    buffer_load_dwordx4 v4, s[20:23], s48 offen nt lds
    s_add_u32 s48, s48, 28672
    s_mov_b32 m0, s49
    s_waitcnt vmcnt(19)
    buffer_load_dwordx4 v5, s[16:19], s48 offen nt lds
    s_add_u32 m0, s49, 32768
    s_add_u32 s49, s49, 1024
    s_waitcnt vmcnt(19)
    buffer_load_dwordx4 v5, s[20:23], s48 offen nt lds
    s_add_u32 s48, s48, 28672
    s_mov_b32 m0, s49
    s_waitcnt vmcnt(19)
    buffer_load_dwordx4 v5, s[16:19], s48 offen nt lds
    s_add_u32 m0, s49, 32768
    s_add_u32 s49, s49, 1024
    s_waitcnt vmcnt(19)
    buffer_load_dwordx4 v5, s[20:23], s48 offen nt lds
    s_add_u32 s48, s48, 28672
    s_cmp_lt_u32 s48, 917504
    s_cbranch_scc1 L_dma0
    s_branch L_dma_done
L_dft_rest:
    s_mov_b32 s18, 0x400000
    s_mov_b32 s19, 0x00020000
    s_sub_u32 s31, 2047, s52
    s_sub_u32 s32, 2047, s53
    v_mov_b32 v200, s31
    v_writelane_b32 v200, s32, 63
    s_lshl_b32 s31, s30, 2
    v_mov_b32 v201, s31
    s_bfe_u32 s31, s53, 0x20008
    s_lshl_b32 s31, s31, 2
    s_add_u32 s31, s31, 16
    v_writelane_b32 v201, s31, 63
    v_and_b32 v6, 32, v2
    s_lshl_b32 s31, s51, 2
    v_add_u32 v203, s31, v6
    v_lshrrev_b32 v202, 1, v203
    s_lshl_b32 s31, s2, 4
    s_add_u32 s31, s31, 4096
    v_mov_b32 v4, s31
    v_lshlrev_b32 v5, 3, v2
    s_and_b32 s31, s52, 7
    s_lshl_b32 s31, s31, 11
    s_and_b32 s32, s52, 1024
    s_add_u32 s31, s31, s32
    s_and_b32 s32, s52, 0xf8
    s_lshl_b32 s32, s32, 2
    s_add_u32 s31, s31, s32
    s_add_u32 s31, s31, 32768
    v_writelane_b32 v4, s31, 0
    s_add_u32 s31, s31, 16
    v_writelane_b32 v4, s31, 1
    s_and_b32 s31, s53, 7
    s_lshl_b32 s31, s31, 11
    s_and_b32 s32, s53, 1024
    s_add_u32 s31, s31, s32
    s_and_b32 s32, s53, 0xf8
    s_lshl_b32 s32, s32, 2
    s_add_u32 s31, s31, s32
    s_add_u32 s31, s31, 32768
    v_writelane_b32 v4, s31, 2
    s_add_u32 s31, s31, 16
    v_writelane_b32 v4, s31, 3
    s_mul_i32 s31, s51, 2592
    v_and_b32 v204, 32, v2
    v_lshlrev_b32 v204, 2, v204
    v_add3_u32 v204, v204, v3, s31
    s_lshl_b32 s32, s31, 1
    s_add_u32 s32, s32, 21872
    v_sub_u32 v205, s32, v204
    v_bfe_u32 v206, v2, 2, 2
    v_mul_u32_u24 v206, 2592, v206
    v_lshrrev_b32 v6, 4, v2
    v_mul_u32_u24 v7, 640, v6
    v_add_u32 v206, v206, v7
    v_and_b32 v7, 3, v2
    v_lshlrev_b32 v7, 3, v7
    s_lshl_b32 s31, s30, 7
    v_add3_u32 v206, v206, v7, s31
    v_lshlrev_b32 v6, 12, v6
    v_and_b32 v7, 15, v2
    v_lshl_add_u32 v6, v7, 4, v6
    s_lshl_b32 s31, s30, 8
    v_add_u32 v207, s31, v6
    v_bfe_i32 v208, v2, 4, 1
    v_and_b32 v208, 0x80008000, v208
    s_cmp_eq_u32 s47, 0
    s_movk_i32 s48, 0x7403
    s_cselect_b32 s48, 0x7721, s48
    v_and_b32 v250, 12, v2
    v_bfe_u32 v250, s48, v250, 4
    v_lshrrev_b32 v251, 4, v2
    v_bfe_u32 v252, v2, 1, 1
    v_mul_u32_u24 v251, v251, v252
    v_and_b32 v252, 1, v2
    v_add_u32 v251, v251, v252
    v_cvt_f32_u32 v250, v250
    v_cvt_f32_u32 v251, v251
    v_mul_f32 v250, 0x3e000000, v250
    v_mul_f32 v251, 0x3e800000, v251
    v_cos_f32 v8, v251
    v_add_f32 v251, v251, v250
    v_cos_f32 v9, v251
    v_add_f32 v251, v251, v250
    v_cos_f32 v10, v251
    v_add_f32 v251, v251, v250
    v_cos_f32 v11, v251
    v_add_f32 v251, v251, v250
    v_cos_f32 v12, v251
    v_add_f32 v251, v251, v250
    v_cos_f32 v13, v251
    v_add_f32 v251, v251, v250
    v_cos_f32 v14, v251
    v_add_f32 v251, v251, v250
    v_cos_f32 v15, v251
    v_mul_f32 v8, 0xbf317218, v8
    v_mul_f32 v9, 0xbf317218, v9
    v_mul_f32 v10, 0xbf317218, v10
    v_mul_f32 v11, 0xbf317218, v11
    v_mul_f32 v12, 0xbf317218, v12
    v_mul_f32 v13, 0xbf317218, v13
    v_mul_f32 v14, 0xbf317218, v14
    v_mul_f32 v15, 0xbf317218, v15
    v_lshrrev_b32 v250, 2, v2
    v_and_b32 v250, 12, v250
    v_and_b32 v251, 15, v2
    v_lshlrev_b32 v251, 2, v251
    v_cvt_f32_u32 v250, v250
    v_cvt_f32_u32 v251, v251
    v_mul_f32 v212, 0x3c800000, v250
    s_lshl_b32 s31, s30, 2
    s_lshr_b32 s48, s48, s31
    s_and_b32 s48, s48, 15
    s_sub_u32 s31, s48, 4
    s_mul_i32 s31, s31, s46
    v_cvt_f32_i32 v252, s31
    v_mul_f32 v252, 0x3a000000, v252
    v_add_f32 v213, 0x3c800000, v212
    v_add_f32 v214, 0x3d000000, v212
    v_add_f32 v215, 0x3d400000, v212
    s_and_b32 s31, s2, 7
    s_sub_u32 s32, 8, s31
    s_min_u32 s76, s31, s32
    s_lshr_b32 s78, s31, 2
    s_lshr_b32 s77, s2, 3
    s_and_b32 s32, s77, 1
    s_and_b32 s31, s31, 3
    s_cselect_b32 s78, s78, s32
    s_cselect_b32 s31, 0, 1
    s_lshr_b32 s77, s77, s31
    s_lshl_b32 s78, s78, 4
    s_lshl_b32 s31, s30, 5
    s_add_u32 s78, s78, s31
    s_lshl_b32 s78, s78, 3
    s_add_u32 s78, s78, s76
    s_lshl_b32 s77, s77, 6
    s_sub_u32 s79, 1984, s77
    s_lshl_b32 s76, s76, 1
    s_add_u32 s76, s76, 2040
    v_and_b32 v116, 15, v2
    v_lshl_add_u32 v116, v116, 3, s78
    v_and_b32 v7, 32, v2
    v_lshl_add_u32 v7, v7, 5, v116
    s_mov_b32 vcc_lo, 0xffff0000
    s_mov_b32 vcc_hi, 0xffff0000
    v_sub_u32 v6, 0, v7
    v_cndmask_b32 v7, v7, v6, vcc
    v_and_b32 v6, 7, v7
    v_and_b32 v1, 1024, v7
    v_lshl_add_u32 v6, v6, 11, v1
    v_and_b32 v1, 0xf8, v7
    v_lshl_add_u32 v6, v1, 2, v6
    v_bfe_u32 v1, v7, 9, 1
    v_lshl_add_u32 v119, v1, 4, v6
    v_and_b32 v1, 256, v7
    v_cmp_ne_u32 s[88:89], 0, v1
    v_lshrrev_b32 v118, 2, v2
    v_lshl_add_u32 v118, v118, 3, s78
    v_lshlrev_b32 v1, 1, v2
    v_xor_b32 v1, v1, v3
    v_and_b32 v1, 48, v1
    v_add_u32 v114, 1024, v118
    v_sub_u32 v113, 0, v118
    v_and_b32 v113, 2047, v113
    v_sub_u32 v115, 2048, v114
    v_add_u32 v112, s77, v1
    v_lshl_add_u32 v114, v114, 11, v112
    v_lshl_add_u32 v112, v118, 11, v112
    v_xor_b32 v1, 48, v1
    v_add_u32 v1, s79, v1
    v_lshl_add_u32 v113, v113, 11, v1
    v_lshl_add_u32 v115, v115, 11, v1
    s_lshl_b32 s76, s30, 12
    s_add_u32 s76, s76, 44032
    v_and_b32 v1, 15, v2
    v_lshlrev_b32 v6, 6, v1
    v_lshlrev_b32 v1, 3, v2
    v_xor_b32 v1, v1, v2
    v_and_b32 v1, 48, v1
    v_add3_u32 v117, v6, v1, s76
    v_mul_f32 v250, v212, v251
    v_fmamk_f32 v52, v250, 0x3d800000, v252
    v_sin_f32 v20, v250
    v_cos_f32 v250, v250
    v_cos_f32 v48, v52
    v_sin_f32 v52, v52
    v_cvt_pk_f16_f32 v16, v250, v20
    v_cvt_pk_f16_f32 v20, -v20, v250
    v_mul_f32 v250, v213, v251
    v_fmamk_f32 v53, v250, 0x3d800000, v252
    v_sin_f32 v21, v250
    v_cos_f32 v250, v250
    v_cos_f32 v49, v53
    v_sin_f32 v53, v53
    v_cvt_pk_f16_f32 v17, v250, v21
    v_cvt_pk_f16_f32 v21, -v21, v250
    v_mul_f32 v250, v214, v251
    v_fmamk_f32 v54, v250, 0x3d800000, v252
    v_sin_f32 v22, v250
    v_cos_f32 v250, v250
    v_cos_f32 v50, v54
    v_sin_f32 v54, v54
    v_cvt_pk_f16_f32 v18, v250, v22
    v_cvt_pk_f16_f32 v22, -v22, v250
    v_mul_f32 v250, v215, v251
    v_fmamk_f32 v55, v250, 0x3d800000, v252
    v_sin_f32 v23, v250
    v_cos_f32 v250, v250
    v_cos_f32 v51, v55
    v_sin_f32 v55, v55
    v_cvt_pk_f16_f32 v19, v250, v23
    v_cvt_pk_f16_f32 v23, -v23, v250
    v_add_f32 v251, 1.0, v251
    v_mul_f32 v250, v212, v251
    v_fmamk_f32 v60, v250, 0x3d800000, v252
    v_sin_f32 v28, v250
    v_cos_f32 v250, v250
    v_cos_f32 v56, v60
    v_sin_f32 v60, v60
    v_cvt_pk_f16_f32 v24, v250, v28
    v_cvt_pk_f16_f32 v28, -v28, v250
    v_mul_f32 v250, v213, v251
    v_fmamk_f32 v61, v250, 0x3d800000, v252
    v_sin_f32 v29, v250
    v_cos_f32 v250, v250
    v_cos_f32 v57, v61
    v_sin_f32 v61, v61
    v_cvt_pk_f16_f32 v25, v250, v29
    v_cvt_pk_f16_f32 v29, -v29, v250
    v_mul_f32 v250, v214, v251
    v_fmamk_f32 v62, v250, 0x3d800000, v252
    v_sin_f32 v30, v250
    v_cos_f32 v250, v250
    v_cos_f32 v58, v62
    v_sin_f32 v62, v62
    v_cvt_pk_f16_f32 v26, v250, v30
    v_cvt_pk_f16_f32 v30, -v30, v250
    v_mul_f32 v250, v215, v251
    v_fmamk_f32 v63, v250, 0x3d800000, v252
    v_sin_f32 v31, v250
    v_cos_f32 v250, v250
    v_cos_f32 v59, v63
    v_sin_f32 v63, v63
    v_cvt_pk_f16_f32 v27, v250, v31
    v_cvt_pk_f16_f32 v31, -v31, v250
    v_add_f32 v251, 1.0, v251
    v_mov_b32 v160, 0
    v_mov_b32 v161, 0
    v_mov_b32 v162, 0
    v_mov_b32 v163, 0
    v_mov_b32 v164, 0
    v_mov_b32 v165, 0
    v_mov_b32 v166, 0
    v_mov_b32 v167, 0
    v_mov_b32 v168, 0
    v_mov_b32 v169, 0
    v_mov_b32 v170, 0
    s_mov_b32 s57, 0x3f803f80
    s_mov_b32 s59, 0xffff
    s_brev_b32 s67, 1
    s_mov_b32 s66, 0
    s_brev_b32 s64, 1
    s_brev_b32 s65, 1
    s_cmp_eq_u32 s47, 0
    s_movk_i32 s62, -10368
    s_cselect_b32 s62, 10368, s62
    s_waitcnt lgkmcnt(0)
    s_add_u32 s28, s28, 0x7f4a7c15
    s_addc_u32 s29, s29, 0x9e3779b9
    v_mov_b32 v174, s28
    v_mov_b32 v175, s29
    s_cmp_lt_u32 s2, 224
    s_cbranch_scc1 L_epoch_ok
L_sync1:
    ds_read_b32 v1, v0 offset:42872
    s_add_u32 s92, s92, 1
    s_bitcmp1_b32 s92, 20
    s_cbranch_scc1 L_sync1x
    s_waitcnt lgkmcnt(0)
    v_readfirstlane_b32 s31, v1
    s_nop 0
    s_cmp_ge_u32 s31, 4
    s_cbranch_scc0 L_sync1
L_sync1x:
L_epoch_ok:
    s_setprio 3
    s_waitcnt vmcnt(8)
    v_dot2c_f32_bf16 v160, s57, v120
    v_dot2c_f32_bf16 v164, v120, v120
    v_dot2c_f32_bf16 v160, s57, v121
    v_dot2c_f32_bf16 v164, v121, v121
    v_dot2c_f32_bf16 v160, s57, v122
    v_dot2c_f32_bf16 v164, v122, v122
    v_dot2c_f32_bf16 v160, s57, v123
    v_dot2c_f32_bf16 v164, v123, v123
    v_dot2c_f32_bf16 v160, s57, v124
    v_dot2c_f32_bf16 v164, v124, v124
    v_dot2c_f32_bf16 v160, s57, v125
    v_dot2c_f32_bf16 v164, v125, v125
    v_dot2c_f32_bf16 v160, s57, v126
    v_dot2c_f32_bf16 v164, v126, v126
    v_dot2c_f32_bf16 v160, s57, v127
    v_dot2c_f32_bf16 v164, v127, v127
    s_waitcnt vmcnt(6)
    v_dot2c_f32_bf16 v161, s57, v128
    v_dot2c_f32_bf16 v165, v128, v128
    v_dot2c_f32_bf16 v161, s57, v129
    v_dot2c_f32_bf16 v165, v129, v129
    v_dot2c_f32_bf16 v161, s57, v130
    v_dot2c_f32_bf16 v165, v130, v130
    v_dot2c_f32_bf16 v161, s57, v131
    v_dot2c_f32_bf16 v165, v131, v131
    v_dot2c_f32_bf16 v161, s57, v132
    v_dot2c_f32_bf16 v165, v132, v132
    v_dot2c_f32_bf16 v161, s57, v133
    v_dot2c_f32_bf16 v165, v133, v133
    v_dot2c_f32_bf16 v161, s57, v134
    v_dot2c_f32_bf16 v165, v134, v134
    v_dot2c_f32_bf16 v161, s57, v135
    v_dot2c_f32_bf16 v165, v135, v135
    s_waitcnt vmcnt(4)
    v_dot2c_f32_bf16 v170, s57, v152
    v_dot2c_f32_bf16 v170, s57, v153
    v_dot2c_f32_bf16 v170, s57, v154
    v_dot2c_f32_bf16 v170, s57, v155
    v_dot2c_f32_bf16 v170, s57, v156
    v_dot2c_f32_bf16 v170, s57, v157
    v_dot2c_f32_bf16 v170, s57, v158
    v_dot2c_f32_bf16 v170, s57, v159
    v_dot2c_f32_bf16 v168, v152, v120
    v_dot2c_f32_bf16 v169, v152, v128
    v_dot2c_f32_bf16 v168, v153, v121
    v_dot2c_f32_bf16 v169, v153, v129
    v_dot2c_f32_bf16 v168, v154, v122
    v_dot2c_f32_bf16 v169, v154, v130
    v_dot2c_f32_bf16 v168, v155, v123
    v_dot2c_f32_bf16 v169, v155, v131
    v_mov_b32 v171, v170
    v_dot2c_f32_bf16 v168, v156, v124
    v_dot2c_f32_bf16 v169, v156, v132
    v_dot2c_f32_bf16 v168, v157, v125
    v_dot2c_f32_bf16 v169, v157, v133
    v_dot2c_f32_bf16 v168, v158, v126
    v_dot2c_f32_bf16 v169, v158, v134
    v_dot2c_f32_bf16 v168, v159, v127
    v_dot2c_f32_bf16 v169, v159, v135
    v_permlane32_swap_b32 v160, v161
    v_permlane32_swap_b32 v164, v165
    v_permlane32_swap_b32 v170, v171
    v_permlane32_swap_b32 v168, v169
    v_add_f32 v160, v160, v161
    v_add_f32 v164, v164, v165
    v_add_f32 v170, v170, v171
    v_add_f32 v168, v168, v169
    v_add_f32_dpp v160, v160, v160 row_shr:1 row_mask:0xf bank_mask:0xf
    v_add_f32_dpp v164, v164, v164 row_shr:1 row_mask:0xf bank_mask:0xf
    v_add_f32_dpp v170, v170, v170 row_shr:1 row_mask:0xf bank_mask:0xf
    v_add_f32_dpp v168, v168, v168 row_shr:1 row_mask:0xf bank_mask:0xf
    v_add_f32_dpp v160, v160, v160 row_shr:2 row_mask:0xf bank_mask:0xf
    v_add_f32_dpp v164, v164, v164 row_shr:2 row_mask:0xf bank_mask:0xf
    v_add_f32_dpp v170, v170, v170 row_shr:2 row_mask:0xf bank_mask:0xf
    v_add_f32_dpp v168, v168, v168 row_shr:2 row_mask:0xf bank_mask:0xf
    v_add_f32_dpp v160, v160, v160 row_shr:4 row_mask:0xf bank_mask:0xf
    v_add_f32_dpp v164, v164, v164 row_shr:4 row_mask:0xf bank_mask:0xf
    v_add_f32_dpp v170, v170, v170 row_shr:4 row_mask:0xf bank_mask:0xf
    v_add_f32_dpp v168, v168, v168 row_shr:4 row_mask:0xf bank_mask:0xf
    v_add_f32_dpp v160, v160, v160 row_shr:8 row_mask:0xf bank_mask:0xf
    v_add_f32_dpp v164, v164, v164 row_shr:8 row_mask:0xf bank_mask:0xf
    v_add_f32_dpp v170, v170, v170 row_shr:8 row_mask:0xf bank_mask:0xf
    v_add_f32_dpp v168, v168, v168 row_shr:8 row_mask:0xf bank_mask:0xf
    v_add_f32_dpp v160, v160, v160 row_bcast:15 row_mask:0xa bank_mask:0xf
    v_add_f32_dpp v164, v164, v164 row_bcast:15 row_mask:0xa bank_mask:0xf
    v_add_f32_dpp v170, v170, v170 row_bcast:15 row_mask:0xa bank_mask:0xf
    v_add_f32_dpp v168, v168, v168 row_bcast:15 row_mask:0xa bank_mask:0xf
    v_mul_f32 v160, 0x3a800000, v160
    v_mul_f32 v164, 0x3a800000, v164
    v_fma_f32 v164, -v160, v160, v164
    v_cvt_pk_bf16_f32 v161, -v160, -v160
    v_max_f32 v164, 0, v164
    v_cvt_pk_bf16_f32 v164, v164, v164
    v_and_b32 v164, 0xffff0000, v164
    v_add_f32 v164, 0x3727c5ac, v164
    v_cvt_pk_bf16_f32 v164, v164, v164
    v_and_b32 v164, 0xffff0000, v164
    v_sqrt_f32 v164, v164
    v_and_b32 v165, 0xffff0000, v161
    v_cvt_pk_bf16_f32 v248, v160, v164
    v_and_b32 v164, 0xffff0000, v248
    v_rcp_f32 v164, v164
    v_fmac_f32 v168, v170, v165
    v_mul_f32 v168, v168, v164
    v_ashrrev_i32 v170, 31, v168
    v_or_b32 v170, 0x80000000, v170
    v_xor_b32 v168, v168, v170
    v_and_b32 v168, 0xfffff800, v168
    v_or_b32 v249, v200, v168
    s_mov_b64 exec, s[64:65]
    ds_write_b32 v201, v248 offset:41472
    ds_max_u64 v0, v[248:249] offset:41504
    s_mov_b64 exec, 1
    ds_add_rtn_u32 v1, v0, v255 offset:42816
    s_mov_b64 exec, 31
    ds_read_b64 v[172:173], v5 offset:41472
    s_mov_b64 exec, s[64:65]
    ds_write_b16 v202, v161 offset:41568
    ds_write_b32 v203, v164 offset:42752
    s_mov_b64 exec, -1
    s_nop 0
    v_mov_b32_dpp v6, v128 wave_rol:1 row_mask:0xf bank_mask:0xf
    v_mov_b32_dpp v7, v132 wave_rol:1 row_mask:0xf bank_mask:0xf
    v_bfi_b32 v221, s59, v131, v130
    v_bfi_b32 v222, s59, v130, v129
    v_bfi_b32 v223, s59, v129, v128
    v_bfi_b32 v217, s59, v135, v134
    v_bfi_b32 v218, s59, v134, v133
    v_bfi_b32 v219, s59, v133, v132
    v_cndmask_b32 v220, v6, v7, s[66:67]
    v_cndmask_b32 v216, v7, v6, s[66:67]
    v_bfi_b32 v220, s59, v220, v131
    v_bfi_b32 v216, s59, v216, v135
    s_waitcnt lgkmcnt(2)
    v_readfirstlane_b32 s31, v1
    s_nop 0
    s_cmp_lg_u32 s31, 3
    s_cbranch_scc1 L_not_last
    s_mov_b64 exec, 31
    buffer_store_dwordx4 v[172:175], v4, s[12:15], 0 offen sc1
    s_mov_b64 exec, -1
    s_waitcnt vmcnt(1)
    s_branch L_b_ready
L_not_last:
    s_waitcnt vmcnt(0)
L_b_ready:
    s_setprio 3
    ds_write_b128 v204, v[120:123] offset:0
    ds_write_b128 v204, v[124:127] offset:1280
    s_cmp_lg_u32 s50, 0
    s_cbranch_scc1 L_plain1
    ds_write_b128 v205, v[216:219]
    ds_write_b128 v205, v[220:223] offset:1280
    s_branch L_second1
L_plain1:
    ds_write_b128 v204, v[128:131] offset:20736
    ds_write_b128 v204, v[132:135] offset:22016
L_second1:
    v_add_u32 v204, s62, v204
    v_add_u32 v205, s62, v205
    v_dot2c_f32_bf16 v162, s57, v136
    v_dot2c_f32_bf16 v166, v136, v136
    v_dot2c_f32_bf16 v162, s57, v137
    v_dot2c_f32_bf16 v166, v137, v137
    v_dot2c_f32_bf16 v162, s57, v138
    v_dot2c_f32_bf16 v166, v138, v138
    v_dot2c_f32_bf16 v162, s57, v139
    v_dot2c_f32_bf16 v166, v139, v139
    v_dot2c_f32_bf16 v162, s57, v140
    v_dot2c_f32_bf16 v166, v140, v140
    v_dot2c_f32_bf16 v162, s57, v141
    v_dot2c_f32_bf16 v166, v141, v141
    v_dot2c_f32_bf16 v162, s57, v142
    v_dot2c_f32_bf16 v166, v142, v142
    v_dot2c_f32_bf16 v162, s57, v143
    v_dot2c_f32_bf16 v166, v143, v143
    ds_write_b128 v204, v[136:139] offset:0
    ds_write_b128 v204, v[140:143] offset:1280
    v_dot2c_f32_bf16 v163, s57, v144
    v_dot2c_f32_bf16 v167, v144, v144
    v_dot2c_f32_bf16 v163, s57, v145
    v_dot2c_f32_bf16 v167, v145, v145
    v_dot2c_f32_bf16 v163, s57, v146
    v_dot2c_f32_bf16 v167, v146, v146
    v_dot2c_f32_bf16 v163, s57, v147
    v_dot2c_f32_bf16 v167, v147, v147
    v_dot2c_f32_bf16 v163, s57, v148
    v_dot2c_f32_bf16 v167, v148, v148
    v_dot2c_f32_bf16 v163, s57, v149
    v_dot2c_f32_bf16 v167, v149, v149
    v_dot2c_f32_bf16 v163, s57, v150
    v_dot2c_f32_bf16 v167, v150, v150
    v_dot2c_f32_bf16 v163, s57, v151
    v_dot2c_f32_bf16 v167, v151, v151
    v_xor_b32 v202, 8, v202
    v_xor_b32 v203, 16, v203
    s_waitcnt lgkmcnt(2)
    s_nop 0
    v_mov_b32_dpp v6, v144 wave_rol:1 row_mask:0xf bank_mask:0xf
    v_mov_b32_dpp v7, v148 wave_rol:1 row_mask:0xf bank_mask:0xf
    v_bfi_b32 v221, s59, v147, v146
    v_bfi_b32 v222, s59, v146, v145
    v_bfi_b32 v223, s59, v145, v144
    v_bfi_b32 v217, s59, v151, v150
    v_bfi_b32 v218, s59, v150, v149
    v_bfi_b32 v219, s59, v149, v148
    v_cndmask_b32 v220, v6, v7, s[66:67]
    v_cndmask_b32 v216, v7, v6, s[66:67]
    v_bfi_b32 v220, s59, v220, v147
    v_bfi_b32 v216, s59, v216, v151
    s_cmp_lg_u32 s50, 0
    s_cbranch_scc1 L_plain3
    ds_write_b128 v205, v[216:219]
    ds_write_b128 v205, v[220:223] offset:1280
    s_branch L_second3
L_plain3:
    ds_write_b128 v204, v[144:147] offset:20736
    ds_write_b128 v204, v[148:151] offset:22016
L_second3:
    v_permlane32_swap_b32 v162, v163
    v_permlane32_swap_b32 v166, v167
    v_add_f32 v162, v162, v163
    v_add_f32 v166, v166, v167
    s_nop 0
    v_add_f32_dpp v162, v162, v162 row_shr:1 row_mask:0xf bank_mask:0xf
    v_add_f32_dpp v166, v166, v166 row_shr:1 row_mask:0xf bank_mask:0xf
    s_nop 0
    v_add_f32_dpp v162, v162, v162 row_shr:2 row_mask:0xf bank_mask:0xf
    v_add_f32_dpp v166, v166, v166 row_shr:2 row_mask:0xf bank_mask:0xf
    s_nop 0
    v_add_f32_dpp v162, v162, v162 row_shr:4 row_mask:0xf bank_mask:0xf
    v_add_f32_dpp v166, v166, v166 row_shr:4 row_mask:0xf bank_mask:0xf
    s_nop 0
    v_add_f32_dpp v162, v162, v162 row_shr:8 row_mask:0xf bank_mask:0xf
    v_add_f32_dpp v166, v166, v166 row_shr:8 row_mask:0xf bank_mask:0xf
    s_nop 0
    v_add_f32_dpp v162, v162, v162 row_bcast:15 row_mask:0xa bank_mask:0xf
    v_add_f32_dpp v166, v166, v166 row_bcast:15 row_mask:0xa bank_mask:0xf
    v_mul_f32 v162, 0x3a800000, v162
    v_mul_f32 v166, 0x3a800000, v166
    v_fma_f32 v166, -v162, v162, v166
    v_cvt_pk_bf16_f32 v161, -v162, -v162
    v_max_f32 v166, 0, v166
    v_cvt_pk_bf16_f32 v166, v166, v166
    v_and_b32 v166, 0xffff0000, v166
    v_add_f32 v166, 0x3727c5ac, v166
    v_cvt_pk_bf16_f32 v166, v166, v166
    v_and_b32 v166, 0xffff0000, v166
    v_sqrt_f32 v166, v166
    v_and_b32 v167, 0xffff0000, v161
    v_cvt_pk_bf16_f32 v248, v162, v166
    v_and_b32 v166, 0xffff0000, v248
    v_rcp_f32 v166, v166
    s_mov_b64 exec, s[64:65]
    ds_write_b16 v202, v161 offset:41568
    ds_write_b32 v203, v166 offset:42752
    s_mov_b64 exec, 1
    ds_add_u32 v0, v255 offset:42820
    s_mov_b64 exec, -1
L_sync2:
    ds_read_b32 v1, v0 offset:42820
    ds_read_b128 v[176:179], v0 offset:42752
    ds_read_b128 v[180:183], v0 offset:42768
    ds_read_b128 v[184:187], v0 offset:42784
    ds_read_b128 v[188:191], v0 offset:42800
    ds_read_b128 v[192:195], v0 offset:41568
    ds_read_b128 v[196:199], v0 offset:41584
    s_add_u32 s92, s92, 1
    s_bitcmp1_b32 s92, 20
    s_cbranch_scc1 L_sync2x
    s_waitcnt lgkmcnt(6)
    v_readfirstlane_b32 s31, v1
    s_nop 0
    s_cmp_ge_u32 s31, 4
    s_cbranch_scc0 L_sync2
L_sync2x:
    ds_read_b64_tr_b16 v[120:121], v206 offset:0
    ds_read_b64_tr_b16 v[122:123], v206 offset:10368
    ds_read_b64_tr_b16 v[124:125], v206 offset:20736
    ds_read_b64_tr_b16 v[126:127], v206 offset:31104
    ds_read_b64_tr_b16 v[128:129], v206 offset:32
    ds_read_b64_tr_b16 v[130:131], v206 offset:10400
    ds_read_b64_tr_b16 v[132:133], v206 offset:20768
    ds_read_b64_tr_b16 v[134:135], v206 offset:31136
    s_waitcnt lgkmcnt(10)
    s_nop 0
    ds_read_b64_tr_b16 v[136:137], v206 offset:64
    ds_read_b64_tr_b16 v[138:139], v206 offset:10432
    ds_read_b64_tr_b16 v[140:141], v206 offset:20800
    ds_read_b64_tr_b16 v[142:143], v206 offset:31168
    v_pk_mul_f32 v[176:177], v[176:177], v[8:9]
    v_pk_mul_f32 v[178:179], v[178:179], v[10:11]
    v_pk_mul_f32 v[180:181], v[180:181], v[12:13]
    v_pk_mul_f32 v[182:183], v[182:183], v[14:15]
    v_pk_mul_f32 v[184:185], v[184:185], v[8:9]
    v_pk_mul_f32 v[186:187], v[186:187], v[10:11]
    v_pk_mul_f32 v[188:189], v[188:189], v[12:13]
    v_pk_mul_f32 v[190:191], v[190:191], v[14:15]
    v_cvt_pk_bf16_f32 v160, v176, v177
    v_cvt_pk_bf16_f32 v152, v184, v185
    v_cvt_pk_bf16_f32 v161, v178, v179
    v_cvt_pk_bf16_f32 v153, v186, v187
    v_cvt_pk_bf16_f32 v162, v180, v181
    v_cvt_pk_bf16_f32 v154, v188, v189
    v_cvt_pk_bf16_f32 v163, v182, v183
    v_cvt_pk_bf16_f32 v155, v190, v191
    v_xor_b32 v164, v208, v160
    v_xor_b32 v156, v208, v152
    v_xor_b32 v165, v208, v161
    v_xor_b32 v157, v208, v153
    v_xor_b32 v166, v208, v162
    v_xor_b32 v158, v208, v154
    v_xor_b32 v167, v208, v163
    v_xor_b32 v159, v208, v155
    s_waitcnt lgkmcnt(12)
    s_cmp_lg_u32 s50, 0
    s_cbranch_scc1 L_st1_split
    v_mfma_f32_16x16x32_bf16 v[168:171], v[160:163], v[192:195], 0
    v_mfma_f32_16x16x32_bf16 v[168:171], v[152:155], v[196:199], v[168:171]
    s_waitcnt lgkmcnt(10)
    ds_read_b64_tr_b16 v[144:145], v206 offset:96
    ds_read_b64_tr_b16 v[146:147], v206 offset:10464
    ds_read_b64_tr_b16 v[148:149], v206 offset:20832
    ds_read_b64_tr_b16 v[150:151], v206 offset:31200
    v_mfma_f32_16x16x32_bf16 v[216:219], v[160:163], v[120:123], v[168:171]
    s_waitcnt lgkmcnt(12)
    v_mfma_f32_16x16x32_bf16 v[216:219], v[152:155], v[124:127], v[216:219]
    s_waitcnt lgkmcnt(10)
    v_mfma_f32_16x16x32_bf16 v[224:227], v[160:163], v[128:131], v[168:171]
    s_waitcnt lgkmcnt(8)
    v_mfma_f32_16x16x32_bf16 v[224:227], v[152:155], v[132:135], v[224:227]
    s_waitcnt lgkmcnt(6)
    v_mfma_f32_16x16x32_bf16 v[232:235], v[160:163], v[136:139], v[168:171]
    s_waitcnt lgkmcnt(4)
    v_mfma_f32_16x16x32_bf16 v[232:235], v[152:155], v[140:143], v[232:235]
    s_waitcnt lgkmcnt(2)
    v_mfma_f32_16x16x32_bf16 v[240:243], v[160:163], v[144:147], v[168:171]
    s_waitcnt lgkmcnt(0)
    v_mfma_f32_16x16x32_bf16 v[240:243], v[152:155], v[148:151], v[240:243]
    v_mfma_f32_16x16x32_bf16 v[220:223], v[164:167], v[120:123], 0
    v_mfma_f32_16x16x32_bf16 v[220:223], v[156:159], v[124:127], v[220:223]
    v_mfma_f32_16x16x32_bf16 v[228:231], v[164:167], v[128:131], 0
    v_mfma_f32_16x16x32_bf16 v[228:231], v[156:159], v[132:135], v[228:231]
    v_cvt_pk_f16_f32 v176, v216, v217
    v_cvt_pk_f16_f32 v177, v224, v225
    v_cvt_pk_f16_f32 v178, v232, v233
    s_nop 0
    v_cvt_pk_f16_f32 v179, v240, v241
    ds_write_b128 v207, v[176:179] offset:44032
    v_mfma_f32_16x16x32_bf16 v[236:239], v[164:167], v[136:139], 0
    v_mfma_f32_16x16x32_bf16 v[236:239], v[156:159], v[140:143], v[236:239]
    v_cvt_pk_f16_f32 v180, v218, v219
    v_cvt_pk_f16_f32 v181, v226, v227
    v_cvt_pk_f16_f32 v182, v234, v235
    v_cvt_pk_f16_f32 v183, v242, v243
    ds_write_b128 v207, v[180:183] offset:45056
    v_mfma_f32_16x16x32_bf16 v[244:247], v[164:167], v[144:147], 0
    v_mfma_f32_16x16x32_bf16 v[244:247], v[156:159], v[148:151], v[244:247]
    v_cvt_pk_f16_f32 v184, v220, v221
    v_cvt_pk_f16_f32 v185, v228, v229
    v_cvt_pk_f16_f32 v186, v236, v237
    s_nop 4
    v_cvt_pk_f16_f32 v187, v244, v245
    ds_write_b128 v207, v[184:187] offset:46080
    v_cvt_pk_f16_f32 v188, v222, v223
    v_cvt_pk_f16_f32 v189, v230, v231
    v_cvt_pk_f16_f32 v190, v238, v239
    v_cvt_pk_f16_f32 v191, v246, v247
    ds_write_b128 v207, v[188:191] offset:47104
    s_branch L_st1_done
L_st1_split:
    s_waitcnt lgkmcnt(8)
    ds_read_b64_tr_b16 v[144:145], v206 offset:96
    ds_read_b64_tr_b16 v[146:147], v206 offset:10464
    ds_read_b64_tr_b16 v[148:149], v206 offset:20832
    ds_read_b64_tr_b16 v[150:151], v206 offset:31200
    s_waitcnt lgkmcnt(0)
    v_mfma_f32_16x16x32_bf16 v[168:171], v[160:163], v[192:195], 0
    v_mfma_f32_16x16x32_bf16 v[220:223], v[164:167], v[120:123], 0
    v_mfma_f32_16x16x32_bf16 v[216:219], v[160:163], v[120:123], v[168:171]
    v_mfma_f32_16x16x32_bf16 v[228:231], v[164:167], v[128:131], 0
    v_mfma_f32_16x16x32_bf16 v[224:227], v[160:163], v[128:131], v[168:171]
    v_mfma_f32_16x16x32_bf16 v[236:239], v[164:167], v[136:139], 0
    v_mfma_f32_16x16x32_bf16 v[232:235], v[160:163], v[136:139], v[168:171]
    v_mfma_f32_16x16x32_bf16 v[244:247], v[164:167], v[144:147], 0
    v_mfma_f32_16x16x32_bf16 v[240:243], v[160:163], v[144:147], v[168:171]
    s_nop 1
    s_nop 0
    v_cvt_pk_f16_f32 v176, v216, v217
    v_cvt_pk_f16_f32 v180, v218, v219
    v_cvt_pk_f16_f32 v184, v220, v221
    v_cvt_pk_f16_f32 v188, v222, v223
    v_cvt_pk_f16_f32 v177, v224, v225
    v_cvt_pk_f16_f32 v181, v226, v227
    v_cvt_pk_f16_f32 v185, v228, v229
    v_cvt_pk_f16_f32 v189, v230, v231
    v_cvt_pk_f16_f32 v178, v232, v233
    v_cvt_pk_f16_f32 v182, v234, v235
    v_cvt_pk_f16_f32 v186, v236, v237
    v_cvt_pk_f16_f32 v190, v238, v239
    v_cvt_pk_f16_f32 v179, v240, v241
    v_cvt_pk_f16_f32 v183, v242, v243
    v_cvt_pk_f16_f32 v187, v244, v245
    v_cvt_pk_f16_f32 v191, v246, v247
    ds_write_b128 v207, v[176:179] offset:44032
    ds_write_b128 v207, v[180:183] offset:45056
    ds_write_b128 v207, v[184:187] offset:46080
    ds_write_b128 v207, v[188:191] offset:47104
    v_mfma_f32_16x16x32_bf16 v[168:171], v[152:155], v[196:199], 0
    v_mfma_f32_16x16x32_bf16 v[220:223], v[156:159], v[124:127], 0
    v_mfma_f32_16x16x32_bf16 v[216:219], v[152:155], v[124:127], v[168:171]
    v_mfma_f32_16x16x32_bf16 v[228:231], v[156:159], v[132:135], 0
    v_mfma_f32_16x16x32_bf16 v[224:227], v[152:155], v[132:135], v[168:171]
    v_mfma_f32_16x16x32_bf16 v[236:239], v[156:159], v[140:143], 0
    v_mfma_f32_16x16x32_bf16 v[232:235], v[152:155], v[140:143], v[168:171]
    v_mfma_f32_16x16x32_bf16 v[244:247], v[156:159], v[148:151], 0
    v_mfma_f32_16x16x32_bf16 v[240:243], v[152:155], v[148:151], v[168:171]
    s_waitcnt lgkmcnt(0)
    s_nop 0
    v_cvt_pk_f16_f32 v176, v216, v217
    v_cvt_pk_f16_f32 v180, v218, v219
    v_cvt_pk_f16_f32 v184, v220, v221
    v_cvt_pk_f16_f32 v188, v222, v223
    v_cvt_pk_f16_f32 v177, v224, v225
    v_cvt_pk_f16_f32 v181, v226, v227
    v_cvt_pk_f16_f32 v185, v228, v229
    v_cvt_pk_f16_f32 v189, v230, v231
    v_cvt_pk_f16_f32 v178, v232, v233
    v_cvt_pk_f16_f32 v182, v234, v235
    v_cvt_pk_f16_f32 v186, v236, v237
    v_cvt_pk_f16_f32 v190, v238, v239
    v_cvt_pk_f16_f32 v179, v240, v241
    v_cvt_pk_f16_f32 v183, v242, v243
    v_cvt_pk_f16_f32 v187, v244, v245
    v_cvt_pk_f16_f32 v191, v246, v247
    ds_write_b128 v207, v[176:179] offset:60416
    ds_write_b128 v207, v[180:183] offset:61440
    ds_write_b128 v207, v[184:187] offset:62464
    ds_write_b128 v207, v[188:191] offset:63488
L_st1_done:
    s_mov_b64 exec, 1
    ds_add_u32 v0, v255 offset:42824
    s_mov_b64 exec, -1
    s_lshl_b32 s31, s30, 12
    v_add_u32 v5, s31, v3
    s_and_b32 s31, s28, 0x30003
    v_mov_b32 v210, s31
    s_mov_b32 s58, 0xfffcfffc
    s_and_b32 s32, s48, 3
    s_cselect_b32 s72, -1, 0xff
    s_cselect_b32 s73, -1, 0
    s_mov_b32 s74, s48
    s_mov_b64 s[60:61], 0
    s_mov_b64 s[62:63], 0
    v_mov_b32 v209, 2147483392
    s_cmp_eq_u32 s48, 7
    s_cbranch_scc1 L_no_consts
    v_mul_f32 v250, v212, v251
    v_fmamk_f32 v68, v250, 0x3d800000, v252
    v_sin_f32 v36, v250
    v_cos_f32 v250, v250
    v_cos_f32 v64, v68
    v_sin_f32 v68, v68
    v_cvt_pk_f16_f32 v32, v250, v36
    v_cvt_pk_f16_f32 v36, -v36, v250
    v_mul_f32 v250, v213, v251
    v_fmamk_f32 v69, v250, 0x3d800000, v252
    v_sin_f32 v37, v250
    v_cos_f32 v250, v250
    v_cos_f32 v65, v69
    v_sin_f32 v69, v69
    v_cvt_pk_f16_f32 v33, v250, v37
    v_cvt_pk_f16_f32 v37, -v37, v250
    v_mul_f32 v250, v214, v251
    v_fmamk_f32 v70, v250, 0x3d800000, v252
    v_sin_f32 v38, v250
    v_cos_f32 v250, v250
    v_cos_f32 v66, v70
    v_sin_f32 v70, v70
    v_cvt_pk_f16_f32 v34, v250, v38
    v_cvt_pk_f16_f32 v38, -v38, v250
    v_mul_f32 v250, v215, v251
    v_fmamk_f32 v71, v250, 0x3d800000, v252
    v_sin_f32 v39, v250
    v_cos_f32 v250, v250
    v_cos_f32 v67, v71
    v_sin_f32 v71, v71
    v_cvt_pk_f16_f32 v35, v250, v39
    v_cvt_pk_f16_f32 v39, -v39, v250
    v_add_f32 v251, 1.0, v251
    v_mul_f32 v250, v212, v251
    v_fmamk_f32 v76, v250, 0x3d800000, v252
    v_sin_f32 v44, v250
    v_cos_f32 v250, v250
    v_cos_f32 v72, v76
    v_sin_f32 v76, v76
    v_cvt_pk_f16_f32 v40, v250, v44
    v_cvt_pk_f16_f32 v44, -v44, v250
    v_mul_f32 v250, v213, v251
    v_fmamk_f32 v77, v250, 0x3d800000, v252
    v_sin_f32 v45, v250
    v_cos_f32 v250, v250
    v_cos_f32 v73, v77
    v_sin_f32 v77, v77
    v_cvt_pk_f16_f32 v41, v250, v45
    v_cvt_pk_f16_f32 v45, -v45, v250
    v_mul_f32 v250, v214, v251
    v_fmamk_f32 v78, v250, 0x3d800000, v252
    v_sin_f32 v46, v250
    v_cos_f32 v250, v250
    v_cos_f32 v74, v78
    v_sin_f32 v78, v78
    v_cvt_pk_f16_f32 v42, v250, v46
    v_cvt_pk_f16_f32 v46, -v46, v250
    v_mul_f32 v250, v215, v251
    v_fmamk_f32 v79, v250, 0x3d800000, v252
    v_sin_f32 v47, v250
    v_cos_f32 v250, v250
    v_cos_f32 v75, v79
    v_sin_f32 v79, v79
    v_cvt_pk_f16_f32 v43, v250, v47
    v_cvt_pk_f16_f32 v47, -v47, v250
    s_and_b32 s31, s46, 1
    s_lshl_b32 s31, s31, 6
    s_lshr_b32 s32, s46, 1
    s_add_u32 s49, s31, s32
    s_bitcmp1_b32 s49, 2
    s_cselect_b64 vcc, -1, 0
    v_cndmask_b32 v80, v16, v20, vcc
    v_cndmask_b32 v84, v20, v16, vcc
    v_cndmask_b32 v81, v17, v21, vcc
    v_cndmask_b32 v85, v21, v17, vcc
    v_cndmask_b32 v82, v18, v22, vcc
    v_cndmask_b32 v86, v22, v18, vcc
    v_cndmask_b32 v83, v19, v23, vcc
    v_cndmask_b32 v87, v23, v19, vcc
    s_bfe_u32 s31, s49, 0x10001
    v_and_b32 v6, 7, v2
    v_xor_b32 v6, s31, v6
    v_lshlrev_b32 v6, 4, v6
    v_lshrrev_b32 v7, 4, v2
    v_lshlrev_b32 v7, 3, v7
    v_bfe_u32 v209, v2, 3, 1
    v_add_u32 v7, v7, v209
    v_mul_u32_u24 v7, 16512, v7
    v_add_u32 v209, v6, v7
    s_mul_i32 s31, s48, 528384
    s_lshl_b32 s32, s49, 7
    s_add_u32 s31, s31, s32
    s_add_u32 s60, s31, 2097152
L_no_consts:
L_st23:
L_sync3:
    ds_read_b32 v1, v0 offset:42824
    ds_read_b128 v[120:123], v5 offset:44032
    ds_read_b128 v[124:127], v5 offset:45056
    ds_read_b128 v[128:131], v5 offset:46080
    ds_read_b128 v[132:135], v5 offset:47104
    s_add_u32 s92, s92, 1
    s_bitcmp1_b32 s92, 20
    s_cbranch_scc1 L_sync3x
    s_waitcnt lgkmcnt(4)
    v_readfirstlane_b32 s31, v1
    s_nop 0
    s_cmp_ge_u32 s31, 4
    s_cbranch_scc0 L_sync3
L_sync3x:
    s_cmp_eq_u32 s48, 7
    s_cbranch_scc1 L_p1_done
    s_add_u32 s61, s60, 33024
    s_add_u32 s62, s61, 33024
    s_add_u32 s63, s62, 33024
    s_waitcnt lgkmcnt(3)
    v_mfma_f32_16x16x32_f16 v[136:139], v[120:123], v[16:19], 0
    v_mfma_f32_16x16x32_f16 v[140:143], v[120:123], v[20:23], 0
    s_waitcnt lgkmcnt(2)
    v_mfma_f32_16x16x32_f16 v[144:147], v[124:127], v[24:27], 0
    v_mfma_f32_16x16x32_f16 v[148:151], v[124:127], v[28:31], 0
    s_nop 3
    s_nop 0
    v_pk_mul_f32 v[152:153], v[48:49], v[136:137]
    v_pk_mul_f32 v[154:155], v[50:51], v[138:139]
    v_pk_mul_f32 v[156:157], v[52:53], v[136:137]
    v_pk_mul_f32 v[158:159], v[54:55], v[138:139]
    v_pk_fma_f32 v[152:153], v[52:53], v[140:141], v[152:153]
    v_pk_fma_f32 v[156:157], v[48:49], v[140:141], v[156:157] neg_lo:[0,0,1] neg_hi:[0,0,1]
    v_pk_fma_f32 v[154:155], v[54:55], v[142:143], v[154:155]
    v_pk_fma_f32 v[158:159], v[50:51], v[142:143], v[158:159] neg_lo:[0,0,1] neg_hi:[0,0,1]
    v_cvt_pk_f16_f32 v120, v152, v156
    v_cvt_pk_f16_f32 v121, v153, v157
    v_cvt_pk_f16_f32 v122, v154, v158
    v_cvt_pk_f16_f32 v123, v155, v159
    s_waitcnt lgkmcnt(1)
    s_nop 0
    v_mfma_f32_16x16x32_f16 v[136:139], v[128:131], v[32:35], 0
    v_mfma_f32_16x16x32_f16 v[140:143], v[128:131], v[36:39], 0
    v_mfma_f32_16x16x32_f16 v[216:219], v[80:83], v[120:123], 0
    v_mfma_f32_16x16x32_f16 v[220:223], v[84:87], v[120:123], 0
    v_pk_mul_f32 v[152:153], v[56:57], v[144:145]
    v_pk_mul_f32 v[154:155], v[58:59], v[146:147]
    v_pk_mul_f32 v[156:157], v[60:61], v[144:145]
    v_pk_mul_f32 v[158:159], v[62:63], v[146:147]
    v_pk_fma_f32 v[152:153], v[60:61], v[148:149], v[152:153]
    v_pk_fma_f32 v[156:157], v[56:57], v[148:149], v[156:157] neg_lo:[0,0,1] neg_hi:[0,0,1]
    v_pk_fma_f32 v[154:155], v[62:63], v[150:151], v[154:155]
    v_pk_fma_f32 v[158:159], v[58:59], v[150:151], v[158:159] neg_lo:[0,0,1] neg_hi:[0,0,1]
    v_cvt_pk_f16_f32 v124, v152, v156
    v_cvt_pk_f16_f32 v125, v153, v157
    v_cvt_pk_f16_f32 v126, v154, v158
    v_cvt_pk_f16_f32 v127, v155, v159
    s_waitcnt lgkmcnt(0)
    s_nop 0
    v_mfma_f32_16x16x32_f16 v[144:147], v[132:135], v[40:43], 0
    v_mfma_f32_16x16x32_f16 v[148:151], v[132:135], v[44:47], 0
    v_mfma_f32_16x16x32_f16 v[224:227], v[80:83], v[124:127], 0
    v_mfma_f32_16x16x32_f16 v[228:231], v[84:87], v[124:127], 0
    v_pk_mul_f32 v[152:153], v[64:65], v[136:137]
    v_pk_mul_f32 v[154:155], v[66:67], v[138:139]
    v_pk_mul_f32 v[156:157], v[68:69], v[136:137]
    v_pk_mul_f32 v[158:159], v[70:71], v[138:139]
    v_pk_fma_f32 v[152:153], v[68:69], v[140:141], v[152:153]
    v_pk_fma_f32 v[156:157], v[64:65], v[140:141], v[156:157] neg_lo:[0,0,1] neg_hi:[0,0,1]
    v_pk_fma_f32 v[154:155], v[70:71], v[142:143], v[154:155]
    v_pk_fma_f32 v[158:159], v[66:67], v[142:143], v[158:159] neg_lo:[0,0,1] neg_hi:[0,0,1]
    v_cvt_pk_f16_f32 v128, v152, v156
    v_cvt_pk_f16_f32 v129, v153, v157
    v_cvt_pk_f16_f32 v130, v154, v158
    v_cvt_pk_f16_f32 v131, v155, v159
    s_nop 1
    s_nop 0
    v_mfma_f32_16x16x32_f16 v[232:235], v[80:83], v[128:131], 0
    v_mfma_f32_16x16x32_f16 v[236:239], v[84:87], v[128:131], 0
    v_pk_mul_f32 v[152:153], v[72:73], v[144:145]
    v_pk_mul_f32 v[154:155], v[74:75], v[146:147]
    v_pk_mul_f32 v[156:157], v[76:77], v[144:145]
    v_pk_mul_f32 v[158:159], v[78:79], v[146:147]
    v_pk_fma_f32 v[152:153], v[76:77], v[148:149], v[152:153]
    v_pk_fma_f32 v[156:157], v[72:73], v[148:149], v[156:157] neg_lo:[0,0,1] neg_hi:[0,0,1]
    v_pk_fma_f32 v[154:155], v[78:79], v[150:151], v[154:155]
    v_pk_fma_f32 v[158:159], v[74:75], v[150:151], v[158:159] neg_lo:[0,0,1] neg_hi:[0,0,1]
    v_cvt_pk_f16_f32 v132, v152, v156
    v_cvt_pk_f16_f32 v133, v153, v157
    v_cvt_pk_f16_f32 v134, v154, v158
    v_cvt_pk_f16_f32 v135, v155, v159
    s_nop 1
    s_nop 0
    v_mfma_f32_16x16x32_f16 v[240:243], v[80:83], v[132:135], 0
    v_mfma_f32_16x16x32_f16 v[244:247], v[84:87], v[132:135], 0
    v_cvt_pk_f16_f32 v176, v216, v224
    v_cvt_pk_f16_f32 v178, v220, v228
    v_and_or_b32 v176, v176, s58, v210
    v_and_or_b32 v178, v178, s58, v210
    v_cvt_pk_f16_f32 v180, v217, v225
    v_cvt_pk_f16_f32 v182, v221, v229
    v_and_or_b32 v180, v180, s58, v210
    v_and_or_b32 v182, v182, s58, v210
    v_cvt_pk_f16_f32 v184, v218, v226
    v_cvt_pk_f16_f32 v186, v222, v230
    v_and_or_b32 v184, v184, s58, v210
    v_and_or_b32 v186, v186, s58, v210
    v_cvt_pk_f16_f32 v188, v219, v227
    v_cvt_pk_f16_f32 v190, v223, v231
    v_and_or_b32 v188, v188, s58, v210
    v_and_or_b32 v190, v190, s58, v210
    v_cvt_pk_f16_f32 v177, v232, v240
    v_cvt_pk_f16_f32 v179, v236, v244
    v_and_or_b32 v177, v177, s58, v210
    v_and_or_b32 v179, v179, s58, v210
    v_cvt_pk_f16_f32 v181, v233, v241
    v_cvt_pk_f16_f32 v183, v237, v245
    v_and_or_b32 v181, v181, s58, v210
    v_and_or_b32 v183, v183, s58, v210
    v_cvt_pk_f16_f32 v185, v234, v242
    v_cvt_pk_f16_f32 v187, v238, v246
    v_and_or_b32 v185, v185, s58, v210
    v_and_or_b32 v187, v187, s58, v210
    v_cvt_pk_f16_f32 v189, v235, v243
    v_cvt_pk_f16_f32 v191, v239, v247
    v_and_or_b32 v189, v189, s58, v210
    v_and_or_b32 v191, v191, s58, v210
    s_cmp_eq_u32 s50, 0
    s_cbranch_scc1 L_p1_done
    s_mov_b32 exec_hi, s72
    buffer_store_dwordx4 v[176:179], v209, s[12:15], s60 offen sc1
    s_mov_b32 exec_hi, s73
    buffer_store_dwordx4 v[180:183], v209, s[12:15], s61 offen sc1
    buffer_store_dwordx4 v[184:187], v209, s[12:15], s62 offen sc1
    buffer_store_dwordx4 v[188:191], v209, s[12:15], s63 offen sc1
    s_mov_b32 exec_hi, -1
    s_mov_b32 s50, 0
    s_add_u32 s60, s60, 16384
    v_add_u32 v5, 16384, v5
    s_sub_u32 s31, s48, 4
    v_cvt_f32_i32 v252, s31
    v_mul_f32 v252, 0x3d800000, v252
    v_and_b32 v251, 15, v2
    v_lshlrev_b32 v251, 2, v251
    v_cvt_f32_u32 v251, v251
    v_fma_f32 v250, v212, v251, v252
    v_sin_f32 v84, v250
    v_cos_f32 v250, v250
    s_nop 0
    v_cvt_pk_f16_f32 v80, v250, v84
    v_cvt_pk_f16_f32 v84, -v84, v250
    v_fma_f32 v250, v213, v251, v252
    v_sin_f32 v85, v250
    v_cos_f32 v250, v250
    s_nop 0
    v_cvt_pk_f16_f32 v81, v250, v85
    v_cvt_pk_f16_f32 v85, -v85, v250
    v_fma_f32 v250, v214, v251, v252
    v_sin_f32 v86, v250
    v_cos_f32 v250, v250
    s_nop 0
    v_cvt_pk_f16_f32 v82, v250, v86
    v_cvt_pk_f16_f32 v86, -v86, v250
    v_fma_f32 v250, v215, v251, v252
    v_sin_f32 v87, v250
    v_cos_f32 v250, v250
    s_nop 0
    v_cvt_pk_f16_f32 v83, v250, v87
    v_cvt_pk_f16_f32 v87, -v87, v250
    s_branch L_st23
L_p1_done:
    s_mov_b64 exec, 1
    ds_add_u32 v0, v255 offset:42828
    s_mov_b64 exec, -1
    s_setprio 0
    v_mov_b32 v4, v112
    v_mov_b32 v5, v113
    v_mov_b32 v249, v114
    v_mov_b32 v205, v115
    v_mov_b32 v248, v116
    v_mov_b32 v208, v117
    v_mov_b32 v7, v118
    v_mov_b32 v6, v119
    s_and_b32 s31, s2, 7
    s_sub_u32 s32, 8, s31
    s_min_u32 s46, s31, s32
    s_lshr_b32 s53, s31, 2
    s_lshr_b32 s47, s2, 3
    s_and_b32 s32, s47, 1
    s_and_b32 s31, s31, 3
    s_cselect_b32 s53, s53, s32
    s_cselect_b32 s31, 0, 1
    s_lshr_b32 s47, s47, s31
    s_lshl_b32 s53, s53, 4
    s_lshl_b32 s31, s30, 5
    s_add_u32 s53, s53, s31
    s_lshl_b32 s48, s46, 1
    s_add_u32 s48, s48, 2040
    s_mov_b32 s49, 32768
    v_mov_b32 v212, v210
    v_mov_b32 v213, v210
    v_mov_b32 v214, v210
    v_mov_b32 v215, v210
    s_cmp_ge_u32 s2, 224
    s_cbranch_scc1 L_zst_go
L_sync4:
    ds_read_b32 v1, v0 offset:42840
    s_add_u32 s92, s92, 1
    s_bitcmp1_b32 s92, 20
    s_cbranch_scc1 L_sync4x
    s_waitcnt lgkmcnt(0)
    v_readfirstlane_b32 s31, v1
    s_nop 0
    s_cmp_ge_u32 s31, 1
    s_cbranch_scc0 L_sync4
L_sync4x:
L_zst_go:
    s_mov_b32 exec_hi, s72
    buffer_store_dwordx4 v[176:179], v209, s[12:15], s60 offen sc1
    s_mov_b32 exec_hi, s73
    buffer_store_dwordx4 v[180:183], v209, s[12:15], s61 offen sc1
    buffer_store_dwordx4 v[184:187], v209, s[12:15], s62 offen sc1
    buffer_store_dwordx4 v[188:191], v209, s[12:15], s63 offen sc1
    s_mov_b32 exec_hi, -1
L_sync5:
    ds_read_b32 v1, v0 offset:42860
    s_add_u32 s92, s92, 1
    s_bitcmp1_b32 s92, 20
    s_cbranch_scc1 L_sync5x
    s_waitcnt lgkmcnt(0)
    v_readfirstlane_b32 s31, v1
    s_nop 0
    s_cmp_ge_u32 s31, 1
    s_cbranch_scc0 L_sync5
L_sync5x:
    buffer_load_dwordx4 v[24:27], v6, s[12:15], s49 offen
    s_add_u32 m0, s76, 0
    s_nop 0
    buffer_load_dwordx4 v4, s[8:11], 0 offen lds
    s_add_u32 m0, s76, 1024
    s_nop 0
    buffer_load_dwordx4 v5, s[8:11], 0 offen lds
    v_and_b32 v160, 15, v2
    v_add_u32 v160, s53, v160
    v_cvt_f32_u32 v160, v160
    v_add_f32 v160, 0.5, v160
    v_mul_f32 v160, 0x3b800000, v160
    v_and_b32 v161, 32, v2
    v_bfe_u32 v162, v2, 4, 1
    v_lshl_add_u32 v161, v162, 3, v161
    v_cvt_f32_u32 v161, v161
    v_mul_f32 v161, v161, v160
    v_fmamk_f32 v88, v160, 0x0, v161
    v_fmamk_f32 v162, v160, 0x40000000, v161
    v_sin_f32 v104, v88
    v_sin_f32 v163, v162
    v_cos_f32 v88, v88
    v_cos_f32 v162, v162
    v_cvt_pk_f16_f32 v104, v104, v163
    v_cvt_pk_f16_f32 v88, v88, v162
    v_fmamk_f32 v89, v160, 0x40800000, v161
    v_fmamk_f32 v162, v160, 0x40c00000, v161
    v_sin_f32 v105, v89
    v_sin_f32 v163, v162
    v_cos_f32 v89, v89
    v_cos_f32 v162, v162
    v_cvt_pk_f16_f32 v105, v105, v163
    v_cvt_pk_f16_f32 v89, v89, v162
    v_fmamk_f32 v90, v160, 0x41800000, v161
    v_fmamk_f32 v162, v160, 0x41900000, v161
    v_sin_f32 v106, v90
    v_sin_f32 v163, v162
    v_cos_f32 v90, v90
    v_cos_f32 v162, v162
    v_cvt_pk_f16_f32 v106, v106, v163
    v_cvt_pk_f16_f32 v90, v90, v162
    v_fmamk_f32 v91, v160, 0x41a00000, v161
    v_fmamk_f32 v162, v160, 0x41b00000, v161
    v_sin_f32 v107, v91
    v_sin_f32 v163, v162
    v_cos_f32 v91, v91
    v_cos_f32 v162, v162
    v_cvt_pk_f16_f32 v107, v107, v163
    v_cvt_pk_f16_f32 v91, v91, v162
    v_fmamk_f32 v92, v160, 0x42800000, v161
    v_fmamk_f32 v162, v160, 0x42840000, v161
    v_sin_f32 v108, v92
    v_sin_f32 v163, v162
    v_cos_f32 v92, v92
    v_cos_f32 v162, v162
    v_cvt_pk_f16_f32 v108, v108, v163
    v_cvt_pk_f16_f32 v92, v92, v162
    v_fmamk_f32 v93, v160, 0x42880000, v161
    v_fmamk_f32 v162, v160, 0x428c0000, v161
    v_sin_f32 v109, v93
    v_sin_f32 v163, v162
    v_cos_f32 v93, v93
    v_cos_f32 v162, v162
    v_cvt_pk_f16_f32 v109, v109, v163
    v_cvt_pk_f16_f32 v93, v93, v162
    v_fmamk_f32 v94, v160, 0x42a00000, v161
    v_fmamk_f32 v162, v160, 0x42a40000, v161
    v_sin_f32 v110, v94
    v_sin_f32 v163, v162
    v_cos_f32 v94, v94
    v_cos_f32 v162, v162
    v_cvt_pk_f16_f32 v110, v110, v163
    v_cvt_pk_f16_f32 v94, v94, v162
    v_fmamk_f32 v95, v160, 0x42a80000, v161
    v_fmamk_f32 v162, v160, 0x42ac0000, v161
    v_sin_f32 v111, v95
    v_sin_f32 v163, v162
    v_cos_f32 v95, v95
    v_cos_f32 v162, v162
    v_cvt_pk_f16_f32 v111, v111, v163
    v_cvt_pk_f16_f32 v95, v95, v162
    v_fmamk_f32 v96, v160, 0x3f800000, v161
    v_fmamk_f32 v162, v160, 0x40400000, v161
    v_sin_f32 v112, v96
    v_sin_f32 v163, v162
    v_cos_f32 v96, v96
    v_cos_f32 v162, v162
    v_cvt_pk_f16_f32 v112, v112, v163
    v_cvt_pk_f16_f32 v96, v96, v162
    v_fmamk_f32 v97, v160, 0x40a00000, v161
    v_fmamk_f32 v162, v160, 0x40e00000, v161
    v_sin_f32 v113, v97
    v_sin_f32 v163, v162
    v_cos_f32 v97, v97
    v_cos_f32 v162, v162
    v_cvt_pk_f16_f32 v113, v113, v163
    v_cvt_pk_f16_f32 v97, v97, v162
    v_fmamk_f32 v98, v160, 0x41880000, v161
    v_fmamk_f32 v162, v160, 0x41980000, v161
    v_sin_f32 v114, v98
    v_sin_f32 v163, v162
    v_cos_f32 v98, v98
    v_cos_f32 v162, v162
    v_cvt_pk_f16_f32 v114, v114, v163
    v_cvt_pk_f16_f32 v98, v98, v162
    v_fmamk_f32 v99, v160, 0x41a80000, v161
    v_fmamk_f32 v162, v160, 0x41b80000, v161
    v_sin_f32 v115, v99
    v_sin_f32 v163, v162
    v_cos_f32 v99, v99
    v_cos_f32 v162, v162
    v_cvt_pk_f16_f32 v115, v115, v163
    v_cvt_pk_f16_f32 v99, v99, v162
    v_fmamk_f32 v100, v160, 0x42820000, v161
    v_fmamk_f32 v162, v160, 0x42860000, v161
    v_sin_f32 v116, v100
    v_sin_f32 v163, v162
    v_cos_f32 v100, v100
    v_cos_f32 v162, v162
    v_cvt_pk_f16_f32 v116, v116, v163
    v_cvt_pk_f16_f32 v100, v100, v162
    v_fmamk_f32 v101, v160, 0x428a0000, v161
    v_fmamk_f32 v162, v160, 0x428e0000, v161
    v_sin_f32 v117, v101
    v_sin_f32 v163, v162
    v_cos_f32 v101, v101
    v_cos_f32 v162, v162
    v_cvt_pk_f16_f32 v117, v117, v163
    v_cvt_pk_f16_f32 v101, v101, v162
    v_fmamk_f32 v102, v160, 0x42a20000, v161
    v_fmamk_f32 v162, v160, 0x42a60000, v161
    v_sin_f32 v118, v102
    v_sin_f32 v163, v162
    v_cos_f32 v102, v102
    v_cos_f32 v162, v162
    v_cvt_pk_f16_f32 v118, v118, v163
    v_cvt_pk_f16_f32 v102, v102, v162
    v_fmamk_f32 v103, v160, 0x42aa0000, v161
    v_fmamk_f32 v162, v160, 0x42ae0000, v161
    v_sin_f32 v119, v103
    v_sin_f32 v163, v162
    v_cos_f32 v103, v103
    v_cos_f32 v162, v162
    v_cvt_pk_f16_f32 v119, v119, v163
    v_cvt_pk_f16_f32 v103, v103, v162
    v_cmp_gt_u32 vcc, 16, v2
    v_and_b32 v162, 1, v2
    v_lshlrev_b32 v162, 15, v162
    v_or_b32 v162, 0x3c00, v162
    v_and_b32 v160, 0xffff0000, v104
    v_or_b32 v162, v162, v160
    v_cndmask_b32 v104, v104, v162, vcc
    s_mul_i32 s51, s46, 528384
    s_add_u32 s51, s51, 2097152
    s_mul_i32 s54, s47, 16512
    s_lshl_b32 s32, s30, 12
    s_add_u32 s50, s51, s54
    s_add_u32 s50, s50, s32
    s_add_u32 s55, s47, 1
    s_and_b32 s55, s55, 31
    s_mul_i32 s55, s55, 16512
    v_add_u32 v250, s32, v3
    v_add_u32 v199, s76, v3
    v_lshl_add_u32 v200, v2, 7, s32
    v_and_b32 v1, 2, v2
    v_lshl_add_u32 v200, v1, 3, v200
    v_and_b32 v1, 0x70, v3
    v_add_u32 v1, 16384, v1
    s_mov_b32 vcc_lo, 0
    s_mov_b32 vcc_hi, -1
    v_cndmask_b32 v200, v200, v1, vcc
    s_mov_b32 vcc_hi, 0xff
    v_mov_b32 v1, s55
    v_mov_b32 v201, s54
    v_cndmask_b32 v1, v1, v201, vcc
    v_mov_b32 v201, 16640
    v_cndmask_b32 v201, v201, v0, vcc
    v_add_u32 v201, v201, v200
    v_add_u32 v200, v1, v200
    v_lshrrev_b32 v251, 5, v2
    v_lshlrev_b32 v251, 11, v251
    v_bfe_u32 v1, v2, 2, 3
    v_lshl_add_u32 v251, v1, 7, v251
    v_and_b32 v1, 3, v2
    v_lshl_add_u32 v251, v1, 5, v251
    v_bfe_u32 v1, v2, 3, 1
    v_lshl_add_u32 v251, v1, 4, v251
    v_bfe_u32 v1, v2, 4, 1
    v_lshl_add_u32 v251, v1, 3, v251
    v_xor_b32 v252, 16, v251
    v_xor_b32 v253, 8, v251
    v_xor_b32 v254, 24, v251
    v_cmp_gt_u32 vcc, 4, v2
    v_mov_b32 v1, 16384
    s_nop 0
    v_cndmask_b32 v1, v0, v1, vcc
    v_add_u32 v206, v253, v1
    v_add_u32 v207, v254, v1
    s_mov_b32 vcc_lo, 0x88888888
    s_mov_b32 vcc_hi, 0x88888888
    v_mov_b32 v1, 16544
    v_cndmask_b32 v1, 32, v1, vcc
    v_add_u32 v202, v251, v1
    v_add_u32 v203, v253, v1
    v_add_u32 v204, v206, v1
    s_waitcnt vmcnt(0)
L_stat_check:
    v_cmp_ne_u64 vcc, s[28:29], v[26:27]
    s_nop 0
    s_cbranch_vccz L_stat_got
    s_cmp_eq_u32 s35, 0
    s_cbranch_scc1 L_stat_got
    s_sub_u32 s35, s35, 1
    s_sleep 2
    s_mov_b64 exec, vcc
    buffer_load_dwordx4 v[24:27], v6, s[12:15], s49 offen sc1
    s_mov_b64 exec, -1
    s_waitcnt vmcnt(0)
    s_branch L_stat_check
L_stat_got:
    v_cndmask_b32 v24, v24, v25, s[88:89]
    v_mov_b32 v32, v24
    s_nop 1
    v_permlane32_swap_b32 v24, v32
    v_mov_b32 v28, v24
    v_mov_b32 v36, v32
    s_nop 0
    v_permlane16_swap_b32 v24, v28
    v_permlane16_swap_b32 v32, v36
    v_lshlrev_b32 v26, 16, v24
    v_and_b32 v24, 0xffff0000, v24
    v_rcp_f32 v24, v24
    v_lshlrev_b32 v30, 16, v28
    v_and_b32 v28, 0xffff0000, v28
    v_rcp_f32 v28, v28
    v_lshlrev_b32 v34, 16, v32
    v_and_b32 v32, 0xffff0000, v32
    v_rcp_f32 v32, v32
    v_lshlrev_b32 v38, 16, v36
    v_and_b32 v36, 0xffff0000, v36
    v_rcp_f32 v36, v36
    v_mul_f32 v24, 0xbfb8aa3b, v24
    v_mul_f32_e64 v26, -v26, v24
    v_mul_f32 v28, 0xbfb8aa3b, v28
    v_mul_f32_e64 v30, -v30, v28
    v_mul_f32 v32, 0xbfb8aa3b, v32
    v_mul_f32_e64 v34, -v34, v32
    v_mul_f32 v36, 0xbfb8aa3b, v36
    v_mul_f32_e64 v38, -v38, v36
    ds_read_b128 v[8:11], v208 offset:0
    ds_read_b128 v[12:15], v208 offset:1024
    s_waitcnt lgkmcnt(0)
    v_lshlrev_b32 v40, 16, v8
    v_and_b32 v41, 0xffff0000, v8
    v_lshlrev_b32 v42, 16, v9
    v_and_b32 v43, 0xffff0000, v9
    v_lshlrev_b32 v44, 16, v10
    v_and_b32 v45, 0xffff0000, v10
    v_lshlrev_b32 v46, 16, v11
    v_and_b32 v47, 0xffff0000, v11
    v_lshlrev_b32 v48, 16, v12
    v_and_b32 v55, 0xffff0000, v12
    v_lshlrev_b32 v54, 16, v13
    v_and_b32 v53, 0xffff0000, v13
    v_lshlrev_b32 v52, 16, v14
    v_and_b32 v51, 0xffff0000, v14
    v_lshlrev_b32_e64 v50, 16, v15
    v_and_b32 v49, 0xffff0000, v15
    v_pk_fma_f32 v[120:121], v[40:41], v[24:25], v[26:27] op_sel_hi:[1,0,0]
    v_pk_fma_f32 v[122:123], v[42:43], v[24:25], v[26:27] op_sel_hi:[1,0,0]
    v_pk_fma_f32 v[124:125], v[44:45], v[24:25], v[26:27] op_sel_hi:[1,0,0]
    v_pk_fma_f32 v[126:127], v[46:47], v[24:25], v[26:27] op_sel_hi:[1,0,0]
    v_pk_fma_f32 v[128:129], v[48:49], v[28:29], v[30:31] op_sel_hi:[1,0,0]
    v_pk_fma_f32 v[130:131], v[50:51], v[28:29], v[30:31] op_sel_hi:[1,0,0]
    v_pk_fma_f32 v[132:133], v[52:53], v[28:29], v[30:31] op_sel_hi:[1,0,0]
    v_pk_fma_f32 v[134:135], v[54:55], v[28:29], v[30:31] op_sel_hi:[1,0,0]
    v_exp_f32 v216, v120
    v_exp_f32 v217, v121
    v_exp_f32 v218, v122
    v_exp_f32 v219, v123
    v_exp_f32 v220, v124
    v_exp_f32 v221, v125
    v_exp_f32 v222, v126
    v_exp_f32 v223, v127
    v_exp_f32 v224, v128
    v_exp_f32 v225, v129
    v_exp_f32 v226, v130
    v_exp_f32 v227, v131
    v_exp_f32 v228, v132
    v_exp_f32 v229, v133
    v_exp_f32 v230, v134
    v_exp_f32 v231, v135
    v_pk_add_f32 v[216:217], v[216:217], 1.0 op_sel_hi:[1,0]
    v_pk_add_f32 v[218:219], v[218:219], 1.0 op_sel_hi:[1,0]
    v_pk_add_f32 v[220:221], v[220:221], 1.0 op_sel_hi:[1,0]
    v_pk_add_f32 v[222:223], v[222:223], 1.0 op_sel_hi:[1,0]
    v_pk_add_f32 v[224:225], v[224:225], 1.0 op_sel_hi:[1,0]
    v_pk_add_f32 v[226:227], v[226:227], 1.0 op_sel_hi:[1,0]
    v_pk_add_f32 v[228:229], v[228:229], 1.0 op_sel_hi:[1,0]
    v_pk_add_f32 v[230:231], v[230:231], 1.0 op_sel_hi:[1,0]
    v_rcp_f32 v216, v216
    v_rcp_f32 v217, v217
    v_rcp_f32 v218, v218
    v_rcp_f32 v219, v219
    v_rcp_f32 v220, v220
    v_rcp_f32 v221, v221
    v_rcp_f32 v222, v222
    v_rcp_f32 v223, v223
    v_rcp_f32 v224, v224
    v_rcp_f32 v225, v225
    v_rcp_f32 v226, v226
    v_rcp_f32 v227, v227
    v_rcp_f32 v228, v228
    v_rcp_f32 v229, v229
    v_rcp_f32 v230, v230
    v_rcp_f32 v231, v231
    v_pk_mul_f32 v[120:121], v[120:121], v[216:217]
    v_pk_mul_f32 v[122:123], v[122:123], v[218:219]
    v_pk_mul_f32 v[124:125], v[124:125], v[220:221]
    v_pk_mul_f32 v[126:127], v[126:127], v[222:223]
    v_pk_mul_f32 v[128:129], v[128:129], v[224:225]
    v_pk_mul_f32 v[130:131], v[130:131], v[226:227]
    v_pk_mul_f32 v[132:133], v[132:133], v[228:229]
    v_pk_mul_f32 v[134:135], v[134:135], v[230:231]
L_sync6:
    ds_read_b32 v1, v0 offset:42848
    s_add_u32 s92, s92, 1
    s_bitcmp1_b32 s92, 20
    s_cbranch_scc1 L_sync6x
    s_waitcnt lgkmcnt(0)
    v_readfirstlane_b32 s31, v1
    s_nop 0
    s_cmp_ge_u32 s31, 4
    s_cbranch_scc0 L_sync6
L_sync6x:
    s_add_u32 m0, s76, 2048
    s_nop 0
    buffer_load_dwordx4 v249, s[8:11], 0 offen lds
    s_add_u32 m0, s76, 3072
    s_nop 0
    buffer_load_dwordx4 v205, s[8:11], 0 offen lds
L_sync7:
    ds_read_b32 v1, v0 offset:42844
    ds_read_b32 v198, v0 offset:41556
    s_add_u32 s92, s92, 1
    s_bitcmp1_b32 s92, 20
    s_cbranch_scc1 L_sync7x
    s_waitcnt lgkmcnt(1)
    v_readfirstlane_b32 s31, v1
    s_nop 0
    s_cmp_ge_u32 s31, 1
    s_cbranch_scc0 L_sync7
L_sync7x:
    v_and_b32 v6, 48, v2
    v_lshlrev_b32 v6, 1, v6
    v_mov_b32 v209, 2147483392
    s_waitcnt lgkmcnt(0)
    v_readfirstlane_b32 s33, v198
    s_nop 0
    s_andn2_b32 s33, 0x7ff, s33
    s_sub_u32 s31, 0, s33
    s_and_b32 s31, s31, 2047
    s_sub_u32 s32, s33, 1024
    s_sub_u32 s34, s31, 1024
    v_cmp_eq_u32 vcc, s33, v7
    v_cmp_eq_u32 s[54:55], s33, v248
    s_nop 0
    v_cndmask_b32 v4, v4, v209, vcc
    v_cmp_eq_u32 vcc, s31, v7
    v_cmp_eq_u32 s[56:57], s31, v248
    s_nop 0
    v_cndmask_b32 v5, v5, v209, vcc
    v_cmp_eq_u32 vcc, s32, v7
    v_cmp_eq_u32 s[58:59], s32, v248
    s_nop 0
    v_cndmask_b32 v249, v249, v209, vcc
    v_cmp_eq_u32 vcc, s34, v7
    v_cmp_eq_u32 s[60:61], s34, v248
    s_nop 0
    v_cndmask_b32 v205, v205, v209, vcc
    s_or_b64 s[62:63], s[54:55], s[58:59]
    s_or_b64 s[64:65], s[56:57], s[60:61]
    s_waitcnt vmcnt(0)
    buffer_load_dwordx4 v[72:75], v3, s[12:15], s50 offen offset:0 sc1
    buffer_load_dwordx4 v[76:79], v3, s[12:15], s50 offen offset:1024 sc1
    buffer_load_dwordx4 v[80:83], v3, s[12:15], s50 offen offset:2048 sc1
    buffer_load_dwordx4 v[84:87], v3, s[12:15], s50 offen offset:3072 sc1
    s_mov_b32 exec_hi, 0x1ff
    buffer_load_dwordx4 v[212:215], v200, s[12:15], s51 offen sc1
    s_mov_b32 exec_hi, -1
    s_setprio 2
    ds_read_b128 v[16:19], v208 offset:2048
    ds_read_b128 v[20:23], v208 offset:3072
    s_waitcnt lgkmcnt(0)
    v_lshlrev_b32 v56, 16, v16
    v_and_b32 v57, 0xffff0000, v16
    v_lshlrev_b32 v58, 16, v17
    v_and_b32 v59, 0xffff0000, v17
    v_lshlrev_b32 v60, 16, v18
    v_and_b32 v61, 0xffff0000, v18
    v_lshlrev_b32 v62, 16, v19
    v_and_b32 v63, 0xffff0000, v19
    v_lshlrev_b32 v64, 16, v20
    v_and_b32 v71, 0xffff0000, v20
    v_lshlrev_b32 v70, 16, v21
    v_and_b32 v69, 0xffff0000, v21
    v_lshlrev_b32 v68, 16, v22
    v_and_b32 v67, 0xffff0000, v22
    v_lshlrev_b32 v66, 16, v23
    v_and_b32 v65, 0xffff0000, v23
    v_pk_fma_f32 v[136:137], v[56:57], v[32:33], v[34:35] op_sel_hi:[1,0,0]
    v_pk_fma_f32 v[138:139], v[58:59], v[32:33], v[34:35] op_sel_hi:[1,0,0]
    v_pk_fma_f32 v[140:141], v[60:61], v[32:33], v[34:35] op_sel_hi:[1,0,0]
    v_pk_fma_f32 v[142:143], v[62:63], v[32:33], v[34:35] op_sel_hi:[1,0,0]
    v_pk_fma_f32 v[144:145], v[64:65], v[36:37], v[38:39] op_sel_hi:[1,0,0]
    v_pk_fma_f32 v[146:147], v[66:67], v[36:37], v[38:39] op_sel_hi:[1,0,0]
    v_pk_fma_f32 v[148:149], v[68:69], v[36:37], v[38:39] op_sel_hi:[1,0,0]
    v_pk_fma_f32 v[150:151], v[70:71], v[36:37], v[38:39] op_sel_hi:[1,0,0]
    v_exp_f32 v232, v136
    v_exp_f32 v233, v137
    v_exp_f32 v234, v138
    v_exp_f32 v235, v139
    v_exp_f32 v236, v140
    v_exp_f32 v237, v141
    v_exp_f32 v238, v142
    v_exp_f32 v239, v143
    v_exp_f32 v240, v144
    v_exp_f32 v241, v145
    v_exp_f32 v242, v146
    v_exp_f32 v243, v147
    v_exp_f32 v244, v148
    v_exp_f32 v245, v149
    v_exp_f32 v246, v150
    v_exp_f32 v247, v151
    v_pk_add_f32 v[232:233], v[232:233], 1.0 op_sel_hi:[1,0]
    v_pk_add_f32 v[234:235], v[234:235], 1.0 op_sel_hi:[1,0]
    v_pk_add_f32 v[236:237], v[236:237], 1.0 op_sel_hi:[1,0]
    v_pk_add_f32 v[238:239], v[238:239], 1.0 op_sel_hi:[1,0]
    v_pk_add_f32 v[240:241], v[240:241], 1.0 op_sel_hi:[1,0]
    v_pk_add_f32 v[242:243], v[242:243], 1.0 op_sel_hi:[1,0]
    v_pk_add_f32 v[244:245], v[244:245], 1.0 op_sel_hi:[1,0]
    v_pk_add_f32 v[246:247], v[246:247], 1.0 op_sel_hi:[1,0]
    v_rcp_f32 v232, v232
    v_rcp_f32 v233, v233
    v_rcp_f32 v234, v234
    v_rcp_f32 v235, v235
    v_rcp_f32 v236, v236
    v_rcp_f32 v237, v237
    v_rcp_f32 v238, v238
    v_rcp_f32 v239, v239
    v_rcp_f32 v240, v240
    v_rcp_f32 v241, v241
    v_rcp_f32 v242, v242
    v_rcp_f32 v243, v243
    v_rcp_f32 v244, v244
    v_rcp_f32 v245, v245
    v_rcp_f32 v246, v246
    v_rcp_f32 v247, v247
    v_pk_mul_f32 v[136:137], v[136:137], v[232:233]
    v_pk_mul_f32 v[138:139], v[138:139], v[234:235]
    v_pk_mul_f32 v[140:141], v[140:141], v[236:237]
    v_pk_mul_f32 v[142:143], v[142:143], v[238:239]
    v_pk_mul_f32 v[144:145], v[144:145], v[240:241]
    v_pk_mul_f32 v[146:147], v[146:147], v[242:243]
    v_pk_mul_f32 v[148:149], v[148:149], v[244:245]
    v_pk_mul_f32 v[150:151], v[150:151], v[246:247]
L_z_wait:
    s_setprio 2
    s_waitcnt vmcnt(4)
    v_xor_b32 v160, v210, v72
    v_xor_b32 v161, v210, v73
    v_xor_b32 v162, v210, v74
    v_xor_b32 v163, v210, v75
    ds_write_b128 v250, v[160:163] offset:0
    v_or3_b32 v1, v160, v161, v162
    v_or_b32 v1, v1, v163
    s_waitcnt vmcnt(3)
    v_xor_b32 v164, v210, v76
    v_xor_b32 v165, v210, v77
    v_xor_b32 v166, v210, v78
    v_xor_b32 v167, v210, v79
    ds_write_b128 v250, v[164:167] offset:1024
    v_or3_b32 v1, v1, v164, v165
    v_or3_b32 v1, v1, v166, v167
    s_waitcnt vmcnt(2)
    v_xor_b32 v168, v210, v80
    v_xor_b32 v169, v210, v81
    v_xor_b32 v170, v210, v82
    v_xor_b32 v171, v210, v83
    ds_write_b128 v250, v[168:171] offset:2048
    v_or3_b32 v1, v1, v168, v169
    v_or3_b32 v1, v1, v170, v171
    s_waitcnt vmcnt(1)
    v_xor_b32 v172, v210, v84
    v_xor_b32 v173, v210, v85
    v_xor_b32 v174, v210, v86
    v_xor_b32 v175, v210, v87
    ds_write_b128 v250, v[172:175] offset:3072
    v_or3_b32 v1, v1, v172, v173
    v_or3_b32 v1, v1, v174, v175
    s_waitcnt vmcnt(0)
    v_xor_b32 v176, v210, v212
    v_xor_b32 v177, v210, v213
    v_xor_b32 v178, v210, v214
    v_xor_b32 v179, v210, v215
    s_mov_b32 exec_hi, 0x1ff
    ds_write_b128 v201, v[176:179]
    s_mov_b32 exec_hi, -1
    v_or3_b32 v1, v1, v176, v177
    v_or3_b32 v1, v1, v178, v179
    v_and_b32 v1, 0x30003, v1
    v_cmp_ne_u32 vcc, 0, v1
    s_nop 0
    s_cbranch_vccz L_z_got
    s_cmp_eq_u32 s35, 0
    s_cbranch_scc1 L_z_got
    s_sub_u32 s35, s35, 1
    s_sleep 2
    s_mov_b64 exec, vcc
    buffer_load_dwordx4 v[72:75], v3, s[12:15], s50 offen offset:0 sc1
    buffer_load_dwordx4 v[76:79], v3, s[12:15], s50 offen offset:1024 sc1
    buffer_load_dwordx4 v[80:83], v3, s[12:15], s50 offen offset:2048 sc1
    buffer_load_dwordx4 v[84:87], v3, s[12:15], s50 offen offset:3072 sc1
    s_and_b32 exec_hi, exec_hi, 0x1ff
    s_or_b32 exec_lo, exec_lo, 1
    buffer_load_dwordx4 v[212:215], v200, s[12:15], s51 offen sc1
    s_mov_b64 exec, -1
    s_waitcnt lgkmcnt(0)
    s_branch L_z_wait
L_z_got:
    s_mov_b64 exec, 1
    ds_add_u32 v0, v255 offset:42832
    s_mov_b64 exec, -1
L_sync8:
    ds_read_b32 v1, v0 offset:42832
    ds_read_b64_tr_b16 v[152:153], v251 offset:0
    ds_read_b64_tr_b16 v[154:155], v251 offset:1024
    ds_read_b64_tr_b16 v[156:157], v252 offset:0
    ds_read_b64_tr_b16 v[158:159], v252 offset:1024
    s_add_u32 s92, s92, 1
    s_bitcmp1_b32 s92, 20
    s_cbranch_scc1 L_sync8x
    s_waitcnt lgkmcnt(4)
    v_readfirstlane_b32 s31, v1
    s_nop 0
    s_cmp_ge_u32 s31, 4
    s_cbranch_scc0 L_sync8
L_sync8x:
    ds_read_b64_tr_b16 v[160:161], v251 offset:4096
    ds_read_b64_tr_b16 v[162:163], v251 offset:5120
    ds_read_b64_tr_b16 v[164:165], v252 offset:4096
    ds_read_b64_tr_b16 v[166:167], v252 offset:5120
    ds_read_b64_tr_b16 v[168:169], v251 offset:8192
    ds_read_b64_tr_b16 v[170:171], v251 offset:9216
    ds_read_b64_tr_b16 v[172:173], v252 offset:8192
    ds_read_b64_tr_b16 v[174:175], v252 offset:9216
    s_waitcnt lgkmcnt(8)
    v_mfma_f32_16x16x32_f16 v[216:219], v[152:155], v[88:91], 0
    v_mfma_f32_16x16x32_f16 v[220:223], v[156:159], v[88:91], 0
    ds_read_b64_tr_b16 v[176:177], v251 offset:12288
    ds_read_b64_tr_b16 v[178:179], v251 offset:13312
    ds_read_b64_tr_b16 v[180:181], v252 offset:12288
    ds_read_b64_tr_b16 v[182:183], v252 offset:13312
    s_waitcnt lgkmcnt(8)
    v_mfma_f32_16x16x32_f16 v[216:219], v[160:163], v[92:95], v[216:219]
    v_mfma_f32_16x16x32_f16 v[220:223], v[164:167], v[92:95], v[220:223]
    ds_read_b64_tr_b16 v[152:153], v206 offset:0
    ds_read_b64_tr_b16 v[154:155], v253 offset:1024
    ds_read_b64_tr_b16 v[156:157], v207 offset:0
    ds_read_b64_tr_b16 v[158:159], v254 offset:1024
    s_waitcnt lgkmcnt(8)
    v_mfma_f32_16x16x32_f16 v[224:227], v[168:171], v[96:99], 0
    v_mfma_f32_16x16x32_f16 v[228:231], v[172:175], v[96:99], 0
    ds_read_b64_tr_b16 v[160:161], v253 offset:4096
    ds_read_b64_tr_b16 v[162:163], v253 offset:5120
    ds_read_b64_tr_b16 v[164:165], v254 offset:4096
    ds_read_b64_tr_b16 v[166:167], v254 offset:5120
    s_waitcnt lgkmcnt(8)
    v_mfma_f32_16x16x32_f16 v[224:227], v[176:179], v[100:103], v[224:227]
    v_mfma_f32_16x16x32_f16 v[228:231], v[180:183], v[100:103], v[228:231]
    ds_read_b64_tr_b16 v[168:169], v253 offset:8192
    ds_read_b64_tr_b16 v[170:171], v253 offset:9216
    ds_read_b64_tr_b16 v[172:173], v254 offset:8192
    ds_read_b64_tr_b16 v[174:175], v254 offset:9216
    s_waitcnt lgkmcnt(8)
    v_mfma_f32_16x16x32_f16 v[216:219], v[152:155], v[104:107], v[216:219]
    v_mfma_f32_16x16x32_f16 v[220:223], v[156:159], v[104:107], v[220:223]
    ds_read_b64_tr_b16 v[176:177], v253 offset:12288
    ds_read_b64_tr_b16 v[178:179], v253 offset:13312
    ds_read_b64_tr_b16 v[180:181], v254 offset:12288
    ds_read_b64_tr_b16 v[182:183], v254 offset:13312
    s_waitcnt lgkmcnt(8)
    v_mfma_f32_16x16x32_f16 v[216:219], v[160:163], v[108:111], v[216:219]
    v_mfma_f32_16x16x32_f16 v[220:223], v[164:167], v[108:111], v[220:223]
    ds_read_b64_tr_b16 v[72:73], v202 offset:0
    ds_read_b64_tr_b16 v[74:75], v202 offset:1024
    ds_read_b64_tr_b16 v[76:77], v202 offset:4096
    ds_read_b64_tr_b16 v[78:79], v202 offset:5120
    s_waitcnt lgkmcnt(8)
    v_mfma_f32_16x16x32_f16 v[224:227], v[168:171], v[112:115], v[224:227]
    v_mfma_f32_16x16x32_f16 v[228:231], v[172:175], v[112:115], v[228:231]
    ds_read_b64_tr_b16 v[80:81], v202 offset:8192
    ds_read_b64_tr_b16 v[82:83], v202 offset:9216
    ds_read_b64_tr_b16 v[84:85], v202 offset:12288
    ds_read_b64_tr_b16 v[86:87], v202 offset:13312
    s_waitcnt lgkmcnt(8)
    v_mfma_f32_16x16x32_f16 v[224:227], v[176:179], v[116:119], v[224:227]
    v_mfma_f32_16x16x32_f16 v[228:231], v[180:183], v[116:119], v[228:231]
    ds_read_b64_tr_b16 v[240:241], v204 offset:0
    ds_read_b64_tr_b16 v[242:243], v203 offset:1024
    ds_read_b64_tr_b16 v[244:245], v203 offset:4096
    ds_read_b64_tr_b16 v[246:247], v203 offset:5120
    s_waitcnt lgkmcnt(8)
    ds_read_b64_tr_b16 v[184:185], v203 offset:8192
    ds_read_b64_tr_b16 v[186:187], v203 offset:9216
    ds_read_b64_tr_b16 v[188:189], v203 offset:12288
    ds_read_b64_tr_b16 v[190:191], v203 offset:13312
    v_mfma_f32_16x16x32_f16 v[232:235], v[72:75], v[88:91], 0
    v_mfma_f32_16x16x32_f16 v[232:235], v[76:79], v[92:95], v[232:235]
    s_waitcnt lgkmcnt(4)
    v_mfma_f32_16x16x32_f16 v[236:239], v[80:83], v[96:99], 0
    v_mfma_f32_16x16x32_f16 v[236:239], v[84:87], v[100:103], v[236:239]
    v_pk_add_f32 v[152:153], v[216:217], v[224:225]
    v_pk_add_f32 v[154:155], v[218:219], v[226:227]
    v_pk_add_f32 v[156:157], v[220:221], v[228:229]
    v_pk_add_f32 v[158:159], v[222:223], v[230:231]
    v_mfma_f32_16x16x32_f16 v[232:235], v[240:243], v[104:107], v[232:235]
    v_mfma_f32_16x16x32_f16 v[232:235], v[244:247], v[108:111], v[232:235]
    v_pk_fma_f32 v[40:41], v[152:153], v[120:121], v[40:41]
    v_pk_fma_f32 v[42:43], v[154:155], v[122:123], v[42:43]
    v_pk_fma_f32 v[44:45], v[156:157], v[124:125], v[44:45]
    v_pk_fma_f32 v[46:47], v[158:159], v[126:127], v[46:47]
    s_waitcnt lgkmcnt(0)
    s_nop 0
    v_mfma_f32_16x16x32_f16 v[236:239], v[184:187], v[112:115], v[236:239]
    v_mfma_f32_16x16x32_f16 v[236:239], v[188:191], v[116:119], v[236:239]
    v_cvt_pk_bf16_f32 v8, v40, v41
    v_cvt_pk_bf16_f32 v9, v42, v43
    v_cvt_pk_bf16_f32 v10, v44, v45
    v_cvt_pk_bf16_f32 v11, v46, v47
    ds_write_b128 v208, v[8:11] offset:0
    ds_read_b128 v[24:27], v199 offset:0
    v_pk_add_f32 v[160:161], v[216:217], v[224:225] neg_lo:[0,1] neg_hi:[0,1]
    v_pk_add_f32 v[162:163], v[218:219], v[226:227] neg_lo:[0,1] neg_hi:[0,1]
    v_pk_add_f32 v[164:165], v[220:221], v[228:229] neg_lo:[0,1] neg_hi:[0,1]
    v_pk_add_f32 v[166:167], v[222:223], v[230:231] neg_lo:[0,1] neg_hi:[0,1]
    s_cmp_eq_u64 s[62:63], 0
    s_cbranch_scc1 L_nodump0
    s_mov_b64 exec, s[54:55]
    ds_write_b128 v6, v[152:155] offset:42496
    ds_write_b128 v6, v[156:159] offset:42512
    s_mov_b64 exec, s[58:59]
    ds_write_b128 v6, v[160:163] offset:42496
    ds_write_b128 v6, v[164:167] offset:42512
    s_mov_b64 exec, 1
    ds_add_u32 v0, v255 offset:42836
    s_mov_b64 exec, -1
    s_waitcnt lgkmcnt(0)
L_nodump0:
    s_nop 0
    v_pk_fma_f32 v[56:57], v[160:161], v[136:137], v[56:57]
    v_pk_fma_f32 v[58:59], v[162:163], v[138:139], v[58:59]
    v_pk_fma_f32 v[60:61], v[164:165], v[140:141], v[60:61]
    v_pk_fma_f32 v[62:63], v[166:167], v[142:143], v[62:63]
    v_cvt_pk_bf16_f32 v16, v56, v57
    v_cvt_pk_bf16_f32 v17, v58, v59
    v_cvt_pk_bf16_f32 v18, v60, v61
    v_cvt_pk_bf16_f32 v19, v62, v63
    ds_write_b128 v208, v[16:19] offset:2048
    ds_read_b128 v[32:35], v199 offset:2048
    s_waitcnt lgkmcnt(2)
    buffer_store_dwordx4 v[24:27], v4, s[16:19], 0 offen sc1
    v_add_f32 v152, v232, v236
    v_sub_f32 v160, v232, v236
    s_cmp_eq_u64 s[64:65], 0
    s_cbranch_scc1 L_nodump1
    s_mov_b64 exec, s[56:57]
    ds_write_b128 v6, v[152:155] offset:42624
    ds_write_b128 v6, v[156:159] offset:42640
    s_mov_b64 exec, s[60:61]
    ds_write_b128 v6, v[160:163] offset:42624
    ds_write_b128 v6, v[164:167] offset:42640
    s_mov_b64 exec, 1
    ds_add_u32 v0, v255 offset:42864
    s_mov_b64 exec, -1
    s_waitcnt lgkmcnt(0)
L_nodump1:
    v_pk_fma_f32 v[48:49], v[152:153], v[128:129], v[48:49]
    v_pk_fma_f32 v[50:51], v[154:155], v[130:131], v[50:51]
    v_pk_fma_f32 v[52:53], v[156:157], v[132:133], v[52:53]
    v_pk_fma_f32 v[54:55], v[158:159], v[134:135], v[54:55]
    v_cvt_pk_bf16_f32 v12, v48, v55
    v_cvt_pk_bf16_f32 v13, v54, v53
    v_cvt_pk_bf16_f32 v14, v52, v51
    v_cvt_pk_bf16_f32 v15, v50, v49
    ds_write_b128 v208, v[12:15] offset:1024
    ds_read_b128 v[28:31], v199 offset:1024
    s_waitcnt lgkmcnt(2)
    s_nop 0
    buffer_store_dwordx4 v[32:35], v249, s[16:19], 0 offen sc1
    v_pk_fma_f32 v[64:65], v[160:161], v[144:145], v[64:65]
    v_pk_fma_f32 v[66:67], v[162:163], v[146:147], v[66:67]
    v_pk_fma_f32 v[68:69], v[164:165], v[148:149], v[68:69]
    v_pk_fma_f32 v[70:71], v[166:167], v[150:151], v[70:71]
    v_cvt_pk_bf16_f32 v20, v64, v71
    v_cvt_pk_bf16_f32 v21, v70, v69
    v_cvt_pk_bf16_f32 v22, v68, v67
    v_cvt_pk_bf16_f32 v23, v66, v65
    ds_write_b128 v208, v[20:23] offset:3072
    ds_read_b128 v[36:39], v199 offset:3072
    s_waitcnt lgkmcnt(2)
    buffer_store_dwordx4 v[28:31], v5, s[16:19], 0 offen sc1
    s_waitcnt lgkmcnt(0)
    buffer_store_dwordx4 v[36:39], v205, s[16:19], 0 offen sc1
    s_branch L_fin
L_dma_done:
    s_setprio 0
    s_lshr_b32 s31, s47, 2
    s_andn2_b32 s31, s31, s75
    s_add_u32 s50, s31, s46
    s_lshl_b32 s31, s50, 17
    s_bfe_u32 s32, s2, 0x20003
    s_lshl_b32 s32, s32, 2
    s_add_u32 s51, s32, s30
    s_lshl_b32 s32, s51, 7
    s_add_u32 s31, s31, s32
    v_lshrrev_b32 v6, 3, v2
    v_lshlrev_b32 v6, 11, v6
    v_and_b32 v7, 0x70, v3
    v_and_b32 v11, 16, v2
    v_lshlrev_b32 v11, 1, v11
    v_xor_b32 v11, v11, v7
    v_add3_u32 v6, v6, v11, s31
    v_xor_b32 v11, 64, v6
    s_lshl_b32 s74, s30, 13
    s_cmp_lt_u32 s30, 2
    s_mov_b32 s31, 125952
    s_cselect_b32 s31, 60416, s31
    s_add_u32 s74, s74, s31
    s_mov_b32 s60, 4096
    s_mov_b32 s61, 8192
    s_mov_b32 s62, 12288
    v_bfe_u32 v8, v2, 2, 3
    v_lshlrev_b32 v9, 5, v8
    s_lshl_b32 s31, s30, 6
    v_xor_b32 v9, s31, v9
    v_bfe_u32 v8, v2, 2, 2
    v_lshl_add_u32 v9, v8, 8, v9
    v_lshrrev_b32 v8, 4, v2
    v_lshl_add_u32 v9, v8, 11, v9
    v_and_b32 v10, 3, v2
    v_lshl_add_u32 v9, v10, 3, v9
    v_add_u32 v9, 76800, v9
    v_xor_b32 v10, 32, v9
    v_lshlrev_b32 v8, 4, v8
    s_lshr_b32 s31, s30, 1
    s_and_b32 s32, s31, s75
    s_lshl_b32 s32, s32, 8
    v_add_u32 v8, s32, v8
    s_cmp_eq_u32 s75, 0
    s_cselect_b32 s32, 12, 9
    s_lshl_b32 s31, s31, s32
    s_lshl_b32 s32, s46, 3
    s_add_u32 s32, s32, s47
    s_lshl_b32 s32, s32, 9
    s_add_u32 s31, s31, s32
    s_and_b32 s32, s30, 1
    s_lshl_b32 s32, s32, 8
    s_add_u32 s31, s31, s32
    s_add_u32 s31, s31, 262144
    v_lshl_add_u32 v13, v2, 3, s31
    s_waitcnt lgkmcnt(0)
    s_add_u32 s28, s28, 0x7f4a7c15
    s_addc_u32 s29, s29, 0x9e3779b9
    s_and_b32 s31, s28, 0xff
    v_mov_b32 v14, s31
    s_mov_b32 s49, 0xffffff00
    s_cmp_lg_u32 s30, 2
    s_cbranch_scc1 L_no_tlb
    s_mov_b32 s52, s44
    s_mov_b32 s53, s45
    s_mov_b32 s54, 0x400000
    s_mov_b32 s55, 0x00020000
    v_lshlrev_b32 v250, 18, v2
    buffer_load_dword v252, v250, s[52:55], 0 offen
    s_mov_b64 exec, 3
    v_lshlrev_b32 v250, 21, v2
    s_mov_b32 s31, 2625408
    buffer_load_dword v251, v250, s[12:15], s31 offen
    s_mov_b64 exec, 1
    buffer_load_dword v253, v6, s[24:27], 0 offen
    s_mov_b64 exec, -1
L_no_tlb:
    s_cmp_lg_u32 s66, 0
    s_cbranch_scc1 L_tagged
    s_mov_b64 exec, 1
    ds_add_u32 v0, v255 offset:42872
    s_mov_b64 exec, -1
L_tagged:
    s_cmp_eq_u32 s30, 3
    s_cbranch_scc1 L_h1
    s_cmp_eq_u32 s66, 0
    s_cbranch_scc1 L_key
    s_cmp_lg_u32 s30, 0
    s_cbranch_scc1 L_follower
    s_setprio 3
    s_waitcnt vmcnt(16)
    s_mov_b64 exec, 1
    ds_add_u32 v0, v255 offset:42868
    s_mov_b64 exec, -1
    s_nop 0
    ds_read_b64_tr_b16 v[36:37], v9 offset:0
    ds_read_b64_tr_b16 v[38:39], v9 offset:1024
    ds_read_b64_tr_b16 v[40:41], v10 offset:0
    ds_read_b64_tr_b16 v[42:43], v10 offset:1024
    ds_read_b64_tr_b16 v[44:45], v9 offset:32768
    ds_read_b64_tr_b16 v[46:47], v9 offset:33792
    ds_read_b64_tr_b16 v[48:49], v10 offset:32768
    ds_read_b64_tr_b16 v[50:51], v10 offset:33792
    ds_read_b64_tr_b16 v[52:53], v9 offset:8192
    ds_read_b64_tr_b16 v[54:55], v9 offset:9216
    ds_read_b64_tr_b16 v[56:57], v10 offset:8192
    ds_read_b64_tr_b16 v[58:59], v10 offset:9216
    ds_read_b64_tr_b16 v[60:61], v9 offset:40960
    ds_read_b64_tr_b16 v[62:63], v9 offset:41984
    s_waitcnt lgkmcnt(12)
    ds_read_b64_tr_b16 v[64:65], v10 offset:40960
    ds_read_b64_tr_b16 v[66:67], v10 offset:41984
    s_waitcnt lgkmcnt(12)
    ds_read_b64_tr_b16 v[68:69], v9 offset:16384
    ds_read_b64_tr_b16 v[70:71], v9 offset:17408
    s_waitcnt lgkmcnt(12)
    ds_read_b64_tr_b16 v[72:73], v10 offset:16384
    ds_read_b64_tr_b16 v[74:75], v10 offset:17408
    s_waitcnt lgkmcnt(12)
    ds_read_b64_tr_b16 v[76:77], v9 offset:49152
    ds_read_b64_tr_b16 v[78:79], v9 offset:50176
    s_waitcnt lgkmcnt(12)
    ds_read_b64_tr_b16 v[80:81], v10 offset:49152
    ds_read_b64_tr_b16 v[82:83], v10 offset:50176
    s_waitcnt vmcnt(8)
    s_mov_b64 exec, 1
    ds_add_u32 v0, v255 offset:42868
    s_mov_b64 exec, -1
    s_branch L_d_first
L_follower:
    v_readfirstlane_b32 s52, v13
    s_and_b32 s32, s30, 1
    s_lshl_b32 s32, s32, 8
    s_sub_u32 s52, s52, s32
    s_lshl_b32 s31, s50, 12
    s_sub_u32 s31, s31, s32
    s_lshl_b32 s32, s51, 8
    s_add_u32 s31, s31, s32
    s_add_u32 s53, s31, 524288
    s_load_dword s54, s[12:13], s52
    s_load_dword s54, s[12:13], s53
    s_add_u32 s52, s52, 64
    s_add_u32 s53, s53, 64
    s_load_dword s54, s[12:13], s52
    s_load_dword s54, s[12:13], s53
    s_add_u32 s52, s52, 64
    s_add_u32 s53, s53, 64
    s_load_dword s54, s[12:13], s52
    s_load_dword s54, s[12:13], s53
    s_add_u32 s52, s52, 64
    s_add_u32 s53, s53, 64
    s_load_dword s54, s[12:13], s52
    s_load_dword s54, s[12:13], s53
    s_add_u32 s52, s52, 64
    s_add_u32 s53, s53, 64
    s_waitcnt lgkmcnt(0)
    s_load_dword s54, s[12:13], s52
    s_load_dword s54, s[12:13], s53
    s_add_u32 s52, s52, 64
    s_add_u32 s53, s53, 64
    s_load_dword s54, s[12:13], s52
    s_load_dword s54, s[12:13], s53
    s_add_u32 s52, s52, 64
    s_add_u32 s53, s53, 64
    s_load_dword s54, s[12:13], s52
    s_load_dword s54, s[12:13], s53
    s_add_u32 s52, s52, 64
    s_add_u32 s53, s53, 64
    s_load_dword s54, s[12:13], s52
    s_load_dword s54, s[12:13], s53
L_sync9:
    ds_read_b32 v1, v0 offset:42868
    s_add_u32 s92, s92, 1
    s_bitcmp1_b32 s92, 20
    s_cbranch_scc1 L_sync9x
    s_waitcnt lgkmcnt(0)
    v_readfirstlane_b32 s31, v1
    s_nop 0
    s_cmp_ge_u32 s31, 1
    s_cbranch_scc0 L_sync9
L_sync9x:
    s_setprio 3
    s_nop 0
    ds_read_b64_tr_b16 v[36:37], v9 offset:0
    ds_read_b64_tr_b16 v[38:39], v9 offset:1024
    ds_read_b64_tr_b16 v[40:41], v10 offset:0
    ds_read_b64_tr_b16 v[42:43], v10 offset:1024
    ds_read_b64_tr_b16 v[44:45], v9 offset:32768
    ds_read_b64_tr_b16 v[46:47], v9 offset:33792
    ds_read_b64_tr_b16 v[48:49], v10 offset:32768
    ds_read_b64_tr_b16 v[50:51], v10 offset:33792
    ds_read_b64_tr_b16 v[52:53], v9 offset:8192
    ds_read_b64_tr_b16 v[54:55], v9 offset:9216
    ds_read_b64_tr_b16 v[56:57], v10 offset:8192
    ds_read_b64_tr_b16 v[58:59], v10 offset:9216
    ds_read_b64_tr_b16 v[60:61], v9 offset:40960
    ds_read_b64_tr_b16 v[62:63], v9 offset:41984
    s_waitcnt lgkmcnt(12)
    ds_read_b64_tr_b16 v[64:65], v10 offset:40960
    ds_read_b64_tr_b16 v[66:67], v10 offset:41984
    s_waitcnt lgkmcnt(12)
    ds_read_b64_tr_b16 v[68:69], v9 offset:16384
    ds_read_b64_tr_b16 v[70:71], v9 offset:17408
    s_waitcnt lgkmcnt(12)
    ds_read_b64_tr_b16 v[72:73], v10 offset:16384
    ds_read_b64_tr_b16 v[74:75], v10 offset:17408
    s_waitcnt lgkmcnt(12)
    ds_read_b64_tr_b16 v[76:77], v9 offset:49152
    ds_read_b64_tr_b16 v[78:79], v9 offset:50176
    s_waitcnt lgkmcnt(12)
    ds_read_b64_tr_b16 v[80:81], v10 offset:49152
    ds_read_b64_tr_b16 v[82:83], v10 offset:50176
    s_add_u32 s67, s30, 0
L_sync10:
    ds_read_b32 v1, v0 offset:42868
    s_add_u32 s92, s92, 1
    s_bitcmp1_b32 s92, 20
    s_cbranch_scc1 L_sync10x
    s_waitcnt lgkmcnt(0)
    v_readfirstlane_b32 s31, v1
    s_nop 0
    s_cmp_ge_u32 s31, s67
    s_cbranch_scc0 L_sync10
L_sync10x:
L_d_first:
    s_add_u32 m0, s74, 0
    s_mov_b32 s31, 0
    buffer_load_dwordx4 v6, s[24:27], s31 offen nt lds
    s_add_u32 m0, s74, 1024
    s_mov_b32 s31, 16384
    buffer_load_dwordx4 v11, s[24:27], s31 offen nt lds
    s_add_u32 m0, s74, 2048
    s_mov_b32 s31, 32768
    buffer_load_dwordx4 v6, s[24:27], s31 offen nt lds
    s_add_u32 m0, s74, 3072
    s_mov_b32 s31, 49152
    buffer_load_dwordx4 v11, s[24:27], s31 offen nt lds
    s_add_u32 m0, s74, 4096
    s_mov_b32 s31, 65536
    buffer_load_dwordx4 v6, s[24:27], s31 offen nt lds
    s_cmp_lg_u32 s30, 0
    s_cbranch_scc1 L_k3_waitp
    s_waitcnt vmcnt(5)
    s_mov_b64 exec, 1
    ds_add_u32 v0, v255 offset:42868
    s_mov_b64 exec, -1
L_k3_waitp:
    s_waitcnt lgkmcnt(4)
    s_branch L_sync11a
L_sync11:
    s_waitcnt lgkmcnt(0)
L_sync11a:
    ds_read_b32 v1, v0 offset:42868
    ds_read_b64_tr_b16 v[84:85], v9 offset:24576
    ds_read_b64_tr_b16 v[86:87], v9 offset:25600
    ds_read_b64_tr_b16 v[88:89], v10 offset:24576
    ds_read_b64_tr_b16 v[90:91], v10 offset:25600
    ds_read_b64_tr_b16 v[92:93], v9 offset:57344
    ds_read_b64_tr_b16 v[94:95], v9 offset:58368
    ds_read_b64_tr_b16 v[96:97], v10 offset:57344
    ds_read_b64_tr_b16 v[98:99], v10 offset:58368
    s_add_u32 s92, s92, 1
    s_bitcmp1_b32 s92, 20
    s_cbranch_scc1 L_sync11x
    s_waitcnt lgkmcnt(8)
    v_readfirstlane_b32 s31, v1
    s_nop 0
    s_cmp_ge_u32 s31, 3
    s_cbranch_scc0 L_sync11
L_sync11x:
L_key:
    s_waitcnt lgkmcnt(0)
L_sync12:
    ds_read_b32 v1, v0 offset:42844
    ds_read_b64 v[18:19], v0 offset:41552
    ds_read_b128 v[20:23], v8 offset:41600
    ds_read_b128 v[24:27], v8 offset:41664
    ds_read_b128 v[28:31], v8 offset:41728
    ds_read_b128 v[32:35], v8 offset:41792
    s_add_u32 s92, s92, 1
    s_bitcmp1_b32 s92, 20
    s_cbranch_scc1 L_sync12x
    s_waitcnt lgkmcnt(5)
    v_readfirstlane_b32 s31, v1
    s_nop 0
    s_cmp_ge_u32 s31, 1
    s_cbranch_scc0 L_sync12
L_sync12x:
    s_cmp_eq_u32 s66, 0
    s_cbranch_scc1 L_idle
    s_branch L_xs_ok
L_h1:
    s_mov_b32 s63, 4096
    s_lshl_b32 s31, s47, 8
    v_lshlrev_b32 v15, 3, v2
    v_add_u32 v16, s31, v15
    s_cmp_lg_u32 s66, 0
    s_cbranch_scc1 L_gate
L_sync13:
    ds_read_b32 v1, v0 offset:42828
    s_add_u32 s92, s92, 1
    s_bitcmp1_b32 s92, 20
    s_cbranch_scc1 L_sync13x
    s_waitcnt lgkmcnt(0)
    v_readfirstlane_b32 s31, v1
    s_nop 0
    s_cmp_ge_u32 s31, 4
    s_cbranch_scc0 L_sync13
L_sync13x:
    s_branch L_gate_open
L_gate:
L_sync14:
    ds_read_b32 v1, v0 offset:42824
    s_add_u32 s92, s92, 1
    s_bitcmp1_b32 s92, 20
    s_cbranch_scc1 L_sync14x
    s_waitcnt lgkmcnt(0)
    v_readfirstlane_b32 s31, v1
    s_nop 0
    s_cmp_ge_u32 s31, 4
    s_cbranch_scc0 L_sync14
L_sync14x:
L_gate_open:
    s_setprio 3
    buffer_load_dwordx4 v[20:23], v3, s[12:15], s63 offen offset:0 sc1
    buffer_load_dwordx4 v[24:27], v3, s[12:15], s63 offen offset:1024 sc1
    buffer_load_dwordx4 v[28:31], v3, s[12:15], s63 offen offset:2048 sc1
    buffer_load_dwordx4 v[32:35], v3, s[12:15], s63 offen offset:3072 sc1
    s_mov_b64 exec, 1
    ds_add_u32 v0, v255 offset:42860
    s_mov_b64 exec, -1
    s_waitcnt vmcnt(0)
L_mi_check:
    v_cmp_ne_u64 s[52:53], s[28:29], v[22:23]
    v_cmp_ne_u64 s[54:55], s[28:29], v[26:27]
    v_cmp_ne_u64 s[56:57], s[28:29], v[30:31]
    v_cmp_ne_u64 s[58:59], s[28:29], v[34:35]
    v_max_u32 v18, v21, v25
    v_max3_u32 v18, v18, v29, v33
    s_or_b64 s[64:65], s[52:53], s[54:55]
    s_or_b64 vcc, s[56:57], s[58:59]
    s_or_b64 s[64:65], s[64:65], vcc
    s_cbranch_scc0 L_mi_got
    s_cmp_eq_u32 s35, 0
    s_cbranch_scc1 L_mi_got
    s_sub_u32 s35, s35, 1
    s_sleep 2
    s_mov_b64 exec, s[52:53]
    s_cbranch_execz L_mi_skip0
    buffer_load_dwordx4 v[20:23], v3, s[12:15], s63 offen offset:0 sc1
L_mi_skip0:
    s_mov_b64 exec, s[54:55]
    s_cbranch_execz L_mi_skip1
    buffer_load_dwordx4 v[24:27], v3, s[12:15], s63 offen offset:1024 sc1
L_mi_skip1:
    s_mov_b64 exec, s[56:57]
    s_cbranch_execz L_mi_skip2
    buffer_load_dwordx4 v[28:31], v3, s[12:15], s63 offen offset:2048 sc1
L_mi_skip2:
    s_mov_b64 exec, s[58:59]
    s_cbranch_execz L_mi_skip3
    buffer_load_dwordx4 v[32:35], v3, s[12:15], s63 offen offset:3072 sc1
L_mi_skip3:
    s_mov_b64 exec, -1
    s_waitcnt vmcnt(0)
    s_branch L_mi_check
L_mi_got:
    v_max_u32_dpp v19, v18, v18 row_ror:1 row_mask:0xf bank_mask:0xf
    s_nop 1
    v_max_u32_dpp v19, v19, v19 row_ror:2 row_mask:0xf bank_mask:0xf
    s_nop 1
    v_max_u32_dpp v19, v19, v19 row_ror:4 row_mask:0xf bank_mask:0xf
    s_nop 1
    v_max_u32_dpp v19, v19, v19 row_ror:8 row_mask:0xf bank_mask:0xf
    s_nop 0
    v_readlane_b32 s33, v19, 0
    v_readlane_b32 s31, v19, 16
    v_readlane_b32 s32, v19, 32
    v_readlane_b32 s34, v19, 48
    s_max_u32 s33, s33, s31
    s_max_u32 s32, s32, s34
    s_max_u32 s33, s33, s32
    s_andn2_b32 s31, 0x7ff, s33
    s_lshl_b32 s48, s31, 11
    buffer_load_dwordx2 v[150:151], v16, s[8:11], s48 offen
    s_mov_b64 exec, 1
    ds_add_u32 v0, v255 offset:42840
    s_mov_b64 exec, -1
    v_cmp_eq_u32 s[52:53], s33, v25
    v_cmp_eq_u32 s[54:55], s33, v29
    v_cmp_eq_u32 s[56:57], s33, v33
    v_cmp_eq_u32 vcc, s33, v18
    v_cndmask_b32 v19, v20, v24, s[52:53]
    v_cndmask_b32 v19, v19, v28, s[54:55]
    v_cndmask_b32 v19, v19, v32, s[56:57]
    s_ff1_i32_b64 s32, vcc
    v_readlane_b32 s34, v19, s32
    v_mov_b32 v19, s33
    s_nop 0
    v_mov_b32 v18, s34
    ds_write_b64 v0, v[18:19] offset:41552
    s_lshl_b32 s52, s34, 16
    s_and_b32 s32, s34, 0xffff0000
    v_rcp_f32 v148, s32
    s_cmp_eq_u32 s66, 0
    s_cbranch_scc1 L_h1_idle
L_sync15:
    ds_read_b32 v1, v0 offset:42868
    s_add_u32 s92, s92, 1
    s_bitcmp1_b32 s92, 20
    s_cbranch_scc1 L_sync15x
    s_waitcnt lgkmcnt(0)
    v_readfirstlane_b32 s31, v1
    s_nop 0
    s_cmp_ge_u32 s31, 1
    s_cbranch_scc0 L_sync15
L_sync15x:
    s_nop 0
    ds_read_b64_tr_b16 v[36:37], v9 offset:0
    ds_read_b64_tr_b16 v[38:39], v9 offset:1024
    ds_read_b64_tr_b16 v[40:41], v10 offset:0
    ds_read_b64_tr_b16 v[42:43], v10 offset:1024
    ds_read_b64_tr_b16 v[44:45], v9 offset:32768
    ds_read_b64_tr_b16 v[46:47], v9 offset:33792
    ds_read_b64_tr_b16 v[48:49], v10 offset:32768
    ds_read_b64_tr_b16 v[50:51], v10 offset:33792
    ds_read_b64_tr_b16 v[52:53], v9 offset:8192
    ds_read_b64_tr_b16 v[54:55], v9 offset:9216
    ds_read_b64_tr_b16 v[56:57], v10 offset:8192
    ds_read_b64_tr_b16 v[58:59], v10 offset:9216
    ds_read_b64_tr_b16 v[60:61], v9 offset:40960
    ds_read_b64_tr_b16 v[62:63], v9 offset:41984
    s_waitcnt lgkmcnt(12)
    ds_read_b64_tr_b16 v[64:65], v10 offset:40960
    ds_read_b64_tr_b16 v[66:67], v10 offset:41984
    s_waitcnt lgkmcnt(12)
    ds_read_b64_tr_b16 v[68:69], v9 offset:16384
    ds_read_b64_tr_b16 v[70:71], v9 offset:17408
    s_waitcnt lgkmcnt(12)
    ds_read_b64_tr_b16 v[72:73], v10 offset:16384
    ds_read_b64_tr_b16 v[74:75], v10 offset:17408
    s_waitcnt lgkmcnt(12)
    ds_read_b64_tr_b16 v[76:77], v9 offset:49152
    ds_read_b64_tr_b16 v[78:79], v9 offset:50176
    s_waitcnt lgkmcnt(12)
    ds_read_b64_tr_b16 v[80:81], v10 offset:49152
    ds_read_b64_tr_b16 v[82:83], v10 offset:50176
    s_waitcnt lgkmcnt(4)
    s_branch L_sync16a
L_sync16:
    s_waitcnt lgkmcnt(0)
L_sync16a:
    ds_read_b32 v1, v0 offset:42868
    ds_read_b64_tr_b16 v[84:85], v9 offset:24576
    ds_read_b64_tr_b16 v[86:87], v9 offset:25600
    ds_read_b64_tr_b16 v[88:89], v10 offset:24576
    ds_read_b64_tr_b16 v[90:91], v10 offset:25600
    ds_read_b64_tr_b16 v[92:93], v9 offset:57344
    ds_read_b64_tr_b16 v[94:95], v9 offset:58368
    ds_read_b64_tr_b16 v[96:97], v10 offset:57344
    ds_read_b64_tr_b16 v[98:99], v10 offset:58368
    s_add_u32 s92, s92, 1
    s_bitcmp1_b32 s92, 20
    s_cbranch_scc1 L_sync16x
    s_waitcnt lgkmcnt(8)
    v_readfirstlane_b32 s31, v1
    s_nop 0
    s_cmp_ge_u32 s31, 3
    s_cbranch_scc0 L_sync16
L_sync16x:
    s_waitcnt vmcnt(0) lgkmcnt(0)
    s_branch L_h1_x
L_h1_idle:
    s_waitcnt vmcnt(0)
L_h1_x:
    v_lshlrev_b32 v20, 16, v150
    v_and_b32 v21, 0xffff0000, v150
    v_lshlrev_b32 v22, 16, v151
    v_and_b32 v23, 0xffff0000, v151
    v_pk_add_f32 v[20:21], v[20:21], s[52:53] op_sel_hi:[1,0] neg_lo:[0,1] neg_hi:[0,1]
    v_pk_add_f32 v[22:23], v[22:23], s[52:53] op_sel_hi:[1,0] neg_lo:[0,1] neg_hi:[0,1]
    v_cvt_pk_bf16_f32 v150, v20, v21
    v_cvt_pk_bf16_f32 v151, v22, v23
    v_lshlrev_b32 v20, 16, v150
    v_and_b32 v21, 0xffff0000, v150
    v_lshlrev_b32 v22, 16, v151
    v_and_b32 v23, 0xffff0000, v151
    v_pk_mul_f32 v[20:21], v[20:21], v[148:149] op_sel_hi:[1,0]
    v_pk_mul_f32 v[22:23], v[22:23], v[148:149] op_sel_hi:[1,0]
    v_cvt_pk_bf16_f32 v150, v20, v21
    v_cvt_pk_bf16_f32 v151, v22, v23
    ds_write_b64 v15, v[150:151] offset:41600
    s_mov_b64 exec, 1
    ds_add_u32 v0, v255 offset:42844
    s_mov_b64 exec, -1
    s_cmp_eq_u32 s66, 0
    s_cbranch_scc1 L_idle
    ds_read_b128 v[20:23], v8 offset:41600
    ds_read_b128 v[24:27], v8 offset:41664
    ds_read_b128 v[28:31], v8 offset:41728
    ds_read_b128 v[32:35], v8 offset:41792
    s_add_u32 m0, s74, 0
    s_mov_b32 s31, 0
    s_nop 0
    buffer_load_dwordx4 v6, s[24:27], s31 offen nt lds
    s_add_u32 m0, s74, 1024
    s_mov_b32 s31, 16384
    buffer_load_dwordx4 v11, s[24:27], s31 offen nt lds
    s_add_u32 m0, s74, 2048
    s_mov_b32 s31, 32768
    buffer_load_dwordx4 v6, s[24:27], s31 offen nt lds
    s_add_u32 m0, s74, 3072
    s_mov_b32 s31, 49152
    buffer_load_dwordx4 v11, s[24:27], s31 offen nt lds
    s_add_u32 m0, s74, 4096
    s_mov_b32 s31, 65536
    buffer_load_dwordx4 v6, s[24:27], s31 offen nt lds
L_xs_ok:
    s_waitcnt lgkmcnt(3)
    v_mfma_f32_16x16x32_bf16 v[132:135], v[20:23], v[36:39], 0
    v_mfma_f32_16x16x32_bf16 v[136:139], v[20:23], v[40:43], 0
    v_mfma_f32_16x16x32_bf16 v[140:143], v[20:23], v[44:47], 0
    v_mfma_f32_16x16x32_bf16 v[144:147], v[20:23], v[48:51], 0
    s_waitcnt lgkmcnt(2)
    v_mfma_f32_16x16x32_bf16 v[132:135], v[24:27], v[52:55], v[132:135]
    v_mfma_f32_16x16x32_bf16 v[136:139], v[24:27], v[56:59], v[136:139]
    v_mfma_f32_16x16x32_bf16 v[140:143], v[24:27], v[60:63], v[140:143]
    v_mfma_f32_16x16x32_bf16 v[144:147], v[24:27], v[64:67], v[144:147]
    s_waitcnt lgkmcnt(1)
    v_mfma_f32_16x16x32_bf16 v[132:135], v[28:31], v[68:71], v[132:135]
    v_mfma_f32_16x16x32_bf16 v[136:139], v[28:31], v[72:75], v[136:139]
    v_mfma_f32_16x16x32_bf16 v[140:143], v[28:31], v[76:79], v[140:143]
    v_mfma_f32_16x16x32_bf16 v[144:147], v[28:31], v[80:83], v[144:147]
    v_readfirstlane_b32 s33, v19
    v_readfirstlane_b32 s34, v18
    s_waitcnt lgkmcnt(0)
    v_mfma_f32_16x16x32_bf16 v[132:135], v[32:35], v[84:87], v[132:135]
    v_mfma_f32_16x16x32_bf16 v[136:139], v[32:35], v[88:91], v[136:139]
    v_mfma_f32_16x16x32_bf16 v[140:143], v[32:35], v[92:95], v[140:143]
    v_mfma_f32_16x16x32_bf16 v[144:147], v[32:35], v[96:99], v[144:147]
    s_mov_b32 vcc_lo, 0xffff0000
    s_mov_b32 vcc_hi, 0
    s_lshl_b32 s31, s50, 12
    s_lshl_b32 s32, s30, 7
    s_add_u32 s31, s31, s32
    s_add_u32 s31, s31, 262144
    v_lshrrev_b32 v15, 3, v2
    v_lshlrev_b32 v15, 9, v15
    v_add3_u32 v15, v15, v7, s31
    v_cndmask_b32 v26, v132, v136, vcc
    v_cndmask_b32 v27, v140, v144, vcc
    v_and_or_b32 v26, v26, s49, v14
    v_and_or_b32 v27, v27, s49, v14
    s_mov_b32 exec_hi, 0
    buffer_store_dwordx2 v[26:27], v13, s[12:15], 0 offen sc1
    s_mov_b64 exec, -1
    s_add_u32 m0, s74, 5120
    s_mov_b32 s31, 81920
    buffer_load_dwordx4 v11, s[24:27], s31 offen nt lds
    s_add_u32 m0, s74, 6144
    s_mov_b32 s31, 98304
    buffer_load_dwordx4 v6, s[24:27], s31 offen nt lds
    s_add_u32 m0, s74, 7168
    s_mov_b32 s31, 114688
    buffer_load_dwordx4 v11, s[24:27], s31 offen nt lds
    s_mov_b64 exec, 1
    ds_add_u32 v0, v255 offset:42848
    s_mov_b64 exec, -1
    s_setprio 3
    v_and_b32 v16, 7, v2
    v_lshlrev_b32 v16, 2, v16
    v_lshrrev_b32 v17, 5, v2
    v_lshl_add_u32 v16, v17, 1, v16
    s_lshl_b32 s31, s30, 5
    v_add_u32 v16, s31, v16
    v_and_b32 v17, 48, v2
    v_bfe_u32 v9, v2, 3, 2
    v_lshlrev_b32 v9, 5, v9
    v_bfe_u32 v10, v2, 2, 2
    v_lshl_add_u32 v9, v10, 7, v9
    v_lshl_add_u32 v9, v17, 6, v9
    v_and_b32 v10, 3, v2
    v_lshlrev_b32 v10, 3, v10
    v_add3_u32 v9, v9, v10, s74
    v_xor_b32 v10, 32, v9
    v_xor_b32 v12, 96, v9
    v_xor_b32 v8, 64, v9
    s_lshl_b32 s31, s50, 12
    s_lshl_b32 s32, s51, 8
    s_add_u32 s31, s31, s32
    s_add_u32 s31, s31, 524288
    v_lshl_add_u32 v18, v2, 2, s31
    s_waitcnt vmcnt(5)
    s_waitcnt lgkmcnt(4)
    ds_read_b64_tr_b16 v[100:101], v9 offset:0
    ds_read_b64_tr_b16 v[102:103], v9 offset:512
    ds_read_b64_tr_b16 v[104:105], v10 offset:0
    ds_read_b64_tr_b16 v[106:107], v10 offset:512
    ds_read_b64_tr_b16 v[108:109], v8 offset:0
    ds_read_b64_tr_b16 v[110:111], v8 offset:512
    ds_read_b64_tr_b16 v[112:113], v12 offset:0
    ds_read_b64_tr_b16 v[114:115], v12 offset:512
    s_waitcnt vmcnt(0)
    buffer_load_dwordx4 v[20:23], v15, s[12:15], 0 offen sc1
    s_waitcnt lgkmcnt(4)
    ds_read_b64_tr_b16 v[116:117], v9 offset:4096
    ds_read_b64_tr_b16 v[118:119], v9 offset:4608
    ds_read_b64_tr_b16 v[120:121], v10 offset:4096
    ds_read_b64_tr_b16 v[122:123], v10 offset:4608
    ds_read_b64_tr_b16 v[124:125], v8 offset:4096
    ds_read_b64_tr_b16 v[126:127], v8 offset:4608
    ds_read_b64_tr_b16 v[128:129], v12 offset:4096
    ds_read_b64_tr_b16 v[130:131], v12 offset:4608
    s_mov_b32 s54, 0
    s_branch L_hp_wait
L_hp_poll:
    buffer_load_dwordx4 v[20:23], v15, s[12:15], 0 offen sc1
L_hp_wait:
    s_waitcnt vmcnt(0)
    v_xor_b32 v20, v14, v20
    v_xor_b32 v21, v14, v21
    v_xor_b32 v22, v14, v22
    v_xor_b32 v23, v14, v23
    v_or3_b32 v24, v20, v21, v22
    v_or_b32 v24, v24, v23
    v_and_b32 v24, 0xff, v24
    v_cmp_ne_u32 vcc, 0, v24
    v_permlane16_swap_b32 v20, v21
    v_permlane16_swap_b32 v22, v23
    s_cbranch_vccz L_hp_got
    s_cmp_eq_u32 s35, 0
    s_cbranch_scc1 L_hp_got
    s_sub_u32 s35, s35, 1
    s_branch L_hp_poll
L_hp_got:
    v_add_f32 v20, v20, v21
    v_add_f32 v22, v22, v23
    s_nop 1
    v_permlane32_swap_b32 v20, v22
    v_add_f32 v20, v20, v22
    s_nop 1
    v_add_f32_dpp v21, v20, v20 row_ror:8 row_mask:0xf bank_mask:0xf
    v_add_f32_dpp v20, v20, v20 row_ror:8 row_mask:0xf bank_mask:0xf
    s_nop 1
    v_permlane16_swap_b32 v20, v21
    v_cvt_pk_bf16_f32 v20, v20, v21
    v_and_b32 v21, 0xffff0000, v20
    v_lshlrev_b32 v20, 16, v20
    v_mul_f32 v22, 0xbfb8aa3b, v20
    v_exp_f32 v22, v22
    s_nop 0
    v_add_f32 v22, 1.0, v22
    v_rcp_f32 v22, v22
    s_nop 0
    v_mul_f32 v20, v20, v22
    v_cvt_pk_bf16_f32 v20, v20, v20
    v_lshlrev_b32 v20, 16, v20
    v_mul_f32 v20, v20, v21
    v_cvt_pk_bf16_f32 v20, v20, v20
    ds_write_b16 v16, v20 offset:42368
    s_mov_b64 exec, 1
    ds_add_u32 v0, v255 offset:42852
    s_mov_b64 exec, -1
L_sync17:
    ds_read_b32 v1, v0 offset:42852
    ds_read_b128 v[28:31], v17 offset:42368
    ds_read_b128 v[32:35], v17 offset:42432
    s_add_u32 s92, s92, 1
    s_bitcmp1_b32 s92, 20
    s_cbranch_scc1 L_sync17x
    s_waitcnt lgkmcnt(2)
    v_readfirstlane_b32 s31, v1
    s_nop 0
    s_cmp_ge_u32 s31, 4
    s_cbranch_scc0 L_sync17
L_sync17x:
    s_waitcnt lgkmcnt(1)
    v_mfma_f32_16x16x32_bf16 v[36:39], v[28:31], v[100:103], 0
    v_mfma_f32_16x16x32_bf16 v[40:43], v[28:31], v[104:107], 0
    v_mfma_f32_16x16x32_bf16 v[44:47], v[28:31], v[108:111], 0
    v_mfma_f32_16x16x32_bf16 v[48:51], v[28:31], v[112:115], 0
    s_waitcnt lgkmcnt(0)
    v_mfma_f32_16x16x32_bf16 v[36:39], v[32:35], v[116:119], v[36:39]
    v_mfma_f32_16x16x32_bf16 v[40:43], v[32:35], v[120:123], v[40:43]
    v_mfma_f32_16x16x32_bf16 v[44:47], v[32:35], v[124:127], v[44:47]
    v_mfma_f32_16x16x32_bf16 v[48:51], v[32:35], v[128:131], v[48:51]
    s_mov_b32 vcc_lo, 0xffff0000
    s_mov_b32 vcc_hi, 0xffff0000
    s_mov_b32 s52, 0
    s_mov_b32 s53, -1
    s_nop 1
    v_cndmask_b32 v36, v36, v40, vcc
    s_nop 0
    v_cndmask_b32 v44, v44, v48, vcc
    v_cndmask_b32 v36, v36, v44, s[52:53]
    v_and_or_b32 v36, v36, s49, v14
    buffer_store_dword v36, v18, s[12:15], 0 offen sc1
    s_mov_b64 exec, 1
    ds_add_u32 v0, v255 offset:42856
    s_mov_b64 exec, -1
    s_branch L_owner
L_idle:
    s_mov_b64 exec, 1
    ds_add_u32 v0, v255 offset:42868
    s_mov_b64 exec, -1
    s_mov_b64 exec, 1
    ds_add_u32 v0, v255 offset:42848
    s_mov_b64 exec, -1
    s_mov_b64 exec, 1
    ds_add_u32 v0, v255 offset:42852
    s_mov_b64 exec, -1
    s_mov_b64 exec, 1
    ds_add_u32 v0, v255 offset:42856
    s_mov_b64 exec, -1
    s_waitcnt lgkmcnt(0)
    v_readfirstlane_b32 s33, v19
    v_readfirstlane_b32 s34, v18
L_owner:
    s_setprio 1
    s_and_b32 s31, s2, 7
    s_sub_u32 s32, 8, s31
    s_min_u32 s46, s31, s32
    s_lshr_b32 s53, s31, 2
    s_lshr_b32 s47, s2, 3
    s_and_b32 s32, s47, 1
    s_and_b32 s31, s31, 3
    s_cselect_b32 s53, s53, s32
    s_cselect_b32 s31, 0, 1
    s_lshr_b32 s47, s47, s31
    s_lshl_b32 s53, s53, 4
    s_lshl_b32 s53, s53, 3
    s_add_u32 s53, s53, s46
    s_andn2_b32 s51, 0x7ff, s33
    s_mov_b32 s54, s51
    s_mov_b32 s55, 0
    s_mov_b32 s56, 0
    s_mov_b32 s16, s44
    s_mov_b32 s17, s45
    s_mov_b32 s18, 0x400000
    v_and_b32 v8, 31, v2
    v_lshlrev_b32 v15, 2, v8
    v_lshlrev_b32 v8, 1, v8
    v_mov_b32 v16, 0
L_seg:
    s_xor_b32 s31, s54, s53
    s_and_b32 s31, s31, 0x87
    s_cbranch_scc1 L_seg_next
    s_lshl_b32 s31, s51, 11
    s_lshl_b32 s32, s47, 6
    s_add_u32 s63, s31, s32
    buffer_load_ushort v9, v8, s[8:11], s63 offen
    v_lshrrev_b32 v4, 3, v2
    s_lshl_b32 s31, s30, 4
    v_add_u32 v4, s31, v4
    v_lshlrev_b32 v4, 12, v4
    s_lshl_b32 s31, s47, 7
    s_add_u32 s31, s31, 524288
    v_add3_u32 v4, v4, v7, s31
    s_mov_b32 s62, 32768
    v_mov_b32 v24, v14
    v_mov_b32 v25, v14
    v_mov_b32 v26, v14
    v_mov_b32 v27, v14
    v_lshrrev_b32 v5, 4, v2
    v_lshl_add_u32 v6, v5, 2, v7
    s_lshl_b32 s31, s30, 7
    s_add_u32 s31, s31, s55
    v_add_u32 v6, s31, v6
    s_ashr_i32 s31, s33, 31
    s_orn2_b32 s31, 0x80000000, s31
    s_xor_b32 s31, s31, s33
    s_and_b32 s31, s31, 0xfffff800
    v_cvt_pk_bf16_f32 v11, s31, s31
    v_lshlrev_b32 v11, 16, v11
    v_mul_f32 v11, 0xbfb8aa3b, v11
    v_exp_f32 v11, v11
    s_and_b32 s32, s34, 0xffff0000
    v_add_f32 v11, 1.0, v11
    v_rcp_f32 v11, v11
    v_rcp_f32 v12, s32
    v_cvt_pk_bf16_f32 v11, v11, v11
    v_lshlrev_b32 v11, 16, v11
    s_lshl_b32 s31, s34, 16
    s_waitcnt vmcnt(0)
    v_lshl_add_u32 v13, v8, 1, s55
    s_mov_b64 vcc, -1
    s_mov_b32 s56, 1
L_y_poll:
    s_mov_b64 exec, vcc
    buffer_load_dwordx4 v[20:23], v4, s[12:15], 0 offen sc1
    s_cmp_eq_u32 s30, 3
    s_cbranch_scc1 L_y_one
    buffer_load_dwordx4 v[24:27], v4, s[12:15], s62 offen sc1
L_y_one:
    s_mov_b64 exec, -1
    s_waitcnt vmcnt(0)
    v_xor_b32 v28, v14, v20
    v_xor_b32 v29, v14, v21
    v_xor_b32 v30, v14, v22
    v_xor_b32 v31, v14, v23
    v_xor_b32 v32, v14, v24
    v_xor_b32 v33, v14, v25
    v_xor_b32 v34, v14, v26
    v_xor_b32 v35, v14, v27
    v_or3_b32 v1, v28, v29, v30
    v_or3_b32 v1, v1, v31, v32
    v_or3_b32 v1, v1, v33, v34
    v_or_b32 v1, v1, v35
    v_and_b32 v1, 0xff, v1
    v_cmp_ne_u32 vcc, 0, v1
    v_pk_add_f32 v[28:29], v[28:29], v[32:33]
    v_pk_add_f32 v[30:31], v[30:31], v[34:35]
    s_cbranch_vccz L_y_got
    s_cmp_eq_u32 s35, 0
    s_cbranch_scc1 L_y_got
    s_sub_u32 s35, s35, 1
    s_branch L_y_poll
L_y_got:
    v_permlane16_swap_b32 v28, v29
    v_permlane16_swap_b32 v30, v31
    v_add_f32 v28, v28, v29
    v_add_f32 v30, v30, v31
    s_nop 1
    v_permlane32_swap_b32 v28, v30
    v_add_f32 v28, v28, v30
    s_nop 1
    v_add_f32_dpp v28, v28, v28 row_ror:8 row_mask:0xf bank_mask:0xf
    ds_write_b32 v6, v28 offset:43008
    s_mov_b64 exec, 1
    ds_add_u32 v16, v255 offset:42836
    s_mov_b64 exec, -1
    s_cmp_lg_u32 s30, 0
    s_cbranch_scc1 L_seg_next
    s_cmp_eq_u32 s47, 0
    s_cselect_b32 s32, 0, 2147483392
    v_mov_b32 v5, 2147483392
    v_writelane_b32 v5, s32, 0
    v_mov_b32 v18, s28
    v_mov_b32 v19, s29
    s_lshl_b32 s31, s34, 16
    v_lshlrev_b32 v9, 16, v9
    v_subrev_f32 v10, s31, v9
    v_cvt_pk_bf16_f32 v10, v10, v10
    v_lshlrev_b32 v10, 16, v10
    v_mul_f32 v10, v10, v12
    v_cvt_pk_bf16_f32 v10, v10, v10
    v_lshlrev_b32 v10, 16, v10
L_sync18:
    ds_read_b32 v1, v16 offset:42836
    ds_read_b32 v20, v13 offset:43008
    ds_read_b32 v21, v13 offset:43136
    ds_read_b32 v22, v13 offset:43264
    ds_read_b32 v23, v13 offset:43392
    ds_read_b32 v24, v15 offset:42496
    s_add_u32 s92, s92, 1
    s_bitcmp1_b32 s92, 20
    s_cbranch_scc1 L_sync18x
    s_waitcnt lgkmcnt(5)
    v_readfirstlane_b32 s31, v1
    s_nop 0
    s_cmp_ge_u32 s31, 5
    s_cbranch_scc0 L_sync18
L_sync18x:
    s_waitcnt lgkmcnt(0)
    v_add_f32 v20, v20, v21
    v_add_f32 v22, v22, v23
    v_add_f32 v20, v20, v22
    v_cvt_pk_bf16_f32 v20, v20, v20
    v_lshlrev_b32 v20, 16, v20
    v_mul_f32 v20, v20, v11
    v_cvt_pk_bf16_f32 v20, v20, v20
    v_lshlrev_b32 v20, 16, v20
    v_add_f32 v20, v20, v10
    v_cvt_pk_bf16_f32 v20, v20, v20
    v_lshlrev_b32 v20, 16, v20
    v_mul_f32 v1, 0xbfb8aa3b, v20
    v_mul_f32 v20, v1, v24
    v_exp_f32 v1, v1
    s_nop 0
    v_add_f32 v1, 1.0, v1
    v_rcp_f32 v1, v1
    s_mov_b32 exec_hi, 0
    v_fma_f32 v20, v20, v1, v9
    v_cvt_pk_bf16_f32 v20, v20, v20
    buffer_store_short v20, v8, s[16:19], s63 offen sc1
    buffer_store_dwordx2 v[18:19], v5, s[12:15], 0 offen sc1
    s_mov_b64 exec, -1
L_seg_next:
    s_cmp_lg_u32 s55, 0
    s_cbranch_scc1 L_seg_end
    s_mov_b32 s55, 512
    s_sub_u32 s54, 0, s51
    s_sub_u32 s47, 31, s47
    v_mov_b32 v16, 28
    v_and_b32 v15, 24, v2
    v_xor_b32 v15, 24, v15
    v_sub_u32 v1, 0, v2
    v_and_b32 v1, 7, v1
    v_add_u32 v15, v15, v1
    v_lshlrev_b32 v15, 2, v15
    v_add_u32 v15, 128, v15
    s_branch L_seg
L_seg_end:
L_fin:
L_exit:
    s_endpgm
L_code_end:
.section .rodata,"a"
.p2align 6
.amdhsa_kernel recurrent_scan__spectral_fnet__moe_arch_mod__prompt_kernel
  .amdhsa_next_free_vgpr 256
  .amdhsa_next_free_sgpr 94
  .amdhsa_accum_offset 256
  .amdhsa_group_segment_fixed_size 0
  .amdhsa_kernarg_size 104
  .amdhsa_user_sgpr_count 2
  .amdhsa_user_sgpr_kernarg_segment_ptr 1
  .amdhsa_system_sgpr_workgroup_id_x 1
  .amdhsa_float_denorm_mode_32 3
.end_amdhsa_kernel
```

```asm
; @launch grid=(256,1,1) block=(512,1,1) lds=158720
.amdgcn_target "amdgcn-amd-amdhsa--gfx950"
.text
.globl recurrent_scan__spectral_fnet__moe_arch_mod__prompt_kernel
.p2align 8
.type recurrent_scan__spectral_fnet__moe_arch_mod__prompt_kernel,@function
recurrent_scan__spectral_fnet__moe_arch_mod__prompt_kernel:
    s_cmp_ge_u32 s2, 256
    s_cbranch_scc1 L_exit
    s_load_dwordx2 s[8:9], s[0:1], 0
    s_load_dwordx4 s[36:39], s[0:1], 48
    s_load_dwordx2 s[12:13], s[0:1], 96
    s_getpc_b64 s[32:33]
L_pc:
    s_bfe_u32 s31, s2, 0x30003
    v_subrev_u32 v3, 492, v0
    v_lshl_add_u32 v3, v3, 3, s31
    v_lshlrev_b32 v3, 7, v3
    v_cmp_gt_u32 vcc, L_code_end-L_pc, v3
    s_nop 0
    s_and_saveexec_b64 s[46:47], vcc
    s_cbranch_execz L_nopf
    global_load_dword v254, v3, s[32:33]
L_nopf:
    s_mov_b64 exec, -1
    v_lshrrev_b32 v1, 6, v0
    v_and_b32 v2, 63, v0
    v_readfirstlane_b32 s30, v1
    s_mov_b32 s10, 0x400000
    s_mov_b32 s11, 0x00020000
    s_mov_b32 s14, 0x10000000
    s_mov_b32 s15, 0x00020000
    s_mov_b32 s35, 65536
    s_mov_b32 s92, 0
    v_lshlrev_b32 v3, 4, v2
    v_mov_b32 v0, 0
    v_mov_b32 v255, 1
    s_mov_b32 s3, s30
    s_and_b32 s30, s30, 3
    s_cmp_ge_u32 s3, 4
    s_cbranch_scc1 L_moe
    s_and_b32 s31, s2, 7
    s_lshr_b32 s32, s2, 4
    s_sub_u32 s32, 15, s32
    s_lshl_b32 s32, s32, 3
    s_add_u32 s46, s32, s31
    s_bfe_u32 s47, s2, 0x10003
    s_lshl_b32 s31, s47, 2
    s_add_u32 s51, s31, s30
    s_lshl_b32 s31, s51, 8
    s_add_u32 s52, s31, s46
    s_xor_b32 s54, s52, 1024
    s_sub_u32 s53, 2048, s52
    s_add_u32 s31, s52, 128
    s_cmp_eq_u32 s46, 0
    s_cselect_b32 s53, s31, s53
    s_cselect_b32 s50, 1, 0
    s_xor_b32 s55, s53, 1024
    s_lshl_b32 s56, s52, 11
    s_lshl_b32 s57, s53, 11
    s_lshl_b32 s58, s54, 11
    s_lshl_b32 s59, s55, 11
    s_mov_b32 s22, 2048
    s_mov_b32 s23, 0x00020000
    v_mov_b32 v1, 0
    v_and_b32 v6, 15, v2
    v_lshlrev_b32 v6, 2, v6
    ds_write_b64 v0, v[0:1] offset:41504
    ds_write_b32 v6, v0 offset:42816
    s_waitcnt lgkmcnt(0)
    s_load_dwordx2 s[28:29], s[12:13], 0
    s_load_dwordx2 s[16:17], s[0:1], 80
    buffer_load_dwordx4 v[120:123], v3, s[8:11], s56 offen
    buffer_load_dwordx4 v[124:127], v3, s[8:11], s56 offen offset:1024
    buffer_load_dwordx4 v[128:131], v3, s[8:11], s57 offen
    buffer_load_dwordx4 v[132:135], v3, s[8:11], s57 offen offset:1024
    s_mov_b32 s20, s36
    s_mov_b32 s21, s37
    buffer_load_dwordx4 v[152:155], v3, s[20:23], 0 offen
    buffer_load_dwordx4 v[156:159], v3, s[20:23], 0 offen offset:1024
    buffer_load_dwordx4 v[136:139], v3, s[8:11], s58 offen
    buffer_load_dwordx4 v[140:143], v3, s[8:11], s58 offen offset:1024
    buffer_load_dwordx4 v[144:147], v3, s[8:11], s59 offen
    buffer_load_dwordx4 v[148:151], v3, s[8:11], s59 offen offset:1024
    s_barrier
    s_branch L_dft_rest
L_moe:
    s_load_dwordx2 s[20:21], s[0:1], 64
    s_and_b32 s32, s2, 7
    s_mul_i32 s32, s32, 28
    s_lshr_b32 s31, s2, 3
    s_add_u32 s31, s31, s32
    s_lshr_b32 s46, s31, 3
    s_lshl_b32 s46, s46, 1
    s_and_b32 s47, s31, 7
    s_mov_b32 s75, 0
    s_mov_b32 s18, 7340032
    s_mov_b32 s19, 0x00020000
    s_mov_b32 s22, 7340032
    s_mov_b32 s23, 0x00020000
    s_mov_b32 s26, 7340032
    s_mov_b32 s27, 0x00020000
    v_lshrrev_b32 v4, 4, v2
    v_lshlrev_b32 v5, 5, v4
    v_and_b32 v6, 0x70, v3
    v_xor_b32 v5, v5, v6
    v_mul_u32_u24 v4, 7168, v4
    s_mul_i32 s31, s47, 917504
    s_lshl_b32 s32, s46, 7
    s_add_u32 s31, s31, s32
    v_add3_u32 v4, v4, v5, s31
    s_cmp_eq_u32 s75, 0
    s_mov_b32 s31, 917504
    s_cselect_b32 s31, 128, s31
    v_add_u32 v6, s31, v4
    s_mov_b32 vcc_lo, 0xff00ff00
    s_mov_b32 vcc_hi, 0xff00ff00
    v_cndmask_b32 v5, v6, v4, vcc
    v_cndmask_b32 v4, v4, v6, vcc
    s_mov_b32 s48, 0
    s_mov_b32 s49, 76800
    s_waitcnt lgkmcnt(0)
    s_mov_b32 s16, s38
    s_mov_b32 s17, s39
    s_load_dwordx2 s[28:29], s[12:13], 0
    s_load_dwordx2 s[24:25], s[0:1], 72
    s_load_dwordx2 s[44:45], s[0:1], 80
    s_barrier
    s_cmp_ge_u32 s2, 224
    s_cselect_b32 s66, 0, 1
    s_cbranch_scc1 L_dma_done
    s_cmp_lg_u32 s30, 0
    s_cbranch_scc1 L_dma_done
    s_setprio 3
L_dma0:
    s_mov_b32 m0, s49
    s_waitcnt vmcnt(19)
    buffer_load_dwordx4 v4, s[16:19], s48 offen nt lds
    s_add_u32 m0, s49, 32768
    s_add_u32 s49, s49, 1024
    s_waitcnt vmcnt(19)
    buffer_load_dwordx4 v4, s[20:23], s48 offen nt lds
    s_add_u32 s48, s48, 28672
    s_mov_b32 m0, s49
    s_waitcnt vmcnt(19)
    buffer_load_dwordx4 v4, s[16:19], s48 offen nt lds
    s_add_u32 m0, s49, 32768
    s_add_u32 s49, s49, 1024
    s_waitcnt vmcnt(19)
    buffer_load_dwordx4 v4, s[20:23], s48 offen nt lds
    s_add_u32 s48, s48, 28672
    s_mov_b32 m0, s49
    s_waitcnt vmcnt(19)
    buffer_load_dwordx4 v5, s[16:19], s48 offen nt lds
    s_add_u32 m0, s49, 32768
    s_add_u32 s49, s49, 1024
    s_waitcnt vmcnt(19)
    buffer_load_dwordx4 v5, s[20:23], s48 offen nt lds
    s_add_u32 s48, s48, 28672
    s_mov_b32 m0, s49
    s_waitcnt vmcnt(19)
    buffer_load_dwordx4 v5, s[16:19], s48 offen nt lds
    s_add_u32 m0, s49, 32768
    s_add_u32 s49, s49, 1024
    s_waitcnt vmcnt(19)
    buffer_load_dwordx4 v5, s[20:23], s48 offen nt lds
    s_add_u32 s48, s48, 28672
    s_cmp_lt_u32 s48, 917504
    s_cbranch_scc1 L_dma0
    s_branch L_dma_done
L_dft_rest:
    s_mov_b32 s18, 0x400000
    s_mov_b32 s19, 0x00020000
    s_sub_u32 s31, 2047, s52
    s_sub_u32 s32, 2047, s53
    v_mov_b32 v200, s31
    v_writelane_b32 v200, s32, 63
    s_lshl_b32 s31, s30, 2
    v_mov_b32 v201, s31
    s_bfe_u32 s31, s53, 0x20008
    s_lshl_b32 s31, s31, 2
    s_add_u32 s31, s31, 16
    v_writelane_b32 v201, s31, 63
    v_and_b32 v6, 32, v2
    s_lshl_b32 s31, s51, 2
    v_add_u32 v203, s31, v6
    v_lshrrev_b32 v202, 1, v203
    s_lshl_b32 s31, s2, 4
    s_add_u32 s31, s31, 4096
    v_mov_b32 v4, s31
    v_lshlrev_b32 v5, 3, v2
    s_and_b32 s31, s52, 7
    s_lshl_b32 s31, s31, 11
    s_and_b32 s32, s52, 1024
    s_add_u32 s31, s31, s32
    s_and_b32 s32, s52, 0xf8
    s_lshl_b32 s32, s32, 2
    s_add_u32 s31, s31, s32
    s_add_u32 s31, s31, 32768
    v_writelane_b32 v4, s31, 0
    s_add_u32 s31, s31, 16
    v_writelane_b32 v4, s31, 1
    s_and_b32 s31, s53, 7
    s_lshl_b32 s31, s31, 11
    s_and_b32 s32, s53, 1024
    s_add_u32 s31, s31, s32
    s_and_b32 s32, s53, 0xf8
    s_lshl_b32 s32, s32, 2
    s_add_u32 s31, s31, s32
    s_add_u32 s31, s31, 32768
    v_writelane_b32 v4, s31, 2
    s_add_u32 s31, s31, 16
    v_writelane_b32 v4, s31, 3
    s_mul_i32 s31, s51, 2592
    v_and_b32 v204, 32, v2
    v_lshlrev_b32 v204, 2, v204
    v_add3_u32 v204, v204, v3, s31
    s_lshl_b32 s32, s31, 1
    s_add_u32 s32, s32, 21872
    v_sub_u32 v205, s32, v204
    v_bfe_u32 v206, v2, 2, 2
    v_mul_u32_u24 v206, 2592, v206
    v_lshrrev_b32 v6, 4, v2
    v_mul_u32_u24 v7, 640, v6
    v_add_u32 v206, v206, v7
    v_and_b32 v7, 3, v2
    v_lshlrev_b32 v7, 3, v7
    s_lshl_b32 s31, s30, 7
    v_add3_u32 v206, v206, v7, s31
    v_lshlrev_b32 v6, 12, v6
    v_and_b32 v7, 15, v2
    v_lshl_add_u32 v6, v7, 4, v6
    s_lshl_b32 s31, s30, 8
    v_add_u32 v207, s31, v6
    v_bfe_i32 v208, v2, 4, 1
    v_and_b32 v208, 0x80008000, v208
    s_cmp_eq_u32 s47, 0
    s_movk_i32 s48, 0x7403
    s_cselect_b32 s48, 0x7721, s48
    v_and_b32 v250, 12, v2
    v_bfe_u32 v250, s48, v250, 4
    v_lshrrev_b32 v251, 4, v2
    v_bfe_u32 v252, v2, 1, 1
    v_mul_u32_u24 v251, v251, v252
    v_and_b32 v252, 1, v2
    v_add_u32 v251, v251, v252
    v_cvt_f32_u32 v250, v250
    v_cvt_f32_u32 v251, v251
    v_mul_f32 v250, 0x3e000000, v250
    v_mul_f32 v251, 0x3e800000, v251
    v_cos_f32 v8, v251
    v_add_f32 v251, v251, v250
    v_cos_f32 v9, v251
    v_add_f32 v251, v251, v250
    v_cos_f32 v10, v251
    v_add_f32 v251, v251, v250
    v_cos_f32 v11, v251
    v_add_f32 v251, v251, v250
    v_cos_f32 v12, v251
    v_add_f32 v251, v251, v250
    v_cos_f32 v13, v251
    v_add_f32 v251, v251, v250
    v_cos_f32 v14, v251
    v_add_f32 v251, v251, v250
    v_cos_f32 v15, v251
    v_mul_f32 v8, 0xbf317218, v8
    v_mul_f32 v9, 0xbf317218, v9
    v_mul_f32 v10, 0xbf317218, v10
    v_mul_f32 v11, 0xbf317218, v11
    v_mul_f32 v12, 0xbf317218, v12
    v_mul_f32 v13, 0xbf317218, v13
    v_mul_f32 v14, 0xbf317218, v14
    v_mul_f32 v15, 0xbf317218, v15
    v_lshrrev_b32 v250, 2, v2
    v_and_b32 v250, 12, v250
    v_and_b32 v251, 15, v2
    v_lshlrev_b32 v251, 2, v251
    v_cvt_f32_u32 v250, v250
    v_cvt_f32_u32 v251, v251
    v_mul_f32 v212, 0x3c800000, v250
    s_lshl_b32 s31, s30, 2
    s_lshr_b32 s48, s48, s31
    s_and_b32 s48, s48, 15
    s_sub_u32 s31, s48, 4
    s_mul_i32 s31, s31, s46
    v_cvt_f32_i32 v252, s31
    v_mul_f32 v252, 0x3a000000, v252
    v_add_f32 v213, 0x3c800000, v212
    v_add_f32 v214, 0x3d000000, v212
    v_add_f32 v215, 0x3d400000, v212
    s_and_b32 s31, s2, 7
    s_sub_u32 s32, 8, s31
    s_min_u32 s76, s31, s32
    s_lshr_b32 s78, s31, 2
    s_lshr_b32 s77, s2, 3
    s_and_b32 s32, s77, 1
    s_and_b32 s31, s31, 3
    s_cselect_b32 s78, s78, s32
    s_cselect_b32 s31, 0, 1
    s_lshr_b32 s77, s77, s31
    s_lshl_b32 s78, s78, 4
    s_lshl_b32 s31, s30, 5
    s_add_u32 s78, s78, s31
    s_lshl_b32 s78, s78, 3
    s_add_u32 s78, s78, s76
    s_lshl_b32 s77, s77, 6
    s_sub_u32 s79, 1984, s77
    s_lshl_b32 s76, s76, 1
    s_add_u32 s76, s76, 2040
    v_and_b32 v116, 15, v2
    v_lshl_add_u32 v116, v116, 3, s78
    v_and_b32 v7, 32, v2
    v_lshl_add_u32 v7, v7, 5, v116
    s_mov_b32 vcc_lo, 0xffff0000
    s_mov_b32 vcc_hi, 0xffff0000
    v_sub_u32 v6, 0, v7
    v_cndmask_b32 v7, v7, v6, vcc
    v_and_b32 v6, 7, v7
    v_and_b32 v1, 1024, v7
    v_lshl_add_u32 v6, v6, 11, v1
    v_and_b32 v1, 0xf8, v7
    v_lshl_add_u32 v6, v1, 2, v6
    v_bfe_u32 v1, v7, 9, 1
    v_lshl_add_u32 v119, v1, 4, v6
    v_and_b32 v1, 256, v7
    v_cmp_ne_u32 s[88:89], 0, v1
    v_lshrrev_b32 v118, 2, v2
    v_lshl_add_u32 v118, v118, 3, s78
    v_lshlrev_b32 v1, 1, v2
    v_xor_b32 v1, v1, v3
    v_and_b32 v1, 48, v1
    v_add_u32 v114, 1024, v118
    v_sub_u32 v113, 0, v118
    v_and_b32 v113, 2047, v113
    v_sub_u32 v115, 2048, v114
    v_add_u32 v112, s77, v1
    v_lshl_add_u32 v114, v114, 11, v112
    v_lshl_add_u32 v112, v118, 11, v112
    v_xor_b32 v1, 48, v1
    v_add_u32 v1, s79, v1
    v_lshl_add_u32 v113, v113, 11, v1
    v_lshl_add_u32 v115, v115, 11, v1
    s_lshl_b32 s76, s30, 12
    s_add_u32 s76, s76, 44032
    v_and_b32 v1, 15, v2
    v_lshlrev_b32 v6, 6, v1
    v_lshlrev_b32 v1, 3, v2
    v_xor_b32 v1, v1, v2
    v_and_b32 v1, 48, v1
    v_add3_u32 v117, v6, v1, s76
    v_mul_f32 v250, v212, v251
    v_fmamk_f32 v52, v250, 0x3d800000, v252
    v_sin_f32 v20, v250
    v_cos_f32 v250, v250
    v_cos_f32 v48, v52
    v_sin_f32 v52, v52
    v_cvt_pk_f16_f32 v16, v250, v20
    v_cvt_pk_f16_f32 v20, -v20, v250
    v_mul_f32 v250, v213, v251
    v_fmamk_f32 v53, v250, 0x3d800000, v252
    v_sin_f32 v21, v250
    v_cos_f32 v250, v250
    v_cos_f32 v49, v53
    v_sin_f32 v53, v53
    v_cvt_pk_f16_f32 v17, v250, v21
    v_cvt_pk_f16_f32 v21, -v21, v250
    v_mul_f32 v250, v214, v251
    v_fmamk_f32 v54, v250, 0x3d800000, v252
    v_sin_f32 v22, v250
    v_cos_f32 v250, v250
    v_cos_f32 v50, v54
    v_sin_f32 v54, v54
    v_cvt_pk_f16_f32 v18, v250, v22
    v_cvt_pk_f16_f32 v22, -v22, v250
    v_mul_f32 v250, v215, v251
    v_fmamk_f32 v55, v250, 0x3d800000, v252
    v_sin_f32 v23, v250
    v_cos_f32 v250, v250
    v_cos_f32 v51, v55
    v_sin_f32 v55, v55
    v_cvt_pk_f16_f32 v19, v250, v23
    v_cvt_pk_f16_f32 v23, -v23, v250
    v_add_f32 v251, 1.0, v251
    v_mul_f32 v250, v212, v251
    v_fmamk_f32 v60, v250, 0x3d800000, v252
    v_sin_f32 v28, v250
    v_cos_f32 v250, v250
    v_cos_f32 v56, v60
    v_sin_f32 v60, v60
    v_cvt_pk_f16_f32 v24, v250, v28
    v_cvt_pk_f16_f32 v28, -v28, v250
    v_mul_f32 v250, v213, v251
    v_fmamk_f32 v61, v250, 0x3d800000, v252
    v_sin_f32 v29, v250
    v_cos_f32 v250, v250
    v_cos_f32 v57, v61
    v_sin_f32 v61, v61
    v_cvt_pk_f16_f32 v25, v250, v29
    v_cvt_pk_f16_f32 v29, -v29, v250
    v_mul_f32 v250, v214, v251
    v_fmamk_f32 v62, v250, 0x3d800000, v252
    v_sin_f32 v30, v250
    v_cos_f32 v250, v250
    v_cos_f32 v58, v62
    v_sin_f32 v62, v62
    v_cvt_pk_f16_f32 v26, v250, v30
    v_cvt_pk_f16_f32 v30, -v30, v250
    v_mul_f32 v250, v215, v251
    v_fmamk_f32 v63, v250, 0x3d800000, v252
    v_sin_f32 v31, v250
    v_cos_f32 v250, v250
    v_cos_f32 v59, v63
    v_sin_f32 v63, v63
    v_cvt_pk_f16_f32 v27, v250, v31
    v_cvt_pk_f16_f32 v31, -v31, v250
    v_add_f32 v251, 1.0, v251
    v_mov_b32 v160, 0
    v_mov_b32 v161, 0
    v_mov_b32 v162, 0
    v_mov_b32 v163, 0
    v_mov_b32 v164, 0
    v_mov_b32 v165, 0
    v_mov_b32 v166, 0
    v_mov_b32 v167, 0
    v_mov_b32 v168, 0
    v_mov_b32 v169, 0
    v_mov_b32 v170, 0
    s_mov_b32 s57, 0x3f803f80
    s_mov_b32 s59, 0xffff
    s_brev_b32 s67, 1
    s_mov_b32 s66, 0
    s_brev_b32 s64, 1
    s_brev_b32 s65, 1
    s_cmp_eq_u32 s47, 0
    s_movk_i32 s62, -10368
    s_cselect_b32 s62, 10368, s62
    s_waitcnt lgkmcnt(0)
    s_add_u32 s28, s28, 0x7f4a7c15
    s_addc_u32 s29, s29, 0x9e3779b9
    v_mov_b32 v174, s28
    v_mov_b32 v175, s29
    s_cmp_lt_u32 s2, 224
    s_cbranch_scc1 L_epoch_ok
L_sync1:
    ds_read_b32 v1, v0 offset:42872
    s_add_u32 s92, s92, 1
    s_bitcmp1_b32 s92, 20
    s_cbranch_scc1 L_sync1x
    s_waitcnt lgkmcnt(0)
    v_readfirstlane_b32 s31, v1
    s_nop 0
    s_cmp_ge_u32 s31, 4
    s_cbranch_scc0 L_sync1
L_sync1x:
L_epoch_ok:
    s_setprio 3
    s_waitcnt vmcnt(8)
    v_dot2c_f32_bf16 v160, s57, v120
    v_dot2c_f32_bf16 v164, v120, v120
    v_dot2c_f32_bf16 v160, s57, v121
    v_dot2c_f32_bf16 v164, v121, v121
    v_dot2c_f32_bf16 v160, s57, v122
    v_dot2c_f32_bf16 v164, v122, v122
    v_dot2c_f32_bf16 v160, s57, v123
    v_dot2c_f32_bf16 v164, v123, v123
    v_dot2c_f32_bf16 v160, s57, v124
    v_dot2c_f32_bf16 v164, v124, v124
    v_dot2c_f32_bf16 v160, s57, v125
    v_dot2c_f32_bf16 v164, v125, v125
    v_dot2c_f32_bf16 v160, s57, v126
    v_dot2c_f32_bf16 v164, v126, v126
    v_dot2c_f32_bf16 v160, s57, v127
    v_dot2c_f32_bf16 v164, v127, v127
    s_waitcnt vmcnt(6)
    v_dot2c_f32_bf16 v161, s57, v128
    v_dot2c_f32_bf16 v165, v128, v128
    v_dot2c_f32_bf16 v161, s57, v129
    v_dot2c_f32_bf16 v165, v129, v129
    v_dot2c_f32_bf16 v161, s57, v130
    v_dot2c_f32_bf16 v165, v130, v130
    v_dot2c_f32_bf16 v161, s57, v131
    v_dot2c_f32_bf16 v165, v131, v131
    v_dot2c_f32_bf16 v161, s57, v132
    v_dot2c_f32_bf16 v165, v132, v132
    v_dot2c_f32_bf16 v161, s57, v133
    v_dot2c_f32_bf16 v165, v133, v133
    v_dot2c_f32_bf16 v161, s57, v134
    v_dot2c_f32_bf16 v165, v134, v134
    v_dot2c_f32_bf16 v161, s57, v135
    v_dot2c_f32_bf16 v165, v135, v135
    s_waitcnt vmcnt(4)
    v_dot2c_f32_bf16 v170, s57, v152
    v_dot2c_f32_bf16 v170, s57, v153
    v_dot2c_f32_bf16 v170, s57, v154
    v_dot2c_f32_bf16 v170, s57, v155
    v_dot2c_f32_bf16 v170, s57, v156
    v_dot2c_f32_bf16 v170, s57, v157
    v_dot2c_f32_bf16 v170, s57, v158
    v_dot2c_f32_bf16 v170, s57, v159
    v_dot2c_f32_bf16 v168, v152, v120
    v_dot2c_f32_bf16 v169, v152, v128
    v_dot2c_f32_bf16 v168, v153, v121
    v_dot2c_f32_bf16 v169, v153, v129
    v_dot2c_f32_bf16 v168, v154, v122
    v_dot2c_f32_bf16 v169, v154, v130
    v_dot2c_f32_bf16 v168, v155, v123
    v_dot2c_f32_bf16 v169, v155, v131
    v_mov_b32 v171, v170
    v_dot2c_f32_bf16 v168, v156, v124
    v_dot2c_f32_bf16 v169, v156, v132
    v_dot2c_f32_bf16 v168, v157, v125
    v_dot2c_f32_bf16 v169, v157, v133
    v_dot2c_f32_bf16 v168, v158, v126
    v_dot2c_f32_bf16 v169, v158, v134
    v_dot2c_f32_bf16 v168, v159, v127
    v_dot2c_f32_bf16 v169, v159, v135
    v_permlane32_swap_b32 v160, v161
    v_permlane32_swap_b32 v164, v165
    v_permlane32_swap_b32 v170, v171
    v_permlane32_swap_b32 v168, v169
    v_add_f32 v160, v160, v161
    v_add_f32 v164, v164, v165
    v_add_f32 v170, v170, v171
    v_add_f32 v168, v168, v169
    v_add_f32_dpp v160, v160, v160 row_shr:1 row_mask:0xf bank_mask:0xf
    v_add_f32_dpp v164, v164, v164 row_shr:1 row_mask:0xf bank_mask:0xf
    v_add_f32_dpp v170, v170, v170 row_shr:1 row_mask:0xf bank_mask:0xf
    v_add_f32_dpp v168, v168, v168 row_shr:1 row_mask:0xf bank_mask:0xf
    v_add_f32_dpp v160, v160, v160 row_shr:2 row_mask:0xf bank_mask:0xf
    v_add_f32_dpp v164, v164, v164 row_shr:2 row_mask:0xf bank_mask:0xf
    v_add_f32_dpp v170, v170, v170 row_shr:2 row_mask:0xf bank_mask:0xf
    v_add_f32_dpp v168, v168, v168 row_shr:2 row_mask:0xf bank_mask:0xf
    v_add_f32_dpp v160, v160, v160 row_shr:4 row_mask:0xf bank_mask:0xf
    v_add_f32_dpp v164, v164, v164 row_shr:4 row_mask:0xf bank_mask:0xf
    v_add_f32_dpp v170, v170, v170 row_shr:4 row_mask:0xf bank_mask:0xf
    v_add_f32_dpp v168, v168, v168 row_shr:4 row_mask:0xf bank_mask:0xf
    v_add_f32_dpp v160, v160, v160 row_shr:8 row_mask:0xf bank_mask:0xf
    v_add_f32_dpp v164, v164, v164 row_shr:8 row_mask:0xf bank_mask:0xf
    v_add_f32_dpp v170, v170, v170 row_shr:8 row_mask:0xf bank_mask:0xf
    v_add_f32_dpp v168, v168, v168 row_shr:8 row_mask:0xf bank_mask:0xf
    v_add_f32_dpp v160, v160, v160 row_bcast:15 row_mask:0xa bank_mask:0xf
    v_add_f32_dpp v164, v164, v164 row_bcast:15 row_mask:0xa bank_mask:0xf
    v_add_f32_dpp v170, v170, v170 row_bcast:15 row_mask:0xa bank_mask:0xf
    v_add_f32_dpp v168, v168, v168 row_bcast:15 row_mask:0xa bank_mask:0xf
    v_mul_f32 v160, 0x3a800000, v160
    v_mul_f32 v164, 0x3a800000, v164
    v_fma_f32 v164, -v160, v160, v164
    v_cvt_pk_bf16_f32 v161, -v160, -v160
    v_max_f32 v164, 0, v164
    v_cvt_pk_bf16_f32 v164, v164, v164
    v_and_b32 v164, 0xffff0000, v164
    v_add_f32 v164, 0x3727c5ac, v164
    v_cvt_pk_bf16_f32 v164, v164, v164
    v_and_b32 v164, 0xffff0000, v164
    v_sqrt_f32 v164, v164
    v_and_b32 v165, 0xffff0000, v161
    v_cvt_pk_bf16_f32 v248, v160, v164
    v_and_b32 v164, 0xffff0000, v248
    v_rcp_f32 v164, v164
    v_fmac_f32 v168, v170, v165
    v_mul_f32 v168, v168, v164
    v_ashrrev_i32 v170, 31, v168
    v_or_b32 v170, 0x80000000, v170
    v_xor_b32 v168, v168, v170
    v_and_b32 v168, 0xfffff800, v168
    v_or_b32 v249, v200, v168
    s_mov_b64 exec, s[64:65]
    ds_write_b32 v201, v248 offset:41472
    ds_max_u64 v0, v[248:249] offset:41504
    s_mov_b64 exec, 1
    ds_add_rtn_u32 v1, v0, v255 offset:42816
    s_mov_b64 exec, 31
    ds_read_b64 v[172:173], v5 offset:41472
    s_mov_b64 exec, s[64:65]
    ds_write_b16 v202, v161 offset:41568
    ds_write_b32 v203, v164 offset:42752
    s_mov_b64 exec, -1
    s_nop 0
    v_mov_b32_dpp v6, v128 wave_rol:1 row_mask:0xf bank_mask:0xf
    v_mov_b32_dpp v7, v132 wave_rol:1 row_mask:0xf bank_mask:0xf
    v_bfi_b32 v221, s59, v131, v130
    v_bfi_b32 v222, s59, v130, v129
    v_bfi_b32 v223, s59, v129, v128
    v_bfi_b32 v217, s59, v135, v134
    v_bfi_b32 v218, s59, v134, v133
    v_bfi_b32 v219, s59, v133, v132
    v_cndmask_b32 v220, v6, v7, s[66:67]
    v_cndmask_b32 v216, v7, v6, s[66:67]
    v_bfi_b32 v220, s59, v220, v131
    v_bfi_b32 v216, s59, v216, v135
    s_waitcnt lgkmcnt(2)
    v_readfirstlane_b32 s31, v1
    s_nop 0
    s_cmp_lg_u32 s31, 3
    s_cbranch_scc1 L_not_last
    s_mov_b64 exec, 31
    buffer_store_dwordx4 v[172:175], v4, s[12:15], 0 offen sc1
    s_mov_b64 exec, -1
    s_waitcnt vmcnt(1)
    s_branch L_b_ready
L_not_last:
    s_waitcnt vmcnt(0)
L_b_ready:
    s_setprio 3
    ds_write_b128 v204, v[120:123] offset:0
    ds_write_b128 v204, v[124:127] offset:1280
    s_cmp_lg_u32 s50, 0
    s_cbranch_scc1 L_plain1
    ds_write_b128 v205, v[216:219]
    ds_write_b128 v205, v[220:223] offset:1280
    s_branch L_second1
L_plain1:
    ds_write_b128 v204, v[128:131] offset:20736
    ds_write_b128 v204, v[132:135] offset:22016
L_second1:
    v_add_u32 v204, s62, v204
    v_add_u32 v205, s62, v205
    v_dot2c_f32_bf16 v162, s57, v136
    v_dot2c_f32_bf16 v166, v136, v136
    v_dot2c_f32_bf16 v162, s57, v137
    v_dot2c_f32_bf16 v166, v137, v137
    v_dot2c_f32_bf16 v162, s57, v138
    v_dot2c_f32_bf16 v166, v138, v138
    v_dot2c_f32_bf16 v162, s57, v139
    v_dot2c_f32_bf16 v166, v139, v139
    v_dot2c_f32_bf16 v162, s57, v140
    v_dot2c_f32_bf16 v166, v140, v140
    v_dot2c_f32_bf16 v162, s57, v141
    v_dot2c_f32_bf16 v166, v141, v141
    v_dot2c_f32_bf16 v162, s57, v142
    v_dot2c_f32_bf16 v166, v142, v142
    v_dot2c_f32_bf16 v162, s57, v143
    v_dot2c_f32_bf16 v166, v143, v143
    ds_write_b128 v204, v[136:139] offset:0
    ds_write_b128 v204, v[140:143] offset:1280
    v_dot2c_f32_bf16 v163, s57, v144
    v_dot2c_f32_bf16 v167, v144, v144
    v_dot2c_f32_bf16 v163, s57, v145
    v_dot2c_f32_bf16 v167, v145, v145
    v_dot2c_f32_bf16 v163, s57, v146
    v_dot2c_f32_bf16 v167, v146, v146
    v_dot2c_f32_bf16 v163, s57, v147
    v_dot2c_f32_bf16 v167, v147, v147
    v_dot2c_f32_bf16 v163, s57, v148
    v_dot2c_f32_bf16 v167, v148, v148
    v_dot2c_f32_bf16 v163, s57, v149
    v_dot2c_f32_bf16 v167, v149, v149
    v_dot2c_f32_bf16 v163, s57, v150
    v_dot2c_f32_bf16 v167, v150, v150
    v_dot2c_f32_bf16 v163, s57, v151
    v_dot2c_f32_bf16 v167, v151, v151
    v_xor_b32 v202, 8, v202
    v_xor_b32 v203, 16, v203
    s_waitcnt lgkmcnt(2)
    s_nop 0
    v_mov_b32_dpp v6, v144 wave_rol:1 row_mask:0xf bank_mask:0xf
    v_mov_b32_dpp v7, v148 wave_rol:1 row_mask:0xf bank_mask:0xf
    v_bfi_b32 v221, s59, v147, v146
    v_bfi_b32 v222, s59, v146, v145
    v_bfi_b32 v223, s59, v145, v144
    v_bfi_b32 v217, s59, v151, v150
    v_bfi_b32 v218, s59, v150, v149
    v_bfi_b32 v219, s59, v149, v148
    v_cndmask_b32 v220, v6, v7, s[66:67]
    v_cndmask_b32 v216, v7, v6, s[66:67]
    v_bfi_b32 v220, s59, v220, v147
    v_bfi_b32 v216, s59, v216, v151
    s_cmp_lg_u32 s50, 0
    s_cbranch_scc1 L_plain3
    ds_write_b128 v205, v[216:219]
    ds_write_b128 v205, v[220:223] offset:1280
    s_branch L_second3
L_plain3:
    ds_write_b128 v204, v[144:147] offset:20736
    ds_write_b128 v204, v[148:151] offset:22016
L_second3:
    v_permlane32_swap_b32 v162, v163
    v_permlane32_swap_b32 v166, v167
    v_add_f32 v162, v162, v163
    v_add_f32 v166, v166, v167
    s_nop 0
    v_add_f32_dpp v162, v162, v162 row_shr:1 row_mask:0xf bank_mask:0xf
    v_add_f32_dpp v166, v166, v166 row_shr:1 row_mask:0xf bank_mask:0xf
    s_nop 0
    v_add_f32_dpp v162, v162, v162 row_shr:2 row_mask:0xf bank_mask:0xf
    v_add_f32_dpp v166, v166, v166 row_shr:2 row_mask:0xf bank_mask:0xf
    s_nop 0
    v_add_f32_dpp v162, v162, v162 row_shr:4 row_mask:0xf bank_mask:0xf
    v_add_f32_dpp v166, v166, v166 row_shr:4 row_mask:0xf bank_mask:0xf
    s_nop 0
    v_add_f32_dpp v162, v162, v162 row_shr:8 row_mask:0xf bank_mask:0xf
    v_add_f32_dpp v166, v166, v166 row_shr:8 row_mask:0xf bank_mask:0xf
    s_nop 0
    v_add_f32_dpp v162, v162, v162 row_bcast:15 row_mask:0xa bank_mask:0xf
    v_add_f32_dpp v166, v166, v166 row_bcast:15 row_mask:0xa bank_mask:0xf
    v_mul_f32 v162, 0x3a800000, v162
    v_mul_f32 v166, 0x3a800000, v166
    v_fma_f32 v166, -v162, v162, v166
    v_cvt_pk_bf16_f32 v161, -v162, -v162
    v_max_f32 v166, 0, v166
    v_cvt_pk_bf16_f32 v166, v166, v166
    v_and_b32 v166, 0xffff0000, v166
    v_add_f32 v166, 0x3727c5ac, v166
    v_cvt_pk_bf16_f32 v166, v166, v166
    v_and_b32 v166, 0xffff0000, v166
    v_sqrt_f32 v166, v166
    v_and_b32 v167, 0xffff0000, v161
    v_cvt_pk_bf16_f32 v248, v162, v166
    v_and_b32 v166, 0xffff0000, v248
    v_rcp_f32 v166, v166
    s_mov_b64 exec, s[64:65]
    ds_write_b16 v202, v161 offset:41568
    ds_write_b32 v203, v166 offset:42752
    s_mov_b64 exec, 1
    ds_add_u32 v0, v255 offset:42820
    s_mov_b64 exec, -1
L_sync2:
    ds_read_b32 v1, v0 offset:42820
    ds_read_b128 v[176:179], v0 offset:42752
    ds_read_b128 v[180:183], v0 offset:42768
    ds_read_b128 v[184:187], v0 offset:42784
    ds_read_b128 v[188:191], v0 offset:42800
    ds_read_b128 v[192:195], v0 offset:41568
    ds_read_b128 v[196:199], v0 offset:41584
    s_add_u32 s92, s92, 1
    s_bitcmp1_b32 s92, 20
    s_cbranch_scc1 L_sync2x
    s_waitcnt lgkmcnt(6)
    v_readfirstlane_b32 s31, v1
    s_nop 0
    s_cmp_ge_u32 s31, 4
    s_cbranch_scc0 L_sync2
L_sync2x:
    ds_read_b64_tr_b16 v[120:121], v206 offset:0
    ds_read_b64_tr_b16 v[122:123], v206 offset:10368
    ds_read_b64_tr_b16 v[124:125], v206 offset:20736
    ds_read_b64_tr_b16 v[126:127], v206 offset:31104
    ds_read_b64_tr_b16 v[128:129], v206 offset:32
    ds_read_b64_tr_b16 v[130:131], v206 offset:10400
    ds_read_b64_tr_b16 v[132:133], v206 offset:20768
    ds_read_b64_tr_b16 v[134:135], v206 offset:31136
    s_waitcnt lgkmcnt(10)
    s_nop 0
    ds_read_b64_tr_b16 v[136:137], v206 offset:64
    ds_read_b64_tr_b16 v[138:139], v206 offset:10432
    ds_read_b64_tr_b16 v[140:141], v206 offset:20800
    ds_read_b64_tr_b16 v[142:143], v206 offset:31168
    v_pk_mul_f32 v[176:177], v[176:177], v[8:9]
    v_pk_mul_f32 v[178:179], v[178:179], v[10:11]
    v_pk_mul_f32 v[180:181], v[180:181], v[12:13]
    v_pk_mul_f32 v[182:183], v[182:183], v[14:15]
    v_pk_mul_f32 v[184:185], v[184:185], v[8:9]
    v_pk_mul_f32 v[186:187], v[186:187], v[10:11]
    v_pk_mul_f32 v[188:189], v[188:189], v[12:13]
    v_pk_mul_f32 v[190:191], v[190:191], v[14:15]
    v_cvt_pk_bf16_f32 v160, v176, v177
    v_cvt_pk_bf16_f32 v152, v184, v185
    v_cvt_pk_bf16_f32 v161, v178, v179
    v_cvt_pk_bf16_f32 v153, v186, v187
    v_cvt_pk_bf16_f32 v162, v180, v181
    v_cvt_pk_bf16_f32 v154, v188, v189
    v_cvt_pk_bf16_f32 v163, v182, v183
    v_cvt_pk_bf16_f32 v155, v190, v191
    v_xor_b32 v164, v208, v160
    v_xor_b32 v156, v208, v152
    v_xor_b32 v165, v208, v161
    v_xor_b32 v157, v208, v153
    v_xor_b32 v166, v208, v162
    v_xor_b32 v158, v208, v154
    v_xor_b32 v167, v208, v163
    v_xor_b32 v159, v208, v155
    s_waitcnt lgkmcnt(12)
    s_cmp_lg_u32 s50, 0
    s_cbranch_scc1 L_st1_split
    v_mfma_f32_16x16x32_bf16 v[168:171], v[160:163], v[192:195], 0
    v_mfma_f32_16x16x32_bf16 v[168:171], v[152:155], v[196:199], v[168:171]
    s_waitcnt lgkmcnt(10)
    ds_read_b64_tr_b16 v[144:145], v206 offset:96
    ds_read_b64_tr_b16 v[146:147], v206 offset:10464
    ds_read_b64_tr_b16 v[148:149], v206 offset:20832
    ds_read_b64_tr_b16 v[150:151], v206 offset:31200
    v_mfma_f32_16x16x32_bf16 v[216:219], v[160:163], v[120:123], v[168:171]
    s_waitcnt lgkmcnt(12)
    v_mfma_f32_16x16x32_bf16 v[216:219], v[152:155], v[124:127], v[216:219]
    s_waitcnt lgkmcnt(10)
    v_mfma_f32_16x16x32_bf16 v[224:227], v[160:163], v[128:131], v[168:171]
    s_waitcnt lgkmcnt(8)
    v_mfma_f32_16x16x32_bf16 v[224:227], v[152:155], v[132:135], v[224:227]
    s_waitcnt lgkmcnt(6)
    v_mfma_f32_16x16x32_bf16 v[232:235], v[160:163], v[136:139], v[168:171]
    s_waitcnt lgkmcnt(4)
    v_mfma_f32_16x16x32_bf16 v[232:235], v[152:155], v[140:143], v[232:235]
    s_waitcnt lgkmcnt(2)
    v_mfma_f32_16x16x32_bf16 v[240:243], v[160:163], v[144:147], v[168:171]
    s_waitcnt lgkmcnt(0)
    v_mfma_f32_16x16x32_bf16 v[240:243], v[152:155], v[148:151], v[240:243]
    v_mfma_f32_16x16x32_bf16 v[220:223], v[164:167], v[120:123], 0
    v_mfma_f32_16x16x32_bf16 v[220:223], v[156:159], v[124:127], v[220:223]
    v_mfma_f32_16x16x32_bf16 v[228:231], v[164:167], v[128:131], 0
    v_mfma_f32_16x16x32_bf16 v[228:231], v[156:159], v[132:135], v[228:231]
    v_cvt_pk_f16_f32 v176, v216, v217
    v_cvt_pk_f16_f32 v177, v224, v225
    v_cvt_pk_f16_f32 v178, v232, v233
    s_nop 0
    v_cvt_pk_f16_f32 v179, v240, v241
    ds_write_b128 v207, v[176:179] offset:44032
    v_mfma_f32_16x16x32_bf16 v[236:239], v[164:167], v[136:139], 0
    v_mfma_f32_16x16x32_bf16 v[236:239], v[156:159], v[140:143], v[236:239]
    v_cvt_pk_f16_f32 v180, v218, v219
    v_cvt_pk_f16_f32 v181, v226, v227
    v_cvt_pk_f16_f32 v182, v234, v235
    v_cvt_pk_f16_f32 v183, v242, v243
    ds_write_b128 v207, v[180:183] offset:45056
    v_mfma_f32_16x16x32_bf16 v[244:247], v[164:167], v[144:147], 0
    v_mfma_f32_16x16x32_bf16 v[244:247], v[156:159], v[148:151], v[244:247]
    v_cvt_pk_f16_f32 v184, v220, v221
    v_cvt_pk_f16_f32 v185, v228, v229
    v_cvt_pk_f16_f32 v186, v236, v237
    s_nop 4
    v_cvt_pk_f16_f32 v187, v244, v245
    ds_write_b128 v207, v[184:187] offset:46080
    v_cvt_pk_f16_f32 v188, v222, v223
    v_cvt_pk_f16_f32 v189, v230, v231
    v_cvt_pk_f16_f32 v190, v238, v239
    v_cvt_pk_f16_f32 v191, v246, v247
    ds_write_b128 v207, v[188:191] offset:47104
    s_branch L_st1_done
L_st1_split:
    s_waitcnt lgkmcnt(8)
    ds_read_b64_tr_b16 v[144:145], v206 offset:96
    ds_read_b64_tr_b16 v[146:147], v206 offset:10464
    ds_read_b64_tr_b16 v[148:149], v206 offset:20832
    ds_read_b64_tr_b16 v[150:151], v206 offset:31200
    s_waitcnt lgkmcnt(0)
    v_mfma_f32_16x16x32_bf16 v[168:171], v[160:163], v[192:195], 0
    v_mfma_f32_16x16x32_bf16 v[220:223], v[164:167], v[120:123], 0
    v_mfma_f32_16x16x32_bf16 v[216:219], v[160:163], v[120:123], v[168:171]
    v_mfma_f32_16x16x32_bf16 v[228:231], v[164:167], v[128:131], 0
    v_mfma_f32_16x16x32_bf16 v[224:227], v[160:163], v[128:131], v[168:171]
    v_mfma_f32_16x16x32_bf16 v[236:239], v[164:167], v[136:139], 0
    v_mfma_f32_16x16x32_bf16 v[232:235], v[160:163], v[136:139], v[168:171]
    v_mfma_f32_16x16x32_bf16 v[244:247], v[164:167], v[144:147], 0
    v_mfma_f32_16x16x32_bf16 v[240:243], v[160:163], v[144:147], v[168:171]
    s_nop 1
    s_nop 0
    v_cvt_pk_f16_f32 v176, v216, v217
    v_cvt_pk_f16_f32 v180, v218, v219
    v_cvt_pk_f16_f32 v184, v220, v221
    v_cvt_pk_f16_f32 v188, v222, v223
    v_cvt_pk_f16_f32 v177, v224, v225
    v_cvt_pk_f16_f32 v181, v226, v227
    v_cvt_pk_f16_f32 v185, v228, v229
    v_cvt_pk_f16_f32 v189, v230, v231
    v_cvt_pk_f16_f32 v178, v232, v233
    v_cvt_pk_f16_f32 v182, v234, v235
    v_cvt_pk_f16_f32 v186, v236, v237
    v_cvt_pk_f16_f32 v190, v238, v239
    v_cvt_pk_f16_f32 v179, v240, v241
    v_cvt_pk_f16_f32 v183, v242, v243
    v_cvt_pk_f16_f32 v187, v244, v245
    v_cvt_pk_f16_f32 v191, v246, v247
    ds_write_b128 v207, v[176:179] offset:44032
    ds_write_b128 v207, v[180:183] offset:45056
    ds_write_b128 v207, v[184:187] offset:46080
    ds_write_b128 v207, v[188:191] offset:47104
    v_mfma_f32_16x16x32_bf16 v[168:171], v[152:155], v[196:199], 0
    v_mfma_f32_16x16x32_bf16 v[220:223], v[156:159], v[124:127], 0
    v_mfma_f32_16x16x32_bf16 v[216:219], v[152:155], v[124:127], v[168:171]
    v_mfma_f32_16x16x32_bf16 v[228:231], v[156:159], v[132:135], 0
    v_mfma_f32_16x16x32_bf16 v[224:227], v[152:155], v[132:135], v[168:171]
    v_mfma_f32_16x16x32_bf16 v[236:239], v[156:159], v[140:143], 0
    v_mfma_f32_16x16x32_bf16 v[232:235], v[152:155], v[140:143], v[168:171]
    v_mfma_f32_16x16x32_bf16 v[244:247], v[156:159], v[148:151], 0
    v_mfma_f32_16x16x32_bf16 v[240:243], v[152:155], v[148:151], v[168:171]
    s_waitcnt lgkmcnt(0)
    s_nop 0
    v_cvt_pk_f16_f32 v176, v216, v217
    v_cvt_pk_f16_f32 v180, v218, v219
    v_cvt_pk_f16_f32 v184, v220, v221
    v_cvt_pk_f16_f32 v188, v222, v223
    v_cvt_pk_f16_f32 v177, v224, v225
    v_cvt_pk_f16_f32 v181, v226, v227
    v_cvt_pk_f16_f32 v185, v228, v229
    v_cvt_pk_f16_f32 v189, v230, v231
    v_cvt_pk_f16_f32 v178, v232, v233
    v_cvt_pk_f16_f32 v182, v234, v235
    v_cvt_pk_f16_f32 v186, v236, v237
    v_cvt_pk_f16_f32 v190, v238, v239
    v_cvt_pk_f16_f32 v179, v240, v241
    v_cvt_pk_f16_f32 v183, v242, v243
    v_cvt_pk_f16_f32 v187, v244, v245
    v_cvt_pk_f16_f32 v191, v246, v247
    ds_write_b128 v207, v[176:179] offset:60416
    ds_write_b128 v207, v[180:183] offset:61440
    ds_write_b128 v207, v[184:187] offset:62464
    ds_write_b128 v207, v[188:191] offset:63488
L_st1_done:
    s_mov_b64 exec, 1
    ds_add_u32 v0, v255 offset:42824
    s_mov_b64 exec, -1
    s_lshl_b32 s31, s30, 12
    v_add_u32 v5, s31, v3
    s_and_b32 s31, s28, 0x30003
    v_mov_b32 v210, s31
    s_mov_b32 s58, 0xfffcfffc
    s_and_b32 s32, s48, 3
    s_cselect_b32 s72, -1, 0xff
    s_cselect_b32 s73, -1, 0
    s_mov_b32 s74, s48
    s_mov_b64 s[60:61], 0
    s_mov_b64 s[62:63], 0
    v_mov_b32 v209, 2147483392
    s_cmp_eq_u32 s48, 7
    s_cbranch_scc1 L_no_consts
    v_mul_f32 v250, v212, v251
    v_fmamk_f32 v68, v250, 0x3d800000, v252
    v_sin_f32 v36, v250
    v_cos_f32 v250, v250
    v_cos_f32 v64, v68
    v_sin_f32 v68, v68
    v_cvt_pk_f16_f32 v32, v250, v36
    v_cvt_pk_f16_f32 v36, -v36, v250
    v_mul_f32 v250, v213, v251
    v_fmamk_f32 v69, v250, 0x3d800000, v252
    v_sin_f32 v37, v250
    v_cos_f32 v250, v250
    v_cos_f32 v65, v69
    v_sin_f32 v69, v69
    v_cvt_pk_f16_f32 v33, v250, v37
    v_cvt_pk_f16_f32 v37, -v37, v250
    v_mul_f32 v250, v214, v251
    v_fmamk_f32 v70, v250, 0x3d800000, v252
    v_sin_f32 v38, v250
    v_cos_f32 v250, v250
    v_cos_f32 v66, v70
    v_sin_f32 v70, v70
    v_cvt_pk_f16_f32 v34, v250, v38
    v_cvt_pk_f16_f32 v38, -v38, v250
    v_mul_f32 v250, v215, v251
    v_fmamk_f32 v71, v250, 0x3d800000, v252
    v_sin_f32 v39, v250
    v_cos_f32 v250, v250
    v_cos_f32 v67, v71
    v_sin_f32 v71, v71
    v_cvt_pk_f16_f32 v35, v250, v39
    v_cvt_pk_f16_f32 v39, -v39, v250
    v_add_f32 v251, 1.0, v251
    v_mul_f32 v250, v212, v251
    v_fmamk_f32 v76, v250, 0x3d800000, v252
    v_sin_f32 v44, v250
    v_cos_f32 v250, v250
    v_cos_f32 v72, v76
    v_sin_f32 v76, v76
    v_cvt_pk_f16_f32 v40, v250, v44
    v_cvt_pk_f16_f32 v44, -v44, v250
    v_mul_f32 v250, v213, v251
    v_fmamk_f32 v77, v250, 0x3d800000, v252
    v_sin_f32 v45, v250
    v_cos_f32 v250, v250
    v_cos_f32 v73, v77
    v_sin_f32 v77, v77
    v_cvt_pk_f16_f32 v41, v250, v45
    v_cvt_pk_f16_f32 v45, -v45, v250
    v_mul_f32 v250, v214, v251
    v_fmamk_f32 v78, v250, 0x3d800000, v252
    v_sin_f32 v46, v250
    v_cos_f32 v250, v250
    v_cos_f32 v74, v78
    v_sin_f32 v78, v78
    v_cvt_pk_f16_f32 v42, v250, v46
    v_cvt_pk_f16_f32 v46, -v46, v250
    v_mul_f32 v250, v215, v251
    v_fmamk_f32 v79, v250, 0x3d800000, v252
    v_sin_f32 v47, v250
    v_cos_f32 v250, v250
    v_cos_f32 v75, v79
    v_sin_f32 v79, v79
    v_cvt_pk_f16_f32 v43, v250, v47
    v_cvt_pk_f16_f32 v47, -v47, v250
    s_and_b32 s31, s46, 1
    s_lshl_b32 s31, s31, 6
    s_lshr_b32 s32, s46, 1
    s_add_u32 s49, s31, s32
    s_bitcmp1_b32 s49, 2
    s_cselect_b64 vcc, -1, 0
    v_cndmask_b32 v80, v16, v20, vcc
    v_cndmask_b32 v84, v20, v16, vcc
    v_cndmask_b32 v81, v17, v21, vcc
    v_cndmask_b32 v85, v21, v17, vcc
    v_cndmask_b32 v82, v18, v22, vcc
    v_cndmask_b32 v86, v22, v18, vcc
    v_cndmask_b32 v83, v19, v23, vcc
    v_cndmask_b32 v87, v23, v19, vcc
    s_bfe_u32 s31, s49, 0x10001
    v_and_b32 v6, 7, v2
    v_xor_b32 v6, s31, v6
    v_lshlrev_b32 v6, 4, v6
    v_lshrrev_b32 v7, 4, v2
    v_lshlrev_b32 v7, 3, v7
    v_bfe_u32 v209, v2, 3, 1
    v_add_u32 v7, v7, v209
    v_mul_u32_u24 v7, 16512, v7
    v_add_u32 v209, v6, v7
    s_mul_i32 s31, s48, 528384
    s_lshl_b32 s32, s49, 7
    s_add_u32 s31, s31, s32
    s_add_u32 s60, s31, 2097152
L_no_consts:
L_st23:
L_sync3:
    ds_read_b32 v1, v0 offset:42824
    ds_read_b128 v[120:123], v5 offset:44032
    ds_read_b128 v[124:127], v5 offset:45056
    ds_read_b128 v[128:131], v5 offset:46080
    ds_read_b128 v[132:135], v5 offset:47104
    s_add_u32 s92, s92, 1
    s_bitcmp1_b32 s92, 20
    s_cbranch_scc1 L_sync3x
    s_waitcnt lgkmcnt(4)
    v_readfirstlane_b32 s31, v1
    s_nop 0
    s_cmp_ge_u32 s31, 4
    s_cbranch_scc0 L_sync3
L_sync3x:
    s_cmp_eq_u32 s48, 7
    s_cbranch_scc1 L_p1_done
    s_add_u32 s61, s60, 33024
    s_add_u32 s62, s61, 33024
    s_add_u32 s63, s62, 33024
    s_waitcnt lgkmcnt(3)
    v_mfma_f32_16x16x32_f16 v[136:139], v[120:123], v[16:19], 0
    v_mfma_f32_16x16x32_f16 v[140:143], v[120:123], v[20:23], 0
    s_waitcnt lgkmcnt(2)
    v_mfma_f32_16x16x32_f16 v[144:147], v[124:127], v[24:27], 0
    v_mfma_f32_16x16x32_f16 v[148:151], v[124:127], v[28:31], 0
    s_nop 3
    s_nop 0
    v_pk_mul_f32 v[152:153], v[48:49], v[136:137]
    v_pk_mul_f32 v[154:155], v[50:51], v[138:139]
    v_pk_mul_f32 v[156:157], v[52:53], v[136:137]
    v_pk_mul_f32 v[158:159], v[54:55], v[138:139]
    v_pk_fma_f32 v[152:153], v[52:53], v[140:141], v[152:153]
    v_pk_fma_f32 v[156:157], v[48:49], v[140:141], v[156:157] neg_lo:[0,0,1] neg_hi:[0,0,1]
    v_pk_fma_f32 v[154:155], v[54:55], v[142:143], v[154:155]
    v_pk_fma_f32 v[158:159], v[50:51], v[142:143], v[158:159] neg_lo:[0,0,1] neg_hi:[0,0,1]
    v_cvt_pk_f16_f32 v120, v152, v156
    v_cvt_pk_f16_f32 v121, v153, v157
    v_cvt_pk_f16_f32 v122, v154, v158
    v_cvt_pk_f16_f32 v123, v155, v159
    s_waitcnt lgkmcnt(1)
    s_nop 0
    v_mfma_f32_16x16x32_f16 v[136:139], v[128:131], v[32:35], 0
    v_mfma_f32_16x16x32_f16 v[140:143], v[128:131], v[36:39], 0
    v_mfma_f32_16x16x32_f16 v[216:219], v[80:83], v[120:123], 0
    v_mfma_f32_16x16x32_f16 v[220:223], v[84:87], v[120:123], 0
    v_pk_mul_f32 v[152:153], v[56:57], v[144:145]
    v_pk_mul_f32 v[154:155], v[58:59], v[146:147]
    v_pk_mul_f32 v[156:157], v[60:61], v[144:145]
    v_pk_mul_f32 v[158:159], v[62:63], v[146:147]
    v_pk_fma_f32 v[152:153], v[60:61], v[148:149], v[152:153]
    v_pk_fma_f32 v[156:157], v[56:57], v[148:149], v[156:157] neg_lo:[0,0,1] neg_hi:[0,0,1]
    v_pk_fma_f32 v[154:155], v[62:63], v[150:151], v[154:155]
    v_pk_fma_f32 v[158:159], v[58:59], v[150:151], v[158:159] neg_lo:[0,0,1] neg_hi:[0,0,1]
    v_cvt_pk_f16_f32 v124, v152, v156
    v_cvt_pk_f16_f32 v125, v153, v157
    v_cvt_pk_f16_f32 v126, v154, v158
    v_cvt_pk_f16_f32 v127, v155, v159
    s_waitcnt lgkmcnt(0)
    s_nop 0
    v_mfma_f32_16x16x32_f16 v[144:147], v[132:135], v[40:43], 0
    v_mfma_f32_16x16x32_f16 v[148:151], v[132:135], v[44:47], 0
    v_mfma_f32_16x16x32_f16 v[224:227], v[80:83], v[124:127], 0
    v_mfma_f32_16x16x32_f16 v[228:231], v[84:87], v[124:127], 0
    v_pk_mul_f32 v[152:153], v[64:65], v[136:137]
    v_pk_mul_f32 v[154:155], v[66:67], v[138:139]
    v_pk_mul_f32 v[156:157], v[68:69], v[136:137]
    v_pk_mul_f32 v[158:159], v[70:71], v[138:139]
    v_pk_fma_f32 v[152:153], v[68:69], v[140:141], v[152:153]
    v_pk_fma_f32 v[156:157], v[64:65], v[140:141], v[156:157] neg_lo:[0,0,1] neg_hi:[0,0,1]
    v_pk_fma_f32 v[154:155], v[70:71], v[142:143], v[154:155]
    v_pk_fma_f32 v[158:159], v[66:67], v[142:143], v[158:159] neg_lo:[0,0,1] neg_hi:[0,0,1]
    v_cvt_pk_f16_f32 v128, v152, v156
    v_cvt_pk_f16_f32 v129, v153, v157
    v_cvt_pk_f16_f32 v130, v154, v158
    v_cvt_pk_f16_f32 v131, v155, v159
    s_nop 1
    s_nop 0
    v_mfma_f32_16x16x32_f16 v[232:235], v[80:83], v[128:131], 0
    v_mfma_f32_16x16x32_f16 v[236:239], v[84:87], v[128:131], 0
    v_pk_mul_f32 v[152:153], v[72:73], v[144:145]
    v_pk_mul_f32 v[154:155], v[74:75], v[146:147]
    v_pk_mul_f32 v[156:157], v[76:77], v[144:145]
    v_pk_mul_f32 v[158:159], v[78:79], v[146:147]
    v_pk_fma_f32 v[152:153], v[76:77], v[148:149], v[152:153]
    v_pk_fma_f32 v[156:157], v[72:73], v[148:149], v[156:157] neg_lo:[0,0,1] neg_hi:[0,0,1]
    v_pk_fma_f32 v[154:155], v[78:79], v[150:151], v[154:155]
    v_pk_fma_f32 v[158:159], v[74:75], v[150:151], v[158:159] neg_lo:[0,0,1] neg_hi:[0,0,1]
    v_cvt_pk_f16_f32 v132, v152, v156
    v_cvt_pk_f16_f32 v133, v153, v157
    v_cvt_pk_f16_f32 v134, v154, v158
    v_cvt_pk_f16_f32 v135, v155, v159
    s_nop 1
    s_nop 0
    v_mfma_f32_16x16x32_f16 v[240:243], v[80:83], v[132:135], 0
    v_mfma_f32_16x16x32_f16 v[244:247], v[84:87], v[132:135], 0
    v_cvt_pk_f16_f32 v176, v216, v224
    v_cvt_pk_f16_f32 v178, v220, v228
    v_and_or_b32 v176, v176, s58, v210
    v_and_or_b32 v178, v178, s58, v210
    v_cvt_pk_f16_f32 v180, v217, v225
    v_cvt_pk_f16_f32 v182, v221, v229
    v_and_or_b32 v180, v180, s58, v210
    v_and_or_b32 v182, v182, s58, v210
    v_cvt_pk_f16_f32 v184, v218, v226
    v_cvt_pk_f16_f32 v186, v222, v230
    v_and_or_b32 v184, v184, s58, v210
    v_and_or_b32 v186, v186, s58, v210
    v_cvt_pk_f16_f32 v188, v219, v227
    v_cvt_pk_f16_f32 v190, v223, v231
    v_and_or_b32 v188, v188, s58, v210
    v_and_or_b32 v190, v190, s58, v210
    v_cvt_pk_f16_f32 v177, v232, v240
    v_cvt_pk_f16_f32 v179, v236, v244
    v_and_or_b32 v177, v177, s58, v210
    v_and_or_b32 v179, v179, s58, v210
    v_cvt_pk_f16_f32 v181, v233, v241
    v_cvt_pk_f16_f32 v183, v237, v245
    v_and_or_b32 v181, v181, s58, v210
    v_and_or_b32 v183, v183, s58, v210
    v_cvt_pk_f16_f32 v185, v234, v242
    v_cvt_pk_f16_f32 v187, v238, v246
    v_and_or_b32 v185, v185, s58, v210
    v_and_or_b32 v187, v187, s58, v210
    v_cvt_pk_f16_f32 v189, v235, v243
    v_cvt_pk_f16_f32 v191, v239, v247
    v_and_or_b32 v189, v189, s58, v210
    v_and_or_b32 v191, v191, s58, v210
    s_cmp_eq_u32 s50, 0
    s_cbranch_scc1 L_p1_done
    s_mov_b32 exec_hi, s72
    buffer_store_dwordx4 v[176:179], v209, s[12:15], s60 offen sc1
    s_mov_b32 exec_hi, s73
    buffer_store_dwordx4 v[180:183], v209, s[12:15], s61 offen sc1
    buffer_store_dwordx4 v[184:187], v209, s[12:15], s62 offen sc1
    buffer_store_dwordx4 v[188:191], v209, s[12:15], s63 offen sc1
    s_mov_b32 exec_hi, -1
    s_mov_b32 s50, 0
    s_add_u32 s60, s60, 16384
    v_add_u32 v5, 16384, v5
    s_sub_u32 s31, s48, 4
    v_cvt_f32_i32 v252, s31
    v_mul_f32 v252, 0x3d800000, v252
    v_and_b32 v251, 15, v2
    v_lshlrev_b32 v251, 2, v251
    v_cvt_f32_u32 v251, v251
    v_fma_f32 v250, v212, v251, v252
    v_sin_f32 v84, v250
    v_cos_f32 v250, v250
    s_nop 0
    v_cvt_pk_f16_f32 v80, v250, v84
    v_cvt_pk_f16_f32 v84, -v84, v250
    v_fma_f32 v250, v213, v251, v252
    v_sin_f32 v85, v250
    v_cos_f32 v250, v250
    s_nop 0
    v_cvt_pk_f16_f32 v81, v250, v85
    v_cvt_pk_f16_f32 v85, -v85, v250
    v_fma_f32 v250, v214, v251, v252
    v_sin_f32 v86, v250
    v_cos_f32 v250, v250
    s_nop 0
    v_cvt_pk_f16_f32 v82, v250, v86
    v_cvt_pk_f16_f32 v86, -v86, v250
    v_fma_f32 v250, v215, v251, v252
    v_sin_f32 v87, v250
    v_cos_f32 v250, v250
    s_nop 0
    v_cvt_pk_f16_f32 v83, v250, v87
    v_cvt_pk_f16_f32 v87, -v87, v250
    s_branch L_st23
L_p1_done:
    s_mov_b64 exec, 1
    ds_add_u32 v0, v255 offset:42828
    s_mov_b64 exec, -1
    s_setprio 0
    v_mov_b32 v4, v112
    v_mov_b32 v5, v113
    v_mov_b32 v249, v114
    v_mov_b32 v205, v115
    v_mov_b32 v248, v116
    v_mov_b32 v208, v117
    v_mov_b32 v7, v118
    v_mov_b32 v6, v119
    s_and_b32 s31, s2, 7
    s_sub_u32 s32, 8, s31
    s_min_u32 s46, s31, s32
    s_lshr_b32 s53, s31, 2
    s_lshr_b32 s47, s2, 3
    s_and_b32 s32, s47, 1
    s_and_b32 s31, s31, 3
    s_cselect_b32 s53, s53, s32
    s_cselect_b32 s31, 0, 1
    s_lshr_b32 s47, s47, s31
    s_lshl_b32 s53, s53, 4
    s_lshl_b32 s31, s30, 5
    s_add_u32 s53, s53, s31
    s_lshl_b32 s48, s46, 1
    s_add_u32 s48, s48, 2040
    s_mov_b32 s49, 32768
    v_mov_b32 v212, v210
    v_mov_b32 v213, v210
    v_mov_b32 v214, v210
    v_mov_b32 v215, v210
    s_cmp_ge_u32 s2, 224
    s_cbranch_scc1 L_zst_go
L_sync4:
    ds_read_b32 v1, v0 offset:42840
    s_add_u32 s92, s92, 1
    s_bitcmp1_b32 s92, 20
    s_cbranch_scc1 L_sync4x
    s_waitcnt lgkmcnt(0)
    v_readfirstlane_b32 s31, v1
    s_nop 0
    s_cmp_ge_u32 s31, 1
    s_cbranch_scc0 L_sync4
L_sync4x:
L_zst_go:
    s_mov_b32 exec_hi, s72
    buffer_store_dwordx4 v[176:179], v209, s[12:15], s60 offen sc1
    s_mov_b32 exec_hi, s73
    buffer_store_dwordx4 v[180:183], v209, s[12:15], s61 offen sc1
    buffer_store_dwordx4 v[184:187], v209, s[12:15], s62 offen sc1
    buffer_store_dwordx4 v[188:191], v209, s[12:15], s63 offen sc1
    s_mov_b32 exec_hi, -1
L_sync5:
    ds_read_b32 v1, v0 offset:42860
    s_add_u32 s92, s92, 1
    s_bitcmp1_b32 s92, 20
    s_cbranch_scc1 L_sync5x
    s_waitcnt lgkmcnt(0)
    v_readfirstlane_b32 s31, v1
    s_nop 0
    s_cmp_ge_u32 s31, 1
    s_cbranch_scc0 L_sync5
L_sync5x:
    buffer_load_dwordx4 v[24:27], v6, s[12:15], s49 offen
    s_add_u32 m0, s76, 0
    s_nop 0
    buffer_load_dwordx4 v4, s[8:11], 0 offen lds
    s_add_u32 m0, s76, 1024
    s_nop 0
    buffer_load_dwordx4 v5, s[8:11], 0 offen lds
    v_and_b32 v160, 15, v2
    v_add_u32 v160, s53, v160
    v_cvt_f32_u32 v160, v160
    v_add_f32 v160, 0.5, v160
    v_mul_f32 v160, 0x3b800000, v160
    v_and_b32 v161, 32, v2
    v_bfe_u32 v162, v2, 4, 1
    v_lshl_add_u32 v161, v162, 3, v161
    v_cvt_f32_u32 v161, v161
    v_mul_f32 v161, v161, v160
    v_fmamk_f32 v88, v160, 0x0, v161
    v_fmamk_f32 v162, v160, 0x40000000, v161
    v_sin_f32 v104, v88
    v_sin_f32 v163, v162
    v_cos_f32 v88, v88
    v_cos_f32 v162, v162
    v_cvt_pk_f16_f32 v104, v104, v163
    v_cvt_pk_f16_f32 v88, v88, v162
    v_fmamk_f32 v89, v160, 0x40800000, v161
    v_fmamk_f32 v162, v160, 0x40c00000, v161
    v_sin_f32 v105, v89
    v_sin_f32 v163, v162
    v_cos_f32 v89, v89
    v_cos_f32 v162, v162
    v_cvt_pk_f16_f32 v105, v105, v163
    v_cvt_pk_f16_f32 v89, v89, v162
    v_fmamk_f32 v90, v160, 0x41800000, v161
    v_fmamk_f32 v162, v160, 0x41900000, v161
    v_sin_f32 v106, v90
    v_sin_f32 v163, v162
    v_cos_f32 v90, v90
    v_cos_f32 v162, v162
    v_cvt_pk_f16_f32 v106, v106, v163
    v_cvt_pk_f16_f32 v90, v90, v162
    v_fmamk_f32 v91, v160, 0x41a00000, v161
    v_fmamk_f32 v162, v160, 0x41b00000, v161
    v_sin_f32 v107, v91
    v_sin_f32 v163, v162
    v_cos_f32 v91, v91
    v_cos_f32 v162, v162
    v_cvt_pk_f16_f32 v107, v107, v163
    v_cvt_pk_f16_f32 v91, v91, v162
    v_fmamk_f32 v92, v160, 0x42800000, v161
    v_fmamk_f32 v162, v160, 0x42840000, v161
    v_sin_f32 v108, v92
    v_sin_f32 v163, v162
    v_cos_f32 v92, v92
    v_cos_f32 v162, v162
    v_cvt_pk_f16_f32 v108, v108, v163
    v_cvt_pk_f16_f32 v92, v92, v162
    v_fmamk_f32 v93, v160, 0x42880000, v161
    v_fmamk_f32 v162, v160, 0x428c0000, v161
    v_sin_f32 v109, v93
    v_sin_f32 v163, v162
    v_cos_f32 v93, v93
    v_cos_f32 v162, v162
    v_cvt_pk_f16_f32 v109, v109, v163
    v_cvt_pk_f16_f32 v93, v93, v162
    v_fmamk_f32 v94, v160, 0x42a00000, v161
    v_fmamk_f32 v162, v160, 0x42a40000, v161
    v_sin_f32 v110, v94
    v_sin_f32 v163, v162
    v_cos_f32 v94, v94
    v_cos_f32 v162, v162
    v_cvt_pk_f16_f32 v110, v110, v163
    v_cvt_pk_f16_f32 v94, v94, v162
    v_fmamk_f32 v95, v160, 0x42a80000, v161
    v_fmamk_f32 v162, v160, 0x42ac0000, v161
    v_sin_f32 v111, v95
    v_sin_f32 v163, v162
    v_cos_f32 v95, v95
    v_cos_f32 v162, v162
    v_cvt_pk_f16_f32 v111, v111, v163
    v_cvt_pk_f16_f32 v95, v95, v162
    v_fmamk_f32 v96, v160, 0x3f800000, v161
    v_fmamk_f32 v162, v160, 0x40400000, v161
    v_sin_f32 v112, v96
    v_sin_f32 v163, v162
    v_cos_f32 v96, v96
    v_cos_f32 v162, v162
    v_cvt_pk_f16_f32 v112, v112, v163
    v_cvt_pk_f16_f32 v96, v96, v162
    v_fmamk_f32 v97, v160, 0x40a00000, v161
    v_fmamk_f32 v162, v160, 0x40e00000, v161
    v_sin_f32 v113, v97
    v_sin_f32 v163, v162
    v_cos_f32 v97, v97
    v_cos_f32 v162, v162
    v_cvt_pk_f16_f32 v113, v113, v163
    v_cvt_pk_f16_f32 v97, v97, v162
    v_fmamk_f32 v98, v160, 0x41880000, v161
    v_fmamk_f32 v162, v160, 0x41980000, v161
    v_sin_f32 v114, v98
    v_sin_f32 v163, v162
    v_cos_f32 v98, v98
    v_cos_f32 v162, v162
    v_cvt_pk_f16_f32 v114, v114, v163
    v_cvt_pk_f16_f32 v98, v98, v162
    v_fmamk_f32 v99, v160, 0x41a80000, v161
    v_fmamk_f32 v162, v160, 0x41b80000, v161
    v_sin_f32 v115, v99
    v_sin_f32 v163, v162
    v_cos_f32 v99, v99
    v_cos_f32 v162, v162
    v_cvt_pk_f16_f32 v115, v115, v163
    v_cvt_pk_f16_f32 v99, v99, v162
    v_fmamk_f32 v100, v160, 0x42820000, v161
    v_fmamk_f32 v162, v160, 0x42860000, v161
    v_sin_f32 v116, v100
    v_sin_f32 v163, v162
    v_cos_f32 v100, v100
    v_cos_f32 v162, v162
    v_cvt_pk_f16_f32 v116, v116, v163
    v_cvt_pk_f16_f32 v100, v100, v162
    v_fmamk_f32 v101, v160, 0x428a0000, v161
    v_fmamk_f32 v162, v160, 0x428e0000, v161
    v_sin_f32 v117, v101
    v_sin_f32 v163, v162
    v_cos_f32 v101, v101
    v_cos_f32 v162, v162
    v_cvt_pk_f16_f32 v117, v117, v163
    v_cvt_pk_f16_f32 v101, v101, v162
    v_fmamk_f32 v102, v160, 0x42a20000, v161
    v_fmamk_f32 v162, v160, 0x42a60000, v161
    v_sin_f32 v118, v102
    v_sin_f32 v163, v162
    v_cos_f32 v102, v102
    v_cos_f32 v162, v162
    v_cvt_pk_f16_f32 v118, v118, v163
    v_cvt_pk_f16_f32 v102, v102, v162
    v_fmamk_f32 v103, v160, 0x42aa0000, v161
    v_fmamk_f32 v162, v160, 0x42ae0000, v161
    v_sin_f32 v119, v103
    v_sin_f32 v163, v162
    v_cos_f32 v103, v103
    v_cos_f32 v162, v162
    v_cvt_pk_f16_f32 v119, v119, v163
    v_cvt_pk_f16_f32 v103, v103, v162
    v_cmp_gt_u32 vcc, 16, v2
    v_and_b32 v162, 1, v2
    v_lshlrev_b32 v162, 15, v162
    v_or_b32 v162, 0x3c00, v162
    v_and_b32 v160, 0xffff0000, v104
    v_or_b32 v162, v162, v160
    v_cndmask_b32 v104, v104, v162, vcc
    s_mul_i32 s51, s46, 528384
    s_add_u32 s51, s51, 2097152
    s_mul_i32 s54, s47, 16512
    s_lshl_b32 s32, s30, 12
    s_add_u32 s50, s51, s54
    s_add_u32 s50, s50, s32
    s_add_u32 s55, s47, 1
    s_and_b32 s55, s55, 31
    s_mul_i32 s55, s55, 16512
    v_add_u32 v250, s32, v3
    v_add_u32 v199, s76, v3
    v_lshl_add_u32 v200, v2, 7, s32
    v_and_b32 v1, 2, v2
    v_lshl_add_u32 v200, v1, 3, v200
    v_and_b32 v1, 0x70, v3
    v_add_u32 v1, 16384, v1
    s_mov_b32 vcc_lo, 0
    s_mov_b32 vcc_hi, -1
    v_cndmask_b32 v200, v200, v1, vcc
    s_mov_b32 vcc_hi, 0xff
    v_mov_b32 v1, s55
    v_mov_b32 v201, s54
    v_cndmask_b32 v1, v1, v201, vcc
    v_mov_b32 v201, 16640
    v_cndmask_b32 v201, v201, v0, vcc
    v_add_u32 v201, v201, v200
    v_add_u32 v200, v1, v200
    v_lshrrev_b32 v251, 5, v2
    v_lshlrev_b32 v251, 11, v251
    v_bfe_u32 v1, v2, 2, 3
    v_lshl_add_u32 v251, v1, 7, v251
    v_and_b32 v1, 3, v2
    v_lshl_add_u32 v251, v1, 5, v251
    v_bfe_u32 v1, v2, 3, 1
    v_lshl_add_u32 v251, v1, 4, v251
    v_bfe_u32 v1, v2, 4, 1
    v_lshl_add_u32 v251, v1, 3, v251
    v_xor_b32 v252, 16, v251
    v_xor_b32 v253, 8, v251
    v_xor_b32 v254, 24, v251
    v_cmp_gt_u32 vcc, 4, v2
    v_mov_b32 v1, 16384
    s_nop 0
    v_cndmask_b32 v1, v0, v1, vcc
    v_add_u32 v206, v253, v1
    v_add_u32 v207, v254, v1
    s_mov_b32 vcc_lo, 0x88888888
    s_mov_b32 vcc_hi, 0x88888888
    v_mov_b32 v1, 16544
    v_cndmask_b32 v1, 32, v1, vcc
    v_add_u32 v202, v251, v1
    v_add_u32 v203, v253, v1
    v_add_u32 v204, v206, v1
    s_waitcnt vmcnt(0)
L_stat_check:
    v_cmp_ne_u64 vcc, s[28:29], v[26:27]
    s_nop 0
    s_cbranch_vccz L_stat_got
    s_cmp_eq_u32 s35, 0
    s_cbranch_scc1 L_stat_got
    s_sub_u32 s35, s35, 1
    s_sleep 2
    s_mov_b64 exec, vcc
    buffer_load_dwordx4 v[24:27], v6, s[12:15], s49 offen sc1
    s_mov_b64 exec, -1
    s_waitcnt vmcnt(0)
    s_branch L_stat_check
L_stat_got:
    v_cndmask_b32 v24, v24, v25, s[88:89]
    v_mov_b32 v32, v24
    s_nop 1
    v_permlane32_swap_b32 v24, v32
    v_mov_b32 v28, v24
    v_mov_b32 v36, v32
    s_nop 0
    v_permlane16_swap_b32 v24, v28
    v_permlane16_swap_b32 v32, v36
    v_lshlrev_b32 v26, 16, v24
    v_and_b32 v24, 0xffff0000, v24
    v_rcp_f32 v24, v24
    v_lshlrev_b32 v30, 16, v28
    v_and_b32 v28, 0xffff0000, v28
    v_rcp_f32 v28, v28
    v_lshlrev_b32 v34, 16, v32
    v_and_b32 v32, 0xffff0000, v32
    v_rcp_f32 v32, v32
    v_lshlrev_b32 v38, 16, v36
    v_and_b32 v36, 0xffff0000, v36
    v_rcp_f32 v36, v36
    v_mul_f32 v24, 0xbfb8aa3b, v24
    v_mul_f32_e64 v26, -v26, v24
    v_mul_f32 v28, 0xbfb8aa3b, v28
    v_mul_f32_e64 v30, -v30, v28
    v_mul_f32 v32, 0xbfb8aa3b, v32
    v_mul_f32_e64 v34, -v34, v32
    v_mul_f32 v36, 0xbfb8aa3b, v36
    v_mul_f32_e64 v38, -v38, v36
    ds_read_b128 v[8:11], v208 offset:0
    ds_read_b128 v[12:15], v208 offset:1024
    s_waitcnt lgkmcnt(0)
    v_lshlrev_b32 v40, 16, v8
    v_and_b32 v41, 0xffff0000, v8
    v_lshlrev_b32 v42, 16, v9
    v_and_b32 v43, 0xffff0000, v9
    v_lshlrev_b32 v44, 16, v10
    v_and_b32 v45, 0xffff0000, v10
    v_lshlrev_b32 v46, 16, v11
    v_and_b32 v47, 0xffff0000, v11
    v_lshlrev_b32 v48, 16, v12
    v_and_b32 v55, 0xffff0000, v12
    v_lshlrev_b32 v54, 16, v13
    v_and_b32 v53, 0xffff0000, v13
    v_lshlrev_b32 v52, 16, v14
    v_and_b32 v51, 0xffff0000, v14
    v_lshlrev_b32_e64 v50, 16, v15
    v_and_b32 v49, 0xffff0000, v15
    v_pk_fma_f32 v[120:121], v[40:41], v[24:25], v[26:27] op_sel_hi:[1,0,0]
    v_pk_fma_f32 v[122:123], v[42:43], v[24:25], v[26:27] op_sel_hi:[1,0,0]
    v_pk_fma_f32 v[124:125], v[44:45], v[24:25], v[26:27] op_sel_hi:[1,0,0]
    v_pk_fma_f32 v[126:127], v[46:47], v[24:25], v[26:27] op_sel_hi:[1,0,0]
    v_pk_fma_f32 v[128:129], v[48:49], v[28:29], v[30:31] op_sel_hi:[1,0,0]
    v_pk_fma_f32 v[130:131], v[50:51], v[28:29], v[30:31] op_sel_hi:[1,0,0]
    v_pk_fma_f32 v[132:133], v[52:53], v[28:29], v[30:31] op_sel_hi:[1,0,0]
    v_pk_fma_f32 v[134:135], v[54:55], v[28:29], v[30:31] op_sel_hi:[1,0,0]
    v_exp_f32 v216, v120
    v_exp_f32 v217, v121
    v_exp_f32 v218, v122
    v_exp_f32 v219, v123
    v_exp_f32 v220, v124
    v_exp_f32 v221, v125
    v_exp_f32 v222, v126
    v_exp_f32 v223, v127
    v_exp_f32 v224, v128
    v_exp_f32 v225, v129
    v_exp_f32 v226, v130
    v_exp_f32 v227, v131
    v_exp_f32 v228, v132
    v_exp_f32 v229, v133
    v_exp_f32 v230, v134
    v_exp_f32 v231, v135
    v_pk_add_f32 v[216:217], v[216:217], 1.0 op_sel_hi:[1,0]
    v_pk_add_f32 v[218:219], v[218:219], 1.0 op_sel_hi:[1,0]
    v_pk_add_f32 v[220:221], v[220:221], 1.0 op_sel_hi:[1,0]
    v_pk_add_f32 v[222:223], v[222:223], 1.0 op_sel_hi:[1,0]
    v_pk_add_f32 v[224:225], v[224:225], 1.0 op_sel_hi:[1,0]
    v_pk_add_f32 v[226:227], v[226:227], 1.0 op_sel_hi:[1,0]
    v_pk_add_f32 v[228:229], v[228:229], 1.0 op_sel_hi:[1,0]
    v_pk_add_f32 v[230:231], v[230:231], 1.0 op_sel_hi:[1,0]
    v_rcp_f32 v216, v216
    v_rcp_f32 v217, v217
    v_rcp_f32 v218, v218
    v_rcp_f32 v219, v219
    v_rcp_f32 v220, v220
    v_rcp_f32 v221, v221
    v_rcp_f32 v222, v222
    v_rcp_f32 v223, v223
    v_rcp_f32 v224, v224
    v_rcp_f32 v225, v225
    v_rcp_f32 v226, v226
    v_rcp_f32 v227, v227
    v_rcp_f32 v228, v228
    v_rcp_f32 v229, v229
    v_rcp_f32 v230, v230
    v_rcp_f32 v231, v231
    v_pk_mul_f32 v[120:121], v[120:121], v[216:217]
    v_pk_mul_f32 v[122:123], v[122:123], v[218:219]
    v_pk_mul_f32 v[124:125], v[124:125], v[220:221]
    v_pk_mul_f32 v[126:127], v[126:127], v[222:223]
    v_pk_mul_f32 v[128:129], v[128:129], v[224:225]
    v_pk_mul_f32 v[130:131], v[130:131], v[226:227]
    v_pk_mul_f32 v[132:133], v[132:133], v[228:229]
    v_pk_mul_f32 v[134:135], v[134:135], v[230:231]
L_sync6:
    ds_read_b32 v1, v0 offset:42848
    s_add_u32 s92, s92, 1
    s_bitcmp1_b32 s92, 20
    s_cbranch_scc1 L_sync6x
    s_waitcnt lgkmcnt(0)
    v_readfirstlane_b32 s31, v1
    s_nop 0
    s_cmp_ge_u32 s31, 4
    s_cbranch_scc0 L_sync6
L_sync6x:
    s_add_u32 m0, s76, 2048
    s_nop 0
    buffer_load_dwordx4 v249, s[8:11], 0 offen lds
    s_add_u32 m0, s76, 3072
    s_nop 0
    buffer_load_dwordx4 v205, s[8:11], 0 offen lds
L_sync7:
    ds_read_b32 v1, v0 offset:42844
    ds_read_b32 v198, v0 offset:41556
    s_add_u32 s92, s92, 1
    s_bitcmp1_b32 s92, 20
    s_cbranch_scc1 L_sync7x
    s_waitcnt lgkmcnt(1)
    v_readfirstlane_b32 s31, v1
    s_nop 0
    s_cmp_ge_u32 s31, 1
    s_cbranch_scc0 L_sync7
L_sync7x:
    v_and_b32 v6, 48, v2
    v_lshlrev_b32 v6, 1, v6
    v_mov_b32 v209, 2147483392
    s_waitcnt lgkmcnt(0)
    v_readfirstlane_b32 s33, v198
    s_nop 0
    s_andn2_b32 s33, 0x7ff, s33
    s_sub_u32 s31, 0, s33
    s_and_b32 s31, s31, 2047
    s_sub_u32 s32, s33, 1024
    s_sub_u32 s34, s31, 1024
    v_cmp_eq_u32 vcc, s33, v7
    v_cmp_eq_u32 s[54:55], s33, v248
    s_nop 0
    v_cndmask_b32 v4, v4, v209, vcc
    v_cmp_eq_u32 vcc, s31, v7
    v_cmp_eq_u32 s[56:57], s31, v248
    s_nop 0
    v_cndmask_b32 v5, v5, v209, vcc
    v_cmp_eq_u32 vcc, s32, v7
    v_cmp_eq_u32 s[58:59], s32, v248
    s_nop 0
    v_cndmask_b32 v249, v249, v209, vcc
    v_cmp_eq_u32 vcc, s34, v7
    v_cmp_eq_u32 s[60:61], s34, v248
    s_nop 0
    v_cndmask_b32 v205, v205, v209, vcc
    s_or_b64 s[62:63], s[54:55], s[58:59]
    s_or_b64 s[64:65], s[56:57], s[60:61]
    s_waitcnt vmcnt(0)
    buffer_load_dwordx4 v[72:75], v3, s[12:15], s50 offen offset:0 sc1
    buffer_load_dwordx4 v[76:79], v3, s[12:15], s50 offen offset:1024 sc1
    buffer_load_dwordx4 v[80:83], v3, s[12:15], s50 offen offset:2048 sc1
    buffer_load_dwordx4 v[84:87], v3, s[12:15], s50 offen offset:3072 sc1
    s_mov_b32 exec_hi, 0x1ff
    buffer_load_dwordx4 v[212:215], v200, s[12:15], s51 offen sc1
    s_mov_b32 exec_hi, -1
    s_setprio 2
    ds_read_b128 v[16:19], v208 offset:2048
    ds_read_b128 v[20:23], v208 offset:3072
    s_waitcnt lgkmcnt(0)
    v_lshlrev_b32 v56, 16, v16
    v_and_b32 v57, 0xffff0000, v16
    v_lshlrev_b32 v58, 16, v17
    v_and_b32 v59, 0xffff0000, v17
    v_lshlrev_b32 v60, 16, v18
    v_and_b32 v61, 0xffff0000, v18
    v_lshlrev_b32 v62, 16, v19
    v_and_b32 v63, 0xffff0000, v19
    v_lshlrev_b32 v64, 16, v20
    v_and_b32 v71, 0xffff0000, v20
    v_lshlrev_b32 v70, 16, v21
    v_and_b32 v69, 0xffff0000, v21
    v_lshlrev_b32 v68, 16, v22
    v_and_b32 v67, 0xffff0000, v22
    v_lshlrev_b32 v66, 16, v23
    v_and_b32 v65, 0xffff0000, v23
    v_pk_fma_f32 v[136:137], v[56:57], v[32:33], v[34:35] op_sel_hi:[1,0,0]
    v_pk_fma_f32 v[138:139], v[58:59], v[32:33], v[34:35] op_sel_hi:[1,0,0]
    v_pk_fma_f32 v[140:141], v[60:61], v[32:33], v[34:35] op_sel_hi:[1,0,0]
    v_pk_fma_f32 v[142:143], v[62:63], v[32:33], v[34:35] op_sel_hi:[1,0,0]
    v_pk_fma_f32 v[144:145], v[64:65], v[36:37], v[38:39] op_sel_hi:[1,0,0]
    v_pk_fma_f32 v[146:147], v[66:67], v[36:37], v[38:39] op_sel_hi:[1,0,0]
    v_pk_fma_f32 v[148:149], v[68:69], v[36:37], v[38:39] op_sel_hi:[1,0,0]
    v_pk_fma_f32 v[150:151], v[70:71], v[36:37], v[38:39] op_sel_hi:[1,0,0]
    v_exp_f32 v232, v136
    v_exp_f32 v233, v137
    v_exp_f32 v234, v138
    v_exp_f32 v235, v139
    v_exp_f32 v236, v140
    v_exp_f32 v237, v141
    v_exp_f32 v238, v142
    v_exp_f32 v239, v143
    v_exp_f32 v240, v144
    v_exp_f32 v241, v145
    v_exp_f32 v242, v146
    v_exp_f32 v243, v147
    v_exp_f32 v244, v148
    v_exp_f32 v245, v149
    v_exp_f32 v246, v150
    v_exp_f32 v247, v151
    v_pk_add_f32 v[232:233], v[232:233], 1.0 op_sel_hi:[1,0]
    v_pk_add_f32 v[234:235], v[234:235], 1.0 op_sel_hi:[1,0]
    v_pk_add_f32 v[236:237], v[236:237], 1.0 op_sel_hi:[1,0]
    v_pk_add_f32 v[238:239], v[238:239], 1.0 op_sel_hi:[1,0]
    v_pk_add_f32 v[240:241], v[240:241], 1.0 op_sel_hi:[1,0]
    v_pk_add_f32 v[242:243], v[242:243], 1.0 op_sel_hi:[1,0]
    v_pk_add_f32 v[244:245], v[244:245], 1.0 op_sel_hi:[1,0]
    v_pk_add_f32 v[246:247], v[246:247], 1.0 op_sel_hi:[1,0]
    v_rcp_f32 v232, v232
    v_rcp_f32 v233, v233
    v_rcp_f32 v234, v234
    v_rcp_f32 v235, v235
    v_rcp_f32 v236, v236
    v_rcp_f32 v237, v237
    v_rcp_f32 v238, v238
    v_rcp_f32 v239, v239
    v_rcp_f32 v240, v240
    v_rcp_f32 v241, v241
    v_rcp_f32 v242, v242
    v_rcp_f32 v243, v243
    v_rcp_f32 v244, v244
    v_rcp_f32 v245, v245
    v_rcp_f32 v246, v246
    v_rcp_f32 v247, v247
    v_pk_mul_f32 v[136:137], v[136:137], v[232:233]
    v_pk_mul_f32 v[138:139], v[138:139], v[234:235]
    v_pk_mul_f32 v[140:141], v[140:141], v[236:237]
    v_pk_mul_f32 v[142:143], v[142:143], v[238:239]
    v_pk_mul_f32 v[144:145], v[144:145], v[240:241]
    v_pk_mul_f32 v[146:147], v[146:147], v[242:243]
    v_pk_mul_f32 v[148:149], v[148:149], v[244:245]
    v_pk_mul_f32 v[150:151], v[150:151], v[246:247]
L_z_wait:
    s_setprio 2
    s_waitcnt vmcnt(4)
    v_xor_b32 v160, v210, v72
    v_xor_b32 v161, v210, v73
    v_xor_b32 v162, v210, v74
    v_xor_b32 v163, v210, v75
    ds_write_b128 v250, v[160:163] offset:0
    v_or3_b32 v1, v160, v161, v162
    v_or_b32 v1, v1, v163
    s_waitcnt vmcnt(3)
    v_xor_b32 v164, v210, v76
    v_xor_b32 v165, v210, v77
    v_xor_b32 v166, v210, v78
    v_xor_b32 v167, v210, v79
    ds_write_b128 v250, v[164:167] offset:1024
    v_or3_b32 v1, v1, v164, v165
    v_or3_b32 v1, v1, v166, v167
    s_waitcnt vmcnt(2)
    v_xor_b32 v168, v210, v80
    v_xor_b32 v169, v210, v81
    v_xor_b32 v170, v210, v82
    v_xor_b32 v171, v210, v83
    ds_write_b128 v250, v[168:171] offset:2048
    v_or3_b32 v1, v1, v168, v169
    v_or3_b32 v1, v1, v170, v171
    s_waitcnt vmcnt(1)
    v_xor_b32 v172, v210, v84
    v_xor_b32 v173, v210, v85
    v_xor_b32 v174, v210, v86
    v_xor_b32 v175, v210, v87
    ds_write_b128 v250, v[172:175] offset:3072
    v_or3_b32 v1, v1, v172, v173
    v_or3_b32 v1, v1, v174, v175
    s_waitcnt vmcnt(0)
    v_xor_b32 v176, v210, v212
    v_xor_b32 v177, v210, v213
    v_xor_b32 v178, v210, v214
    v_xor_b32 v179, v210, v215
    s_mov_b32 exec_hi, 0x1ff
    ds_write_b128 v201, v[176:179]
    s_mov_b32 exec_hi, -1
    v_or3_b32 v1, v1, v176, v177
    v_or3_b32 v1, v1, v178, v179
    v_and_b32 v1, 0x30003, v1
    v_cmp_ne_u32 vcc, 0, v1
    s_nop 0
    s_cbranch_vccz L_z_got
    s_cmp_eq_u32 s35, 0
    s_cbranch_scc1 L_z_got
    s_sub_u32 s35, s35, 1
    s_sleep 2
    s_mov_b64 exec, vcc
    buffer_load_dwordx4 v[72:75], v3, s[12:15], s50 offen offset:0 sc1
    buffer_load_dwordx4 v[76:79], v3, s[12:15], s50 offen offset:1024 sc1
    buffer_load_dwordx4 v[80:83], v3, s[12:15], s50 offen offset:2048 sc1
    buffer_load_dwordx4 v[84:87], v3, s[12:15], s50 offen offset:3072 sc1
    s_and_b32 exec_hi, exec_hi, 0x1ff
    s_or_b32 exec_lo, exec_lo, 1
    buffer_load_dwordx4 v[212:215], v200, s[12:15], s51 offen sc1
    s_mov_b64 exec, -1
    s_waitcnt lgkmcnt(0)
    s_branch L_z_wait
L_z_got:
    s_mov_b64 exec, 1
    ds_add_u32 v0, v255 offset:42832
    s_mov_b64 exec, -1
L_sync8:
    ds_read_b32 v1, v0 offset:42832
    ds_read_b64_tr_b16 v[152:153], v251 offset:0
    ds_read_b64_tr_b16 v[154:155], v251 offset:1024
    ds_read_b64_tr_b16 v[156:157], v252 offset:0
    ds_read_b64_tr_b16 v[158:159], v252 offset:1024
    s_add_u32 s92, s92, 1
    s_bitcmp1_b32 s92, 20
    s_cbranch_scc1 L_sync8x
    s_waitcnt lgkmcnt(4)
    v_readfirstlane_b32 s31, v1
    s_nop 0
    s_cmp_ge_u32 s31, 4
    s_cbranch_scc0 L_sync8
L_sync8x:
    ds_read_b64_tr_b16 v[160:161], v251 offset:4096
    ds_read_b64_tr_b16 v[162:163], v251 offset:5120
    ds_read_b64_tr_b16 v[164:165], v252 offset:4096
    ds_read_b64_tr_b16 v[166:167], v252 offset:5120
    ds_read_b64_tr_b16 v[168:169], v251 offset:8192
    ds_read_b64_tr_b16 v[170:171], v251 offset:9216
    ds_read_b64_tr_b16 v[172:173], v252 offset:8192
    ds_read_b64_tr_b16 v[174:175], v252 offset:9216
    s_waitcnt lgkmcnt(8)
    v_mfma_f32_16x16x32_f16 v[216:219], v[152:155], v[88:91], 0
    v_mfma_f32_16x16x32_f16 v[220:223], v[156:159], v[88:91], 0
    ds_read_b64_tr_b16 v[176:177], v251 offset:12288
    ds_read_b64_tr_b16 v[178:179], v251 offset:13312
    ds_read_b64_tr_b16 v[180:181], v252 offset:12288
    ds_read_b64_tr_b16 v[182:183], v252 offset:13312
    s_waitcnt lgkmcnt(8)
    v_mfma_f32_16x16x32_f16 v[216:219], v[160:163], v[92:95], v[216:219]
    v_mfma_f32_16x16x32_f16 v[220:223], v[164:167], v[92:95], v[220:223]
    ds_read_b64_tr_b16 v[152:153], v206 offset:0
    ds_read_b64_tr_b16 v[154:155], v253 offset:1024
    ds_read_b64_tr_b16 v[156:157], v207 offset:0
    ds_read_b64_tr_b16 v[158:159], v254 offset:1024
    s_waitcnt lgkmcnt(8)
    v_mfma_f32_16x16x32_f16 v[224:227], v[168:171], v[96:99], 0
    v_mfma_f32_16x16x32_f16 v[228:231], v[172:175], v[96:99], 0
    ds_read_b64_tr_b16 v[160:161], v253 offset:4096
    ds_read_b64_tr_b16 v[162:163], v253 offset:5120
    ds_read_b64_tr_b16 v[164:165], v254 offset:4096
    ds_read_b64_tr_b16 v[166:167], v254 offset:5120
    s_waitcnt lgkmcnt(8)
    v_mfma_f32_16x16x32_f16 v[224:227], v[176:179], v[100:103], v[224:227]
    v_mfma_f32_16x16x32_f16 v[228:231], v[180:183], v[100:103], v[228:231]
    ds_read_b64_tr_b16 v[168:169], v253 offset:8192
    ds_read_b64_tr_b16 v[170:171], v253 offset:9216
    ds_read_b64_tr_b16 v[172:173], v254 offset:8192
    ds_read_b64_tr_b16 v[174:175], v254 offset:9216
    s_waitcnt lgkmcnt(8)
    v_mfma_f32_16x16x32_f16 v[216:219], v[152:155], v[104:107], v[216:219]
    v_mfma_f32_16x16x32_f16 v[220:223], v[156:159], v[104:107], v[220:223]
    ds_read_b64_tr_b16 v[176:177], v253 offset:12288
    ds_read_b64_tr_b16 v[178:179], v253 offset:13312
    ds_read_b64_tr_b16 v[180:181], v254 offset:12288
    ds_read_b64_tr_b16 v[182:183], v254 offset:13312
    s_waitcnt lgkmcnt(8)
    v_mfma_f32_16x16x32_f16 v[216:219], v[160:163], v[108:111], v[216:219]
    v_mfma_f32_16x16x32_f16 v[220:223], v[164:167], v[108:111], v[220:223]
    ds_read_b64_tr_b16 v[72:73], v202 offset:0
    ds_read_b64_tr_b16 v[74:75], v202 offset:1024
    ds_read_b64_tr_b16 v[76:77], v202 offset:4096
    ds_read_b64_tr_b16 v[78:79], v202 offset:5120
    s_waitcnt lgkmcnt(8)
    v_mfma_f32_16x16x32_f16 v[224:227], v[168:171], v[112:115], v[224:227]
    v_mfma_f32_16x16x32_f16 v[228:231], v[172:175], v[112:115], v[228:231]
    ds_read_b64_tr_b16 v[80:81], v202 offset:8192
    ds_read_b64_tr_b16 v[82:83], v202 offset:9216
    ds_read_b64_tr_b16 v[84:85], v202 offset:12288
    ds_read_b64_tr_b16 v[86:87], v202 offset:13312
    s_waitcnt lgkmcnt(8)
    v_mfma_f32_16x16x32_f16 v[224:227], v[176:179], v[116:119], v[224:227]
    v_mfma_f32_16x16x32_f16 v[228:231], v[180:183], v[116:119], v[228:231]
    ds_read_b64_tr_b16 v[240:241], v204 offset:0
    ds_read_b64_tr_b16 v[242:243], v203 offset:1024
    ds_read_b64_tr_b16 v[244:245], v203 offset:4096
    ds_read_b64_tr_b16 v[246:247], v203 offset:5120
    s_waitcnt lgkmcnt(8)
    ds_read_b64_tr_b16 v[184:185], v203 offset:8192
    ds_read_b64_tr_b16 v[186:187], v203 offset:9216
    ds_read_b64_tr_b16 v[188:189], v203 offset:12288
    ds_read_b64_tr_b16 v[190:191], v203 offset:13312
    v_mfma_f32_16x16x32_f16 v[232:235], v[72:75], v[88:91], 0
    v_mfma_f32_16x16x32_f16 v[232:235], v[76:79], v[92:95], v[232:235]
    s_waitcnt lgkmcnt(4)
    v_mfma_f32_16x16x32_f16 v[236:239], v[80:83], v[96:99], 0
    v_mfma_f32_16x16x32_f16 v[236:239], v[84:87], v[100:103], v[236:239]
    v_pk_add_f32 v[152:153], v[216:217], v[224:225]
    v_pk_add_f32 v[154:155], v[218:219], v[226:227]
    v_pk_add_f32 v[156:157], v[220:221], v[228:229]
    v_pk_add_f32 v[158:159], v[222:223], v[230:231]
    v_mfma_f32_16x16x32_f16 v[232:235], v[240:243], v[104:107], v[232:235]
    v_mfma_f32_16x16x32_f16 v[232:235], v[244:247], v[108:111], v[232:235]
    v_pk_fma_f32 v[40:41], v[152:153], v[120:121], v[40:41]
    v_pk_fma_f32 v[42:43], v[154:155], v[122:123], v[42:43]
    v_pk_fma_f32 v[44:45], v[156:157], v[124:125], v[44:45]
    v_pk_fma_f32 v[46:47], v[158:159], v[126:127], v[46:47]
    s_waitcnt lgkmcnt(0)
    s_nop 0
    v_mfma_f32_16x16x32_f16 v[236:239], v[184:187], v[112:115], v[236:239]
    v_mfma_f32_16x16x32_f16 v[236:239], v[188:191], v[116:119], v[236:239]
    v_cvt_pk_bf16_f32 v8, v40, v41
    v_cvt_pk_bf16_f32 v9, v42, v43
    v_cvt_pk_bf16_f32 v10, v44, v45
    v_cvt_pk_bf16_f32 v11, v46, v47
    ds_write_b128 v208, v[8:11] offset:0
    ds_read_b128 v[24:27], v199 offset:0
    v_pk_add_f32 v[160:161], v[216:217], v[224:225] neg_lo:[0,1] neg_hi:[0,1]
    v_pk_add_f32 v[162:163], v[218:219], v[226:227] neg_lo:[0,1] neg_hi:[0,1]
    v_pk_add_f32 v[164:165], v[220:221], v[228:229] neg_lo:[0,1] neg_hi:[0,1]
    v_pk_add_f32 v[166:167], v[222:223], v[230:231] neg_lo:[0,1] neg_hi:[0,1]
    s_cmp_eq_u64 s[62:63], 0
    s_cbranch_scc1 L_nodump0
    s_mov_b64 exec, s[54:55]
    ds_write_b128 v6, v[152:155] offset:42496
    ds_write_b128 v6, v[156:159] offset:42512
    s_mov_b64 exec, s[58:59]
    ds_write_b128 v6, v[160:163] offset:42496
    ds_write_b128 v6, v[164:167] offset:42512
    s_mov_b64 exec, 1
    ds_add_u32 v0, v255 offset:42836
    s_mov_b64 exec, -1
    s_waitcnt lgkmcnt(0)
L_nodump0:
    s_nop 0
    v_pk_fma_f32 v[56:57], v[160:161], v[136:137], v[56:57]
    v_pk_fma_f32 v[58:59], v[162:163], v[138:139], v[58:59]
    v_pk_fma_f32 v[60:61], v[164:165], v[140:141], v[60:61]
    v_pk_fma_f32 v[62:63], v[166:167], v[142:143], v[62:63]
    v_cvt_pk_bf16_f32 v16, v56, v57
    v_cvt_pk_bf16_f32 v17, v58, v59
    v_cvt_pk_bf16_f32 v18, v60, v61
    v_cvt_pk_bf16_f32 v19, v62, v63
    ds_write_b128 v208, v[16:19] offset:2048
    ds_read_b128 v[32:35], v199 offset:2048
    s_waitcnt lgkmcnt(2)
    buffer_store_dwordx4 v[24:27], v4, s[16:19], 0 offen sc1
    v_add_f32 v152, v232, v236
    v_sub_f32 v160, v232, v236
    s_cmp_eq_u64 s[64:65], 0
    s_cbranch_scc1 L_nodump1
    s_mov_b64 exec, s[56:57]
    ds_write_b128 v6, v[152:155] offset:42624
    ds_write_b128 v6, v[156:159] offset:42640
    s_mov_b64 exec, s[60:61]
    ds_write_b128 v6, v[160:163] offset:42624
    ds_write_b128 v6, v[164:167] offset:42640
    s_mov_b64 exec, 1
    ds_add_u32 v0, v255 offset:42864
    s_mov_b64 exec, -1
    s_waitcnt lgkmcnt(0)
L_nodump1:
    v_pk_fma_f32 v[48:49], v[152:153], v[128:129], v[48:49]
    v_pk_fma_f32 v[50:51], v[154:155], v[130:131], v[50:51]
    v_pk_fma_f32 v[52:53], v[156:157], v[132:133], v[52:53]
    v_pk_fma_f32 v[54:55], v[158:159], v[134:135], v[54:55]
    v_cvt_pk_bf16_f32 v12, v48, v55
    v_cvt_pk_bf16_f32 v13, v54, v53
    v_cvt_pk_bf16_f32 v14, v52, v51
    v_cvt_pk_bf16_f32 v15, v50, v49
    ds_write_b128 v208, v[12:15] offset:1024
    ds_read_b128 v[28:31], v199 offset:1024
    s_waitcnt lgkmcnt(2)
    s_nop 0
    buffer_store_dwordx4 v[32:35], v249, s[16:19], 0 offen sc1
    v_pk_fma_f32 v[64:65], v[160:161], v[144:145], v[64:65]
    v_pk_fma_f32 v[66:67], v[162:163], v[146:147], v[66:67]
    v_pk_fma_f32 v[68:69], v[164:165], v[148:149], v[68:69]
    v_pk_fma_f32 v[70:71], v[166:167], v[150:151], v[70:71]
    v_cvt_pk_bf16_f32 v20, v64, v71
    v_cvt_pk_bf16_f32 v21, v70, v69
    v_cvt_pk_bf16_f32 v22, v68, v67
    v_cvt_pk_bf16_f32 v23, v66, v65
    ds_write_b128 v208, v[20:23] offset:3072
    ds_read_b128 v[36:39], v199 offset:3072
    s_waitcnt lgkmcnt(2)
    buffer_store_dwordx4 v[28:31], v5, s[16:19], 0 offen sc1
    s_waitcnt lgkmcnt(0)
    buffer_store_dwordx4 v[36:39], v205, s[16:19], 0 offen sc1
    s_branch L_fin
L_dma_done:
    s_setprio 0
    s_lshr_b32 s31, s47, 2
    s_andn2_b32 s31, s31, s75
    s_add_u32 s50, s31, s46
    s_lshl_b32 s31, s50, 17
    s_bfe_u32 s32, s2, 0x20003
    s_lshl_b32 s32, s32, 2
    s_add_u32 s51, s32, s30
    s_lshl_b32 s32, s51, 7
    s_add_u32 s31, s31, s32
    v_lshrrev_b32 v6, 3, v2
    v_lshlrev_b32 v6, 11, v6
    v_and_b32 v7, 0x70, v3
    v_and_b32 v11, 16, v2
    v_lshlrev_b32 v11, 1, v11
    v_xor_b32 v11, v11, v7
    v_add3_u32 v6, v6, v11, s31
    v_xor_b32 v11, 64, v6
    s_lshl_b32 s74, s30, 13
    s_cmp_lt_u32 s30, 2
    s_mov_b32 s31, 125952
    s_cselect_b32 s31, 60416, s31
    s_add_u32 s74, s74, s31
    s_mov_b32 s60, 4096
    s_mov_b32 s61, 8192
    s_mov_b32 s62, 12288
    v_bfe_u32 v8, v2, 2, 3
    v_lshlrev_b32 v9, 5, v8
    s_lshl_b32 s31, s30, 6
    v_xor_b32 v9, s31, v9
    v_bfe_u32 v8, v2, 2, 2
    v_lshl_add_u32 v9, v8, 8, v9
    v_lshrrev_b32 v8, 4, v2
    v_lshl_add_u32 v9, v8, 11, v9
    v_and_b32 v10, 3, v2
    v_lshl_add_u32 v9, v10, 3, v9
    v_add_u32 v9, 76800, v9
    v_xor_b32 v10, 32, v9
    v_lshlrev_b32 v8, 4, v8
    s_lshr_b32 s31, s30, 1
    s_and_b32 s32, s31, s75
    s_lshl_b32 s32, s32, 8
    v_add_u32 v8, s32, v8
    s_cmp_eq_u32 s75, 0
    s_cselect_b32 s32, 12, 9
    s_lshl_b32 s31, s31, s32
    s_lshl_b32 s32, s46, 3
    s_add_u32 s32, s32, s47
    s_lshl_b32 s32, s32, 9
    s_add_u32 s31, s31, s32
    s_and_b32 s32, s30, 1
    s_lshl_b32 s32, s32, 8
    s_add_u32 s31, s31, s32
    s_add_u32 s31, s31, 262144
    v_lshl_add_u32 v13, v2, 3, s31
    s_waitcnt lgkmcnt(0)
    s_add_u32 s28, s28, 0x7f4a7c15
    s_addc_u32 s29, s29, 0x9e3779b9
    s_and_b32 s31, s28, 0xff
    v_mov_b32 v14, s31
    s_mov_b32 s49, 0xffffff00
    s_cmp_lg_u32 s30, 2
    s_cbranch_scc1 L_no_tlb
    s_mov_b32 s52, s44
    s_mov_b32 s53, s45
    s_mov_b32 s54, 0x400000
    s_mov_b32 s55, 0x00020000
    v_lshlrev_b32 v250, 18, v2
    v_min_u32 v250, 0x3ffffc, v250
    s_mov_b32 exec_lo, 0x1ffff
    s_mov_b32 exec_hi, 0x0
    buffer_load_dword v252, v250, s[52:55], 0 offen
    s_mov_b64 exec, 0x3f
    v_lshlrev_b32 v250, 20, v2
    v_add_u32 v250, 753664, v250
    v_min_u32 v250, 4491392, v250
    buffer_load_dword v251, v250, s[12:15], 0 offen
    s_mov_b64 exec, 3
    v_mul_u32_u24 v250, 0x1f800, v2
    v_add_u32 v250, v250, v6
    buffer_load_dword v253, v250, s[24:27], 0 offen
    s_mov_b64 exec, -1
L_no_tlb:
    s_cmp_lg_u32 s66, 0
    s_cbranch_scc1 L_tagged
    s_mov_b64 exec, 1
    ds_add_u32 v0, v255 offset:42872
    s_mov_b64 exec, -1
L_tagged:
    s_cmp_eq_u32 s30, 3
    s_cbranch_scc1 L_h1
    s_cmp_eq_u32 s66, 0
    s_cbranch_scc1 L_key
    s_cmp_lg_u32 s30, 0
    s_cbranch_scc1 L_follower
    s_setprio 3
    s_waitcnt vmcnt(16)
    s_mov_b64 exec, 1
    ds_add_u32 v0, v255 offset:42868
    s_mov_b64 exec, -1
    s_nop 0
    ds_read_b64_tr_b16 v[36:37], v9 offset:0
    ds_read_b64_tr_b16 v[38:39], v9 offset:1024
    ds_read_b64_tr_b16 v[40:41], v10 offset:0
    ds_read_b64_tr_b16 v[42:43], v10 offset:1024
    ds_read_b64_tr_b16 v[44:45], v9 offset:32768
    ds_read_b64_tr_b16 v[46:47], v9 offset:33792
    ds_read_b64_tr_b16 v[48:49], v10 offset:32768
    ds_read_b64_tr_b16 v[50:51], v10 offset:33792
    ds_read_b64_tr_b16 v[52:53], v9 offset:8192
    ds_read_b64_tr_b16 v[54:55], v9 offset:9216
    ds_read_b64_tr_b16 v[56:57], v10 offset:8192
    ds_read_b64_tr_b16 v[58:59], v10 offset:9216
    ds_read_b64_tr_b16 v[60:61], v9 offset:40960
    ds_read_b64_tr_b16 v[62:63], v9 offset:41984
    s_waitcnt lgkmcnt(12)
    ds_read_b64_tr_b16 v[64:65], v10 offset:40960
    ds_read_b64_tr_b16 v[66:67], v10 offset:41984
    s_waitcnt lgkmcnt(12)
    ds_read_b64_tr_b16 v[68:69], v9 offset:16384
    ds_read_b64_tr_b16 v[70:71], v9 offset:17408
    s_waitcnt lgkmcnt(12)
    ds_read_b64_tr_b16 v[72:73], v10 offset:16384
    ds_read_b64_tr_b16 v[74:75], v10 offset:17408
    s_waitcnt lgkmcnt(12)
    ds_read_b64_tr_b16 v[76:77], v9 offset:49152
    ds_read_b64_tr_b16 v[78:79], v9 offset:50176
    s_waitcnt lgkmcnt(12)
    ds_read_b64_tr_b16 v[80:81], v10 offset:49152
    ds_read_b64_tr_b16 v[82:83], v10 offset:50176
    s_waitcnt vmcnt(8)
    s_mov_b64 exec, 1
    ds_add_u32 v0, v255 offset:42868
    s_mov_b64 exec, -1
    s_branch L_d_first
L_follower:
    v_readfirstlane_b32 s52, v13
    s_and_b32 s32, s30, 1
    s_lshl_b32 s32, s32, 8
    s_sub_u32 s52, s52, s32
    s_lshl_b32 s31, s50, 12
    s_sub_u32 s31, s31, s32
    s_lshl_b32 s32, s51, 8
    s_add_u32 s31, s31, s32
    s_add_u32 s53, s31, 524288
    s_load_dword s54, s[12:13], s52
    s_load_dword s54, s[12:13], s53
    s_add_u32 s52, s52, 64
    s_add_u32 s53, s53, 64
    s_load_dword s54, s[12:13], s52
    s_load_dword s54, s[12:13], s53
    s_add_u32 s52, s52, 64
    s_add_u32 s53, s53, 64
    s_load_dword s54, s[12:13], s52
    s_load_dword s54, s[12:13], s53
    s_add_u32 s52, s52, 64
    s_add_u32 s53, s53, 64
    s_load_dword s54, s[12:13], s52
    s_load_dword s54, s[12:13], s53
    s_add_u32 s52, s52, 64
    s_add_u32 s53, s53, 64
    s_waitcnt lgkmcnt(0)
    s_load_dword s54, s[12:13], s52
    s_load_dword s54, s[12:13], s53
    s_add_u32 s52, s52, 64
    s_add_u32 s53, s53, 64
    s_load_dword s54, s[12:13], s52
    s_load_dword s54, s[12:13], s53
    s_add_u32 s52, s52, 64
    s_add_u32 s53, s53, 64
    s_load_dword s54, s[12:13], s52
    s_load_dword s54, s[12:13], s53
    s_add_u32 s52, s52, 64
    s_add_u32 s53, s53, 64
    s_load_dword s54, s[12:13], s52
    s_load_dword s54, s[12:13], s53
L_sync9:
    ds_read_b32 v1, v0 offset:42868
    s_add_u32 s92, s92, 1
    s_bitcmp1_b32 s92, 20
    s_cbranch_scc1 L_sync9x
    s_waitcnt lgkmcnt(0)
    v_readfirstlane_b32 s31, v1
    s_nop 0
    s_cmp_ge_u32 s31, 1
    s_cbranch_scc0 L_sync9
L_sync9x:
    s_setprio 3
    s_nop 0
    ds_read_b64_tr_b16 v[36:37], v9 offset:0
    ds_read_b64_tr_b16 v[38:39], v9 offset:1024
    ds_read_b64_tr_b16 v[40:41], v10 offset:0
    ds_read_b64_tr_b16 v[42:43], v10 offset:1024
    ds_read_b64_tr_b16 v[44:45], v9 offset:32768
    ds_read_b64_tr_b16 v[46:47], v9 offset:33792
    ds_read_b64_tr_b16 v[48:49], v10 offset:32768
    ds_read_b64_tr_b16 v[50:51], v10 offset:33792
    ds_read_b64_tr_b16 v[52:53], v9 offset:8192
    ds_read_b64_tr_b16 v[54:55], v9 offset:9216
    ds_read_b64_tr_b16 v[56:57], v10 offset:8192
    ds_read_b64_tr_b16 v[58:59], v10 offset:9216
    ds_read_b64_tr_b16 v[60:61], v9 offset:40960
    ds_read_b64_tr_b16 v[62:63], v9 offset:41984
    s_waitcnt lgkmcnt(12)
    ds_read_b64_tr_b16 v[64:65], v10 offset:40960
    ds_read_b64_tr_b16 v[66:67], v10 offset:41984
    s_waitcnt lgkmcnt(12)
    ds_read_b64_tr_b16 v[68:69], v9 offset:16384
    ds_read_b64_tr_b16 v[70:71], v9 offset:17408
    s_waitcnt lgkmcnt(12)
    ds_read_b64_tr_b16 v[72:73], v10 offset:16384
    ds_read_b64_tr_b16 v[74:75], v10 offset:17408
    s_waitcnt lgkmcnt(12)
    ds_read_b64_tr_b16 v[76:77], v9 offset:49152
    ds_read_b64_tr_b16 v[78:79], v9 offset:50176
    s_waitcnt lgkmcnt(12)
    ds_read_b64_tr_b16 v[80:81], v10 offset:49152
    ds_read_b64_tr_b16 v[82:83], v10 offset:50176
    s_add_u32 s67, s30, 0
L_sync10:
    ds_read_b32 v1, v0 offset:42868
    s_add_u32 s92, s92, 1
    s_bitcmp1_b32 s92, 20
    s_cbranch_scc1 L_sync10x
    s_waitcnt lgkmcnt(0)
    v_readfirstlane_b32 s31, v1
    s_nop 0
    s_cmp_ge_u32 s31, s67
    s_cbranch_scc0 L_sync10
L_sync10x:
L_d_first:
    s_add_u32 m0, s74, 0
    s_mov_b32 s31, 0
    buffer_load_dwordx4 v6, s[24:27], s31 offen nt lds
    s_add_u32 m0, s74, 1024
    s_mov_b32 s31, 16384
    buffer_load_dwordx4 v11, s[24:27], s31 offen nt lds
    s_add_u32 m0, s74, 2048
    s_mov_b32 s31, 32768
    buffer_load_dwordx4 v6, s[24:27], s31 offen nt lds
    s_add_u32 m0, s74, 3072
    s_mov_b32 s31, 49152
    buffer_load_dwordx4 v11, s[24:27], s31 offen nt lds
    s_add_u32 m0, s74, 4096
    s_mov_b32 s31, 65536
    buffer_load_dwordx4 v6, s[24:27], s31 offen nt lds
    s_cmp_lg_u32 s30, 0
    s_cbranch_scc1 L_k3_waitp
    s_waitcnt vmcnt(5)
    s_mov_b64 exec, 1
    ds_add_u32 v0, v255 offset:42868
    s_mov_b64 exec, -1
L_k3_waitp:
    s_waitcnt lgkmcnt(4)
    s_branch L_sync11a
L_sync11:
    s_waitcnt lgkmcnt(0)
L_sync11a:
    ds_read_b32 v1, v0 offset:42868
    ds_read_b64_tr_b16 v[84:85], v9 offset:24576
    ds_read_b64_tr_b16 v[86:87], v9 offset:25600
    ds_read_b64_tr_b16 v[88:89], v10 offset:24576
    ds_read_b64_tr_b16 v[90:91], v10 offset:25600
    ds_read_b64_tr_b16 v[92:93], v9 offset:57344
    ds_read_b64_tr_b16 v[94:95], v9 offset:58368
    ds_read_b64_tr_b16 v[96:97], v10 offset:57344
    ds_read_b64_tr_b16 v[98:99], v10 offset:58368
    s_add_u32 s92, s92, 1
    s_bitcmp1_b32 s92, 20
    s_cbranch_scc1 L_sync11x
    s_waitcnt lgkmcnt(8)
    v_readfirstlane_b32 s31, v1
    s_nop 0
    s_cmp_ge_u32 s31, 3
    s_cbranch_scc0 L_sync11
L_sync11x:
L_key:
    s_waitcnt lgkmcnt(0)
L_sync12:
    ds_read_b32 v1, v0 offset:42844
    ds_read_b64 v[18:19], v0 offset:41552
    ds_read_b128 v[20:23], v8 offset:41600
    ds_read_b128 v[24:27], v8 offset:41664
    ds_read_b128 v[28:31], v8 offset:41728
    ds_read_b128 v[32:35], v8 offset:41792
    s_add_u32 s92, s92, 1
    s_bitcmp1_b32 s92, 20
    s_cbranch_scc1 L_sync12x
    s_waitcnt lgkmcnt(5)
    v_readfirstlane_b32 s31, v1
    s_nop 0
    s_cmp_ge_u32 s31, 1
    s_cbranch_scc0 L_sync12
L_sync12x:
    s_cmp_eq_u32 s66, 0
    s_cbranch_scc1 L_idle
    s_branch L_xs_ok
L_h1:
    s_mov_b32 s63, 4096
    s_lshl_b32 s31, s47, 8
    v_lshlrev_b32 v15, 3, v2
    v_add_u32 v16, s31, v15
    s_cmp_lg_u32 s66, 0
    s_cbranch_scc1 L_gate
L_sync13:
    ds_read_b32 v1, v0 offset:42828
    s_add_u32 s92, s92, 1
    s_bitcmp1_b32 s92, 20
    s_cbranch_scc1 L_sync13x
    s_waitcnt lgkmcnt(0)
    v_readfirstlane_b32 s31, v1
    s_nop 0
    s_cmp_ge_u32 s31, 4
    s_cbranch_scc0 L_sync13
L_sync13x:
    s_branch L_gate_open
L_gate:
L_sync14:
    ds_read_b32 v1, v0 offset:42824
    s_add_u32 s92, s92, 1
    s_bitcmp1_b32 s92, 20
    s_cbranch_scc1 L_sync14x
    s_waitcnt lgkmcnt(0)
    v_readfirstlane_b32 s31, v1
    s_nop 0
    s_cmp_ge_u32 s31, 4
    s_cbranch_scc0 L_sync14
L_sync14x:
L_gate_open:
    s_setprio 3
    buffer_load_dwordx4 v[20:23], v3, s[12:15], s63 offen offset:0 sc1
    buffer_load_dwordx4 v[24:27], v3, s[12:15], s63 offen offset:1024 sc1
    buffer_load_dwordx4 v[28:31], v3, s[12:15], s63 offen offset:2048 sc1
    buffer_load_dwordx4 v[32:35], v3, s[12:15], s63 offen offset:3072 sc1
    s_mov_b64 exec, 1
    ds_add_u32 v0, v255 offset:42860
    s_mov_b64 exec, -1
    s_waitcnt vmcnt(0)
L_mi_check:
    v_cmp_ne_u64 s[52:53], s[28:29], v[22:23]
    v_cmp_ne_u64 s[54:55], s[28:29], v[26:27]
    v_cmp_ne_u64 s[56:57], s[28:29], v[30:31]
    v_cmp_ne_u64 s[58:59], s[28:29], v[34:35]
    v_max_u32 v18, v21, v25
    v_max3_u32 v18, v18, v29, v33
    s_or_b64 s[64:65], s[52:53], s[54:55]
    s_or_b64 vcc, s[56:57], s[58:59]
    s_or_b64 s[64:65], s[64:65], vcc
    s_cbranch_scc0 L_mi_got
    s_cmp_eq_u32 s35, 0
    s_cbranch_scc1 L_mi_got
    s_sub_u32 s35, s35, 1
    s_sleep 2
    s_mov_b64 exec, s[52:53]
    s_cbranch_execz L_mi_skip0
    buffer_load_dwordx4 v[20:23], v3, s[12:15], s63 offen offset:0 sc1
L_mi_skip0:
    s_mov_b64 exec, s[54:55]
    s_cbranch_execz L_mi_skip1
    buffer_load_dwordx4 v[24:27], v3, s[12:15], s63 offen offset:1024 sc1
L_mi_skip1:
    s_mov_b64 exec, s[56:57]
    s_cbranch_execz L_mi_skip2
    buffer_load_dwordx4 v[28:31], v3, s[12:15], s63 offen offset:2048 sc1
L_mi_skip2:
    s_mov_b64 exec, s[58:59]
    s_cbranch_execz L_mi_skip3
    buffer_load_dwordx4 v[32:35], v3, s[12:15], s63 offen offset:3072 sc1
L_mi_skip3:
    s_mov_b64 exec, -1
    s_waitcnt vmcnt(0)
    s_branch L_mi_check
L_mi_got:
    v_max_u32_dpp v19, v18, v18 row_ror:1 row_mask:0xf bank_mask:0xf
    s_nop 1
    v_max_u32_dpp v19, v19, v19 row_ror:2 row_mask:0xf bank_mask:0xf
    s_nop 1
    v_max_u32_dpp v19, v19, v19 row_ror:4 row_mask:0xf bank_mask:0xf
    s_nop 1
    v_max_u32_dpp v19, v19, v19 row_ror:8 row_mask:0xf bank_mask:0xf
    s_nop 0
    v_readlane_b32 s33, v19, 0
    v_readlane_b32 s31, v19, 16
    v_readlane_b32 s32, v19, 32
    v_readlane_b32 s34, v19, 48
    s_max_u32 s33, s33, s31
    s_max_u32 s32, s32, s34
    s_max_u32 s33, s33, s32
    s_andn2_b32 s31, 0x7ff, s33
    s_lshl_b32 s48, s31, 11
    buffer_load_dwordx2 v[150:151], v16, s[8:11], s48 offen
    s_mov_b64 exec, 1
    ds_add_u32 v0, v255 offset:42840
    s_mov_b64 exec, -1
    v_cmp_eq_u32 s[52:53], s33, v25
    v_cmp_eq_u32 s[54:55], s33, v29
    v_cmp_eq_u32 s[56:57], s33, v33
    v_cmp_eq_u32 vcc, s33, v18
    v_cndmask_b32 v19, v20, v24, s[52:53]
    v_cndmask_b32 v19, v19, v28, s[54:55]
    v_cndmask_b32 v19, v19, v32, s[56:57]
    s_ff1_i32_b64 s32, vcc
    v_readlane_b32 s34, v19, s32
    v_mov_b32 v19, s33
    s_nop 0
    v_mov_b32 v18, s34
    ds_write_b64 v0, v[18:19] offset:41552
    s_lshl_b32 s52, s34, 16
    s_and_b32 s32, s34, 0xffff0000
    v_rcp_f32 v148, s32
    s_cmp_eq_u32 s66, 0
    s_cbranch_scc1 L_h1_idle
L_sync15:
    ds_read_b32 v1, v0 offset:42868
    s_add_u32 s92, s92, 1
    s_bitcmp1_b32 s92, 20
    s_cbranch_scc1 L_sync15x
    s_waitcnt lgkmcnt(0)
    v_readfirstlane_b32 s31, v1
    s_nop 0
    s_cmp_ge_u32 s31, 1
    s_cbranch_scc0 L_sync15
L_sync15x:
    s_nop 0
    ds_read_b64_tr_b16 v[36:37], v9 offset:0
    ds_read_b64_tr_b16 v[38:39], v9 offset:1024
    ds_read_b64_tr_b16 v[40:41], v10 offset:0
    ds_read_b64_tr_b16 v[42:43], v10 offset:1024
    ds_read_b64_tr_b16 v[44:45], v9 offset:32768
    ds_read_b64_tr_b16 v[46:47], v9 offset:33792
    ds_read_b64_tr_b16 v[48:49], v10 offset:32768
    ds_read_b64_tr_b16 v[50:51], v10 offset:33792
    ds_read_b64_tr_b16 v[52:53], v9 offset:8192
    ds_read_b64_tr_b16 v[54:55], v9 offset:9216
    ds_read_b64_tr_b16 v[56:57], v10 offset:8192
    ds_read_b64_tr_b16 v[58:59], v10 offset:9216
    ds_read_b64_tr_b16 v[60:61], v9 offset:40960
    ds_read_b64_tr_b16 v[62:63], v9 offset:41984
    s_waitcnt lgkmcnt(12)
    ds_read_b64_tr_b16 v[64:65], v10 offset:40960
    ds_read_b64_tr_b16 v[66:67], v10 offset:41984
    s_waitcnt lgkmcnt(12)
    ds_read_b64_tr_b16 v[68:69], v9 offset:16384
    ds_read_b64_tr_b16 v[70:71], v9 offset:17408
    s_waitcnt lgkmcnt(12)
    ds_read_b64_tr_b16 v[72:73], v10 offset:16384
    ds_read_b64_tr_b16 v[74:75], v10 offset:17408
    s_waitcnt lgkmcnt(12)
    ds_read_b64_tr_b16 v[76:77], v9 offset:49152
    ds_read_b64_tr_b16 v[78:79], v9 offset:50176
    s_waitcnt lgkmcnt(12)
    ds_read_b64_tr_b16 v[80:81], v10 offset:49152
    ds_read_b64_tr_b16 v[82:83], v10 offset:50176
    s_waitcnt lgkmcnt(4)
    s_branch L_sync16a
L_sync16:
    s_waitcnt lgkmcnt(0)
L_sync16a:
    ds_read_b32 v1, v0 offset:42868
    ds_read_b64_tr_b16 v[84:85], v9 offset:24576
    ds_read_b64_tr_b16 v[86:87], v9 offset:25600
    ds_read_b64_tr_b16 v[88:89], v10 offset:24576
    ds_read_b64_tr_b16 v[90:91], v10 offset:25600
    ds_read_b64_tr_b16 v[92:93], v9 offset:57344
    ds_read_b64_tr_b16 v[94:95], v9 offset:58368
    ds_read_b64_tr_b16 v[96:97], v10 offset:57344
    ds_read_b64_tr_b16 v[98:99], v10 offset:58368
    s_add_u32 s92, s92, 1
    s_bitcmp1_b32 s92, 20
    s_cbranch_scc1 L_sync16x
    s_waitcnt lgkmcnt(8)
    v_readfirstlane_b32 s31, v1
    s_nop 0
    s_cmp_ge_u32 s31, 3
    s_cbranch_scc0 L_sync16
L_sync16x:
    s_waitcnt vmcnt(0) lgkmcnt(0)
    s_branch L_h1_x
L_h1_idle:
    s_waitcnt vmcnt(0)
L_h1_x:
    v_lshlrev_b32 v20, 16, v150
    v_and_b32 v21, 0xffff0000, v150
    v_lshlrev_b32 v22, 16, v151
    v_and_b32 v23, 0xffff0000, v151
    v_pk_add_f32 v[20:21], v[20:21], s[52:53] op_sel_hi:[1,0] neg_lo:[0,1] neg_hi:[0,1]
    v_pk_add_f32 v[22:23], v[22:23], s[52:53] op_sel_hi:[1,0] neg_lo:[0,1] neg_hi:[0,1]
    v_cvt_pk_bf16_f32 v150, v20, v21
    v_cvt_pk_bf16_f32 v151, v22, v23
    v_lshlrev_b32 v20, 16, v150
    v_and_b32 v21, 0xffff0000, v150
    v_lshlrev_b32 v22, 16, v151
    v_and_b32 v23, 0xffff0000, v151
    v_pk_mul_f32 v[20:21], v[20:21], v[148:149] op_sel_hi:[1,0]
    v_pk_mul_f32 v[22:23], v[22:23], v[148:149] op_sel_hi:[1,0]
    v_cvt_pk_bf16_f32 v150, v20, v21
    v_cvt_pk_bf16_f32 v151, v22, v23
    ds_write_b64 v15, v[150:151] offset:41600
    s_mov_b64 exec, 1
    ds_add_u32 v0, v255 offset:42844
    s_mov_b64 exec, -1
    s_cmp_eq_u32 s66, 0
    s_cbranch_scc1 L_idle
    ds_read_b128 v[20:23], v8 offset:41600
    ds_read_b128 v[24:27], v8 offset:41664
    ds_read_b128 v[28:31], v8 offset:41728
    ds_read_b128 v[32:35], v8 offset:41792
    s_add_u32 m0, s74, 0
    s_mov_b32 s31, 0
    s_nop 0
    buffer_load_dwordx4 v6, s[24:27], s31 offen nt lds
    s_add_u32 m0, s74, 1024
    s_mov_b32 s31, 16384
    buffer_load_dwordx4 v11, s[24:27], s31 offen nt lds
    s_add_u32 m0, s74, 2048
    s_mov_b32 s31, 32768
    buffer_load_dwordx4 v6, s[24:27], s31 offen nt lds
    s_add_u32 m0, s74, 3072
    s_mov_b32 s31, 49152
    buffer_load_dwordx4 v11, s[24:27], s31 offen nt lds
    s_add_u32 m0, s74, 4096
    s_mov_b32 s31, 65536
    buffer_load_dwordx4 v6, s[24:27], s31 offen nt lds
L_xs_ok:
    s_waitcnt lgkmcnt(3)
    v_mfma_f32_16x16x32_bf16 v[132:135], v[20:23], v[36:39], 0
    v_mfma_f32_16x16x32_bf16 v[136:139], v[20:23], v[40:43], 0
    v_mfma_f32_16x16x32_bf16 v[140:143], v[20:23], v[44:47], 0
    v_mfma_f32_16x16x32_bf16 v[144:147], v[20:23], v[48:51], 0
    s_waitcnt lgkmcnt(2)
    v_mfma_f32_16x16x32_bf16 v[132:135], v[24:27], v[52:55], v[132:135]
    v_mfma_f32_16x16x32_bf16 v[136:139], v[24:27], v[56:59], v[136:139]
    v_mfma_f32_16x16x32_bf16 v[140:143], v[24:27], v[60:63], v[140:143]
    v_mfma_f32_16x16x32_bf16 v[144:147], v[24:27], v[64:67], v[144:147]
    s_waitcnt lgkmcnt(1)
    v_mfma_f32_16x16x32_bf16 v[132:135], v[28:31], v[68:71], v[132:135]
    v_mfma_f32_16x16x32_bf16 v[136:139], v[28:31], v[72:75], v[136:139]
    v_mfma_f32_16x16x32_bf16 v[140:143], v[28:31], v[76:79], v[140:143]
    v_mfma_f32_16x16x32_bf16 v[144:147], v[28:31], v[80:83], v[144:147]
    v_readfirstlane_b32 s33, v19
    v_readfirstlane_b32 s34, v18
    s_waitcnt lgkmcnt(0)
    v_mfma_f32_16x16x32_bf16 v[132:135], v[32:35], v[84:87], v[132:135]
    v_mfma_f32_16x16x32_bf16 v[136:139], v[32:35], v[88:91], v[136:139]
    v_mfma_f32_16x16x32_bf16 v[140:143], v[32:35], v[92:95], v[140:143]
    v_mfma_f32_16x16x32_bf16 v[144:147], v[32:35], v[96:99], v[144:147]
    s_mov_b32 vcc_lo, 0xffff0000
    s_mov_b32 vcc_hi, 0
    s_lshl_b32 s31, s50, 12
    s_lshl_b32 s32, s30, 7
    s_add_u32 s31, s31, s32
    s_add_u32 s31, s31, 262144
    v_lshrrev_b32 v15, 3, v2
    v_lshlrev_b32 v15, 9, v15
    v_add3_u32 v15, v15, v7, s31
    v_cndmask_b32 v26, v132, v136, vcc
    v_cndmask_b32 v27, v140, v144, vcc
    v_and_or_b32 v26, v26, s49, v14
    v_and_or_b32 v27, v27, s49, v14
    s_mov_b32 exec_hi, 0
    buffer_store_dwordx2 v[26:27], v13, s[12:15], 0 offen sc1
    s_mov_b64 exec, -1
    s_add_u32 m0, s74, 5120
    s_mov_b32 s31, 81920
    buffer_load_dwordx4 v11, s[24:27], s31 offen nt lds
    s_add_u32 m0, s74, 6144
    s_mov_b32 s31, 98304
    buffer_load_dwordx4 v6, s[24:27], s31 offen nt lds
    s_add_u32 m0, s74, 7168
    s_mov_b32 s31, 114688
    buffer_load_dwordx4 v11, s[24:27], s31 offen nt lds
    s_mov_b64 exec, 1
    ds_add_u32 v0, v255 offset:42848
    s_mov_b64 exec, -1
    s_setprio 3
    v_and_b32 v16, 7, v2
    v_lshlrev_b32 v16, 2, v16
    v_lshrrev_b32 v17, 5, v2
    v_lshl_add_u32 v16, v17, 1, v16
    s_lshl_b32 s31, s30, 5
    v_add_u32 v16, s31, v16
    v_and_b32 v17, 48, v2
    v_bfe_u32 v9, v2, 3, 2
    v_lshlrev_b32 v9, 5, v9
    v_bfe_u32 v10, v2, 2, 2
    v_lshl_add_u32 v9, v10, 7, v9
    v_lshl_add_u32 v9, v17, 6, v9
    v_and_b32 v10, 3, v2
    v_lshlrev_b32 v10, 3, v10
    v_add3_u32 v9, v9, v10, s74
    v_xor_b32 v10, 32, v9
    v_xor_b32 v12, 96, v9
    v_xor_b32 v8, 64, v9
    s_lshl_b32 s31, s50, 12
    s_lshl_b32 s32, s51, 8
    s_add_u32 s31, s31, s32
    s_add_u32 s31, s31, 524288
    v_lshl_add_u32 v18, v2, 2, s31
    s_waitcnt vmcnt(5)
    s_waitcnt lgkmcnt(4)
    ds_read_b64_tr_b16 v[100:101], v9 offset:0
    ds_read_b64_tr_b16 v[102:103], v9 offset:512
    ds_read_b64_tr_b16 v[104:105], v10 offset:0
    ds_read_b64_tr_b16 v[106:107], v10 offset:512
    ds_read_b64_tr_b16 v[108:109], v8 offset:0
    ds_read_b64_tr_b16 v[110:111], v8 offset:512
    ds_read_b64_tr_b16 v[112:113], v12 offset:0
    ds_read_b64_tr_b16 v[114:115], v12 offset:512
    s_waitcnt vmcnt(0)
    buffer_load_dwordx4 v[20:23], v15, s[12:15], 0 offen sc1
    s_waitcnt lgkmcnt(4)
    ds_read_b64_tr_b16 v[116:117], v9 offset:4096
    ds_read_b64_tr_b16 v[118:119], v9 offset:4608
    ds_read_b64_tr_b16 v[120:121], v10 offset:4096
    ds_read_b64_tr_b16 v[122:123], v10 offset:4608
    ds_read_b64_tr_b16 v[124:125], v8 offset:4096
    ds_read_b64_tr_b16 v[126:127], v8 offset:4608
    ds_read_b64_tr_b16 v[128:129], v12 offset:4096
    ds_read_b64_tr_b16 v[130:131], v12 offset:4608
    s_mov_b32 s54, 0
    s_branch L_hp_wait
L_hp_poll:
    buffer_load_dwordx4 v[20:23], v15, s[12:15], 0 offen sc1
L_hp_wait:
    s_waitcnt vmcnt(0)
    v_xor_b32 v20, v14, v20
    v_xor_b32 v21, v14, v21
    v_xor_b32 v22, v14, v22
    v_xor_b32 v23, v14, v23
    v_or3_b32 v24, v20, v21, v22
    v_or_b32 v24, v24, v23
    v_and_b32 v24, 0xff, v24
    v_cmp_ne_u32 vcc, 0, v24
    v_permlane16_swap_b32 v20, v21
    v_permlane16_swap_b32 v22, v23
    s_cbranch_vccz L_hp_got
    s_cmp_eq_u32 s35, 0
    s_cbranch_scc1 L_hp_got
    s_sub_u32 s35, s35, 1
    s_branch L_hp_poll
L_hp_got:
    v_add_f32 v20, v20, v21
    v_add_f32 v22, v22, v23
    s_nop 1
    v_permlane32_swap_b32 v20, v22
    v_add_f32 v20, v20, v22
    s_nop 1
    v_add_f32_dpp v21, v20, v20 row_ror:8 row_mask:0xf bank_mask:0xf
    v_add_f32_dpp v20, v20, v20 row_ror:8 row_mask:0xf bank_mask:0xf
    s_nop 1
    v_permlane16_swap_b32 v20, v21
    v_cvt_pk_bf16_f32 v20, v20, v21
    v_and_b32 v21, 0xffff0000, v20
    v_lshlrev_b32 v20, 16, v20
    v_mul_f32 v22, 0xbfb8aa3b, v20
    v_exp_f32 v22, v22
    s_nop 0
    v_add_f32 v22, 1.0, v22
    v_rcp_f32 v22, v22
    s_nop 0
    v_mul_f32 v20, v20, v22
    v_cvt_pk_bf16_f32 v20, v20, v20
    v_lshlrev_b32 v20, 16, v20
    v_mul_f32 v20, v20, v21
    v_cvt_pk_bf16_f32 v20, v20, v20
    ds_write_b16 v16, v20 offset:42368
    s_mov_b64 exec, 1
    ds_add_u32 v0, v255 offset:42852
    s_mov_b64 exec, -1
L_sync17:
    ds_read_b32 v1, v0 offset:42852
    ds_read_b128 v[28:31], v17 offset:42368
    ds_read_b128 v[32:35], v17 offset:42432
    s_add_u32 s92, s92, 1
    s_bitcmp1_b32 s92, 20
    s_cbranch_scc1 L_sync17x
    s_waitcnt lgkmcnt(2)
    v_readfirstlane_b32 s31, v1
    s_nop 0
    s_cmp_ge_u32 s31, 4
    s_cbranch_scc0 L_sync17
L_sync17x:
    s_waitcnt lgkmcnt(1)
    v_mfma_f32_16x16x32_bf16 v[36:39], v[28:31], v[100:103], 0
    v_mfma_f32_16x16x32_bf16 v[40:43], v[28:31], v[104:107], 0
    v_mfma_f32_16x16x32_bf16 v[44:47], v[28:31], v[108:111], 0
    v_mfma_f32_16x16x32_bf16 v[48:51], v[28:31], v[112:115], 0
    s_waitcnt lgkmcnt(0)
    v_mfma_f32_16x16x32_bf16 v[36:39], v[32:35], v[116:119], v[36:39]
    v_mfma_f32_16x16x32_bf16 v[40:43], v[32:35], v[120:123], v[40:43]
    v_mfma_f32_16x16x32_bf16 v[44:47], v[32:35], v[124:127], v[44:47]
    v_mfma_f32_16x16x32_bf16 v[48:51], v[32:35], v[128:131], v[48:51]
    s_mov_b32 vcc_lo, 0xffff0000
    s_mov_b32 vcc_hi, 0xffff0000
    s_mov_b32 s52, 0
    s_mov_b32 s53, -1
    s_nop 1
    v_cndmask_b32 v36, v36, v40, vcc
    s_nop 0
    v_cndmask_b32 v44, v44, v48, vcc
    v_cndmask_b32 v36, v36, v44, s[52:53]
    v_and_or_b32 v36, v36, s49, v14
    buffer_store_dword v36, v18, s[12:15], 0 offen sc1
    s_mov_b64 exec, 1
    ds_add_u32 v0, v255 offset:42856
    s_mov_b64 exec, -1
    s_branch L_owner
L_idle:
    s_mov_b64 exec, 1
    ds_add_u32 v0, v255 offset:42868
    s_mov_b64 exec, -1
    s_mov_b64 exec, 1
    ds_add_u32 v0, v255 offset:42848
    s_mov_b64 exec, -1
    s_mov_b64 exec, 1
    ds_add_u32 v0, v255 offset:42852
    s_mov_b64 exec, -1
    s_mov_b64 exec, 1
    ds_add_u32 v0, v255 offset:42856
    s_mov_b64 exec, -1
    s_waitcnt lgkmcnt(0)
    v_readfirstlane_b32 s33, v19
    v_readfirstlane_b32 s34, v18
L_owner:
    s_setprio 1
    s_and_b32 s31, s2, 7
    s_sub_u32 s32, 8, s31
    s_min_u32 s46, s31, s32
    s_lshr_b32 s53, s31, 2
    s_lshr_b32 s47, s2, 3
    s_and_b32 s32, s47, 1
    s_and_b32 s31, s31, 3
    s_cselect_b32 s53, s53, s32
    s_cselect_b32 s31, 0, 1
    s_lshr_b32 s47, s47, s31
    s_lshl_b32 s53, s53, 4
    s_lshl_b32 s53, s53, 3
    s_add_u32 s53, s53, s46
    s_andn2_b32 s51, 0x7ff, s33
    s_mov_b32 s54, s51
    s_mov_b32 s55, 0
    s_mov_b32 s56, 0
    s_mov_b32 s16, s44
    s_mov_b32 s17, s45
    s_mov_b32 s18, 0x400000
    v_and_b32 v8, 31, v2
    v_lshlrev_b32 v15, 2, v8
    v_lshlrev_b32 v8, 1, v8
    v_mov_b32 v16, 0
L_seg:
    s_xor_b32 s31, s54, s53
    s_and_b32 s31, s31, 0x87
    s_cbranch_scc1 L_seg_next
    s_lshl_b32 s31, s51, 11
    s_lshl_b32 s32, s47, 6
    s_add_u32 s63, s31, s32
    buffer_load_ushort v9, v8, s[8:11], s63 offen
    v_lshrrev_b32 v4, 3, v2
    s_lshl_b32 s31, s30, 4
    v_add_u32 v4, s31, v4
    v_lshlrev_b32 v4, 12, v4
    s_lshl_b32 s31, s47, 7
    s_add_u32 s31, s31, 524288
    v_add3_u32 v4, v4, v7, s31
    s_mov_b32 s62, 32768
    v_mov_b32 v24, v14
    v_mov_b32 v25, v14
    v_mov_b32 v26, v14
    v_mov_b32 v27, v14
    v_lshrrev_b32 v5, 4, v2
    v_lshl_add_u32 v6, v5, 2, v7
    s_lshl_b32 s31, s30, 7
    s_add_u32 s31, s31, s55
    v_add_u32 v6, s31, v6
    s_ashr_i32 s31, s33, 31
    s_orn2_b32 s31, 0x80000000, s31
    s_xor_b32 s31, s31, s33
    s_and_b32 s31, s31, 0xfffff800
    v_cvt_pk_bf16_f32 v11, s31, s31
    v_lshlrev_b32 v11, 16, v11
    v_mul_f32 v11, 0xbfb8aa3b, v11
    v_exp_f32 v11, v11
    s_and_b32 s32, s34, 0xffff0000
    v_add_f32 v11, 1.0, v11
    v_rcp_f32 v11, v11
    v_rcp_f32 v12, s32
    v_cvt_pk_bf16_f32 v11, v11, v11
    v_lshlrev_b32 v11, 16, v11
    s_lshl_b32 s31, s34, 16
    s_waitcnt vmcnt(0)
    v_lshl_add_u32 v13, v8, 1, s55
    s_mov_b64 vcc, -1
    s_mov_b32 s56, 1
L_y_poll:
    s_mov_b64 exec, vcc
    buffer_load_dwordx4 v[20:23], v4, s[12:15], 0 offen sc1
    s_cmp_eq_u32 s30, 3
    s_cbranch_scc1 L_y_one
    buffer_load_dwordx4 v[24:27], v4, s[12:15], s62 offen sc1
L_y_one:
    s_mov_b64 exec, -1
    s_waitcnt vmcnt(0)
    v_xor_b32 v28, v14, v20
    v_xor_b32 v29, v14, v21
    v_xor_b32 v30, v14, v22
    v_xor_b32 v31, v14, v23
    v_xor_b32 v32, v14, v24
    v_xor_b32 v33, v14, v25
    v_xor_b32 v34, v14, v26
    v_xor_b32 v35, v14, v27
    v_or3_b32 v1, v28, v29, v30
    v_or3_b32 v1, v1, v31, v32
    v_or3_b32 v1, v1, v33, v34
    v_or_b32 v1, v1, v35
    v_and_b32 v1, 0xff, v1
    v_cmp_ne_u32 vcc, 0, v1
    v_pk_add_f32 v[28:29], v[28:29], v[32:33]
    v_pk_add_f32 v[30:31], v[30:31], v[34:35]
    s_cbranch_vccz L_y_got
    s_cmp_eq_u32 s35, 0
    s_cbranch_scc1 L_y_got
    s_sub_u32 s35, s35, 1
    s_branch L_y_poll
L_y_got:
    v_permlane16_swap_b32 v28, v29
    v_permlane16_swap_b32 v30, v31
    v_add_f32 v28, v28, v29
    v_add_f32 v30, v30, v31
    s_nop 1
    v_permlane32_swap_b32 v28, v30
    v_add_f32 v28, v28, v30
    s_nop 1
    v_add_f32_dpp v28, v28, v28 row_ror:8 row_mask:0xf bank_mask:0xf
    ds_write_b32 v6, v28 offset:43008
    s_mov_b64 exec, 1
    ds_add_u32 v16, v255 offset:42836
    s_mov_b64 exec, -1
    s_cmp_lg_u32 s30, 0
    s_cbranch_scc1 L_seg_next
    s_cmp_eq_u32 s47, 0
    s_cselect_b32 s32, 0, 2147483392
    v_mov_b32 v5, 2147483392
    v_writelane_b32 v5, s32, 0
    v_mov_b32 v18, s28
    v_mov_b32 v19, s29
    s_lshl_b32 s31, s34, 16
    v_lshlrev_b32 v9, 16, v9
    v_subrev_f32 v10, s31, v9
    v_cvt_pk_bf16_f32 v10, v10, v10
    v_lshlrev_b32 v10, 16, v10
    v_mul_f32 v10, v10, v12
    v_cvt_pk_bf16_f32 v10, v10, v10
    v_lshlrev_b32 v10, 16, v10
L_sync18:
    ds_read_b32 v1, v16 offset:42836
    ds_read_b32 v20, v13 offset:43008
    ds_read_b32 v21, v13 offset:43136
    ds_read_b32 v22, v13 offset:43264
    ds_read_b32 v23, v13 offset:43392
    ds_read_b32 v24, v15 offset:42496
    s_add_u32 s92, s92, 1
    s_bitcmp1_b32 s92, 20
    s_cbranch_scc1 L_sync18x
    s_waitcnt lgkmcnt(5)
    v_readfirstlane_b32 s31, v1
    s_nop 0
    s_cmp_ge_u32 s31, 5
    s_cbranch_scc0 L_sync18
L_sync18x:
    s_waitcnt lgkmcnt(0)
    v_add_f32 v20, v20, v21
    v_add_f32 v22, v22, v23
    v_add_f32 v20, v20, v22
    v_cvt_pk_bf16_f32 v20, v20, v20
    v_lshlrev_b32 v20, 16, v20
    v_mul_f32 v20, v20, v11
    v_cvt_pk_bf16_f32 v20, v20, v20
    v_lshlrev_b32 v20, 16, v20
    v_add_f32 v20, v20, v10
    v_cvt_pk_bf16_f32 v20, v20, v20
    v_lshlrev_b32 v20, 16, v20
    v_mul_f32 v1, 0xbfb8aa3b, v20
    v_mul_f32 v20, v1, v24
    v_exp_f32 v1, v1
    s_nop 0
    v_add_f32 v1, 1.0, v1
    v_rcp_f32 v1, v1
    s_mov_b32 exec_hi, 0
    v_fma_f32 v20, v20, v1, v9
    v_cvt_pk_bf16_f32 v20, v20, v20
    buffer_store_short v20, v8, s[16:19], s63 offen sc1
    buffer_store_dwordx2 v[18:19], v5, s[12:15], 0 offen sc1
    s_mov_b64 exec, -1
L_seg_next:
    s_cmp_lg_u32 s55, 0
    s_cbranch_scc1 L_seg_end
    s_mov_b32 s55, 512
    s_sub_u32 s54, 0, s51
    s_sub_u32 s47, 31, s47
    v_mov_b32 v16, 28
    v_and_b32 v15, 24, v2
    v_xor_b32 v15, 24, v15
    v_sub_u32 v1, 0, v2
    v_and_b32 v1, 7, v1
    v_add_u32 v15, v15, v1
    v_lshlrev_b32 v15, 2, v15
    v_add_u32 v15, 128, v15
    s_branch L_seg
L_seg_end:
L_fin:
L_exit:
    s_endpgm
L_code_end:
.section .rodata,"a"
.p2align 6
.amdhsa_kernel recurrent_scan__spectral_fnet__moe_arch_mod__prompt_kernel
  .amdhsa_next_free_vgpr 256
  .amdhsa_next_free_sgpr 94
  .amdhsa_accum_offset 256
  .amdhsa_group_segment_fixed_size 0
  .amdhsa_kernarg_size 104
  .amdhsa_user_sgpr_count 2
  .amdhsa_user_sgpr_kernarg_segment_ptr 1
  .amdhsa_system_sgpr_workgroup_id_x 1
  .amdhsa_float_denorm_mode_32 3
.end_amdhsa_kernel
```

```asm
; @launch grid=(256,1,1) block=(512,1,1) lds=158720
.amdgcn_target "amdgcn-amd-amdhsa--gfx950"
.text
.globl recurrent_scan__spectral_fnet__moe_arch_mod__prompt_kernel
.p2align 8
.type recurrent_scan__spectral_fnet__moe_arch_mod__prompt_kernel,@function
recurrent_scan__spectral_fnet__moe_arch_mod__prompt_kernel:
    s_cmp_ge_u32 s2, 256
    s_cbranch_scc1 L_exit
    s_load_dwordx2 s[8:9], s[0:1], 0
    s_load_dwordx4 s[36:39], s[0:1], 48
    s_load_dwordx2 s[12:13], s[0:1], 96
    s_getpc_b64 s[32:33]
L_pc:
    s_bfe_u32 s31, s2, 0x30003
    v_subrev_u32 v3, 492, v0
    v_lshl_add_u32 v3, v3, 3, s31
    v_lshlrev_b32 v3, 7, v3
    v_cmp_gt_u32 vcc, L_code_end-L_pc, v3
    s_nop 0
    s_and_saveexec_b64 s[46:47], vcc
    s_cbranch_execz L_nopf
    global_load_dword v254, v3, s[32:33]
L_nopf:
    s_mov_b64 exec, -1
    v_lshrrev_b32 v1, 6, v0
    v_and_b32 v2, 63, v0
    v_readfirstlane_b32 s30, v1
    s_mov_b32 s10, 0x400000
    s_mov_b32 s11, 0x00020000
    s_mov_b32 s14, 0x10000000
    s_mov_b32 s15, 0x00020000
    s_mov_b32 s35, 65536
    s_mov_b32 s92, 0
    v_lshlrev_b32 v3, 4, v2
    v_mov_b32 v0, 0
    v_mov_b32 v255, 1
    s_mov_b32 s3, s30
    s_and_b32 s30, s30, 3
    s_cmp_ge_u32 s3, 4
    s_cbranch_scc1 L_moe
    s_and_b32 s31, s2, 7
    s_lshr_b32 s32, s2, 4
    s_sub_u32 s32, 15, s32
    s_lshl_b32 s32, s32, 3
    s_add_u32 s46, s32, s31
    s_bfe_u32 s47, s2, 0x10003
    s_lshl_b32 s31, s47, 2
    s_add_u32 s51, s31, s30
    s_lshl_b32 s31, s51, 8
    s_add_u32 s52, s31, s46
    s_xor_b32 s54, s52, 1024
    s_sub_u32 s53, 2048, s52
    s_add_u32 s31, s52, 128
    s_cmp_eq_u32 s46, 0
    s_cselect_b32 s53, s31, s53
    s_cselect_b32 s50, 1, 0
    s_xor_b32 s55, s53, 1024
    s_lshl_b32 s56, s52, 11
    s_lshl_b32 s57, s53, 11
    s_lshl_b32 s58, s54, 11
    s_lshl_b32 s59, s55, 11
    s_mov_b32 s22, 2048
    s_mov_b32 s23, 0x00020000
    v_mov_b32 v1, 0
    v_and_b32 v6, 15, v2
    v_lshlrev_b32 v6, 2, v6
    ds_write_b64 v0, v[0:1] offset:41504
    ds_write_b32 v6, v0 offset:42816
    s_waitcnt lgkmcnt(0)
    s_load_dwordx2 s[28:29], s[12:13], 0
    s_load_dwordx2 s[16:17], s[0:1], 80
    buffer_load_dwordx4 v[120:123], v3, s[8:11], s56 offen
    buffer_load_dwordx4 v[124:127], v3, s[8:11], s56 offen offset:1024
    buffer_load_dwordx4 v[128:131], v3, s[8:11], s57 offen
    buffer_load_dwordx4 v[132:135], v3, s[8:11], s57 offen offset:1024
    s_mov_b32 s20, s36
    s_mov_b32 s21, s37
    buffer_load_dwordx4 v[152:155], v3, s[20:23], 0 offen
    buffer_load_dwordx4 v[156:159], v3, s[20:23], 0 offen offset:1024
    buffer_load_dwordx4 v[136:139], v3, s[8:11], s58 offen
    buffer_load_dwordx4 v[140:143], v3, s[8:11], s58 offen offset:1024
    buffer_load_dwordx4 v[144:147], v3, s[8:11], s59 offen
    buffer_load_dwordx4 v[148:151], v3, s[8:11], s59 offen offset:1024
    s_barrier
    s_branch L_dft_rest
L_moe:
    s_load_dwordx2 s[20:21], s[0:1], 64
    s_and_b32 s32, s2, 7
    s_mul_i32 s32, s32, 28
    s_lshr_b32 s31, s2, 3
    s_add_u32 s31, s31, s32
    s_lshr_b32 s46, s31, 3
    s_lshl_b32 s46, s46, 1
    s_and_b32 s47, s31, 7
    s_mov_b32 s75, 0
    s_mov_b32 s18, 7340032
    s_mov_b32 s19, 0x00020000
    s_mov_b32 s22, 7340032
    s_mov_b32 s23, 0x00020000
    s_mov_b32 s26, 7340032
    s_mov_b32 s27, 0x00020000
    v_lshrrev_b32 v4, 4, v2
    v_lshlrev_b32 v5, 5, v4
    v_and_b32 v6, 0x70, v3
    v_xor_b32 v5, v5, v6
    v_mul_u32_u24 v4, 7168, v4
    s_mul_i32 s31, s47, 917504
    s_lshl_b32 s32, s46, 7
    s_add_u32 s31, s31, s32
    v_add3_u32 v4, v4, v5, s31
    s_cmp_eq_u32 s75, 0
    s_mov_b32 s31, 917504
    s_cselect_b32 s31, 128, s31
    v_add_u32 v6, s31, v4
    s_mov_b32 vcc_lo, 0xff00ff00
    s_mov_b32 vcc_hi, 0xff00ff00
    v_cndmask_b32 v5, v6, v4, vcc
    v_cndmask_b32 v4, v4, v6, vcc
    s_mov_b32 s48, 0
    s_mov_b32 s49, 76800
    s_waitcnt lgkmcnt(0)
    s_mov_b32 s16, s38
    s_mov_b32 s17, s39
    s_load_dwordx2 s[28:29], s[12:13], 0
    s_load_dwordx2 s[24:25], s[0:1], 72
    s_load_dwordx2 s[44:45], s[0:1], 80
    s_barrier
    s_cmp_ge_u32 s2, 224
    s_cselect_b32 s66, 0, 1
    s_cbranch_scc1 L_dma_done
    s_cmp_lg_u32 s30, 0
    s_cbranch_scc1 L_dma_done
    s_setprio 3
L_dma0:
    s_mov_b32 m0, s49
    s_waitcnt vmcnt(19)
    buffer_load_dwordx4 v4, s[16:19], s48 offen nt lds
    s_add_u32 m0, s49, 32768
    s_add_u32 s49, s49, 1024
    s_waitcnt vmcnt(19)
    buffer_load_dwordx4 v4, s[20:23], s48 offen nt lds
    s_add_u32 s48, s48, 28672
    s_mov_b32 m0, s49
    s_waitcnt vmcnt(19)
    buffer_load_dwordx4 v4, s[16:19], s48 offen nt lds
    s_add_u32 m0, s49, 32768
    s_add_u32 s49, s49, 1024
    s_waitcnt vmcnt(19)
    buffer_load_dwordx4 v4, s[20:23], s48 offen nt lds
    s_add_u32 s48, s48, 28672
    s_mov_b32 m0, s49
    s_waitcnt vmcnt(19)
    buffer_load_dwordx4 v5, s[16:19], s48 offen nt lds
    s_add_u32 m0, s49, 32768
    s_add_u32 s49, s49, 1024
    s_waitcnt vmcnt(19)
    buffer_load_dwordx4 v5, s[20:23], s48 offen nt lds
    s_add_u32 s48, s48, 28672
    s_mov_b32 m0, s49
    s_waitcnt vmcnt(19)
    buffer_load_dwordx4 v5, s[16:19], s48 offen nt lds
    s_add_u32 m0, s49, 32768
    s_add_u32 s49, s49, 1024
    s_waitcnt vmcnt(19)
    buffer_load_dwordx4 v5, s[20:23], s48 offen nt lds
    s_add_u32 s48, s48, 28672
    s_cmp_lt_u32 s48, 917504
    s_cbranch_scc1 L_dma0
    s_branch L_dma_done
L_dft_rest:
    s_mov_b32 s18, 0x400000
    s_mov_b32 s19, 0x00020000
    s_sub_u32 s31, 2047, s52
    s_sub_u32 s32, 2047, s53
    v_mov_b32 v200, s31
    v_writelane_b32 v200, s32, 63
    s_lshl_b32 s31, s30, 2
    v_mov_b32 v201, s31
    s_bfe_u32 s31, s53, 0x20008
    s_lshl_b32 s31, s31, 2
    s_add_u32 s31, s31, 16
    v_writelane_b32 v201, s31, 63
    v_and_b32 v6, 32, v2
    s_lshl_b32 s31, s51, 2
    v_add_u32 v203, s31, v6
    v_lshrrev_b32 v202, 1, v203
    s_lshl_b32 s31, s2, 4
    s_add_u32 s31, s31, 4096
    v_mov_b32 v4, s31
    v_lshlrev_b32 v5, 3, v2
    s_and_b32 s31, s52, 7
    s_lshl_b32 s31, s31, 11
    s_and_b32 s32, s52, 1024
    s_add_u32 s31, s31, s32
    s_and_b32 s32, s52, 0xf8
    s_lshl_b32 s32, s32, 2
    s_add_u32 s31, s31, s32
    s_add_u32 s31, s31, 32768
    v_writelane_b32 v4, s31, 0
    s_add_u32 s31, s31, 16
    v_writelane_b32 v4, s31, 1
    s_and_b32 s31, s53, 7
    s_lshl_b32 s31, s31, 11
    s_and_b32 s32, s53, 1024
    s_add_u32 s31, s31, s32
    s_and_b32 s32, s53, 0xf8
    s_lshl_b32 s32, s32, 2
    s_add_u32 s31, s31, s32
    s_add_u32 s31, s31, 32768
    v_writelane_b32 v4, s31, 2
    s_add_u32 s31, s31, 16
    v_writelane_b32 v4, s31, 3
    s_mul_i32 s31, s51, 2592
    v_and_b32 v204, 32, v2
    v_lshlrev_b32 v204, 2, v204
    v_add3_u32 v204, v204, v3, s31
    s_lshl_b32 s32, s31, 1
    s_add_u32 s32, s32, 21872
    v_sub_u32 v205, s32, v204
    v_bfe_u32 v206, v2, 2, 2
    v_mul_u32_u24 v206, 2592, v206
    v_lshrrev_b32 v6, 4, v2
    v_mul_u32_u24 v7, 640, v6
    v_add_u32 v206, v206, v7
    v_and_b32 v7, 3, v2
    v_lshlrev_b32 v7, 3, v7
    s_lshl_b32 s31, s30, 7
    v_add3_u32 v206, v206, v7, s31
    v_lshlrev_b32 v6, 12, v6
    v_and_b32 v7, 15, v2
    v_lshl_add_u32 v6, v7, 4, v6
    s_lshl_b32 s31, s30, 8
    v_add_u32 v207, s31, v6
    v_bfe_i32 v208, v2, 4, 1
    v_and_b32 v208, 0x80008000, v208
    s_cmp_eq_u32 s47, 0
    s_movk_i32 s48, 0x7403
    s_cselect_b32 s48, 0x7721, s48
    v_and_b32 v250, 12, v2
    v_bfe_u32 v250, s48, v250, 4
    v_lshrrev_b32 v251, 4, v2
    v_bfe_u32 v252, v2, 1, 1
    v_mul_u32_u24 v251, v251, v252
    v_and_b32 v252, 1, v2
    v_add_u32 v251, v251, v252
    v_cvt_f32_u32 v250, v250
    v_cvt_f32_u32 v251, v251
    v_mul_f32 v250, 0x3e000000, v250
    v_mul_f32 v251, 0x3e800000, v251
    v_cos_f32 v8, v251
    v_add_f32 v251, v251, v250
    v_cos_f32 v9, v251
    v_add_f32 v251, v251, v250
    v_cos_f32 v10, v251
    v_add_f32 v251, v251, v250
    v_cos_f32 v11, v251
    v_add_f32 v251, v251, v250
    v_cos_f32 v12, v251
    v_add_f32 v251, v251, v250
    v_cos_f32 v13, v251
    v_add_f32 v251, v251, v250
    v_cos_f32 v14, v251
    v_add_f32 v251, v251, v250
    v_cos_f32 v15, v251
    v_mul_f32 v8, 0xbf317218, v8
    v_mul_f32 v9, 0xbf317218, v9
    v_mul_f32 v10, 0xbf317218, v10
    v_mul_f32 v11, 0xbf317218, v11
    v_mul_f32 v12, 0xbf317218, v12
    v_mul_f32 v13, 0xbf317218, v13
    v_mul_f32 v14, 0xbf317218, v14
    v_mul_f32 v15, 0xbf317218, v15
    v_lshrrev_b32 v250, 2, v2
    v_and_b32 v250, 12, v250
    v_and_b32 v251, 15, v2
    v_lshlrev_b32 v251, 2, v251
    v_cvt_f32_u32 v250, v250
    v_cvt_f32_u32 v251, v251
    v_mul_f32 v212, 0x3c800000, v250
    s_lshl_b32 s31, s30, 2
    s_lshr_b32 s48, s48, s31
    s_and_b32 s48, s48, 15
    s_sub_u32 s31, s48, 4
    s_mul_i32 s31, s31, s46
    v_cvt_f32_i32 v252, s31
    v_mul_f32 v252, 0x3a000000, v252
    v_add_f32 v213, 0x3c800000, v212
    v_add_f32 v214, 0x3d000000, v212
    v_add_f32 v215, 0x3d400000, v212
    s_and_b32 s31, s2, 7
    s_sub_u32 s32, 8, s31
    s_min_u32 s76, s31, s32
    s_lshr_b32 s78, s31, 2
    s_lshr_b32 s77, s2, 3
    s_and_b32 s32, s77, 1
    s_and_b32 s31, s31, 3
    s_cselect_b32 s78, s78, s32
    s_cselect_b32 s31, 0, 1
    s_lshr_b32 s77, s77, s31
    s_lshl_b32 s78, s78, 4
    s_lshl_b32 s31, s30, 5
    s_add_u32 s78, s78, s31
    s_lshl_b32 s78, s78, 3
    s_add_u32 s78, s78, s76
    s_lshl_b32 s77, s77, 6
    s_sub_u32 s79, 1984, s77
    s_lshl_b32 s76, s76, 1
    s_add_u32 s76, s76, 2040
    v_and_b32 v116, 15, v2
    v_lshl_add_u32 v116, v116, 3, s78
    v_and_b32 v7, 32, v2
    v_lshl_add_u32 v7, v7, 5, v116
    s_mov_b32 vcc_lo, 0xffff0000
    s_mov_b32 vcc_hi, 0xffff0000
    v_sub_u32 v6, 0, v7
    v_cndmask_b32 v7, v7, v6, vcc
    v_and_b32 v6, 7, v7
    v_and_b32 v1, 1024, v7
    v_lshl_add_u32 v6, v6, 11, v1
    v_and_b32 v1, 0xf8, v7
    v_lshl_add_u32 v6, v1, 2, v6
    v_bfe_u32 v1, v7, 9, 1
    v_lshl_add_u32 v119, v1, 4, v6
    v_and_b32 v1, 256, v7
    v_cmp_ne_u32 s[88:89], 0, v1
    v_lshrrev_b32 v118, 2, v2
    v_lshl_add_u32 v118, v118, 3, s78
    v_lshlrev_b32 v1, 1, v2
    v_xor_b32 v1, v1, v3
    v_and_b32 v1, 48, v1
    v_add_u32 v114, 1024, v118
    v_sub_u32 v113, 0, v118
    v_and_b32 v113, 2047, v113
    v_sub_u32 v115, 2048, v114
    v_add_u32 v112, s77, v1
    v_lshl_add_u32 v114, v114, 11, v112
    v_lshl_add_u32 v112, v118, 11, v112
    v_xor_b32 v1, 48, v1
    v_add_u32 v1, s79, v1
    v_lshl_add_u32 v113, v113, 11, v1
    v_lshl_add_u32 v115, v115, 11, v1
    s_lshl_b32 s76, s30, 12
    s_add_u32 s76, s76, 44032
    v_and_b32 v1, 15, v2
    v_lshlrev_b32 v6, 6, v1
    v_lshlrev_b32 v1, 3, v2
    v_xor_b32 v1, v1, v2
    v_and_b32 v1, 48, v1
    v_add3_u32 v117, v6, v1, s76
    v_mul_f32 v250, v212, v251
    v_fmamk_f32 v52, v250, 0x3d800000, v252
    v_sin_f32 v20, v250
    v_cos_f32 v250, v250
    v_cos_f32 v48, v52
    v_sin_f32 v52, v52
    v_cvt_pk_f16_f32 v16, v250, v20
    v_cvt_pk_f16_f32 v20, -v20, v250
    v_mul_f32 v250, v213, v251
    v_fmamk_f32 v53, v250, 0x3d800000, v252
    v_sin_f32 v21, v250
    v_cos_f32 v250, v250
    v_cos_f32 v49, v53
    v_sin_f32 v53, v53
    v_cvt_pk_f16_f32 v17, v250, v21
    v_cvt_pk_f16_f32 v21, -v21, v250
    v_mul_f32 v250, v214, v251
    v_fmamk_f32 v54, v250, 0x3d800000, v252
    v_sin_f32 v22, v250
    v_cos_f32 v250, v250
    v_cos_f32 v50, v54
    v_sin_f32 v54, v54
    v_cvt_pk_f16_f32 v18, v250, v22
    v_cvt_pk_f16_f32 v22, -v22, v250
    v_mul_f32 v250, v215, v251
    v_fmamk_f32 v55, v250, 0x3d800000, v252
    v_sin_f32 v23, v250
    v_cos_f32 v250, v250
    v_cos_f32 v51, v55
    v_sin_f32 v55, v55
    v_cvt_pk_f16_f32 v19, v250, v23
    v_cvt_pk_f16_f32 v23, -v23, v250
    v_add_f32 v251, 1.0, v251
    v_mul_f32 v250, v212, v251
    v_fmamk_f32 v60, v250, 0x3d800000, v252
    v_sin_f32 v28, v250
    v_cos_f32 v250, v250
    v_cos_f32 v56, v60
    v_sin_f32 v60, v60
    v_cvt_pk_f16_f32 v24, v250, v28
    v_cvt_pk_f16_f32 v28, -v28, v250
    v_mul_f32 v250, v213, v251
    v_fmamk_f32 v61, v250, 0x3d800000, v252
    v_sin_f32 v29, v250
    v_cos_f32 v250, v250
    v_cos_f32 v57, v61
    v_sin_f32 v61, v61
    v_cvt_pk_f16_f32 v25, v250, v29
    v_cvt_pk_f16_f32 v29, -v29, v250
    v_mul_f32 v250, v214, v251
    v_fmamk_f32 v62, v250, 0x3d800000, v252
    v_sin_f32 v30, v250
    v_cos_f32 v250, v250
    v_cos_f32 v58, v62
    v_sin_f32 v62, v62
    v_cvt_pk_f16_f32 v26, v250, v30
    v_cvt_pk_f16_f32 v30, -v30, v250
    v_mul_f32 v250, v215, v251
    v_fmamk_f32 v63, v250, 0x3d800000, v252
    v_sin_f32 v31, v250
    v_cos_f32 v250, v250
    v_cos_f32 v59, v63
    v_sin_f32 v63, v63
    v_cvt_pk_f16_f32 v27, v250, v31
    v_cvt_pk_f16_f32 v31, -v31, v250
    v_add_f32 v251, 1.0, v251
    v_mov_b32 v160, 0
    v_mov_b32 v161, 0
    v_mov_b32 v162, 0
    v_mov_b32 v163, 0
    v_mov_b32 v164, 0
    v_mov_b32 v165, 0
    v_mov_b32 v166, 0
    v_mov_b32 v167, 0
    v_mov_b32 v168, 0
    v_mov_b32 v169, 0
    v_mov_b32 v170, 0
    s_mov_b32 s57, 0x3f803f80
    s_mov_b32 s59, 0xffff
    s_brev_b32 s67, 1
    s_mov_b32 s66, 0
    s_brev_b32 s64, 1
    s_brev_b32 s65, 1
    s_cmp_eq_u32 s47, 0
    s_movk_i32 s62, -10368
    s_cselect_b32 s62, 10368, s62
    s_waitcnt lgkmcnt(0)
    s_add_u32 s28, s28, 0x7f4a7c15
    s_addc_u32 s29, s29, 0x9e3779b9
    v_mov_b32 v174, s28
    v_mov_b32 v175, s29
    s_cmp_lt_u32 s2, 224
    s_cbranch_scc1 L_epoch_ok
L_sync1:
    ds_read_b32 v1, v0 offset:42872
    s_add_u32 s92, s92, 1
    s_bitcmp1_b32 s92, 20
    s_cbranch_scc1 L_sync1x
    s_waitcnt lgkmcnt(0)
    v_readfirstlane_b32 s31, v1
    s_nop 0
    s_cmp_ge_u32 s31, 4
    s_cbranch_scc0 L_sync1
L_sync1x:
L_epoch_ok:
    s_setprio 3
    s_waitcnt vmcnt(8)
    v_dot2c_f32_bf16 v160, s57, v120
    v_dot2c_f32_bf16 v164, v120, v120
    v_dot2c_f32_bf16 v160, s57, v121
    v_dot2c_f32_bf16 v164, v121, v121
    v_dot2c_f32_bf16 v160, s57, v122
    v_dot2c_f32_bf16 v164, v122, v122
    v_dot2c_f32_bf16 v160, s57, v123
    v_dot2c_f32_bf16 v164, v123, v123
    v_dot2c_f32_bf16 v160, s57, v124
    v_dot2c_f32_bf16 v164, v124, v124
    v_dot2c_f32_bf16 v160, s57, v125
    v_dot2c_f32_bf16 v164, v125, v125
    v_dot2c_f32_bf16 v160, s57, v126
    v_dot2c_f32_bf16 v164, v126, v126
    v_dot2c_f32_bf16 v160, s57, v127
    v_dot2c_f32_bf16 v164, v127, v127
    s_waitcnt vmcnt(6)
    v_dot2c_f32_bf16 v161, s57, v128
    v_dot2c_f32_bf16 v165, v128, v128
    v_dot2c_f32_bf16 v161, s57, v129
    v_dot2c_f32_bf16 v165, v129, v129
    v_dot2c_f32_bf16 v161, s57, v130
    v_dot2c_f32_bf16 v165, v130, v130
    v_dot2c_f32_bf16 v161, s57, v131
    v_dot2c_f32_bf16 v165, v131, v131
    v_dot2c_f32_bf16 v161, s57, v132
    v_dot2c_f32_bf16 v165, v132, v132
    v_dot2c_f32_bf16 v161, s57, v133
    v_dot2c_f32_bf16 v165, v133, v133
    v_dot2c_f32_bf16 v161, s57, v134
    v_dot2c_f32_bf16 v165, v134, v134
    v_dot2c_f32_bf16 v161, s57, v135
    v_dot2c_f32_bf16 v165, v135, v135
    s_waitcnt vmcnt(4)
    v_dot2c_f32_bf16 v170, s57, v152
    v_dot2c_f32_bf16 v170, s57, v153
    v_dot2c_f32_bf16 v170, s57, v154
    v_dot2c_f32_bf16 v170, s57, v155
    v_dot2c_f32_bf16 v170, s57, v156
    v_dot2c_f32_bf16 v170, s57, v157
    v_dot2c_f32_bf16 v170, s57, v158
    v_dot2c_f32_bf16 v170, s57, v159
    v_dot2c_f32_bf16 v168, v152, v120
    v_dot2c_f32_bf16 v169, v152, v128
    v_dot2c_f32_bf16 v168, v153, v121
    v_dot2c_f32_bf16 v169, v153, v129
    v_dot2c_f32_bf16 v168, v154, v122
    v_dot2c_f32_bf16 v169, v154, v130
    v_dot2c_f32_bf16 v168, v155, v123
    v_dot2c_f32_bf16 v169, v155, v131
    v_mov_b32 v171, v170
    v_dot2c_f32_bf16 v168, v156, v124
    v_dot2c_f32_bf16 v169, v156, v132
    v_dot2c_f32_bf16 v168, v157, v125
    v_dot2c_f32_bf16 v169, v157, v133
    v_dot2c_f32_bf16 v168, v158, v126
    v_dot2c_f32_bf16 v169, v158, v134
    v_dot2c_f32_bf16 v168, v159, v127
    v_dot2c_f32_bf16 v169, v159, v135
    v_permlane32_swap_b32 v160, v161
    v_permlane32_swap_b32 v164, v165
    v_permlane32_swap_b32 v170, v171
    v_permlane32_swap_b32 v168, v169
    v_add_f32 v160, v160, v161
    v_add_f32 v164, v164, v165
    v_add_f32 v170, v170, v171
    v_add_f32 v168, v168, v169
    v_add_f32_dpp v160, v160, v160 row_shr:1 row_mask:0xf bank_mask:0xf
    v_add_f32_dpp v164, v164, v164 row_shr:1 row_mask:0xf bank_mask:0xf
    v_add_f32_dpp v170, v170, v170 row_shr:1 row_mask:0xf bank_mask:0xf
    v_add_f32_dpp v168, v168, v168 row_shr:1 row_mask:0xf bank_mask:0xf
    v_add_f32_dpp v160, v160, v160 row_shr:2 row_mask:0xf bank_mask:0xf
    v_add_f32_dpp v164, v164, v164 row_shr:2 row_mask:0xf bank_mask:0xf
    v_add_f32_dpp v170, v170, v170 row_shr:2 row_mask:0xf bank_mask:0xf
    v_add_f32_dpp v168, v168, v168 row_shr:2 row_mask:0xf bank_mask:0xf
    v_add_f32_dpp v160, v160, v160 row_shr:4 row_mask:0xf bank_mask:0xf
    v_add_f32_dpp v164, v164, v164 row_shr:4 row_mask:0xf bank_mask:0xf
    v_add_f32_dpp v170, v170, v170 row_shr:4 row_mask:0xf bank_mask:0xf
    v_add_f32_dpp v168, v168, v168 row_shr:4 row_mask:0xf bank_mask:0xf
    v_add_f32_dpp v160, v160, v160 row_shr:8 row_mask:0xf bank_mask:0xf
    v_add_f32_dpp v164, v164, v164 row_shr:8 row_mask:0xf bank_mask:0xf
    v_add_f32_dpp v170, v170, v170 row_shr:8 row_mask:0xf bank_mask:0xf
    v_add_f32_dpp v168, v168, v168 row_shr:8 row_mask:0xf bank_mask:0xf
    v_add_f32_dpp v160, v160, v160 row_bcast:15 row_mask:0xa bank_mask:0xf
    v_add_f32_dpp v164, v164, v164 row_bcast:15 row_mask:0xa bank_mask:0xf
    v_add_f32_dpp v170, v170, v170 row_bcast:15 row_mask:0xa bank_mask:0xf
    v_add_f32_dpp v168, v168, v168 row_bcast:15 row_mask:0xa bank_mask:0xf
    v_mul_f32 v160, 0x3a800000, v160
    v_mul_f32 v164, 0x3a800000, v164
    v_fma_f32 v164, -v160, v160, v164
    v_cvt_pk_bf16_f32 v161, -v160, -v160
    v_max_f32 v164, 0, v164
    v_cvt_pk_bf16_f32 v164, v164, v164
    v_and_b32 v164, 0xffff0000, v164
    v_add_f32 v164, 0x3727c5ac, v164
    v_cvt_pk_bf16_f32 v164, v164, v164
    v_and_b32 v164, 0xffff0000, v164
    v_sqrt_f32 v164, v164
    v_and_b32 v165, 0xffff0000, v161
    v_cvt_pk_bf16_f32 v248, v160, v164
    v_and_b32 v164, 0xffff0000, v248
    v_rcp_f32 v164, v164
    v_fmac_f32 v168, v170, v165
    v_mul_f32 v168, v168, v164
    v_ashrrev_i32 v170, 31, v168
    v_or_b32 v170, 0x80000000, v170
    v_xor_b32 v168, v168, v170
    v_and_b32 v168, 0xfffff800, v168
    v_or_b32 v249, v200, v168
    s_mov_b64 exec, s[64:65]
    ds_write_b32 v201, v248 offset:41472
    ds_max_u64 v0, v[248:249] offset:41504
    s_mov_b64 exec, 1
    ds_add_rtn_u32 v1, v0, v255 offset:42816
    s_mov_b64 exec, 31
    ds_read_b64 v[172:173], v5 offset:41472
    s_mov_b64 exec, s[64:65]
    ds_write_b16 v202, v161 offset:41568
    ds_write_b32 v203, v164 offset:42752
    s_mov_b64 exec, -1
    s_nop 0
    v_mov_b32_dpp v6, v128 wave_rol:1 row_mask:0xf bank_mask:0xf
    v_mov_b32_dpp v7, v132 wave_rol:1 row_mask:0xf bank_mask:0xf
    v_bfi_b32 v221, s59, v131, v130
    v_bfi_b32 v222, s59, v130, v129
    v_bfi_b32 v223, s59, v129, v128
    v_bfi_b32 v217, s59, v135, v134
    v_bfi_b32 v218, s59, v134, v133
    v_bfi_b32 v219, s59, v133, v132
    v_cndmask_b32 v220, v6, v7, s[66:67]
    v_cndmask_b32 v216, v7, v6, s[66:67]
    v_bfi_b32 v220, s59, v220, v131
    v_bfi_b32 v216, s59, v216, v135
    s_waitcnt lgkmcnt(2)
    v_readfirstlane_b32 s31, v1
    s_nop 0
    s_cmp_lg_u32 s31, 3
    s_cbranch_scc1 L_not_last
    s_mov_b64 exec, 31
    buffer_store_dwordx4 v[172:175], v4, s[12:15], 0 offen sc1
    s_mov_b64 exec, -1
    s_waitcnt vmcnt(1)
    s_branch L_b_ready
L_not_last:
    s_waitcnt vmcnt(0)
L_b_ready:
    s_setprio 3
    ds_write_b128 v204, v[120:123] offset:0
    ds_write_b128 v204, v[124:127] offset:1280
    s_cmp_lg_u32 s50, 0
    s_cbranch_scc1 L_plain1
    ds_write_b128 v205, v[216:219]
    ds_write_b128 v205, v[220:223] offset:1280
    s_branch L_second1
L_plain1:
    ds_write_b128 v204, v[128:131] offset:20736
    ds_write_b128 v204, v[132:135] offset:22016
L_second1:
    v_add_u32 v204, s62, v204
    v_add_u32 v205, s62, v205
    v_dot2c_f32_bf16 v162, s57, v136
    v_dot2c_f32_bf16 v166, v136, v136
    v_dot2c_f32_bf16 v162, s57, v137
    v_dot2c_f32_bf16 v166, v137, v137
    v_dot2c_f32_bf16 v162, s57, v138
    v_dot2c_f32_bf16 v166, v138, v138
    v_dot2c_f32_bf16 v162, s57, v139
    v_dot2c_f32_bf16 v166, v139, v139
    v_dot2c_f32_bf16 v162, s57, v140
    v_dot2c_f32_bf16 v166, v140, v140
    v_dot2c_f32_bf16 v162, s57, v141
    v_dot2c_f32_bf16 v166, v141, v141
    v_dot2c_f32_bf16 v162, s57, v142
    v_dot2c_f32_bf16 v166, v142, v142
    v_dot2c_f32_bf16 v162, s57, v143
    v_dot2c_f32_bf16 v166, v143, v143
    ds_write_b128 v204, v[136:139] offset:0
    ds_write_b128 v204, v[140:143] offset:1280
    v_dot2c_f32_bf16 v163, s57, v144
    v_dot2c_f32_bf16 v167, v144, v144
    v_dot2c_f32_bf16 v163, s57, v145
    v_dot2c_f32_bf16 v167, v145, v145
    v_dot2c_f32_bf16 v163, s57, v146
    v_dot2c_f32_bf16 v167, v146, v146
    v_dot2c_f32_bf16 v163, s57, v147
    v_dot2c_f32_bf16 v167, v147, v147
    v_dot2c_f32_bf16 v163, s57, v148
    v_dot2c_f32_bf16 v167, v148, v148
    v_dot2c_f32_bf16 v163, s57, v149
    v_dot2c_f32_bf16 v167, v149, v149
    v_dot2c_f32_bf16 v163, s57, v150
    v_dot2c_f32_bf16 v167, v150, v150
    v_dot2c_f32_bf16 v163, s57, v151
    v_dot2c_f32_bf16 v167, v151, v151
    v_xor_b32 v202, 8, v202
    v_xor_b32 v203, 16, v203
    s_waitcnt lgkmcnt(2)
    s_nop 0
    v_mov_b32_dpp v6, v144 wave_rol:1 row_mask:0xf bank_mask:0xf
    v_mov_b32_dpp v7, v148 wave_rol:1 row_mask:0xf bank_mask:0xf
    v_bfi_b32 v221, s59, v147, v146
    v_bfi_b32 v222, s59, v146, v145
    v_bfi_b32 v223, s59, v145, v144
    v_bfi_b32 v217, s59, v151, v150
    v_bfi_b32 v218, s59, v150, v149
    v_bfi_b32 v219, s59, v149, v148
    v_cndmask_b32 v220, v6, v7, s[66:67]
    v_cndmask_b32 v216, v7, v6, s[66:67]
    v_bfi_b32 v220, s59, v220, v147
    v_bfi_b32 v216, s59, v216, v151
    s_cmp_lg_u32 s50, 0
    s_cbranch_scc1 L_plain3
    ds_write_b128 v205, v[216:219]
    ds_write_b128 v205, v[220:223] offset:1280
    s_branch L_second3
L_plain3:
    ds_write_b128 v204, v[144:147] offset:20736
    ds_write_b128 v204, v[148:151] offset:22016
L_second3:
    v_permlane32_swap_b32 v162, v163
    v_permlane32_swap_b32 v166, v167
    v_add_f32 v162, v162, v163
    v_add_f32 v166, v166, v167
    s_nop 0
    v_add_f32_dpp v162, v162, v162 row_shr:1 row_mask:0xf bank_mask:0xf
    v_add_f32_dpp v166, v166, v166 row_shr:1 row_mask:0xf bank_mask:0xf
    s_nop 0
    v_add_f32_dpp v162, v162, v162 row_shr:2 row_mask:0xf bank_mask:0xf
    v_add_f32_dpp v166, v166, v166 row_shr:2 row_mask:0xf bank_mask:0xf
    s_nop 0
    v_add_f32_dpp v162, v162, v162 row_shr:4 row_mask:0xf bank_mask:0xf
    v_add_f32_dpp v166, v166, v166 row_shr:4 row_mask:0xf bank_mask:0xf
    s_nop 0
    v_add_f32_dpp v162, v162, v162 row_shr:8 row_mask:0xf bank_mask:0xf
    v_add_f32_dpp v166, v166, v166 row_shr:8 row_mask:0xf bank_mask:0xf
    s_nop 0
    v_add_f32_dpp v162, v162, v162 row_bcast:15 row_mask:0xa bank_mask:0xf
    v_add_f32_dpp v166, v166, v166 row_bcast:15 row_mask:0xa bank_mask:0xf
    v_mul_f32 v162, 0x3a800000, v162
    v_mul_f32 v166, 0x3a800000, v166
    v_fma_f32 v166, -v162, v162, v166
    v_cvt_pk_bf16_f32 v161, -v162, -v162
    v_max_f32 v166, 0, v166
    v_cvt_pk_bf16_f32 v166, v166, v166
    v_and_b32 v166, 0xffff0000, v166
    v_add_f32 v166, 0x3727c5ac, v166
    v_cvt_pk_bf16_f32 v166, v166, v166
    v_and_b32 v166, 0xffff0000, v166
    v_sqrt_f32 v166, v166
    v_and_b32 v167, 0xffff0000, v161
    v_cvt_pk_bf16_f32 v248, v162, v166
    v_and_b32 v166, 0xffff0000, v248
    v_rcp_f32 v166, v166
    s_mov_b64 exec, s[64:65]
    ds_write_b16 v202, v161 offset:41568
    ds_write_b32 v203, v166 offset:42752
    s_mov_b64 exec, 1
    ds_add_u32 v0, v255 offset:42820
    s_mov_b64 exec, -1
L_sync2:
    ds_read_b32 v1, v0 offset:42820
    ds_read_b128 v[176:179], v0 offset:42752
    ds_read_b128 v[180:183], v0 offset:42768
    ds_read_b128 v[184:187], v0 offset:42784
    ds_read_b128 v[188:191], v0 offset:42800
    ds_read_b128 v[192:195], v0 offset:41568
    ds_read_b128 v[196:199], v0 offset:41584
    s_add_u32 s92, s92, 1
    s_bitcmp1_b32 s92, 20
    s_cbranch_scc1 L_sync2x
    s_waitcnt lgkmcnt(6)
    v_readfirstlane_b32 s31, v1
    s_nop 0
    s_cmp_ge_u32 s31, 4
    s_cbranch_scc0 L_sync2
L_sync2x:
    ds_read_b64_tr_b16 v[120:121], v206 offset:0
    ds_read_b64_tr_b16 v[122:123], v206 offset:10368
    ds_read_b64_tr_b16 v[124:125], v206 offset:20736
    ds_read_b64_tr_b16 v[126:127], v206 offset:31104
    ds_read_b64_tr_b16 v[128:129], v206 offset:32
    ds_read_b64_tr_b16 v[130:131], v206 offset:10400
    ds_read_b64_tr_b16 v[132:133], v206 offset:20768
    ds_read_b64_tr_b16 v[134:135], v206 offset:31136
    s_waitcnt lgkmcnt(10)
    s_nop 0
    ds_read_b64_tr_b16 v[136:137], v206 offset:64
    ds_read_b64_tr_b16 v[138:139], v206 offset:10432
    ds_read_b64_tr_b16 v[140:141], v206 offset:20800
    ds_read_b64_tr_b16 v[142:143], v206 offset:31168
    v_pk_mul_f32 v[176:177], v[176:177], v[8:9]
    v_pk_mul_f32 v[178:179], v[178:179], v[10:11]
    v_pk_mul_f32 v[180:181], v[180:181], v[12:13]
    v_pk_mul_f32 v[182:183], v[182:183], v[14:15]
    v_pk_mul_f32 v[184:185], v[184:185], v[8:9]
    v_pk_mul_f32 v[186:187], v[186:187], v[10:11]
    v_pk_mul_f32 v[188:189], v[188:189], v[12:13]
    v_pk_mul_f32 v[190:191], v[190:191], v[14:15]
    v_cvt_pk_bf16_f32 v160, v176, v177
    v_cvt_pk_bf16_f32 v152, v184, v185
    v_cvt_pk_bf16_f32 v161, v178, v179
    v_cvt_pk_bf16_f32 v153, v186, v187
    v_cvt_pk_bf16_f32 v162, v180, v181
    v_cvt_pk_bf16_f32 v154, v188, v189
    v_cvt_pk_bf16_f32 v163, v182, v183
    v_cvt_pk_bf16_f32 v155, v190, v191
    v_xor_b32 v164, v208, v160
    v_xor_b32 v156, v208, v152
    v_xor_b32 v165, v208, v161
    v_xor_b32 v157, v208, v153
    v_xor_b32 v166, v208, v162
    v_xor_b32 v158, v208, v154
    v_xor_b32 v167, v208, v163
    v_xor_b32 v159, v208, v155
    s_waitcnt lgkmcnt(12)
    s_cmp_lg_u32 s50, 0
    s_cbranch_scc1 L_st1_split
    v_mfma_f32_16x16x32_bf16 v[168:171], v[160:163], v[192:195], 0
    v_mfma_f32_16x16x32_bf16 v[168:171], v[152:155], v[196:199], v[168:171]
    s_waitcnt lgkmcnt(10)
    ds_read_b64_tr_b16 v[144:145], v206 offset:96
    ds_read_b64_tr_b16 v[146:147], v206 offset:10464
    ds_read_b64_tr_b16 v[148:149], v206 offset:20832
    ds_read_b64_tr_b16 v[150:151], v206 offset:31200
    v_mfma_f32_16x16x32_bf16 v[216:219], v[160:163], v[120:123], v[168:171]
    s_waitcnt lgkmcnt(12)
    v_mfma_f32_16x16x32_bf16 v[216:219], v[152:155], v[124:127], v[216:219]
    s_waitcnt lgkmcnt(10)
    v_mfma_f32_16x16x32_bf16 v[224:227], v[160:163], v[128:131], v[168:171]
    s_waitcnt lgkmcnt(8)
    v_mfma_f32_16x16x32_bf16 v[224:227], v[152:155], v[132:135], v[224:227]
    s_waitcnt lgkmcnt(6)
    v_mfma_f32_16x16x32_bf16 v[232:235], v[160:163], v[136:139], v[168:171]
    s_waitcnt lgkmcnt(4)
    v_mfma_f32_16x16x32_bf16 v[232:235], v[152:155], v[140:143], v[232:235]
    s_waitcnt lgkmcnt(2)
    v_mfma_f32_16x16x32_bf16 v[240:243], v[160:163], v[144:147], v[168:171]
    s_waitcnt lgkmcnt(0)
    v_mfma_f32_16x16x32_bf16 v[240:243], v[152:155], v[148:151], v[240:243]
    v_mfma_f32_16x16x32_bf16 v[220:223], v[164:167], v[120:123], 0
    v_mfma_f32_16x16x32_bf16 v[220:223], v[156:159], v[124:127], v[220:223]
    v_mfma_f32_16x16x32_bf16 v[228:231], v[164:167], v[128:131], 0
    v_mfma_f32_16x16x32_bf16 v[228:231], v[156:159], v[132:135], v[228:231]
    v_cvt_pk_f16_f32 v176, v216, v217
    v_cvt_pk_f16_f32 v177, v224, v225
    v_cvt_pk_f16_f32 v178, v232, v233
    s_nop 0
    v_cvt_pk_f16_f32 v179, v240, v241
    ds_write_b128 v207, v[176:179] offset:44032
    v_mfma_f32_16x16x32_bf16 v[236:239], v[164:167], v[136:139], 0
    v_mfma_f32_16x16x32_bf16 v[236:239], v[156:159], v[140:143], v[236:239]
    v_cvt_pk_f16_f32 v180, v218, v219
    v_cvt_pk_f16_f32 v181, v226, v227
    v_cvt_pk_f16_f32 v182, v234, v235
    v_cvt_pk_f16_f32 v183, v242, v243
    ds_write_b128 v207, v[180:183] offset:45056
    v_mfma_f32_16x16x32_bf16 v[244:247], v[164:167], v[144:147], 0
    v_mfma_f32_16x16x32_bf16 v[244:247], v[156:159], v[148:151], v[244:247]
    v_cvt_pk_f16_f32 v184, v220, v221
    v_cvt_pk_f16_f32 v185, v228, v229
    v_cvt_pk_f16_f32 v186, v236, v237
    s_nop 4
    v_cvt_pk_f16_f32 v187, v244, v245
    ds_write_b128 v207, v[184:187] offset:46080
    v_cvt_pk_f16_f32 v188, v222, v223
    v_cvt_pk_f16_f32 v189, v230, v231
    v_cvt_pk_f16_f32 v190, v238, v239
    v_cvt_pk_f16_f32 v191, v246, v247
    ds_write_b128 v207, v[188:191] offset:47104
    s_branch L_st1_done
L_st1_split:
    s_waitcnt lgkmcnt(8)
    ds_read_b64_tr_b16 v[144:145], v206 offset:96
    ds_read_b64_tr_b16 v[146:147], v206 offset:10464
    ds_read_b64_tr_b16 v[148:149], v206 offset:20832
    ds_read_b64_tr_b16 v[150:151], v206 offset:31200
    s_waitcnt lgkmcnt(0)
    v_mfma_f32_16x16x32_bf16 v[168:171], v[160:163], v[192:195], 0
    v_mfma_f32_16x16x32_bf16 v[220:223], v[164:167], v[120:123], 0
    v_mfma_f32_16x16x32_bf16 v[216:219], v[160:163], v[120:123], v[168:171]
    v_mfma_f32_16x16x32_bf16 v[228:231], v[164:167], v[128:131], 0
    v_mfma_f32_16x16x32_bf16 v[224:227], v[160:163], v[128:131], v[168:171]
    v_mfma_f32_16x16x32_bf16 v[236:239], v[164:167], v[136:139], 0
    v_mfma_f32_16x16x32_bf16 v[232:235], v[160:163], v[136:139], v[168:171]
    v_mfma_f32_16x16x32_bf16 v[244:247], v[164:167], v[144:147], 0
    v_mfma_f32_16x16x32_bf16 v[240:243], v[160:163], v[144:147], v[168:171]
    s_nop 1
    s_nop 0
    v_cvt_pk_f16_f32 v176, v216, v217
    v_cvt_pk_f16_f32 v180, v218, v219
    v_cvt_pk_f16_f32 v184, v220, v221
    v_cvt_pk_f16_f32 v188, v222, v223
    v_cvt_pk_f16_f32 v177, v224, v225
    v_cvt_pk_f16_f32 v181, v226, v227
    v_cvt_pk_f16_f32 v185, v228, v229
    v_cvt_pk_f16_f32 v189, v230, v231
    v_cvt_pk_f16_f32 v178, v232, v233
    v_cvt_pk_f16_f32 v182, v234, v235
    v_cvt_pk_f16_f32 v186, v236, v237
    v_cvt_pk_f16_f32 v190, v238, v239
    v_cvt_pk_f16_f32 v179, v240, v241
    v_cvt_pk_f16_f32 v183, v242, v243
    v_cvt_pk_f16_f32 v187, v244, v245
    v_cvt_pk_f16_f32 v191, v246, v247
    ds_write_b128 v207, v[176:179] offset:44032
    ds_write_b128 v207, v[180:183] offset:45056
    ds_write_b128 v207, v[184:187] offset:46080
    ds_write_b128 v207, v[188:191] offset:47104
    v_mfma_f32_16x16x32_bf16 v[168:171], v[152:155], v[196:199], 0
    v_mfma_f32_16x16x32_bf16 v[220:223], v[156:159], v[124:127], 0
    v_mfma_f32_16x16x32_bf16 v[216:219], v[152:155], v[124:127], v[168:171]
    v_mfma_f32_16x16x32_bf16 v[228:231], v[156:159], v[132:135], 0
    v_mfma_f32_16x16x32_bf16 v[224:227], v[152:155], v[132:135], v[168:171]
    v_mfma_f32_16x16x32_bf16 v[236:239], v[156:159], v[140:143], 0
    v_mfma_f32_16x16x32_bf16 v[232:235], v[152:155], v[140:143], v[168:171]
    v_mfma_f32_16x16x32_bf16 v[244:247], v[156:159], v[148:151], 0
    v_mfma_f32_16x16x32_bf16 v[240:243], v[152:155], v[148:151], v[168:171]
    s_waitcnt lgkmcnt(0)
    s_nop 0
    v_cvt_pk_f16_f32 v176, v216, v217
    v_cvt_pk_f16_f32 v180, v218, v219
    v_cvt_pk_f16_f32 v184, v220, v221
    v_cvt_pk_f16_f32 v188, v222, v223
    v_cvt_pk_f16_f32 v177, v224, v225
    v_cvt_pk_f16_f32 v181, v226, v227
    v_cvt_pk_f16_f32 v185, v228, v229
    v_cvt_pk_f16_f32 v189, v230, v231
    v_cvt_pk_f16_f32 v178, v232, v233
    v_cvt_pk_f16_f32 v182, v234, v235
    v_cvt_pk_f16_f32 v186, v236, v237
    v_cvt_pk_f16_f32 v190, v238, v239
    v_cvt_pk_f16_f32 v179, v240, v241
    v_cvt_pk_f16_f32 v183, v242, v243
    v_cvt_pk_f16_f32 v187, v244, v245
    v_cvt_pk_f16_f32 v191, v246, v247
    ds_write_b128 v207, v[176:179] offset:60416
    ds_write_b128 v207, v[180:183] offset:61440
    ds_write_b128 v207, v[184:187] offset:62464
    ds_write_b128 v207, v[188:191] offset:63488
L_st1_done:
    s_mov_b64 exec, 1
    ds_add_u32 v0, v255 offset:42824
    s_mov_b64 exec, -1
    s_lshl_b32 s31, s30, 12
    v_add_u32 v5, s31, v3
    s_and_b32 s31, s28, 0x30003
    v_mov_b32 v210, s31
    s_mov_b32 s58, 0xfffcfffc
    s_and_b32 s32, s48, 3
    s_cselect_b32 s72, -1, 0xff
    s_cselect_b32 s73, -1, 0
    s_mov_b32 s74, s48
    s_mov_b64 s[60:61], 0
    s_mov_b64 s[62:63], 0
    v_mov_b32 v209, 2147483392
    s_cmp_eq_u32 s48, 7
    s_cbranch_scc1 L_no_consts
    v_mul_f32 v250, v212, v251
    v_fmamk_f32 v68, v250, 0x3d800000, v252
    v_sin_f32 v36, v250
    v_cos_f32 v250, v250
    v_cos_f32 v64, v68
    v_sin_f32 v68, v68
    v_cvt_pk_f16_f32 v32, v250, v36
    v_cvt_pk_f16_f32 v36, -v36, v250
    v_mul_f32 v250, v213, v251
    v_fmamk_f32 v69, v250, 0x3d800000, v252
    v_sin_f32 v37, v250
    v_cos_f32 v250, v250
    v_cos_f32 v65, v69
    v_sin_f32 v69, v69
    v_cvt_pk_f16_f32 v33, v250, v37
    v_cvt_pk_f16_f32 v37, -v37, v250
    v_mul_f32 v250, v214, v251
    v_fmamk_f32 v70, v250, 0x3d800000, v252
    v_sin_f32 v38, v250
    v_cos_f32 v250, v250
    v_cos_f32 v66, v70
    v_sin_f32 v70, v70
    v_cvt_pk_f16_f32 v34, v250, v38
    v_cvt_pk_f16_f32 v38, -v38, v250
    v_mul_f32 v250, v215, v251
    v_fmamk_f32 v71, v250, 0x3d800000, v252
    v_sin_f32 v39, v250
    v_cos_f32 v250, v250
    v_cos_f32 v67, v71
    v_sin_f32 v71, v71
    v_cvt_pk_f16_f32 v35, v250, v39
    v_cvt_pk_f16_f32 v39, -v39, v250
    v_add_f32 v251, 1.0, v251
    v_mul_f32 v250, v212, v251
    v_fmamk_f32 v76, v250, 0x3d800000, v252
    v_sin_f32 v44, v250
    v_cos_f32 v250, v250
    v_cos_f32 v72, v76
    v_sin_f32 v76, v76
    v_cvt_pk_f16_f32 v40, v250, v44
    v_cvt_pk_f16_f32 v44, -v44, v250
    v_mul_f32 v250, v213, v251
    v_fmamk_f32 v77, v250, 0x3d800000, v252
    v_sin_f32 v45, v250
    v_cos_f32 v250, v250
    v_cos_f32 v73, v77
    v_sin_f32 v77, v77
    v_cvt_pk_f16_f32 v41, v250, v45
    v_cvt_pk_f16_f32 v45, -v45, v250
    v_mul_f32 v250, v214, v251
    v_fmamk_f32 v78, v250, 0x3d800000, v252
    v_sin_f32 v46, v250
    v_cos_f32 v250, v250
    v_cos_f32 v74, v78
    v_sin_f32 v78, v78
    v_cvt_pk_f16_f32 v42, v250, v46
    v_cvt_pk_f16_f32 v46, -v46, v250
    v_mul_f32 v250, v215, v251
    v_fmamk_f32 v79, v250, 0x3d800000, v252
    v_sin_f32 v47, v250
    v_cos_f32 v250, v250
    v_cos_f32 v75, v79
    v_sin_f32 v79, v79
    v_cvt_pk_f16_f32 v43, v250, v47
    v_cvt_pk_f16_f32 v47, -v47, v250
    s_and_b32 s31, s46, 1
    s_lshl_b32 s31, s31, 6
    s_lshr_b32 s32, s46, 1
    s_add_u32 s49, s31, s32
    s_bitcmp1_b32 s49, 2
    s_cselect_b64 vcc, -1, 0
    v_cndmask_b32 v80, v16, v20, vcc
    v_cndmask_b32 v84, v20, v16, vcc
    v_cndmask_b32 v81, v17, v21, vcc
    v_cndmask_b32 v85, v21, v17, vcc
    v_cndmask_b32 v82, v18, v22, vcc
    v_cndmask_b32 v86, v22, v18, vcc
    v_cndmask_b32 v83, v19, v23, vcc
    v_cndmask_b32 v87, v23, v19, vcc
    s_bfe_u32 s31, s49, 0x10001
    v_and_b32 v6, 7, v2
    v_xor_b32 v6, s31, v6
    v_lshlrev_b32 v6, 4, v6
    v_lshrrev_b32 v7, 4, v2
    v_lshlrev_b32 v7, 3, v7
    v_bfe_u32 v209, v2, 3, 1
    v_add_u32 v7, v7, v209
    v_mul_u32_u24 v7, 16512, v7
    v_add_u32 v209, v6, v7
    s_mul_i32 s31, s48, 528384
    s_lshl_b32 s32, s49, 7
    s_add_u32 s31, s31, s32
    s_add_u32 s60, s31, 2097152
L_no_consts:
L_st23:
L_sync3:
    ds_read_b32 v1, v0 offset:42824
    ds_read_b128 v[120:123], v5 offset:44032
    ds_read_b128 v[124:127], v5 offset:45056
    ds_read_b128 v[128:131], v5 offset:46080
    ds_read_b128 v[132:135], v5 offset:47104
    s_add_u32 s92, s92, 1
    s_bitcmp1_b32 s92, 20
    s_cbranch_scc1 L_sync3x
    s_waitcnt lgkmcnt(4)
    v_readfirstlane_b32 s31, v1
    s_nop 0
    s_cmp_ge_u32 s31, 4
    s_cbranch_scc0 L_sync3
L_sync3x:
    s_cmp_eq_u32 s48, 7
    s_cbranch_scc1 L_p1_done
    s_add_u32 s61, s60, 33024
    s_add_u32 s62, s61, 33024
    s_add_u32 s63, s62, 33024
    s_waitcnt lgkmcnt(3)
    v_mfma_f32_16x16x32_f16 v[136:139], v[120:123], v[16:19], 0
    v_mfma_f32_16x16x32_f16 v[140:143], v[120:123], v[20:23], 0
    s_waitcnt lgkmcnt(2)
    v_mfma_f32_16x16x32_f16 v[144:147], v[124:127], v[24:27], 0
    v_mfma_f32_16x16x32_f16 v[148:151], v[124:127], v[28:31], 0
    s_nop 3
    s_nop 0
    v_pk_mul_f32 v[152:153], v[48:49], v[136:137]
    v_pk_mul_f32 v[154:155], v[50:51], v[138:139]
    v_pk_mul_f32 v[156:157], v[52:53], v[136:137]
    v_pk_mul_f32 v[158:159], v[54:55], v[138:139]
    v_pk_fma_f32 v[152:153], v[52:53], v[140:141], v[152:153]
    v_pk_fma_f32 v[156:157], v[48:49], v[140:141], v[156:157] neg_lo:[0,0,1] neg_hi:[0,0,1]
    v_pk_fma_f32 v[154:155], v[54:55], v[142:143], v[154:155]
    v_pk_fma_f32 v[158:159], v[50:51], v[142:143], v[158:159] neg_lo:[0,0,1] neg_hi:[0,0,1]
    v_cvt_pk_f16_f32 v120, v152, v156
    v_cvt_pk_f16_f32 v121, v153, v157
    v_cvt_pk_f16_f32 v122, v154, v158
    v_cvt_pk_f16_f32 v123, v155, v159
    s_waitcnt lgkmcnt(1)
    s_nop 0
    v_mfma_f32_16x16x32_f16 v[136:139], v[128:131], v[32:35], 0
    v_mfma_f32_16x16x32_f16 v[140:143], v[128:131], v[36:39], 0
    v_mfma_f32_16x16x32_f16 v[216:219], v[80:83], v[120:123], 0
    v_mfma_f32_16x16x32_f16 v[220:223], v[84:87], v[120:123], 0
    v_pk_mul_f32 v[152:153], v[56:57], v[144:145]
    v_pk_mul_f32 v[154:155], v[58:59], v[146:147]
    v_pk_mul_f32 v[156:157], v[60:61], v[144:145]
    v_pk_mul_f32 v[158:159], v[62:63], v[146:147]
    v_pk_fma_f32 v[152:153], v[60:61], v[148:149], v[152:153]
    v_pk_fma_f32 v[156:157], v[56:57], v[148:149], v[156:157] neg_lo:[0,0,1] neg_hi:[0,0,1]
    v_pk_fma_f32 v[154:155], v[62:63], v[150:151], v[154:155]
    v_pk_fma_f32 v[158:159], v[58:59], v[150:151], v[158:159] neg_lo:[0,0,1] neg_hi:[0,0,1]
    v_cvt_pk_f16_f32 v124, v152, v156
    v_cvt_pk_f16_f32 v125, v153, v157
    v_cvt_pk_f16_f32 v126, v154, v158
    v_cvt_pk_f16_f32 v127, v155, v159
    s_waitcnt lgkmcnt(0)
    s_nop 0
    v_mfma_f32_16x16x32_f16 v[144:147], v[132:135], v[40:43], 0
    v_mfma_f32_16x16x32_f16 v[148:151], v[132:135], v[44:47], 0
    v_mfma_f32_16x16x32_f16 v[224:227], v[80:83], v[124:127], 0
    v_mfma_f32_16x16x32_f16 v[228:231], v[84:87], v[124:127], 0
    v_pk_mul_f32 v[152:153], v[64:65], v[136:137]
    v_pk_mul_f32 v[154:155], v[66:67], v[138:139]
    v_pk_mul_f32 v[156:157], v[68:69], v[136:137]
    v_pk_mul_f32 v[158:159], v[70:71], v[138:139]
    v_pk_fma_f32 v[152:153], v[68:69], v[140:141], v[152:153]
    v_pk_fma_f32 v[156:157], v[64:65], v[140:141], v[156:157] neg_lo:[0,0,1] neg_hi:[0,0,1]
    v_pk_fma_f32 v[154:155], v[70:71], v[142:143], v[154:155]
    v_pk_fma_f32 v[158:159], v[66:67], v[142:143], v[158:159] neg_lo:[0,0,1] neg_hi:[0,0,1]
    v_cvt_pk_f16_f32 v128, v152, v156
    v_cvt_pk_f16_f32 v129, v153, v157
    v_cvt_pk_f16_f32 v130, v154, v158
    v_cvt_pk_f16_f32 v131, v155, v159
    s_nop 1
    s_nop 0
    v_mfma_f32_16x16x32_f16 v[232:235], v[80:83], v[128:131], 0
    v_mfma_f32_16x16x32_f16 v[236:239], v[84:87], v[128:131], 0
    v_pk_mul_f32 v[152:153], v[72:73], v[144:145]
    v_pk_mul_f32 v[154:155], v[74:75], v[146:147]
    v_pk_mul_f32 v[156:157], v[76:77], v[144:145]
    v_pk_mul_f32 v[158:159], v[78:79], v[146:147]
    v_pk_fma_f32 v[152:153], v[76:77], v[148:149], v[152:153]
    v_pk_fma_f32 v[156:157], v[72:73], v[148:149], v[156:157] neg_lo:[0,0,1] neg_hi:[0,0,1]
    v_pk_fma_f32 v[154:155], v[78:79], v[150:151], v[154:155]
    v_pk_fma_f32 v[158:159], v[74:75], v[150:151], v[158:159] neg_lo:[0,0,1] neg_hi:[0,0,1]
    v_cvt_pk_f16_f32 v132, v152, v156
    v_cvt_pk_f16_f32 v133, v153, v157
    v_cvt_pk_f16_f32 v134, v154, v158
    v_cvt_pk_f16_f32 v135, v155, v159
    s_nop 1
    s_nop 0
    v_mfma_f32_16x16x32_f16 v[240:243], v[80:83], v[132:135], 0
    v_mfma_f32_16x16x32_f16 v[244:247], v[84:87], v[132:135], 0
    v_cvt_pk_f16_f32 v176, v216, v224
    v_cvt_pk_f16_f32 v178, v220, v228
    v_and_or_b32 v176, v176, s58, v210
    v_and_or_b32 v178, v178, s58, v210
    v_cvt_pk_f16_f32 v180, v217, v225
    v_cvt_pk_f16_f32 v182, v221, v229
    v_and_or_b32 v180, v180, s58, v210
    v_and_or_b32 v182, v182, s58, v210
    v_cvt_pk_f16_f32 v184, v218, v226
    v_cvt_pk_f16_f32 v186, v222, v230
    v_and_or_b32 v184, v184, s58, v210
    v_and_or_b32 v186, v186, s58, v210
    v_cvt_pk_f16_f32 v188, v219, v227
    v_cvt_pk_f16_f32 v190, v223, v231
    v_and_or_b32 v188, v188, s58, v210
    v_and_or_b32 v190, v190, s58, v210
    v_cvt_pk_f16_f32 v177, v232, v240
    v_cvt_pk_f16_f32 v179, v236, v244
    v_and_or_b32 v177, v177, s58, v210
    v_and_or_b32 v179, v179, s58, v210
    v_cvt_pk_f16_f32 v181, v233, v241
    v_cvt_pk_f16_f32 v183, v237, v245
    v_and_or_b32 v181, v181, s58, v210
    v_and_or_b32 v183, v183, s58, v210
    v_cvt_pk_f16_f32 v185, v234, v242
    v_cvt_pk_f16_f32 v187, v238, v246
    v_and_or_b32 v185, v185, s58, v210
    v_and_or_b32 v187, v187, s58, v210
    v_cvt_pk_f16_f32 v189, v235, v243
    v_cvt_pk_f16_f32 v191, v239, v247
    v_and_or_b32 v189, v189, s58, v210
    v_and_or_b32 v191, v191, s58, v210
    s_cmp_eq_u32 s50, 0
    s_cbranch_scc1 L_p1_done
    s_mov_b32 exec_hi, s72
    buffer_store_dwordx4 v[176:179], v209, s[12:15], s60 offen sc1
    s_mov_b32 exec_hi, s73
    buffer_store_dwordx4 v[180:183], v209, s[12:15], s61 offen sc1
    buffer_store_dwordx4 v[184:187], v209, s[12:15], s62 offen sc1
    buffer_store_dwordx4 v[188:191], v209, s[12:15], s63 offen sc1
    s_mov_b32 exec_hi, -1
    s_mov_b32 s50, 0
    s_add_u32 s60, s60, 16384
    v_add_u32 v5, 16384, v5
    s_sub_u32 s31, s48, 4
    v_cvt_f32_i32 v252, s31
    v_mul_f32 v252, 0x3d800000, v252
    v_and_b32 v251, 15, v2
    v_lshlrev_b32 v251, 2, v251
    v_cvt_f32_u32 v251, v251
    v_fma_f32 v250, v212, v251, v252
    v_sin_f32 v84, v250
    v_cos_f32 v250, v250
    s_nop 0
    v_cvt_pk_f16_f32 v80, v250, v84
    v_cvt_pk_f16_f32 v84, -v84, v250
    v_fma_f32 v250, v213, v251, v252
    v_sin_f32 v85, v250
    v_cos_f32 v250, v250
    s_nop 0
    v_cvt_pk_f16_f32 v81, v250, v85
    v_cvt_pk_f16_f32 v85, -v85, v250
    v_fma_f32 v250, v214, v251, v252
    v_sin_f32 v86, v250
    v_cos_f32 v250, v250
    s_nop 0
    v_cvt_pk_f16_f32 v82, v250, v86
    v_cvt_pk_f16_f32 v86, -v86, v250
    v_fma_f32 v250, v215, v251, v252
    v_sin_f32 v87, v250
    v_cos_f32 v250, v250
    s_nop 0
    v_cvt_pk_f16_f32 v83, v250, v87
    v_cvt_pk_f16_f32 v87, -v87, v250
    s_branch L_st23
L_p1_done:
    s_mov_b64 exec, 1
    ds_add_u32 v0, v255 offset:42828
    s_mov_b64 exec, -1
    s_setprio 0
    v_mov_b32 v4, v112
    v_mov_b32 v5, v113
    v_mov_b32 v249, v114
    v_mov_b32 v205, v115
    v_mov_b32 v248, v116
    v_mov_b32 v208, v117
    v_mov_b32 v7, v118
    v_mov_b32 v6, v119
    s_and_b32 s31, s2, 7
    s_sub_u32 s32, 8, s31
    s_min_u32 s46, s31, s32
    s_lshr_b32 s53, s31, 2
    s_lshr_b32 s47, s2, 3
    s_and_b32 s32, s47, 1
    s_and_b32 s31, s31, 3
    s_cselect_b32 s53, s53, s32
    s_cselect_b32 s31, 0, 1
    s_lshr_b32 s47, s47, s31
    s_lshl_b32 s53, s53, 4
    s_lshl_b32 s31, s30, 5
    s_add_u32 s53, s53, s31
    s_lshl_b32 s48, s46, 1
    s_add_u32 s48, s48, 2040
    s_mov_b32 s49, 32768
    v_mov_b32 v212, v210
    v_mov_b32 v213, v210
    v_mov_b32 v214, v210
    v_mov_b32 v215, v210
    s_cmp_ge_u32 s2, 224
    s_cbranch_scc1 L_zst_go
L_sync4:
    ds_read_b32 v1, v0 offset:42840
    s_add_u32 s92, s92, 1
    s_bitcmp1_b32 s92, 20
    s_cbranch_scc1 L_sync4x
    s_waitcnt lgkmcnt(0)
    v_readfirstlane_b32 s31, v1
    s_nop 0
    s_cmp_ge_u32 s31, 1
    s_cbranch_scc0 L_sync4
L_sync4x:
L_zst_go:
    s_mov_b32 exec_hi, s72
    buffer_store_dwordx4 v[176:179], v209, s[12:15], s60 offen sc1
    s_mov_b32 exec_hi, s73
    buffer_store_dwordx4 v[180:183], v209, s[12:15], s61 offen sc1
    buffer_store_dwordx4 v[184:187], v209, s[12:15], s62 offen sc1
    buffer_store_dwordx4 v[188:191], v209, s[12:15], s63 offen sc1
    s_mov_b32 exec_hi, -1
L_sync5:
    ds_read_b32 v1, v0 offset:42860
    s_add_u32 s92, s92, 1
    s_bitcmp1_b32 s92, 20
    s_cbranch_scc1 L_sync5x
    s_waitcnt lgkmcnt(0)
    v_readfirstlane_b32 s31, v1
    s_nop 0
    s_cmp_ge_u32 s31, 1
    s_cbranch_scc0 L_sync5
L_sync5x:
    buffer_load_dwordx4 v[24:27], v6, s[12:15], s49 offen
    s_add_u32 m0, s76, 0
    s_nop 0
    buffer_load_dwordx4 v4, s[8:11], 0 offen lds
    s_add_u32 m0, s76, 1024
    s_nop 0
    buffer_load_dwordx4 v5, s[8:11], 0 offen lds
    v_and_b32 v160, 15, v2
    v_add_u32 v160, s53, v160
    v_cvt_f32_u32 v160, v160
    v_add_f32 v160, 0.5, v160
    v_mul_f32 v160, 0x3b800000, v160
    v_and_b32 v161, 32, v2
    v_bfe_u32 v162, v2, 4, 1
    v_lshl_add_u32 v161, v162, 3, v161
    v_cvt_f32_u32 v161, v161
    v_mul_f32 v161, v161, v160
    v_fmamk_f32 v88, v160, 0x0, v161
    v_fmamk_f32 v162, v160, 0x40000000, v161
    v_sin_f32 v104, v88
    v_sin_f32 v163, v162
    v_cos_f32 v88, v88
    v_cos_f32 v162, v162
    v_cvt_pk_f16_f32 v104, v104, v163
    v_cvt_pk_f16_f32 v88, v88, v162
    v_fmamk_f32 v89, v160, 0x40800000, v161
    v_fmamk_f32 v162, v160, 0x40c00000, v161
    v_sin_f32 v105, v89
    v_sin_f32 v163, v162
    v_cos_f32 v89, v89
    v_cos_f32 v162, v162
    v_cvt_pk_f16_f32 v105, v105, v163
    v_cvt_pk_f16_f32 v89, v89, v162
    v_fmamk_f32 v90, v160, 0x41800000, v161
    v_fmamk_f32 v162, v160, 0x41900000, v161
    v_sin_f32 v106, v90
    v_sin_f32 v163, v162
    v_cos_f32 v90, v90
    v_cos_f32 v162, v162
    v_cvt_pk_f16_f32 v106, v106, v163
    v_cvt_pk_f16_f32 v90, v90, v162
    v_fmamk_f32 v91, v160, 0x41a00000, v161
    v_fmamk_f32 v162, v160, 0x41b00000, v161
    v_sin_f32 v107, v91
    v_sin_f32 v163, v162
    v_cos_f32 v91, v91
    v_cos_f32 v162, v162
    v_cvt_pk_f16_f32 v107, v107, v163
    v_cvt_pk_f16_f32 v91, v91, v162
    v_fmamk_f32 v92, v160, 0x42800000, v161
    v_fmamk_f32 v162, v160, 0x42840000, v161
    v_sin_f32 v108, v92
    v_sin_f32 v163, v162
    v_cos_f32 v92, v92
    v_cos_f32 v162, v162
    v_cvt_pk_f16_f32 v108, v108, v163
    v_cvt_pk_f16_f32 v92, v92, v162
    v_fmamk_f32 v93, v160, 0x42880000, v161
    v_fmamk_f32 v162, v160, 0x428c0000, v161
    v_sin_f32 v109, v93
    v_sin_f32 v163, v162
    v_cos_f32 v93, v93
    v_cos_f32 v162, v162
    v_cvt_pk_f16_f32 v109, v109, v163
    v_cvt_pk_f16_f32 v93, v93, v162
    v_fmamk_f32 v94, v160, 0x42a00000, v161
    v_fmamk_f32 v162, v160, 0x42a40000, v161
    v_sin_f32 v110, v94
    v_sin_f32 v163, v162
    v_cos_f32 v94, v94
    v_cos_f32 v162, v162
    v_cvt_pk_f16_f32 v110, v110, v163
    v_cvt_pk_f16_f32 v94, v94, v162
    v_fmamk_f32 v95, v160, 0x42a80000, v161
    v_fmamk_f32 v162, v160, 0x42ac0000, v161
    v_sin_f32 v111, v95
    v_sin_f32 v163, v162
    v_cos_f32 v95, v95
    v_cos_f32 v162, v162
    v_cvt_pk_f16_f32 v111, v111, v163
    v_cvt_pk_f16_f32 v95, v95, v162
    v_fmamk_f32 v96, v160, 0x3f800000, v161
    v_fmamk_f32 v162, v160, 0x40400000, v161
    v_sin_f32 v112, v96
    v_sin_f32 v163, v162
    v_cos_f32 v96, v96
    v_cos_f32 v162, v162
    v_cvt_pk_f16_f32 v112, v112, v163
    v_cvt_pk_f16_f32 v96, v96, v162
    v_fmamk_f32 v97, v160, 0x40a00000, v161
    v_fmamk_f32 v162, v160, 0x40e00000, v161
    v_sin_f32 v113, v97
    v_sin_f32 v163, v162
    v_cos_f32 v97, v97
    v_cos_f32 v162, v162
    v_cvt_pk_f16_f32 v113, v113, v163
    v_cvt_pk_f16_f32 v97, v97, v162
    v_fmamk_f32 v98, v160, 0x41880000, v161
    v_fmamk_f32 v162, v160, 0x41980000, v161
    v_sin_f32 v114, v98
    v_sin_f32 v163, v162
    v_cos_f32 v98, v98
    v_cos_f32 v162, v162
    v_cvt_pk_f16_f32 v114, v114, v163
    v_cvt_pk_f16_f32 v98, v98, v162
    v_fmamk_f32 v99, v160, 0x41a80000, v161
    v_fmamk_f32 v162, v160, 0x41b80000, v161
    v_sin_f32 v115, v99
    v_sin_f32 v163, v162
    v_cos_f32 v99, v99
    v_cos_f32 v162, v162
    v_cvt_pk_f16_f32 v115, v115, v163
    v_cvt_pk_f16_f32 v99, v99, v162
    v_fmamk_f32 v100, v160, 0x42820000, v161
    v_fmamk_f32 v162, v160, 0x42860000, v161
    v_sin_f32 v116, v100
    v_sin_f32 v163, v162
    v_cos_f32 v100, v100
    v_cos_f32 v162, v162
    v_cvt_pk_f16_f32 v116, v116, v163
    v_cvt_pk_f16_f32 v100, v100, v162
    v_fmamk_f32 v101, v160, 0x428a0000, v161
    v_fmamk_f32 v162, v160, 0x428e0000, v161
    v_sin_f32 v117, v101
    v_sin_f32 v163, v162
    v_cos_f32 v101, v101
    v_cos_f32 v162, v162
    v_cvt_pk_f16_f32 v117, v117, v163
    v_cvt_pk_f16_f32 v101, v101, v162
    v_fmamk_f32 v102, v160, 0x42a20000, v161
    v_fmamk_f32 v162, v160, 0x42a60000, v161
    v_sin_f32 v118, v102
    v_sin_f32 v163, v162
    v_cos_f32 v102, v102
    v_cos_f32 v162, v162
    v_cvt_pk_f16_f32 v118, v118, v163
    v_cvt_pk_f16_f32 v102, v102, v162
    v_fmamk_f32 v103, v160, 0x42aa0000, v161
    v_fmamk_f32 v162, v160, 0x42ae0000, v161
    v_sin_f32 v119, v103
    v_sin_f32 v163, v162
    v_cos_f32 v103, v103
    v_cos_f32 v162, v162
    v_cvt_pk_f16_f32 v119, v119, v163
    v_cvt_pk_f16_f32 v103, v103, v162
    v_cmp_gt_u32 vcc, 16, v2
    v_and_b32 v162, 1, v2
    v_lshlrev_b32 v162, 15, v162
    v_or_b32 v162, 0x3c00, v162
    v_and_b32 v160, 0xffff0000, v104
    v_or_b32 v162, v162, v160
    v_cndmask_b32 v104, v104, v162, vcc
    s_mul_i32 s51, s46, 528384
    s_add_u32 s51, s51, 2097152
    s_mul_i32 s54, s47, 16512
    s_lshl_b32 s32, s30, 12
    s_add_u32 s50, s51, s54
    s_add_u32 s50, s50, s32
    s_add_u32 s55, s47, 1
    s_and_b32 s55, s55, 31
    s_mul_i32 s55, s55, 16512
    v_add_u32 v250, s32, v3
    v_add_u32 v199, s76, v3
    v_lshl_add_u32 v200, v2, 7, s32
    v_and_b32 v1, 2, v2
    v_lshl_add_u32 v200, v1, 3, v200
    v_and_b32 v1, 0x70, v3
    v_add_u32 v1, 16384, v1
    s_mov_b32 vcc_lo, 0
    s_mov_b32 vcc_hi, -1
    v_cndmask_b32 v200, v200, v1, vcc
    s_mov_b32 vcc_hi, 0xff
    v_mov_b32 v1, s55
    v_mov_b32 v201, s54
    v_cndmask_b32 v1, v1, v201, vcc
    v_mov_b32 v201, 16640
    v_cndmask_b32 v201, v201, v0, vcc
    v_add_u32 v201, v201, v200
    v_add_u32 v200, v1, v200
    v_lshrrev_b32 v251, 5, v2
    v_lshlrev_b32 v251, 11, v251
    v_bfe_u32 v1, v2, 2, 3
    v_lshl_add_u32 v251, v1, 7, v251
    v_and_b32 v1, 3, v2
    v_lshl_add_u32 v251, v1, 5, v251
    v_bfe_u32 v1, v2, 3, 1
    v_lshl_add_u32 v251, v1, 4, v251
    v_bfe_u32 v1, v2, 4, 1
    v_lshl_add_u32 v251, v1, 3, v251
    v_xor_b32 v252, 16, v251
    v_xor_b32 v253, 8, v251
    v_xor_b32 v254, 24, v251
    v_cmp_gt_u32 vcc, 4, v2
    v_mov_b32 v1, 16384
    s_nop 0
    v_cndmask_b32 v1, v0, v1, vcc
    v_add_u32 v206, v253, v1
    v_add_u32 v207, v254, v1
    s_mov_b32 vcc_lo, 0x88888888
    s_mov_b32 vcc_hi, 0x88888888
    v_mov_b32 v1, 16544
    v_cndmask_b32 v1, 32, v1, vcc
    v_add_u32 v202, v251, v1
    v_add_u32 v203, v253, v1
    v_add_u32 v204, v206, v1
    s_waitcnt vmcnt(0)
L_stat_check:
    v_cmp_ne_u64 vcc, s[28:29], v[26:27]
    s_nop 0
    s_cbranch_vccz L_stat_got
    s_cmp_eq_u32 s35, 0
    s_cbranch_scc1 L_stat_got
    s_sub_u32 s35, s35, 1
    s_sleep 2
    s_mov_b64 exec, vcc
    buffer_load_dwordx4 v[24:27], v6, s[12:15], s49 offen sc1
    s_mov_b64 exec, -1
    s_waitcnt vmcnt(0)
    s_branch L_stat_check
L_stat_got:
    v_cndmask_b32 v24, v24, v25, s[88:89]
    v_mov_b32 v32, v24
    s_nop 1
    v_permlane32_swap_b32 v24, v32
    v_mov_b32 v28, v24
    v_mov_b32 v36, v32
    s_nop 0
    v_permlane16_swap_b32 v24, v28
    v_permlane16_swap_b32 v32, v36
    v_lshlrev_b32 v26, 16, v24
    v_and_b32 v24, 0xffff0000, v24
    v_rcp_f32 v24, v24
    v_lshlrev_b32 v30, 16, v28
    v_and_b32 v28, 0xffff0000, v28
    v_rcp_f32 v28, v28
    v_lshlrev_b32 v34, 16, v32
    v_and_b32 v32, 0xffff0000, v32
    v_rcp_f32 v32, v32
    v_lshlrev_b32 v38, 16, v36
    v_and_b32 v36, 0xffff0000, v36
    v_rcp_f32 v36, v36
    v_mul_f32 v24, 0xbfb8aa3b, v24
    v_mul_f32_e64 v26, -v26, v24
    v_mul_f32 v28, 0xbfb8aa3b, v28
    v_mul_f32_e64 v30, -v30, v28
    v_mul_f32 v32, 0xbfb8aa3b, v32
    v_mul_f32_e64 v34, -v34, v32
    v_mul_f32 v36, 0xbfb8aa3b, v36
    v_mul_f32_e64 v38, -v38, v36
    ds_read_b128 v[8:11], v208 offset:0
    ds_read_b128 v[12:15], v208 offset:1024
    s_waitcnt lgkmcnt(0)
    v_lshlrev_b32 v40, 16, v8
    v_and_b32 v41, 0xffff0000, v8
    v_lshlrev_b32 v42, 16, v9
    v_and_b32 v43, 0xffff0000, v9
    v_lshlrev_b32 v44, 16, v10
    v_and_b32 v45, 0xffff0000, v10
    v_lshlrev_b32 v46, 16, v11
    v_and_b32 v47, 0xffff0000, v11
    v_lshlrev_b32 v48, 16, v12
    v_and_b32 v55, 0xffff0000, v12
    v_lshlrev_b32 v54, 16, v13
    v_and_b32 v53, 0xffff0000, v13
    v_lshlrev_b32 v52, 16, v14
    v_and_b32 v51, 0xffff0000, v14
    v_lshlrev_b32_e64 v50, 16, v15
    v_and_b32 v49, 0xffff0000, v15
    v_pk_fma_f32 v[120:121], v[40:41], v[24:25], v[26:27] op_sel_hi:[1,0,0]
    v_pk_fma_f32 v[122:123], v[42:43], v[24:25], v[26:27] op_sel_hi:[1,0,0]
    v_pk_fma_f32 v[124:125], v[44:45], v[24:25], v[26:27] op_sel_hi:[1,0,0]
    v_pk_fma_f32 v[126:127], v[46:47], v[24:25], v[26:27] op_sel_hi:[1,0,0]
    v_pk_fma_f32 v[128:129], v[48:49], v[28:29], v[30:31] op_sel_hi:[1,0,0]
    v_pk_fma_f32 v[130:131], v[50:51], v[28:29], v[30:31] op_sel_hi:[1,0,0]
    v_pk_fma_f32 v[132:133], v[52:53], v[28:29], v[30:31] op_sel_hi:[1,0,0]
    v_pk_fma_f32 v[134:135], v[54:55], v[28:29], v[30:31] op_sel_hi:[1,0,0]
    v_exp_f32 v216, v120
    v_exp_f32 v217, v121
    v_exp_f32 v218, v122
    v_exp_f32 v219, v123
    v_exp_f32 v220, v124
    v_exp_f32 v221, v125
    v_exp_f32 v222, v126
    v_exp_f32 v223, v127
    v_exp_f32 v224, v128
    v_exp_f32 v225, v129
    v_exp_f32 v226, v130
    v_exp_f32 v227, v131
    v_exp_f32 v228, v132
    v_exp_f32 v229, v133
    v_exp_f32 v230, v134
    v_exp_f32 v231, v135
    v_pk_add_f32 v[216:217], v[216:217], 1.0 op_sel_hi:[1,0]
    v_pk_add_f32 v[218:219], v[218:219], 1.0 op_sel_hi:[1,0]
    v_pk_add_f32 v[220:221], v[220:221], 1.0 op_sel_hi:[1,0]
    v_pk_add_f32 v[222:223], v[222:223], 1.0 op_sel_hi:[1,0]
    v_pk_add_f32 v[224:225], v[224:225], 1.0 op_sel_hi:[1,0]
    v_pk_add_f32 v[226:227], v[226:227], 1.0 op_sel_hi:[1,0]
    v_pk_add_f32 v[228:229], v[228:229], 1.0 op_sel_hi:[1,0]
    v_pk_add_f32 v[230:231], v[230:231], 1.0 op_sel_hi:[1,0]
    v_rcp_f32 v216, v216
    v_rcp_f32 v217, v217
    v_rcp_f32 v218, v218
    v_rcp_f32 v219, v219
    v_rcp_f32 v220, v220
    v_rcp_f32 v221, v221
    v_rcp_f32 v222, v222
    v_rcp_f32 v223, v223
    v_rcp_f32 v224, v224
    v_rcp_f32 v225, v225
    v_rcp_f32 v226, v226
    v_rcp_f32 v227, v227
    v_rcp_f32 v228, v228
    v_rcp_f32 v229, v229
    v_rcp_f32 v230, v230
    v_rcp_f32 v231, v231
    v_pk_mul_f32 v[120:121], v[120:121], v[216:217]
    v_pk_mul_f32 v[122:123], v[122:123], v[218:219]
    v_pk_mul_f32 v[124:125], v[124:125], v[220:221]
    v_pk_mul_f32 v[126:127], v[126:127], v[222:223]
    v_pk_mul_f32 v[128:129], v[128:129], v[224:225]
    v_pk_mul_f32 v[130:131], v[130:131], v[226:227]
    v_pk_mul_f32 v[132:133], v[132:133], v[228:229]
    v_pk_mul_f32 v[134:135], v[134:135], v[230:231]
L_sync6:
    ds_read_b32 v1, v0 offset:42848
    s_add_u32 s92, s92, 1
    s_bitcmp1_b32 s92, 20
    s_cbranch_scc1 L_sync6x
    s_waitcnt lgkmcnt(0)
    v_readfirstlane_b32 s31, v1
    s_nop 0
    s_cmp_ge_u32 s31, 4
    s_cbranch_scc0 L_sync6
L_sync6x:
    s_add_u32 m0, s76, 2048
    s_nop 0
    buffer_load_dwordx4 v249, s[8:11], 0 offen lds
    s_add_u32 m0, s76, 3072
    s_nop 0
    buffer_load_dwordx4 v205, s[8:11], 0 offen lds
L_sync7:
    ds_read_b32 v1, v0 offset:42844
    ds_read_b32 v198, v0 offset:41556
    s_add_u32 s92, s92, 1
    s_bitcmp1_b32 s92, 20
    s_cbranch_scc1 L_sync7x
    s_waitcnt lgkmcnt(1)
    v_readfirstlane_b32 s31, v1
    s_nop 0
    s_cmp_ge_u32 s31, 1
    s_cbranch_scc0 L_sync7
L_sync7x:
    v_and_b32 v6, 48, v2
    v_lshlrev_b32 v6, 1, v6
    v_mov_b32 v209, 2147483392
    s_waitcnt lgkmcnt(0)
    v_readfirstlane_b32 s33, v198
    s_nop 0
    s_andn2_b32 s33, 0x7ff, s33
    s_sub_u32 s31, 0, s33
    s_and_b32 s31, s31, 2047
    s_sub_u32 s32, s33, 1024
    s_sub_u32 s34, s31, 1024
    v_cmp_eq_u32 vcc, s33, v7
    v_cmp_eq_u32 s[54:55], s33, v248
    s_nop 0
    v_cndmask_b32 v4, v4, v209, vcc
    v_cmp_eq_u32 vcc, s31, v7
    v_cmp_eq_u32 s[56:57], s31, v248
    s_nop 0
    v_cndmask_b32 v5, v5, v209, vcc
    v_cmp_eq_u32 vcc, s32, v7
    v_cmp_eq_u32 s[58:59], s32, v248
    s_nop 0
    v_cndmask_b32 v249, v249, v209, vcc
    v_cmp_eq_u32 vcc, s34, v7
    v_cmp_eq_u32 s[60:61], s34, v248
    s_nop 0
    v_cndmask_b32 v205, v205, v209, vcc
    s_or_b64 s[62:63], s[54:55], s[58:59]
    s_or_b64 s[64:65], s[56:57], s[60:61]
    s_waitcnt vmcnt(0)
    buffer_load_dwordx4 v[72:75], v3, s[12:15], s50 offen offset:0 sc1
    buffer_load_dwordx4 v[76:79], v3, s[12:15], s50 offen offset:1024 sc1
    buffer_load_dwordx4 v[80:83], v3, s[12:15], s50 offen offset:2048 sc1
    buffer_load_dwordx4 v[84:87], v3, s[12:15], s50 offen offset:3072 sc1
    s_mov_b32 exec_hi, 0x1ff
    buffer_load_dwordx4 v[212:215], v200, s[12:15], s51 offen sc1
    s_mov_b32 exec_hi, -1
    s_setprio 2
    ds_read_b128 v[16:19], v208 offset:2048
    ds_read_b128 v[20:23], v208 offset:3072
    s_waitcnt lgkmcnt(0)
    v_lshlrev_b32 v56, 16, v16
    v_and_b32 v57, 0xffff0000, v16
    v_lshlrev_b32 v58, 16, v17
    v_and_b32 v59, 0xffff0000, v17
    v_lshlrev_b32 v60, 16, v18
    v_and_b32 v61, 0xffff0000, v18
    v_lshlrev_b32 v62, 16, v19
    v_and_b32 v63, 0xffff0000, v19
    v_lshlrev_b32 v64, 16, v20
    v_and_b32 v71, 0xffff0000, v20
    v_lshlrev_b32 v70, 16, v21
    v_and_b32 v69, 0xffff0000, v21
    v_lshlrev_b32 v68, 16, v22
    v_and_b32 v67, 0xffff0000, v22
    v_lshlrev_b32 v66, 16, v23
    v_and_b32 v65, 0xffff0000, v23
    v_pk_fma_f32 v[136:137], v[56:57], v[32:33], v[34:35] op_sel_hi:[1,0,0]
    v_pk_fma_f32 v[138:139], v[58:59], v[32:33], v[34:35] op_sel_hi:[1,0,0]
    v_pk_fma_f32 v[140:141], v[60:61], v[32:33], v[34:35] op_sel_hi:[1,0,0]
    v_pk_fma_f32 v[142:143], v[62:63], v[32:33], v[34:35] op_sel_hi:[1,0,0]
    v_pk_fma_f32 v[144:145], v[64:65], v[36:37], v[38:39] op_sel_hi:[1,0,0]
    v_pk_fma_f32 v[146:147], v[66:67], v[36:37], v[38:39] op_sel_hi:[1,0,0]
    v_pk_fma_f32 v[148:149], v[68:69], v[36:37], v[38:39] op_sel_hi:[1,0,0]
    v_pk_fma_f32 v[150:151], v[70:71], v[36:37], v[38:39] op_sel_hi:[1,0,0]
    v_exp_f32 v232, v136
    v_exp_f32 v233, v137
    v_exp_f32 v234, v138
    v_exp_f32 v235, v139
    v_exp_f32 v236, v140
    v_exp_f32 v237, v141
    v_exp_f32 v238, v142
    v_exp_f32 v239, v143
    v_exp_f32 v240, v144
    v_exp_f32 v241, v145
    v_exp_f32 v242, v146
    v_exp_f32 v243, v147
    v_exp_f32 v244, v148
    v_exp_f32 v245, v149
    v_exp_f32 v246, v150
    v_exp_f32 v247, v151
    v_pk_add_f32 v[232:233], v[232:233], 1.0 op_sel_hi:[1,0]
    v_pk_add_f32 v[234:235], v[234:235], 1.0 op_sel_hi:[1,0]
    v_pk_add_f32 v[236:237], v[236:237], 1.0 op_sel_hi:[1,0]
    v_pk_add_f32 v[238:239], v[238:239], 1.0 op_sel_hi:[1,0]
    v_pk_add_f32 v[240:241], v[240:241], 1.0 op_sel_hi:[1,0]
    v_pk_add_f32 v[242:243], v[242:243], 1.0 op_sel_hi:[1,0]
    v_pk_add_f32 v[244:245], v[244:245], 1.0 op_sel_hi:[1,0]
    v_pk_add_f32 v[246:247], v[246:247], 1.0 op_sel_hi:[1,0]
    v_rcp_f32 v232, v232
    v_rcp_f32 v233, v233
    v_rcp_f32 v234, v234
    v_rcp_f32 v235, v235
    v_rcp_f32 v236, v236
    v_rcp_f32 v237, v237
    v_rcp_f32 v238, v238
    v_rcp_f32 v239, v239
    v_rcp_f32 v240, v240
    v_rcp_f32 v241, v241
    v_rcp_f32 v242, v242
    v_rcp_f32 v243, v243
    v_rcp_f32 v244, v244
    v_rcp_f32 v245, v245
    v_rcp_f32 v246, v246
    v_rcp_f32 v247, v247
    v_pk_mul_f32 v[136:137], v[136:137], v[232:233]
    v_pk_mul_f32 v[138:139], v[138:139], v[234:235]
    v_pk_mul_f32 v[140:141], v[140:141], v[236:237]
    v_pk_mul_f32 v[142:143], v[142:143], v[238:239]
    v_pk_mul_f32 v[144:145], v[144:145], v[240:241]
    v_pk_mul_f32 v[146:147], v[146:147], v[242:243]
    v_pk_mul_f32 v[148:149], v[148:149], v[244:245]
    v_pk_mul_f32 v[150:151], v[150:151], v[246:247]
L_z_wait:
    s_setprio 2
    s_waitcnt vmcnt(4)
    v_xor_b32 v160, v210, v72
    v_xor_b32 v161, v210, v73
    v_xor_b32 v162, v210, v74
    v_xor_b32 v163, v210, v75
    ds_write_b128 v250, v[160:163] offset:0
    v_or3_b32 v1, v160, v161, v162
    v_or_b32 v1, v1, v163
    s_waitcnt vmcnt(3)
    v_xor_b32 v164, v210, v76
    v_xor_b32 v165, v210, v77
    v_xor_b32 v166, v210, v78
    v_xor_b32 v167, v210, v79
    ds_write_b128 v250, v[164:167] offset:1024
    v_or3_b32 v1, v1, v164, v165
    v_or3_b32 v1, v1, v166, v167
    s_waitcnt vmcnt(2)
    v_xor_b32 v168, v210, v80
    v_xor_b32 v169, v210, v81
    v_xor_b32 v170, v210, v82
    v_xor_b32 v171, v210, v83
    ds_write_b128 v250, v[168:171] offset:2048
    v_or3_b32 v1, v1, v168, v169
    v_or3_b32 v1, v1, v170, v171
    s_waitcnt vmcnt(1)
    v_xor_b32 v172, v210, v84
    v_xor_b32 v173, v210, v85
    v_xor_b32 v174, v210, v86
    v_xor_b32 v175, v210, v87
    ds_write_b128 v250, v[172:175] offset:3072
    v_or3_b32 v1, v1, v172, v173
    v_or3_b32 v1, v1, v174, v175
    s_waitcnt vmcnt(0)
    v_xor_b32 v176, v210, v212
    v_xor_b32 v177, v210, v213
    v_xor_b32 v178, v210, v214
    v_xor_b32 v179, v210, v215
    s_mov_b32 exec_hi, 0x1ff
    ds_write_b128 v201, v[176:179]
    s_mov_b32 exec_hi, -1
    v_or3_b32 v1, v1, v176, v177
    v_or3_b32 v1, v1, v178, v179
    v_and_b32 v1, 0x30003, v1
    v_cmp_ne_u32 vcc, 0, v1
    s_nop 0
    s_cbranch_vccz L_z_got
    s_cmp_eq_u32 s35, 0
    s_cbranch_scc1 L_z_got
    s_sub_u32 s35, s35, 1
    s_sleep 2
    s_mov_b64 exec, vcc
    buffer_load_dwordx4 v[72:75], v3, s[12:15], s50 offen offset:0 sc1
    buffer_load_dwordx4 v[76:79], v3, s[12:15], s50 offen offset:1024 sc1
    buffer_load_dwordx4 v[80:83], v3, s[12:15], s50 offen offset:2048 sc1
    buffer_load_dwordx4 v[84:87], v3, s[12:15], s50 offen offset:3072 sc1
    s_and_b32 exec_hi, exec_hi, 0x1ff
    s_or_b32 exec_lo, exec_lo, 1
    buffer_load_dwordx4 v[212:215], v200, s[12:15], s51 offen sc1
    s_mov_b64 exec, -1
    s_waitcnt lgkmcnt(0)
    s_branch L_z_wait
L_z_got:
    s_mov_b64 exec, 1
    ds_add_u32 v0, v255 offset:42832
    s_mov_b64 exec, -1
L_sync8:
    ds_read_b32 v1, v0 offset:42832
    ds_read_b64_tr_b16 v[152:153], v251 offset:0
    ds_read_b64_tr_b16 v[154:155], v251 offset:1024
    ds_read_b64_tr_b16 v[156:157], v252 offset:0
    ds_read_b64_tr_b16 v[158:159], v252 offset:1024
    s_add_u32 s92, s92, 1
    s_bitcmp1_b32 s92, 20
    s_cbranch_scc1 L_sync8x
    s_waitcnt lgkmcnt(4)
    v_readfirstlane_b32 s31, v1
    s_nop 0
    s_cmp_ge_u32 s31, 4
    s_cbranch_scc0 L_sync8
L_sync8x:
    ds_read_b64_tr_b16 v[160:161], v251 offset:4096
    ds_read_b64_tr_b16 v[162:163], v251 offset:5120
    ds_read_b64_tr_b16 v[164:165], v252 offset:4096
    ds_read_b64_tr_b16 v[166:167], v252 offset:5120
    ds_read_b64_tr_b16 v[168:169], v251 offset:8192
    ds_read_b64_tr_b16 v[170:171], v251 offset:9216
    ds_read_b64_tr_b16 v[172:173], v252 offset:8192
    ds_read_b64_tr_b16 v[174:175], v252 offset:9216
    s_waitcnt lgkmcnt(8)
    v_mfma_f32_16x16x32_f16 v[216:219], v[152:155], v[88:91], 0
    v_mfma_f32_16x16x32_f16 v[220:223], v[156:159], v[88:91], 0
    ds_read_b64_tr_b16 v[176:177], v251 offset:12288
    ds_read_b64_tr_b16 v[178:179], v251 offset:13312
    ds_read_b64_tr_b16 v[180:181], v252 offset:12288
    ds_read_b64_tr_b16 v[182:183], v252 offset:13312
    s_waitcnt lgkmcnt(8)
    v_mfma_f32_16x16x32_f16 v[216:219], v[160:163], v[92:95], v[216:219]
    v_mfma_f32_16x16x32_f16 v[220:223], v[164:167], v[92:95], v[220:223]
    ds_read_b64_tr_b16 v[152:153], v206 offset:0
    ds_read_b64_tr_b16 v[154:155], v253 offset:1024
    ds_read_b64_tr_b16 v[156:157], v207 offset:0
    ds_read_b64_tr_b16 v[158:159], v254 offset:1024
    s_waitcnt lgkmcnt(8)
    v_mfma_f32_16x16x32_f16 v[224:227], v[168:171], v[96:99], 0
    v_mfma_f32_16x16x32_f16 v[228:231], v[172:175], v[96:99], 0
    ds_read_b64_tr_b16 v[160:161], v253 offset:4096
    ds_read_b64_tr_b16 v[162:163], v253 offset:5120
    ds_read_b64_tr_b16 v[164:165], v254 offset:4096
    ds_read_b64_tr_b16 v[166:167], v254 offset:5120
    s_waitcnt lgkmcnt(8)
    v_mfma_f32_16x16x32_f16 v[224:227], v[176:179], v[100:103], v[224:227]
    v_mfma_f32_16x16x32_f16 v[228:231], v[180:183], v[100:103], v[228:231]
    ds_read_b64_tr_b16 v[168:169], v253 offset:8192
    ds_read_b64_tr_b16 v[170:171], v253 offset:9216
    ds_read_b64_tr_b16 v[172:173], v254 offset:8192
    ds_read_b64_tr_b16 v[174:175], v254 offset:9216
    s_waitcnt lgkmcnt(8)
    v_mfma_f32_16x16x32_f16 v[216:219], v[152:155], v[104:107], v[216:219]
    v_mfma_f32_16x16x32_f16 v[220:223], v[156:159], v[104:107], v[220:223]
    ds_read_b64_tr_b16 v[176:177], v253 offset:12288
    ds_read_b64_tr_b16 v[178:179], v253 offset:13312
    ds_read_b64_tr_b16 v[180:181], v254 offset:12288
    ds_read_b64_tr_b16 v[182:183], v254 offset:13312
    s_waitcnt lgkmcnt(8)
    v_mfma_f32_16x16x32_f16 v[216:219], v[160:163], v[108:111], v[216:219]
    v_mfma_f32_16x16x32_f16 v[220:223], v[164:167], v[108:111], v[220:223]
    ds_read_b64_tr_b16 v[72:73], v202 offset:0
    ds_read_b64_tr_b16 v[74:75], v202 offset:1024
    ds_read_b64_tr_b16 v[76:77], v202 offset:4096
    ds_read_b64_tr_b16 v[78:79], v202 offset:5120
    s_waitcnt lgkmcnt(8)
    v_mfma_f32_16x16x32_f16 v[224:227], v[168:171], v[112:115], v[224:227]
    v_mfma_f32_16x16x32_f16 v[228:231], v[172:175], v[112:115], v[228:231]
    ds_read_b64_tr_b16 v[80:81], v202 offset:8192
    ds_read_b64_tr_b16 v[82:83], v202 offset:9216
    ds_read_b64_tr_b16 v[84:85], v202 offset:12288
    ds_read_b64_tr_b16 v[86:87], v202 offset:13312
    s_waitcnt lgkmcnt(8)
    v_mfma_f32_16x16x32_f16 v[224:227], v[176:179], v[116:119], v[224:227]
    v_mfma_f32_16x16x32_f16 v[228:231], v[180:183], v[116:119], v[228:231]
    ds_read_b64_tr_b16 v[240:241], v204 offset:0
    ds_read_b64_tr_b16 v[242:243], v203 offset:1024
    ds_read_b64_tr_b16 v[244:245], v203 offset:4096
    ds_read_b64_tr_b16 v[246:247], v203 offset:5120
    s_waitcnt lgkmcnt(8)
    ds_read_b64_tr_b16 v[184:185], v203 offset:8192
    ds_read_b64_tr_b16 v[186:187], v203 offset:9216
    ds_read_b64_tr_b16 v[188:189], v203 offset:12288
    ds_read_b64_tr_b16 v[190:191], v203 offset:13312
    v_mfma_f32_16x16x32_f16 v[232:235], v[72:75], v[88:91], 0
    v_mfma_f32_16x16x32_f16 v[232:235], v[76:79], v[92:95], v[232:235]
    s_waitcnt lgkmcnt(4)
    v_mfma_f32_16x16x32_f16 v[236:239], v[80:83], v[96:99], 0
    v_mfma_f32_16x16x32_f16 v[236:239], v[84:87], v[100:103], v[236:239]
    v_pk_add_f32 v[152:153], v[216:217], v[224:225]
    v_pk_add_f32 v[154:155], v[218:219], v[226:227]
    v_pk_add_f32 v[156:157], v[220:221], v[228:229]
    v_pk_add_f32 v[158:159], v[222:223], v[230:231]
    v_mfma_f32_16x16x32_f16 v[232:235], v[240:243], v[104:107], v[232:235]
    v_mfma_f32_16x16x32_f16 v[232:235], v[244:247], v[108:111], v[232:235]
    v_pk_fma_f32 v[40:41], v[152:153], v[120:121], v[40:41]
    v_pk_fma_f32 v[42:43], v[154:155], v[122:123], v[42:43]
    v_pk_fma_f32 v[44:45], v[156:157], v[124:125], v[44:45]
    v_pk_fma_f32 v[46:47], v[158:159], v[126:127], v[46:47]
    s_waitcnt lgkmcnt(0)
    s_nop 0
    v_mfma_f32_16x16x32_f16 v[236:239], v[184:187], v[112:115], v[236:239]
    v_mfma_f32_16x16x32_f16 v[236:239], v[188:191], v[116:119], v[236:239]
    v_cvt_pk_bf16_f32 v8, v40, v41
    v_cvt_pk_bf16_f32 v9, v42, v43
    v_cvt_pk_bf16_f32 v10, v44, v45
    v_cvt_pk_bf16_f32 v11, v46, v47
    ds_write_b128 v208, v[8:11] offset:0
    ds_read_b128 v[24:27], v199 offset:0
    v_pk_add_f32 v[160:161], v[216:217], v[224:225] neg_lo:[0,1] neg_hi:[0,1]
    v_pk_add_f32 v[162:163], v[218:219], v[226:227] neg_lo:[0,1] neg_hi:[0,1]
    v_pk_add_f32 v[164:165], v[220:221], v[228:229] neg_lo:[0,1] neg_hi:[0,1]
    v_pk_add_f32 v[166:167], v[222:223], v[230:231] neg_lo:[0,1] neg_hi:[0,1]
    s_cmp_eq_u64 s[62:63], 0
    s_cbranch_scc1 L_nodump0
    s_mov_b64 exec, s[54:55]
    ds_write_b128 v6, v[152:155] offset:42496
    ds_write_b128 v6, v[156:159] offset:42512
    s_mov_b64 exec, s[58:59]
    ds_write_b128 v6, v[160:163] offset:42496
    ds_write_b128 v6, v[164:167] offset:42512
    s_mov_b64 exec, 1
    ds_add_u32 v0, v255 offset:42836
    s_mov_b64 exec, -1
    s_waitcnt lgkmcnt(0)
L_nodump0:
    s_nop 0
    v_pk_fma_f32 v[56:57], v[160:161], v[136:137], v[56:57]
    v_pk_fma_f32 v[58:59], v[162:163], v[138:139], v[58:59]
    v_pk_fma_f32 v[60:61], v[164:165], v[140:141], v[60:61]
    v_pk_fma_f32 v[62:63], v[166:167], v[142:143], v[62:63]
    v_cvt_pk_bf16_f32 v16, v56, v57
    v_cvt_pk_bf16_f32 v17, v58, v59
    v_cvt_pk_bf16_f32 v18, v60, v61
    v_cvt_pk_bf16_f32 v19, v62, v63
    ds_write_b128 v208, v[16:19] offset:2048
    ds_read_b128 v[32:35], v199 offset:2048
    s_waitcnt lgkmcnt(2)
    buffer_store_dwordx4 v[24:27], v4, s[16:19], 0 offen sc1
    v_add_f32 v152, v232, v236
    v_sub_f32 v160, v232, v236
    s_cmp_eq_u64 s[64:65], 0
    s_cbranch_scc1 L_nodump1
    s_mov_b64 exec, s[56:57]
    ds_write_b128 v6, v[152:155] offset:42624
    ds_write_b128 v6, v[156:159] offset:42640
    s_mov_b64 exec, s[60:61]
    ds_write_b128 v6, v[160:163] offset:42624
    ds_write_b128 v6, v[164:167] offset:42640
    s_mov_b64 exec, 1
    ds_add_u32 v0, v255 offset:42864
    s_mov_b64 exec, -1
    s_waitcnt lgkmcnt(0)
L_nodump1:
    v_pk_fma_f32 v[48:49], v[152:153], v[128:129], v[48:49]
    v_pk_fma_f32 v[50:51], v[154:155], v[130:131], v[50:51]
    v_pk_fma_f32 v[52:53], v[156:157], v[132:133], v[52:53]
    v_pk_fma_f32 v[54:55], v[158:159], v[134:135], v[54:55]
    v_cvt_pk_bf16_f32 v12, v48, v55
    v_cvt_pk_bf16_f32 v13, v54, v53
    v_cvt_pk_bf16_f32 v14, v52, v51
    v_cvt_pk_bf16_f32 v15, v50, v49
    ds_write_b128 v208, v[12:15] offset:1024
    ds_read_b128 v[28:31], v199 offset:1024
    s_waitcnt lgkmcnt(2)
    s_nop 0
    buffer_store_dwordx4 v[32:35], v249, s[16:19], 0 offen sc1
    v_pk_fma_f32 v[64:65], v[160:161], v[144:145], v[64:65]
    v_pk_fma_f32 v[66:67], v[162:163], v[146:147], v[66:67]
    v_pk_fma_f32 v[68:69], v[164:165], v[148:149], v[68:69]
    v_pk_fma_f32 v[70:71], v[166:167], v[150:151], v[70:71]
    v_cvt_pk_bf16_f32 v20, v64, v71
    v_cvt_pk_bf16_f32 v21, v70, v69
    v_cvt_pk_bf16_f32 v22, v68, v67
    v_cvt_pk_bf16_f32 v23, v66, v65
    ds_write_b128 v208, v[20:23] offset:3072
    ds_read_b128 v[36:39], v199 offset:3072
    s_waitcnt lgkmcnt(2)
    buffer_store_dwordx4 v[28:31], v5, s[16:19], 0 offen sc1
    s_waitcnt lgkmcnt(0)
    buffer_store_dwordx4 v[36:39], v205, s[16:19], 0 offen sc1
    s_branch L_fin
L_dma_done:
    s_setprio 0
    s_lshr_b32 s31, s47, 2
    s_andn2_b32 s31, s31, s75
    s_add_u32 s50, s31, s46
    s_lshl_b32 s31, s50, 17
    s_bfe_u32 s32, s2, 0x20003
    s_lshl_b32 s32, s32, 2
    s_add_u32 s51, s32, s30
    s_lshl_b32 s32, s51, 7
    s_add_u32 s31, s31, s32
    v_lshrrev_b32 v6, 3, v2
    v_lshlrev_b32 v6, 11, v6
    v_and_b32 v7, 0x70, v3
    v_and_b32 v11, 16, v2
    v_lshlrev_b32 v11, 1, v11
    v_xor_b32 v11, v11, v7
    v_add3_u32 v6, v6, v11, s31
    v_xor_b32 v11, 64, v6
    s_lshl_b32 s74, s30, 13
    s_cmp_lt_u32 s30, 2
    s_mov_b32 s31, 125952
    s_cselect_b32 s31, 60416, s31
    s_add_u32 s74, s74, s31
    s_mov_b32 s60, 4096
    s_mov_b32 s61, 8192
    s_mov_b32 s62, 12288
    v_bfe_u32 v8, v2, 2, 3
    v_lshlrev_b32 v9, 5, v8
    s_lshl_b32 s31, s30, 6
    v_xor_b32 v9, s31, v9
    v_bfe_u32 v8, v2, 2, 2
    v_lshl_add_u32 v9, v8, 8, v9
    v_lshrrev_b32 v8, 4, v2
    v_lshl_add_u32 v9, v8, 11, v9
    v_and_b32 v10, 3, v2
    v_lshl_add_u32 v9, v10, 3, v9
    v_add_u32 v9, 76800, v9
    v_xor_b32 v10, 32, v9
    v_lshlrev_b32 v8, 4, v8
    s_lshr_b32 s31, s30, 1
    s_and_b32 s32, s31, s75
    s_lshl_b32 s32, s32, 8
    v_add_u32 v8, s32, v8
    s_cmp_eq_u32 s75, 0
    s_cselect_b32 s32, 12, 9
    s_lshl_b32 s31, s31, s32
    s_lshl_b32 s32, s46, 3
    s_add_u32 s32, s32, s47
    s_lshl_b32 s32, s32, 9
    s_add_u32 s31, s31, s32
    s_and_b32 s32, s30, 1
    s_lshl_b32 s32, s32, 8
    s_add_u32 s31, s31, s32
    s_add_u32 s31, s31, 262144
    v_lshl_add_u32 v13, v2, 3, s31
    s_waitcnt lgkmcnt(0)
    s_add_u32 s28, s28, 0x7f4a7c15
    s_addc_u32 s29, s29, 0x9e3779b9
    s_and_b32 s31, s28, 0xff
    v_mov_b32 v14, s31
    s_mov_b32 s49, 0xffffff00
    s_cmp_lg_u32 s30, 2
    s_cbranch_scc1 L_no_tlb
    s_mov_b32 s52, s44
    s_mov_b32 s53, s45
    s_mov_b32 s54, 0x400000
    s_mov_b32 s55, 0x00020000
    v_lshlrev_b32 v250, 18, v2
    v_min_u32 v250, 0x3ffffc, v250
    s_mov_b32 exec_lo, 0x1ffff
    s_mov_b32 exec_hi, 0x0
    buffer_load_dword v252, v250, s[52:55], 0 offen
    s_mov_b64 exec, 0x3f
    v_lshlrev_b32 v250, 20, v2
    v_add_u32 v250, 753664, v250
    v_min_u32 v250, 4491392, v250
    buffer_load_dword v251, v250, s[12:15], 0 offen
    s_mov_b64 exec, 3
    v_mul_u32_u24 v250, 0x1f800, v2
    v_add_u32 v250, v250, v6
    buffer_load_dword v253, v250, s[24:27], 0 offen
    s_mov_b64 exec, -1
L_no_tlb:
    s_cmp_lg_u32 s66, 0
    s_cbranch_scc1 L_tagged
    s_mov_b64 exec, 1
    ds_add_u32 v0, v255 offset:42872
    s_mov_b64 exec, -1
L_tagged:
    s_cmp_eq_u32 s30, 3
    s_cbranch_scc1 L_h1
    s_cmp_eq_u32 s66, 0
    s_cbranch_scc1 L_key
    s_cmp_lg_u32 s30, 0
    s_cbranch_scc1 L_follower
    s_setprio 3
    s_waitcnt vmcnt(16)
    s_mov_b64 exec, 1
    ds_add_u32 v0, v255 offset:42868
    s_mov_b64 exec, -1
    s_nop 0
    ds_read_b64_tr_b16 v[36:37], v9 offset:0
    ds_read_b64_tr_b16 v[38:39], v9 offset:1024
    ds_read_b64_tr_b16 v[40:41], v10 offset:0
    ds_read_b64_tr_b16 v[42:43], v10 offset:1024
    ds_read_b64_tr_b16 v[44:45], v9 offset:32768
    ds_read_b64_tr_b16 v[46:47], v9 offset:33792
    ds_read_b64_tr_b16 v[48:49], v10 offset:32768
    ds_read_b64_tr_b16 v[50:51], v10 offset:33792
    ds_read_b64_tr_b16 v[52:53], v9 offset:8192
    ds_read_b64_tr_b16 v[54:55], v9 offset:9216
    ds_read_b64_tr_b16 v[56:57], v10 offset:8192
    ds_read_b64_tr_b16 v[58:59], v10 offset:9216
    ds_read_b64_tr_b16 v[60:61], v9 offset:40960
    ds_read_b64_tr_b16 v[62:63], v9 offset:41984
    s_waitcnt lgkmcnt(12)
    ds_read_b64_tr_b16 v[64:65], v10 offset:40960
    ds_read_b64_tr_b16 v[66:67], v10 offset:41984
    s_waitcnt lgkmcnt(12)
    ds_read_b64_tr_b16 v[68:69], v9 offset:16384
    ds_read_b64_tr_b16 v[70:71], v9 offset:17408
    s_waitcnt lgkmcnt(12)
    ds_read_b64_tr_b16 v[72:73], v10 offset:16384
    ds_read_b64_tr_b16 v[74:75], v10 offset:17408
    s_waitcnt lgkmcnt(12)
    ds_read_b64_tr_b16 v[76:77], v9 offset:49152
    ds_read_b64_tr_b16 v[78:79], v9 offset:50176
    s_waitcnt lgkmcnt(12)
    ds_read_b64_tr_b16 v[80:81], v10 offset:49152
    ds_read_b64_tr_b16 v[82:83], v10 offset:50176
    s_waitcnt vmcnt(8)
    s_mov_b64 exec, 1
    ds_add_u32 v0, v255 offset:42868
    s_mov_b64 exec, -1
    s_branch L_d_first
L_follower:
    v_readfirstlane_b32 s52, v13
    s_and_b32 s32, s30, 1
    s_lshl_b32 s32, s32, 8
    s_sub_u32 s52, s52, s32
    s_lshl_b32 s31, s50, 12
    s_sub_u32 s31, s31, s32
    s_lshl_b32 s32, s51, 8
    s_add_u32 s31, s31, s32
    s_add_u32 s53, s31, 524288
    s_load_dword s54, s[12:13], s52
    s_load_dword s54, s[12:13], s53
    s_add_u32 s52, s52, 64
    s_add_u32 s53, s53, 64
    s_load_dword s54, s[12:13], s52
    s_load_dword s54, s[12:13], s53
    s_add_u32 s52, s52, 64
    s_add_u32 s53, s53, 64
    s_load_dword s54, s[12:13], s52
    s_load_dword s54, s[12:13], s53
    s_add_u32 s52, s52, 64
    s_add_u32 s53, s53, 64
    s_load_dword s54, s[12:13], s52
    s_load_dword s54, s[12:13], s53
    s_add_u32 s52, s52, 64
    s_add_u32 s53, s53, 64
    s_waitcnt lgkmcnt(0)
    s_load_dword s54, s[12:13], s52
    s_load_dword s54, s[12:13], s53
    s_add_u32 s52, s52, 64
    s_add_u32 s53, s53, 64
    s_load_dword s54, s[12:13], s52
    s_load_dword s54, s[12:13], s53
    s_add_u32 s52, s52, 64
    s_add_u32 s53, s53, 64
    s_load_dword s54, s[12:13], s52
    s_load_dword s54, s[12:13], s53
    s_add_u32 s52, s52, 64
    s_add_u32 s53, s53, 64
    s_load_dword s54, s[12:13], s52
    s_load_dword s54, s[12:13], s53
L_sync9:
    ds_read_b32 v1, v0 offset:42868
    s_add_u32 s92, s92, 1
    s_bitcmp1_b32 s92, 20
    s_cbranch_scc1 L_sync9x
    s_waitcnt lgkmcnt(0)
    v_readfirstlane_b32 s31, v1
    s_nop 0
    s_cmp_ge_u32 s31, 1
    s_cbranch_scc0 L_sync9
L_sync9x:
    s_setprio 3
    s_nop 0
    ds_read_b64_tr_b16 v[36:37], v9 offset:0
    ds_read_b64_tr_b16 v[38:39], v9 offset:1024
    ds_read_b64_tr_b16 v[40:41], v10 offset:0
    ds_read_b64_tr_b16 v[42:43], v10 offset:1024
    ds_read_b64_tr_b16 v[44:45], v9 offset:32768
    ds_read_b64_tr_b16 v[46:47], v9 offset:33792
    ds_read_b64_tr_b16 v[48:49], v10 offset:32768
    ds_read_b64_tr_b16 v[50:51], v10 offset:33792
    ds_read_b64_tr_b16 v[52:53], v9 offset:8192
    ds_read_b64_tr_b16 v[54:55], v9 offset:9216
    ds_read_b64_tr_b16 v[56:57], v10 offset:8192
    ds_read_b64_tr_b16 v[58:59], v10 offset:9216
    ds_read_b64_tr_b16 v[60:61], v9 offset:40960
    ds_read_b64_tr_b16 v[62:63], v9 offset:41984
    s_waitcnt lgkmcnt(12)
    ds_read_b64_tr_b16 v[64:65], v10 offset:40960
    ds_read_b64_tr_b16 v[66:67], v10 offset:41984
    s_waitcnt lgkmcnt(12)
    ds_read_b64_tr_b16 v[68:69], v9 offset:16384
    ds_read_b64_tr_b16 v[70:71], v9 offset:17408
    s_waitcnt lgkmcnt(12)
    ds_read_b64_tr_b16 v[72:73], v10 offset:16384
    ds_read_b64_tr_b16 v[74:75], v10 offset:17408
    s_waitcnt lgkmcnt(12)
    ds_read_b64_tr_b16 v[76:77], v9 offset:49152
    ds_read_b64_tr_b16 v[78:79], v9 offset:50176
    s_waitcnt lgkmcnt(12)
    ds_read_b64_tr_b16 v[80:81], v10 offset:49152
    ds_read_b64_tr_b16 v[82:83], v10 offset:50176
    s_add_u32 s67, s30, 0
L_sync10:
    ds_read_b32 v1, v0 offset:42868
    s_add_u32 s92, s92, 1
    s_bitcmp1_b32 s92, 20
    s_cbranch_scc1 L_sync10x
    s_waitcnt lgkmcnt(0)
    v_readfirstlane_b32 s31, v1
    s_nop 0
    s_cmp_ge_u32 s31, s67
    s_cbranch_scc0 L_sync10
L_sync10x:
L_d_first:
    s_add_u32 m0, s74, 0
    s_mov_b32 s31, 0
    buffer_load_dwordx4 v6, s[24:27], s31 offen nt lds
    s_add_u32 m0, s74, 1024
    s_mov_b32 s31, 16384
    buffer_load_dwordx4 v11, s[24:27], s31 offen nt lds
    s_add_u32 m0, s74, 2048
    s_mov_b32 s31, 32768
    buffer_load_dwordx4 v6, s[24:27], s31 offen nt lds
    s_add_u32 m0, s74, 3072
    s_mov_b32 s31, 49152
    buffer_load_dwordx4 v11, s[24:27], s31 offen nt lds
    s_add_u32 m0, s74, 4096
    s_mov_b32 s31, 65536
    buffer_load_dwordx4 v6, s[24:27], s31 offen nt lds
    s_cmp_lg_u32 s30, 0
    s_cbranch_scc1 L_k3_waitp
    s_waitcnt vmcnt(5)
    s_mov_b64 exec, 1
    ds_add_u32 v0, v255 offset:42868
    s_mov_b64 exec, -1
L_k3_waitp:
    s_waitcnt lgkmcnt(4)
    s_branch L_sync11a
L_sync11:
    s_waitcnt lgkmcnt(0)
L_sync11a:
    ds_read_b32 v1, v0 offset:42868
    ds_read_b64_tr_b16 v[84:85], v9 offset:24576
    ds_read_b64_tr_b16 v[86:87], v9 offset:25600
    ds_read_b64_tr_b16 v[88:89], v10 offset:24576
    ds_read_b64_tr_b16 v[90:91], v10 offset:25600
    ds_read_b64_tr_b16 v[92:93], v9 offset:57344
    ds_read_b64_tr_b16 v[94:95], v9 offset:58368
    ds_read_b64_tr_b16 v[96:97], v10 offset:57344
    ds_read_b64_tr_b16 v[98:99], v10 offset:58368
    s_add_u32 s92, s92, 1
    s_bitcmp1_b32 s92, 20
    s_cbranch_scc1 L_sync11x
    s_waitcnt lgkmcnt(8)
    v_readfirstlane_b32 s31, v1
    s_nop 0
    s_cmp_ge_u32 s31, 3
    s_cbranch_scc0 L_sync11
L_sync11x:
L_key:
    s_waitcnt lgkmcnt(0)
L_sync12:
    ds_read_b32 v1, v0 offset:42844
    ds_read_b64 v[18:19], v0 offset:41552
    ds_read_b128 v[20:23], v8 offset:41600
    ds_read_b128 v[24:27], v8 offset:41664
    ds_read_b128 v[28:31], v8 offset:41728
    ds_read_b128 v[32:35], v8 offset:41792
    s_add_u32 s92, s92, 1
    s_bitcmp1_b32 s92, 20
    s_cbranch_scc1 L_sync12x
    s_waitcnt lgkmcnt(5)
    v_readfirstlane_b32 s31, v1
    s_nop 0
    s_cmp_ge_u32 s31, 1
    s_cbranch_scc0 L_sync12
L_sync12x:
    s_cmp_eq_u32 s66, 0
    s_cbranch_scc1 L_idle
    s_branch L_xs_ok
L_h1:
    s_mov_b32 s63, 4096
    s_lshl_b32 s31, s47, 8
    v_lshlrev_b32 v15, 3, v2
    v_add_u32 v16, s31, v15
    s_cmp_lg_u32 s66, 0
    s_cbranch_scc1 L_gate
L_sync13:
    ds_read_b32 v1, v0 offset:42828
    s_add_u32 s92, s92, 1
    s_bitcmp1_b32 s92, 20
    s_cbranch_scc1 L_sync13x
    s_waitcnt lgkmcnt(0)
    v_readfirstlane_b32 s31, v1
    s_nop 0
    s_cmp_ge_u32 s31, 4
    s_cbranch_scc0 L_sync13
L_sync13x:
    s_branch L_gate_open
L_gate:
L_sync14:
    ds_read_b32 v1, v0 offset:42824
    s_add_u32 s92, s92, 1
    s_bitcmp1_b32 s92, 20
    s_cbranch_scc1 L_sync14x
    s_waitcnt lgkmcnt(0)
    v_readfirstlane_b32 s31, v1
    s_nop 0
    s_cmp_ge_u32 s31, 4
    s_cbranch_scc0 L_sync14
L_sync14x:
L_gate_open:
    s_setprio 3
    buffer_load_dwordx4 v[20:23], v3, s[12:15], s63 offen offset:0 sc1
    buffer_load_dwordx4 v[24:27], v3, s[12:15], s63 offen offset:1024 sc1
    buffer_load_dwordx4 v[28:31], v3, s[12:15], s63 offen offset:2048 sc1
    buffer_load_dwordx4 v[32:35], v3, s[12:15], s63 offen offset:3072 sc1
    s_mov_b64 exec, 1
    ds_add_u32 v0, v255 offset:42860
    s_mov_b64 exec, -1
    s_waitcnt vmcnt(0)
L_mi_check:
    v_cmp_ne_u64 s[52:53], s[28:29], v[22:23]
    v_cmp_ne_u64 s[54:55], s[28:29], v[26:27]
    v_cmp_ne_u64 s[56:57], s[28:29], v[30:31]
    v_cmp_ne_u64 s[58:59], s[28:29], v[34:35]
    v_max_u32 v18, v21, v25
    v_max3_u32 v18, v18, v29, v33
    s_or_b64 s[64:65], s[52:53], s[54:55]
    s_or_b64 vcc, s[56:57], s[58:59]
    s_or_b64 s[64:65], s[64:65], vcc
    s_cbranch_scc0 L_mi_got
    s_cmp_eq_u32 s35, 0
    s_cbranch_scc1 L_mi_got
    s_sub_u32 s35, s35, 1
    s_sleep 2
    s_mov_b64 exec, s[52:53]
    s_cbranch_execz L_mi_skip0
    buffer_load_dwordx4 v[20:23], v3, s[12:15], s63 offen offset:0 sc1
L_mi_skip0:
    s_mov_b64 exec, s[54:55]
    s_cbranch_execz L_mi_skip1
    buffer_load_dwordx4 v[24:27], v3, s[12:15], s63 offen offset:1024 sc1
L_mi_skip1:
    s_mov_b64 exec, s[56:57]
    s_cbranch_execz L_mi_skip2
    buffer_load_dwordx4 v[28:31], v3, s[12:15], s63 offen offset:2048 sc1
L_mi_skip2:
    s_mov_b64 exec, s[58:59]
    s_cbranch_execz L_mi_skip3
    buffer_load_dwordx4 v[32:35], v3, s[12:15], s63 offen offset:3072 sc1
L_mi_skip3:
    s_mov_b64 exec, -1
    s_waitcnt vmcnt(0)
    s_branch L_mi_check
L_mi_got:
    v_max_u32_dpp v19, v18, v18 row_ror:1 row_mask:0xf bank_mask:0xf
    s_nop 1
    v_max_u32_dpp v19, v19, v19 row_ror:2 row_mask:0xf bank_mask:0xf
    s_nop 1
    v_max_u32_dpp v19, v19, v19 row_ror:4 row_mask:0xf bank_mask:0xf
    s_nop 1
    v_max_u32_dpp v19, v19, v19 row_ror:8 row_mask:0xf bank_mask:0xf
    s_nop 0
    v_readlane_b32 s33, v19, 0
    v_readlane_b32 s31, v19, 16
    v_readlane_b32 s32, v19, 32
    v_readlane_b32 s34, v19, 48
    s_max_u32 s33, s33, s31
    s_max_u32 s32, s32, s34
    s_max_u32 s33, s33, s32
    s_andn2_b32 s31, 0x7ff, s33
    s_lshl_b32 s48, s31, 11
    buffer_load_dwordx2 v[150:151], v16, s[8:11], s48 offen
    s_mov_b64 exec, 1
    ds_add_u32 v0, v255 offset:42840
    s_mov_b64 exec, -1
    v_cmp_eq_u32 s[52:53], s33, v25
    v_cmp_eq_u32 s[54:55], s33, v29
    v_cmp_eq_u32 s[56:57], s33, v33
    v_cmp_eq_u32 vcc, s33, v18
    v_cndmask_b32 v19, v20, v24, s[52:53]
    v_cndmask_b32 v19, v19, v28, s[54:55]
    v_cndmask_b32 v19, v19, v32, s[56:57]
    s_ff1_i32_b64 s32, vcc
    v_readlane_b32 s34, v19, s32
    v_mov_b32 v19, s33
    s_nop 0
    v_mov_b32 v18, s34
    ds_write_b64 v0, v[18:19] offset:41552
    s_lshl_b32 s52, s34, 16
    s_and_b32 s32, s34, 0xffff0000
    v_rcp_f32 v148, s32
    s_cmp_eq_u32 s66, 0
    s_cbranch_scc1 L_h1_idle
L_sync15:
    ds_read_b32 v1, v0 offset:42868
    s_add_u32 s92, s92, 1
    s_bitcmp1_b32 s92, 20
    s_cbranch_scc1 L_sync15x
    s_waitcnt lgkmcnt(0)
    v_readfirstlane_b32 s31, v1
    s_nop 0
    s_cmp_ge_u32 s31, 1
    s_cbranch_scc0 L_sync15
L_sync15x:
    s_nop 0
    ds_read_b64_tr_b16 v[36:37], v9 offset:0
    ds_read_b64_tr_b16 v[38:39], v9 offset:1024
    ds_read_b64_tr_b16 v[40:41], v10 offset:0
    ds_read_b64_tr_b16 v[42:43], v10 offset:1024
    ds_read_b64_tr_b16 v[44:45], v9 offset:32768
    ds_read_b64_tr_b16 v[46:47], v9 offset:33792
    ds_read_b64_tr_b16 v[48:49], v10 offset:32768
    ds_read_b64_tr_b16 v[50:51], v10 offset:33792
    ds_read_b64_tr_b16 v[52:53], v9 offset:8192
    ds_read_b64_tr_b16 v[54:55], v9 offset:9216
    ds_read_b64_tr_b16 v[56:57], v10 offset:8192
    ds_read_b64_tr_b16 v[58:59], v10 offset:9216
    ds_read_b64_tr_b16 v[60:61], v9 offset:40960
    ds_read_b64_tr_b16 v[62:63], v9 offset:41984
    s_waitcnt lgkmcnt(12)
    ds_read_b64_tr_b16 v[64:65], v10 offset:40960
    ds_read_b64_tr_b16 v[66:67], v10 offset:41984
    s_waitcnt lgkmcnt(12)
    ds_read_b64_tr_b16 v[68:69], v9 offset:16384
    ds_read_b64_tr_b16 v[70:71], v9 offset:17408
    s_waitcnt lgkmcnt(12)
    ds_read_b64_tr_b16 v[72:73], v10 offset:16384
    ds_read_b64_tr_b16 v[74:75], v10 offset:17408
    s_waitcnt lgkmcnt(12)
    ds_read_b64_tr_b16 v[76:77], v9 offset:49152
    ds_read_b64_tr_b16 v[78:79], v9 offset:50176
    s_waitcnt lgkmcnt(12)
    ds_read_b64_tr_b16 v[80:81], v10 offset:49152
    ds_read_b64_tr_b16 v[82:83], v10 offset:50176
    s_waitcnt lgkmcnt(4)
    s_branch L_sync16a
L_sync16:
    s_waitcnt lgkmcnt(0)
L_sync16a:
    ds_read_b32 v1, v0 offset:42868
    ds_read_b64_tr_b16 v[84:85], v9 offset:24576
    ds_read_b64_tr_b16 v[86:87], v9 offset:25600
    ds_read_b64_tr_b16 v[88:89], v10 offset:24576
    ds_read_b64_tr_b16 v[90:91], v10 offset:25600
    ds_read_b64_tr_b16 v[92:93], v9 offset:57344
    ds_read_b64_tr_b16 v[94:95], v9 offset:58368
    ds_read_b64_tr_b16 v[96:97], v10 offset:57344
    ds_read_b64_tr_b16 v[98:99], v10 offset:58368
    s_add_u32 s92, s92, 1
    s_bitcmp1_b32 s92, 20
    s_cbranch_scc1 L_sync16x
    s_waitcnt lgkmcnt(8)
    v_readfirstlane_b32 s31, v1
    s_nop 0
    s_cmp_ge_u32 s31, 3
    s_cbranch_scc0 L_sync16
L_sync16x:
    s_waitcnt vmcnt(0) lgkmcnt(0)
    s_branch L_h1_x
L_h1_idle:
    s_waitcnt vmcnt(0)
L_h1_x:
    v_lshlrev_b32 v20, 16, v150
    v_and_b32 v21, 0xffff0000, v150
    v_lshlrev_b32 v22, 16, v151
    v_and_b32 v23, 0xffff0000, v151
    v_pk_add_f32 v[20:21], v[20:21], s[52:53] op_sel_hi:[1,0] neg_lo:[0,1] neg_hi:[0,1]
    v_pk_add_f32 v[22:23], v[22:23], s[52:53] op_sel_hi:[1,0] neg_lo:[0,1] neg_hi:[0,1]
    v_cvt_pk_bf16_f32 v150, v20, v21
    v_cvt_pk_bf16_f32 v151, v22, v23
    v_lshlrev_b32 v20, 16, v150
    v_and_b32 v21, 0xffff0000, v150
    v_lshlrev_b32 v22, 16, v151
    v_and_b32 v23, 0xffff0000, v151
    v_pk_mul_f32 v[20:21], v[20:21], v[148:149] op_sel_hi:[1,0]
    v_pk_mul_f32 v[22:23], v[22:23], v[148:149] op_sel_hi:[1,0]
    v_cvt_pk_bf16_f32 v150, v20, v21
    v_cvt_pk_bf16_f32 v151, v22, v23
    ds_write_b64 v15, v[150:151] offset:41600
    s_mov_b64 exec, 1
    ds_add_u32 v0, v255 offset:42844
    s_mov_b64 exec, -1
    s_cmp_eq_u32 s66, 0
    s_cbranch_scc1 L_idle
    ds_read_b128 v[20:23], v8 offset:41600
    ds_read_b128 v[24:27], v8 offset:41664
    ds_read_b128 v[28:31], v8 offset:41728
    ds_read_b128 v[32:35], v8 offset:41792
    s_add_u32 m0, s74, 0
    s_mov_b32 s31, 0
    s_nop 0
    buffer_load_dwordx4 v6, s[24:27], s31 offen nt lds
    s_add_u32 m0, s74, 1024
    s_mov_b32 s31, 16384
    buffer_load_dwordx4 v11, s[24:27], s31 offen nt lds
    s_add_u32 m0, s74, 2048
    s_mov_b32 s31, 32768
    buffer_load_dwordx4 v6, s[24:27], s31 offen nt lds
    s_add_u32 m0, s74, 3072
    s_mov_b32 s31, 49152
    buffer_load_dwordx4 v11, s[24:27], s31 offen nt lds
    s_add_u32 m0, s74, 4096
    s_mov_b32 s31, 65536
    buffer_load_dwordx4 v6, s[24:27], s31 offen nt lds
L_xs_ok:
    s_waitcnt lgkmcnt(3)
    v_mfma_f32_16x16x32_bf16 v[132:135], v[20:23], v[36:39], 0
    v_mfma_f32_16x16x32_bf16 v[136:139], v[20:23], v[40:43], 0
    v_mfma_f32_16x16x32_bf16 v[140:143], v[20:23], v[44:47], 0
    v_mfma_f32_16x16x32_bf16 v[144:147], v[20:23], v[48:51], 0
    s_waitcnt lgkmcnt(2)
    v_mfma_f32_16x16x32_bf16 v[132:135], v[24:27], v[52:55], v[132:135]
    v_mfma_f32_16x16x32_bf16 v[136:139], v[24:27], v[56:59], v[136:139]
    v_mfma_f32_16x16x32_bf16 v[140:143], v[24:27], v[60:63], v[140:143]
    v_mfma_f32_16x16x32_bf16 v[144:147], v[24:27], v[64:67], v[144:147]
    s_waitcnt lgkmcnt(1)
    v_mfma_f32_16x16x32_bf16 v[132:135], v[28:31], v[68:71], v[132:135]
    v_mfma_f32_16x16x32_bf16 v[136:139], v[28:31], v[72:75], v[136:139]
    v_mfma_f32_16x16x32_bf16 v[140:143], v[28:31], v[76:79], v[140:143]
    v_mfma_f32_16x16x32_bf16 v[144:147], v[28:31], v[80:83], v[144:147]
    v_readfirstlane_b32 s33, v19
    v_readfirstlane_b32 s34, v18
    s_waitcnt lgkmcnt(0)
    v_mfma_f32_16x16x32_bf16 v[132:135], v[32:35], v[84:87], v[132:135]
    v_mfma_f32_16x16x32_bf16 v[136:139], v[32:35], v[88:91], v[136:139]
    v_mfma_f32_16x16x32_bf16 v[140:143], v[32:35], v[92:95], v[140:143]
    v_mfma_f32_16x16x32_bf16 v[144:147], v[32:35], v[96:99], v[144:147]
    s_mov_b32 vcc_lo, 0xffff0000
    s_mov_b32 vcc_hi, 0
    s_lshl_b32 s31, s50, 12
    s_lshl_b32 s32, s30, 7
    s_add_u32 s31, s31, s32
    s_add_u32 s31, s31, 262144
    v_lshrrev_b32 v15, 3, v2
    v_lshlrev_b32 v15, 9, v15
    v_add3_u32 v15, v15, v7, s31
    v_cndmask_b32 v26, v132, v136, vcc
    v_cndmask_b32 v27, v140, v144, vcc
    v_and_or_b32 v26, v26, s49, v14
    v_and_or_b32 v27, v27, s49, v14
    s_mov_b32 exec_hi, 0
    buffer_store_dwordx2 v[26:27], v13, s[12:15], 0 offen sc1
    s_mov_b64 exec, -1
    s_add_u32 m0, s74, 5120
    s_mov_b32 s31, 81920
    buffer_load_dwordx4 v11, s[24:27], s31 offen nt lds
    s_add_u32 m0, s74, 6144
    s_mov_b32 s31, 98304
    buffer_load_dwordx4 v6, s[24:27], s31 offen nt lds
    s_add_u32 m0, s74, 7168
    s_mov_b32 s31, 114688
    buffer_load_dwordx4 v11, s[24:27], s31 offen nt lds
L_d_done:
    s_mov_b64 exec, 1
    ds_add_u32 v0, v255 offset:42848
    s_mov_b64 exec, -1
    s_cmp_eq_u32 s30, 1
    s_cselect_b32 s31, s2, 0
    s_cmp_lt_u32 s31, 192
    s_cbranch_scc1 L_no_hint
    s_and_b32 s31, s2, 31
    s_lshl_b32 s31, s31, 7
    s_add_u32 s31, s31, 12288
    v_mov_b32 v250, s28
    v_mov_b32 v251, s29
    s_mov_b64 exec, 1
    buffer_store_dwordx2 v[250:251], v0, s[12:15], s31 offen sc1
    s_mov_b64 exec, -1
L_no_hint:
    s_setprio 3
    v_and_b32 v16, 7, v2
    v_lshlrev_b32 v16, 2, v16
    v_lshrrev_b32 v17, 5, v2
    v_lshl_add_u32 v16, v17, 1, v16
    s_lshl_b32 s31, s30, 5
    v_add_u32 v16, s31, v16
    v_and_b32 v17, 48, v2
    v_bfe_u32 v9, v2, 3, 2
    v_lshlrev_b32 v9, 5, v9
    v_bfe_u32 v10, v2, 2, 2
    v_lshl_add_u32 v9, v10, 7, v9
    v_lshl_add_u32 v9, v17, 6, v9
    v_and_b32 v10, 3, v2
    v_lshlrev_b32 v10, 3, v10
    v_add3_u32 v9, v9, v10, s74
    v_xor_b32 v10, 32, v9
    v_xor_b32 v12, 96, v9
    v_xor_b32 v8, 64, v9
    s_lshl_b32 s31, s50, 12
    s_lshl_b32 s32, s51, 8
    s_add_u32 s31, s31, s32
    s_add_u32 s31, s31, 524288
    v_lshl_add_u32 v18, v2, 2, s31
    s_waitcnt vmcnt(5)
    s_waitcnt lgkmcnt(4)
    ds_read_b64_tr_b16 v[100:101], v9 offset:0
    ds_read_b64_tr_b16 v[102:103], v9 offset:512
    ds_read_b64_tr_b16 v[104:105], v10 offset:0
    ds_read_b64_tr_b16 v[106:107], v10 offset:512
    ds_read_b64_tr_b16 v[108:109], v8 offset:0
    ds_read_b64_tr_b16 v[110:111], v8 offset:512
    ds_read_b64_tr_b16 v[112:113], v12 offset:0
    ds_read_b64_tr_b16 v[114:115], v12 offset:512
    s_waitcnt vmcnt(0)
    buffer_load_dwordx4 v[20:23], v15, s[12:15], 0 offen sc1
    s_waitcnt lgkmcnt(4)
    ds_read_b64_tr_b16 v[116:117], v9 offset:4096
    ds_read_b64_tr_b16 v[118:119], v9 offset:4608
    ds_read_b64_tr_b16 v[120:121], v10 offset:4096
    ds_read_b64_tr_b16 v[122:123], v10 offset:4608
    ds_read_b64_tr_b16 v[124:125], v8 offset:4096
    ds_read_b64_tr_b16 v[126:127], v8 offset:4608
    ds_read_b64_tr_b16 v[128:129], v12 offset:4096
    ds_read_b64_tr_b16 v[130:131], v12 offset:4608
    s_mov_b32 s54, 0
    s_branch L_hp_wait
L_hp_poll:
    buffer_load_dwordx4 v[20:23], v15, s[12:15], 0 offen sc1
L_hp_wait:
    s_waitcnt vmcnt(0)
    v_xor_b32 v20, v14, v20
    v_xor_b32 v21, v14, v21
    v_xor_b32 v22, v14, v22
    v_xor_b32 v23, v14, v23
    v_or3_b32 v24, v20, v21, v22
    v_or_b32 v24, v24, v23
    v_and_b32 v24, 0xff, v24
    v_cmp_ne_u32 vcc, 0, v24
    v_permlane16_swap_b32 v20, v21
    v_permlane16_swap_b32 v22, v23
    s_cbranch_vccz L_hp_got
    s_cmp_eq_u32 s35, 0
    s_cbranch_scc1 L_hp_got
    s_sub_u32 s35, s35, 1
    s_branch L_hp_poll
L_hp_got:
    v_add_f32 v20, v20, v21
    v_add_f32 v22, v22, v23
    s_nop 1
    v_permlane32_swap_b32 v20, v22
    v_add_f32 v20, v20, v22
    s_nop 1
    v_add_f32_dpp v21, v20, v20 row_ror:8 row_mask:0xf bank_mask:0xf
    v_add_f32_dpp v20, v20, v20 row_ror:8 row_mask:0xf bank_mask:0xf
    s_nop 1
    v_permlane16_swap_b32 v20, v21
    v_cvt_pk_bf16_f32 v20, v20, v21
    v_and_b32 v21, 0xffff0000, v20
    v_lshlrev_b32 v20, 16, v20
    v_mul_f32 v22, 0xbfb8aa3b, v20
    v_exp_f32 v22, v22
    s_nop 0
    v_add_f32 v22, 1.0, v22
    v_rcp_f32 v22, v22
    s_nop 0
    v_mul_f32 v20, v20, v22
    v_cvt_pk_bf16_f32 v20, v20, v20
    v_lshlrev_b32 v20, 16, v20
    v_mul_f32 v20, v20, v21
    v_cvt_pk_bf16_f32 v20, v20, v20
    ds_write_b16 v16, v20 offset:42368
    s_mov_b64 exec, 1
    ds_add_u32 v0, v255 offset:42852
    s_mov_b64 exec, -1
L_sync17:
    ds_read_b32 v1, v0 offset:42852
    ds_read_b128 v[28:31], v17 offset:42368
    ds_read_b128 v[32:35], v17 offset:42432
    s_add_u32 s92, s92, 1
    s_bitcmp1_b32 s92, 20
    s_cbranch_scc1 L_sync17x
    s_waitcnt lgkmcnt(2)
    v_readfirstlane_b32 s31, v1
    s_nop 0
    s_cmp_ge_u32 s31, 4
    s_cbranch_scc0 L_sync17
L_sync17x:
    s_waitcnt lgkmcnt(1)
    v_mfma_f32_16x16x32_bf16 v[36:39], v[28:31], v[100:103], 0
    v_mfma_f32_16x16x32_bf16 v[40:43], v[28:31], v[104:107], 0
    v_mfma_f32_16x16x32_bf16 v[44:47], v[28:31], v[108:111], 0
    v_mfma_f32_16x16x32_bf16 v[48:51], v[28:31], v[112:115], 0
    s_waitcnt lgkmcnt(0)
    v_mfma_f32_16x16x32_bf16 v[36:39], v[32:35], v[116:119], v[36:39]
    v_mfma_f32_16x16x32_bf16 v[40:43], v[32:35], v[120:123], v[40:43]
    v_mfma_f32_16x16x32_bf16 v[44:47], v[32:35], v[124:127], v[44:47]
    v_mfma_f32_16x16x32_bf16 v[48:51], v[32:35], v[128:131], v[48:51]
    s_mov_b32 vcc_lo, 0xffff0000
    s_mov_b32 vcc_hi, 0xffff0000
    s_mov_b32 s52, 0
    s_mov_b32 s53, -1
    s_nop 1
    v_cndmask_b32 v36, v36, v40, vcc
    s_nop 0
    v_cndmask_b32 v44, v44, v48, vcc
    v_cndmask_b32 v36, v36, v44, s[52:53]
    v_and_or_b32 v36, v36, s49, v14
    buffer_store_dword v36, v18, s[12:15], 0 offen sc1
    s_mov_b64 exec, 1
    ds_add_u32 v0, v255 offset:42856
    s_mov_b64 exec, -1
    s_branch L_owner
L_idle:
    s_mov_b64 exec, 1
    ds_add_u32 v0, v255 offset:42868
    s_mov_b64 exec, -1
    s_and_b32 s52, s2, 31
    s_lshl_b32 s52, s52, 7
    s_add_u32 s52, s52, 12288
L_hint:
    s_load_dwordx2 s[54:55], s[12:13], s52 glc
    s_waitcnt lgkmcnt(0)
    s_cmp_eq_u64 s[54:55], s[28:29]
    s_cbranch_scc1 L_hint_ok
    s_cmp_eq_u32 s35, 0
    s_cbranch_scc1 L_hint_ok
    s_sub_u32 s35, s35, 1
    s_sleep 4
    s_branch L_hint
L_hint_ok:
    s_mov_b64 exec, 1
    ds_add_u32 v0, v255 offset:42848
    s_mov_b64 exec, -1
    s_mov_b64 exec, 1
    ds_add_u32 v0, v255 offset:42852
    s_mov_b64 exec, -1
    s_mov_b64 exec, 1
    ds_add_u32 v0, v255 offset:42856
    s_mov_b64 exec, -1
L_idle_done:
    s_waitcnt lgkmcnt(0)
    v_readfirstlane_b32 s33, v19
    v_readfirstlane_b32 s34, v18
L_owner:
    s_setprio 1
    s_and_b32 s31, s2, 7
    s_sub_u32 s32, 8, s31
    s_min_u32 s46, s31, s32
    s_lshr_b32 s53, s31, 2
    s_lshr_b32 s47, s2, 3
    s_and_b32 s32, s47, 1
    s_and_b32 s31, s31, 3
    s_cselect_b32 s53, s53, s32
    s_cselect_b32 s31, 0, 1
    s_lshr_b32 s47, s47, s31
    s_lshl_b32 s53, s53, 4
    s_lshl_b32 s53, s53, 3
    s_add_u32 s53, s53, s46
    s_andn2_b32 s51, 0x7ff, s33
    s_mov_b32 s54, s51
    s_mov_b32 s55, 0
    s_mov_b32 s56, 0
    s_mov_b32 s16, s44
    s_mov_b32 s17, s45
    s_mov_b32 s18, 0x400000
    v_and_b32 v8, 31, v2
    v_lshlrev_b32 v15, 2, v8
    v_lshlrev_b32 v8, 1, v8
    v_mov_b32 v16, 0
L_seg:
    s_xor_b32 s31, s54, s53
    s_and_b32 s31, s31, 0x87
    s_cbranch_scc1 L_seg_next
    s_lshl_b32 s31, s51, 11
    s_lshl_b32 s32, s47, 6
    s_add_u32 s63, s31, s32
    buffer_load_ushort v9, v8, s[8:11], s63 offen
    v_lshrrev_b32 v4, 3, v2
    s_lshl_b32 s31, s30, 4
    v_add_u32 v4, s31, v4
    v_lshlrev_b32 v4, 12, v4
    s_lshl_b32 s31, s47, 7
    s_add_u32 s31, s31, 524288
    v_add3_u32 v4, v4, v7, s31
    s_mov_b32 s62, 32768
    v_mov_b32 v24, v14
    v_mov_b32 v25, v14
    v_mov_b32 v26, v14
    v_mov_b32 v27, v14
    v_lshrrev_b32 v5, 4, v2
    v_lshl_add_u32 v6, v5, 2, v7
    s_lshl_b32 s31, s30, 7
    s_add_u32 s31, s31, s55
    v_add_u32 v6, s31, v6
    s_ashr_i32 s31, s33, 31
    s_orn2_b32 s31, 0x80000000, s31
    s_xor_b32 s31, s31, s33
    s_and_b32 s31, s31, 0xfffff800
    v_cvt_pk_bf16_f32 v11, s31, s31
    v_lshlrev_b32 v11, 16, v11
    v_mul_f32 v11, 0xbfb8aa3b, v11
    v_exp_f32 v11, v11
    s_and_b32 s32, s34, 0xffff0000
    v_add_f32 v11, 1.0, v11
    v_rcp_f32 v11, v11
    v_rcp_f32 v12, s32
    v_cvt_pk_bf16_f32 v11, v11, v11
    v_lshlrev_b32 v11, 16, v11
    s_lshl_b32 s31, s34, 16
    s_waitcnt vmcnt(0)
    v_lshl_add_u32 v13, v8, 1, s55
    s_mov_b64 vcc, -1
    s_mov_b32 s56, 1
L_y_poll:
    s_mov_b64 exec, vcc
    buffer_load_dwordx4 v[20:23], v4, s[12:15], 0 offen sc1
    s_cmp_eq_u32 s30, 3
    s_cbranch_scc1 L_y_one
    buffer_load_dwordx4 v[24:27], v4, s[12:15], s62 offen sc1
L_y_one:
    s_mov_b64 exec, -1
    s_waitcnt vmcnt(0)
    v_xor_b32 v28, v14, v20
    v_xor_b32 v29, v14, v21
    v_xor_b32 v30, v14, v22
    v_xor_b32 v31, v14, v23
    v_xor_b32 v32, v14, v24
    v_xor_b32 v33, v14, v25
    v_xor_b32 v34, v14, v26
    v_xor_b32 v35, v14, v27
    v_or3_b32 v1, v28, v29, v30
    v_or3_b32 v1, v1, v31, v32
    v_or3_b32 v1, v1, v33, v34
    v_or_b32 v1, v1, v35
    v_and_b32 v1, 0xff, v1
    v_cmp_ne_u32 vcc, 0, v1
    v_pk_add_f32 v[28:29], v[28:29], v[32:33]
    v_pk_add_f32 v[30:31], v[30:31], v[34:35]
    s_cbranch_vccz L_y_got
    s_cmp_eq_u32 s35, 0
    s_cbranch_scc1 L_y_got
    s_sub_u32 s35, s35, 1
    s_branch L_y_poll
L_y_got:
    v_permlane16_swap_b32 v28, v29
    v_permlane16_swap_b32 v30, v31
    v_add_f32 v28, v28, v29
    v_add_f32 v30, v30, v31
    s_nop 1
    v_permlane32_swap_b32 v28, v30
    v_add_f32 v28, v28, v30
    s_nop 1
    v_add_f32_dpp v28, v28, v28 row_ror:8 row_mask:0xf bank_mask:0xf
    ds_write_b32 v6, v28 offset:43008
    s_mov_b64 exec, 1
    ds_add_u32 v16, v255 offset:42836
    s_mov_b64 exec, -1
    s_cmp_lg_u32 s30, 0
    s_cbranch_scc1 L_seg_next
    s_cmp_eq_u32 s47, 0
    s_cselect_b32 s32, 0, 2147483392
    v_mov_b32 v5, 2147483392
    v_writelane_b32 v5, s32, 0
    v_mov_b32 v18, s28
    v_mov_b32 v19, s29
    s_lshl_b32 s31, s34, 16
    v_lshlrev_b32 v9, 16, v9
    v_subrev_f32 v10, s31, v9
    v_cvt_pk_bf16_f32 v10, v10, v10
    v_lshlrev_b32 v10, 16, v10
    v_mul_f32 v10, v10, v12
    v_cvt_pk_bf16_f32 v10, v10, v10
    v_lshlrev_b32 v10, 16, v10
L_sync18:
    ds_read_b32 v1, v16 offset:42836
    ds_read_b32 v20, v13 offset:43008
    ds_read_b32 v21, v13 offset:43136
    ds_read_b32 v22, v13 offset:43264
    ds_read_b32 v23, v13 offset:43392
    ds_read_b32 v24, v15 offset:42496
    s_add_u32 s92, s92, 1
    s_bitcmp1_b32 s92, 20
    s_cbranch_scc1 L_sync18x
    s_waitcnt lgkmcnt(5)
    v_readfirstlane_b32 s31, v1
    s_nop 0
    s_cmp_ge_u32 s31, 5
    s_cbranch_scc0 L_sync18
L_sync18x:
    s_waitcnt lgkmcnt(0)
    v_add_f32 v20, v20, v21
    v_add_f32 v22, v22, v23
    v_add_f32 v20, v20, v22
    v_cvt_pk_bf16_f32 v20, v20, v20
    v_lshlrev_b32 v20, 16, v20
    v_mul_f32 v20, v20, v11
    v_cvt_pk_bf16_f32 v20, v20, v20
    v_lshlrev_b32 v20, 16, v20
    v_add_f32 v20, v20, v10
    v_cvt_pk_bf16_f32 v20, v20, v20
    v_lshlrev_b32 v20, 16, v20
    v_mul_f32 v1, 0xbfb8aa3b, v20
    v_mul_f32 v20, v1, v24
    v_exp_f32 v1, v1
    s_nop 0
    v_add_f32 v1, 1.0, v1
    v_rcp_f32 v1, v1
    s_mov_b32 exec_hi, 0
    v_fma_f32 v20, v20, v1, v9
    v_cvt_pk_bf16_f32 v20, v20, v20
    buffer_store_short v20, v8, s[16:19], s63 offen sc1
    buffer_store_dwordx2 v[18:19], v5, s[12:15], 0 offen sc1
    s_mov_b64 exec, -1
L_seg_next:
    s_cmp_lg_u32 s55, 0
    s_cbranch_scc1 L_seg_end
    s_mov_b32 s55, 512
    s_sub_u32 s54, 0, s51
    s_sub_u32 s47, 31, s47
    v_mov_b32 v16, 28
    v_and_b32 v15, 24, v2
    v_xor_b32 v15, 24, v15
    v_sub_u32 v1, 0, v2
    v_and_b32 v1, 7, v1
    v_add_u32 v15, v15, v1
    v_lshlrev_b32 v15, 2, v15
    v_add_u32 v15, 128, v15
    s_branch L_seg
L_seg_end:
L_fin:
L_exit:
    s_endpgm
L_code_end:
.section .rodata,"a"
.p2align 6
.amdhsa_kernel recurrent_scan__spectral_fnet__moe_arch_mod__prompt_kernel
  .amdhsa_next_free_vgpr 256
  .amdhsa_next_free_sgpr 94
  .amdhsa_accum_offset 256
  .amdhsa_group_segment_fixed_size 0
  .amdhsa_kernarg_size 104
  .amdhsa_user_sgpr_count 2
  .amdhsa_user_sgpr_kernarg_segment_ptr 1
  .amdhsa_system_sgpr_workgroup_id_x 1
  .amdhsa_float_denorm_mode_32 3
.end_amdhsa_kernel
```

```asm
; @launch grid=(256,1,1) block=(512,1,1) lds=158720
.amdgcn_target "amdgcn-amd-amdhsa--gfx950"
.text
.globl recurrent_scan__spectral_fnet__moe_arch_mod__prompt_kernel
.p2align 8
.type recurrent_scan__spectral_fnet__moe_arch_mod__prompt_kernel,@function
recurrent_scan__spectral_fnet__moe_arch_mod__prompt_kernel:
    s_cmp_ge_u32 s2, 256
    s_cbranch_scc1 L_exit
    s_load_dwordx2 s[8:9], s[0:1], 0
    s_load_dwordx4 s[36:39], s[0:1], 48
    s_load_dwordx2 s[12:13], s[0:1], 96
    s_getpc_b64 s[32:33]
L_pc:
    s_bfe_u32 s31, s2, 0x30003
    v_subrev_u32 v3, 492, v0
    v_lshl_add_u32 v3, v3, 3, s31
    v_lshlrev_b32 v3, 7, v3
    v_cmp_gt_u32 vcc, L_code_end-L_pc, v3
    s_nop 0
    s_and_saveexec_b64 s[46:47], vcc
    s_cbranch_execz L_nopf
    global_load_dword v254, v3, s[32:33]
L_nopf:
    s_mov_b64 exec, -1
    v_lshrrev_b32 v1, 6, v0
    v_and_b32 v2, 63, v0
    v_readfirstlane_b32 s30, v1
    s_mov_b32 s10, 0x400000
    s_mov_b32 s11, 0x00020000
    s_mov_b32 s14, 0x10000000
    s_mov_b32 s15, 0x00020000
    s_mov_b32 s35, 65536
    s_mov_b32 s92, 0
    v_lshlrev_b32 v3, 4, v2
    v_mov_b32 v0, 0
    v_mov_b32 v255, 1
    s_mov_b32 s3, s30
    s_and_b32 s30, s30, 3
    s_cmp_ge_u32 s3, 4
    s_cbranch_scc1 L_moe
    s_and_b32 s31, s2, 7
    s_lshr_b32 s32, s2, 4
    s_sub_u32 s32, 15, s32
    s_lshl_b32 s32, s32, 3
    s_add_u32 s46, s32, s31
    s_bfe_u32 s47, s2, 0x10003
    s_lshl_b32 s31, s47, 2
    s_add_u32 s51, s31, s30
    s_lshl_b32 s31, s51, 8
    s_add_u32 s52, s31, s46
    s_xor_b32 s54, s52, 1024
    s_sub_u32 s53, 2048, s52
    s_add_u32 s31, s52, 128
    s_cmp_eq_u32 s46, 0
    s_cselect_b32 s53, s31, s53
    s_cselect_b32 s50, 1, 0
    s_xor_b32 s55, s53, 1024
    s_lshl_b32 s56, s52, 11
    s_lshl_b32 s57, s53, 11
    s_lshl_b32 s58, s54, 11
    s_lshl_b32 s59, s55, 11
    s_mov_b32 s22, 2048
    s_mov_b32 s23, 0x00020000
    v_mov_b32 v1, 0
    v_and_b32 v6, 15, v2
    v_lshlrev_b32 v6, 2, v6
    ds_write_b64 v0, v[0:1] offset:41504
    ds_write_b32 v6, v0 offset:42816
    s_waitcnt lgkmcnt(0)
    s_load_dwordx2 s[28:29], s[12:13], 0
    s_load_dwordx2 s[16:17], s[0:1], 80
    buffer_load_dwordx4 v[120:123], v3, s[8:11], s56 offen
    buffer_load_dwordx4 v[124:127], v3, s[8:11], s56 offen offset:1024
    buffer_load_dwordx4 v[128:131], v3, s[8:11], s57 offen
    buffer_load_dwordx4 v[132:135], v3, s[8:11], s57 offen offset:1024
    s_mov_b32 s20, s36
    s_mov_b32 s21, s37
    buffer_load_dwordx4 v[152:155], v3, s[20:23], 0 offen
    buffer_load_dwordx4 v[156:159], v3, s[20:23], 0 offen offset:1024
    buffer_load_dwordx4 v[136:139], v3, s[8:11], s58 offen
    buffer_load_dwordx4 v[140:143], v3, s[8:11], s58 offen offset:1024
    buffer_load_dwordx4 v[144:147], v3, s[8:11], s59 offen
    buffer_load_dwordx4 v[148:151], v3, s[8:11], s59 offen offset:1024
    s_barrier
    s_branch L_dft_rest
L_moe:
    s_load_dwordx2 s[20:21], s[0:1], 64
    s_and_b32 s32, s2, 7
    s_mul_i32 s32, s32, 28
    s_lshr_b32 s31, s2, 3
    s_add_u32 s31, s31, s32
    s_lshr_b32 s46, s31, 3
    s_lshl_b32 s46, s46, 1
    s_and_b32 s47, s31, 7
    s_mov_b32 s75, 0
    s_mov_b32 s18, 7340032
    s_mov_b32 s19, 0x00020000
    s_mov_b32 s22, 7340032
    s_mov_b32 s23, 0x00020000
    s_mov_b32 s26, 7340032
    s_mov_b32 s27, 0x00020000
    v_lshrrev_b32 v4, 4, v2
    v_lshlrev_b32 v5, 5, v4
    v_and_b32 v6, 0x70, v3
    v_xor_b32 v5, v5, v6
    v_mul_u32_u24 v4, 7168, v4
    s_mul_i32 s31, s47, 917504
    s_lshl_b32 s32, s46, 7
    s_add_u32 s31, s31, s32
    v_add3_u32 v4, v4, v5, s31
    s_cmp_eq_u32 s75, 0
    s_mov_b32 s31, 917504
    s_cselect_b32 s31, 128, s31
    v_add_u32 v6, s31, v4
    s_mov_b32 vcc_lo, 0xff00ff00
    s_mov_b32 vcc_hi, 0xff00ff00
    v_cndmask_b32 v5, v6, v4, vcc
    v_cndmask_b32 v4, v4, v6, vcc
    s_mov_b32 s48, 0
    s_mov_b32 s49, 76800
    s_waitcnt lgkmcnt(0)
    s_mov_b32 s16, s38
    s_mov_b32 s17, s39
    s_load_dwordx2 s[28:29], s[12:13], 0
    s_load_dwordx2 s[24:25], s[0:1], 72
    s_load_dwordx2 s[44:45], s[0:1], 80
    s_barrier
    s_cmp_ge_u32 s2, 224
    s_cselect_b32 s66, 0, 1
    s_cbranch_scc1 L_dma_done
    s_cmp_lg_u32 s30, 0
    s_cbranch_scc1 L_dma_done
    s_setprio 3
L_dma0:
    s_mov_b32 m0, s49
    s_waitcnt vmcnt(20)
    buffer_load_dwordx4 v4, s[16:19], s48 offen nt lds
    s_add_u32 m0, s49, 32768
    s_add_u32 s49, s49, 1024
    s_waitcnt vmcnt(20)
    buffer_load_dwordx4 v4, s[20:23], s48 offen nt lds
    s_add_u32 s48, s48, 28672
    s_mov_b32 m0, s49
    s_waitcnt vmcnt(20)
    buffer_load_dwordx4 v4, s[16:19], s48 offen nt lds
    s_add_u32 m0, s49, 32768
    s_add_u32 s49, s49, 1024
    s_waitcnt vmcnt(20)
    buffer_load_dwordx4 v4, s[20:23], s48 offen nt lds
    s_add_u32 s48, s48, 28672
    s_mov_b32 m0, s49
    s_waitcnt vmcnt(20)
    buffer_load_dwordx4 v5, s[16:19], s48 offen nt lds
    s_add_u32 m0, s49, 32768
    s_add_u32 s49, s49, 1024
    s_waitcnt vmcnt(20)
    buffer_load_dwordx4 v5, s[20:23], s48 offen nt lds
    s_add_u32 s48, s48, 28672
    s_mov_b32 m0, s49
    s_waitcnt vmcnt(20)
    buffer_load_dwordx4 v5, s[16:19], s48 offen nt lds
    s_add_u32 m0, s49, 32768
    s_add_u32 s49, s49, 1024
    s_waitcnt vmcnt(20)
    buffer_load_dwordx4 v5, s[20:23], s48 offen nt lds
    s_add_u32 s48, s48, 28672
    s_cmp_lt_u32 s48, 917504
    s_cbranch_scc1 L_dma0
    s_branch L_dma_done
L_dft_rest:
    s_mov_b32 s18, 0x400000
    s_mov_b32 s19, 0x00020000
    s_sub_u32 s31, 2047, s52
    s_sub_u32 s32, 2047, s53
    v_mov_b32 v200, s31
    v_writelane_b32 v200, s32, 63
    s_lshl_b32 s31, s30, 2
    v_mov_b32 v201, s31
    s_bfe_u32 s31, s53, 0x20008
    s_lshl_b32 s31, s31, 2
    s_add_u32 s31, s31, 16
    v_writelane_b32 v201, s31, 63
    v_and_b32 v6, 32, v2
    s_lshl_b32 s31, s51, 2
    v_add_u32 v203, s31, v6
    v_lshrrev_b32 v202, 1, v203
    s_and_b32 s31, s2, 7
    s_lshl_b32 s31, s31, 9
    s_lshr_b32 s32, s2, 3
    s_lshl_b32 s32, s32, 4
    s_add_u32 s31, s31, s32
    s_add_u32 s31, s31, 4096
    v_mov_b32 v4, s31
    v_lshlrev_b32 v5, 3, v2
    s_and_b32 s31, s52, 7
    s_lshl_b32 s31, s31, 11
    s_and_b32 s32, s52, 1024
    s_add_u32 s31, s31, s32
    s_and_b32 s32, s52, 0xf8
    s_lshl_b32 s32, s32, 2
    s_add_u32 s31, s31, s32
    s_add_u32 s31, s31, 32768
    v_writelane_b32 v4, s31, 0
    s_add_u32 s31, s31, 16
    v_writelane_b32 v4, s31, 1
    s_and_b32 s31, s53, 7
    s_lshl_b32 s31, s31, 11
    s_and_b32 s32, s53, 1024
    s_add_u32 s31, s31, s32
    s_and_b32 s32, s53, 0xf8
    s_lshl_b32 s32, s32, 2
    s_add_u32 s31, s31, s32
    s_add_u32 s31, s31, 32768
    v_writelane_b32 v4, s31, 2
    s_add_u32 s31, s31, 16
    v_writelane_b32 v4, s31, 3
    s_mul_i32 s31, s51, 2592
    v_and_b32 v204, 32, v2
    v_lshlrev_b32 v204, 2, v204
    v_add3_u32 v204, v204, v3, s31
    s_lshl_b32 s32, s31, 1
    s_add_u32 s32, s32, 21872
    v_sub_u32 v205, s32, v204
    v_bfe_u32 v206, v2, 2, 2
    v_mul_u32_u24 v206, 2592, v206
    v_lshrrev_b32 v6, 4, v2
    v_mul_u32_u24 v7, 640, v6
    v_add_u32 v206, v206, v7
    v_and_b32 v7, 3, v2
    v_lshlrev_b32 v7, 3, v7
    s_lshl_b32 s31, s30, 7
    v_add3_u32 v206, v206, v7, s31
    v_lshlrev_b32 v6, 12, v6
    v_and_b32 v7, 15, v2
    v_lshl_add_u32 v6, v7, 4, v6
    s_lshl_b32 s31, s30, 8
    v_add_u32 v207, s31, v6
    v_bfe_i32 v208, v2, 4, 1
    v_and_b32 v208, 0x80008000, v208
    s_cmp_eq_u32 s47, 0
    s_movk_i32 s48, 0x7403
    s_cselect_b32 s48, 0x7721, s48
    v_and_b32 v250, 12, v2
    v_bfe_u32 v250, s48, v250, 4
    v_lshrrev_b32 v251, 4, v2
    v_bfe_u32 v252, v2, 1, 1
    v_mul_u32_u24 v251, v251, v252
    v_and_b32 v252, 1, v2
    v_add_u32 v251, v251, v252
    v_cvt_f32_u32 v250, v250
    v_cvt_f32_u32 v251, v251
    v_mul_f32 v250, 0x3e000000, v250
    v_mul_f32 v251, 0x3e800000, v251
    v_cos_f32 v8, v251
    v_add_f32 v251, v251, v250
    v_cos_f32 v9, v251
    v_add_f32 v251, v251, v250
    v_cos_f32 v10, v251
    v_add_f32 v251, v251, v250
    v_cos_f32 v11, v251
    v_add_f32 v251, v251, v250
    v_cos_f32 v12, v251
    v_add_f32 v251, v251, v250
    v_cos_f32 v13, v251
    v_add_f32 v251, v251, v250
    v_cos_f32 v14, v251
    v_add_f32 v251, v251, v250
    v_cos_f32 v15, v251
    v_mul_f32 v8, 0xbf317218, v8
    v_mul_f32 v9, 0xbf317218, v9
    v_mul_f32 v10, 0xbf317218, v10
    v_mul_f32 v11, 0xbf317218, v11
    v_mul_f32 v12, 0xbf317218, v12
    v_mul_f32 v13, 0xbf317218, v13
    v_mul_f32 v14, 0xbf317218, v14
    v_mul_f32 v15, 0xbf317218, v15
    v_lshrrev_b32 v250, 2, v2
    v_and_b32 v250, 12, v250
    v_and_b32 v251, 15, v2
    v_lshlrev_b32 v251, 2, v251
    v_cvt_f32_u32 v250, v250
    v_cvt_f32_u32 v251, v251
    v_mul_f32 v212, 0x3c800000, v250
    s_lshl_b32 s31, s30, 2
    s_lshr_b32 s48, s48, s31
    s_and_b32 s48, s48, 15
    s_sub_u32 s31, s48, 4
    s_mul_i32 s31, s31, s46
    v_cvt_f32_i32 v252, s31
    v_mul_f32 v252, 0x3a000000, v252
    v_add_f32 v213, 0x3c800000, v212
    v_add_f32 v214, 0x3d000000, v212
    v_add_f32 v215, 0x3d400000, v212
    s_and_b32 s31, s2, 7
    s_sub_u32 s32, 8, s31
    s_min_u32 s76, s31, s32
    s_lshr_b32 s78, s31, 2
    s_lshr_b32 s77, s2, 3
    s_and_b32 s32, s77, 1
    s_and_b32 s31, s31, 3
    s_cselect_b32 s78, s78, s32
    s_cselect_b32 s31, 0, 1
    s_lshr_b32 s77, s77, s31
    s_lshl_b32 s78, s78, 4
    s_lshl_b32 s31, s30, 5
    s_add_u32 s78, s78, s31
    s_lshl_b32 s78, s78, 3
    s_add_u32 s78, s78, s76
    s_lshl_b32 s77, s77, 6
    s_sub_u32 s79, 1984, s77
    s_lshl_b32 s76, s76, 1
    s_add_u32 s76, s76, 2040
    v_and_b32 v116, 15, v2
    v_lshl_add_u32 v116, v116, 3, s78
    v_and_b32 v7, 32, v2
    v_lshl_add_u32 v7, v7, 5, v116
    s_mov_b32 vcc_lo, 0xffff0000
    s_mov_b32 vcc_hi, 0xffff0000
    v_sub_u32 v6, 0, v7
    v_cndmask_b32 v7, v7, v6, vcc
    v_and_b32 v6, 7, v7
    v_and_b32 v1, 1024, v7
    v_lshl_add_u32 v6, v6, 11, v1
    v_and_b32 v1, 0xf8, v7
    v_lshl_add_u32 v6, v1, 2, v6
    v_bfe_u32 v1, v7, 9, 1
    v_lshl_add_u32 v119, v1, 4, v6
    v_and_b32 v1, 256, v7
    v_cmp_ne_u32 s[88:89], 0, v1
    v_lshrrev_b32 v118, 2, v2
    v_lshl_add_u32 v118, v118, 3, s78
    v_lshlrev_b32 v1, 1, v2
    v_xor_b32 v1, v1, v3
    v_and_b32 v1, 48, v1
    v_add_u32 v114, 1024, v118
    v_sub_u32 v113, 0, v118
    v_and_b32 v113, 2047, v113
    v_sub_u32 v115, 2048, v114
    v_add_u32 v112, s77, v1
    v_lshl_add_u32 v114, v114, 11, v112
    v_lshl_add_u32 v112, v118, 11, v112
    v_xor_b32 v1, 48, v1
    v_add_u32 v1, s79, v1
    v_lshl_add_u32 v113, v113, 11, v1
    v_lshl_add_u32 v115, v115, 11, v1
    s_lshl_b32 s76, s30, 12
    s_add_u32 s76, s76, 44032
    v_and_b32 v1, 15, v2
    v_lshlrev_b32 v6, 6, v1
    v_lshlrev_b32 v1, 3, v2
    v_xor_b32 v1, v1, v2
    v_and_b32 v1, 48, v1
    v_add3_u32 v117, v6, v1, s76
    v_mul_f32 v250, v212, v251
    v_fmamk_f32 v52, v250, 0x3d800000, v252
    v_sin_f32 v20, v250
    v_cos_f32 v250, v250
    v_cos_f32 v48, v52
    v_sin_f32 v52, v52
    v_cvt_pk_f16_f32 v16, v250, v20
    v_cvt_pk_f16_f32 v20, -v20, v250
    v_mul_f32 v250, v213, v251
    v_fmamk_f32 v53, v250, 0x3d800000, v252
    v_sin_f32 v21, v250
    v_cos_f32 v250, v250
    v_cos_f32 v49, v53
    v_sin_f32 v53, v53
    v_cvt_pk_f16_f32 v17, v250, v21
    v_cvt_pk_f16_f32 v21, -v21, v250
    v_mul_f32 v250, v214, v251
    v_fmamk_f32 v54, v250, 0x3d800000, v252
    v_sin_f32 v22, v250
    v_cos_f32 v250, v250
    v_cos_f32 v50, v54
    v_sin_f32 v54, v54
    v_cvt_pk_f16_f32 v18, v250, v22
    v_cvt_pk_f16_f32 v22, -v22, v250
    v_mul_f32 v250, v215, v251
    v_fmamk_f32 v55, v250, 0x3d800000, v252
    v_sin_f32 v23, v250
    v_cos_f32 v250, v250
    v_cos_f32 v51, v55
    v_sin_f32 v55, v55
    v_cvt_pk_f16_f32 v19, v250, v23
    v_cvt_pk_f16_f32 v23, -v23, v250
    v_add_f32 v251, 1.0, v251
    v_mul_f32 v250, v212, v251
    v_fmamk_f32 v60, v250, 0x3d800000, v252
    v_sin_f32 v28, v250
    v_cos_f32 v250, v250
    v_cos_f32 v56, v60
    v_sin_f32 v60, v60
    v_cvt_pk_f16_f32 v24, v250, v28
    v_cvt_pk_f16_f32 v28, -v28, v250
    v_mul_f32 v250, v213, v251
    v_fmamk_f32 v61, v250, 0x3d800000, v252
    v_sin_f32 v29, v250
    v_cos_f32 v250, v250
    v_cos_f32 v57, v61
    v_sin_f32 v61, v61
    v_cvt_pk_f16_f32 v25, v250, v29
    v_cvt_pk_f16_f32 v29, -v29, v250
    v_mul_f32 v250, v214, v251
    v_fmamk_f32 v62, v250, 0x3d800000, v252
    v_sin_f32 v30, v250
    v_cos_f32 v250, v250
    v_cos_f32 v58, v62
    v_sin_f32 v62, v62
    v_cvt_pk_f16_f32 v26, v250, v30
    v_cvt_pk_f16_f32 v30, -v30, v250
    v_mul_f32 v250, v215, v251
    v_fmamk_f32 v63, v250, 0x3d800000, v252
    v_sin_f32 v31, v250
    v_cos_f32 v250, v250
    v_cos_f32 v59, v63
    v_sin_f32 v63, v63
    v_cvt_pk_f16_f32 v27, v250, v31
    v_cvt_pk_f16_f32 v31, -v31, v250
    v_add_f32 v251, 1.0, v251
    v_mov_b32 v160, 0
    v_mov_b32 v161, 0
    v_mov_b32 v162, 0
    v_mov_b32 v163, 0
    v_mov_b32 v164, 0
    v_mov_b32 v165, 0
    v_mov_b32 v166, 0
    v_mov_b32 v167, 0
    v_mov_b32 v168, 0
    v_mov_b32 v169, 0
    v_mov_b32 v170, 0
    s_mov_b32 s57, 0x3f803f80
    s_mov_b32 s59, 0xffff
    s_brev_b32 s67, 1
    s_mov_b32 s66, 0
    s_brev_b32 s64, 1
    s_brev_b32 s65, 1
    s_cmp_eq_u32 s47, 0
    s_movk_i32 s62, -10368
    s_cselect_b32 s62, 10368, s62
    s_waitcnt lgkmcnt(0)
    s_add_u32 s28, s28, 0x7f4a7c15
    s_addc_u32 s29, s29, 0x9e3779b9
    v_mov_b32 v174, s28
    v_mov_b32 v175, s29
    s_cmp_lt_u32 s2, 224
    s_cbranch_scc1 L_epoch_ok
L_sync1:
    ds_read_b32 v1, v0 offset:42872
    s_add_u32 s92, s92, 1
    s_bitcmp1_b32 s92, 20
    s_cbranch_scc1 L_sync1x
    s_waitcnt lgkmcnt(0)
    v_readfirstlane_b32 s31, v1
    s_nop 0
    s_cmp_ge_u32 s31, 4
    s_cbranch_scc0 L_sync1
L_sync1x:
L_epoch_ok:
    s_setprio 3
    s_waitcnt vmcnt(8)
    v_dot2c_f32_bf16 v160, s57, v120
    v_dot2c_f32_bf16 v164, v120, v120
    v_dot2c_f32_bf16 v160, s57, v121
    v_dot2c_f32_bf16 v164, v121, v121
    v_dot2c_f32_bf16 v160, s57, v122
    v_dot2c_f32_bf16 v164, v122, v122
    v_dot2c_f32_bf16 v160, s57, v123
    v_dot2c_f32_bf16 v164, v123, v123
    v_dot2c_f32_bf16 v160, s57, v124
    v_dot2c_f32_bf16 v164, v124, v124
    v_dot2c_f32_bf16 v160, s57, v125
    v_dot2c_f32_bf16 v164, v125, v125
    v_dot2c_f32_bf16 v160, s57, v126
    v_dot2c_f32_bf16 v164, v126, v126
    v_dot2c_f32_bf16 v160, s57, v127
    v_dot2c_f32_bf16 v164, v127, v127
    s_waitcnt vmcnt(6)
    v_dot2c_f32_bf16 v161, s57, v128
    v_dot2c_f32_bf16 v165, v128, v128
    v_dot2c_f32_bf16 v161, s57, v129
    v_dot2c_f32_bf16 v165, v129, v129
    v_dot2c_f32_bf16 v161, s57, v130
    v_dot2c_f32_bf16 v165, v130, v130
    v_dot2c_f32_bf16 v161, s57, v131
    v_dot2c_f32_bf16 v165, v131, v131
    v_dot2c_f32_bf16 v161, s57, v132
    v_dot2c_f32_bf16 v165, v132, v132
    v_dot2c_f32_bf16 v161, s57, v133
    v_dot2c_f32_bf16 v165, v133, v133
    v_dot2c_f32_bf16 v161, s57, v134
    v_dot2c_f32_bf16 v165, v134, v134
    v_dot2c_f32_bf16 v161, s57, v135
    v_dot2c_f32_bf16 v165, v135, v135
    s_waitcnt vmcnt(4)
    v_dot2c_f32_bf16 v170, s57, v152
    v_dot2c_f32_bf16 v170, s57, v153
    v_dot2c_f32_bf16 v170, s57, v154
    v_dot2c_f32_bf16 v170, s57, v155
    v_dot2c_f32_bf16 v170, s57, v156
    v_dot2c_f32_bf16 v170, s57, v157
    v_dot2c_f32_bf16 v170, s57, v158
    v_dot2c_f32_bf16 v170, s57, v159
    v_dot2c_f32_bf16 v168, v152, v120
    v_dot2c_f32_bf16 v169, v152, v128
    v_dot2c_f32_bf16 v168, v153, v121
    v_dot2c_f32_bf16 v169, v153, v129
    v_dot2c_f32_bf16 v168, v154, v122
    v_dot2c_f32_bf16 v169, v154, v130
    v_dot2c_f32_bf16 v168, v155, v123
    v_dot2c_f32_bf16 v169, v155, v131
    v_mov_b32 v171, v170
    v_dot2c_f32_bf16 v168, v156, v124
    v_dot2c_f32_bf16 v169, v156, v132
    v_dot2c_f32_bf16 v168, v157, v125
    v_dot2c_f32_bf16 v169, v157, v133
    v_dot2c_f32_bf16 v168, v158, v126
    v_dot2c_f32_bf16 v169, v158, v134
    v_dot2c_f32_bf16 v168, v159, v127
    v_dot2c_f32_bf16 v169, v159, v135
    v_permlane32_swap_b32 v160, v161
    v_permlane32_swap_b32 v164, v165
    v_permlane32_swap_b32 v170, v171
    v_permlane32_swap_b32 v168, v169
    v_add_f32 v160, v160, v161
    v_add_f32 v164, v164, v165
    v_add_f32 v170, v170, v171
    v_add_f32 v168, v168, v169
    v_add_f32_dpp v160, v160, v160 row_shr:1 row_mask:0xf bank_mask:0xf
    v_add_f32_dpp v164, v164, v164 row_shr:1 row_mask:0xf bank_mask:0xf
    v_add_f32_dpp v170, v170, v170 row_shr:1 row_mask:0xf bank_mask:0xf
    v_add_f32_dpp v168, v168, v168 row_shr:1 row_mask:0xf bank_mask:0xf
    v_add_f32_dpp v160, v160, v160 row_shr:2 row_mask:0xf bank_mask:0xf
    v_add_f32_dpp v164, v164, v164 row_shr:2 row_mask:0xf bank_mask:0xf
    v_add_f32_dpp v170, v170, v170 row_shr:2 row_mask:0xf bank_mask:0xf
    v_add_f32_dpp v168, v168, v168 row_shr:2 row_mask:0xf bank_mask:0xf
    v_add_f32_dpp v160, v160, v160 row_shr:4 row_mask:0xf bank_mask:0xf
    v_add_f32_dpp v164, v164, v164 row_shr:4 row_mask:0xf bank_mask:0xf
    v_add_f32_dpp v170, v170, v170 row_shr:4 row_mask:0xf bank_mask:0xf
    v_add_f32_dpp v168, v168, v168 row_shr:4 row_mask:0xf bank_mask:0xf
    v_add_f32_dpp v160, v160, v160 row_shr:8 row_mask:0xf bank_mask:0xf
    v_add_f32_dpp v164, v164, v164 row_shr:8 row_mask:0xf bank_mask:0xf
    v_add_f32_dpp v170, v170, v170 row_shr:8 row_mask:0xf bank_mask:0xf
    v_add_f32_dpp v168, v168, v168 row_shr:8 row_mask:0xf bank_mask:0xf
    v_add_f32_dpp v160, v160, v160 row_bcast:15 row_mask:0xa bank_mask:0xf
    v_add_f32_dpp v164, v164, v164 row_bcast:15 row_mask:0xa bank_mask:0xf
    v_add_f32_dpp v170, v170, v170 row_bcast:15 row_mask:0xa bank_mask:0xf
    v_add_f32_dpp v168, v168, v168 row_bcast:15 row_mask:0xa bank_mask:0xf
    v_mul_f32 v160, 0x3a800000, v160
    v_mul_f32 v164, 0x3a800000, v164
    v_fma_f32 v164, -v160, v160, v164
    v_cvt_pk_bf16_f32 v161, -v160, -v160
    v_max_f32 v164, 0, v164
    v_cvt_pk_bf16_f32 v164, v164, v164
    v_and_b32 v164, 0xffff0000, v164
    v_add_f32 v164, 0x3727c5ac, v164
    v_cvt_pk_bf16_f32 v164, v164, v164
    v_and_b32 v164, 0xffff0000, v164
    v_sqrt_f32 v164, v164
    v_and_b32 v165, 0xffff0000, v161
    v_cvt_pk_bf16_f32 v248, v160, v164
    v_and_b32 v164, 0xffff0000, v248
    v_rcp_f32 v164, v164
    v_fmac_f32 v168, v170, v165
    v_mul_f32 v168, v168, v164
    v_ashrrev_i32 v170, 31, v168
    v_or_b32 v170, 0x80000000, v170
    v_xor_b32 v168, v168, v170
    v_and_b32 v168, 0xfffff800, v168
    v_or_b32 v249, v200, v168
    s_mov_b64 exec, s[64:65]
    ds_write_b32 v201, v248 offset:41472
    ds_max_u64 v0, v[248:249] offset:41504
    s_mov_b64 exec, 1
    ds_add_rtn_u32 v1, v0, v255 offset:42816
    s_mov_b64 exec, 31
    ds_read_b64 v[172:173], v5 offset:41472
    s_mov_b64 exec, s[64:65]
    ds_write_b16 v202, v161 offset:41568
    ds_write_b32 v203, v164 offset:42752
    s_mov_b64 exec, -1
    s_nop 0
    v_mov_b32_dpp v6, v128 wave_rol:1 row_mask:0xf bank_mask:0xf
    v_mov_b32_dpp v7, v132 wave_rol:1 row_mask:0xf bank_mask:0xf
    v_bfi_b32 v221, s59, v131, v130
    v_bfi_b32 v222, s59, v130, v129
    v_bfi_b32 v223, s59, v129, v128
    v_bfi_b32 v217, s59, v135, v134
    v_bfi_b32 v218, s59, v134, v133
    v_bfi_b32 v219, s59, v133, v132
    v_cndmask_b32 v220, v6, v7, s[66:67]
    v_cndmask_b32 v216, v7, v6, s[66:67]
    v_bfi_b32 v220, s59, v220, v131
    v_bfi_b32 v216, s59, v216, v135
    s_waitcnt lgkmcnt(2)
    v_readfirstlane_b32 s31, v1
    s_nop 0
    s_cmp_lg_u32 s31, 3
    s_cbranch_scc1 L_not_last
    s_mov_b64 exec, 31
    buffer_store_dwordx4 v[172:175], v4, s[12:15], 0 offen sc1
    s_mov_b64 exec, -1
    s_waitcnt vmcnt(1)
    s_branch L_b_ready
L_not_last:
    s_waitcnt vmcnt(0)
L_b_ready:
    s_setprio 3
    ds_write_b128 v204, v[120:123] offset:0
    ds_write_b128 v204, v[124:127] offset:1280
    s_cmp_lg_u32 s50, 0
    s_cbranch_scc1 L_plain1
    ds_write_b128 v205, v[216:219]
    ds_write_b128 v205, v[220:223] offset:1280
    s_branch L_second1
L_plain1:
    ds_write_b128 v204, v[128:131] offset:20736
    ds_write_b128 v204, v[132:135] offset:22016
L_second1:
    v_add_u32 v204, s62, v204
    v_add_u32 v205, s62, v205
    v_dot2c_f32_bf16 v162, s57, v136
    v_dot2c_f32_bf16 v166, v136, v136
    v_dot2c_f32_bf16 v162, s57, v137
    v_dot2c_f32_bf16 v166, v137, v137
    v_dot2c_f32_bf16 v162, s57, v138
    v_dot2c_f32_bf16 v166, v138, v138
    v_dot2c_f32_bf16 v162, s57, v139
    v_dot2c_f32_bf16 v166, v139, v139
    v_dot2c_f32_bf16 v162, s57, v140
    v_dot2c_f32_bf16 v166, v140, v140
    v_dot2c_f32_bf16 v162, s57, v141
    v_dot2c_f32_bf16 v166, v141, v141
    v_dot2c_f32_bf16 v162, s57, v142
    v_dot2c_f32_bf16 v166, v142, v142
    v_dot2c_f32_bf16 v162, s57, v143
    v_dot2c_f32_bf16 v166, v143, v143
    ds_write_b128 v204, v[136:139] offset:0
    ds_write_b128 v204, v[140:143] offset:1280
    v_dot2c_f32_bf16 v163, s57, v144
    v_dot2c_f32_bf16 v167, v144, v144
    v_dot2c_f32_bf16 v163, s57, v145
    v_dot2c_f32_bf16 v167, v145, v145
    v_dot2c_f32_bf16 v163, s57, v146
    v_dot2c_f32_bf16 v167, v146, v146
    v_dot2c_f32_bf16 v163, s57, v147
    v_dot2c_f32_bf16 v167, v147, v147
    v_dot2c_f32_bf16 v163, s57, v148
    v_dot2c_f32_bf16 v167, v148, v148
    v_dot2c_f32_bf16 v163, s57, v149
    v_dot2c_f32_bf16 v167, v149, v149
    v_dot2c_f32_bf16 v163, s57, v150
    v_dot2c_f32_bf16 v167, v150, v150
    v_dot2c_f32_bf16 v163, s57, v151
    v_dot2c_f32_bf16 v167, v151, v151
    v_xor_b32 v202, 8, v202
    v_xor_b32 v203, 16, v203
    s_waitcnt lgkmcnt(2)
    s_nop 0
    v_mov_b32_dpp v6, v144 wave_rol:1 row_mask:0xf bank_mask:0xf
    v_mov_b32_dpp v7, v148 wave_rol:1 row_mask:0xf bank_mask:0xf
    v_bfi_b32 v221, s59, v147, v146
    v_bfi_b32 v222, s59, v146, v145
    v_bfi_b32 v223, s59, v145, v144
    v_bfi_b32 v217, s59, v151, v150
    v_bfi_b32 v218, s59, v150, v149
    v_bfi_b32 v219, s59, v149, v148
    v_cndmask_b32 v220, v6, v7, s[66:67]
    v_cndmask_b32 v216, v7, v6, s[66:67]
    v_bfi_b32 v220, s59, v220, v147
    v_bfi_b32 v216, s59, v216, v151
    s_cmp_lg_u32 s50, 0
    s_cbranch_scc1 L_plain3
    ds_write_b128 v205, v[216:219]
    ds_write_b128 v205, v[220:223] offset:1280
    s_branch L_second3
L_plain3:
    ds_write_b128 v204, v[144:147] offset:20736
    ds_write_b128 v204, v[148:151] offset:22016
L_second3:
    v_permlane32_swap_b32 v162, v163
    v_permlane32_swap_b32 v166, v167
    v_add_f32 v162, v162, v163
    v_add_f32 v166, v166, v167
    s_nop 0
    v_add_f32_dpp v162, v162, v162 row_shr:1 row_mask:0xf bank_mask:0xf
    v_add_f32_dpp v166, v166, v166 row_shr:1 row_mask:0xf bank_mask:0xf
    s_nop 0
    v_add_f32_dpp v162, v162, v162 row_shr:2 row_mask:0xf bank_mask:0xf
    v_add_f32_dpp v166, v166, v166 row_shr:2 row_mask:0xf bank_mask:0xf
    s_nop 0
    v_add_f32_dpp v162, v162, v162 row_shr:4 row_mask:0xf bank_mask:0xf
    v_add_f32_dpp v166, v166, v166 row_shr:4 row_mask:0xf bank_mask:0xf
    s_nop 0
    v_add_f32_dpp v162, v162, v162 row_shr:8 row_mask:0xf bank_mask:0xf
    v_add_f32_dpp v166, v166, v166 row_shr:8 row_mask:0xf bank_mask:0xf
    s_nop 0
    v_add_f32_dpp v162, v162, v162 row_bcast:15 row_mask:0xa bank_mask:0xf
    v_add_f32_dpp v166, v166, v166 row_bcast:15 row_mask:0xa bank_mask:0xf
    v_mul_f32 v162, 0x3a800000, v162
    v_mul_f32 v166, 0x3a800000, v166
    v_fma_f32 v166, -v162, v162, v166
    v_cvt_pk_bf16_f32 v161, -v162, -v162
    v_max_f32 v166, 0, v166
    v_cvt_pk_bf16_f32 v166, v166, v166
    v_and_b32 v166, 0xffff0000, v166
    v_add_f32 v166, 0x3727c5ac, v166
    v_cvt_pk_bf16_f32 v166, v166, v166
    v_and_b32 v166, 0xffff0000, v166
    v_sqrt_f32 v166, v166
    v_and_b32 v167, 0xffff0000, v161
    v_cvt_pk_bf16_f32 v248, v162, v166
    v_and_b32 v166, 0xffff0000, v248
    v_rcp_f32 v166, v166
    s_mov_b64 exec, s[64:65]
    ds_write_b16 v202, v161 offset:41568
    ds_write_b32 v203, v166 offset:42752
    s_mov_b64 exec, 1
    ds_add_u32 v0, v255 offset:42820
    s_mov_b64 exec, -1
L_sync2:
    ds_read_b32 v1, v0 offset:42820
    ds_read_b128 v[176:179], v0 offset:42752
    ds_read_b128 v[180:183], v0 offset:42768
    ds_read_b128 v[184:187], v0 offset:42784
    ds_read_b128 v[188:191], v0 offset:42800
    ds_read_b128 v[192:195], v0 offset:41568
    ds_read_b128 v[196:199], v0 offset:41584
    s_add_u32 s92, s92, 1
    s_bitcmp1_b32 s92, 20
    s_cbranch_scc1 L_sync2x
    s_waitcnt lgkmcnt(6)
    v_readfirstlane_b32 s31, v1
    s_nop 0
    s_cmp_ge_u32 s31, 4
    s_cbranch_scc0 L_sync2
L_sync2x:
    ds_read_b64_tr_b16 v[120:121], v206 offset:0
    ds_read_b64_tr_b16 v[122:123], v206 offset:10368
    ds_read_b64_tr_b16 v[124:125], v206 offset:20736
    ds_read_b64_tr_b16 v[126:127], v206 offset:31104
    ds_read_b64_tr_b16 v[128:129], v206 offset:32
    ds_read_b64_tr_b16 v[130:131], v206 offset:10400
    ds_read_b64_tr_b16 v[132:133], v206 offset:20768
    ds_read_b64_tr_b16 v[134:135], v206 offset:31136
    s_waitcnt lgkmcnt(10)
    s_nop 0
    ds_read_b64_tr_b16 v[136:137], v206 offset:64
    ds_read_b64_tr_b16 v[138:139], v206 offset:10432
    ds_read_b64_tr_b16 v[140:141], v206 offset:20800
    ds_read_b64_tr_b16 v[142:143], v206 offset:31168
    v_pk_mul_f32 v[176:177], v[176:177], v[8:9]
    v_pk_mul_f32 v[178:179], v[178:179], v[10:11]
    v_pk_mul_f32 v[180:181], v[180:181], v[12:13]
    v_pk_mul_f32 v[182:183], v[182:183], v[14:15]
    v_pk_mul_f32 v[184:185], v[184:185], v[8:9]
    v_pk_mul_f32 v[186:187], v[186:187], v[10:11]
    v_pk_mul_f32 v[188:189], v[188:189], v[12:13]
    v_pk_mul_f32 v[190:191], v[190:191], v[14:15]
    v_cvt_pk_bf16_f32 v160, v176, v177
    v_cvt_pk_bf16_f32 v152, v184, v185
    v_cvt_pk_bf16_f32 v161, v178, v179
    v_cvt_pk_bf16_f32 v153, v186, v187
    v_cvt_pk_bf16_f32 v162, v180, v181
    v_cvt_pk_bf16_f32 v154, v188, v189
    v_cvt_pk_bf16_f32 v163, v182, v183
    v_cvt_pk_bf16_f32 v155, v190, v191
    v_xor_b32 v164, v208, v160
    v_xor_b32 v156, v208, v152
    v_xor_b32 v165, v208, v161
    v_xor_b32 v157, v208, v153
    v_xor_b32 v166, v208, v162
    v_xor_b32 v158, v208, v154
    v_xor_b32 v167, v208, v163
    v_xor_b32 v159, v208, v155
    s_waitcnt lgkmcnt(12)
    s_cmp_lg_u32 s50, 0
    s_cbranch_scc1 L_st1_split
    v_mfma_f32_16x16x32_bf16 v[168:171], v[160:163], v[192:195], 0
    v_mfma_f32_16x16x32_bf16 v[168:171], v[152:155], v[196:199], v[168:171]
    s_waitcnt lgkmcnt(10)
    ds_read_b64_tr_b16 v[144:145], v206 offset:96
    ds_read_b64_tr_b16 v[146:147], v206 offset:10464
    ds_read_b64_tr_b16 v[148:149], v206 offset:20832
    ds_read_b64_tr_b16 v[150:151], v206 offset:31200
    v_mfma_f32_16x16x32_bf16 v[216:219], v[160:163], v[120:123], v[168:171]
    s_waitcnt lgkmcnt(12)
    v_mfma_f32_16x16x32_bf16 v[216:219], v[152:155], v[124:127], v[216:219]
    s_waitcnt lgkmcnt(10)
    v_mfma_f32_16x16x32_bf16 v[224:227], v[160:163], v[128:131], v[168:171]
    s_waitcnt lgkmcnt(8)
    v_mfma_f32_16x16x32_bf16 v[224:227], v[152:155], v[132:135], v[224:227]
    s_waitcnt lgkmcnt(6)
    v_mfma_f32_16x16x32_bf16 v[232:235], v[160:163], v[136:139], v[168:171]
    s_waitcnt lgkmcnt(4)
    v_mfma_f32_16x16x32_bf16 v[232:235], v[152:155], v[140:143], v[232:235]
    s_waitcnt lgkmcnt(2)
    v_mfma_f32_16x16x32_bf16 v[240:243], v[160:163], v[144:147], v[168:171]
    s_waitcnt lgkmcnt(0)
    v_mfma_f32_16x16x32_bf16 v[240:243], v[152:155], v[148:151], v[240:243]
    v_mfma_f32_16x16x32_bf16 v[220:223], v[164:167], v[120:123], 0
    v_mfma_f32_16x16x32_bf16 v[220:223], v[156:159], v[124:127], v[220:223]
    v_mfma_f32_16x16x32_bf16 v[228:231], v[164:167], v[128:131], 0
    v_mfma_f32_16x16x32_bf16 v[228:231], v[156:159], v[132:135], v[228:231]
    v_cvt_pk_f16_f32 v176, v216, v217
    v_cvt_pk_f16_f32 v177, v224, v225
    v_cvt_pk_f16_f32 v178, v232, v233
    s_nop 0
    v_cvt_pk_f16_f32 v179, v240, v241
    ds_write_b128 v207, v[176:179] offset:44032
    v_mfma_f32_16x16x32_bf16 v[236:239], v[164:167], v[136:139], 0
    v_mfma_f32_16x16x32_bf16 v[236:239], v[156:159], v[140:143], v[236:239]
    v_cvt_pk_f16_f32 v180, v218, v219
    v_cvt_pk_f16_f32 v181, v226, v227
    v_cvt_pk_f16_f32 v182, v234, v235
    v_cvt_pk_f16_f32 v183, v242, v243
    ds_write_b128 v207, v[180:183] offset:45056
    v_mfma_f32_16x16x32_bf16 v[244:247], v[164:167], v[144:147], 0
    v_mfma_f32_16x16x32_bf16 v[244:247], v[156:159], v[148:151], v[244:247]
    v_cvt_pk_f16_f32 v184, v220, v221
    v_cvt_pk_f16_f32 v185, v228, v229
    v_cvt_pk_f16_f32 v186, v236, v237
    s_nop 4
    v_cvt_pk_f16_f32 v187, v244, v245
    ds_write_b128 v207, v[184:187] offset:46080
    v_cvt_pk_f16_f32 v188, v222, v223
    v_cvt_pk_f16_f32 v189, v230, v231
    v_cvt_pk_f16_f32 v190, v238, v239
    v_cvt_pk_f16_f32 v191, v246, v247
    ds_write_b128 v207, v[188:191] offset:47104
    s_branch L_st1_done
L_st1_split:
    s_waitcnt lgkmcnt(8)
    ds_read_b64_tr_b16 v[144:145], v206 offset:96
    ds_read_b64_tr_b16 v[146:147], v206 offset:10464
    ds_read_b64_tr_b16 v[148:149], v206 offset:20832
    ds_read_b64_tr_b16 v[150:151], v206 offset:31200
    s_waitcnt lgkmcnt(0)
    v_mfma_f32_16x16x32_bf16 v[168:171], v[160:163], v[192:195], 0
    v_mfma_f32_16x16x32_bf16 v[220:223], v[164:167], v[120:123], 0
    v_mfma_f32_16x16x32_bf16 v[216:219], v[160:163], v[120:123], v[168:171]
    v_mfma_f32_16x16x32_bf16 v[228:231], v[164:167], v[128:131], 0
    v_mfma_f32_16x16x32_bf16 v[224:227], v[160:163], v[128:131], v[168:171]
    v_mfma_f32_16x16x32_bf16 v[236:239], v[164:167], v[136:139], 0
    v_mfma_f32_16x16x32_bf16 v[232:235], v[160:163], v[136:139], v[168:171]
    v_mfma_f32_16x16x32_bf16 v[244:247], v[164:167], v[144:147], 0
    v_mfma_f32_16x16x32_bf16 v[240:243], v[160:163], v[144:147], v[168:171]
    s_nop 1
    s_nop 0
    v_cvt_pk_f16_f32 v176, v216, v217
    v_cvt_pk_f16_f32 v180, v218, v219
    v_cvt_pk_f16_f32 v184, v220, v221
    v_cvt_pk_f16_f32 v188, v222, v223
    v_cvt_pk_f16_f32 v177, v224, v225
    v_cvt_pk_f16_f32 v181, v226, v227
    v_cvt_pk_f16_f32 v185, v228, v229
    v_cvt_pk_f16_f32 v189, v230, v231
    v_cvt_pk_f16_f32 v178, v232, v233
    v_cvt_pk_f16_f32 v182, v234, v235
    v_cvt_pk_f16_f32 v186, v236, v237
    v_cvt_pk_f16_f32 v190, v238, v239
    v_cvt_pk_f16_f32 v179, v240, v241
    v_cvt_pk_f16_f32 v183, v242, v243
    v_cvt_pk_f16_f32 v187, v244, v245
    v_cvt_pk_f16_f32 v191, v246, v247
    ds_write_b128 v207, v[176:179] offset:44032
    ds_write_b128 v207, v[180:183] offset:45056
    ds_write_b128 v207, v[184:187] offset:46080
    ds_write_b128 v207, v[188:191] offset:47104
    v_mfma_f32_16x16x32_bf16 v[168:171], v[152:155], v[196:199], 0
    v_mfma_f32_16x16x32_bf16 v[220:223], v[156:159], v[124:127], 0
    v_mfma_f32_16x16x32_bf16 v[216:219], v[152:155], v[124:127], v[168:171]
    v_mfma_f32_16x16x32_bf16 v[228:231], v[156:159], v[132:135], 0
    v_mfma_f32_16x16x32_bf16 v[224:227], v[152:155], v[132:135], v[168:171]
    v_mfma_f32_16x16x32_bf16 v[236:239], v[156:159], v[140:143], 0
    v_mfma_f32_16x16x32_bf16 v[232:235], v[152:155], v[140:143], v[168:171]
    v_mfma_f32_16x16x32_bf16 v[244:247], v[156:159], v[148:151], 0
    v_mfma_f32_16x16x32_bf16 v[240:243], v[152:155], v[148:151], v[168:171]
    s_waitcnt lgkmcnt(0)
    s_nop 0
    v_cvt_pk_f16_f32 v176, v216, v217
    v_cvt_pk_f16_f32 v180, v218, v219
    v_cvt_pk_f16_f32 v184, v220, v221
    v_cvt_pk_f16_f32 v188, v222, v223
    v_cvt_pk_f16_f32 v177, v224, v225
    v_cvt_pk_f16_f32 v181, v226, v227
    v_cvt_pk_f16_f32 v185, v228, v229
    v_cvt_pk_f16_f32 v189, v230, v231
    v_cvt_pk_f16_f32 v178, v232, v233
    v_cvt_pk_f16_f32 v182, v234, v235
    v_cvt_pk_f16_f32 v186, v236, v237
    v_cvt_pk_f16_f32 v190, v238, v239
    v_cvt_pk_f16_f32 v179, v240, v241
    v_cvt_pk_f16_f32 v183, v242, v243
    v_cvt_pk_f16_f32 v187, v244, v245
    v_cvt_pk_f16_f32 v191, v246, v247
    ds_write_b128 v207, v[176:179] offset:60416
    ds_write_b128 v207, v[180:183] offset:61440
    ds_write_b128 v207, v[184:187] offset:62464
    ds_write_b128 v207, v[188:191] offset:63488
L_st1_done:
    s_mov_b64 exec, 1
    ds_add_u32 v0, v255 offset:42824
    s_mov_b64 exec, -1
    s_lshl_b32 s31, s30, 12
    v_add_u32 v5, s31, v3
    s_and_b32 s31, s28, 0x30003
    v_mov_b32 v210, s31
    s_mov_b32 s58, 0xfffcfffc
    s_and_b32 s32, s48, 3
    s_cselect_b32 s72, -1, 0xff
    s_cselect_b32 s73, -1, 0
    s_mov_b32 s74, s48
    s_mov_b64 s[60:61], 0
    s_mov_b64 s[62:63], 0
    v_mov_b32 v209, 2147483392
    s_cmp_eq_u32 s48, 7
    s_cbranch_scc1 L_no_consts
    v_mul_f32 v250, v212, v251
    v_fmamk_f32 v68, v250, 0x3d800000, v252
    v_sin_f32 v36, v250
    v_cos_f32 v250, v250
    v_cos_f32 v64, v68
    v_sin_f32 v68, v68
    v_cvt_pk_f16_f32 v32, v250, v36
    v_cvt_pk_f16_f32 v36, -v36, v250
    v_mul_f32 v250, v213, v251
    v_fmamk_f32 v69, v250, 0x3d800000, v252
    v_sin_f32 v37, v250
    v_cos_f32 v250, v250
    v_cos_f32 v65, v69
    v_sin_f32 v69, v69
    v_cvt_pk_f16_f32 v33, v250, v37
    v_cvt_pk_f16_f32 v37, -v37, v250
    v_mul_f32 v250, v214, v251
    v_fmamk_f32 v70, v250, 0x3d800000, v252
    v_sin_f32 v38, v250
    v_cos_f32 v250, v250
    v_cos_f32 v66, v70
    v_sin_f32 v70, v70
    v_cvt_pk_f16_f32 v34, v250, v38
    v_cvt_pk_f16_f32 v38, -v38, v250
    v_mul_f32 v250, v215, v251
    v_fmamk_f32 v71, v250, 0x3d800000, v252
    v_sin_f32 v39, v250
    v_cos_f32 v250, v250
    v_cos_f32 v67, v71
    v_sin_f32 v71, v71
    v_cvt_pk_f16_f32 v35, v250, v39
    v_cvt_pk_f16_f32 v39, -v39, v250
    v_add_f32 v251, 1.0, v251
    v_mul_f32 v250, v212, v251
    v_fmamk_f32 v76, v250, 0x3d800000, v252
    v_sin_f32 v44, v250
    v_cos_f32 v250, v250
    v_cos_f32 v72, v76
    v_sin_f32 v76, v76
    v_cvt_pk_f16_f32 v40, v250, v44
    v_cvt_pk_f16_f32 v44, -v44, v250
    v_mul_f32 v250, v213, v251
    v_fmamk_f32 v77, v250, 0x3d800000, v252
    v_sin_f32 v45, v250
    v_cos_f32 v250, v250
    v_cos_f32 v73, v77
    v_sin_f32 v77, v77
    v_cvt_pk_f16_f32 v41, v250, v45
    v_cvt_pk_f16_f32 v45, -v45, v250
    v_mul_f32 v250, v214, v251
    v_fmamk_f32 v78, v250, 0x3d800000, v252
    v_sin_f32 v46, v250
    v_cos_f32 v250, v250
    v_cos_f32 v74, v78
    v_sin_f32 v78, v78
    v_cvt_pk_f16_f32 v42, v250, v46
    v_cvt_pk_f16_f32 v46, -v46, v250
    v_mul_f32 v250, v215, v251
    v_fmamk_f32 v79, v250, 0x3d800000, v252
    v_sin_f32 v47, v250
    v_cos_f32 v250, v250
    v_cos_f32 v75, v79
    v_sin_f32 v79, v79
    v_cvt_pk_f16_f32 v43, v250, v47
    v_cvt_pk_f16_f32 v47, -v47, v250
    s_and_b32 s31, s46, 1
    s_lshl_b32 s31, s31, 6
    s_lshr_b32 s32, s46, 1
    s_add_u32 s49, s31, s32
    s_bitcmp1_b32 s49, 2
    s_cselect_b64 vcc, -1, 0
    v_cndmask_b32 v80, v16, v20, vcc
    v_cndmask_b32 v84, v20, v16, vcc
    v_cndmask_b32 v81, v17, v21, vcc
    v_cndmask_b32 v85, v21, v17, vcc
    v_cndmask_b32 v82, v18, v22, vcc
    v_cndmask_b32 v86, v22, v18, vcc
    v_cndmask_b32 v83, v19, v23, vcc
    v_cndmask_b32 v87, v23, v19, vcc
    s_bfe_u32 s31, s49, 0x10001
    v_and_b32 v6, 7, v2
    v_xor_b32 v6, s31, v6
    v_lshlrev_b32 v6, 4, v6
    v_lshrrev_b32 v7, 4, v2
    v_lshlrev_b32 v7, 3, v7
    v_bfe_u32 v209, v2, 3, 1
    v_add_u32 v7, v7, v209
    v_mul_u32_u24 v7, 16512, v7
    v_add_u32 v209, v6, v7
    s_mul_i32 s31, s48, 528384
    s_lshl_b32 s32, s49, 7
    s_add_u32 s31, s31, s32
    s_add_u32 s60, s31, 2097152
L_no_consts:
L_st23:
L_sync3:
    ds_read_b32 v1, v0 offset:42824
    ds_read_b128 v[120:123], v5 offset:44032
    ds_read_b128 v[124:127], v5 offset:45056
    ds_read_b128 v[128:131], v5 offset:46080
    ds_read_b128 v[132:135], v5 offset:47104
    s_add_u32 s92, s92, 1
    s_bitcmp1_b32 s92, 20
    s_cbranch_scc1 L_sync3x
    s_waitcnt lgkmcnt(4)
    v_readfirstlane_b32 s31, v1
    s_nop 0
    s_cmp_ge_u32 s31, 4
    s_cbranch_scc0 L_sync3
L_sync3x:
    s_cmp_eq_u32 s48, 7
    s_cbranch_scc1 L_p1_done
    s_add_u32 s61, s60, 33024
    s_add_u32 s62, s61, 33024
    s_add_u32 s63, s62, 33024
    s_waitcnt lgkmcnt(3)
    v_mfma_f32_16x16x32_f16 v[136:139], v[120:123], v[16:19], 0
    v_mfma_f32_16x16x32_f16 v[140:143], v[120:123], v[20:23], 0
    s_waitcnt lgkmcnt(2)
    v_mfma_f32_16x16x32_f16 v[144:147], v[124:127], v[24:27], 0
    v_mfma_f32_16x16x32_f16 v[148:151], v[124:127], v[28:31], 0
    s_nop 3
    s_nop 0
    v_pk_mul_f32 v[152:153], v[48:49], v[136:137]
    v_pk_mul_f32 v[154:155], v[50:51], v[138:139]
    v_pk_mul_f32 v[156:157], v[52:53], v[136:137]
    v_pk_mul_f32 v[158:159], v[54:55], v[138:139]
    v_pk_fma_f32 v[152:153], v[52:53], v[140:141], v[152:153]
    v_pk_fma_f32 v[156:157], v[48:49], v[140:141], v[156:157] neg_lo:[0,0,1] neg_hi:[0,0,1]
    v_pk_fma_f32 v[154:155], v[54:55], v[142:143], v[154:155]
    v_pk_fma_f32 v[158:159], v[50:51], v[142:143], v[158:159] neg_lo:[0,0,1] neg_hi:[0,0,1]
    v_cvt_pk_f16_f32 v120, v152, v156
    v_cvt_pk_f16_f32 v121, v153, v157
    v_cvt_pk_f16_f32 v122, v154, v158
    v_cvt_pk_f16_f32 v123, v155, v159
    s_waitcnt lgkmcnt(1)
    s_nop 0
    v_mfma_f32_16x16x32_f16 v[136:139], v[128:131], v[32:35], 0
    v_mfma_f32_16x16x32_f16 v[140:143], v[128:131], v[36:39], 0
    v_mfma_f32_16x16x32_f16 v[216:219], v[80:83], v[120:123], 0
    v_mfma_f32_16x16x32_f16 v[220:223], v[84:87], v[120:123], 0
    v_pk_mul_f32 v[152:153], v[56:57], v[144:145]
    v_pk_mul_f32 v[154:155], v[58:59], v[146:147]
    v_pk_mul_f32 v[156:157], v[60:61], v[144:145]
    v_pk_mul_f32 v[158:159], v[62:63], v[146:147]
    v_pk_fma_f32 v[152:153], v[60:61], v[148:149], v[152:153]
    v_pk_fma_f32 v[156:157], v[56:57], v[148:149], v[156:157] neg_lo:[0,0,1] neg_hi:[0,0,1]
    v_pk_fma_f32 v[154:155], v[62:63], v[150:151], v[154:155]
    v_pk_fma_f32 v[158:159], v[58:59], v[150:151], v[158:159] neg_lo:[0,0,1] neg_hi:[0,0,1]
    v_cvt_pk_f16_f32 v124, v152, v156
    v_cvt_pk_f16_f32 v125, v153, v157
    v_cvt_pk_f16_f32 v126, v154, v158
    v_cvt_pk_f16_f32 v127, v155, v159
    s_waitcnt lgkmcnt(0)
    s_nop 0
    v_mfma_f32_16x16x32_f16 v[144:147], v[132:135], v[40:43], 0
    v_mfma_f32_16x16x32_f16 v[148:151], v[132:135], v[44:47], 0
    v_mfma_f32_16x16x32_f16 v[224:227], v[80:83], v[124:127], 0
    v_mfma_f32_16x16x32_f16 v[228:231], v[84:87], v[124:127], 0
    v_pk_mul_f32 v[152:153], v[64:65], v[136:137]
    v_pk_mul_f32 v[154:155], v[66:67], v[138:139]
    v_pk_mul_f32 v[156:157], v[68:69], v[136:137]
    v_pk_mul_f32 v[158:159], v[70:71], v[138:139]
    v_pk_fma_f32 v[152:153], v[68:69], v[140:141], v[152:153]
    v_pk_fma_f32 v[156:157], v[64:65], v[140:141], v[156:157] neg_lo:[0,0,1] neg_hi:[0,0,1]
    v_pk_fma_f32 v[154:155], v[70:71], v[142:143], v[154:155]
    v_pk_fma_f32 v[158:159], v[66:67], v[142:143], v[158:159] neg_lo:[0,0,1] neg_hi:[0,0,1]
    v_cvt_pk_f16_f32 v128, v152, v156
    v_cvt_pk_f16_f32 v129, v153, v157
    v_cvt_pk_f16_f32 v130, v154, v158
    v_cvt_pk_f16_f32 v131, v155, v159
    s_nop 1
    s_nop 0
    v_mfma_f32_16x16x32_f16 v[232:235], v[80:83], v[128:131], 0
    v_mfma_f32_16x16x32_f16 v[236:239], v[84:87], v[128:131], 0
    v_pk_mul_f32 v[152:153], v[72:73], v[144:145]
    v_pk_mul_f32 v[154:155], v[74:75], v[146:147]
    v_pk_mul_f32 v[156:157], v[76:77], v[144:145]
    v_pk_mul_f32 v[158:159], v[78:79], v[146:147]
    v_pk_fma_f32 v[152:153], v[76:77], v[148:149], v[152:153]
    v_pk_fma_f32 v[156:157], v[72:73], v[148:149], v[156:157] neg_lo:[0,0,1] neg_hi:[0,0,1]
    v_pk_fma_f32 v[154:155], v[78:79], v[150:151], v[154:155]
    v_pk_fma_f32 v[158:159], v[74:75], v[150:151], v[158:159] neg_lo:[0,0,1] neg_hi:[0,0,1]
    v_cvt_pk_f16_f32 v132, v152, v156
    v_cvt_pk_f16_f32 v133, v153, v157
    v_cvt_pk_f16_f32 v134, v154, v158
    v_cvt_pk_f16_f32 v135, v155, v159
    s_nop 1
    s_nop 0
    v_mfma_f32_16x16x32_f16 v[240:243], v[80:83], v[132:135], 0
    v_mfma_f32_16x16x32_f16 v[244:247], v[84:87], v[132:135], 0
    v_cvt_pk_f16_f32 v176, v216, v224
    v_cvt_pk_f16_f32 v178, v220, v228
    v_and_or_b32 v176, v176, s58, v210
    v_and_or_b32 v178, v178, s58, v210
    v_cvt_pk_f16_f32 v180, v217, v225
    v_cvt_pk_f16_f32 v182, v221, v229
    v_and_or_b32 v180, v180, s58, v210
    v_and_or_b32 v182, v182, s58, v210
    v_cvt_pk_f16_f32 v184, v218, v226
    v_cvt_pk_f16_f32 v186, v222, v230
    v_and_or_b32 v184, v184, s58, v210
    v_and_or_b32 v186, v186, s58, v210
    v_cvt_pk_f16_f32 v188, v219, v227
    v_cvt_pk_f16_f32 v190, v223, v231
    v_and_or_b32 v188, v188, s58, v210
    v_and_or_b32 v190, v190, s58, v210
    v_cvt_pk_f16_f32 v177, v232, v240
    v_cvt_pk_f16_f32 v179, v236, v244
    v_and_or_b32 v177, v177, s58, v210
    v_and_or_b32 v179, v179, s58, v210
    v_cvt_pk_f16_f32 v181, v233, v241
    v_cvt_pk_f16_f32 v183, v237, v245
    v_and_or_b32 v181, v181, s58, v210
    v_and_or_b32 v183, v183, s58, v210
    v_cvt_pk_f16_f32 v185, v234, v242
    v_cvt_pk_f16_f32 v187, v238, v246
    v_and_or_b32 v185, v185, s58, v210
    v_and_or_b32 v187, v187, s58, v210
    v_cvt_pk_f16_f32 v189, v235, v243
    v_cvt_pk_f16_f32 v191, v239, v247
    v_and_or_b32 v189, v189, s58, v210
    v_and_or_b32 v191, v191, s58, v210
    s_cmp_eq_u32 s50, 0
    s_cbranch_scc1 L_p1_done
    s_mov_b32 exec_hi, s72
    buffer_store_dwordx4 v[176:179], v209, s[12:15], s60 offen sc1
    s_mov_b32 exec_hi, s73
    buffer_store_dwordx4 v[180:183], v209, s[12:15], s61 offen sc1
    buffer_store_dwordx4 v[184:187], v209, s[12:15], s62 offen sc1
    buffer_store_dwordx4 v[188:191], v209, s[12:15], s63 offen sc1
    s_mov_b32 exec_hi, -1
    s_mov_b32 s50, 0
    s_add_u32 s60, s60, 16384
    v_add_u32 v5, 16384, v5
    s_sub_u32 s31, s48, 4
    v_cvt_f32_i32 v252, s31
    v_mul_f32 v252, 0x3d800000, v252
    v_and_b32 v251, 15, v2
    v_lshlrev_b32 v251, 2, v251
    v_cvt_f32_u32 v251, v251
    v_fma_f32 v250, v212, v251, v252
    v_sin_f32 v84, v250
    v_cos_f32 v250, v250
    s_nop 0
    v_cvt_pk_f16_f32 v80, v250, v84
    v_cvt_pk_f16_f32 v84, -v84, v250
    v_fma_f32 v250, v213, v251, v252
    v_sin_f32 v85, v250
    v_cos_f32 v250, v250
    s_nop 0
    v_cvt_pk_f16_f32 v81, v250, v85
    v_cvt_pk_f16_f32 v85, -v85, v250
    v_fma_f32 v250, v214, v251, v252
    v_sin_f32 v86, v250
    v_cos_f32 v250, v250
    s_nop 0
    v_cvt_pk_f16_f32 v82, v250, v86
    v_cvt_pk_f16_f32 v86, -v86, v250
    v_fma_f32 v250, v215, v251, v252
    v_sin_f32 v87, v250
    v_cos_f32 v250, v250
    s_nop 0
    v_cvt_pk_f16_f32 v83, v250, v87
    v_cvt_pk_f16_f32 v87, -v87, v250
    s_branch L_st23
L_p1_done:
    s_mov_b64 exec, 1
    ds_add_u32 v0, v255 offset:42828
    s_mov_b64 exec, -1
    s_setprio 0
    v_mov_b32 v4, v112
    v_mov_b32 v5, v113
    v_mov_b32 v249, v114
    v_mov_b32 v205, v115
    v_mov_b32 v248, v116
    v_mov_b32 v208, v117
    v_mov_b32 v7, v118
    v_mov_b32 v6, v119
    s_and_b32 s31, s2, 7
    s_sub_u32 s32, 8, s31
    s_min_u32 s46, s31, s32
    s_lshr_b32 s53, s31, 2
    s_lshr_b32 s47, s2, 3
    s_and_b32 s32, s47, 1
    s_and_b32 s31, s31, 3
    s_cselect_b32 s53, s53, s32
    s_cselect_b32 s31, 0, 1
    s_lshr_b32 s47, s47, s31
    s_lshl_b32 s53, s53, 4
    s_lshl_b32 s31, s30, 5
    s_add_u32 s53, s53, s31
    s_lshl_b32 s48, s46, 1
    s_add_u32 s48, s48, 2040
    s_mov_b32 s49, 32768
    v_mov_b32 v212, v210
    v_mov_b32 v213, v210
    v_mov_b32 v214, v210
    v_mov_b32 v215, v210
    s_cmp_ge_u32 s2, 224
    s_cbranch_scc1 L_zst_go
L_sync4:
    ds_read_b32 v1, v0 offset:42840
    s_add_u32 s92, s92, 1
    s_bitcmp1_b32 s92, 20
    s_cbranch_scc1 L_sync4x
    s_waitcnt lgkmcnt(0)
    v_readfirstlane_b32 s31, v1
    s_nop 0
    s_cmp_ge_u32 s31, 1
    s_cbranch_scc0 L_sync4
L_sync4x:
L_zst_go:
    s_mov_b32 exec_hi, s72
    buffer_store_dwordx4 v[176:179], v209, s[12:15], s60 offen sc1
    s_mov_b32 exec_hi, s73
    buffer_store_dwordx4 v[180:183], v209, s[12:15], s61 offen sc1
    buffer_store_dwordx4 v[184:187], v209, s[12:15], s62 offen sc1
    buffer_store_dwordx4 v[188:191], v209, s[12:15], s63 offen sc1
    s_mov_b32 exec_hi, -1
L_sync5:
    ds_read_b32 v1, v0 offset:42860
    s_add_u32 s92, s92, 1
    s_bitcmp1_b32 s92, 20
    s_cbranch_scc1 L_sync5x
    s_waitcnt lgkmcnt(0)
    v_readfirstlane_b32 s31, v1
    s_nop 0
    s_cmp_ge_u32 s31, 1
    s_cbranch_scc0 L_sync5
L_sync5x:
    buffer_load_dwordx4 v[24:27], v6, s[12:15], s49 offen
    s_add_u32 m0, s76, 0
    s_nop 0
    buffer_load_dwordx4 v4, s[8:11], 0 offen lds
    s_add_u32 m0, s76, 1024
    s_nop 0
    buffer_load_dwordx4 v5, s[8:11], 0 offen lds
    v_and_b32 v160, 15, v2
    v_add_u32 v160, s53, v160
    v_cvt_f32_u32 v160, v160
    v_add_f32 v160, 0.5, v160
    v_mul_f32 v160, 0x3b800000, v160
    v_and_b32 v161, 32, v2
    v_bfe_u32 v162, v2, 4, 1
    v_lshl_add_u32 v161, v162, 3, v161
    v_cvt_f32_u32 v161, v161
    v_mul_f32 v161, v161, v160
    v_fmamk_f32 v88, v160, 0x0, v161
    v_fmamk_f32 v162, v160, 0x40000000, v161
    v_sin_f32 v104, v88
    v_sin_f32 v163, v162
    v_cos_f32 v88, v88
    v_cos_f32 v162, v162
    v_cvt_pk_f16_f32 v104, v104, v163
    v_cvt_pk_f16_f32 v88, v88, v162
    v_fmamk_f32 v89, v160, 0x40800000, v161
    v_fmamk_f32 v162, v160, 0x40c00000, v161
    v_sin_f32 v105, v89
    v_sin_f32 v163, v162
    v_cos_f32 v89, v89
    v_cos_f32 v162, v162
    v_cvt_pk_f16_f32 v105, v105, v163
    v_cvt_pk_f16_f32 v89, v89, v162
    v_fmamk_f32 v90, v160, 0x41800000, v161
    v_fmamk_f32 v162, v160, 0x41900000, v161
    v_sin_f32 v106, v90
    v_sin_f32 v163, v162
    v_cos_f32 v90, v90
    v_cos_f32 v162, v162
    v_cvt_pk_f16_f32 v106, v106, v163
    v_cvt_pk_f16_f32 v90, v90, v162
    v_fmamk_f32 v91, v160, 0x41a00000, v161
    v_fmamk_f32 v162, v160, 0x41b00000, v161
    v_sin_f32 v107, v91
    v_sin_f32 v163, v162
    v_cos_f32 v91, v91
    v_cos_f32 v162, v162
    v_cvt_pk_f16_f32 v107, v107, v163
    v_cvt_pk_f16_f32 v91, v91, v162
    v_fmamk_f32 v92, v160, 0x42800000, v161
    v_fmamk_f32 v162, v160, 0x42840000, v161
    v_sin_f32 v108, v92
    v_sin_f32 v163, v162
    v_cos_f32 v92, v92
    v_cos_f32 v162, v162
    v_cvt_pk_f16_f32 v108, v108, v163
    v_cvt_pk_f16_f32 v92, v92, v162
    v_fmamk_f32 v93, v160, 0x42880000, v161
    v_fmamk_f32 v162, v160, 0x428c0000, v161
    v_sin_f32 v109, v93
    v_sin_f32 v163, v162
    v_cos_f32 v93, v93
    v_cos_f32 v162, v162
    v_cvt_pk_f16_f32 v109, v109, v163
    v_cvt_pk_f16_f32 v93, v93, v162
    v_fmamk_f32 v94, v160, 0x42a00000, v161
    v_fmamk_f32 v162, v160, 0x42a40000, v161
    v_sin_f32 v110, v94
    v_sin_f32 v163, v162
    v_cos_f32 v94, v94
    v_cos_f32 v162, v162
    v_cvt_pk_f16_f32 v110, v110, v163
    v_cvt_pk_f16_f32 v94, v94, v162
    v_fmamk_f32 v95, v160, 0x42a80000, v161
    v_fmamk_f32 v162, v160, 0x42ac0000, v161
    v_sin_f32 v111, v95
    v_sin_f32 v163, v162
    v_cos_f32 v95, v95
    v_cos_f32 v162, v162
    v_cvt_pk_f16_f32 v111, v111, v163
    v_cvt_pk_f16_f32 v95, v95, v162
    v_fmamk_f32 v96, v160, 0x3f800000, v161
    v_fmamk_f32 v162, v160, 0x40400000, v161
    v_sin_f32 v112, v96
    v_sin_f32 v163, v162
    v_cos_f32 v96, v96
    v_cos_f32 v162, v162
    v_cvt_pk_f16_f32 v112, v112, v163
    v_cvt_pk_f16_f32 v96, v96, v162
    v_fmamk_f32 v97, v160, 0x40a00000, v161
    v_fmamk_f32 v162, v160, 0x40e00000, v161
    v_sin_f32 v113, v97
    v_sin_f32 v163, v162
    v_cos_f32 v97, v97
    v_cos_f32 v162, v162
    v_cvt_pk_f16_f32 v113, v113, v163
    v_cvt_pk_f16_f32 v97, v97, v162
    v_fmamk_f32 v98, v160, 0x41880000, v161
    v_fmamk_f32 v162, v160, 0x41980000, v161
    v_sin_f32 v114, v98
    v_sin_f32 v163, v162
    v_cos_f32 v98, v98
    v_cos_f32 v162, v162
    v_cvt_pk_f16_f32 v114, v114, v163
    v_cvt_pk_f16_f32 v98, v98, v162
    v_fmamk_f32 v99, v160, 0x41a80000, v161
    v_fmamk_f32 v162, v160, 0x41b80000, v161
    v_sin_f32 v115, v99
    v_sin_f32 v163, v162
    v_cos_f32 v99, v99
    v_cos_f32 v162, v162
    v_cvt_pk_f16_f32 v115, v115, v163
    v_cvt_pk_f16_f32 v99, v99, v162
    v_fmamk_f32 v100, v160, 0x42820000, v161
    v_fmamk_f32 v162, v160, 0x42860000, v161
    v_sin_f32 v116, v100
    v_sin_f32 v163, v162
    v_cos_f32 v100, v100
    v_cos_f32 v162, v162
    v_cvt_pk_f16_f32 v116, v116, v163
    v_cvt_pk_f16_f32 v100, v100, v162
    v_fmamk_f32 v101, v160, 0x428a0000, v161
    v_fmamk_f32 v162, v160, 0x428e0000, v161
    v_sin_f32 v117, v101
    v_sin_f32 v163, v162
    v_cos_f32 v101, v101
    v_cos_f32 v162, v162
    v_cvt_pk_f16_f32 v117, v117, v163
    v_cvt_pk_f16_f32 v101, v101, v162
    v_fmamk_f32 v102, v160, 0x42a20000, v161
    v_fmamk_f32 v162, v160, 0x42a60000, v161
    v_sin_f32 v118, v102
    v_sin_f32 v163, v162
    v_cos_f32 v102, v102
    v_cos_f32 v162, v162
    v_cvt_pk_f16_f32 v118, v118, v163
    v_cvt_pk_f16_f32 v102, v102, v162
    v_fmamk_f32 v103, v160, 0x42aa0000, v161
    v_fmamk_f32 v162, v160, 0x42ae0000, v161
    v_sin_f32 v119, v103
    v_sin_f32 v163, v162
    v_cos_f32 v103, v103
    v_cos_f32 v162, v162
    v_cvt_pk_f16_f32 v119, v119, v163
    v_cvt_pk_f16_f32 v103, v103, v162
    v_cmp_gt_u32 vcc, 16, v2
    v_and_b32 v162, 1, v2
    v_lshlrev_b32 v162, 15, v162
    v_or_b32 v162, 0x3c00, v162
    v_and_b32 v160, 0xffff0000, v104
    v_or_b32 v162, v162, v160
    v_cndmask_b32 v104, v104, v162, vcc
    s_mul_i32 s51, s46, 528384
    s_add_u32 s51, s51, 2097152
    s_mul_i32 s54, s47, 16512
    s_lshl_b32 s32, s30, 12
    s_add_u32 s50, s51, s54
    s_add_u32 s50, s50, s32
    s_add_u32 s55, s47, 1
    s_and_b32 s55, s55, 31
    s_mul_i32 s55, s55, 16512
    v_add_u32 v250, s32, v3
    v_add_u32 v199, s76, v3
    v_lshl_add_u32 v200, v2, 7, s32
    v_and_b32 v1, 2, v2
    v_lshl_add_u32 v200, v1, 3, v200
    v_and_b32 v1, 0x70, v3
    v_add_u32 v1, 16384, v1
    s_mov_b32 vcc_lo, 0
    s_mov_b32 vcc_hi, -1
    v_cndmask_b32 v200, v200, v1, vcc
    s_mov_b32 vcc_hi, 0xff
    v_mov_b32 v1, s55
    v_mov_b32 v201, s54
    v_cndmask_b32 v1, v1, v201, vcc
    v_mov_b32 v201, 16640
    v_cndmask_b32 v201, v201, v0, vcc
    v_add_u32 v201, v201, v200
    v_add_u32 v200, v1, v200
    v_lshrrev_b32 v251, 5, v2
    v_lshlrev_b32 v251, 11, v251
    v_bfe_u32 v1, v2, 2, 3
    v_lshl_add_u32 v251, v1, 7, v251
    v_and_b32 v1, 3, v2
    v_lshl_add_u32 v251, v1, 5, v251
    v_bfe_u32 v1, v2, 3, 1
    v_lshl_add_u32 v251, v1, 4, v251
    v_bfe_u32 v1, v2, 4, 1
    v_lshl_add_u32 v251, v1, 3, v251
    v_xor_b32 v252, 16, v251
    v_xor_b32 v253, 8, v251
    v_xor_b32 v254, 24, v251
    v_cmp_gt_u32 vcc, 4, v2
    v_mov_b32 v1, 16384
    s_nop 0
    v_cndmask_b32 v1, v0, v1, vcc
    v_add_u32 v206, v253, v1
    v_add_u32 v207, v254, v1
    s_mov_b32 vcc_lo, 0x88888888
    s_mov_b32 vcc_hi, 0x88888888
    v_mov_b32 v1, 16544
    v_cndmask_b32 v1, 32, v1, vcc
    v_add_u32 v202, v251, v1
    v_add_u32 v203, v253, v1
    v_add_u32 v204, v206, v1
    s_waitcnt vmcnt(0)
L_stat_check:
    v_cmp_ne_u64 vcc, s[28:29], v[26:27]
    s_nop 0
    s_cbranch_vccz L_stat_got
    s_cmp_eq_u32 s35, 0
    s_cbranch_scc1 L_stat_got
    s_sub_u32 s35, s35, 1
    s_sleep 2
    s_mov_b64 exec, vcc
    buffer_load_dwordx4 v[24:27], v6, s[12:15], s49 offen sc1
    s_mov_b64 exec, -1
    s_waitcnt vmcnt(0)
    s_branch L_stat_check
L_stat_got:
    v_cndmask_b32 v24, v24, v25, s[88:89]
    v_mov_b32 v32, v24
    s_nop 1
    v_permlane32_swap_b32 v24, v32
    v_mov_b32 v28, v24
    v_mov_b32 v36, v32
    s_nop 0
    v_permlane16_swap_b32 v24, v28
    v_permlane16_swap_b32 v32, v36
    v_lshlrev_b32 v26, 16, v24
    v_and_b32 v24, 0xffff0000, v24
    v_rcp_f32 v24, v24
    v_lshlrev_b32 v30, 16, v28
    v_and_b32 v28, 0xffff0000, v28
    v_rcp_f32 v28, v28
    v_lshlrev_b32 v34, 16, v32
    v_and_b32 v32, 0xffff0000, v32
    v_rcp_f32 v32, v32
    v_lshlrev_b32 v38, 16, v36
    v_and_b32 v36, 0xffff0000, v36
    v_rcp_f32 v36, v36
    v_mul_f32 v24, 0xbfb8aa3b, v24
    v_mul_f32_e64 v26, -v26, v24
    v_mul_f32 v28, 0xbfb8aa3b, v28
    v_mul_f32_e64 v30, -v30, v28
    v_mul_f32 v32, 0xbfb8aa3b, v32
    v_mul_f32_e64 v34, -v34, v32
    v_mul_f32 v36, 0xbfb8aa3b, v36
    v_mul_f32_e64 v38, -v38, v36
    ds_read_b128 v[8:11], v208 offset:0
    ds_read_b128 v[12:15], v208 offset:1024
    s_waitcnt lgkmcnt(0)
    v_lshlrev_b32 v40, 16, v8
    v_and_b32 v41, 0xffff0000, v8
    v_lshlrev_b32 v42, 16, v9
    v_and_b32 v43, 0xffff0000, v9
    v_lshlrev_b32 v44, 16, v10
    v_and_b32 v45, 0xffff0000, v10
    v_lshlrev_b32 v46, 16, v11
    v_and_b32 v47, 0xffff0000, v11
    v_lshlrev_b32 v48, 16, v12
    v_and_b32 v55, 0xffff0000, v12
    v_lshlrev_b32 v54, 16, v13
    v_and_b32 v53, 0xffff0000, v13
    v_lshlrev_b32 v52, 16, v14
    v_and_b32 v51, 0xffff0000, v14
    v_lshlrev_b32_e64 v50, 16, v15
    v_and_b32 v49, 0xffff0000, v15
    v_pk_fma_f32 v[120:121], v[40:41], v[24:25], v[26:27] op_sel_hi:[1,0,0]
    v_pk_fma_f32 v[122:123], v[42:43], v[24:25], v[26:27] op_sel_hi:[1,0,0]
    v_pk_fma_f32 v[124:125], v[44:45], v[24:25], v[26:27] op_sel_hi:[1,0,0]
    v_pk_fma_f32 v[126:127], v[46:47], v[24:25], v[26:27] op_sel_hi:[1,0,0]
    v_pk_fma_f32 v[128:129], v[48:49], v[28:29], v[30:31] op_sel_hi:[1,0,0]
    v_pk_fma_f32 v[130:131], v[50:51], v[28:29], v[30:31] op_sel_hi:[1,0,0]
    v_pk_fma_f32 v[132:133], v[52:53], v[28:29], v[30:31] op_sel_hi:[1,0,0]
    v_pk_fma_f32 v[134:135], v[54:55], v[28:29], v[30:31] op_sel_hi:[1,0,0]
    v_exp_f32 v216, v120
    v_exp_f32 v217, v121
    v_exp_f32 v218, v122
    v_exp_f32 v219, v123
    v_exp_f32 v220, v124
    v_exp_f32 v221, v125
    v_exp_f32 v222, v126
    v_exp_f32 v223, v127
    v_exp_f32 v224, v128
    v_exp_f32 v225, v129
    v_exp_f32 v226, v130
    v_exp_f32 v227, v131
    v_exp_f32 v228, v132
    v_exp_f32 v229, v133
    v_exp_f32 v230, v134
    v_exp_f32 v231, v135
    v_pk_add_f32 v[216:217], v[216:217], 1.0 op_sel_hi:[1,0]
    v_pk_add_f32 v[218:219], v[218:219], 1.0 op_sel_hi:[1,0]
    v_pk_add_f32 v[220:221], v[220:221], 1.0 op_sel_hi:[1,0]
    v_pk_add_f32 v[222:223], v[222:223], 1.0 op_sel_hi:[1,0]
    v_pk_add_f32 v[224:225], v[224:225], 1.0 op_sel_hi:[1,0]
    v_pk_add_f32 v[226:227], v[226:227], 1.0 op_sel_hi:[1,0]
    v_pk_add_f32 v[228:229], v[228:229], 1.0 op_sel_hi:[1,0]
    v_pk_add_f32 v[230:231], v[230:231], 1.0 op_sel_hi:[1,0]
    v_rcp_f32 v216, v216
    v_rcp_f32 v217, v217
    v_rcp_f32 v218, v218
    v_rcp_f32 v219, v219
    v_rcp_f32 v220, v220
    v_rcp_f32 v221, v221
    v_rcp_f32 v222, v222
    v_rcp_f32 v223, v223
    v_rcp_f32 v224, v224
    v_rcp_f32 v225, v225
    v_rcp_f32 v226, v226
    v_rcp_f32 v227, v227
    v_rcp_f32 v228, v228
    v_rcp_f32 v229, v229
    v_rcp_f32 v230, v230
    v_rcp_f32 v231, v231
    v_pk_mul_f32 v[120:121], v[120:121], v[216:217]
    v_pk_mul_f32 v[122:123], v[122:123], v[218:219]
    v_pk_mul_f32 v[124:125], v[124:125], v[220:221]
    v_pk_mul_f32 v[126:127], v[126:127], v[222:223]
    v_pk_mul_f32 v[128:129], v[128:129], v[224:225]
    v_pk_mul_f32 v[130:131], v[130:131], v[226:227]
    v_pk_mul_f32 v[132:133], v[132:133], v[228:229]
    v_pk_mul_f32 v[134:135], v[134:135], v[230:231]
L_sync6:
    ds_read_b32 v1, v0 offset:42848
    s_add_u32 s92, s92, 1
    s_bitcmp1_b32 s92, 20
    s_cbranch_scc1 L_sync6x
    s_waitcnt lgkmcnt(0)
    v_readfirstlane_b32 s31, v1
    s_nop 0
    s_cmp_ge_u32 s31, 4
    s_cbranch_scc0 L_sync6
L_sync6x:
    s_add_u32 m0, s76, 2048
    s_nop 0
    buffer_load_dwordx4 v249, s[8:11], 0 offen lds
    s_add_u32 m0, s76, 3072
    s_nop 0
    buffer_load_dwordx4 v205, s[8:11], 0 offen lds
L_sync7:
    ds_read_b32 v1, v0 offset:42844
    ds_read_b32 v198, v0 offset:41556
    s_add_u32 s92, s92, 1
    s_bitcmp1_b32 s92, 20
    s_cbranch_scc1 L_sync7x
    s_waitcnt lgkmcnt(1)
    v_readfirstlane_b32 s31, v1
    s_nop 0
    s_cmp_ge_u32 s31, 1
    s_cbranch_scc0 L_sync7
L_sync7x:
    v_and_b32 v6, 48, v2
    v_lshlrev_b32 v6, 1, v6
    v_mov_b32 v209, 2147483392
    s_waitcnt lgkmcnt(0)
    v_readfirstlane_b32 s33, v198
    s_nop 0
    s_andn2_b32 s33, 0x7ff, s33
    s_sub_u32 s31, 0, s33
    s_and_b32 s31, s31, 2047
    s_sub_u32 s32, s33, 1024
    s_sub_u32 s34, s31, 1024
    v_cmp_eq_u32 vcc, s33, v7
    v_cmp_eq_u32 s[54:55], s33, v248
    s_nop 0
    v_cndmask_b32 v4, v4, v209, vcc
    v_cmp_eq_u32 vcc, s31, v7
    v_cmp_eq_u32 s[56:57], s31, v248
    s_nop 0
    v_cndmask_b32 v5, v5, v209, vcc
    v_cmp_eq_u32 vcc, s32, v7
    v_cmp_eq_u32 s[58:59], s32, v248
    s_nop 0
    v_cndmask_b32 v249, v249, v209, vcc
    v_cmp_eq_u32 vcc, s34, v7
    v_cmp_eq_u32 s[60:61], s34, v248
    s_nop 0
    v_cndmask_b32 v205, v205, v209, vcc
    s_or_b64 s[62:63], s[54:55], s[58:59]
    s_or_b64 s[64:65], s[56:57], s[60:61]
    s_waitcnt vmcnt(0)
    buffer_load_dwordx4 v[72:75], v3, s[12:15], s50 offen offset:0 sc1
    buffer_load_dwordx4 v[76:79], v3, s[12:15], s50 offen offset:1024 sc1
    buffer_load_dwordx4 v[80:83], v3, s[12:15], s50 offen offset:2048 sc1
    buffer_load_dwordx4 v[84:87], v3, s[12:15], s50 offen offset:3072 sc1
    s_mov_b32 exec_hi, 0x1ff
    buffer_load_dwordx4 v[212:215], v200, s[12:15], s51 offen sc1
    s_mov_b32 exec_hi, -1
    s_setprio 2
    ds_read_b128 v[16:19], v208 offset:2048
    ds_read_b128 v[20:23], v208 offset:3072
    s_waitcnt lgkmcnt(0)
    v_lshlrev_b32 v56, 16, v16
    v_and_b32 v57, 0xffff0000, v16
    v_lshlrev_b32 v58, 16, v17
    v_and_b32 v59, 0xffff0000, v17
    v_lshlrev_b32 v60, 16, v18
    v_and_b32 v61, 0xffff0000, v18
    v_lshlrev_b32 v62, 16, v19
    v_and_b32 v63, 0xffff0000, v19
    v_lshlrev_b32 v64, 16, v20
    v_and_b32 v71, 0xffff0000, v20
    v_lshlrev_b32 v70, 16, v21
    v_and_b32 v69, 0xffff0000, v21
    v_lshlrev_b32 v68, 16, v22
    v_and_b32 v67, 0xffff0000, v22
    v_lshlrev_b32 v66, 16, v23
    v_and_b32 v65, 0xffff0000, v23
    v_pk_fma_f32 v[136:137], v[56:57], v[32:33], v[34:35] op_sel_hi:[1,0,0]
    v_pk_fma_f32 v[138:139], v[58:59], v[32:33], v[34:35] op_sel_hi:[1,0,0]
    v_pk_fma_f32 v[140:141], v[60:61], v[32:33], v[34:35] op_sel_hi:[1,0,0]
    v_pk_fma_f32 v[142:143], v[62:63], v[32:33], v[34:35] op_sel_hi:[1,0,0]
    v_pk_fma_f32 v[144:145], v[64:65], v[36:37], v[38:39] op_sel_hi:[1,0,0]
    v_pk_fma_f32 v[146:147], v[66:67], v[36:37], v[38:39] op_sel_hi:[1,0,0]
    v_pk_fma_f32 v[148:149], v[68:69], v[36:37], v[38:39] op_sel_hi:[1,0,0]
    v_pk_fma_f32 v[150:151], v[70:71], v[36:37], v[38:39] op_sel_hi:[1,0,0]
    v_exp_f32 v232, v136
    v_exp_f32 v233, v137
    v_exp_f32 v234, v138
    v_exp_f32 v235, v139
    v_exp_f32 v236, v140
    v_exp_f32 v237, v141
    v_exp_f32 v238, v142
    v_exp_f32 v239, v143
    v_exp_f32 v240, v144
    v_exp_f32 v241, v145
    v_exp_f32 v242, v146
    v_exp_f32 v243, v147
    v_exp_f32 v244, v148
    v_exp_f32 v245, v149
    v_exp_f32 v246, v150
    v_exp_f32 v247, v151
    v_pk_add_f32 v[232:233], v[232:233], 1.0 op_sel_hi:[1,0]
    v_pk_add_f32 v[234:235], v[234:235], 1.0 op_sel_hi:[1,0]
    v_pk_add_f32 v[236:237], v[236:237], 1.0 op_sel_hi:[1,0]
    v_pk_add_f32 v[238:239], v[238:239], 1.0 op_sel_hi:[1,0]
    v_pk_add_f32 v[240:241], v[240:241], 1.0 op_sel_hi:[1,0]
    v_pk_add_f32 v[242:243], v[242:243], 1.0 op_sel_hi:[1,0]
    v_pk_add_f32 v[244:245], v[244:245], 1.0 op_sel_hi:[1,0]
    v_pk_add_f32 v[246:247], v[246:247], 1.0 op_sel_hi:[1,0]
    v_rcp_f32 v232, v232
    v_rcp_f32 v233, v233
    v_rcp_f32 v234, v234
    v_rcp_f32 v235, v235
    v_rcp_f32 v236, v236
    v_rcp_f32 v237, v237
    v_rcp_f32 v238, v238
    v_rcp_f32 v239, v239
    v_rcp_f32 v240, v240
    v_rcp_f32 v241, v241
    v_rcp_f32 v242, v242
    v_rcp_f32 v243, v243
    v_rcp_f32 v244, v244
    v_rcp_f32 v245, v245
    v_rcp_f32 v246, v246
    v_rcp_f32 v247, v247
    v_pk_mul_f32 v[136:137], v[136:137], v[232:233]
    v_pk_mul_f32 v[138:139], v[138:139], v[234:235]
    v_pk_mul_f32 v[140:141], v[140:141], v[236:237]
    v_pk_mul_f32 v[142:143], v[142:143], v[238:239]
    v_pk_mul_f32 v[144:145], v[144:145], v[240:241]
    v_pk_mul_f32 v[146:147], v[146:147], v[242:243]
    v_pk_mul_f32 v[148:149], v[148:149], v[244:245]
    v_pk_mul_f32 v[150:151], v[150:151], v[246:247]
L_z_wait:
    s_setprio 2
    s_waitcnt vmcnt(4)
    v_xor_b32 v160, v210, v72
    v_xor_b32 v161, v210, v73
    v_xor_b32 v162, v210, v74
    v_xor_b32 v163, v210, v75
    ds_write_b128 v250, v[160:163] offset:0
    v_or3_b32 v1, v160, v161, v162
    v_or_b32 v1, v1, v163
    s_waitcnt vmcnt(3)
    v_xor_b32 v164, v210, v76
    v_xor_b32 v165, v210, v77
    v_xor_b32 v166, v210, v78
    v_xor_b32 v167, v210, v79
    ds_write_b128 v250, v[164:167] offset:1024
    v_or3_b32 v1, v1, v164, v165
    v_or3_b32 v1, v1, v166, v167
    s_waitcnt vmcnt(2)
    v_xor_b32 v168, v210, v80
    v_xor_b32 v169, v210, v81
    v_xor_b32 v170, v210, v82
    v_xor_b32 v171, v210, v83
    ds_write_b128 v250, v[168:171] offset:2048
    v_or3_b32 v1, v1, v168, v169
    v_or3_b32 v1, v1, v170, v171
    s_waitcnt vmcnt(1)
    v_xor_b32 v172, v210, v84
    v_xor_b32 v173, v210, v85
    v_xor_b32 v174, v210, v86
    v_xor_b32 v175, v210, v87
    ds_write_b128 v250, v[172:175] offset:3072
    v_or3_b32 v1, v1, v172, v173
    v_or3_b32 v1, v1, v174, v175
    s_waitcnt vmcnt(0)
    v_xor_b32 v176, v210, v212
    v_xor_b32 v177, v210, v213
    v_xor_b32 v178, v210, v214
    v_xor_b32 v179, v210, v215
    s_mov_b32 exec_hi, 0x1ff
    ds_write_b128 v201, v[176:179]
    s_mov_b32 exec_hi, -1
    v_or3_b32 v1, v1, v176, v177
    v_or3_b32 v1, v1, v178, v179
    v_and_b32 v1, 0x30003, v1
    v_cmp_ne_u32 vcc, 0, v1
    s_nop 0
    s_cbranch_vccz L_z_got
    s_cmp_eq_u32 s35, 0
    s_cbranch_scc1 L_z_got
    s_sub_u32 s35, s35, 1
    s_sleep 2
    s_mov_b64 exec, vcc
    buffer_load_dwordx4 v[72:75], v3, s[12:15], s50 offen offset:0 sc1
    buffer_load_dwordx4 v[76:79], v3, s[12:15], s50 offen offset:1024 sc1
    buffer_load_dwordx4 v[80:83], v3, s[12:15], s50 offen offset:2048 sc1
    buffer_load_dwordx4 v[84:87], v3, s[12:15], s50 offen offset:3072 sc1
    s_and_b32 exec_hi, exec_hi, 0x1ff
    s_or_b32 exec_lo, exec_lo, 1
    buffer_load_dwordx4 v[212:215], v200, s[12:15], s51 offen sc1
    s_mov_b64 exec, -1
    s_waitcnt lgkmcnt(0)
    s_branch L_z_wait
L_z_got:
    s_mov_b64 exec, 1
    ds_add_u32 v0, v255 offset:42832
    s_mov_b64 exec, -1
L_sync8:
    ds_read_b32 v1, v0 offset:42832
    ds_read_b64_tr_b16 v[152:153], v251 offset:0
    ds_read_b64_tr_b16 v[154:155], v251 offset:1024
    ds_read_b64_tr_b16 v[156:157], v252 offset:0
    ds_read_b64_tr_b16 v[158:159], v252 offset:1024
    s_add_u32 s92, s92, 1
    s_bitcmp1_b32 s92, 20
    s_cbranch_scc1 L_sync8x
    s_waitcnt lgkmcnt(4)
    v_readfirstlane_b32 s31, v1
    s_nop 0
    s_cmp_ge_u32 s31, 4
    s_cbranch_scc0 L_sync8
L_sync8x:
    ds_read_b64_tr_b16 v[160:161], v251 offset:4096
    ds_read_b64_tr_b16 v[162:163], v251 offset:5120
    ds_read_b64_tr_b16 v[164:165], v252 offset:4096
    ds_read_b64_tr_b16 v[166:167], v252 offset:5120
    ds_read_b64_tr_b16 v[168:169], v251 offset:8192
    ds_read_b64_tr_b16 v[170:171], v251 offset:9216
    ds_read_b64_tr_b16 v[172:173], v252 offset:8192
    ds_read_b64_tr_b16 v[174:175], v252 offset:9216
    s_waitcnt lgkmcnt(8)
    v_mfma_f32_16x16x32_f16 v[216:219], v[152:155], v[88:91], 0
    v_mfma_f32_16x16x32_f16 v[220:223], v[156:159], v[88:91], 0
    ds_read_b64_tr_b16 v[176:177], v251 offset:12288
    ds_read_b64_tr_b16 v[178:179], v251 offset:13312
    ds_read_b64_tr_b16 v[180:181], v252 offset:12288
    ds_read_b64_tr_b16 v[182:183], v252 offset:13312
    s_waitcnt lgkmcnt(8)
    v_mfma_f32_16x16x32_f16 v[216:219], v[160:163], v[92:95], v[216:219]
    v_mfma_f32_16x16x32_f16 v[220:223], v[164:167], v[92:95], v[220:223]
    ds_read_b64_tr_b16 v[152:153], v206 offset:0
    ds_read_b64_tr_b16 v[154:155], v253 offset:1024
    ds_read_b64_tr_b16 v[156:157], v207 offset:0
    ds_read_b64_tr_b16 v[158:159], v254 offset:1024
    s_waitcnt lgkmcnt(8)
    v_mfma_f32_16x16x32_f16 v[224:227], v[168:171], v[96:99], 0
    v_mfma_f32_16x16x32_f16 v[228:231], v[172:175], v[96:99], 0
    ds_read_b64_tr_b16 v[160:161], v253 offset:4096
    ds_read_b64_tr_b16 v[162:163], v253 offset:5120
    ds_read_b64_tr_b16 v[164:165], v254 offset:4096
    ds_read_b64_tr_b16 v[166:167], v254 offset:5120
    s_waitcnt lgkmcnt(8)
    v_mfma_f32_16x16x32_f16 v[224:227], v[176:179], v[100:103], v[224:227]
    v_mfma_f32_16x16x32_f16 v[228:231], v[180:183], v[100:103], v[228:231]
    ds_read_b64_tr_b16 v[168:169], v253 offset:8192
    ds_read_b64_tr_b16 v[170:171], v253 offset:9216
    ds_read_b64_tr_b16 v[172:173], v254 offset:8192
    ds_read_b64_tr_b16 v[174:175], v254 offset:9216
    s_waitcnt lgkmcnt(8)
    v_mfma_f32_16x16x32_f16 v[216:219], v[152:155], v[104:107], v[216:219]
    v_mfma_f32_16x16x32_f16 v[220:223], v[156:159], v[104:107], v[220:223]
    ds_read_b64_tr_b16 v[176:177], v253 offset:12288
    ds_read_b64_tr_b16 v[178:179], v253 offset:13312
    ds_read_b64_tr_b16 v[180:181], v254 offset:12288
    ds_read_b64_tr_b16 v[182:183], v254 offset:13312
    s_waitcnt lgkmcnt(8)
    v_mfma_f32_16x16x32_f16 v[216:219], v[160:163], v[108:111], v[216:219]
    v_mfma_f32_16x16x32_f16 v[220:223], v[164:167], v[108:111], v[220:223]
    ds_read_b64_tr_b16 v[72:73], v202 offset:0
    ds_read_b64_tr_b16 v[74:75], v202 offset:1024
    ds_read_b64_tr_b16 v[76:77], v202 offset:4096
    ds_read_b64_tr_b16 v[78:79], v202 offset:5120
    s_waitcnt lgkmcnt(8)
    v_mfma_f32_16x16x32_f16 v[224:227], v[168:171], v[112:115], v[224:227]
    v_mfma_f32_16x16x32_f16 v[228:231], v[172:175], v[112:115], v[228:231]
    ds_read_b64_tr_b16 v[80:81], v202 offset:8192
    ds_read_b64_tr_b16 v[82:83], v202 offset:9216
    ds_read_b64_tr_b16 v[84:85], v202 offset:12288
    ds_read_b64_tr_b16 v[86:87], v202 offset:13312
    s_waitcnt lgkmcnt(8)
    v_mfma_f32_16x16x32_f16 v[224:227], v[176:179], v[116:119], v[224:227]
    v_mfma_f32_16x16x32_f16 v[228:231], v[180:183], v[116:119], v[228:231]
    ds_read_b64_tr_b16 v[240:241], v204 offset:0
    ds_read_b64_tr_b16 v[242:243], v203 offset:1024
    ds_read_b64_tr_b16 v[244:245], v203 offset:4096
    ds_read_b64_tr_b16 v[246:247], v203 offset:5120
    s_waitcnt lgkmcnt(8)
    ds_read_b64_tr_b16 v[184:185], v203 offset:8192
    ds_read_b64_tr_b16 v[186:187], v203 offset:9216
    ds_read_b64_tr_b16 v[188:189], v203 offset:12288
    ds_read_b64_tr_b16 v[190:191], v203 offset:13312
    v_mfma_f32_16x16x32_f16 v[232:235], v[72:75], v[88:91], 0
    v_mfma_f32_16x16x32_f16 v[232:235], v[76:79], v[92:95], v[232:235]
    s_waitcnt lgkmcnt(4)
    v_mfma_f32_16x16x32_f16 v[236:239], v[80:83], v[96:99], 0
    v_mfma_f32_16x16x32_f16 v[236:239], v[84:87], v[100:103], v[236:239]
    v_pk_add_f32 v[152:153], v[216:217], v[224:225]
    v_pk_add_f32 v[154:155], v[218:219], v[226:227]
    v_pk_add_f32 v[156:157], v[220:221], v[228:229]
    v_pk_add_f32 v[158:159], v[222:223], v[230:231]
    v_mfma_f32_16x16x32_f16 v[232:235], v[240:243], v[104:107], v[232:235]
    v_mfma_f32_16x16x32_f16 v[232:235], v[244:247], v[108:111], v[232:235]
    v_pk_fma_f32 v[40:41], v[152:153], v[120:121], v[40:41]
    v_pk_fma_f32 v[42:43], v[154:155], v[122:123], v[42:43]
    v_pk_fma_f32 v[44:45], v[156:157], v[124:125], v[44:45]
    v_pk_fma_f32 v[46:47], v[158:159], v[126:127], v[46:47]
    s_waitcnt lgkmcnt(0)
    s_nop 0
    v_mfma_f32_16x16x32_f16 v[236:239], v[184:187], v[112:115], v[236:239]
    v_mfma_f32_16x16x32_f16 v[236:239], v[188:191], v[116:119], v[236:239]
    v_cvt_pk_bf16_f32 v8, v40, v41
    v_cvt_pk_bf16_f32 v9, v42, v43
    v_cvt_pk_bf16_f32 v10, v44, v45
    v_cvt_pk_bf16_f32 v11, v46, v47
    ds_write_b128 v208, v[8:11] offset:0
    ds_read_b128 v[24:27], v199 offset:0
    v_pk_add_f32 v[160:161], v[216:217], v[224:225] neg_lo:[0,1] neg_hi:[0,1]
    v_pk_add_f32 v[162:163], v[218:219], v[226:227] neg_lo:[0,1] neg_hi:[0,1]
    v_pk_add_f32 v[164:165], v[220:221], v[228:229] neg_lo:[0,1] neg_hi:[0,1]
    v_pk_add_f32 v[166:167], v[222:223], v[230:231] neg_lo:[0,1] neg_hi:[0,1]
    s_cmp_eq_u64 s[62:63], 0
    s_cbranch_scc1 L_nodump0
    s_mov_b64 exec, s[54:55]
    ds_write_b128 v6, v[152:155] offset:42496
    ds_write_b128 v6, v[156:159] offset:42512
    s_mov_b64 exec, s[58:59]
    ds_write_b128 v6, v[160:163] offset:42496
    ds_write_b128 v6, v[164:167] offset:42512
    s_mov_b64 exec, 1
    ds_add_u32 v0, v255 offset:42836
    s_mov_b64 exec, -1
    s_waitcnt lgkmcnt(0)
L_nodump0:
    s_nop 0
    v_pk_fma_f32 v[56:57], v[160:161], v[136:137], v[56:57]
    v_pk_fma_f32 v[58:59], v[162:163], v[138:139], v[58:59]
    v_pk_fma_f32 v[60:61], v[164:165], v[140:141], v[60:61]
    v_pk_fma_f32 v[62:63], v[166:167], v[142:143], v[62:63]
    v_cvt_pk_bf16_f32 v16, v56, v57
    v_cvt_pk_bf16_f32 v17, v58, v59
    v_cvt_pk_bf16_f32 v18, v60, v61
    v_cvt_pk_bf16_f32 v19, v62, v63
    ds_write_b128 v208, v[16:19] offset:2048
    ds_read_b128 v[32:35], v199 offset:2048
    s_waitcnt lgkmcnt(2)
    buffer_store_dwordx4 v[24:27], v4, s[16:19], 0 offen sc1
    v_add_f32 v152, v232, v236
    v_sub_f32 v160, v232, v236
    s_cmp_eq_u64 s[64:65], 0
    s_cbranch_scc1 L_nodump1
    s_mov_b64 exec, s[56:57]
    ds_write_b128 v6, v[152:155] offset:42624
    ds_write_b128 v6, v[156:159] offset:42640
    s_mov_b64 exec, s[60:61]
    ds_write_b128 v6, v[160:163] offset:42624
    ds_write_b128 v6, v[164:167] offset:42640
    s_mov_b64 exec, 1
    ds_add_u32 v0, v255 offset:42864
    s_mov_b64 exec, -1
    s_waitcnt lgkmcnt(0)
L_nodump1:
    v_pk_fma_f32 v[48:49], v[152:153], v[128:129], v[48:49]
    v_pk_fma_f32 v[50:51], v[154:155], v[130:131], v[50:51]
    v_pk_fma_f32 v[52:53], v[156:157], v[132:133], v[52:53]
    v_pk_fma_f32 v[54:55], v[158:159], v[134:135], v[54:55]
    v_cvt_pk_bf16_f32 v12, v48, v55
    v_cvt_pk_bf16_f32 v13, v54, v53
    v_cvt_pk_bf16_f32 v14, v52, v51
    v_cvt_pk_bf16_f32 v15, v50, v49
    ds_write_b128 v208, v[12:15] offset:1024
    ds_read_b128 v[28:31], v199 offset:1024
    s_waitcnt lgkmcnt(2)
    s_nop 0
    buffer_store_dwordx4 v[32:35], v249, s[16:19], 0 offen sc1
    v_pk_fma_f32 v[64:65], v[160:161], v[144:145], v[64:65]
    v_pk_fma_f32 v[66:67], v[162:163], v[146:147], v[66:67]
    v_pk_fma_f32 v[68:69], v[164:165], v[148:149], v[68:69]
    v_pk_fma_f32 v[70:71], v[166:167], v[150:151], v[70:71]
    v_cvt_pk_bf16_f32 v20, v64, v71
    v_cvt_pk_bf16_f32 v21, v70, v69
    v_cvt_pk_bf16_f32 v22, v68, v67
    v_cvt_pk_bf16_f32 v23, v66, v65
    ds_write_b128 v208, v[20:23] offset:3072
    ds_read_b128 v[36:39], v199 offset:3072
    s_waitcnt lgkmcnt(2)
    buffer_store_dwordx4 v[28:31], v5, s[16:19], 0 offen sc1
    s_waitcnt lgkmcnt(0)
    buffer_store_dwordx4 v[36:39], v205, s[16:19], 0 offen sc1
    s_branch L_fin
L_dma_done:
    s_setprio 0
    s_lshr_b32 s31, s47, 2
    s_andn2_b32 s31, s31, s75
    s_add_u32 s50, s31, s46
    s_lshl_b32 s31, s50, 17
    s_bfe_u32 s32, s2, 0x20003
    s_lshl_b32 s32, s32, 2
    s_add_u32 s51, s32, s30
    s_lshl_b32 s32, s51, 7
    s_add_u32 s31, s31, s32
    v_lshrrev_b32 v6, 3, v2
    v_lshlrev_b32 v6, 11, v6
    v_and_b32 v7, 0x70, v3
    v_and_b32 v11, 16, v2
    v_lshlrev_b32 v11, 1, v11
    v_xor_b32 v11, v11, v7
    v_add3_u32 v6, v6, v11, s31
    v_xor_b32 v11, 64, v6
    s_lshl_b32 s74, s30, 13
    s_cmp_lt_u32 s30, 2
    s_mov_b32 s31, 125952
    s_cselect_b32 s31, 60416, s31
    s_add_u32 s74, s74, s31
    s_mov_b32 s60, 4096
    s_mov_b32 s61, 8192
    s_mov_b32 s62, 12288
    v_bfe_u32 v8, v2, 2, 3
    v_lshlrev_b32 v9, 5, v8
    s_lshl_b32 s31, s30, 6
    v_xor_b32 v9, s31, v9
    v_bfe_u32 v8, v2, 2, 2
    v_lshl_add_u32 v9, v8, 8, v9
    v_lshrrev_b32 v8, 4, v2
    v_lshl_add_u32 v9, v8, 11, v9
    v_and_b32 v10, 3, v2
    v_lshl_add_u32 v9, v10, 3, v9
    v_add_u32 v9, 76800, v9
    v_xor_b32 v10, 32, v9
    v_lshlrev_b32 v8, 4, v8
    s_lshr_b32 s31, s30, 1
    s_and_b32 s32, s31, s75
    s_lshl_b32 s32, s32, 8
    v_add_u32 v8, s32, v8
    s_cmp_eq_u32 s75, 0
    s_cselect_b32 s32, 12, 9
    s_lshl_b32 s31, s31, s32
    s_lshl_b32 s32, s46, 3
    s_add_u32 s32, s32, s47
    s_lshl_b32 s32, s32, 9
    s_add_u32 s31, s31, s32
    s_and_b32 s32, s30, 1
    s_lshl_b32 s32, s32, 8
    s_add_u32 s31, s31, s32
    s_add_u32 s31, s31, 262144
    v_lshl_add_u32 v13, v2, 3, s31
    s_waitcnt lgkmcnt(0)
    s_add_u32 s28, s28, 0x7f4a7c15
    s_addc_u32 s29, s29, 0x9e3779b9
    s_and_b32 s31, s28, 0xff
    v_mov_b32 v14, s31
    s_mov_b32 s49, 0xffffff00
    s_cmp_lg_u32 s30, 2
    s_cbranch_scc1 L_no_tlb
    s_mov_b32 s52, s44
    s_mov_b32 s53, s45
    s_mov_b32 s54, 0x400000
    s_mov_b32 s55, 0x00020000
    v_lshlrev_b32 v250, 18, v2
    v_min_u32 v250, 0x3ffffc, v250
    s_mov_b32 exec_lo, 0x1ffff
    s_mov_b32 exec_hi, 0x0
    buffer_load_dword v252, v250, s[52:55], 0 offen
    s_mov_b64 exec, 0x3f
    v_lshlrev_b32 v250, 20, v2
    v_add_u32 v250, 753664, v250
    v_min_u32 v250, 4491392, v250
    buffer_load_dword v251, v250, s[12:15], 0 offen
    s_mov_b64 exec, 3
    v_mul_u32_u24 v250, 0x1f800, v2
    v_add_u32 v250, v250, v6
    buffer_load_dword v253, v250, s[24:27], 0 offen
    s_mov_b64 exec, -1
L_no_tlb:
    s_cmp_lg_u32 s66, 0
    s_cbranch_scc1 L_tagged
    s_mov_b64 exec, 1
    ds_add_u32 v0, v255 offset:42872
    s_mov_b64 exec, -1
L_tagged:
    s_cmp_eq_u32 s30, 3
    s_cbranch_scc1 L_h1
    s_cmp_eq_u32 s66, 0
    s_cbranch_scc1 L_key
    s_cmp_lg_u32 s30, 0
    s_cbranch_scc1 L_follower
    s_setprio 3
    s_waitcnt vmcnt(16)
    s_mov_b64 exec, 1
    ds_add_u32 v0, v255 offset:42868
    s_mov_b64 exec, -1
    s_nop 0
    ds_read_b64_tr_b16 v[36:37], v9 offset:0
    ds_read_b64_tr_b16 v[38:39], v9 offset:1024
    ds_read_b64_tr_b16 v[40:41], v10 offset:0
    ds_read_b64_tr_b16 v[42:43], v10 offset:1024
    ds_read_b64_tr_b16 v[44:45], v9 offset:32768
    ds_read_b64_tr_b16 v[46:47], v9 offset:33792
    ds_read_b64_tr_b16 v[48:49], v10 offset:32768
    ds_read_b64_tr_b16 v[50:51], v10 offset:33792
    ds_read_b64_tr_b16 v[52:53], v9 offset:8192
    ds_read_b64_tr_b16 v[54:55], v9 offset:9216
    ds_read_b64_tr_b16 v[56:57], v10 offset:8192
    ds_read_b64_tr_b16 v[58:59], v10 offset:9216
    ds_read_b64_tr_b16 v[60:61], v9 offset:40960
    ds_read_b64_tr_b16 v[62:63], v9 offset:41984
    s_waitcnt lgkmcnt(12)
    ds_read_b64_tr_b16 v[64:65], v10 offset:40960
    ds_read_b64_tr_b16 v[66:67], v10 offset:41984
    s_waitcnt lgkmcnt(12)
    ds_read_b64_tr_b16 v[68:69], v9 offset:16384
    ds_read_b64_tr_b16 v[70:71], v9 offset:17408
    s_waitcnt lgkmcnt(12)
    ds_read_b64_tr_b16 v[72:73], v10 offset:16384
    ds_read_b64_tr_b16 v[74:75], v10 offset:17408
    s_waitcnt lgkmcnt(12)
    ds_read_b64_tr_b16 v[76:77], v9 offset:49152
    ds_read_b64_tr_b16 v[78:79], v9 offset:50176
    s_waitcnt lgkmcnt(12)
    ds_read_b64_tr_b16 v[80:81], v10 offset:49152
    ds_read_b64_tr_b16 v[82:83], v10 offset:50176
    s_waitcnt vmcnt(8)
    s_mov_b64 exec, 1
    ds_add_u32 v0, v255 offset:42868
    s_mov_b64 exec, -1
    s_branch L_d_first
L_follower:
    v_readfirstlane_b32 s52, v13
    s_and_b32 s32, s30, 1
    s_lshl_b32 s32, s32, 8
    s_sub_u32 s52, s52, s32
    s_lshl_b32 s31, s50, 12
    s_sub_u32 s31, s31, s32
    s_lshl_b32 s32, s51, 8
    s_add_u32 s31, s31, s32
    s_add_u32 s53, s31, 524288
    s_load_dword s54, s[12:13], s53
    s_load_dword s54, s[12:13], s52
    s_add_u32 s52, s52, 64
    s_add_u32 s53, s53, 64
    s_load_dword s54, s[12:13], s53
    s_load_dword s54, s[12:13], s52
    s_add_u32 s52, s52, 64
    s_add_u32 s53, s53, 64
    s_load_dword s54, s[12:13], s53
    s_load_dword s54, s[12:13], s52
    s_add_u32 s52, s52, 64
    s_add_u32 s53, s53, 64
    s_load_dword s54, s[12:13], s53
    s_load_dword s54, s[12:13], s52
    s_add_u32 s52, s52, 64
    s_add_u32 s53, s53, 64
    s_waitcnt lgkmcnt(0)
    s_load_dword s54, s[12:13], s53
    s_load_dword s54, s[12:13], s52
    s_add_u32 s52, s52, 64
    s_add_u32 s53, s53, 64
    s_load_dword s54, s[12:13], s53
    s_load_dword s54, s[12:13], s52
    s_add_u32 s52, s52, 64
    s_add_u32 s53, s53, 64
    s_load_dword s54, s[12:13], s53
    s_load_dword s54, s[12:13], s52
    s_add_u32 s52, s52, 64
    s_add_u32 s53, s53, 64
    s_load_dword s54, s[12:13], s53
    s_load_dword s54, s[12:13], s52
L_sync9:
    ds_read_b32 v1, v0 offset:42868
    s_add_u32 s92, s92, 1
    s_bitcmp1_b32 s92, 20
    s_cbranch_scc1 L_sync9x
    s_waitcnt lgkmcnt(0)
    v_readfirstlane_b32 s31, v1
    s_nop 0
    s_cmp_ge_u32 s31, 1
    s_cbranch_scc0 L_sync9
L_sync9x:
    s_setprio 3
    s_nop 0
    ds_read_b64_tr_b16 v[36:37], v9 offset:0
    ds_read_b64_tr_b16 v[38:39], v9 offset:1024
    ds_read_b64_tr_b16 v[40:41], v10 offset:0
    ds_read_b64_tr_b16 v[42:43], v10 offset:1024
    ds_read_b64_tr_b16 v[44:45], v9 offset:32768
    ds_read_b64_tr_b16 v[46:47], v9 offset:33792
    ds_read_b64_tr_b16 v[48:49], v10 offset:32768
    ds_read_b64_tr_b16 v[50:51], v10 offset:33792
    ds_read_b64_tr_b16 v[52:53], v9 offset:8192
    ds_read_b64_tr_b16 v[54:55], v9 offset:9216
    ds_read_b64_tr_b16 v[56:57], v10 offset:8192
    ds_read_b64_tr_b16 v[58:59], v10 offset:9216
    ds_read_b64_tr_b16 v[60:61], v9 offset:40960
    ds_read_b64_tr_b16 v[62:63], v9 offset:41984
    s_waitcnt lgkmcnt(12)
    ds_read_b64_tr_b16 v[64:65], v10 offset:40960
    ds_read_b64_tr_b16 v[66:67], v10 offset:41984
    s_waitcnt lgkmcnt(12)
    ds_read_b64_tr_b16 v[68:69], v9 offset:16384
    ds_read_b64_tr_b16 v[70:71], v9 offset:17408
    s_waitcnt lgkmcnt(12)
    ds_read_b64_tr_b16 v[72:73], v10 offset:16384
    ds_read_b64_tr_b16 v[74:75], v10 offset:17408
    s_waitcnt lgkmcnt(12)
    ds_read_b64_tr_b16 v[76:77], v9 offset:49152
    ds_read_b64_tr_b16 v[78:79], v9 offset:50176
    s_waitcnt lgkmcnt(12)
    ds_read_b64_tr_b16 v[80:81], v10 offset:49152
    ds_read_b64_tr_b16 v[82:83], v10 offset:50176
    s_add_u32 s67, s30, 0
L_sync10:
    ds_read_b32 v1, v0 offset:42868
    s_add_u32 s92, s92, 1
    s_bitcmp1_b32 s92, 20
    s_cbranch_scc1 L_sync10x
    s_waitcnt lgkmcnt(0)
    v_readfirstlane_b32 s31, v1
    s_nop 0
    s_cmp_ge_u32 s31, s67
    s_cbranch_scc0 L_sync10
L_sync10x:
L_d_first:
    s_add_u32 m0, s74, 0
    s_mov_b32 s31, 0
    buffer_load_dwordx4 v6, s[24:27], s31 offen nt lds
    s_add_u32 m0, s74, 1024
    s_mov_b32 s31, 16384
    buffer_load_dwordx4 v11, s[24:27], s31 offen nt lds
    s_add_u32 m0, s74, 2048
    s_mov_b32 s31, 32768
    buffer_load_dwordx4 v6, s[24:27], s31 offen nt lds
    s_add_u32 m0, s74, 3072
    s_mov_b32 s31, 49152
    buffer_load_dwordx4 v11, s[24:27], s31 offen nt lds
    s_add_u32 m0, s74, 4096
    s_mov_b32 s31, 65536
    buffer_load_dwordx4 v6, s[24:27], s31 offen nt lds
    s_cmp_lg_u32 s30, 0
    s_cbranch_scc1 L_k3_waitp
    s_waitcnt vmcnt(5)
    s_mov_b64 exec, 1
    ds_add_u32 v0, v255 offset:42868
    s_mov_b64 exec, -1
L_k3_waitp:
    s_waitcnt lgkmcnt(4)
    s_branch L_sync11a
L_sync11:
    s_waitcnt lgkmcnt(0)
L_sync11a:
    ds_read_b32 v1, v0 offset:42868
    ds_read_b64_tr_b16 v[84:85], v9 offset:24576
    ds_read_b64_tr_b16 v[86:87], v9 offset:25600
    ds_read_b64_tr_b16 v[88:89], v10 offset:24576
    ds_read_b64_tr_b16 v[90:91], v10 offset:25600
    ds_read_b64_tr_b16 v[92:93], v9 offset:57344
    ds_read_b64_tr_b16 v[94:95], v9 offset:58368
    ds_read_b64_tr_b16 v[96:97], v10 offset:57344
    ds_read_b64_tr_b16 v[98:99], v10 offset:58368
    s_add_u32 s92, s92, 1
    s_bitcmp1_b32 s92, 20
    s_cbranch_scc1 L_sync11x
    s_waitcnt lgkmcnt(8)
    v_readfirstlane_b32 s31, v1
    s_nop 0
    s_cmp_ge_u32 s31, 3
    s_cbranch_scc0 L_sync11
L_sync11x:
L_key:
    s_waitcnt lgkmcnt(0)
L_sync12:
    ds_read_b32 v1, v0 offset:42844
    ds_read_b64 v[18:19], v0 offset:41552
    ds_read_b128 v[20:23], v8 offset:41600
    ds_read_b128 v[24:27], v8 offset:41664
    ds_read_b128 v[28:31], v8 offset:41728
    ds_read_b128 v[32:35], v8 offset:41792
    s_add_u32 s92, s92, 1
    s_bitcmp1_b32 s92, 20
    s_cbranch_scc1 L_sync12x
    s_waitcnt lgkmcnt(5)
    v_readfirstlane_b32 s31, v1
    s_nop 0
    s_cmp_ge_u32 s31, 1
    s_cbranch_scc0 L_sync12
L_sync12x:
    s_cmp_eq_u32 s66, 0
    s_cbranch_scc1 L_idle
    s_branch L_xs_ok
L_h1:
    s_mov_b32 s63, 4096
    s_lshl_b32 s31, s47, 8
    v_lshlrev_b32 v15, 3, v2
    v_add_u32 v16, s31, v15
    s_cmp_lg_u32 s66, 0
    s_cbranch_scc1 L_gate
L_sync13:
    ds_read_b32 v1, v0 offset:42828
    s_add_u32 s92, s92, 1
    s_bitcmp1_b32 s92, 20
    s_cbranch_scc1 L_sync13x
    s_waitcnt lgkmcnt(0)
    v_readfirstlane_b32 s31, v1
    s_nop 0
    s_cmp_ge_u32 s31, 4
    s_cbranch_scc0 L_sync13
L_sync13x:
    s_branch L_gate_open
L_gate:
L_sync14:
    ds_read_b32 v1, v0 offset:42828
    s_add_u32 s92, s92, 1
    s_bitcmp1_b32 s92, 20
    s_cbranch_scc1 L_sync14x
    s_waitcnt lgkmcnt(0)
    v_readfirstlane_b32 s31, v1
    s_nop 0
    s_cmp_ge_u32 s31, 1
    s_cbranch_scc0 L_sync14
L_sync14x:
L_gate_open:
    s_setprio 3
    buffer_load_dwordx4 v[20:23], v3, s[12:15], s63 offen offset:0 sc1
    buffer_load_dwordx4 v[24:27], v3, s[12:15], s63 offen offset:1024 sc1
    buffer_load_dwordx4 v[28:31], v3, s[12:15], s63 offen offset:2048 sc1
    buffer_load_dwordx4 v[32:35], v3, s[12:15], s63 offen offset:3072 sc1
    s_mov_b64 exec, 1
    ds_add_u32 v0, v255 offset:42860
    s_mov_b64 exec, -1
    s_waitcnt vmcnt(0)
L_mi_check:
    v_cmp_ne_u64 s[52:53], s[28:29], v[22:23]
    v_cmp_ne_u64 s[54:55], s[28:29], v[26:27]
    v_cmp_ne_u64 s[56:57], s[28:29], v[30:31]
    v_cmp_ne_u64 s[58:59], s[28:29], v[34:35]
    v_max_u32 v18, v21, v25
    v_max3_u32 v18, v18, v29, v33
    s_or_b64 s[64:65], s[52:53], s[54:55]
    s_or_b64 vcc, s[56:57], s[58:59]
    s_or_b64 s[64:65], s[64:65], vcc
    s_cbranch_scc0 L_mi_got
    s_cmp_eq_u32 s35, 0
    s_cbranch_scc1 L_mi_got
    s_sub_u32 s35, s35, 1
    s_sleep 2
    s_mov_b64 exec, s[52:53]
    s_cbranch_execz L_mi_skip0
    buffer_load_dwordx4 v[20:23], v3, s[12:15], s63 offen offset:0 sc1
L_mi_skip0:
    s_mov_b64 exec, s[54:55]
    s_cbranch_execz L_mi_skip1
    buffer_load_dwordx4 v[24:27], v3, s[12:15], s63 offen offset:1024 sc1
L_mi_skip1:
    s_mov_b64 exec, s[56:57]
    s_cbranch_execz L_mi_skip2
    buffer_load_dwordx4 v[28:31], v3, s[12:15], s63 offen offset:2048 sc1
L_mi_skip2:
    s_mov_b64 exec, s[58:59]
    s_cbranch_execz L_mi_skip3
    buffer_load_dwordx4 v[32:35], v3, s[12:15], s63 offen offset:3072 sc1
L_mi_skip3:
    s_mov_b64 exec, -1
    s_waitcnt vmcnt(0)
    s_branch L_mi_check
L_mi_got:
    v_max_u32_dpp v19, v18, v18 row_ror:1 row_mask:0xf bank_mask:0xf
    s_nop 1
    v_max_u32_dpp v19, v19, v19 row_ror:2 row_mask:0xf bank_mask:0xf
    s_nop 1
    v_max_u32_dpp v19, v19, v19 row_ror:4 row_mask:0xf bank_mask:0xf
    s_nop 1
    v_max_u32_dpp v19, v19, v19 row_ror:8 row_mask:0xf bank_mask:0xf
    s_nop 0
    v_readlane_b32 s33, v19, 0
    v_readlane_b32 s31, v19, 16
    v_readlane_b32 s32, v19, 32
    v_readlane_b32 s34, v19, 48
    s_max_u32 s33, s33, s31
    s_max_u32 s32, s32, s34
    s_max_u32 s33, s33, s32
    s_andn2_b32 s31, 0x7ff, s33
    s_lshl_b32 s48, s31, 11
    buffer_load_dwordx2 v[150:151], v16, s[8:11], s48 offen
    s_mov_b64 exec, 1
    ds_add_u32 v0, v255 offset:42840
    s_mov_b64 exec, -1
    v_cmp_eq_u32 s[52:53], s33, v25
    v_cmp_eq_u32 s[54:55], s33, v29
    v_cmp_eq_u32 s[56:57], s33, v33
    v_cmp_eq_u32 vcc, s33, v18
    v_cndmask_b32 v19, v20, v24, s[52:53]
    v_cndmask_b32 v19, v19, v28, s[54:55]
    v_cndmask_b32 v19, v19, v32, s[56:57]
    s_ff1_i32_b64 s32, vcc
    v_readlane_b32 s34, v19, s32
    v_mov_b32 v19, s33
    s_nop 0
    v_mov_b32 v18, s34
    ds_write_b64 v0, v[18:19] offset:41552
    s_lshl_b32 s52, s34, 16
    s_and_b32 s32, s34, 0xffff0000
    v_rcp_f32 v148, s32
    s_cmp_eq_u32 s66, 0
    s_cbranch_scc1 L_h1_idle
L_sync15:
    ds_read_b32 v1, v0 offset:42868
    s_add_u32 s92, s92, 1
    s_bitcmp1_b32 s92, 20
    s_cbranch_scc1 L_sync15x
    s_waitcnt lgkmcnt(0)
    v_readfirstlane_b32 s31, v1
    s_nop 0
    s_cmp_ge_u32 s31, 1
    s_cbranch_scc0 L_sync15
L_sync15x:
    s_nop 0
    ds_read_b64_tr_b16 v[36:37], v9 offset:0
    ds_read_b64_tr_b16 v[38:39], v9 offset:1024
    ds_read_b64_tr_b16 v[40:41], v10 offset:0
    ds_read_b64_tr_b16 v[42:43], v10 offset:1024
    ds_read_b64_tr_b16 v[44:45], v9 offset:32768
    ds_read_b64_tr_b16 v[46:47], v9 offset:33792
    ds_read_b64_tr_b16 v[48:49], v10 offset:32768
    ds_read_b64_tr_b16 v[50:51], v10 offset:33792
    ds_read_b64_tr_b16 v[52:53], v9 offset:8192
    ds_read_b64_tr_b16 v[54:55], v9 offset:9216
    ds_read_b64_tr_b16 v[56:57], v10 offset:8192
    ds_read_b64_tr_b16 v[58:59], v10 offset:9216
    ds_read_b64_tr_b16 v[60:61], v9 offset:40960
    ds_read_b64_tr_b16 v[62:63], v9 offset:41984
    s_waitcnt lgkmcnt(12)
    ds_read_b64_tr_b16 v[64:65], v10 offset:40960
    ds_read_b64_tr_b16 v[66:67], v10 offset:41984
    s_waitcnt lgkmcnt(12)
    ds_read_b64_tr_b16 v[68:69], v9 offset:16384
    ds_read_b64_tr_b16 v[70:71], v9 offset:17408
    s_waitcnt lgkmcnt(12)
    ds_read_b64_tr_b16 v[72:73], v10 offset:16384
    ds_read_b64_tr_b16 v[74:75], v10 offset:17408
    s_waitcnt lgkmcnt(12)
    ds_read_b64_tr_b16 v[76:77], v9 offset:49152
    ds_read_b64_tr_b16 v[78:79], v9 offset:50176
    s_waitcnt lgkmcnt(12)
    ds_read_b64_tr_b16 v[80:81], v10 offset:49152
    ds_read_b64_tr_b16 v[82:83], v10 offset:50176
    s_waitcnt lgkmcnt(4)
    s_branch L_sync16a
L_sync16:
    s_waitcnt lgkmcnt(0)
L_sync16a:
    ds_read_b32 v1, v0 offset:42868
    ds_read_b64_tr_b16 v[84:85], v9 offset:24576
    ds_read_b64_tr_b16 v[86:87], v9 offset:25600
    ds_read_b64_tr_b16 v[88:89], v10 offset:24576
    ds_read_b64_tr_b16 v[90:91], v10 offset:25600
    ds_read_b64_tr_b16 v[92:93], v9 offset:57344
    ds_read_b64_tr_b16 v[94:95], v9 offset:58368
    ds_read_b64_tr_b16 v[96:97], v10 offset:57344
    ds_read_b64_tr_b16 v[98:99], v10 offset:58368
    s_add_u32 s92, s92, 1
    s_bitcmp1_b32 s92, 20
    s_cbranch_scc1 L_sync16x
    s_waitcnt lgkmcnt(8)
    v_readfirstlane_b32 s31, v1
    s_nop 0
    s_cmp_ge_u32 s31, 3
    s_cbranch_scc0 L_sync16
L_sync16x:
    s_waitcnt vmcnt(0) lgkmcnt(0)
    s_branch L_h1_x
L_h1_idle:
    s_waitcnt vmcnt(0)
L_h1_x:
    v_lshlrev_b32 v20, 16, v150
    v_and_b32 v21, 0xffff0000, v150
    v_lshlrev_b32 v22, 16, v151
    v_and_b32 v23, 0xffff0000, v151
    v_pk_add_f32 v[20:21], v[20:21], s[52:53] op_sel_hi:[1,0] neg_lo:[0,1] neg_hi:[0,1]
    v_pk_add_f32 v[22:23], v[22:23], s[52:53] op_sel_hi:[1,0] neg_lo:[0,1] neg_hi:[0,1]
    v_cvt_pk_bf16_f32 v150, v20, v21
    v_cvt_pk_bf16_f32 v151, v22, v23
    v_lshlrev_b32 v20, 16, v150
    v_and_b32 v21, 0xffff0000, v150
    v_lshlrev_b32 v22, 16, v151
    v_and_b32 v23, 0xffff0000, v151
    v_pk_mul_f32 v[20:21], v[20:21], v[148:149] op_sel_hi:[1,0]
    v_pk_mul_f32 v[22:23], v[22:23], v[148:149] op_sel_hi:[1,0]
    v_cvt_pk_bf16_f32 v150, v20, v21
    v_cvt_pk_bf16_f32 v151, v22, v23
    ds_write_b64 v15, v[150:151] offset:41600
    s_mov_b64 exec, 1
    ds_add_u32 v0, v255 offset:42844
    s_mov_b64 exec, -1
    s_cmp_eq_u32 s66, 0
    s_cbranch_scc1 L_idle
    ds_read_b128 v[20:23], v8 offset:41600
    ds_read_b128 v[24:27], v8 offset:41664
    ds_read_b128 v[28:31], v8 offset:41728
    ds_read_b128 v[32:35], v8 offset:41792
    s_add_u32 m0, s74, 0
    s_mov_b32 s31, 0
    s_nop 0
    buffer_load_dwordx4 v6, s[24:27], s31 offen nt lds
    s_add_u32 m0, s74, 1024
    s_mov_b32 s31, 16384
    buffer_load_dwordx4 v11, s[24:27], s31 offen nt lds
    s_add_u32 m0, s74, 2048
    s_mov_b32 s31, 32768
    buffer_load_dwordx4 v6, s[24:27], s31 offen nt lds
    s_add_u32 m0, s74, 3072
    s_mov_b32 s31, 49152
    buffer_load_dwordx4 v11, s[24:27], s31 offen nt lds
    s_add_u32 m0, s74, 4096
    s_mov_b32 s31, 65536
    buffer_load_dwordx4 v6, s[24:27], s31 offen nt lds
L_xs_ok:
    s_waitcnt lgkmcnt(3)
    v_mfma_f32_16x16x32_bf16 v[132:135], v[20:23], v[36:39], 0
    v_mfma_f32_16x16x32_bf16 v[136:139], v[20:23], v[40:43], 0
    v_mfma_f32_16x16x32_bf16 v[140:143], v[20:23], v[44:47], 0
    v_mfma_f32_16x16x32_bf16 v[144:147], v[20:23], v[48:51], 0
    s_waitcnt lgkmcnt(2)
    v_mfma_f32_16x16x32_bf16 v[132:135], v[24:27], v[52:55], v[132:135]
    v_mfma_f32_16x16x32_bf16 v[136:139], v[24:27], v[56:59], v[136:139]
    v_mfma_f32_16x16x32_bf16 v[140:143], v[24:27], v[60:63], v[140:143]
    v_mfma_f32_16x16x32_bf16 v[144:147], v[24:27], v[64:67], v[144:147]
    s_waitcnt lgkmcnt(1)
    v_mfma_f32_16x16x32_bf16 v[132:135], v[28:31], v[68:71], v[132:135]
    v_mfma_f32_16x16x32_bf16 v[136:139], v[28:31], v[72:75], v[136:139]
    v_mfma_f32_16x16x32_bf16 v[140:143], v[28:31], v[76:79], v[140:143]
    v_mfma_f32_16x16x32_bf16 v[144:147], v[28:31], v[80:83], v[144:147]
    v_readfirstlane_b32 s33, v19
    v_readfirstlane_b32 s34, v18
    s_waitcnt lgkmcnt(0)
    v_mfma_f32_16x16x32_bf16 v[132:135], v[32:35], v[84:87], v[132:135]
    v_mfma_f32_16x16x32_bf16 v[136:139], v[32:35], v[88:91], v[136:139]
    v_mfma_f32_16x16x32_bf16 v[140:143], v[32:35], v[92:95], v[140:143]
    v_mfma_f32_16x16x32_bf16 v[144:147], v[32:35], v[96:99], v[144:147]
    s_mov_b32 vcc_lo, 0xffff0000
    s_mov_b32 vcc_hi, 0
    s_lshl_b32 s31, s50, 12
    s_lshl_b32 s32, s30, 7
    s_add_u32 s31, s31, s32
    s_add_u32 s31, s31, 262144
    v_lshrrev_b32 v15, 3, v2
    v_lshlrev_b32 v15, 9, v15
    v_add3_u32 v15, v15, v7, s31
    v_cndmask_b32 v26, v132, v136, vcc
    v_cndmask_b32 v27, v140, v144, vcc
    v_and_or_b32 v26, v26, s49, v14
    v_and_or_b32 v27, v27, s49, v14
    s_mov_b32 exec_hi, 0
    buffer_store_dwordx2 v[26:27], v13, s[12:15], 0 offen sc1
    s_mov_b64 exec, -1
    s_add_u32 m0, s74, 5120
    s_mov_b32 s31, 81920
    buffer_load_dwordx4 v11, s[24:27], s31 offen nt lds
    s_add_u32 m0, s74, 6144
    s_mov_b32 s31, 98304
    buffer_load_dwordx4 v6, s[24:27], s31 offen nt lds
    s_add_u32 m0, s74, 7168
    s_mov_b32 s31, 114688
    buffer_load_dwordx4 v11, s[24:27], s31 offen nt lds
L_d_done:
    s_mov_b64 exec, 1
    ds_add_u32 v0, v255 offset:42848
    s_mov_b64 exec, -1
    s_cmp_eq_u32 s30, 1
    s_cselect_b32 s31, s2, 0
    s_cmp_lt_u32 s31, 192
    s_cbranch_scc1 L_no_hint
    s_and_b32 s31, s2, 31
    s_lshl_b32 s31, s31, 7
    s_add_u32 s31, s31, 12288
    v_mov_b32 v250, s28
    v_mov_b32 v251, s29
    s_mov_b64 exec, 1
    buffer_store_dwordx2 v[250:251], v0, s[12:15], s31 offen sc1
    s_mov_b64 exec, -1
L_no_hint:
    s_setprio 3
    v_and_b32 v16, 7, v2
    v_lshlrev_b32 v16, 2, v16
    v_lshrrev_b32 v17, 5, v2
    v_lshl_add_u32 v16, v17, 1, v16
    s_lshl_b32 s31, s30, 5
    v_add_u32 v16, s31, v16
    v_and_b32 v17, 48, v2
    v_bfe_u32 v9, v2, 3, 2
    v_lshlrev_b32 v9, 5, v9
    v_bfe_u32 v10, v2, 2, 2
    v_lshl_add_u32 v9, v10, 7, v9
    v_lshl_add_u32 v9, v17, 6, v9
    v_and_b32 v10, 3, v2
    v_lshlrev_b32 v10, 3, v10
    v_add3_u32 v9, v9, v10, s74
    v_xor_b32 v10, 32, v9
    v_xor_b32 v12, 96, v9
    v_xor_b32 v8, 64, v9
    s_lshl_b32 s31, s50, 12
    s_lshl_b32 s32, s51, 8
    s_add_u32 s31, s31, s32
    s_add_u32 s31, s31, 524288
    v_lshl_add_u32 v18, v2, 2, s31
    s_waitcnt vmcnt(5)
    s_waitcnt lgkmcnt(4)
    ds_read_b64_tr_b16 v[100:101], v9 offset:0
    ds_read_b64_tr_b16 v[102:103], v9 offset:512
    ds_read_b64_tr_b16 v[104:105], v10 offset:0
    ds_read_b64_tr_b16 v[106:107], v10 offset:512
    ds_read_b64_tr_b16 v[108:109], v8 offset:0
    ds_read_b64_tr_b16 v[110:111], v8 offset:512
    ds_read_b64_tr_b16 v[112:113], v12 offset:0
    ds_read_b64_tr_b16 v[114:115], v12 offset:512
    s_waitcnt vmcnt(0)
    buffer_load_dwordx4 v[20:23], v15, s[12:15], 0 offen sc1
    s_waitcnt lgkmcnt(4)
    ds_read_b64_tr_b16 v[116:117], v9 offset:4096
    ds_read_b64_tr_b16 v[118:119], v9 offset:4608
    ds_read_b64_tr_b16 v[120:121], v10 offset:4096
    ds_read_b64_tr_b16 v[122:123], v10 offset:4608
    ds_read_b64_tr_b16 v[124:125], v8 offset:4096
    ds_read_b64_tr_b16 v[126:127], v8 offset:4608
    ds_read_b64_tr_b16 v[128:129], v12 offset:4096
    ds_read_b64_tr_b16 v[130:131], v12 offset:4608
    s_mov_b32 s54, 0
    s_branch L_hp_wait
L_hp_poll:
    buffer_load_dwordx4 v[20:23], v15, s[12:15], 0 offen sc1
L_hp_wait:
    s_waitcnt vmcnt(0)
    v_xor_b32 v20, v14, v20
    v_xor_b32 v21, v14, v21
    v_xor_b32 v22, v14, v22
    v_xor_b32 v23, v14, v23
    v_or3_b32 v24, v20, v21, v22
    v_or_b32 v24, v24, v23
    v_and_b32 v24, 0xff, v24
    v_cmp_ne_u32 vcc, 0, v24
    v_permlane16_swap_b32 v20, v21
    v_permlane16_swap_b32 v22, v23
    s_cbranch_vccz L_hp_got
    s_cmp_eq_u32 s35, 0
    s_cbranch_scc1 L_hp_got
    s_sub_u32 s35, s35, 1
    s_branch L_hp_poll
L_hp_got:
    v_add_f32 v20, v20, v21
    v_add_f32 v22, v22, v23
    s_nop 1
    v_permlane32_swap_b32 v20, v22
    v_add_f32 v20, v20, v22
    s_nop 1
    v_add_f32_dpp v21, v20, v20 row_ror:8 row_mask:0xf bank_mask:0xf
    v_add_f32_dpp v20, v20, v20 row_ror:8 row_mask:0xf bank_mask:0xf
    s_nop 1
    v_permlane16_swap_b32 v20, v21
    v_cvt_pk_bf16_f32 v20, v20, v21
    v_and_b32 v21, 0xffff0000, v20
    v_lshlrev_b32 v20, 16, v20
    v_mul_f32 v22, 0xbfb8aa3b, v20
    v_exp_f32 v22, v22
    s_nop 0
    v_add_f32 v22, 1.0, v22
    v_rcp_f32 v22, v22
    s_nop 0
    v_mul_f32 v20, v20, v22
    v_cvt_pk_bf16_f32 v20, v20, v20
    v_lshlrev_b32 v20, 16, v20
    v_mul_f32 v20, v20, v21
    v_cvt_pk_bf16_f32 v20, v20, v20
    ds_write_b16 v16, v20 offset:42368
    s_mov_b64 exec, 1
    ds_add_u32 v0, v255 offset:42852
    s_mov_b64 exec, -1
L_sync17:
    ds_read_b32 v1, v0 offset:42852
    ds_read_b128 v[28:31], v17 offset:42368
    ds_read_b128 v[32:35], v17 offset:42432
    s_add_u32 s92, s92, 1
    s_bitcmp1_b32 s92, 20
    s_cbranch_scc1 L_sync17x
    s_waitcnt lgkmcnt(2)
    v_readfirstlane_b32 s31, v1
    s_nop 0
    s_cmp_ge_u32 s31, 4
    s_cbranch_scc0 L_sync17
L_sync17x:
    s_waitcnt lgkmcnt(1)
    v_mfma_f32_16x16x32_bf16 v[36:39], v[28:31], v[100:103], 0
    v_mfma_f32_16x16x32_bf16 v[40:43], v[28:31], v[104:107], 0
    v_mfma_f32_16x16x32_bf16 v[44:47], v[28:31], v[108:111], 0
    v_mfma_f32_16x16x32_bf16 v[48:51], v[28:31], v[112:115], 0
    s_waitcnt lgkmcnt(0)
    v_mfma_f32_16x16x32_bf16 v[36:39], v[32:35], v[116:119], v[36:39]
    v_mfma_f32_16x16x32_bf16 v[40:43], v[32:35], v[120:123], v[40:43]
    v_mfma_f32_16x16x32_bf16 v[44:47], v[32:35], v[124:127], v[44:47]
    v_mfma_f32_16x16x32_bf16 v[48:51], v[32:35], v[128:131], v[48:51]
    s_mov_b32 vcc_lo, 0xffff0000
    s_mov_b32 vcc_hi, 0xffff0000
    s_mov_b32 s52, 0
    s_mov_b32 s53, -1
    s_nop 1
    v_cndmask_b32 v36, v36, v40, vcc
    s_nop 0
    v_cndmask_b32 v44, v44, v48, vcc
    v_cndmask_b32 v36, v36, v44, s[52:53]
    v_and_or_b32 v36, v36, s49, v14
    buffer_store_dword v36, v18, s[12:15], 0 offen sc1
    s_mov_b64 exec, 1
    ds_add_u32 v0, v255 offset:42856
    s_mov_b64 exec, -1
    s_branch L_owner
L_idle:
    s_mov_b64 exec, 1
    ds_add_u32 v0, v255 offset:42868
    s_mov_b64 exec, -1
    s_and_b32 s52, s2, 31
    s_lshl_b32 s52, s52, 7
    s_add_u32 s52, s52, 12288
L_hint:
    s_load_dwordx2 s[54:55], s[12:13], s52 glc
    s_waitcnt lgkmcnt(0)
    s_cmp_eq_u64 s[54:55], s[28:29]
    s_cbranch_scc1 L_hint_ok
    s_cmp_eq_u32 s35, 0
    s_cbranch_scc1 L_hint_ok
    s_sub_u32 s35, s35, 1
    s_sleep 4
    s_branch L_hint
L_hint_ok:
    s_mov_b64 exec, 1
    ds_add_u32 v0, v255 offset:42848
    s_mov_b64 exec, -1
    s_mov_b64 exec, 1
    ds_add_u32 v0, v255 offset:42852
    s_mov_b64 exec, -1
    s_mov_b64 exec, 1
    ds_add_u32 v0, v255 offset:42856
    s_mov_b64 exec, -1
L_idle_done:
    s_waitcnt lgkmcnt(0)
    v_readfirstlane_b32 s33, v19
    v_readfirstlane_b32 s34, v18
L_owner:
    s_setprio 1
    s_and_b32 s31, s2, 7
    s_sub_u32 s32, 8, s31
    s_min_u32 s46, s31, s32
    s_lshr_b32 s53, s31, 2
    s_lshr_b32 s47, s2, 3
    s_and_b32 s32, s47, 1
    s_and_b32 s31, s31, 3
    s_cselect_b32 s53, s53, s32
    s_cselect_b32 s31, 0, 1
    s_lshr_b32 s47, s47, s31
    s_lshl_b32 s53, s53, 4
    s_lshl_b32 s53, s53, 3
    s_add_u32 s53, s53, s46
    s_andn2_b32 s51, 0x7ff, s33
    s_mov_b32 s54, s51
    s_mov_b32 s55, 0
    s_mov_b32 s56, 0
    s_mov_b32 s16, s44
    s_mov_b32 s17, s45
    s_mov_b32 s18, 0x400000
    v_and_b32 v8, 31, v2
    v_lshlrev_b32 v15, 2, v8
    v_lshlrev_b32 v8, 1, v8
    v_mov_b32 v16, 0
L_seg:
    s_xor_b32 s31, s54, s53
    s_and_b32 s31, s31, 0x87
    s_cbranch_scc1 L_seg_next
    s_lshl_b32 s31, s51, 11
    s_lshl_b32 s32, s47, 6
    s_add_u32 s63, s31, s32
    buffer_load_ushort v9, v8, s[8:11], s63 offen
    v_lshrrev_b32 v4, 3, v2
    s_lshl_b32 s31, s30, 4
    v_add_u32 v4, s31, v4
    v_lshlrev_b32 v4, 12, v4
    s_lshl_b32 s31, s47, 7
    s_add_u32 s31, s31, 524288
    v_add3_u32 v4, v4, v7, s31
    s_mov_b32 s62, 32768
    v_mov_b32 v24, v14
    v_mov_b32 v25, v14
    v_mov_b32 v26, v14
    v_mov_b32 v27, v14
    v_lshrrev_b32 v5, 4, v2
    v_lshl_add_u32 v6, v5, 2, v7
    s_lshl_b32 s31, s30, 7
    s_add_u32 s31, s31, s55
    v_add_u32 v6, s31, v6
    s_ashr_i32 s31, s33, 31
    s_orn2_b32 s31, 0x80000000, s31
    s_xor_b32 s31, s31, s33
    s_and_b32 s31, s31, 0xfffff800
    v_cvt_pk_bf16_f32 v11, s31, s31
    v_lshlrev_b32 v11, 16, v11
    v_mul_f32 v11, 0xbfb8aa3b, v11
    v_exp_f32 v11, v11
    s_and_b32 s32, s34, 0xffff0000
    v_add_f32 v11, 1.0, v11
    v_rcp_f32 v11, v11
    v_rcp_f32 v12, s32
    v_cvt_pk_bf16_f32 v11, v11, v11
    v_lshlrev_b32 v11, 16, v11
    s_lshl_b32 s31, s34, 16
    s_waitcnt vmcnt(0)
    v_lshl_add_u32 v13, v8, 1, s55
    s_mov_b64 vcc, -1
    s_mov_b32 s56, 1
L_y_poll:
    s_mov_b64 exec, vcc
    buffer_load_dwordx4 v[20:23], v4, s[12:15], 0 offen sc1
    s_cmp_eq_u32 s30, 3
    s_cbranch_scc1 L_y_one
    buffer_load_dwordx4 v[24:27], v4, s[12:15], s62 offen sc1
L_y_one:
    s_mov_b64 exec, -1
    s_waitcnt vmcnt(0)
    v_xor_b32 v28, v14, v20
    v_xor_b32 v29, v14, v21
    v_xor_b32 v30, v14, v22
    v_xor_b32 v31, v14, v23
    v_xor_b32 v32, v14, v24
    v_xor_b32 v33, v14, v25
    v_xor_b32 v34, v14, v26
    v_xor_b32 v35, v14, v27
    v_or3_b32 v1, v28, v29, v30
    v_or3_b32 v1, v1, v31, v32
    v_or3_b32 v1, v1, v33, v34
    v_or_b32 v1, v1, v35
    v_and_b32 v1, 0xff, v1
    v_cmp_ne_u32 vcc, 0, v1
    v_pk_add_f32 v[28:29], v[28:29], v[32:33]
    v_pk_add_f32 v[30:31], v[30:31], v[34:35]
    s_cbranch_vccz L_y_got
    s_cmp_eq_u32 s35, 0
    s_cbranch_scc1 L_y_got
    s_sub_u32 s35, s35, 1
    s_branch L_y_poll
L_y_got:
    v_permlane16_swap_b32 v28, v29
    v_permlane16_swap_b32 v30, v31
    v_add_f32 v28, v28, v29
    v_add_f32 v30, v30, v31
    s_nop 1
    v_permlane32_swap_b32 v28, v30
    v_add_f32 v28, v28, v30
    s_nop 1
    v_add_f32_dpp v28, v28, v28 row_ror:8 row_mask:0xf bank_mask:0xf
    ds_write_b32 v6, v28 offset:43008
    s_mov_b64 exec, 1
    ds_add_u32 v16, v255 offset:42836
    s_mov_b64 exec, -1
    s_cmp_lg_u32 s30, 0
    s_cbranch_scc1 L_seg_next
    s_cmp_eq_u32 s47, 0
    s_cselect_b32 s32, 0, 2147483392
    v_mov_b32 v5, 2147483392
    v_writelane_b32 v5, s32, 0
    v_mov_b32 v18, s28
    v_mov_b32 v19, s29
    s_lshl_b32 s31, s34, 16
    v_lshlrev_b32 v9, 16, v9
    v_subrev_f32 v10, s31, v9
    v_cvt_pk_bf16_f32 v10, v10, v10
    v_lshlrev_b32 v10, 16, v10
    v_mul_f32 v10, v10, v12
    v_cvt_pk_bf16_f32 v10, v10, v10
    v_lshlrev_b32 v10, 16, v10
L_sync18:
    ds_read_b32 v1, v16 offset:42836
    ds_read_b32 v20, v13 offset:43008
    ds_read_b32 v21, v13 offset:43136
    ds_read_b32 v22, v13 offset:43264
    ds_read_b32 v23, v13 offset:43392
    ds_read_b32 v24, v15 offset:42496
    s_add_u32 s92, s92, 1
    s_bitcmp1_b32 s92, 20
    s_cbranch_scc1 L_sync18x
    s_waitcnt lgkmcnt(5)
    v_readfirstlane_b32 s31, v1
    s_nop 0
    s_cmp_ge_u32 s31, 5
    s_cbranch_scc0 L_sync18
L_sync18x:
    s_waitcnt lgkmcnt(0)
    v_add_f32 v20, v20, v21
    v_add_f32 v22, v22, v23
    v_add_f32 v20, v20, v22
    v_cvt_pk_bf16_f32 v20, v20, v20
    v_lshlrev_b32 v20, 16, v20
    v_mul_f32 v20, v20, v11
    v_cvt_pk_bf16_f32 v20, v20, v20
    v_lshlrev_b32 v20, 16, v20
    v_add_f32 v20, v20, v10
    v_cvt_pk_bf16_f32 v20, v20, v20
    v_lshlrev_b32 v20, 16, v20
    v_mul_f32 v1, 0xbfb8aa3b, v20
    v_mul_f32 v20, v1, v24
    v_exp_f32 v1, v1
    s_nop 0
    v_add_f32 v1, 1.0, v1
    v_rcp_f32 v1, v1
    s_mov_b32 exec_hi, 0
    v_fma_f32 v20, v20, v1, v9
    v_cvt_pk_bf16_f32 v20, v20, v20
    buffer_store_short v20, v8, s[16:19], s63 offen sc1
    buffer_store_dwordx2 v[18:19], v5, s[12:15], 0 offen sc1
    s_mov_b64 exec, -1
L_seg_next:
    s_cmp_lg_u32 s55, 0
    s_cbranch_scc1 L_seg_end
    s_mov_b32 s55, 512
    s_sub_u32 s54, 0, s51
    s_sub_u32 s47, 31, s47
    v_mov_b32 v16, 28
    v_and_b32 v15, 24, v2
    v_xor_b32 v15, 24, v15
    v_sub_u32 v1, 0, v2
    v_and_b32 v1, 7, v1
    v_add_u32 v15, v15, v1
    v_lshlrev_b32 v15, 2, v15
    v_add_u32 v15, 128, v15
    s_branch L_seg
L_seg_end:
L_fin:
L_exit:
    s_endpgm
L_code_end:
.section .rodata,"a"
.p2align 6
.amdhsa_kernel recurrent_scan__spectral_fnet__moe_arch_mod__prompt_kernel
  .amdhsa_next_free_vgpr 256
  .amdhsa_next_free_sgpr 94
  .amdhsa_accum_offset 256
  .amdhsa_group_segment_fixed_size 0
  .amdhsa_kernarg_size 104
  .amdhsa_user_sgpr_count 2
  .amdhsa_user_sgpr_kernarg_segment_ptr 1
  .amdhsa_system_sgpr_workgroup_id_x 1
  .amdhsa_float_denorm_mode_32 3
.end_amdhsa_kernel
```

```asm
; @launch grid=(256,1,1) block=(512,1,1) lds=158720
.amdgcn_target "amdgcn-amd-amdhsa--gfx950"
.text
.globl recurrent_scan__spectral_fnet__moe_arch_mod__prompt_kernel
.p2align 8
.type recurrent_scan__spectral_fnet__moe_arch_mod__prompt_kernel,@function
recurrent_scan__spectral_fnet__moe_arch_mod__prompt_kernel:
    s_cmp_ge_u32 s2, 256
    s_cbranch_scc1 L_exit
    s_load_dwordx2 s[8:9], s[0:1], 0
    s_load_dwordx4 s[36:39], s[0:1], 48
    s_load_dwordx2 s[12:13], s[0:1], 96
    s_getpc_b64 s[32:33]
L_pc:
    s_bfe_u32 s31, s2, 0x30003
    v_subrev_u32 v3, 492, v0
    v_lshl_add_u32 v3, v3, 3, s31
    v_lshlrev_b32 v3, 7, v3
    v_cmp_gt_u32 vcc, L_code_end-L_pc, v3
    s_nop 0
    s_and_saveexec_b64 s[46:47], vcc
    s_cbranch_execz L_nopf
    global_load_dword v254, v3, s[32:33]
L_nopf:
    s_mov_b64 exec, -1
    v_lshrrev_b32 v1, 6, v0
    v_and_b32 v2, 63, v0
    v_readfirstlane_b32 s30, v1
    s_mov_b32 s10, 0x400000
    s_mov_b32 s11, 0x00020000
    s_mov_b32 s14, 0x10000000
    s_mov_b32 s15, 0x00020000
    s_mov_b32 s35, 65536
    s_mov_b32 s92, 0
    v_lshlrev_b32 v3, 4, v2
    v_mov_b32 v0, 0
    v_mov_b32 v255, 1
    s_mov_b32 s3, s30
    s_and_b32 s30, s30, 3
    s_cmp_ge_u32 s3, 4
    s_cbranch_scc1 L_moe
    s_and_b32 s31, s2, 7
    s_lshr_b32 s32, s2, 4
    s_sub_u32 s32, 15, s32
    s_lshl_b32 s32, s32, 3
    s_add_u32 s46, s32, s31
    s_bfe_u32 s47, s2, 0x10003
    s_lshl_b32 s31, s47, 2
    s_add_u32 s51, s31, s30
    s_lshl_b32 s31, s51, 8
    s_add_u32 s52, s31, s46
    s_xor_b32 s54, s52, 1024
    s_sub_u32 s53, 2048, s52
    s_add_u32 s31, s52, 128
    s_cmp_eq_u32 s46, 0
    s_cselect_b32 s53, s31, s53
    s_cselect_b32 s50, 1, 0
    s_xor_b32 s55, s53, 1024
    s_lshl_b32 s56, s52, 11
    s_lshl_b32 s57, s53, 11
    s_lshl_b32 s58, s54, 11
    s_lshl_b32 s59, s55, 11
    s_mov_b32 s22, 2048
    s_mov_b32 s23, 0x00020000
    v_mov_b32 v1, 0
    v_and_b32 v6, 15, v2
    v_lshlrev_b32 v6, 2, v6
    ds_write_b64 v0, v[0:1] offset:41504
    ds_write_b32 v6, v0 offset:42816
    s_waitcnt lgkmcnt(0)
    s_load_dwordx2 s[28:29], s[12:13], 0
    s_load_dwordx2 s[16:17], s[0:1], 80
    buffer_load_dwordx4 v[120:123], v3, s[8:11], s56 offen
    buffer_load_dwordx4 v[124:127], v3, s[8:11], s56 offen offset:1024
    buffer_load_dwordx4 v[128:131], v3, s[8:11], s57 offen
    buffer_load_dwordx4 v[132:135], v3, s[8:11], s57 offen offset:1024
    s_mov_b32 s20, s36
    s_mov_b32 s21, s37
    buffer_load_dwordx4 v[152:155], v3, s[20:23], 0 offen
    buffer_load_dwordx4 v[156:159], v3, s[20:23], 0 offen offset:1024
    buffer_load_dwordx4 v[136:139], v3, s[8:11], s58 offen
    buffer_load_dwordx4 v[140:143], v3, s[8:11], s58 offen offset:1024
    buffer_load_dwordx4 v[144:147], v3, s[8:11], s59 offen
    buffer_load_dwordx4 v[148:151], v3, s[8:11], s59 offen offset:1024
    s_barrier
    s_branch L_dft_rest
L_moe:
    s_load_dwordx2 s[20:21], s[0:1], 64
    s_and_b32 s32, s2, 7
    s_mul_i32 s32, s32, 28
    s_lshr_b32 s31, s2, 3
    s_add_u32 s31, s31, s32
    s_lshr_b32 s46, s31, 3
    s_lshl_b32 s46, s46, 1
    s_and_b32 s47, s31, 7
    s_mov_b32 s75, 0
    s_mov_b32 s18, 7340032
    s_mov_b32 s19, 0x00020000
    s_mov_b32 s22, 7340032
    s_mov_b32 s23, 0x00020000
    s_mov_b32 s26, 7340032
    s_mov_b32 s27, 0x00020000
    v_lshrrev_b32 v4, 4, v2
    v_lshlrev_b32 v5, 5, v4
    v_and_b32 v6, 0x70, v3
    v_xor_b32 v5, v5, v6
    v_mul_u32_u24 v4, 7168, v4
    s_mul_i32 s31, s47, 917504
    s_lshl_b32 s32, s46, 7
    s_add_u32 s31, s31, s32
    v_add3_u32 v4, v4, v5, s31
    s_cmp_eq_u32 s75, 0
    s_mov_b32 s31, 917504
    s_cselect_b32 s31, 128, s31
    v_add_u32 v6, s31, v4
    s_mov_b32 vcc_lo, 0xff00ff00
    s_mov_b32 vcc_hi, 0xff00ff00
    v_cndmask_b32 v5, v6, v4, vcc
    v_cndmask_b32 v4, v4, v6, vcc
    s_mov_b32 s48, 0
    s_mov_b32 s49, 76800
    s_waitcnt lgkmcnt(0)
    s_mov_b32 s16, s38
    s_mov_b32 s17, s39
    s_load_dwordx2 s[28:29], s[12:13], 0
    s_load_dwordx2 s[24:25], s[0:1], 72
    s_load_dwordx2 s[44:45], s[0:1], 80
    s_barrier
    s_cmp_ge_u32 s2, 224
    s_cselect_b32 s66, 0, 1
    s_cbranch_scc1 L_dma_done
    s_cmp_lg_u32 s30, 0
    s_cbranch_scc1 L_dma_done
    s_setprio 3
L_dma0:
    s_mov_b32 m0, s49
    s_waitcnt vmcnt(20)
    buffer_load_dwordx4 v4, s[16:19], s48 offen nt lds
    s_add_u32 m0, s49, 32768
    s_add_u32 s49, s49, 1024
    s_waitcnt vmcnt(20)
    buffer_load_dwordx4 v4, s[20:23], s48 offen nt lds
    s_add_u32 s48, s48, 28672
    s_mov_b32 m0, s49
    s_waitcnt vmcnt(20)
    buffer_load_dwordx4 v4, s[16:19], s48 offen nt lds
    s_add_u32 m0, s49, 32768
    s_add_u32 s49, s49, 1024
    s_waitcnt vmcnt(20)
    buffer_load_dwordx4 v4, s[20:23], s48 offen nt lds
    s_add_u32 s48, s48, 28672
    s_mov_b32 m0, s49
    s_waitcnt vmcnt(20)
    buffer_load_dwordx4 v5, s[16:19], s48 offen nt lds
    s_add_u32 m0, s49, 32768
    s_add_u32 s49, s49, 1024
    s_waitcnt vmcnt(20)
    buffer_load_dwordx4 v5, s[20:23], s48 offen nt lds
    s_add_u32 s48, s48, 28672
    s_mov_b32 m0, s49
    s_waitcnt vmcnt(20)
    buffer_load_dwordx4 v5, s[16:19], s48 offen nt lds
    s_add_u32 m0, s49, 32768
    s_add_u32 s49, s49, 1024
    s_waitcnt vmcnt(20)
    buffer_load_dwordx4 v5, s[20:23], s48 offen nt lds
    s_add_u32 s48, s48, 28672
    s_cmp_lt_u32 s48, 917504
    s_cbranch_scc1 L_dma0
    s_branch L_dma_done
L_dft_rest:
    s_mov_b32 s18, 0x400000
    s_mov_b32 s19, 0x00020000
    s_sub_u32 s31, 2047, s52
    s_sub_u32 s32, 2047, s53
    v_mov_b32 v200, s31
    v_writelane_b32 v200, s32, 63
    s_lshl_b32 s31, s30, 2
    v_mov_b32 v201, s31
    s_bfe_u32 s31, s53, 0x20008
    s_lshl_b32 s31, s31, 2
    s_add_u32 s31, s31, 16
    v_writelane_b32 v201, s31, 63
    v_and_b32 v6, 32, v2
    s_lshl_b32 s31, s51, 2
    v_add_u32 v203, s31, v6
    v_lshrrev_b32 v202, 1, v203
    s_and_b32 s31, s2, 7
    s_lshl_b32 s31, s31, 9
    s_lshr_b32 s32, s2, 3
    s_lshl_b32 s32, s32, 4
    s_add_u32 s31, s31, s32
    s_add_u32 s31, s31, 4096
    v_mov_b32 v4, s31
    v_lshlrev_b32 v5, 3, v2
    s_and_b32 s31, s52, 7
    s_lshl_b32 s31, s31, 11
    s_and_b32 s32, s52, 1024
    s_add_u32 s31, s31, s32
    s_and_b32 s32, s52, 0xf8
    s_lshl_b32 s32, s32, 2
    s_add_u32 s31, s31, s32
    s_add_u32 s31, s31, 32768
    v_writelane_b32 v4, s31, 0
    s_add_u32 s31, s31, 16
    v_writelane_b32 v4, s31, 1
    s_and_b32 s31, s53, 7
    s_lshl_b32 s31, s31, 11
    s_and_b32 s32, s53, 1024
    s_add_u32 s31, s31, s32
    s_and_b32 s32, s53, 0xf8
    s_lshl_b32 s32, s32, 2
    s_add_u32 s31, s31, s32
    s_add_u32 s31, s31, 32768
    v_writelane_b32 v4, s31, 2
    s_add_u32 s31, s31, 16
    v_writelane_b32 v4, s31, 3
    s_mul_i32 s31, s51, 2592
    v_and_b32 v204, 32, v2
    v_lshlrev_b32 v204, 2, v204
    v_add3_u32 v204, v204, v3, s31
    s_lshl_b32 s32, s31, 1
    s_add_u32 s32, s32, 21872
    v_sub_u32 v205, s32, v204
    v_bfe_u32 v206, v2, 2, 2
    v_mul_u32_u24 v206, 2592, v206
    v_lshrrev_b32 v6, 4, v2
    v_mul_u32_u24 v7, 640, v6
    v_add_u32 v206, v206, v7
    v_and_b32 v7, 3, v2
    v_lshlrev_b32 v7, 3, v7
    s_lshl_b32 s31, s30, 7
    v_add3_u32 v206, v206, v7, s31
    v_lshlrev_b32 v6, 12, v6
    v_and_b32 v7, 15, v2
    v_lshl_add_u32 v6, v7, 4, v6
    s_lshl_b32 s31, s30, 8
    v_add_u32 v207, s31, v6
    v_bfe_i32 v208, v2, 4, 1
    v_and_b32 v208, 0x80008000, v208
    s_cmp_eq_u32 s47, 0
    s_movk_i32 s48, 0x7403
    s_cselect_b32 s48, 0x7721, s48
    v_and_b32 v250, 12, v2
    v_bfe_u32 v250, s48, v250, 4
    v_lshrrev_b32 v251, 4, v2
    v_bfe_u32 v252, v2, 1, 1
    v_mul_u32_u24 v251, v251, v252
    v_and_b32 v252, 1, v2
    v_add_u32 v251, v251, v252
    v_cvt_f32_u32 v250, v250
    v_cvt_f32_u32 v251, v251
    v_mul_f32 v250, 0x3e000000, v250
    v_mul_f32 v251, 0x3e800000, v251
    v_cos_f32 v8, v251
    v_add_f32 v251, v251, v250
    v_cos_f32 v9, v251
    v_add_f32 v251, v251, v250
    v_cos_f32 v10, v251
    v_add_f32 v251, v251, v250
    v_cos_f32 v11, v251
    v_add_f32 v251, v251, v250
    v_cos_f32 v12, v251
    v_add_f32 v251, v251, v250
    v_cos_f32 v13, v251
    v_add_f32 v251, v251, v250
    v_cos_f32 v14, v251
    v_add_f32 v251, v251, v250
    v_cos_f32 v15, v251
    v_mul_f32 v8, 0xbf317218, v8
    v_mul_f32 v9, 0xbf317218, v9
    v_mul_f32 v10, 0xbf317218, v10
    v_mul_f32 v11, 0xbf317218, v11
    v_mul_f32 v12, 0xbf317218, v12
    v_mul_f32 v13, 0xbf317218, v13
    v_mul_f32 v14, 0xbf317218, v14
    v_mul_f32 v15, 0xbf317218, v15
    v_lshrrev_b32 v250, 2, v2
    v_and_b32 v250, 12, v250
    v_and_b32 v251, 15, v2
    v_lshlrev_b32 v251, 2, v251
    v_cvt_f32_u32 v250, v250
    v_cvt_f32_u32 v251, v251
    v_mul_f32 v212, 0x3c800000, v250
    s_lshl_b32 s31, s30, 2
    s_lshr_b32 s48, s48, s31
    s_and_b32 s48, s48, 15
    s_sub_u32 s31, s48, 4
    s_mul_i32 s31, s31, s46
    v_cvt_f32_i32 v252, s31
    v_mul_f32 v252, 0x3a000000, v252
    v_add_f32 v213, 0x3c800000, v212
    v_add_f32 v214, 0x3d000000, v212
    v_add_f32 v215, 0x3d400000, v212
    s_and_b32 s31, s2, 7
    s_sub_u32 s32, 8, s31
    s_min_u32 s76, s31, s32
    s_lshr_b32 s78, s31, 2
    s_lshr_b32 s77, s2, 3
    s_and_b32 s32, s77, 1
    s_and_b32 s31, s31, 3
    s_cselect_b32 s78, s78, s32
    s_cselect_b32 s31, 0, 1
    s_lshr_b32 s77, s77, s31
    s_lshl_b32 s78, s78, 4
    s_lshl_b32 s31, s30, 5
    s_add_u32 s78, s78, s31
    s_lshl_b32 s78, s78, 3
    s_add_u32 s78, s78, s76
    s_lshl_b32 s77, s77, 6
    s_sub_u32 s79, 1984, s77
    s_lshl_b32 s76, s76, 1
    s_add_u32 s76, s76, 2040
    v_and_b32 v116, 15, v2
    v_lshl_add_u32 v116, v116, 3, s78
    v_and_b32 v7, 32, v2
    v_lshl_add_u32 v7, v7, 5, v116
    s_mov_b32 vcc_lo, 0xffff0000
    s_mov_b32 vcc_hi, 0xffff0000
    v_sub_u32 v6, 0, v7
    v_cndmask_b32 v7, v7, v6, vcc
    v_and_b32 v6, 7, v7
    v_and_b32 v1, 1024, v7
    v_lshl_add_u32 v6, v6, 11, v1
    v_and_b32 v1, 0xf8, v7
    v_lshl_add_u32 v6, v1, 2, v6
    v_bfe_u32 v1, v7, 9, 1
    v_lshl_add_u32 v119, v1, 4, v6
    v_and_b32 v1, 256, v7
    v_cmp_ne_u32 s[88:89], 0, v1
    v_lshrrev_b32 v118, 2, v2
    v_lshl_add_u32 v118, v118, 3, s78
    v_lshlrev_b32 v1, 1, v2
    v_xor_b32 v1, v1, v3
    v_and_b32 v1, 48, v1
    v_add_u32 v114, 1024, v118
    v_sub_u32 v113, 0, v118
    v_and_b32 v113, 2047, v113
    v_sub_u32 v115, 2048, v114
    v_add_u32 v112, s77, v1
    v_lshl_add_u32 v114, v114, 11, v112
    v_lshl_add_u32 v112, v118, 11, v112
    v_xor_b32 v1, 48, v1
    v_add_u32 v1, s79, v1
    v_lshl_add_u32 v113, v113, 11, v1
    v_lshl_add_u32 v115, v115, 11, v1
    s_lshl_b32 s76, s30, 12
    s_add_u32 s76, s76, 44032
    v_and_b32 v1, 15, v2
    v_lshlrev_b32 v6, 6, v1
    v_lshlrev_b32 v1, 3, v2
    v_xor_b32 v1, v1, v2
    v_and_b32 v1, 48, v1
    v_add3_u32 v117, v6, v1, s76
    v_mul_f32 v250, v212, v251
    v_fmamk_f32 v52, v250, 0x3d800000, v252
    v_sin_f32 v20, v250
    v_cos_f32 v250, v250
    v_cos_f32 v48, v52
    v_sin_f32 v52, v52
    v_cvt_pk_f16_f32 v16, v250, v20
    v_cvt_pk_f16_f32 v20, -v20, v250
    v_mul_f32 v250, v213, v251
    v_fmamk_f32 v53, v250, 0x3d800000, v252
    v_sin_f32 v21, v250
    v_cos_f32 v250, v250
    v_cos_f32 v49, v53
    v_sin_f32 v53, v53
    v_cvt_pk_f16_f32 v17, v250, v21
    v_cvt_pk_f16_f32 v21, -v21, v250
    v_mul_f32 v250, v214, v251
    v_fmamk_f32 v54, v250, 0x3d800000, v252
    v_sin_f32 v22, v250
    v_cos_f32 v250, v250
    v_cos_f32 v50, v54
    v_sin_f32 v54, v54
    v_cvt_pk_f16_f32 v18, v250, v22
    v_cvt_pk_f16_f32 v22, -v22, v250
    v_mul_f32 v250, v215, v251
    v_fmamk_f32 v55, v250, 0x3d800000, v252
    v_sin_f32 v23, v250
    v_cos_f32 v250, v250
    v_cos_f32 v51, v55
    v_sin_f32 v55, v55
    v_cvt_pk_f16_f32 v19, v250, v23
    v_cvt_pk_f16_f32 v23, -v23, v250
    v_add_f32 v251, 1.0, v251
    v_mul_f32 v250, v212, v251
    v_fmamk_f32 v60, v250, 0x3d800000, v252
    v_sin_f32 v28, v250
    v_cos_f32 v250, v250
    v_cos_f32 v56, v60
    v_sin_f32 v60, v60
    v_cvt_pk_f16_f32 v24, v250, v28
    v_cvt_pk_f16_f32 v28, -v28, v250
    v_mul_f32 v250, v213, v251
    v_fmamk_f32 v61, v250, 0x3d800000, v252
    v_sin_f32 v29, v250
    v_cos_f32 v250, v250
    v_cos_f32 v57, v61
    v_sin_f32 v61, v61
    v_cvt_pk_f16_f32 v25, v250, v29
    v_cvt_pk_f16_f32 v29, -v29, v250
    v_mul_f32 v250, v214, v251
    v_fmamk_f32 v62, v250, 0x3d800000, v252
    v_sin_f32 v30, v250
    v_cos_f32 v250, v250
    v_cos_f32 v58, v62
    v_sin_f32 v62, v62
    v_cvt_pk_f16_f32 v26, v250, v30
    v_cvt_pk_f16_f32 v30, -v30, v250
    v_mul_f32 v250, v215, v251
    v_fmamk_f32 v63, v250, 0x3d800000, v252
    v_sin_f32 v31, v250
    v_cos_f32 v250, v250
    v_cos_f32 v59, v63
    v_sin_f32 v63, v63
    v_cvt_pk_f16_f32 v27, v250, v31
    v_cvt_pk_f16_f32 v31, -v31, v250
    v_add_f32 v251, 1.0, v251
    v_mul_f32 v250, v212, v251
    v_fmamk_f32 v68, v250, 0x3d800000, v252
    v_sin_f32 v36, v250
    v_cos_f32 v250, v250
    v_cos_f32 v64, v68
    v_sin_f32 v68, v68
    v_cvt_pk_f16_f32 v32, v250, v36
    v_cvt_pk_f16_f32 v36, -v36, v250
    v_mul_f32 v250, v213, v251
    v_fmamk_f32 v69, v250, 0x3d800000, v252
    v_sin_f32 v37, v250
    v_cos_f32 v250, v250
    v_cos_f32 v65, v69
    v_sin_f32 v69, v69
    v_cvt_pk_f16_f32 v33, v250, v37
    v_cvt_pk_f16_f32 v37, -v37, v250
    v_mul_f32 v250, v214, v251
    v_fmamk_f32 v70, v250, 0x3d800000, v252
    v_sin_f32 v38, v250
    v_cos_f32 v250, v250
    v_cos_f32 v66, v70
    v_sin_f32 v70, v70
    v_cvt_pk_f16_f32 v34, v250, v38
    v_cvt_pk_f16_f32 v38, -v38, v250
    v_mul_f32 v250, v215, v251
    v_fmamk_f32 v71, v250, 0x3d800000, v252
    v_sin_f32 v39, v250
    v_cos_f32 v250, v250
    v_cos_f32 v67, v71
    v_sin_f32 v71, v71
    v_cvt_pk_f16_f32 v35, v250, v39
    v_cvt_pk_f16_f32 v39, -v39, v250
    v_add_f32 v251, 1.0, v251
    v_mov_b32 v160, 0
    v_mov_b32 v161, 0
    v_mov_b32 v162, 0
    v_mov_b32 v163, 0
    v_mov_b32 v164, 0
    v_mov_b32 v165, 0
    v_mov_b32 v166, 0
    v_mov_b32 v167, 0
    v_mov_b32 v168, 0
    v_mov_b32 v169, 0
    v_mov_b32 v170, 0
    s_mov_b32 s57, 0x3f803f80
    s_mov_b32 s59, 0xffff
    s_brev_b32 s67, 1
    s_mov_b32 s66, 0
    s_brev_b32 s64, 1
    s_brev_b32 s65, 1
    s_cmp_eq_u32 s47, 0
    s_movk_i32 s62, -10368
    s_cselect_b32 s62, 10368, s62
    s_waitcnt lgkmcnt(0)
    s_add_u32 s28, s28, 0x7f4a7c15
    s_addc_u32 s29, s29, 0x9e3779b9
    v_mov_b32 v174, s28
    v_mov_b32 v175, s29
    s_cmp_lt_u32 s2, 224
    s_cbranch_scc1 L_epoch_ok
L_sync1:
    ds_read_b32 v1, v0 offset:42872
    s_add_u32 s92, s92, 1
    s_bitcmp1_b32 s92, 20
    s_cbranch_scc1 L_sync1x
    s_waitcnt lgkmcnt(0)
    v_readfirstlane_b32 s31, v1
    s_nop 0
    s_cmp_ge_u32 s31, 4
    s_cbranch_scc0 L_sync1
L_sync1x:
L_epoch_ok:
    s_setprio 3
    s_waitcnt vmcnt(8)
    v_dot2c_f32_bf16 v160, s57, v120
    v_dot2c_f32_bf16 v164, v120, v120
    v_dot2c_f32_bf16 v160, s57, v121
    v_dot2c_f32_bf16 v164, v121, v121
    v_dot2c_f32_bf16 v160, s57, v122
    v_dot2c_f32_bf16 v164, v122, v122
    v_dot2c_f32_bf16 v160, s57, v123
    v_dot2c_f32_bf16 v164, v123, v123
    v_dot2c_f32_bf16 v160, s57, v124
    v_dot2c_f32_bf16 v164, v124, v124
    v_dot2c_f32_bf16 v160, s57, v125
    v_dot2c_f32_bf16 v164, v125, v125
    v_dot2c_f32_bf16 v160, s57, v126
    v_dot2c_f32_bf16 v164, v126, v126
    v_dot2c_f32_bf16 v160, s57, v127
    v_dot2c_f32_bf16 v164, v127, v127
    s_waitcnt vmcnt(6)
    v_dot2c_f32_bf16 v161, s57, v128
    v_dot2c_f32_bf16 v165, v128, v128
    v_dot2c_f32_bf16 v161, s57, v129
    v_dot2c_f32_bf16 v165, v129, v129
    v_dot2c_f32_bf16 v161, s57, v130
    v_dot2c_f32_bf16 v165, v130, v130
    v_dot2c_f32_bf16 v161, s57, v131
    v_dot2c_f32_bf16 v165, v131, v131
    v_dot2c_f32_bf16 v161, s57, v132
    v_dot2c_f32_bf16 v165, v132, v132
    v_dot2c_f32_bf16 v161, s57, v133
    v_dot2c_f32_bf16 v165, v133, v133
    v_dot2c_f32_bf16 v161, s57, v134
    v_dot2c_f32_bf16 v165, v134, v134
    v_dot2c_f32_bf16 v161, s57, v135
    v_dot2c_f32_bf16 v165, v135, v135
    s_waitcnt vmcnt(4)
    v_dot2c_f32_bf16 v170, s57, v152
    v_dot2c_f32_bf16 v170, s57, v153
    v_dot2c_f32_bf16 v170, s57, v154
    v_dot2c_f32_bf16 v170, s57, v155
    v_dot2c_f32_bf16 v170, s57, v156
    v_dot2c_f32_bf16 v170, s57, v157
    v_dot2c_f32_bf16 v170, s57, v158
    v_dot2c_f32_bf16 v170, s57, v159
    v_dot2c_f32_bf16 v168, v152, v120
    v_dot2c_f32_bf16 v169, v152, v128
    v_dot2c_f32_bf16 v168, v153, v121
    v_dot2c_f32_bf16 v169, v153, v129
    v_dot2c_f32_bf16 v168, v154, v122
    v_dot2c_f32_bf16 v169, v154, v130
    v_dot2c_f32_bf16 v168, v155, v123
    v_dot2c_f32_bf16 v169, v155, v131
    v_mov_b32 v171, v170
    v_dot2c_f32_bf16 v168, v156, v124
    v_dot2c_f32_bf16 v169, v156, v132
    v_dot2c_f32_bf16 v168, v157, v125
    v_dot2c_f32_bf16 v169, v157, v133
    v_dot2c_f32_bf16 v168, v158, v126
    v_dot2c_f32_bf16 v169, v158, v134
    v_dot2c_f32_bf16 v168, v159, v127
    v_dot2c_f32_bf16 v169, v159, v135
    v_permlane32_swap_b32 v160, v161
    v_permlane32_swap_b32 v164, v165
    v_permlane32_swap_b32 v170, v171
    v_permlane32_swap_b32 v168, v169
    v_add_f32 v160, v160, v161
    v_add_f32 v164, v164, v165
    v_add_f32 v170, v170, v171
    v_add_f32_e64 v168, v168, v169
    v_add_f32_dpp v160, v160, v160 row_shr:1 row_mask:0xf bank_mask:0xf
    v_add_f32_dpp v164, v164, v164 row_shr:1 row_mask:0xf bank_mask:0xf
    v_add_f32_dpp v170, v170, v170 row_shr:1 row_mask:0xf bank_mask:0xf
    v_add_f32_dpp v168, v168, v168 row_shr:1 row_mask:0xf bank_mask:0xf
    v_add_f32_dpp v160, v160, v160 row_shr:2 row_mask:0xf bank_mask:0xf
    v_add_f32_dpp v164, v164, v164 row_shr:2 row_mask:0xf bank_mask:0xf
    v_add_f32_dpp v170, v170, v170 row_shr:2 row_mask:0xf bank_mask:0xf
    v_add_f32_dpp v168, v168, v168 row_shr:2 row_mask:0xf bank_mask:0xf
    v_add_f32_dpp v160, v160, v160 row_shr:4 row_mask:0xf bank_mask:0xf
    v_add_f32_dpp v164, v164, v164 row_shr:4 row_mask:0xf bank_mask:0xf
    v_add_f32_dpp v170, v170, v170 row_shr:4 row_mask:0xf bank_mask:0xf
    v_add_f32_dpp v168, v168, v168 row_shr:4 row_mask:0xf bank_mask:0xf
    v_add_f32_dpp v160, v160, v160 row_shr:8 row_mask:0xf bank_mask:0xf
    v_add_f32_dpp v164, v164, v164 row_shr:8 row_mask:0xf bank_mask:0xf
    v_add_f32_dpp v170, v170, v170 row_shr:8 row_mask:0xf bank_mask:0xf
    v_add_f32_dpp v168, v168, v168 row_shr:8 row_mask:0xf bank_mask:0xf
    v_add_f32_dpp v160, v160, v160 row_bcast:15 row_mask:0xa bank_mask:0xf
    v_add_f32_dpp v164, v164, v164 row_bcast:15 row_mask:0xa bank_mask:0xf
    v_add_f32_dpp v170, v170, v170 row_bcast:15 row_mask:0xa bank_mask:0xf
    v_add_f32_dpp v168, v168, v168 row_bcast:15 row_mask:0xa bank_mask:0xf
    v_mul_f32 v160, 0x3a800000, v160
    v_mul_f32 v164, 0x3a800000, v164
    v_fma_f32 v164, -v160, v160, v164
    v_cvt_pk_bf16_f32 v161, -v160, -v160
    v_max_f32 v164, 0, v164
    v_cvt_pk_bf16_f32 v164, v164, v164
    v_and_b32 v164, 0xffff0000, v164
    v_add_f32 v164, 0x3727c5ac, v164
    v_cvt_pk_bf16_f32 v164, v164, v164
    v_and_b32 v164, 0xffff0000, v164
    v_sqrt_f32 v164, v164
    v_and_b32 v165, 0xffff0000, v161
    v_cvt_pk_bf16_f32 v248, v160, v164
    v_and_b32 v164, 0xffff0000, v248
    v_rcp_f32 v164, v164
    v_fmac_f32 v168, v170, v165
    v_mul_f32 v168, v168, v164
    v_ashrrev_i32 v170, 31, v168
    v_or_b32 v170, 0x80000000, v170
    v_xor_b32 v168, v168, v170
    v_and_b32 v168, 0xfffff800, v168
    v_or_b32 v249, v200, v168
    s_mov_b64 exec, s[64:65]
    ds_write_b32 v201, v248 offset:41472
    ds_max_u64 v0, v[248:249] offset:41504
    s_mov_b64 exec, 1
    ds_add_rtn_u32 v1, v0, v255 offset:42816
    s_mov_b64 exec, 31
    ds_read_b64 v[172:173], v5 offset:41472
    s_mov_b64 exec, s[64:65]
    ds_write_b16 v202, v161 offset:41568
    ds_write_b32 v203, v164 offset:42752
    s_mov_b64 exec, -1
    s_nop 0
    v_mov_b32_dpp v6, v128 wave_rol:1 row_mask:0xf bank_mask:0xf
    v_mov_b32_dpp v7, v132 wave_rol:1 row_mask:0xf bank_mask:0xf
    v_bfi_b32 v221, s59, v131, v130
    v_bfi_b32 v222, s59, v130, v129
    v_bfi_b32 v223, s59, v129, v128
    v_bfi_b32 v217, s59, v135, v134
    v_bfi_b32 v218, s59, v134, v133
    v_bfi_b32 v219, s59, v133, v132
    v_cndmask_b32 v220, v6, v7, s[66:67]
    v_cndmask_b32 v216, v7, v6, s[66:67]
    v_bfi_b32 v220, s59, v220, v131
    v_bfi_b32 v216, s59, v216, v135
    s_waitcnt lgkmcnt(2)
    v_readfirstlane_b32 s31, v1
    s_nop 0
    s_cmp_lg_u32 s31, 3
    s_cbranch_scc1 L_not_last
    s_mov_b64 exec, 31
    buffer_store_dwordx4 v[172:175], v4, s[12:15], 0 offen sc1
    s_mov_b64 exec, -1
    s_waitcnt vmcnt(1)
    s_branch L_b_ready
L_not_last:
    s_waitcnt vmcnt(0)
L_b_ready:
    s_setprio 3
    ds_write_b128 v204, v[120:123] offset:0
    ds_write_b128 v204, v[124:127] offset:1280
    s_cmp_lg_u32 s50, 0
    s_cbranch_scc1 L_plain1
    ds_write_b128 v205, v[216:219]
    ds_write_b128 v205, v[220:223] offset:1280
    s_branch L_second1
L_plain1:
    ds_write_b128 v204, v[128:131] offset:20736
    ds_write_b128 v204, v[132:135] offset:22016
L_second1:
    v_add_u32 v204, s62, v204
    v_add_u32 v205, s62, v205
    v_dot2c_f32_bf16 v162, s57, v136
    v_dot2c_f32_bf16 v166, v136, v136
    v_dot2c_f32_bf16 v162, s57, v137
    v_dot2c_f32_bf16 v166, v137, v137
    v_dot2c_f32_bf16 v162, s57, v138
    v_dot2c_f32_bf16 v166, v138, v138
    v_dot2c_f32_bf16 v162, s57, v139
    v_dot2c_f32_bf16 v166, v139, v139
    v_dot2c_f32_bf16 v162, s57, v140
    v_dot2c_f32_bf16 v166, v140, v140
    v_dot2c_f32_bf16 v162, s57, v141
    v_dot2c_f32_bf16 v166, v141, v141
    v_dot2c_f32_bf16 v162, s57, v142
    v_dot2c_f32_bf16 v166, v142, v142
    v_dot2c_f32_bf16 v162, s57, v143
    v_dot2c_f32_bf16 v166, v143, v143
    ds_write_b128 v204, v[136:139] offset:0
    ds_write_b128 v204, v[140:143] offset:1280
    v_dot2c_f32_bf16 v163, s57, v144
    v_dot2c_f32_bf16 v167, v144, v144
    v_dot2c_f32_bf16 v163, s57, v145
    v_dot2c_f32_bf16 v167, v145, v145
    v_dot2c_f32_bf16 v163, s57, v146
    v_dot2c_f32_bf16 v167, v146, v146
    v_dot2c_f32_bf16 v163, s57, v147
    v_dot2c_f32_bf16 v167, v147, v147
    v_dot2c_f32_bf16 v163, s57, v148
    v_dot2c_f32_bf16 v167, v148, v148
    v_dot2c_f32_bf16 v163, s57, v149
    v_dot2c_f32_bf16 v167, v149, v149
    v_dot2c_f32_bf16 v163, s57, v150
    v_dot2c_f32_bf16 v167, v150, v150
    v_dot2c_f32_bf16 v163, s57, v151
    v_dot2c_f32_bf16 v167, v151, v151
    v_xor_b32 v202, 8, v202
    v_xor_b32 v203, 16, v203
    s_waitcnt lgkmcnt(2)
    s_nop 0
    v_mov_b32_dpp v6, v144 wave_rol:1 row_mask:0xf bank_mask:0xf
    v_mov_b32_dpp v7, v148 wave_rol:1 row_mask:0xf bank_mask:0xf
    v_bfi_b32 v221, s59, v147, v146
    v_bfi_b32 v222, s59, v146, v145
    v_bfi_b32 v223, s59, v145, v144
    v_bfi_b32 v217, s59, v151, v150
    v_bfi_b32 v218, s59, v150, v149
    v_bfi_b32 v219, s59, v149, v148
    v_cndmask_b32 v220, v6, v7, s[66:67]
    v_cndmask_b32 v216, v7, v6, s[66:67]
    v_bfi_b32 v220, s59, v220, v147
    v_bfi_b32 v216, s59, v216, v151
    s_cmp_lg_u32 s50, 0
    s_cbranch_scc1 L_plain3
    ds_write_b128 v205, v[216:219]
    ds_write_b128 v205, v[220:223] offset:1280
    s_branch L_second3
L_plain3:
    ds_write_b128 v204, v[144:147] offset:20736
    ds_write_b128 v204, v[148:151] offset:22016
L_second3:
    v_permlane32_swap_b32 v162, v163
    v_permlane32_swap_b32 v166, v167
    v_add_f32 v162, v162, v163
    v_add_f32 v166, v166, v167
    s_nop 0
    v_add_f32_dpp v162, v162, v162 row_shr:1 row_mask:0xf bank_mask:0xf
    v_add_f32_dpp v166, v166, v166 row_shr:1 row_mask:0xf bank_mask:0xf
    s_nop 0
    v_add_f32_dpp v162, v162, v162 row_shr:2 row_mask:0xf bank_mask:0xf
    v_add_f32_dpp v166, v166, v166 row_shr:2 row_mask:0xf bank_mask:0xf
    s_nop 0
    v_add_f32_dpp v162, v162, v162 row_shr:4 row_mask:0xf bank_mask:0xf
    v_add_f32_dpp v166, v166, v166 row_shr:4 row_mask:0xf bank_mask:0xf
    s_nop 0
    v_add_f32_dpp v162, v162, v162 row_shr:8 row_mask:0xf bank_mask:0xf
    v_add_f32_dpp v166, v166, v166 row_shr:8 row_mask:0xf bank_mask:0xf
    s_nop 0
    v_add_f32_dpp v162, v162, v162 row_bcast:15 row_mask:0xa bank_mask:0xf
    v_add_f32_dpp v166, v166, v166 row_bcast:15 row_mask:0xa bank_mask:0xf
    v_mul_f32 v162, 0x3a800000, v162
    v_mul_f32 v166, 0x3a800000, v166
    v_fma_f32 v166, -v162, v162, v166
    v_cvt_pk_bf16_f32 v161, -v162, -v162
    v_max_f32 v166, 0, v166
    v_cvt_pk_bf16_f32 v166, v166, v166
    v_and_b32 v166, 0xffff0000, v166
    v_add_f32 v166, 0x3727c5ac, v166
    v_cvt_pk_bf16_f32 v166, v166, v166
    v_and_b32 v166, 0xffff0000, v166
    v_sqrt_f32 v166, v166
    v_and_b32 v167, 0xffff0000, v161
    v_cvt_pk_bf16_f32 v248, v162, v166
    v_and_b32 v166, 0xffff0000, v248
    v_rcp_f32 v166, v166
    s_mov_b64 exec, s[64:65]
    ds_write_b16 v202, v161 offset:41568
    ds_write_b32 v203, v166 offset:42752
    s_mov_b64 exec, 1
    ds_add_u32 v0, v255 offset:42820
    s_mov_b64 exec, -1
L_sync2:
    ds_read_b32 v1, v0 offset:42820
    ds_read_b128 v[176:179], v0 offset:42752
    ds_read_b128 v[180:183], v0 offset:42768
    ds_read_b128 v[184:187], v0 offset:42784
    ds_read_b128 v[188:191], v0 offset:42800
    ds_read_b128 v[192:195], v0 offset:41568
    ds_read_b128 v[196:199], v0 offset:41584
    s_add_u32 s92, s92, 1
    s_bitcmp1_b32 s92, 20
    s_cbranch_scc1 L_sync2x
    s_waitcnt lgkmcnt(6)
    v_readfirstlane_b32 s31, v1
    s_nop 0
    s_cmp_ge_u32 s31, 4
    s_cbranch_scc0 L_sync2
L_sync2x:
    ds_read_b64_tr_b16 v[120:121], v206 offset:0
    ds_read_b64_tr_b16 v[122:123], v206 offset:10368
    ds_read_b64_tr_b16 v[124:125], v206 offset:20736
    ds_read_b64_tr_b16 v[126:127], v206 offset:31104
    ds_read_b64_tr_b16 v[128:129], v206 offset:32
    ds_read_b64_tr_b16 v[130:131], v206 offset:10400
    ds_read_b64_tr_b16 v[132:133], v206 offset:20768
    ds_read_b64_tr_b16 v[134:135], v206 offset:31136
    s_waitcnt lgkmcnt(10)
    s_nop 0
    ds_read_b64_tr_b16 v[136:137], v206 offset:64
    ds_read_b64_tr_b16 v[138:139], v206 offset:10432
    ds_read_b64_tr_b16 v[140:141], v206 offset:20800
    ds_read_b64_tr_b16 v[142:143], v206 offset:31168
    v_pk_mul_f32 v[176:177], v[176:177], v[8:9]
    v_pk_mul_f32 v[178:179], v[178:179], v[10:11]
    v_pk_mul_f32 v[180:181], v[180:181], v[12:13]
    v_pk_mul_f32 v[182:183], v[182:183], v[14:15]
    v_pk_mul_f32 v[184:185], v[184:185], v[8:9]
    v_pk_mul_f32 v[186:187], v[186:187], v[10:11]
    v_pk_mul_f32 v[188:189], v[188:189], v[12:13]
    v_pk_mul_f32 v[190:191], v[190:191], v[14:15]
    v_cvt_pk_bf16_f32 v160, v176, v177
    v_cvt_pk_bf16_f32 v152, v184, v185
    v_cvt_pk_bf16_f32 v161, v178, v179
    v_cvt_pk_bf16_f32 v153, v186, v187
    v_cvt_pk_bf16_f32 v162, v180, v181
    v_cvt_pk_bf16_f32 v154, v188, v189
    v_cvt_pk_bf16_f32 v163, v182, v183
    v_cvt_pk_bf16_f32 v155, v190, v191
    v_xor_b32 v164, v208, v160
    v_xor_b32 v156, v208, v152
    v_xor_b32 v165, v208, v161
    v_xor_b32 v157, v208, v153
    v_xor_b32 v166, v208, v162
    v_xor_b32 v158, v208, v154
    v_xor_b32 v167, v208, v163
    v_xor_b32 v159, v208, v155
    s_waitcnt lgkmcnt(12)
    s_cmp_lg_u32 s50, 0
    s_cbranch_scc1 L_st1_split
    v_mfma_f32_16x16x32_bf16 v[168:171], v[160:163], v[192:195], 0
    v_mfma_f32_16x16x32_bf16 v[168:171], v[152:155], v[196:199], v[168:171]
    s_waitcnt lgkmcnt(10)
    ds_read_b64_tr_b16 v[144:145], v206 offset:96
    ds_read_b64_tr_b16 v[146:147], v206 offset:10464
    ds_read_b64_tr_b16 v[148:149], v206 offset:20832
    ds_read_b64_tr_b16 v[150:151], v206 offset:31200
    v_mfma_f32_16x16x32_bf16 v[216:219], v[160:163], v[120:123], v[168:171]
    s_waitcnt lgkmcnt(12)
    v_mfma_f32_16x16x32_bf16 v[216:219], v[152:155], v[124:127], v[216:219]
    s_waitcnt lgkmcnt(10)
    v_mfma_f32_16x16x32_bf16 v[224:227], v[160:163], v[128:131], v[168:171]
    s_waitcnt lgkmcnt(8)
    v_mfma_f32_16x16x32_bf16 v[224:227], v[152:155], v[132:135], v[224:227]
    s_waitcnt lgkmcnt(6)
    v_mfma_f32_16x16x32_bf16 v[232:235], v[160:163], v[136:139], v[168:171]
    s_waitcnt lgkmcnt(4)
    v_mfma_f32_16x16x32_bf16 v[232:235], v[152:155], v[140:143], v[232:235]
    s_waitcnt lgkmcnt(2)
    v_mfma_f32_16x16x32_bf16 v[240:243], v[160:163], v[144:147], v[168:171]
    s_waitcnt lgkmcnt(0)
    v_mfma_f32_16x16x32_bf16 v[240:243], v[152:155], v[148:151], v[240:243]
    v_mfma_f32_16x16x32_bf16 v[220:223], v[164:167], v[120:123], 0
    v_mfma_f32_16x16x32_bf16 v[220:223], v[156:159], v[124:127], v[220:223]
    v_mfma_f32_16x16x32_bf16 v[228:231], v[164:167], v[128:131], 0
    v_mfma_f32_16x16x32_bf16 v[228:231], v[156:159], v[132:135], v[228:231]
    v_cvt_pk_f16_f32 v176, v216, v217
    v_cvt_pk_f16_f32 v177, v224, v225
    v_cvt_pk_f16_f32 v178, v232, v233
    s_nop 0
    v_cvt_pk_f16_f32 v179, v240, v241
    ds_write_b128 v207, v[176:179] offset:44032
    v_mfma_f32_16x16x32_bf16 v[236:239], v[164:167], v[136:139], 0
    v_mfma_f32_16x16x32_bf16 v[236:239], v[156:159], v[140:143], v[236:239]
    v_cvt_pk_f16_f32 v180, v218, v219
    v_cvt_pk_f16_f32 v181, v226, v227
    v_cvt_pk_f16_f32 v182, v234, v235
    v_cvt_pk_f16_f32 v183, v242, v243
    ds_write_b128 v207, v[180:183] offset:45056
    v_mfma_f32_16x16x32_bf16 v[244:247], v[164:167], v[144:147], 0
    v_mfma_f32_16x16x32_bf16 v[244:247], v[156:159], v[148:151], v[244:247]
    v_cvt_pk_f16_f32 v184, v220, v221
    v_cvt_pk_f16_f32 v185, v228, v229
    v_cvt_pk_f16_f32 v186, v236, v237
    s_nop 4
    v_cvt_pk_f16_f32 v187, v244, v245
    ds_write_b128 v207, v[184:187] offset:46080
    v_cvt_pk_f16_f32 v188, v222, v223
    v_cvt_pk_f16_f32 v189, v230, v231
    v_cvt_pk_f16_f32 v190, v238, v239
    v_cvt_pk_f16_f32 v191, v246, v247
    ds_write_b128 v207, v[188:191] offset:47104
    s_branch L_st1_done
L_st1_split:
    s_waitcnt lgkmcnt(8)
    ds_read_b64_tr_b16 v[144:145], v206 offset:96
    ds_read_b64_tr_b16 v[146:147], v206 offset:10464
    ds_read_b64_tr_b16 v[148:149], v206 offset:20832
    ds_read_b64_tr_b16 v[150:151], v206 offset:31200
    s_waitcnt lgkmcnt(0)
    v_mfma_f32_16x16x32_bf16 v[168:171], v[160:163], v[192:195], 0
    v_mfma_f32_16x16x32_bf16 v[220:223], v[164:167], v[120:123], 0
    v_mfma_f32_16x16x32_bf16 v[216:219], v[160:163], v[120:123], v[168:171]
    v_mfma_f32_16x16x32_bf16 v[228:231], v[164:167], v[128:131], 0
    v_mfma_f32_16x16x32_bf16 v[224:227], v[160:163], v[128:131], v[168:171]
    v_mfma_f32_16x16x32_bf16 v[236:239], v[164:167], v[136:139], 0
    v_mfma_f32_16x16x32_bf16 v[232:235], v[160:163], v[136:139], v[168:171]
    v_mfma_f32_16x16x32_bf16 v[244:247], v[164:167], v[144:147], 0
    v_mfma_f32_16x16x32_bf16 v[240:243], v[160:163], v[144:147], v[168:171]
    s_nop 1
    s_nop 0
    v_cvt_pk_f16_f32 v176, v216, v217
    v_cvt_pk_f16_f32 v180, v218, v219
    v_cvt_pk_f16_f32 v184, v220, v221
    v_cvt_pk_f16_f32 v188, v222, v223
    v_cvt_pk_f16_f32 v177, v224, v225
    v_cvt_pk_f16_f32 v181, v226, v227
    v_cvt_pk_f16_f32 v185, v228, v229
    v_cvt_pk_f16_f32 v189, v230, v231
    v_cvt_pk_f16_f32 v178, v232, v233
    v_cvt_pk_f16_f32 v182, v234, v235
    v_cvt_pk_f16_f32 v186, v236, v237
    v_cvt_pk_f16_f32 v190, v238, v239
    v_cvt_pk_f16_f32 v179, v240, v241
    v_cvt_pk_f16_f32 v183, v242, v243
    v_cvt_pk_f16_f32 v187, v244, v245
    v_cvt_pk_f16_f32 v191, v246, v247
    ds_write_b128 v207, v[176:179] offset:44032
    ds_write_b128 v207, v[180:183] offset:45056
    ds_write_b128 v207, v[184:187] offset:46080
    ds_write_b128 v207, v[188:191] offset:47104
    v_mfma_f32_16x16x32_bf16 v[168:171], v[152:155], v[196:199], 0
    v_mfma_f32_16x16x32_bf16 v[220:223], v[156:159], v[124:127], 0
    v_mfma_f32_16x16x32_bf16 v[216:219], v[152:155], v[124:127], v[168:171]
    v_mfma_f32_16x16x32_bf16 v[228:231], v[156:159], v[132:135], 0
    v_mfma_f32_16x16x32_bf16 v[224:227], v[152:155], v[132:135], v[168:171]
    v_mfma_f32_16x16x32_bf16 v[236:239], v[156:159], v[140:143], 0
    v_mfma_f32_16x16x32_bf16 v[232:235], v[152:155], v[140:143], v[168:171]
    v_mfma_f32_16x16x32_bf16 v[244:247], v[156:159], v[148:151], 0
    v_mfma_f32_16x16x32_bf16 v[240:243], v[152:155], v[148:151], v[168:171]
    s_waitcnt lgkmcnt(0)
    s_nop 0
    v_cvt_pk_f16_f32 v176, v216, v217
    v_cvt_pk_f16_f32 v180, v218, v219
    v_cvt_pk_f16_f32 v184, v220, v221
    v_cvt_pk_f16_f32 v188, v222, v223
    v_cvt_pk_f16_f32 v177, v224, v225
    v_cvt_pk_f16_f32 v181, v226, v227
    v_cvt_pk_f16_f32 v185, v228, v229
    v_cvt_pk_f16_f32 v189, v230, v231
    v_cvt_pk_f16_f32 v178, v232, v233
    v_cvt_pk_f16_f32 v182, v234, v235
    v_cvt_pk_f16_f32 v186, v236, v237
    v_cvt_pk_f16_f32 v190, v238, v239
    v_cvt_pk_f16_f32 v179, v240, v241
    v_cvt_pk_f16_f32 v183, v242, v243
    v_cvt_pk_f16_f32 v187, v244, v245
    v_cvt_pk_f16_f32 v191, v246, v247
    ds_write_b128 v207, v[176:179] offset:60416
    ds_write_b128 v207, v[180:183] offset:61440
    ds_write_b128 v207, v[184:187] offset:62464
    ds_write_b128 v207, v[188:191] offset:63488
L_st1_done:
    s_mov_b64 exec, 1
    ds_add_u32 v0, v255 offset:42824
    s_mov_b64 exec, -1
    s_lshl_b32 s31, s30, 12
    v_add_u32 v5, s31, v3
    s_and_b32 s31, s28, 0x30003
    v_mov_b32 v210, s31
    s_mov_b32 s58, 0xfffcfffc
    s_and_b32 s32, s48, 3
    s_cselect_b32 s72, -1, 0xff
    s_cselect_b32 s73, -1, 0
    s_mov_b32 s74, s48
    s_mov_b64 s[60:61], 0
    s_mov_b64 s[62:63], 0
    v_mov_b32 v209, 2147483392
    s_cmp_eq_u32 s48, 7
    s_cbranch_scc1 L_no_consts
    v_mul_f32 v250, v212, v251
    v_fmamk_f32 v76, v250, 0x3d800000, v252
    v_sin_f32 v44, v250
    v_cos_f32 v250, v250
    v_cos_f32 v72, v76
    v_sin_f32 v76, v76
    v_cvt_pk_f16_f32 v40, v250, v44
    v_cvt_pk_f16_f32 v44, -v44, v250
    v_mul_f32 v250, v213, v251
    v_fmamk_f32 v77, v250, 0x3d800000, v252
    v_sin_f32 v45, v250
    v_cos_f32 v250, v250
    v_cos_f32 v73, v77
    v_sin_f32 v77, v77
    v_cvt_pk_f16_f32 v41, v250, v45
    v_cvt_pk_f16_f32 v45, -v45, v250
    v_mul_f32 v250, v214, v251
    v_fmamk_f32 v78, v250, 0x3d800000, v252
    v_sin_f32 v46, v250
    v_cos_f32 v250, v250
    v_cos_f32 v74, v78
    v_sin_f32 v78, v78
    v_cvt_pk_f16_f32 v42, v250, v46
    v_cvt_pk_f16_f32 v46, -v46, v250
    v_mul_f32 v250, v215, v251
    v_fmamk_f32 v79, v250, 0x3d800000, v252
    v_sin_f32 v47, v250
    v_cos_f32 v250, v250
    v_cos_f32 v75, v79
    v_sin_f32 v79, v79
    v_cvt_pk_f16_f32 v43, v250, v47
    v_cvt_pk_f16_f32 v47, -v47, v250
    s_and_b32 s31, s46, 1
    s_lshl_b32 s31, s31, 6
    s_lshr_b32 s32, s46, 1
    s_add_u32 s49, s31, s32
    s_bitcmp1_b32 s49, 2
    s_cselect_b64 vcc, -1, 0
    v_cndmask_b32 v80, v16, v20, vcc
    v_cndmask_b32 v84, v20, v16, vcc
    v_cndmask_b32 v81, v17, v21, vcc
    v_cndmask_b32 v85, v21, v17, vcc
    v_cndmask_b32 v82, v18, v22, vcc
    v_cndmask_b32 v86, v22, v18, vcc
    v_cndmask_b32 v83, v19, v23, vcc
    v_cndmask_b32 v87, v23, v19, vcc
    s_bfe_u32 s31, s49, 0x10001
    v_and_b32 v6, 7, v2
    v_xor_b32 v6, s31, v6
    v_lshlrev_b32 v6, 4, v6
    v_lshrrev_b32 v7, 4, v2
    v_lshlrev_b32 v7, 3, v7
    v_bfe_u32 v209, v2, 3, 1
    v_add_u32 v7, v7, v209
    v_mul_u32_u24 v7, 16512, v7
    v_add_u32 v209, v6, v7
    s_mul_i32 s31, s48, 528384
    s_lshl_b32 s32, s49, 7
    s_add_u32 s31, s31, s32
    s_add_u32 s60, s31, 2097152
L_no_consts:
L_st23:
L_sync3:
    ds_read_b32 v1, v0 offset:42824
    ds_read_b128 v[120:123], v5 offset:44032
    ds_read_b128 v[124:127], v5 offset:45056
    ds_read_b128 v[128:131], v5 offset:46080
    ds_read_b128 v[132:135], v5 offset:47104
    s_add_u32 s92, s92, 1
    s_bitcmp1_b32 s92, 20
    s_cbranch_scc1 L_sync3x
    s_waitcnt lgkmcnt(4)
    v_readfirstlane_b32 s31, v1
    s_nop 0
    s_cmp_ge_u32 s31, 4
    s_cbranch_scc0 L_sync3
L_sync3x:
    s_cmp_eq_u32 s48, 7
    s_cbranch_scc1 L_p1_done
    s_add_u32 s61, s60, 33024
    s_add_u32 s62, s61, 33024
    s_add_u32 s63, s62, 33024
    s_waitcnt lgkmcnt(3)
    v_mfma_f32_16x16x32_f16 v[136:139], v[120:123], v[16:19], 0
    v_mfma_f32_16x16x32_f16 v[140:143], v[120:123], v[20:23], 0
    s_waitcnt lgkmcnt(2)
    v_mfma_f32_16x16x32_f16 v[144:147], v[124:127], v[24:27], 0
    v_mfma_f32_16x16x32_f16 v[148:151], v[124:127], v[28:31], 0
    s_nop 3
    v_pk_mul_f32 v[152:153], v[48:49], v[136:137]
    v_pk_mul_f32 v[154:155], v[50:51], v[138:139]
    v_pk_mul_f32 v[156:157], v[52:53], v[136:137]
    v_pk_mul_f32 v[158:159], v[54:55], v[138:139]
    v_pk_fma_f32 v[152:153], v[52:53], v[140:141], v[152:153]
    v_pk_fma_f32 v[156:157], v[48:49], v[140:141], v[156:157] neg_lo:[0,0,1] neg_hi:[0,0,1]
    v_pk_fma_f32 v[154:155], v[54:55], v[142:143], v[154:155]
    v_pk_fma_f32 v[158:159], v[50:51], v[142:143], v[158:159] neg_lo:[0,0,1] neg_hi:[0,0,1]
    v_cvt_pk_f16_f32 v120, v152, v156
    v_cvt_pk_f16_f32 v121, v153, v157
    v_cvt_pk_f16_f32 v122, v154, v158
    v_cvt_pk_f16_f32 v123, v155, v159
    s_waitcnt lgkmcnt(1)
    s_nop 0
    v_mfma_f32_16x16x32_f16 v[136:139], v[128:131], v[32:35], 0
    v_mfma_f32_16x16x32_f16 v[140:143], v[128:131], v[36:39], 0
    v_mfma_f32_16x16x32_f16 v[216:219], v[80:83], v[120:123], 0
    v_mfma_f32_16x16x32_f16 v[220:223], v[84:87], v[120:123], 0
    v_pk_mul_f32 v[152:153], v[56:57], v[144:145]
    v_pk_mul_f32 v[154:155], v[58:59], v[146:147]
    v_pk_mul_f32 v[156:157], v[60:61], v[144:145]
    v_pk_mul_f32 v[158:159], v[62:63], v[146:147]
    v_pk_fma_f32 v[152:153], v[60:61], v[148:149], v[152:153]
    v_pk_fma_f32 v[156:157], v[56:57], v[148:149], v[156:157] neg_lo:[0,0,1] neg_hi:[0,0,1]
    v_pk_fma_f32 v[154:155], v[62:63], v[150:151], v[154:155]
    v_pk_fma_f32 v[158:159], v[58:59], v[150:151], v[158:159] neg_lo:[0,0,1] neg_hi:[0,0,1]
    v_cvt_pk_f16_f32 v124, v152, v156
    v_cvt_pk_f16_f32 v125, v153, v157
    v_cvt_pk_f16_f32 v126, v154, v158
    v_cvt_pk_f16_f32 v127, v155, v159
    s_waitcnt lgkmcnt(0)
    s_nop 0
    v_mfma_f32_16x16x32_f16 v[144:147], v[132:135], v[40:43], 0
    v_mfma_f32_16x16x32_f16 v[148:151], v[132:135], v[44:47], 0
    v_mfma_f32_16x16x32_f16 v[224:227], v[80:83], v[124:127], 0
    v_mfma_f32_16x16x32_f16 v[228:231], v[84:87], v[124:127], 0
    v_pk_mul_f32 v[152:153], v[64:65], v[136:137]
    v_pk_mul_f32 v[154:155], v[66:67], v[138:139]
    v_pk_mul_f32 v[156:157], v[68:69], v[136:137]
    v_pk_mul_f32 v[158:159], v[70:71], v[138:139]
    v_pk_fma_f32 v[152:153], v[68:69], v[140:141], v[152:153]
    v_pk_fma_f32 v[156:157], v[64:65], v[140:141], v[156:157] neg_lo:[0,0,1] neg_hi:[0,0,1]
    v_pk_fma_f32 v[154:155], v[70:71], v[142:143], v[154:155]
    v_pk_fma_f32 v[158:159], v[66:67], v[142:143], v[158:159] neg_lo:[0,0,1] neg_hi:[0,0,1]
    v_cvt_pk_f16_f32 v128, v152, v156
    v_cvt_pk_f16_f32 v129, v153, v157
    v_cvt_pk_f16_f32 v130, v154, v158
    v_cvt_pk_f16_f32 v131, v155, v159
    s_nop 1
    s_nop 0
    v_mfma_f32_16x16x32_f16 v[232:235], v[80:83], v[128:131], 0
    v_mfma_f32_16x16x32_f16 v[236:239], v[84:87], v[128:131], 0
    v_pk_mul_f32 v[152:153], v[72:73], v[144:145]
    v_pk_mul_f32 v[154:155], v[74:75], v[146:147]
    v_pk_mul_f32 v[156:157], v[76:77], v[144:145]
    v_pk_mul_f32 v[158:159], v[78:79], v[146:147]
    v_pk_fma_f32 v[152:153], v[76:77], v[148:149], v[152:153]
    v_pk_fma_f32 v[156:157], v[72:73], v[148:149], v[156:157] neg_lo:[0,0,1] neg_hi:[0,0,1]
    v_pk_fma_f32 v[154:155], v[78:79], v[150:151], v[154:155]
    v_pk_fma_f32 v[158:159], v[74:75], v[150:151], v[158:159] neg_lo:[0,0,1] neg_hi:[0,0,1]
    v_cvt_pk_f16_f32 v132, v152, v156
    v_cvt_pk_f16_f32 v133, v153, v157
    v_cvt_pk_f16_f32 v134, v154, v158
    v_cvt_pk_f16_f32 v135, v155, v159
    s_nop 1
    s_nop 0
    v_mfma_f32_16x16x32_f16 v[240:243], v[80:83], v[132:135], 0
    v_mfma_f32_16x16x32_f16 v[244:247], v[84:87], v[132:135], 0
    v_cvt_pk_f16_f32 v176, v216, v224
    v_cvt_pk_f16_f32 v178, v220, v228
    v_and_or_b32 v176, v176, s58, v210
    v_and_or_b32 v178, v178, s58, v210
    v_cvt_pk_f16_f32 v180, v217, v225
    v_cvt_pk_f16_f32 v182, v221, v229
    v_and_or_b32 v180, v180, s58, v210
    v_and_or_b32 v182, v182, s58, v210
    v_cvt_pk_f16_f32 v184, v218, v226
    v_cvt_pk_f16_f32 v186, v222, v230
    v_and_or_b32 v184, v184, s58, v210
    v_and_or_b32 v186, v186, s58, v210
    v_cvt_pk_f16_f32 v188, v219, v227
    v_cvt_pk_f16_f32 v190, v223, v231
    v_and_or_b32 v188, v188, s58, v210
    v_and_or_b32 v190, v190, s58, v210
    v_cvt_pk_f16_f32 v177, v232, v240
    v_cvt_pk_f16_f32 v179, v236, v244
    v_and_or_b32 v177, v177, s58, v210
    v_and_or_b32 v179, v179, s58, v210
    v_cvt_pk_f16_f32 v181, v233, v241
    v_cvt_pk_f16_f32 v183, v237, v245
    v_and_or_b32 v181, v181, s58, v210
    v_and_or_b32 v183, v183, s58, v210
    v_cvt_pk_f16_f32 v185, v234, v242
    v_cvt_pk_f16_f32 v187, v238, v246
    v_and_or_b32 v185, v185, s58, v210
    v_and_or_b32 v187, v187, s58, v210
    v_cvt_pk_f16_f32 v189, v235, v243
    v_cvt_pk_f16_f32 v191, v239, v247
    v_and_or_b32 v189, v189, s58, v210
    v_and_or_b32 v191, v191, s58, v210
    s_cmp_eq_u32 s50, 0
    s_cbranch_scc1 L_p1_done
    s_mov_b32 exec_hi, s72
    buffer_store_dwordx4 v[176:179], v209, s[12:15], s60 offen sc1
    s_mov_b32 exec_hi, s73
    buffer_store_dwordx4 v[180:183], v209, s[12:15], s61 offen sc1
    buffer_store_dwordx4 v[184:187], v209, s[12:15], s62 offen sc1
    buffer_store_dwordx4 v[188:191], v209, s[12:15], s63 offen sc1
    s_mov_b32 exec_hi, -1
    s_mov_b32 s50, 0
    s_add_u32 s60, s60, 16384
    v_add_u32 v5, 16384, v5
    s_sub_u32 s31, s48, 4
    v_cvt_f32_i32 v252, s31
    v_mul_f32 v252, 0x3d800000, v252
    v_and_b32 v251, 15, v2
    v_lshlrev_b32 v251, 2, v251
    v_cvt_f32_u32 v251, v251
    v_fma_f32 v250, v212, v251, v252
    v_sin_f32 v84, v250
    v_cos_f32 v250, v250
    s_nop 0
    v_cvt_pk_f16_f32 v80, v250, v84
    v_cvt_pk_f16_f32 v84, -v84, v250
    v_fma_f32 v250, v213, v251, v252
    v_sin_f32 v85, v250
    v_cos_f32 v250, v250
    s_nop 0
    v_cvt_pk_f16_f32 v81, v250, v85
    v_cvt_pk_f16_f32 v85, -v85, v250
    v_fma_f32 v250, v214, v251, v252
    v_sin_f32 v86, v250
    v_cos_f32 v250, v250
    s_nop 0
    v_cvt_pk_f16_f32 v82, v250, v86
    v_cvt_pk_f16_f32 v86, -v86, v250
    v_fma_f32 v250, v215, v251, v252
    v_sin_f32 v87, v250
    v_cos_f32 v250, v250
    s_nop 0
    v_cvt_pk_f16_f32 v83, v250, v87
    v_cvt_pk_f16_f32 v87, -v87, v250
    s_branch L_st23
L_p1_done:
    s_mov_b64 exec, 1
    ds_add_u32 v0, v255 offset:42828
    s_mov_b64 exec, -1
    s_setprio 0
    v_mov_b32 v4, v112
    v_mov_b32 v5, v113
    v_mov_b32 v249, v114
    v_mov_b32 v205, v115
    v_mov_b32 v248, v116
    v_mov_b32 v208, v117
    v_mov_b32 v7, v118
    v_mov_b32 v6, v119
    s_and_b32 s31, s2, 7
    s_sub_u32 s32, 8, s31
    s_min_u32 s46, s31, s32
    s_lshr_b32 s53, s31, 2
    s_lshr_b32 s47, s2, 3
    s_and_b32 s32, s47, 1
    s_and_b32 s31, s31, 3
    s_cselect_b32 s53, s53, s32
    s_cselect_b32 s31, 0, 1
    s_lshr_b32 s47, s47, s31
    s_lshl_b32 s53, s53, 4
    s_lshl_b32 s31, s30, 5
    s_add_u32 s53, s53, s31
    s_lshl_b32 s48, s46, 1
    s_add_u32 s48, s48, 2040
    s_mov_b32 s49, 32768
    v_mov_b32 v212, v210
    v_mov_b32 v213, v210
    v_mov_b32 v214, v210
    v_mov_b32 v215, v210
    s_cmp_ge_u32 s2, 224
    s_cbranch_scc1 L_zst_go
L_sync4:
    ds_read_b32 v1, v0 offset:42840
    s_add_u32 s92, s92, 1
    s_bitcmp1_b32 s92, 20
    s_cbranch_scc1 L_sync4x
    s_waitcnt lgkmcnt(0)
    v_readfirstlane_b32 s31, v1
    s_nop 0
    s_cmp_ge_u32 s31, 1
    s_cbranch_scc0 L_sync4
L_sync4x:
L_zst_go:
    s_mov_b32 exec_hi, s72
    buffer_store_dwordx4 v[176:179], v209, s[12:15], s60 offen sc1
    s_mov_b32 exec_hi, s73
    buffer_store_dwordx4 v[180:183], v209, s[12:15], s61 offen sc1
    buffer_store_dwordx4 v[184:187], v209, s[12:15], s62 offen sc1
    buffer_store_dwordx4 v[188:191], v209, s[12:15], s63 offen sc1
    s_mov_b32 exec_hi, -1
L_sync5:
    ds_read_b32 v1, v0 offset:42860
    s_add_u32 s92, s92, 1
    s_bitcmp1_b32 s92, 20
    s_cbranch_scc1 L_sync5x
    s_waitcnt lgkmcnt(0)
    v_readfirstlane_b32 s31, v1
    s_nop 0
    s_cmp_ge_u32 s31, 1
    s_cbranch_scc0 L_sync5
L_sync5x:
    buffer_load_dwordx4 v[24:27], v6, s[12:15], s49 offen
    s_add_u32 m0, s76, 0
    s_nop 0
    buffer_load_dwordx4 v4, s[8:11], 0 offen lds
    s_add_u32 m0, s76, 1024
    s_nop 0
    buffer_load_dwordx4 v5, s[8:11], 0 offen lds
    v_and_b32 v160, 15, v2
    v_add_u32 v160, s53, v160
    v_cvt_f32_u32 v160, v160
    v_add_f32 v160, 0.5, v160
    v_mul_f32 v160, 0x3b800000, v160
    v_and_b32 v161, 32, v2
    v_bfe_u32 v162, v2, 4, 1
    v_lshl_add_u32 v161, v162, 3, v161
    v_cvt_f32_u32 v161, v161
    v_mul_f32 v161, v161, v160
    v_fmamk_f32 v88, v160, 0x0, v161
    v_fmamk_f32 v162, v160, 0x40000000, v161
    v_sin_f32 v104, v88
    v_sin_f32 v163, v162
    v_cos_f32 v88, v88
    v_cos_f32 v162, v162
    v_cvt_pk_f16_f32 v104, v104, v163
    v_cvt_pk_f16_f32 v88, v88, v162
    v_fmamk_f32 v89, v160, 0x40800000, v161
    v_fmamk_f32 v162, v160, 0x40c00000, v161
    v_sin_f32 v105, v89
    v_sin_f32 v163, v162
    v_cos_f32 v89, v89
    v_cos_f32 v162, v162
    v_cvt_pk_f16_f32 v105, v105, v163
    v_cvt_pk_f16_f32 v89, v89, v162
    v_fmamk_f32 v90, v160, 0x41800000, v161
    v_fmamk_f32 v162, v160, 0x41900000, v161
    v_sin_f32 v106, v90
    v_sin_f32 v163, v162
    v_cos_f32 v90, v90
    v_cos_f32 v162, v162
    v_cvt_pk_f16_f32 v106, v106, v163
    v_cvt_pk_f16_f32 v90, v90, v162
    v_fmamk_f32 v91, v160, 0x41a00000, v161
    v_fmamk_f32 v162, v160, 0x41b00000, v161
    v_sin_f32 v107, v91
    v_sin_f32 v163, v162
    v_cos_f32 v91, v91
    v_cos_f32 v162, v162
    v_cvt_pk_f16_f32 v107, v107, v163
    v_cvt_pk_f16_f32 v91, v91, v162
    v_fmamk_f32 v92, v160, 0x42800000, v161
    v_fmamk_f32 v162, v160, 0x42840000, v161
    v_sin_f32 v108, v92
    v_sin_f32 v163, v162
    v_cos_f32 v92, v92
    v_cos_f32 v162, v162
    v_cvt_pk_f16_f32 v108, v108, v163
    v_cvt_pk_f16_f32 v92, v92, v162
    v_fmamk_f32 v93, v160, 0x42880000, v161
    v_fmamk_f32 v162, v160, 0x428c0000, v161
    v_sin_f32 v109, v93
    v_sin_f32 v163, v162
    v_cos_f32 v93, v93
    v_cos_f32 v162, v162
    v_cvt_pk_f16_f32 v109, v109, v163
    v_cvt_pk_f16_f32 v93, v93, v162
    v_fmamk_f32 v94, v160, 0x42a00000, v161
    v_fmamk_f32 v162, v160, 0x42a40000, v161
    v_sin_f32 v110, v94
    v_sin_f32 v163, v162
    v_cos_f32 v94, v94
    v_cos_f32 v162, v162
    v_cvt_pk_f16_f32 v110, v110, v163
    v_cvt_pk_f16_f32 v94, v94, v162
    v_fmamk_f32 v95, v160, 0x42a80000, v161
    v_fmamk_f32 v162, v160, 0x42ac0000, v161
    v_sin_f32 v111, v95
    v_sin_f32 v163, v162
    v_cos_f32 v95, v95
    v_cos_f32 v162, v162
    v_cvt_pk_f16_f32 v111, v111, v163
    v_cvt_pk_f16_f32 v95, v95, v162
    v_fmamk_f32 v96, v160, 0x3f800000, v161
    v_fmamk_f32 v162, v160, 0x40400000, v161
    v_sin_f32 v112, v96
    v_sin_f32 v163, v162
    v_cos_f32 v96, v96
    v_cos_f32 v162, v162
    v_cvt_pk_f16_f32 v112, v112, v163
    v_cvt_pk_f16_f32 v96, v96, v162
    v_fmamk_f32 v97, v160, 0x40a00000, v161
    v_fmamk_f32 v162, v160, 0x40e00000, v161
    v_sin_f32 v113, v97
    v_sin_f32 v163, v162
    v_cos_f32 v97, v97
    v_cos_f32 v162, v162
    v_cvt_pk_f16_f32 v113, v113, v163
    v_cvt_pk_f16_f32 v97, v97, v162
    v_fmamk_f32 v98, v160, 0x41880000, v161
    v_fmamk_f32 v162, v160, 0x41980000, v161
    v_sin_f32 v114, v98
    v_sin_f32 v163, v162
    v_cos_f32 v98, v98
    v_cos_f32 v162, v162
    v_cvt_pk_f16_f32 v114, v114, v163
    v_cvt_pk_f16_f32 v98, v98, v162
    v_fmamk_f32 v99, v160, 0x41a80000, v161
    v_fmamk_f32 v162, v160, 0x41b80000, v161
    v_sin_f32 v115, v99
    v_sin_f32 v163, v162
    v_cos_f32 v99, v99
    v_cos_f32 v162, v162
    v_cvt_pk_f16_f32 v115, v115, v163
    v_cvt_pk_f16_f32 v99, v99, v162
    v_fmamk_f32 v100, v160, 0x42820000, v161
    v_fmamk_f32 v162, v160, 0x42860000, v161
    v_sin_f32 v116, v100
    v_sin_f32 v163, v162
    v_cos_f32 v100, v100
    v_cos_f32 v162, v162
    v_cvt_pk_f16_f32 v116, v116, v163
    v_cvt_pk_f16_f32 v100, v100, v162
    v_fmamk_f32 v101, v160, 0x428a0000, v161
    v_fmamk_f32 v162, v160, 0x428e0000, v161
    v_sin_f32 v117, v101
    v_sin_f32 v163, v162
    v_cos_f32 v101, v101
    v_cos_f32 v162, v162
    v_cvt_pk_f16_f32 v117, v117, v163
    v_cvt_pk_f16_f32 v101, v101, v162
    v_fmamk_f32 v102, v160, 0x42a20000, v161
    v_fmamk_f32 v162, v160, 0x42a60000, v161
    v_sin_f32 v118, v102
    v_sin_f32 v163, v162
    v_cos_f32 v102, v102
    v_cos_f32 v162, v162
    v_cvt_pk_f16_f32 v118, v118, v163
    v_cvt_pk_f16_f32 v102, v102, v162
    v_fmamk_f32 v103, v160, 0x42aa0000, v161
    v_fmamk_f32 v162, v160, 0x42ae0000, v161
    v_sin_f32 v119, v103
    v_sin_f32 v163, v162
    v_cos_f32 v103, v103
    v_cos_f32 v162, v162
    v_cvt_pk_f16_f32 v119, v119, v163
    v_cvt_pk_f16_f32 v103, v103, v162
    v_cmp_gt_u32 vcc, 16, v2
    v_and_b32 v162, 1, v2
    v_lshlrev_b32 v162, 15, v162
    v_or_b32 v162, 0x3c00, v162
    v_and_b32 v160, 0xffff0000, v104
    v_or_b32 v162, v162, v160
    v_cndmask_b32 v104, v104, v162, vcc
    s_mul_i32 s51, s46, 528384
    s_add_u32 s51, s51, 2097152
    s_mul_i32 s54, s47, 16512
    s_lshl_b32 s32, s30, 12
    s_add_u32 s50, s51, s54
    s_add_u32 s50, s50, s32
    s_add_u32 s55, s47, 1
    s_and_b32 s55, s55, 31
    s_mul_i32 s55, s55, 16512
    v_add_u32 v250, s32, v3
    v_add_u32 v199, s76, v3
    v_lshl_add_u32 v200, v2, 7, s32
    v_and_b32 v1, 2, v2
    v_lshl_add_u32 v200, v1, 3, v200
    v_and_b32 v1, 0x70, v3
    v_add_u32 v1, 16384, v1
    s_mov_b32 vcc_lo, 0
    s_mov_b32 vcc_hi, -1
    v_cndmask_b32 v200, v200, v1, vcc
    s_mov_b32 vcc_hi, 0xff
    v_mov_b32 v1, s55
    v_mov_b32 v201, s54
    v_cndmask_b32 v1, v1, v201, vcc
    v_mov_b32 v201, 16640
    v_cndmask_b32 v201, v201, v0, vcc
    v_add_u32 v201, v201, v200
    v_add_u32 v200, v1, v200
    v_lshrrev_b32 v251, 5, v2
    v_lshlrev_b32 v251, 11, v251
    v_bfe_u32 v1, v2, 2, 3
    v_lshl_add_u32 v251, v1, 7, v251
    v_and_b32 v1, 3, v2
    v_lshl_add_u32 v251, v1, 5, v251
    v_bfe_u32 v1, v2, 3, 1
    v_lshl_add_u32 v251, v1, 4, v251
    v_bfe_u32 v1, v2, 4, 1
    v_lshl_add_u32 v251, v1, 3, v251
    v_xor_b32 v252, 16, v251
    v_xor_b32 v253, 8, v251
    v_xor_b32 v254, 24, v251
    v_cmp_gt_u32 vcc, 4, v2
    v_mov_b32 v1, 16384
    s_nop 0
    v_cndmask_b32 v1, v0, v1, vcc
    v_add_u32 v206, v253, v1
    v_add_u32 v207, v254, v1
    s_mov_b32 vcc_lo, 0x88888888
    s_mov_b32 vcc_hi, 0x88888888
    v_mov_b32 v1, 16544
    v_cndmask_b32 v1, 32, v1, vcc
    v_add_u32 v202, v251, v1
    v_add_u32 v203, v253, v1
    v_add_u32 v204, v206, v1
    s_waitcnt vmcnt(0)
L_stat_check:
    v_cmp_ne_u64 vcc, s[28:29], v[26:27]
    s_nop 0
    s_cbranch_vccz L_stat_got
    s_cmp_eq_u32 s35, 0
    s_cbranch_scc1 L_stat_got
    s_sub_u32 s35, s35, 1
    s_sleep 2
    s_mov_b64 exec, vcc
    buffer_load_dwordx4 v[24:27], v6, s[12:15], s49 offen sc1
    s_mov_b64 exec, -1
    s_waitcnt vmcnt(0)
    s_branch L_stat_check
L_stat_got:
    v_cndmask_b32 v24, v24, v25, s[88:89]
    v_mov_b32 v32, v24
    s_nop 1
    v_permlane32_swap_b32 v24, v32
    v_mov_b32 v28, v24
    v_mov_b32 v36, v32
    s_nop 0
    v_permlane16_swap_b32 v24, v28
    v_permlane16_swap_b32 v32, v36
    v_lshlrev_b32 v26, 16, v24
    v_and_b32 v24, 0xffff0000, v24
    v_rcp_f32 v24, v24
    v_lshlrev_b32 v30, 16, v28
    v_and_b32 v28, 0xffff0000, v28
    v_rcp_f32 v28, v28
    v_lshlrev_b32 v34, 16, v32
    v_and_b32 v32, 0xffff0000, v32
    v_rcp_f32 v32, v32
    v_lshlrev_b32 v38, 16, v36
    v_and_b32 v36, 0xffff0000, v36
    v_rcp_f32 v36, v36
    v_mul_f32 v24, 0xbfb8aa3b, v24
    v_mul_f32_e64 v26, -v26, v24
    v_mul_f32 v28, 0xbfb8aa3b, v28
    v_mul_f32_e64 v30, -v30, v28
    v_mul_f32 v32, 0xbfb8aa3b, v32
    v_mul_f32_e64 v34, -v34, v32
    v_mul_f32 v36, 0xbfb8aa3b, v36
    v_mul_f32_e64 v38, -v38, v36
    ds_read_b128 v[8:11], v208 offset:0
    ds_read_b128 v[12:15], v208 offset:1024
    s_waitcnt lgkmcnt(0)
    v_lshlrev_b32 v40, 16, v8
    v_and_b32 v41, 0xffff0000, v8
    v_lshlrev_b32 v42, 16, v9
    v_and_b32 v43, 0xffff0000, v9
    v_lshlrev_b32 v44, 16, v10
    v_and_b32 v45, 0xffff0000, v10
    v_lshlrev_b32 v46, 16, v11
    v_and_b32 v47, 0xffff0000, v11
    v_lshlrev_b32 v48, 16, v12
    v_and_b32 v55, 0xffff0000, v12
    v_lshlrev_b32 v54, 16, v13
    v_and_b32 v53, 0xffff0000, v13
    v_lshlrev_b32 v52, 16, v14
    v_and_b32 v51, 0xffff0000, v14
    v_lshlrev_b32_e64 v50, 16, v15
    v_and_b32 v49, 0xffff0000, v15
    v_pk_fma_f32 v[120:121], v[40:41], v[24:25], v[26:27] op_sel_hi:[1,0,0]
    v_pk_fma_f32 v[122:123], v[42:43], v[24:25], v[26:27] op_sel_hi:[1,0,0]
    v_pk_fma_f32 v[124:125], v[44:45], v[24:25], v[26:27] op_sel_hi:[1,0,0]
    v_pk_fma_f32 v[126:127], v[46:47], v[24:25], v[26:27] op_sel_hi:[1,0,0]
    v_pk_fma_f32 v[128:129], v[48:49], v[28:29], v[30:31] op_sel_hi:[1,0,0]
    v_pk_fma_f32 v[130:131], v[50:51], v[28:29], v[30:31] op_sel_hi:[1,0,0]
    v_pk_fma_f32 v[132:133], v[52:53], v[28:29], v[30:31] op_sel_hi:[1,0,0]
    v_pk_fma_f32 v[134:135], v[54:55], v[28:29], v[30:31] op_sel_hi:[1,0,0]
    v_exp_f32 v216, v120
    v_exp_f32 v217, v121
    v_exp_f32 v218, v122
    v_exp_f32 v219, v123
    v_exp_f32 v220, v124
    v_exp_f32 v221, v125
    v_exp_f32 v222, v126
    v_exp_f32 v223, v127
    v_exp_f32 v224, v128
    v_exp_f32 v225, v129
    v_exp_f32 v226, v130
    v_exp_f32 v227, v131
    v_exp_f32 v228, v132
    v_exp_f32 v229, v133
    v_exp_f32 v230, v134
    v_exp_f32 v231, v135
    v_pk_add_f32 v[216:217], v[216:217], 1.0 op_sel_hi:[1,0]
    v_pk_add_f32 v[218:219], v[218:219], 1.0 op_sel_hi:[1,0]
    v_pk_add_f32 v[220:221], v[220:221], 1.0 op_sel_hi:[1,0]
    v_pk_add_f32 v[222:223], v[222:223], 1.0 op_sel_hi:[1,0]
    v_pk_add_f32 v[224:225], v[224:225], 1.0 op_sel_hi:[1,0]
    v_pk_add_f32 v[226:227], v[226:227], 1.0 op_sel_hi:[1,0]
    v_pk_add_f32 v[228:229], v[228:229], 1.0 op_sel_hi:[1,0]
    v_pk_add_f32 v[230:231], v[230:231], 1.0 op_sel_hi:[1,0]
    v_rcp_f32 v216, v216
    v_rcp_f32 v217, v217
    v_rcp_f32 v218, v218
    v_rcp_f32 v219, v219
    v_rcp_f32 v220, v220
    v_rcp_f32 v221, v221
    v_rcp_f32 v222, v222
    v_rcp_f32 v223, v223
    v_rcp_f32 v224, v224
    v_rcp_f32 v225, v225
    v_rcp_f32 v226, v226
    v_rcp_f32 v227, v227
    v_rcp_f32 v228, v228
    v_rcp_f32 v229, v229
    v_rcp_f32 v230, v230
    v_rcp_f32 v231, v231
    v_pk_mul_f32 v[120:121], v[120:121], v[216:217]
    v_pk_mul_f32 v[122:123], v[122:123], v[218:219]
    v_pk_mul_f32 v[124:125], v[124:125], v[220:221]
    v_pk_mul_f32 v[126:127], v[126:127], v[222:223]
    v_pk_mul_f32 v[128:129], v[128:129], v[224:225]
    v_pk_mul_f32 v[130:131], v[130:131], v[226:227]
    v_pk_mul_f32 v[132:133], v[132:133], v[228:229]
    v_pk_mul_f32 v[134:135], v[134:135], v[230:231]
L_sync6:
    ds_read_b32 v1, v0 offset:42848
    s_add_u32 s92, s92, 1
    s_bitcmp1_b32 s92, 20
    s_cbranch_scc1 L_sync6x
    s_waitcnt lgkmcnt(0)
    v_readfirstlane_b32 s31, v1
    s_nop 0
    s_cmp_ge_u32 s31, 4
    s_cbranch_scc0 L_sync6
L_sync6x:
    s_add_u32 m0, s76, 2048
    s_nop 0
    buffer_load_dwordx4 v249, s[8:11], 0 offen lds
    s_add_u32 m0, s76, 3072
    s_nop 0
    buffer_load_dwordx4 v205, s[8:11], 0 offen lds
L_sync7:
    ds_read_b32 v1, v0 offset:42844
    ds_read_b32 v198, v0 offset:41556
    s_add_u32 s92, s92, 1
    s_bitcmp1_b32 s92, 20
    s_cbranch_scc1 L_sync7x
    s_waitcnt lgkmcnt(1)
    v_readfirstlane_b32 s31, v1
    s_nop 0
    s_cmp_ge_u32 s31, 1
    s_cbranch_scc0 L_sync7
L_sync7x:
    v_and_b32 v6, 48, v2
    v_lshlrev_b32 v6, 1, v6
    v_mov_b32 v209, 2147483392
    s_waitcnt lgkmcnt(0)
    v_readfirstlane_b32 s33, v198
    s_nop 0
    s_andn2_b32 s33, 0x7ff, s33
    s_sub_u32 s31, 0, s33
    s_and_b32 s31, s31, 2047
    s_sub_u32 s32, s33, 1024
    s_sub_u32 s34, s31, 1024
    v_cmp_eq_u32 vcc, s33, v7
    v_cmp_eq_u32 s[54:55], s33, v248
    s_nop 0
    v_cndmask_b32 v4, v4, v209, vcc
    v_cmp_eq_u32 vcc, s31, v7
    v_cmp_eq_u32 s[56:57], s31, v248
    s_nop 0
    v_cndmask_b32 v5, v5, v209, vcc
    v_cmp_eq_u32 vcc, s32, v7
    v_cmp_eq_u32 s[58:59], s32, v248
    s_nop 0
    v_cndmask_b32 v249, v249, v209, vcc
    v_cmp_eq_u32 vcc, s34, v7
    v_cmp_eq_u32 s[60:61], s34, v248
    s_nop 0
    v_cndmask_b32 v205, v205, v209, vcc
    s_or_b64 s[62:63], s[54:55], s[58:59]
    s_or_b64 s[64:65], s[56:57], s[60:61]
    s_waitcnt vmcnt(0)
    buffer_load_dwordx4 v[72:75], v3, s[12:15], s50 offen offset:0 sc1
    buffer_load_dwordx4 v[76:79], v3, s[12:15], s50 offen offset:1024 sc1
    buffer_load_dwordx4 v[80:83], v3, s[12:15], s50 offen offset:2048 sc1
    buffer_load_dwordx4 v[84:87], v3, s[12:15], s50 offen offset:3072 sc1
    s_mov_b32 exec_hi, 0x1ff
    buffer_load_dwordx4 v[212:215], v200, s[12:15], s51 offen sc1
    s_mov_b32 exec_hi, -1
    s_setprio 2
    ds_read_b128 v[16:19], v208 offset:2048
    ds_read_b128 v[20:23], v208 offset:3072
    s_waitcnt lgkmcnt(0)
    v_lshlrev_b32 v56, 16, v16
    v_and_b32 v57, 0xffff0000, v16
    v_lshlrev_b32 v58, 16, v17
    v_and_b32 v59, 0xffff0000, v17
    v_lshlrev_b32 v60, 16, v18
    v_and_b32 v61, 0xffff0000, v18
    v_lshlrev_b32 v62, 16, v19
    v_and_b32 v63, 0xffff0000, v19
    v_lshlrev_b32 v64, 16, v20
    v_and_b32 v71, 0xffff0000, v20
    v_lshlrev_b32 v70, 16, v21
    v_and_b32 v69, 0xffff0000, v21
    v_lshlrev_b32 v68, 16, v22
    v_and_b32 v67, 0xffff0000, v22
    v_lshlrev_b32 v66, 16, v23
    v_and_b32 v65, 0xffff0000, v23
    v_pk_fma_f32 v[136:137], v[56:57], v[32:33], v[34:35] op_sel_hi:[1,0,0]
    v_pk_fma_f32 v[138:139], v[58:59], v[32:33], v[34:35] op_sel_hi:[1,0,0]
    v_pk_fma_f32 v[140:141], v[60:61], v[32:33], v[34:35] op_sel_hi:[1,0,0]
    v_pk_fma_f32 v[142:143], v[62:63], v[32:33], v[34:35] op_sel_hi:[1,0,0]
    v_pk_fma_f32 v[144:145], v[64:65], v[36:37], v[38:39] op_sel_hi:[1,0,0]
    v_pk_fma_f32 v[146:147], v[66:67], v[36:37], v[38:39] op_sel_hi:[1,0,0]
    v_pk_fma_f32 v[148:149], v[68:69], v[36:37], v[38:39] op_sel_hi:[1,0,0]
    v_pk_fma_f32 v[150:151], v[70:71], v[36:37], v[38:39] op_sel_hi:[1,0,0]
    v_exp_f32 v232, v136
    v_exp_f32 v233, v137
    v_exp_f32 v234, v138
    v_exp_f32 v235, v139
    v_exp_f32 v236, v140
    v_exp_f32 v237, v141
    v_exp_f32 v238, v142
    v_exp_f32 v239, v143
    v_exp_f32 v240, v144
    v_exp_f32 v241, v145
    v_exp_f32 v242, v146
    v_exp_f32 v243, v147
    v_exp_f32 v244, v148
    v_exp_f32 v245, v149
    v_exp_f32 v246, v150
    v_exp_f32 v247, v151
    v_pk_add_f32 v[232:233], v[232:233], 1.0 op_sel_hi:[1,0]
    v_pk_add_f32 v[234:235], v[234:235], 1.0 op_sel_hi:[1,0]
    v_pk_add_f32 v[236:237], v[236:237], 1.0 op_sel_hi:[1,0]
    v_pk_add_f32 v[238:239], v[238:239], 1.0 op_sel_hi:[1,0]
    v_pk_add_f32 v[240:241], v[240:241], 1.0 op_sel_hi:[1,0]
    v_pk_add_f32 v[242:243], v[242:243], 1.0 op_sel_hi:[1,0]
    v_pk_add_f32 v[244:245], v[244:245], 1.0 op_sel_hi:[1,0]
    v_pk_add_f32 v[246:247], v[246:247], 1.0 op_sel_hi:[1,0]
    v_rcp_f32 v232, v232
    v_rcp_f32 v233, v233
    v_rcp_f32 v234, v234
    v_rcp_f32 v235, v235
    v_rcp_f32 v236, v236
    v_rcp_f32 v237, v237
    v_rcp_f32 v238, v238
    v_rcp_f32 v239, v239
    v_rcp_f32 v240, v240
    v_rcp_f32 v241, v241
    v_rcp_f32 v242, v242
    v_rcp_f32 v243, v243
    v_rcp_f32 v244, v244
    v_rcp_f32 v245, v245
    v_rcp_f32 v246, v246
    v_rcp_f32 v247, v247
    v_pk_mul_f32 v[136:137], v[136:137], v[232:233]
    v_pk_mul_f32 v[138:139], v[138:139], v[234:235]
    v_pk_mul_f32 v[140:141], v[140:141], v[236:237]
    v_pk_mul_f32 v[142:143], v[142:143], v[238:239]
    v_pk_mul_f32 v[144:145], v[144:145], v[240:241]
    v_pk_mul_f32 v[146:147], v[146:147], v[242:243]
    v_pk_mul_f32 v[148:149], v[148:149], v[244:245]
    v_pk_mul_f32 v[150:151], v[150:151], v[246:247]
L_z_wait:
    s_setprio 2
    s_waitcnt vmcnt(4)
    v_xor_b32 v160, v210, v72
    v_xor_b32 v161, v210, v73
    v_xor_b32 v162, v210, v74
    v_xor_b32 v163, v210, v75
    ds_write_b128 v250, v[160:163] offset:0
    v_or3_b32 v1, v160, v161, v162
    v_or_b32 v1, v1, v163
    s_waitcnt vmcnt(3)
    v_xor_b32 v164, v210, v76
    v_xor_b32 v165, v210, v77
    v_xor_b32 v166, v210, v78
    v_xor_b32 v167, v210, v79
    ds_write_b128 v250, v[164:167] offset:1024
    v_or3_b32 v1, v1, v164, v165
    v_or3_b32 v1, v1, v166, v167
    s_waitcnt vmcnt(2)
    v_xor_b32 v168, v210, v80
    v_xor_b32 v169, v210, v81
    v_xor_b32 v170, v210, v82
    v_xor_b32 v171, v210, v83
    ds_write_b128 v250, v[168:171] offset:2048
    v_or3_b32 v1, v1, v168, v169
    v_or3_b32 v1, v1, v170, v171
    s_waitcnt vmcnt(1)
    v_xor_b32 v172, v210, v84
    v_xor_b32 v173, v210, v85
    v_xor_b32 v174, v210, v86
    v_xor_b32 v175, v210, v87
    ds_write_b128 v250, v[172:175] offset:3072
    v_or3_b32 v1, v1, v172, v173
    v_or3_b32 v1, v1, v174, v175
    s_waitcnt vmcnt(0)
    v_xor_b32 v176, v210, v212
    v_xor_b32 v177, v210, v213
    v_xor_b32 v178, v210, v214
    v_xor_b32 v179, v210, v215
    s_mov_b32 exec_hi, 0x1ff
    ds_write_b128 v201, v[176:179]
    s_mov_b32 exec_hi, -1
    v_or3_b32 v1, v1, v176, v177
    v_or3_b32 v1, v1, v178, v179
    v_and_b32 v1, 0x30003, v1
    v_cmp_ne_u32 vcc, 0, v1
    s_nop 0
    s_cbranch_vccz L_z_got
    s_cmp_eq_u32 s35, 0
    s_cbranch_scc1 L_z_got
    s_sub_u32 s35, s35, 1
    s_sleep 2
    s_mov_b64 exec, vcc
    buffer_load_dwordx4 v[72:75], v3, s[12:15], s50 offen offset:0 sc1
    buffer_load_dwordx4 v[76:79], v3, s[12:15], s50 offen offset:1024 sc1
    buffer_load_dwordx4 v[80:83], v3, s[12:15], s50 offen offset:2048 sc1
    buffer_load_dwordx4 v[84:87], v3, s[12:15], s50 offen offset:3072 sc1
    s_and_b32 exec_hi, exec_hi, 0x1ff
    s_or_b32 exec_lo, exec_lo, 1
    buffer_load_dwordx4 v[212:215], v200, s[12:15], s51 offen sc1
    s_mov_b64 exec, -1
    s_waitcnt lgkmcnt(0)
    s_branch L_z_wait
L_z_got:
    s_mov_b64 exec, 1
    ds_add_u32 v0, v255 offset:42832
    s_mov_b64 exec, -1
L_sync8:
    ds_read_b32 v1, v0 offset:42832
    ds_read_b64_tr_b16 v[152:153], v251 offset:0
    ds_read_b64_tr_b16 v[154:155], v251 offset:1024
    ds_read_b64_tr_b16 v[156:157], v252 offset:0
    ds_read_b64_tr_b16 v[158:159], v252 offset:1024
    s_add_u32 s92, s92, 1
    s_bitcmp1_b32 s92, 20
    s_cbranch_scc1 L_sync8x
    s_waitcnt lgkmcnt(4)
    v_readfirstlane_b32 s31, v1
    s_nop 0
    s_cmp_ge_u32 s31, 4
    s_cbranch_scc0 L_sync8
L_sync8x:
    ds_read_b64_tr_b16 v[160:161], v251 offset:4096
    ds_read_b64_tr_b16 v[162:163], v251 offset:5120
    ds_read_b64_tr_b16 v[164:165], v252 offset:4096
    ds_read_b64_tr_b16 v[166:167], v252 offset:5120
    ds_read_b64_tr_b16 v[168:169], v251 offset:8192
    ds_read_b64_tr_b16 v[170:171], v251 offset:9216
    ds_read_b64_tr_b16 v[172:173], v252 offset:8192
    ds_read_b64_tr_b16 v[174:175], v252 offset:9216
    s_waitcnt lgkmcnt(8)
    v_mfma_f32_16x16x32_f16 v[216:219], v[152:155], v[88:91], 0
    v_mfma_f32_16x16x32_f16 v[220:223], v[156:159], v[88:91], 0
    ds_read_b64_tr_b16 v[176:177], v251 offset:12288
    ds_read_b64_tr_b16 v[178:179], v251 offset:13312
    ds_read_b64_tr_b16 v[180:181], v252 offset:12288
    ds_read_b64_tr_b16 v[182:183], v252 offset:13312
    s_waitcnt lgkmcnt(8)
    v_mfma_f32_16x16x32_f16 v[216:219], v[160:163], v[92:95], v[216:219]
    v_mfma_f32_16x16x32_f16 v[220:223], v[164:167], v[92:95], v[220:223]
    ds_read_b64_tr_b16 v[152:153], v206 offset:0
    ds_read_b64_tr_b16 v[154:155], v253 offset:1024
    ds_read_b64_tr_b16 v[156:157], v207 offset:0
    ds_read_b64_tr_b16 v[158:159], v254 offset:1024
    s_waitcnt lgkmcnt(8)
    v_mfma_f32_16x16x32_f16 v[224:227], v[168:171], v[96:99], 0
    v_mfma_f32_16x16x32_f16 v[228:231], v[172:175], v[96:99], 0
    ds_read_b64_tr_b16 v[160:161], v253 offset:4096
    ds_read_b64_tr_b16 v[162:163], v253 offset:5120
    ds_read_b64_tr_b16 v[164:165], v254 offset:4096
    ds_read_b64_tr_b16 v[166:167], v254 offset:5120
    s_waitcnt lgkmcnt(8)
    v_mfma_f32_16x16x32_f16 v[224:227], v[176:179], v[100:103], v[224:227]
    v_mfma_f32_16x16x32_f16 v[228:231], v[180:183], v[100:103], v[228:231]
    ds_read_b64_tr_b16 v[168:169], v253 offset:8192
    ds_read_b64_tr_b16 v[170:171], v253 offset:9216
    ds_read_b64_tr_b16 v[172:173], v254 offset:8192
    ds_read_b64_tr_b16 v[174:175], v254 offset:9216
    s_waitcnt lgkmcnt(8)
    v_mfma_f32_16x16x32_f16 v[216:219], v[152:155], v[104:107], v[216:219]
    v_mfma_f32_16x16x32_f16 v[220:223], v[156:159], v[104:107], v[220:223]
    ds_read_b64_tr_b16 v[176:177], v253 offset:12288
    ds_read_b64_tr_b16 v[178:179], v253 offset:13312
    ds_read_b64_tr_b16 v[180:181], v254 offset:12288
    ds_read_b64_tr_b16 v[182:183], v254 offset:13312
    s_waitcnt lgkmcnt(8)
    v_mfma_f32_16x16x32_f16 v[216:219], v[160:163], v[108:111], v[216:219]
    v_mfma_f32_16x16x32_f16 v[220:223], v[164:167], v[108:111], v[220:223]
    ds_read_b64_tr_b16 v[72:73], v202 offset:0
    ds_read_b64_tr_b16 v[74:75], v202 offset:1024
    ds_read_b64_tr_b16 v[76:77], v202 offset:4096
    ds_read_b64_tr_b16 v[78:79], v202 offset:5120
    s_waitcnt lgkmcnt(8)
    v_mfma_f32_16x16x32_f16 v[224:227], v[168:171], v[112:115], v[224:227]
    v_mfma_f32_16x16x32_f16 v[228:231], v[172:175], v[112:115], v[228:231]
    ds_read_b64_tr_b16 v[80:81], v202 offset:8192
    ds_read_b64_tr_b16 v[82:83], v202 offset:9216
    ds_read_b64_tr_b16 v[84:85], v202 offset:12288
    ds_read_b64_tr_b16 v[86:87], v202 offset:13312
    s_waitcnt lgkmcnt(8)
    v_mfma_f32_16x16x32_f16 v[224:227], v[176:179], v[116:119], v[224:227]
    v_mfma_f32_16x16x32_f16 v[228:231], v[180:183], v[116:119], v[228:231]
    ds_read_b64_tr_b16 v[240:241], v204 offset:0
    ds_read_b64_tr_b16 v[242:243], v203 offset:1024
    ds_read_b64_tr_b16 v[244:245], v203 offset:4096
    ds_read_b64_tr_b16 v[246:247], v203 offset:5120
    s_waitcnt lgkmcnt(8)
    ds_read_b64_tr_b16 v[184:185], v203 offset:8192
    ds_read_b64_tr_b16 v[186:187], v203 offset:9216
    ds_read_b64_tr_b16 v[188:189], v203 offset:12288
    ds_read_b64_tr_b16 v[190:191], v203 offset:13312
    v_mfma_f32_16x16x32_f16 v[232:235], v[72:75], v[88:91], 0
    v_mfma_f32_16x16x32_f16 v[232:235], v[76:79], v[92:95], v[232:235]
    s_waitcnt lgkmcnt(4)
    v_mfma_f32_16x16x32_f16 v[236:239], v[80:83], v[96:99], 0
    v_mfma_f32_16x16x32_f16 v[236:239], v[84:87], v[100:103], v[236:239]
    v_pk_add_f32 v[152:153], v[216:217], v[224:225]
    v_pk_add_f32 v[154:155], v[218:219], v[226:227]
    v_pk_add_f32 v[156:157], v[220:221], v[228:229]
    v_pk_add_f32 v[158:159], v[222:223], v[230:231]
    v_mfma_f32_16x16x32_f16 v[232:235], v[240:243], v[104:107], v[232:235]
    v_mfma_f32_16x16x32_f16 v[232:235], v[244:247], v[108:111], v[232:235]
    v_pk_fma_f32 v[40:41], v[152:153], v[120:121], v[40:41]
    v_pk_fma_f32 v[42:43], v[154:155], v[122:123], v[42:43]
    v_pk_fma_f32 v[44:45], v[156:157], v[124:125], v[44:45]
    v_pk_fma_f32 v[46:47], v[158:159], v[126:127], v[46:47]
    s_waitcnt lgkmcnt(0)
    s_nop 0
    v_mfma_f32_16x16x32_f16 v[236:239], v[184:187], v[112:115], v[236:239]
    v_mfma_f32_16x16x32_f16 v[236:239], v[188:191], v[116:119], v[236:239]
    v_cvt_pk_bf16_f32 v8, v40, v41
    v_cvt_pk_bf16_f32 v9, v42, v43
    v_cvt_pk_bf16_f32 v10, v44, v45
    v_cvt_pk_bf16_f32 v11, v46, v47
    ds_write_b128 v208, v[8:11] offset:0
    ds_read_b128 v[24:27], v199 offset:0
    v_pk_add_f32 v[160:161], v[216:217], v[224:225] neg_lo:[0,1] neg_hi:[0,1]
    v_pk_add_f32 v[162:163], v[218:219], v[226:227] neg_lo:[0,1] neg_hi:[0,1]
    v_pk_add_f32 v[164:165], v[220:221], v[228:229] neg_lo:[0,1] neg_hi:[0,1]
    v_pk_add_f32 v[166:167], v[222:223], v[230:231] neg_lo:[0,1] neg_hi:[0,1]
    s_cmp_eq_u64 s[62:63], 0
    s_cbranch_scc1 L_nodump0
    s_mov_b64 exec, s[54:55]
    ds_write_b128 v6, v[152:155] offset:42496
    ds_write_b128 v6, v[156:159] offset:42512
    s_mov_b64 exec, s[58:59]
    ds_write_b128 v6, v[160:163] offset:42496
    ds_write_b128 v6, v[164:167] offset:42512
    s_mov_b64 exec, 1
    ds_add_u32 v0, v255 offset:42836
    s_mov_b64 exec, -1
    s_waitcnt lgkmcnt(0)
L_nodump0:
    s_nop 0
    v_pk_fma_f32 v[56:57], v[160:161], v[136:137], v[56:57]
    v_pk_fma_f32 v[58:59], v[162:163], v[138:139], v[58:59]
    v_pk_fma_f32 v[60:61], v[164:165], v[140:141], v[60:61]
    v_pk_fma_f32 v[62:63], v[166:167], v[142:143], v[62:63]
    v_cvt_pk_bf16_f32 v16, v56, v57
    v_cvt_pk_bf16_f32 v17, v58, v59
    v_cvt_pk_bf16_f32 v18, v60, v61
    v_cvt_pk_bf16_f32 v19, v62, v63
    ds_write_b128 v208, v[16:19] offset:2048
    ds_read_b128 v[32:35], v199 offset:2048
    s_waitcnt lgkmcnt(2)
    buffer_store_dwordx4 v[24:27], v4, s[16:19], 0 offen sc1
    v_add_f32 v152, v232, v236
    v_sub_f32 v160, v232, v236
    s_cmp_eq_u64 s[64:65], 0
    s_cbranch_scc1 L_nodump1
    s_mov_b64 exec, s[56:57]
    ds_write_b128 v6, v[152:155] offset:42624
    ds_write_b128 v6, v[156:159] offset:42640
    s_mov_b64 exec, s[60:61]
    ds_write_b128 v6, v[160:163] offset:42624
    ds_write_b128 v6, v[164:167] offset:42640
    s_mov_b64 exec, 1
    ds_add_u32 v0, v255 offset:42864
    s_mov_b64 exec, -1
    s_waitcnt lgkmcnt(0)
L_nodump1:
    v_pk_fma_f32 v[48:49], v[152:153], v[128:129], v[48:49]
    v_pk_fma_f32 v[50:51], v[154:155], v[130:131], v[50:51]
    v_pk_fma_f32 v[52:53], v[156:157], v[132:133], v[52:53]
    v_pk_fma_f32 v[54:55], v[158:159], v[134:135], v[54:55]
    v_cvt_pk_bf16_f32 v12, v48, v55
    v_cvt_pk_bf16_f32 v13, v54, v53
    v_cvt_pk_bf16_f32 v14, v52, v51
    v_cvt_pk_bf16_f32 v15, v50, v49
    ds_write_b128 v208, v[12:15] offset:1024
    ds_read_b128 v[28:31], v199 offset:1024
    s_waitcnt lgkmcnt(2)
    s_nop 0
    buffer_store_dwordx4 v[32:35], v249, s[16:19], 0 offen sc1
    v_pk_fma_f32 v[64:65], v[160:161], v[144:145], v[64:65]
    v_pk_fma_f32 v[66:67], v[162:163], v[146:147], v[66:67]
    v_pk_fma_f32 v[68:69], v[164:165], v[148:149], v[68:69]
    v_pk_fma_f32 v[70:71], v[166:167], v[150:151], v[70:71]
    v_cvt_pk_bf16_f32 v20, v64, v71
    v_cvt_pk_bf16_f32 v21, v70, v69
    v_cvt_pk_bf16_f32 v22, v68, v67
    v_cvt_pk_bf16_f32 v23, v66, v65
    ds_write_b128 v208, v[20:23] offset:3072
    ds_read_b128 v[36:39], v199 offset:3072
    s_waitcnt lgkmcnt(2)
    buffer_store_dwordx4 v[28:31], v5, s[16:19], 0 offen sc1
    s_waitcnt lgkmcnt(0)
    buffer_store_dwordx4 v[36:39], v205, s[16:19], 0 offen sc1
    s_branch L_fin
L_dma_done:
    s_setprio 0
    s_lshr_b32 s31, s47, 2
    s_andn2_b32 s31, s31, s75
    s_add_u32 s50, s31, s46
    s_lshl_b32 s31, s50, 17
    s_bfe_u32 s32, s2, 0x20003
    s_lshl_b32 s32, s32, 2
    s_add_u32 s51, s32, s30
    s_lshl_b32 s32, s51, 7
    s_add_u32 s31, s31, s32
    v_lshrrev_b32 v6, 3, v2
    v_lshlrev_b32 v6, 11, v6
    v_and_b32 v7, 0x70, v3
    v_and_b32 v11, 16, v2
    v_lshlrev_b32 v11, 1, v11
    v_xor_b32 v11, v11, v7
    v_add3_u32 v6, v6, v11, s31
    v_xor_b32 v11, 64, v6
    s_lshl_b32 s74, s30, 13
    s_cmp_lt_u32 s30, 2
    s_mov_b32 s31, 125952
    s_cselect_b32 s31, 60416, s31
    s_add_u32 s74, s74, s31
    s_mov_b32 s60, 4096
    s_mov_b32 s61, 8192
    s_mov_b32 s62, 12288
    v_bfe_u32 v8, v2, 2, 3
    v_lshlrev_b32 v9, 5, v8
    s_lshl_b32 s31, s30, 6
    v_xor_b32 v9, s31, v9
    v_bfe_u32 v8, v2, 2, 2
    v_lshl_add_u32 v9, v8, 8, v9
    v_lshrrev_b32 v8, 4, v2
    v_lshl_add_u32 v9, v8, 11, v9
    v_and_b32 v10, 3, v2
    v_lshl_add_u32 v9, v10, 3, v9
    v_add_u32 v9, 76800, v9
    v_xor_b32 v10, 32, v9
    v_lshlrev_b32 v8, 4, v8
    s_lshr_b32 s31, s30, 1
    s_and_b32 s32, s31, s75
    s_lshl_b32 s32, s32, 8
    v_add_u32 v8, s32, v8
    s_cmp_eq_u32 s75, 0
    s_cselect_b32 s32, 12, 9
    s_lshl_b32 s31, s31, s32
    s_lshl_b32 s32, s46, 3
    s_add_u32 s32, s32, s47
    s_lshl_b32 s32, s32, 9
    s_add_u32 s31, s31, s32
    s_and_b32 s32, s30, 1
    s_lshl_b32 s32, s32, 8
    s_add_u32 s31, s31, s32
    s_add_u32 s31, s31, 262144
    v_lshl_add_u32 v13, v2, 3, s31
    s_waitcnt lgkmcnt(0)
    s_add_u32 s28, s28, 0x7f4a7c15
    s_addc_u32 s29, s29, 0x9e3779b9
    s_and_b32 s31, s28, 0xff
    v_mov_b32 v14, s31
    s_mov_b32 s49, 0xffffff00
    s_cmp_lg_u32 s30, 2
    s_cbranch_scc1 L_no_tlb
    s_mov_b32 s52, s44
    s_mov_b32 s53, s45
    s_mov_b32 s54, 0x400000
    s_mov_b32 s55, 0x00020000
    v_lshlrev_b32 v250, 18, v2
    v_min_u32 v250, 0x3ffffc, v250
    s_mov_b32 exec_lo, 0x1ffff
    s_mov_b32 exec_hi, 0x0
    buffer_load_dword v252, v250, s[52:55], 0 offen
    s_mov_b64 exec, 0x3f
    v_lshlrev_b32 v250, 20, v2
    v_add_u32 v250, 753664, v250
    v_min_u32 v250, 4491392, v250
    buffer_load_dword v251, v250, s[12:15], 0 offen
    s_mov_b64 exec, 3
    v_mul_u32_u24 v250, 0x1f800, v2
    v_add_u32 v250, v250, v6
    buffer_load_dword v253, v250, s[24:27], 0 offen
    s_mov_b64 exec, -1
L_no_tlb:
    s_cmp_lg_u32 s66, 0
    s_cbranch_scc1 L_tagged
    s_mov_b64 exec, 1
    ds_add_u32 v0, v255 offset:42872
    s_mov_b64 exec, -1
L_tagged:
    s_cmp_eq_u32 s30, 3
    s_cbranch_scc1 L_h1
    s_cmp_eq_u32 s66, 0
    s_cbranch_scc1 L_key
    s_cmp_lg_u32 s30, 0
    s_cbranch_scc1 L_follower
    s_setprio 3
    s_waitcnt vmcnt(16)
    s_mov_b64 exec, 1
    ds_add_u32 v0, v255 offset:42868
    s_mov_b64 exec, -1
    s_nop 0
    ds_read_b64_tr_b16 v[36:37], v9 offset:0
    ds_read_b64_tr_b16 v[38:39], v9 offset:1024
    ds_read_b64_tr_b16 v[40:41], v10 offset:0
    ds_read_b64_tr_b16 v[42:43], v10 offset:1024
    ds_read_b64_tr_b16 v[44:45], v9 offset:32768
    ds_read_b64_tr_b16 v[46:47], v9 offset:33792
    ds_read_b64_tr_b16 v[48:49], v10 offset:32768
    ds_read_b64_tr_b16 v[50:51], v10 offset:33792
    ds_read_b64_tr_b16 v[52:53], v9 offset:8192
    ds_read_b64_tr_b16 v[54:55], v9 offset:9216
    ds_read_b64_tr_b16 v[56:57], v10 offset:8192
    ds_read_b64_tr_b16 v[58:59], v10 offset:9216
    ds_read_b64_tr_b16 v[60:61], v9 offset:40960
    ds_read_b64_tr_b16 v[62:63], v9 offset:41984
    s_waitcnt lgkmcnt(12)
    ds_read_b64_tr_b16 v[64:65], v10 offset:40960
    ds_read_b64_tr_b16 v[66:67], v10 offset:41984
    s_waitcnt lgkmcnt(12)
    ds_read_b64_tr_b16 v[68:69], v9 offset:16384
    ds_read_b64_tr_b16 v[70:71], v9 offset:17408
    s_waitcnt lgkmcnt(12)
    ds_read_b64_tr_b16 v[72:73], v10 offset:16384
    ds_read_b64_tr_b16 v[74:75], v10 offset:17408
    s_waitcnt lgkmcnt(12)
    ds_read_b64_tr_b16 v[76:77], v9 offset:49152
    ds_read_b64_tr_b16 v[78:79], v9 offset:50176
    s_waitcnt lgkmcnt(12)
    ds_read_b64_tr_b16 v[80:81], v10 offset:49152
    ds_read_b64_tr_b16 v[82:83], v10 offset:50176
    s_waitcnt vmcnt(8)
    s_mov_b64 exec, 1
    ds_add_u32 v0, v255 offset:42868
    s_mov_b64 exec, -1
    s_branch L_d_first
L_follower:
    v_readfirstlane_b32 s52, v13
    s_and_b32 s32, s30, 1
    s_lshl_b32 s32, s32, 8
    s_sub_u32 s52, s52, s32
    s_lshl_b32 s31, s50, 12
    s_sub_u32 s31, s31, s32
    s_lshl_b32 s32, s51, 8
    s_add_u32 s31, s31, s32
    s_add_u32 s53, s31, 524288
    s_load_dword s54, s[12:13], s53
    s_load_dword s54, s[12:13], s52
    s_add_u32 s52, s52, 64
    s_add_u32 s53, s53, 64
    s_load_dword s54, s[12:13], s53
    s_load_dword s54, s[12:13], s52
    s_add_u32 s52, s52, 64
    s_add_u32 s53, s53, 64
    s_load_dword s54, s[12:13], s53
    s_load_dword s54, s[12:13], s52
    s_add_u32 s52, s52, 64
    s_add_u32 s53, s53, 64
    s_load_dword s54, s[12:13], s53
    s_load_dword s54, s[12:13], s52
    s_add_u32 s52, s52, 64
    s_add_u32 s53, s53, 64
    s_waitcnt lgkmcnt(0)
    s_load_dword s54, s[12:13], s53
    s_load_dword s54, s[12:13], s52
    s_add_u32 s52, s52, 64
    s_add_u32 s53, s53, 64
    s_load_dword s54, s[12:13], s53
    s_load_dword s54, s[12:13], s52
    s_add_u32 s52, s52, 64
    s_add_u32 s53, s53, 64
    s_load_dword s54, s[12:13], s53
    s_load_dword s54, s[12:13], s52
    s_add_u32 s52, s52, 64
    s_add_u32 s53, s53, 64
    s_load_dword s54, s[12:13], s53
    s_load_dword s54, s[12:13], s52
L_sync9:
    ds_read_b32 v1, v0 offset:42868
    s_add_u32 s92, s92, 1
    s_bitcmp1_b32 s92, 20
    s_cbranch_scc1 L_sync9x
    s_waitcnt lgkmcnt(0)
    v_readfirstlane_b32 s31, v1
    s_nop 0
    s_cmp_ge_u32 s31, 1
    s_cbranch_scc0 L_sync9
L_sync9x:
    s_setprio 3
    s_nop 0
    ds_read_b64_tr_b16 v[36:37], v9 offset:0
    ds_read_b64_tr_b16 v[38:39], v9 offset:1024
    ds_read_b64_tr_b16 v[40:41], v10 offset:0
    ds_read_b64_tr_b16 v[42:43], v10 offset:1024
    ds_read_b64_tr_b16 v[44:45], v9 offset:32768
    ds_read_b64_tr_b16 v[46:47], v9 offset:33792
    ds_read_b64_tr_b16 v[48:49], v10 offset:32768
    ds_read_b64_tr_b16 v[50:51], v10 offset:33792
    ds_read_b64_tr_b16 v[52:53], v9 offset:8192
    ds_read_b64_tr_b16 v[54:55], v9 offset:9216
    ds_read_b64_tr_b16 v[56:57], v10 offset:8192
    ds_read_b64_tr_b16 v[58:59], v10 offset:9216
    ds_read_b64_tr_b16 v[60:61], v9 offset:40960
    ds_read_b64_tr_b16 v[62:63], v9 offset:41984
    s_waitcnt lgkmcnt(12)
    ds_read_b64_tr_b16 v[64:65], v10 offset:40960
    ds_read_b64_tr_b16 v[66:67], v10 offset:41984
    s_waitcnt lgkmcnt(12)
    ds_read_b64_tr_b16 v[68:69], v9 offset:16384
    ds_read_b64_tr_b16 v[70:71], v9 offset:17408
    s_waitcnt lgkmcnt(12)
    ds_read_b64_tr_b16 v[72:73], v10 offset:16384
    ds_read_b64_tr_b16 v[74:75], v10 offset:17408
    s_waitcnt lgkmcnt(12)
    ds_read_b64_tr_b16 v[76:77], v9 offset:49152
    ds_read_b64_tr_b16 v[78:79], v9 offset:50176
    s_waitcnt lgkmcnt(12)
    ds_read_b64_tr_b16 v[80:81], v10 offset:49152
    ds_read_b64_tr_b16 v[82:83], v10 offset:50176
    s_add_u32 s67, s30, 0
L_sync10:
    ds_read_b32 v1, v0 offset:42868
    s_add_u32 s92, s92, 1
    s_bitcmp1_b32 s92, 20
    s_cbranch_scc1 L_sync10x
    s_waitcnt lgkmcnt(0)
    v_readfirstlane_b32 s31, v1
    s_nop 0
    s_cmp_ge_u32 s31, s67
    s_cbranch_scc0 L_sync10
L_sync10x:
L_d_first:
    s_add_u32 m0, s74, 0
    s_mov_b32 s31, 0
    buffer_load_dwordx4 v6, s[24:27], s31 offen nt lds
    s_add_u32 m0, s74, 1024
    s_mov_b32 s31, 16384
    buffer_load_dwordx4 v11, s[24:27], s31 offen nt lds
    s_add_u32 m0, s74, 2048
    s_mov_b32 s31, 32768
    buffer_load_dwordx4 v6, s[24:27], s31 offen nt lds
    s_add_u32 m0, s74, 3072
    s_mov_b32 s31, 49152
    buffer_load_dwordx4 v11, s[24:27], s31 offen nt lds
    s_add_u32 m0, s74, 4096
    s_mov_b32 s31, 65536
    buffer_load_dwordx4 v6, s[24:27], s31 offen nt lds
    s_cmp_lg_u32 s30, 0
    s_cbranch_scc1 L_k3_waitp
    s_waitcnt vmcnt(5)
    s_mov_b64 exec, 1
    ds_add_u32 v0, v255 offset:42868
    s_mov_b64 exec, -1
L_k3_waitp:
    s_waitcnt lgkmcnt(4)
    s_branch L_sync11a
L_sync11:
    s_waitcnt lgkmcnt(0)
L_sync11a:
    ds_read_b32 v1, v0 offset:42868
    ds_read_b64_tr_b16 v[84:85], v9 offset:24576
    ds_read_b64_tr_b16 v[86:87], v9 offset:25600
    ds_read_b64_tr_b16 v[88:89], v10 offset:24576
    ds_read_b64_tr_b16 v[90:91], v10 offset:25600
    ds_read_b64_tr_b16 v[92:93], v9 offset:57344
    ds_read_b64_tr_b16 v[94:95], v9 offset:58368
    ds_read_b64_tr_b16 v[96:97], v10 offset:57344
    ds_read_b64_tr_b16 v[98:99], v10 offset:58368
    s_add_u32 s92, s92, 1
    s_bitcmp1_b32 s92, 20
    s_cbranch_scc1 L_sync11x
    s_waitcnt lgkmcnt(8)
    v_readfirstlane_b32 s31, v1
    s_nop 0
    s_cmp_ge_u32 s31, 3
    s_cbranch_scc0 L_sync11
L_sync11x:
L_key:
    s_waitcnt lgkmcnt(0)
L_sync12:
    ds_read_b32 v1, v0 offset:42844
    ds_read_b64 v[18:19], v0 offset:41552
    ds_read_b128 v[20:23], v8 offset:41600
    ds_read_b128 v[24:27], v8 offset:41664
    ds_read_b128 v[28:31], v8 offset:41728
    ds_read_b128 v[32:35], v8 offset:41792
    s_add_u32 s92, s92, 1
    s_bitcmp1_b32 s92, 20
    s_cbranch_scc1 L_sync12x
    s_waitcnt lgkmcnt(5)
    v_readfirstlane_b32 s31, v1
    s_nop 0
    s_cmp_ge_u32 s31, 1
    s_cbranch_scc0 L_sync12
L_sync12x:
    s_cmp_eq_u32 s66, 0
    s_cbranch_scc1 L_idle
    s_branch L_xs_ok
L_h1:
    s_mov_b32 s63, 4096
    s_lshl_b32 s31, s47, 8
    v_lshlrev_b32 v15, 3, v2
    v_add_u32 v16, s31, v15
    s_cmp_lg_u32 s66, 0
    s_cbranch_scc1 L_gate
L_sync13:
    ds_read_b32 v1, v0 offset:42828
    s_add_u32 s92, s92, 1
    s_bitcmp1_b32 s92, 20
    s_cbranch_scc1 L_sync13x
    s_waitcnt lgkmcnt(0)
    v_readfirstlane_b32 s31, v1
    s_nop 0
    s_cmp_ge_u32 s31, 4
    s_cbranch_scc0 L_sync13
L_sync13x:
    s_branch L_gate_open
L_gate:
L_sync14:
    ds_read_b32 v1, v0 offset:42828
    s_add_u32 s92, s92, 1
    s_bitcmp1_b32 s92, 20
    s_cbranch_scc1 L_sync14x
    s_waitcnt lgkmcnt(0)
    v_readfirstlane_b32 s31, v1
    s_nop 0
    s_cmp_ge_u32 s31, 1
    s_cbranch_scc0 L_sync14
L_sync14x:
L_gate_open:
    s_setprio 3
    buffer_load_dwordx4 v[20:23], v3, s[12:15], s63 offen offset:0 sc1
    buffer_load_dwordx4 v[24:27], v3, s[12:15], s63 offen offset:1024 sc1
    buffer_load_dwordx4 v[28:31], v3, s[12:15], s63 offen offset:2048 sc1
    buffer_load_dwordx4 v[32:35], v3, s[12:15], s63 offen offset:3072 sc1
    s_mov_b64 exec, 1
    ds_add_u32 v0, v255 offset:42860
    s_mov_b64 exec, -1
    s_waitcnt vmcnt(0)
L_mi_check:
    v_cmp_ne_u64 s[52:53], s[28:29], v[22:23]
    v_cmp_ne_u64 s[54:55], s[28:29], v[26:27]
    v_cmp_ne_u64 s[56:57], s[28:29], v[30:31]
    v_cmp_ne_u64 s[58:59], s[28:29], v[34:35]
    v_max_u32 v18, v21, v25
    v_max3_u32 v18, v18, v29, v33
    s_or_b64 s[64:65], s[52:53], s[54:55]
    s_or_b64 vcc, s[56:57], s[58:59]
    s_or_b64 s[64:65], s[64:65], vcc
    s_cbranch_scc0 L_mi_got
    s_cmp_eq_u32 s35, 0
    s_cbranch_scc1 L_mi_got
    s_sub_u32 s35, s35, 1
    s_sleep 2
    s_mov_b64 exec, s[52:53]
    s_cbranch_execz L_mi_skip0
    buffer_load_dwordx4 v[20:23], v3, s[12:15], s63 offen offset:0 sc1
L_mi_skip0:
    s_mov_b64 exec, s[54:55]
    s_cbranch_execz L_mi_skip1
    buffer_load_dwordx4 v[24:27], v3, s[12:15], s63 offen offset:1024 sc1
L_mi_skip1:
    s_mov_b64 exec, s[56:57]
    s_cbranch_execz L_mi_skip2
    buffer_load_dwordx4 v[28:31], v3, s[12:15], s63 offen offset:2048 sc1
L_mi_skip2:
    s_mov_b64 exec, s[58:59]
    s_cbranch_execz L_mi_skip3
    buffer_load_dwordx4 v[32:35], v3, s[12:15], s63 offen offset:3072 sc1
L_mi_skip3:
    s_mov_b64 exec, -1
    s_waitcnt vmcnt(0)
    s_branch L_mi_check
L_mi_got:
    v_max_u32_dpp v19, v18, v18 row_ror:1 row_mask:0xf bank_mask:0xf
    s_nop 1
    v_max_u32_dpp v19, v19, v19 row_ror:2 row_mask:0xf bank_mask:0xf
    s_nop 1
    v_max_u32_dpp v19, v19, v19 row_ror:4 row_mask:0xf bank_mask:0xf
    s_nop 1
    v_max_u32_dpp v19, v19, v19 row_ror:8 row_mask:0xf bank_mask:0xf
    s_nop 0
    v_readlane_b32 s33, v19, 0
    v_readlane_b32 s31, v19, 16
    v_readlane_b32 s32, v19, 32
    v_readlane_b32 s34, v19, 48
    s_max_u32 s33, s33, s31
    s_max_u32 s32, s32, s34
    s_max_u32 s33, s33, s32
    s_andn2_b32 s31, 0x7ff, s33
    s_lshl_b32 s48, s31, 11
    buffer_load_dwordx2 v[150:151], v16, s[8:11], s48 offen
    s_mov_b64 exec, 1
    ds_add_u32 v0, v255 offset:42840
    s_mov_b64 exec, -1
    v_cmp_eq_u32 s[52:53], s33, v25
    v_cmp_eq_u32 s[54:55], s33, v29
    v_cmp_eq_u32 s[56:57], s33, v33
    v_cmp_eq_u32 vcc, s33, v18
    v_cndmask_b32 v19, v20, v24, s[52:53]
    v_cndmask_b32 v19, v19, v28, s[54:55]
    v_cndmask_b32 v19, v19, v32, s[56:57]
    s_ff1_i32_b64 s32, vcc
    v_readlane_b32 s34, v19, s32
    v_mov_b32 v19, s33
    s_nop 0
    v_mov_b32 v18, s34
    ds_write_b64 v0, v[18:19] offset:41552
    s_lshl_b32 s52, s34, 16
    s_and_b32 s32, s34, 0xffff0000
    v_rcp_f32 v148, s32
    s_cmp_eq_u32 s66, 0
    s_cbranch_scc1 L_h1_idle
L_sync15:
    ds_read_b32 v1, v0 offset:42868
    s_add_u32 s92, s92, 1
    s_bitcmp1_b32 s92, 20
    s_cbranch_scc1 L_sync15x
    s_waitcnt lgkmcnt(0)
    v_readfirstlane_b32 s31, v1
    s_nop 0
    s_cmp_ge_u32 s31, 1
    s_cbranch_scc0 L_sync15
L_sync15x:
    s_nop 0
    ds_read_b64_tr_b16 v[36:37], v9 offset:0
    ds_read_b64_tr_b16 v[38:39], v9 offset:1024
    ds_read_b64_tr_b16 v[40:41], v10 offset:0
    ds_read_b64_tr_b16 v[42:43], v10 offset:1024
    ds_read_b64_tr_b16 v[44:45], v9 offset:32768
    ds_read_b64_tr_b16 v[46:47], v9 offset:33792
    ds_read_b64_tr_b16 v[48:49], v10 offset:32768
    ds_read_b64_tr_b16 v[50:51], v10 offset:33792
    ds_read_b64_tr_b16 v[52:53], v9 offset:8192
    ds_read_b64_tr_b16 v[54:55], v9 offset:9216
    ds_read_b64_tr_b16 v[56:57], v10 offset:8192
    ds_read_b64_tr_b16 v[58:59], v10 offset:9216
    ds_read_b64_tr_b16 v[60:61], v9 offset:40960
    ds_read_b64_tr_b16 v[62:63], v9 offset:41984
    s_waitcnt lgkmcnt(12)
    ds_read_b64_tr_b16 v[64:65], v10 offset:40960
    ds_read_b64_tr_b16 v[66:67], v10 offset:41984
    s_waitcnt lgkmcnt(12)
    ds_read_b64_tr_b16 v[68:69], v9 offset:16384
    ds_read_b64_tr_b16 v[70:71], v9 offset:17408
    s_waitcnt lgkmcnt(12)
    ds_read_b64_tr_b16 v[72:73], v10 offset:16384
    ds_read_b64_tr_b16 v[74:75], v10 offset:17408
    s_waitcnt lgkmcnt(12)
    ds_read_b64_tr_b16 v[76:77], v9 offset:49152
    ds_read_b64_tr_b16 v[78:79], v9 offset:50176
    s_waitcnt lgkmcnt(12)
    ds_read_b64_tr_b16 v[80:81], v10 offset:49152
    ds_read_b64_tr_b16 v[82:83], v10 offset:50176
    s_waitcnt lgkmcnt(4)
    s_branch L_sync16a
L_sync16:
    s_waitcnt lgkmcnt(0)
L_sync16a:
    ds_read_b32 v1, v0 offset:42868
    ds_read_b64_tr_b16 v[84:85], v9 offset:24576
    ds_read_b64_tr_b16 v[86:87], v9 offset:25600
    ds_read_b64_tr_b16 v[88:89], v10 offset:24576
    ds_read_b64_tr_b16 v[90:91], v10 offset:25600
    ds_read_b64_tr_b16 v[92:93], v9 offset:57344
    ds_read_b64_tr_b16 v[94:95], v9 offset:58368
    ds_read_b64_tr_b16 v[96:97], v10 offset:57344
    ds_read_b64_tr_b16 v[98:99], v10 offset:58368
    s_add_u32 s92, s92, 1
    s_bitcmp1_b32 s92, 20
    s_cbranch_scc1 L_sync16x
    s_waitcnt lgkmcnt(8)
    v_readfirstlane_b32 s31, v1
    s_nop 0
    s_cmp_ge_u32 s31, 3
    s_cbranch_scc0 L_sync16
L_sync16x:
    s_waitcnt vmcnt(0) lgkmcnt(0)
    s_branch L_h1_x
L_h1_idle:
    s_waitcnt vmcnt(0)
L_h1_x:
    v_lshlrev_b32 v20, 16, v150
    v_and_b32 v21, 0xffff0000, v150
    v_lshlrev_b32 v22, 16, v151
    v_and_b32 v23, 0xffff0000, v151
    v_pk_add_f32 v[20:21], v[20:21], s[52:53] op_sel_hi:[1,0] neg_lo:[0,1] neg_hi:[0,1]
    v_pk_add_f32 v[22:23], v[22:23], s[52:53] op_sel_hi:[1,0] neg_lo:[0,1] neg_hi:[0,1]
    v_cvt_pk_bf16_f32 v150, v20, v21
    v_cvt_pk_bf16_f32 v151, v22, v23
    v_lshlrev_b32 v20, 16, v150
    v_and_b32 v21, 0xffff0000, v150
    v_lshlrev_b32 v22, 16, v151
    v_and_b32 v23, 0xffff0000, v151
    v_pk_mul_f32 v[20:21], v[20:21], v[148:149] op_sel_hi:[1,0]
    v_pk_mul_f32 v[22:23], v[22:23], v[148:149] op_sel_hi:[1,0]
    v_cvt_pk_bf16_f32 v150, v20, v21
    v_cvt_pk_bf16_f32 v151, v22, v23
    ds_write_b64 v15, v[150:151] offset:41600
    s_mov_b64 exec, 1
    ds_add_u32 v0, v255 offset:42844
    s_mov_b64 exec, -1
    s_cmp_eq_u32 s66, 0
    s_cbranch_scc1 L_idle
    ds_read_b128 v[20:23], v8 offset:41600
    ds_read_b128 v[24:27], v8 offset:41664
    ds_read_b128 v[28:31], v8 offset:41728
    ds_read_b128 v[32:35], v8 offset:41792
    s_add_u32 m0, s74, 0
    s_mov_b32 s31, 0
    s_nop 0
    buffer_load_dwordx4 v6, s[24:27], s31 offen nt lds
    s_add_u32 m0, s74, 1024
    s_mov_b32 s31, 16384
    buffer_load_dwordx4 v11, s[24:27], s31 offen nt lds
    s_add_u32 m0, s74, 2048
    s_mov_b32 s31, 32768
    buffer_load_dwordx4 v6, s[24:27], s31 offen nt lds
    s_add_u32 m0, s74, 3072
    s_mov_b32 s31, 49152
    buffer_load_dwordx4 v11, s[24:27], s31 offen nt lds
    s_add_u32 m0, s74, 4096
    s_mov_b32 s31, 65536
    buffer_load_dwordx4 v6, s[24:27], s31 offen nt lds
L_xs_ok:
    s_waitcnt lgkmcnt(3)
    v_mfma_f32_16x16x32_bf16 v[132:135], v[20:23], v[36:39], 0
    v_mfma_f32_16x16x32_bf16 v[136:139], v[20:23], v[40:43], 0
    v_mfma_f32_16x16x32_bf16 v[140:143], v[20:23], v[44:47], 0
    v_mfma_f32_16x16x32_bf16 v[144:147], v[20:23], v[48:51], 0
    s_waitcnt lgkmcnt(2)
    v_mfma_f32_16x16x32_bf16 v[132:135], v[24:27], v[52:55], v[132:135]
    v_mfma_f32_16x16x32_bf16 v[136:139], v[24:27], v[56:59], v[136:139]
    v_mfma_f32_16x16x32_bf16 v[140:143], v[24:27], v[60:63], v[140:143]
    v_mfma_f32_16x16x32_bf16 v[144:147], v[24:27], v[64:67], v[144:147]
    s_waitcnt lgkmcnt(1)
    v_mfma_f32_16x16x32_bf16 v[132:135], v[28:31], v[68:71], v[132:135]
    v_mfma_f32_16x16x32_bf16 v[136:139], v[28:31], v[72:75], v[136:139]
    v_mfma_f32_16x16x32_bf16 v[140:143], v[28:31], v[76:79], v[140:143]
    v_mfma_f32_16x16x32_bf16 v[144:147], v[28:31], v[80:83], v[144:147]
    v_readfirstlane_b32 s33, v19
    v_readfirstlane_b32 s34, v18
    s_waitcnt lgkmcnt(0)
    v_mfma_f32_16x16x32_bf16 v[132:135], v[32:35], v[84:87], v[132:135]
    v_mfma_f32_16x16x32_bf16 v[136:139], v[32:35], v[88:91], v[136:139]
    v_mfma_f32_16x16x32_bf16 v[140:143], v[32:35], v[92:95], v[140:143]
    v_mfma_f32_16x16x32_bf16 v[144:147], v[32:35], v[96:99], v[144:147]
    s_mov_b32 vcc_lo, 0xffff0000
    s_mov_b32 vcc_hi, 0
    s_lshl_b32 s31, s50, 12
    s_lshl_b32 s32, s30, 7
    s_add_u32 s31, s31, s32
    s_add_u32 s31, s31, 262144
    v_lshrrev_b32 v15, 3, v2
    v_lshlrev_b32 v15, 9, v15
    v_add3_u32 v15, v15, v7, s31
    v_cndmask_b32 v26, v132, v136, vcc
    v_cndmask_b32 v27, v140, v144, vcc
    v_and_or_b32 v26, v26, s49, v14
    v_and_or_b32 v27, v27, s49, v14
    s_mov_b32 exec_hi, 0
    buffer_store_dwordx2 v[26:27], v13, s[12:15], 0 offen sc1
    s_mov_b64 exec, -1
    s_add_u32 m0, s74, 5120
    s_mov_b32 s31, 81920
    buffer_load_dwordx4 v11, s[24:27], s31 offen nt lds
    s_add_u32 m0, s74, 6144
    s_mov_b32 s31, 98304
    buffer_load_dwordx4 v6, s[24:27], s31 offen nt lds
    s_add_u32 m0, s74, 7168
    s_mov_b32 s31, 114688
    buffer_load_dwordx4 v11, s[24:27], s31 offen nt lds
L_d_done:
    s_mov_b64 exec, 1
    ds_add_u32 v0, v255 offset:42848
    s_mov_b64 exec, -1
    s_cmp_eq_u32 s30, 1
    s_cselect_b32 s31, s2, 0
    s_cmp_lt_u32 s31, 192
    s_cbranch_scc1 L_no_hint
    s_and_b32 s31, s2, 31
    s_lshl_b32 s31, s31, 7
    s_add_u32 s31, s31, 12288
    v_mov_b32 v250, s28
    v_mov_b32 v251, s29
    s_mov_b64 exec, 1
    buffer_store_dwordx2 v[250:251], v0, s[12:15], s31 offen sc1
    s_mov_b64 exec, -1
L_no_hint:
    s_setprio 3
    v_and_b32 v16, 7, v2
    v_lshlrev_b32 v16, 2, v16
    v_lshrrev_b32 v17, 5, v2
    v_lshl_add_u32 v16, v17, 1, v16
    s_lshl_b32 s31, s30, 5
    v_add_u32 v16, s31, v16
    v_and_b32 v17, 48, v2
    v_bfe_u32 v9, v2, 3, 2
    v_lshlrev_b32 v9, 5, v9
    v_bfe_u32 v10, v2, 2, 2
    v_lshl_add_u32 v9, v10, 7, v9
    v_lshl_add_u32 v9, v17, 6, v9
    v_and_b32 v10, 3, v2
    v_lshlrev_b32 v10, 3, v10
    v_add3_u32 v9, v9, v10, s74
    v_xor_b32 v10, 32, v9
    v_xor_b32 v12, 96, v9
    v_xor_b32 v8, 64, v9
    s_lshl_b32 s31, s50, 12
    s_lshl_b32 s32, s51, 8
    s_add_u32 s31, s31, s32
    s_add_u32 s31, s31, 524288
    v_lshl_add_u32 v18, v2, 2, s31
    s_waitcnt vmcnt(5)
    s_waitcnt lgkmcnt(4)
    ds_read_b64_tr_b16 v[100:101], v9 offset:0
    ds_read_b64_tr_b16 v[102:103], v9 offset:512
    ds_read_b64_tr_b16 v[104:105], v10 offset:0
    ds_read_b64_tr_b16 v[106:107], v10 offset:512
    ds_read_b64_tr_b16 v[108:109], v8 offset:0
    ds_read_b64_tr_b16 v[110:111], v8 offset:512
    ds_read_b64_tr_b16 v[112:113], v12 offset:0
    ds_read_b64_tr_b16 v[114:115], v12 offset:512
    s_waitcnt vmcnt(0)
    buffer_load_dwordx4 v[20:23], v15, s[12:15], 0 offen sc1
    s_waitcnt lgkmcnt(4)
    ds_read_b64_tr_b16 v[116:117], v9 offset:4096
    ds_read_b64_tr_b16 v[118:119], v9 offset:4608
    ds_read_b64_tr_b16 v[120:121], v10 offset:4096
    ds_read_b64_tr_b16 v[122:123], v10 offset:4608
    ds_read_b64_tr_b16 v[124:125], v8 offset:4096
    ds_read_b64_tr_b16 v[126:127], v8 offset:4608
    ds_read_b64_tr_b16 v[128:129], v12 offset:4096
    ds_read_b64_tr_b16 v[130:131], v12 offset:4608
    s_mov_b32 s54, 0
    s_branch L_hp_wait
L_hp_poll:
    buffer_load_dwordx4 v[20:23], v15, s[12:15], 0 offen sc1
L_hp_wait:
    s_waitcnt vmcnt(0)
    v_xor_b32 v20, v14, v20
    v_xor_b32 v21, v14, v21
    v_xor_b32 v22, v14, v22
    v_xor_b32 v23, v14, v23
    v_or3_b32 v24, v20, v21, v22
    v_or_b32 v24, v24, v23
    v_and_b32 v24, 0xff, v24
    v_cmp_ne_u32 vcc, 0, v24
    v_permlane16_swap_b32 v20, v21
    v_permlane16_swap_b32 v22, v23
    s_cbranch_vccz L_hp_got
    s_cmp_eq_u32 s35, 0
    s_cbranch_scc1 L_hp_got
    s_sub_u32 s35, s35, 1
    s_branch L_hp_poll
L_hp_got:
    v_add_f32 v20, v20, v21
    v_add_f32 v22, v22, v23
    s_nop 1
    v_permlane32_swap_b32 v20, v22
    v_add_f32 v20, v20, v22
    s_nop 1
    v_add_f32_dpp v21, v20, v20 row_ror:8 row_mask:0xf bank_mask:0xf
    v_add_f32_dpp v20, v20, v20 row_ror:8 row_mask:0xf bank_mask:0xf
    s_nop 1
    v_permlane16_swap_b32 v20, v21
    v_cvt_pk_bf16_f32 v20, v20, v21
    v_and_b32 v21, 0xffff0000, v20
    v_lshlrev_b32 v20, 16, v20
    v_mul_f32 v22, 0xbfb8aa3b, v20
    v_exp_f32 v22, v22
    s_nop 0
    v_add_f32 v22, 1.0, v22
    v_rcp_f32 v22, v22
    s_nop 0
    v_mul_f32 v20, v20, v22
    v_cvt_pk_bf16_f32 v20, v20, v20
    v_lshlrev_b32 v20, 16, v20
    v_mul_f32 v20, v20, v21
    v_cvt_pk_bf16_f32 v20, v20, v20
    ds_write_b16 v16, v20 offset:42368
    s_mov_b64 exec, 1
    ds_add_u32 v0, v255 offset:42852
    s_mov_b64 exec, -1
L_sync17:
    ds_read_b32 v1, v0 offset:42852
    ds_read_b128 v[28:31], v17 offset:42368
    ds_read_b128 v[32:35], v17 offset:42432
    s_add_u32 s92, s92, 1
    s_bitcmp1_b32 s92, 20
    s_cbranch_scc1 L_sync17x
    s_waitcnt lgkmcnt(2)
    v_readfirstlane_b32 s31, v1
    s_nop 0
    s_cmp_ge_u32 s31, 4
    s_cbranch_scc0 L_sync17
L_sync17x:
    s_waitcnt lgkmcnt(1)
    v_mfma_f32_16x16x32_bf16 v[36:39], v[28:31], v[100:103], 0
    v_mfma_f32_16x16x32_bf16 v[40:43], v[28:31], v[104:107], 0
    v_mfma_f32_16x16x32_bf16 v[44:47], v[28:31], v[108:111], 0
    v_mfma_f32_16x16x32_bf16 v[48:51], v[28:31], v[112:115], 0
    s_waitcnt lgkmcnt(0)
    v_mfma_f32_16x16x32_bf16 v[36:39], v[32:35], v[116:119], v[36:39]
    v_mfma_f32_16x16x32_bf16 v[40:43], v[32:35], v[120:123], v[40:43]
    v_mfma_f32_16x16x32_bf16 v[44:47], v[32:35], v[124:127], v[44:47]
    v_mfma_f32_16x16x32_bf16 v[48:51], v[32:35], v[128:131], v[48:51]
    s_mov_b32 vcc_lo, 0xffff0000
    s_mov_b32 vcc_hi, 0xffff0000
    s_mov_b32 s52, 0
    s_mov_b32 s53, -1
    s_nop 1
    v_cndmask_b32 v36, v36, v40, vcc
    s_nop 0
    v_cndmask_b32 v44, v44, v48, vcc
    v_cndmask_b32 v36, v36, v44, s[52:53]
    v_and_or_b32 v36, v36, s49, v14
    buffer_store_dword v36, v18, s[12:15], 0 offen sc1
    s_mov_b64 exec, 1
    ds_add_u32 v0, v255 offset:42856
    s_mov_b64 exec, -1
    s_branch L_owner
L_idle:
    s_mov_b64 exec, 1
    ds_add_u32 v0, v255 offset:42868
    s_mov_b64 exec, -1
    s_and_b32 s52, s2, 31
    s_lshl_b32 s52, s52, 7
    s_add_u32 s52, s52, 12288
L_hint:
    s_load_dwordx2 s[54:55], s[12:13], s52 glc
    s_waitcnt lgkmcnt(0)
    s_cmp_eq_u64 s[54:55], s[28:29]
    s_cbranch_scc1 L_hint_ok
    s_cmp_eq_u32 s35, 0
    s_cbranch_scc1 L_hint_ok
    s_sub_u32 s35, s35, 1
    s_sleep 4
    s_branch L_hint
L_hint_ok:
    s_mov_b64 exec, 1
    ds_add_u32 v0, v255 offset:42848
    s_mov_b64 exec, -1
    s_mov_b64 exec, 1
    ds_add_u32 v0, v255 offset:42852
    s_mov_b64 exec, -1
    s_mov_b64 exec, 1
    ds_add_u32 v0, v255 offset:42856
    s_mov_b64 exec, -1
L_idle_done:
    s_waitcnt lgkmcnt(0)
    v_readfirstlane_b32 s33, v19
    v_readfirstlane_b32 s34, v18
L_owner:
    s_setprio 1
    s_and_b32 s31, s2, 7
    s_sub_u32 s32, 8, s31
    s_min_u32 s46, s31, s32
    s_lshr_b32 s53, s31, 2
    s_lshr_b32 s47, s2, 3
    s_and_b32 s32, s47, 1
    s_and_b32 s31, s31, 3
    s_cselect_b32 s53, s53, s32
    s_cselect_b32 s31, 0, 1
    s_lshr_b32 s47, s47, s31
    s_lshl_b32 s53, s53, 4
    s_lshl_b32 s53, s53, 3
    s_add_u32 s53, s53, s46
    s_andn2_b32 s51, 0x7ff, s33
    s_mov_b32 s54, s51
    s_mov_b32 s55, 0
    s_mov_b32 s56, 0
    s_mov_b32 s16, s44
    s_mov_b32 s17, s45
    s_mov_b32 s18, 0x400000
    v_and_b32 v8, 31, v2
    v_lshlrev_b32 v15, 2, v8
    v_lshlrev_b32 v8, 1, v8
    v_mov_b32 v16, 0
L_seg:
    s_xor_b32 s31, s54, s53
    s_and_b32 s31, s31, 0x87
    s_cbranch_scc1 L_seg_next
    s_lshl_b32 s31, s51, 11
    s_lshl_b32 s32, s47, 6
    s_add_u32 s63, s31, s32
    buffer_load_ushort v9, v8, s[8:11], s63 offen
    v_lshrrev_b32 v4, 3, v2
    s_lshl_b32 s31, s30, 4
    v_add_u32 v4, s31, v4
    v_lshlrev_b32 v4, 12, v4
    s_lshl_b32 s31, s47, 7
    s_add_u32 s31, s31, 524288
    v_add3_u32 v4, v4, v7, s31
    s_mov_b32 s62, 32768
    v_mov_b32 v24, v14
    v_mov_b32 v25, v14
    v_mov_b32 v26, v14
    v_mov_b32 v27, v14
    v_lshrrev_b32 v5, 4, v2
    v_lshl_add_u32 v6, v5, 2, v7
    s_lshl_b32 s31, s30, 7
    s_add_u32 s31, s31, s55
    v_add_u32 v6, s31, v6
    s_ashr_i32 s31, s33, 31
    s_orn2_b32 s31, 0x80000000, s31
    s_xor_b32 s31, s31, s33
    s_and_b32 s31, s31, 0xfffff800
    v_cvt_pk_bf16_f32 v11, s31, s31
    v_lshlrev_b32 v11, 16, v11
    v_mul_f32 v11, 0xbfb8aa3b, v11
    v_exp_f32 v11, v11
    s_and_b32 s32, s34, 0xffff0000
    v_add_f32 v11, 1.0, v11
    v_rcp_f32 v11, v11
    v_rcp_f32 v12, s32
    v_cvt_pk_bf16_f32 v11, v11, v11
    v_lshlrev_b32 v11, 16, v11
    s_lshl_b32 s31, s34, 16
    s_waitcnt vmcnt(0)
    v_lshl_add_u32 v13, v8, 1, s55
    s_mov_b64 vcc, -1
    s_mov_b32 s56, 1
L_y_poll:
    s_mov_b64 exec, vcc
    buffer_load_dwordx4 v[20:23], v4, s[12:15], 0 offen sc1
    s_cmp_eq_u32 s30, 3
    s_cbranch_scc1 L_y_one
    buffer_load_dwordx4 v[24:27], v4, s[12:15], s62 offen sc1
L_y_one:
    s_mov_b64 exec, -1
    s_waitcnt vmcnt(0)
    v_xor_b32 v28, v14, v20
    v_xor_b32 v29, v14, v21
    v_xor_b32 v30, v14, v22
    v_xor_b32 v31, v14, v23
    v_xor_b32 v32, v14, v24
    v_xor_b32 v33, v14, v25
    v_xor_b32 v34, v14, v26
    v_xor_b32 v35, v14, v27
    v_or3_b32 v1, v28, v29, v30
    v_or3_b32 v1, v1, v31, v32
    v_or3_b32 v1, v1, v33, v34
    v_or_b32 v1, v1, v35
    v_and_b32 v1, 0xff, v1
    v_cmp_ne_u32 vcc, 0, v1
    v_pk_add_f32 v[28:29], v[28:29], v[32:33]
    v_pk_add_f32 v[30:31], v[30:31], v[34:35]
    s_cbranch_vccz L_y_got
    s_cmp_eq_u32 s35, 0
    s_cbranch_scc1 L_y_got
    s_sub_u32 s35, s35, 1
    s_branch L_y_poll
L_y_got:
    v_permlane16_swap_b32 v28, v29
    v_permlane16_swap_b32 v30, v31
    v_add_f32 v28, v28, v29
    v_add_f32 v30, v30, v31
    s_nop 1
    v_permlane32_swap_b32 v28, v30
    v_add_f32 v28, v28, v30
    s_nop 1
    v_add_f32_dpp v28, v28, v28 row_ror:8 row_mask:0xf bank_mask:0xf
    ds_write_b32 v6, v28 offset:43008
    s_mov_b64 exec, 1
    ds_add_u32 v16, v255 offset:42836
    s_mov_b64 exec, -1
    s_cmp_lg_u32 s30, 0
    s_cbranch_scc1 L_seg_next
    s_cmp_eq_u32 s47, 0
    s_cselect_b32 s32, 0, 2147483392
    v_mov_b32 v5, 2147483392
    v_writelane_b32 v5, s32, 0
    v_mov_b32 v18, s28
    v_mov_b32 v19, s29
    s_lshl_b32 s31, s34, 16
    v_lshlrev_b32 v9, 16, v9
    v_subrev_f32 v10, s31, v9
    v_cvt_pk_bf16_f32 v10, v10, v10
    v_lshlrev_b32 v10, 16, v10
    v_mul_f32 v10, v10, v12
    v_cvt_pk_bf16_f32 v10, v10, v10
    v_lshlrev_b32 v10, 16, v10
L_sync18:
    ds_read_b32 v1, v16 offset:42836
    ds_read_b32 v20, v13 offset:43008
    ds_read_b32 v21, v13 offset:43136
    ds_read_b32 v22, v13 offset:43264
    ds_read_b32 v23, v13 offset:43392
    ds_read_b32 v24, v15 offset:42496
    s_add_u32 s92, s92, 1
    s_bitcmp1_b32 s92, 20
    s_cbranch_scc1 L_sync18x
    s_waitcnt lgkmcnt(5)
    v_readfirstlane_b32 s31, v1
    s_nop 0
    s_cmp_ge_u32 s31, 5
    s_cbranch_scc0 L_sync18
L_sync18x:
    s_waitcnt lgkmcnt(0)
    v_add_f32 v20, v20, v21
    v_add_f32 v22, v22, v23
    v_add_f32 v20, v20, v22
    v_cvt_pk_bf16_f32 v20, v20, v20
    v_lshlrev_b32 v20, 16, v20
    v_mul_f32 v20, v20, v11
    v_cvt_pk_bf16_f32 v20, v20, v20
    v_lshlrev_b32 v20, 16, v20
    v_add_f32 v20, v20, v10
    v_cvt_pk_bf16_f32 v20, v20, v20
    v_lshlrev_b32 v20, 16, v20
    v_mul_f32 v1, 0xbfb8aa3b, v20
    v_mul_f32 v20, v1, v24
    v_exp_f32 v1, v1
    s_nop 0
    v_add_f32 v1, 1.0, v1
    v_rcp_f32 v1, v1
    s_mov_b32 exec_hi, 0
    v_fma_f32 v20, v20, v1, v9
    v_cvt_pk_bf16_f32 v20, v20, v20
    buffer_store_short v20, v8, s[16:19], s63 offen sc1
    buffer_store_dwordx2 v[18:19], v5, s[12:15], 0 offen sc1
    s_mov_b64 exec, -1
L_seg_next:
    s_cmp_lg_u32 s55, 0
    s_cbranch_scc1 L_seg_end
    s_mov_b32 s55, 512
    s_sub_u32 s54, 0, s51
    s_sub_u32 s47, 31, s47
    v_mov_b32 v16, 28
    v_and_b32 v15, 24, v2
    v_xor_b32 v15, 24, v15
    v_sub_u32 v1, 0, v2
    v_and_b32 v1, 7, v1
    v_add_u32 v15, v15, v1
    v_lshlrev_b32 v15, 2, v15
    v_add_u32 v15, 128, v15
    s_branch L_seg
L_seg_end:
L_fin:
L_exit:
    s_endpgm
L_code_end:
.section .rodata,"a"
.p2align 6
.amdhsa_kernel recurrent_scan__spectral_fnet__moe_arch_mod__prompt_kernel
  .amdhsa_next_free_vgpr 256
  .amdhsa_next_free_sgpr 94
  .amdhsa_accum_offset 256
  .amdhsa_group_segment_fixed_size 0
  .amdhsa_kernarg_size 104
  .amdhsa_user_sgpr_count 2
  .amdhsa_user_sgpr_kernarg_segment_ptr 1
  .amdhsa_system_sgpr_workgroup_id_x 1
  .amdhsa_float_denorm_mode_32 3
.end_amdhsa_kernel
```

```asm
; @launch grid=(256,1,1) block=(512,1,1) lds=158720
.amdgcn_target "amdgcn-amd-amdhsa--gfx950"
.text
.globl recurrent_scan__spectral_fnet__moe_arch_mod__prompt_kernel
.p2align 8
.type recurrent_scan__spectral_fnet__moe_arch_mod__prompt_kernel,@function
recurrent_scan__spectral_fnet__moe_arch_mod__prompt_kernel:
    s_cmp_ge_u32 s2, 256
    s_cbranch_scc1 L_exit
    s_load_dwordx2 s[8:9], s[0:1], 0
    s_load_dwordx4 s[36:39], s[0:1], 48
    s_load_dwordx2 s[12:13], s[0:1], 96
    s_getpc_b64 s[32:33]
L_pc:
    s_bfe_u32 s31, s2, 0x30003
    v_subrev_u32 v3, 492, v0
    v_lshl_add_u32 v3, v3, 3, s31
    v_lshlrev_b32 v3, 7, v3
    v_cmp_gt_u32 vcc, L_code_end-L_pc, v3
    s_nop 0
    s_and_saveexec_b64 s[46:47], vcc
    s_cbranch_execz L_nopf
    global_load_dword v254, v3, s[32:33]
L_nopf:
    s_mov_b64 exec, -1
    v_lshrrev_b32 v1, 6, v0
    v_and_b32 v2, 63, v0
    v_readfirstlane_b32 s30, v1
    s_mov_b32 s10, 0x400000
    s_mov_b32 s11, 0x00020000
    s_mov_b32 s14, 0x10000000
    s_mov_b32 s15, 0x00020000
    s_mov_b32 s35, 65536
    s_mov_b32 s92, 0
    v_lshlrev_b32 v3, 4, v2
    v_mov_b32 v0, 0
    s_mov_b32 s3, s30
    s_and_b32 s30, s30, 3
    v_mov_b32 v255, 1
    s_cmp_ge_u32 s3, 4
    s_cbranch_scc1 L_moe
    s_and_b32 s31, s2, 7
    s_lshr_b32 s32, s2, 4
    s_sub_u32 s32, 15, s32
    s_lshl_b32 s32, s32, 3
    s_add_u32 s46, s32, s31
    s_bfe_u32 s47, s2, 0x10003
    s_lshl_b32 s31, s47, 2
    s_add_u32 s51, s31, s30
    s_lshl_b32 s31, s51, 8
    s_add_u32 s52, s31, s46
    s_xor_b32 s54, s52, 1024
    s_sub_u32 s53, 2048, s52
    s_add_u32 s31, s52, 128
    s_cmp_eq_u32 s46, 0
    s_cselect_b32 s53, s31, s53
    s_cselect_b32 s50, 1, 0
    s_xor_b32 s55, s53, 1024
    s_lshl_b32 s56, s52, 11
    s_lshl_b32 s57, s53, 11
    s_lshl_b32 s58, s54, 11
    s_lshl_b32 s59, s55, 11
    s_mov_b32 s22, 2048
    s_mov_b32 s23, 0x00020000
    v_mov_b32 v1, 0
    v_and_b32 v6, 15, v2
    v_lshlrev_b32 v6, 2, v6
    ds_write_b64 v0, v[0:1] offset:41504
    ds_write_b32 v6, v0 offset:42816
    s_waitcnt lgkmcnt(0)
    s_load_dwordx2 s[28:29], s[12:13], 0
    s_load_dwordx2 s[16:17], s[0:1], 80
    buffer_load_dwordx4 v[120:123], v3, s[8:11], s56 offen
    buffer_load_dwordx4 v[124:127], v3, s[8:11], s56 offen offset:1024
    buffer_load_dwordx4 v[128:131], v3, s[8:11], s57 offen
    buffer_load_dwordx4 v[132:135], v3, s[8:11], s57 offen offset:1024
    s_mov_b32 s20, s36
    s_mov_b32 s21, s37
    buffer_load_dwordx4 v[152:155], v3, s[20:23], 0 offen
    buffer_load_dwordx4 v[156:159], v3, s[20:23], 0 offen offset:1024
    buffer_load_dwordx4 v[136:139], v3, s[8:11], s58 offen
    buffer_load_dwordx4 v[140:143], v3, s[8:11], s58 offen offset:1024
    buffer_load_dwordx4 v[144:147], v3, s[8:11], s59 offen
    buffer_load_dwordx4 v[148:151], v3, s[8:11], s59 offen offset:1024
    s_barrier
    s_branch L_dft_rest
L_moe:
    s_load_dwordx2 s[20:21], s[0:1], 64
    s_and_b32 s32, s2, 7
    s_mul_i32 s32, s32, 28
    s_lshr_b32 s31, s2, 3
    s_add_u32 s31, s31, s32
    s_lshr_b32 s46, s31, 3
    s_lshl_b32 s46, s46, 1
    s_and_b32 s47, s31, 7
    s_mov_b32 s75, 0
    s_mov_b32 s18, 7340032
    s_mov_b32 s19, 0x00020000
    s_mov_b32 s22, 7340032
    s_mov_b32 s23, 0x00020000
    s_mov_b32 s26, 7340032
    s_mov_b32 s27, 0x00020000
    v_lshrrev_b32 v4, 4, v2
    v_lshlrev_b32 v5, 5, v4
    v_and_b32 v6, 0x70, v3
    v_xor_b32 v5, v5, v6
    v_mul_u32_u24 v4, 7168, v4
    s_mul_i32 s31, s47, 917504
    s_lshl_b32 s32, s46, 7
    s_add_u32 s31, s31, s32
    v_add3_u32 v4, v4, v5, s31
    s_cmp_eq_u32 s75, 0
    s_mov_b32 s31, 917504
    s_cselect_b32 s31, 128, s31
    v_add_u32 v6, s31, v4
    s_mov_b32 vcc_lo, 0xff00ff00
    s_mov_b32 vcc_hi, 0xff00ff00
    v_cndmask_b32 v5, v6, v4, vcc
    v_cndmask_b32 v4, v4, v6, vcc
    s_mov_b32 s48, 0
    s_mov_b32 s49, 76800
    s_waitcnt lgkmcnt(0)
    s_mov_b32 s16, s38
    s_mov_b32 s17, s39
    s_load_dwordx2 s[28:29], s[12:13], 0
    s_load_dwordx2 s[24:25], s[0:1], 72
    s_load_dwordx2 s[44:45], s[0:1], 80
    s_barrier
    s_cmp_ge_u32 s2, 224
    s_cselect_b32 s66, 0, 1
    s_cbranch_scc1 L_dma_done
    s_cmp_lg_u32 s30, 0
    s_cbranch_scc1 L_dma_done
    s_setprio 3
L_dma0:
    s_mov_b32 m0, s49
    s_waitcnt vmcnt(20)
    buffer_load_dwordx4 v4, s[16:19], s48 offen nt lds
    s_add_u32 m0, s49, 32768
    s_add_u32 s49, s49, 1024
    s_waitcnt vmcnt(20)
    buffer_load_dwordx4 v4, s[20:23], s48 offen nt lds
    s_add_u32 s48, s48, 28672
    s_mov_b32 m0, s49
    s_waitcnt vmcnt(20)
    buffer_load_dwordx4 v4, s[16:19], s48 offen nt lds
    s_add_u32 m0, s49, 32768
    s_add_u32 s49, s49, 1024
    s_waitcnt vmcnt(20)
    buffer_load_dwordx4 v4, s[20:23], s48 offen nt lds
    s_add_u32 s48, s48, 28672
    v_swap_b32 v4, v5
    s_cmp_lt_u32 s48, 917504
    s_cbranch_scc1 L_dma0
    s_branch L_dma_done
L_dft_rest:
    s_mov_b32 s18, 0x400000
    s_mov_b32 s19, 0x00020000
    s_sub_u32 s31, 2047, s52
    s_sub_u32 s32, 2047, s53
    v_mov_b32 v200, s31
    v_writelane_b32 v200, s32, 63
    s_lshl_b32 s31, s30, 2
    v_mov_b32 v201, s31
    s_bfe_u32 s31, s53, 0x20008
    s_lshl_b32 s31, s31, 2
    s_add_u32 s31, s31, 16
    v_writelane_b32 v201, s31, 63
    v_and_b32 v6, 32, v2
    s_lshl_b32 s31, s51, 2
    v_add_u32 v203, s31, v6
    v_lshrrev_b32 v202, 1, v203
    s_and_b32 s31, s2, 7
    s_lshl_b32 s31, s31, 9
    s_lshr_b32 s32, s2, 3
    s_lshl_b32 s32, s32, 4
    s_add_u32 s31, s31, s32
    s_add_u32 s31, s31, 4096
    v_mov_b32 v4, s31
    v_lshlrev_b32 v5, 3, v2
    s_and_b32 s31, s52, 7
    s_lshl_b32 s31, s31, 11
    s_and_b32 s32, s52, 1024
    s_add_u32 s31, s31, s32
    s_and_b32 s32, s52, 0xf8
    s_lshl_b32 s32, s32, 2
    s_add_u32 s31, s31, s32
    s_add_u32 s31, s31, 32768
    v_writelane_b32 v4, s31, 0
    s_add_u32 s31, s31, 16
    v_writelane_b32 v4, s31, 1
    s_and_b32 s31, s53, 7
    s_lshl_b32 s31, s31, 11
    s_and_b32 s32, s53, 1024
    s_add_u32 s31, s31, s32
    s_and_b32 s32, s53, 0xf8
    s_lshl_b32 s32, s32, 2
    s_add_u32 s31, s31, s32
    s_add_u32 s31, s31, 32768
    v_writelane_b32 v4, s31, 2
    s_add_u32 s31, s31, 16
    v_writelane_b32 v4, s31, 3
    s_mul_i32 s31, s51, 2592
    v_and_b32 v204, 32, v2
    v_lshlrev_b32 v204, 2, v204
    v_add3_u32 v204, v204, v3, s31
    s_lshl_b32 s32, s31, 1
    s_add_u32 s32, s32, 21872
    v_sub_u32 v205, s32, v204
    v_bfe_u32 v206, v2, 2, 2
    v_mul_u32_u24 v206, 2592, v206
    v_lshrrev_b32 v6, 4, v2
    v_mul_u32_u24 v7, 640, v6
    v_add_u32 v206, v206, v7
    v_and_b32 v7, 3, v2
    v_lshlrev_b32 v7, 3, v7
    s_lshl_b32 s31, s30, 7
    v_add3_u32 v206, v206, v7, s31
    v_lshlrev_b32 v6, 12, v6
    v_and_b32 v7, 15, v2
    v_lshl_add_u32 v6, v7, 4, v6
    s_lshl_b32 s31, s30, 8
    v_add_u32 v207, s31, v6
    v_bfe_i32 v208, v2, 4, 1
    v_and_b32 v208, 0x80008000, v208
    s_cmp_eq_u32 s47, 0
    s_movk_i32 s48, 0x7403
    s_cselect_b32 s48, 0x7721, s48
    v_and_b32 v250, 12, v2
    v_bfe_u32 v250, s48, v250, 4
    v_lshrrev_b32 v251, 4, v2
    v_bfe_u32 v252, v2, 1, 1
    v_mul_u32_u24 v251, v251, v252
    v_and_b32 v252, 1, v2
    v_add_u32 v251, v251, v252
    v_cvt_f32_u32 v250, v250
    v_cvt_f32_u32 v251, v251
    v_mul_f32 v250, 0x3e000000, v250
    v_mul_f32 v251, 0x3e800000, v251
    v_cos_f32 v8, v251
    v_add_f32 v251, v251, v250
    v_cos_f32 v9, v251
    v_add_f32 v251, v251, v250
    v_cos_f32 v10, v251
    v_add_f32 v251, v251, v250
    v_cos_f32 v11, v251
    v_add_f32 v251, v251, v250
    v_cos_f32 v12, v251
    v_add_f32 v251, v251, v250
    v_cos_f32 v13, v251
    v_add_f32 v251, v251, v250
    v_cos_f32 v14, v251
    v_add_f32 v251, v251, v250
    v_cos_f32 v15, v251
    v_mul_f32 v8, 0xbf317218, v8
    v_mul_f32 v9, 0xbf317218, v9
    v_mul_f32 v10, 0xbf317218, v10
    v_mul_f32 v11, 0xbf317218, v11
    v_mul_f32 v12, 0xbf317218, v12
    v_mul_f32 v13, 0xbf317218, v13
    v_mul_f32 v14, 0xbf317218, v14
    v_mul_f32 v15, 0xbf317218, v15
    v_lshrrev_b32 v250, 2, v2
    v_and_b32 v250, 12, v250
    v_and_b32 v251, 15, v2
    v_lshlrev_b32 v251, 2, v251
    v_cvt_f32_u32 v250, v250
    v_cvt_f32_u32 v251, v251
    v_mul_f32 v212, 0x3c800000, v250
    s_lshl_b32 s31, s30, 2
    s_lshr_b32 s48, s48, s31
    s_and_b32 s48, s48, 15
    s_sub_u32 s31, s48, 4
    s_mul_i32 s31, s31, s46
    v_cvt_f32_i32 v252, s31
    v_mul_f32 v252, 0x3a000000, v252
    v_add_f32 v213, 0x3c800000, v212
    v_add_f32 v214, 0x3d000000, v212
    v_add_f32 v215, 0x3d400000, v212
    s_and_b32 s31, s2, 7
    s_sub_u32 s32, 8, s31
    s_min_u32 s76, s31, s32
    s_lshr_b32 s78, s31, 2
    s_lshr_b32 s77, s2, 3
    s_and_b32 s32, s77, 1
    s_and_b32 s31, s31, 3
    s_cselect_b32 s78, s78, s32
    s_cselect_b32 s31, 0, 1
    s_lshr_b32 s77, s77, s31
    s_lshl_b32 s78, s78, 4
    s_lshl_b32 s31, s30, 5
    s_add_u32 s78, s78, s31
    s_lshl_b32 s78, s78, 3
    s_add_u32 s78, s78, s76
    s_lshl_b32 s77, s77, 6
    s_sub_u32 s79, 1984, s77
    s_lshl_b32 s76, s76, 1
    s_add_u32 s76, s76, 2040
    v_and_b32 v116, 15, v2
    v_lshl_add_u32 v116, v116, 3, s78
    v_and_b32 v7, 32, v2
    v_lshl_add_u32 v7, v7, 5, v116
    s_mov_b32 vcc_lo, 0xffff0000
    s_mov_b32 vcc_hi, 0xffff0000
    v_sub_u32 v6, 0, v7
    v_cndmask_b32 v7, v7, v6, vcc
    v_and_b32 v6, 7, v7
    v_and_b32 v1, 1024, v7
    v_lshl_add_u32 v6, v6, 11, v1
    v_and_b32 v1, 0xf8, v7
    v_lshl_add_u32 v6, v1, 2, v6
    v_bfe_u32 v1, v7, 9, 1
    v_lshl_add_u32 v119, v1, 4, v6
    v_and_b32 v1, 256, v7
    v_cmp_ne_u32 s[88:89], 0, v1
    v_lshrrev_b32 v118, 2, v2
    v_lshl_add_u32 v118, v118, 3, s78
    v_lshlrev_b32 v1, 1, v2
    v_xor_b32 v1, v1, v3
    v_and_b32 v1, 48, v1
    v_add_u32 v114, 1024, v118
    v_sub_u32 v113, 0, v118
    v_and_b32 v113, 2047, v113
    v_sub_u32 v115, 2048, v114
    v_add_u32 v112, s77, v1
    v_lshl_add_u32 v114, v114, 11, v112
    v_lshl_add_u32 v112, v118, 11, v112
    v_xor_b32 v1, 48, v1
    v_add_u32 v1, s79, v1
    v_lshl_add_u32 v113, v113, 11, v1
    v_lshl_add_u32 v115, v115, 11, v1
    s_lshl_b32 s76, s30, 12
    s_add_u32 s76, s76, 44032
    v_and_b32 v1, 15, v2
    v_lshlrev_b32 v6, 6, v1
    v_lshlrev_b32 v1, 3, v2
    v_xor_b32 v1, v1, v2
    v_and_b32 v1, 48, v1
    v_add3_u32 v117, v6, v1, s76
    v_mul_f32 v250, v212, v251
    v_fmamk_f32 v52, v250, 0x3d800000, v252
    v_sin_f32 v20, v250
    v_cos_f32 v250, v250
    v_cos_f32 v48, v52
    v_sin_f32 v52, v52
    v_cvt_pk_f16_f32 v16, v250, v20
    v_cvt_pk_f16_f32 v20, -v20, v250
    v_mul_f32 v250, v213, v251
    v_fmamk_f32 v53, v250, 0x3d800000, v252
    v_sin_f32 v21, v250
    v_cos_f32 v250, v250
    v_cos_f32 v49, v53
    v_sin_f32 v53, v53
    v_cvt_pk_f16_f32 v17, v250, v21
    v_cvt_pk_f16_f32 v21, -v21, v250
    v_mul_f32 v250, v214, v251
    v_fmamk_f32 v54, v250, 0x3d800000, v252
    v_sin_f32 v22, v250
    v_cos_f32 v250, v250
    v_cos_f32 v50, v54
    v_sin_f32 v54, v54
    v_cvt_pk_f16_f32 v18, v250, v22
    v_cvt_pk_f16_f32 v22, -v22, v250
    v_mul_f32 v250, v215, v251
    v_fmamk_f32 v55, v250, 0x3d800000, v252
    v_sin_f32 v23, v250
    v_cos_f32 v250, v250
    v_cos_f32 v51, v55
    v_sin_f32 v55, v55
    v_cvt_pk_f16_f32 v19, v250, v23
    v_cvt_pk_f16_f32 v23, -v23, v250
    v_add_f32 v251, 1.0, v251
    v_mul_f32 v250, v212, v251
    v_fmamk_f32 v60, v250, 0x3d800000, v252
    v_sin_f32 v28, v250
    v_cos_f32 v250, v250
    v_cos_f32 v56, v60
    v_sin_f32 v60, v60
    v_cvt_pk_f16_f32 v24, v250, v28
    v_cvt_pk_f16_f32 v28, -v28, v250
    v_mul_f32 v250, v213, v251
    v_fmamk_f32 v61, v250, 0x3d800000, v252
    v_sin_f32 v29, v250
    v_cos_f32 v250, v250
    v_cos_f32 v57, v61
    v_sin_f32 v61, v61
    v_cvt_pk_f16_f32 v25, v250, v29
    v_cvt_pk_f16_f32 v29, -v29, v250
    v_mul_f32 v250, v214, v251
    v_fmamk_f32 v62, v250, 0x3d800000, v252
    v_sin_f32 v30, v250
    v_cos_f32 v250, v250
    v_cos_f32 v58, v62
    v_sin_f32 v62, v62
    v_cvt_pk_f16_f32 v26, v250, v30
    v_cvt_pk_f16_f32 v30, -v30, v250
    v_mul_f32 v250, v215, v251
    v_fmamk_f32 v63, v250, 0x3d800000, v252
    v_sin_f32 v31, v250
    v_cos_f32 v250, v250
    v_cos_f32 v59, v63
    v_sin_f32 v63, v63
    v_cvt_pk_f16_f32 v27, v250, v31
    v_cvt_pk_f16_f32 v31, -v31, v250
    v_add_f32 v251, 1.0, v251
    v_mov_b32 v160, 0
    v_mov_b32 v161, 0
    v_mov_b32 v162, 0
    v_mov_b32 v163, 0
    v_mov_b32 v164, 0
    v_mov_b32 v165, 0
    v_mov_b32 v166, 0
    v_mov_b32 v167, 0
    v_mov_b32 v168, 0
    v_mov_b32 v169, 0
    v_mov_b32 v170, 0
    s_mov_b32 s57, 0x3f803f80
    s_mov_b32 s59, 0xffff
    s_brev_b32 s67, 1
    s_mov_b32 s66, 0
    s_brev_b32 s64, 1
    s_brev_b32 s65, 1
    s_cmp_eq_u32 s47, 0
    s_movk_i32 s62, -10368
    s_cselect_b32 s62, 10368, s62
    s_waitcnt lgkmcnt(0)
    s_add_u32 s28, s28, 0x7f4a7c15
    s_addc_u32 s29, s29, 0x9e3779b9
    v_mov_b32 v174, s28
    v_mov_b32 v175, s29
    s_cmp_lt_u32 s2, 224
    s_cbranch_scc1 L_epoch_ok
L_sync1:
    ds_read_b32 v1, v0 offset:42872
    s_add_u32 s92, s92, 1
    s_bitcmp1_b32 s92, 20
    s_cbranch_scc1 L_sync1x
    s_waitcnt lgkmcnt(0)
    v_readfirstlane_b32 s31, v1
    s_nop 0
    s_cmp_ge_u32 s31, 4
    s_cbranch_scc0 L_sync1
L_sync1x:
L_epoch_ok:
    s_setprio 3
    s_waitcnt vmcnt(8)
    v_dot2c_f32_bf16 v160, s57, v120
    v_dot2c_f32_bf16 v164, v120, v120
    v_dot2c_f32_bf16 v160, s57, v121
    v_dot2c_f32_bf16 v164, v121, v121
    v_dot2c_f32_bf16 v160, s57, v122
    v_dot2c_f32_bf16 v164, v122, v122
    v_dot2c_f32_bf16 v160, s57, v123
    v_dot2c_f32_bf16 v164, v123, v123
    v_dot2c_f32_bf16 v160, s57, v124
    v_dot2c_f32_bf16 v164, v124, v124
    v_dot2c_f32_bf16 v160, s57, v125
    v_dot2c_f32_bf16 v164, v125, v125
    v_dot2c_f32_bf16 v160, s57, v126
    v_dot2c_f32_bf16 v164, v126, v126
    v_dot2c_f32_bf16 v160, s57, v127
    v_dot2c_f32_bf16 v164, v127, v127
    s_waitcnt vmcnt(6)
    v_dot2c_f32_bf16 v161, s57, v128
    v_dot2c_f32_bf16 v165, v128, v128
    v_dot2c_f32_bf16 v161, s57, v129
    v_dot2c_f32_bf16 v165, v129, v129
    v_dot2c_f32_bf16 v161, s57, v130
    v_dot2c_f32_bf16 v165, v130, v130
    v_dot2c_f32_bf16 v161, s57, v131
    v_dot2c_f32_bf16 v165, v131, v131
    v_dot2c_f32_bf16 v161, s57, v132
    v_dot2c_f32_bf16 v165, v132, v132
    v_dot2c_f32_bf16 v161, s57, v133
    v_dot2c_f32_bf16 v165, v133, v133
    v_dot2c_f32_bf16 v161, s57, v134
    v_dot2c_f32_bf16 v165, v134, v134
    v_dot2c_f32_bf16 v161, s57, v135
    v_dot2c_f32_bf16 v165, v135, v135
    s_waitcnt vmcnt(4)
    v_dot2c_f32_bf16 v170, s57, v152
    v_dot2c_f32_bf16 v170, s57, v153
    v_dot2c_f32_bf16 v170, s57, v154
    v_dot2c_f32_bf16 v170, s57, v155
    v_dot2c_f32_bf16 v170, s57, v156
    v_dot2c_f32_bf16 v170, s57, v157
    v_dot2c_f32_bf16 v170, s57, v158
    v_dot2c_f32_bf16 v170, s57, v159
    v_dot2c_f32_bf16 v168, v152, v120
    v_dot2c_f32_bf16 v169, v152, v128
    v_dot2c_f32_bf16 v168, v153, v121
    v_dot2c_f32_bf16 v169, v153, v129
    v_dot2c_f32_bf16 v168, v154, v122
    v_dot2c_f32_bf16 v169, v154, v130
    v_dot2c_f32_bf16 v168, v155, v123
    v_dot2c_f32_bf16 v169, v155, v131
    v_mov_b32 v171, v170
    v_dot2c_f32_bf16 v168, v156, v124
    v_dot2c_f32_bf16 v169, v156, v132
    v_dot2c_f32_bf16 v168, v157, v125
    v_dot2c_f32_bf16 v169, v157, v133
    v_dot2c_f32_bf16 v168, v158, v126
    v_dot2c_f32_bf16 v169, v158, v134
    v_dot2c_f32_bf16 v168, v159, v127
    v_dot2c_f32_bf16 v169, v159, v135
    v_permlane32_swap_b32 v160, v161
    v_permlane32_swap_b32 v164, v165
    v_permlane32_swap_b32 v170, v171
    v_permlane32_swap_b32 v168, v169
    v_add_f32 v160, v160, v161
    v_add_f32 v164, v164, v165
    v_add_f32 v170, v170, v171
    v_add_f32_e64 v168, v168, v169
    v_add_f32_dpp v160, v160, v160 row_shr:1 row_mask:0xf bank_mask:0xf
    v_add_f32_dpp v164, v164, v164 row_shr:1 row_mask:0xf bank_mask:0xf
    v_add_f32_dpp v170, v170, v170 row_shr:1 row_mask:0xf bank_mask:0xf
    v_add_f32_dpp v168, v168, v168 row_shr:1 row_mask:0xf bank_mask:0xf
    v_add_f32_dpp v160, v160, v160 row_shr:2 row_mask:0xf bank_mask:0xf
    v_add_f32_dpp v164, v164, v164 row_shr:2 row_mask:0xf bank_mask:0xf
    v_add_f32_dpp v170, v170, v170 row_shr:2 row_mask:0xf bank_mask:0xf
    v_add_f32_dpp v168, v168, v168 row_shr:2 row_mask:0xf bank_mask:0xf
    v_add_f32_dpp v160, v160, v160 row_shr:4 row_mask:0xf bank_mask:0xf
    v_add_f32_dpp v164, v164, v164 row_shr:4 row_mask:0xf bank_mask:0xf
    v_add_f32_dpp v170, v170, v170 row_shr:4 row_mask:0xf bank_mask:0xf
    v_add_f32_dpp v168, v168, v168 row_shr:4 row_mask:0xf bank_mask:0xf
    v_add_f32_dpp v160, v160, v160 row_shr:8 row_mask:0xf bank_mask:0xf
    v_add_f32_dpp v164, v164, v164 row_shr:8 row_mask:0xf bank_mask:0xf
    v_add_f32_dpp v170, v170, v170 row_shr:8 row_mask:0xf bank_mask:0xf
    v_add_f32_dpp v168, v168, v168 row_shr:8 row_mask:0xf bank_mask:0xf
    v_add_f32_dpp v160, v160, v160 row_bcast:15 row_mask:0xa bank_mask:0xf
    v_add_f32_dpp v164, v164, v164 row_bcast:15 row_mask:0xa bank_mask:0xf
    v_add_f32_dpp v170, v170, v170 row_bcast:15 row_mask:0xa bank_mask:0xf
    v_add_f32_dpp v168, v168, v168 row_bcast:15 row_mask:0xa bank_mask:0xf
    v_mul_f32 v160, 0x3a800000, v160
    v_mul_f32 v164, 0x3a800000, v164
    v_fma_f32 v164, -v160, v160, v164
    v_cvt_pk_bf16_f32 v161, -v160, -v160
    v_max_f32 v164, 0, v164
    v_cvt_pk_bf16_f32 v164, v164, v164
    v_and_b32 v164, 0xffff0000, v164
    v_add_f32 v164, 0x3727c5ac, v164
    v_cvt_pk_bf16_f32 v164, v164, v164
    v_and_b32 v164, 0xffff0000, v164
    v_sqrt_f32 v164, v164
    v_and_b32 v165, 0xffff0000, v161
    v_cvt_pk_bf16_f32 v248, v160, v164
    v_and_b32 v164, 0xffff0000, v248
    v_rcp_f32 v164, v164
    v_fmac_f32 v168, v170, v165
    v_mul_f32 v168, v168, v164
    v_ashrrev_i32 v170, 31, v168
    v_or_b32 v170, 0x80000000, v170
    v_xor_b32 v168, v168, v170
    v_and_b32 v168, 0xfffff800, v168
    v_or_b32 v249, v200, v168
    s_mov_b64 exec, s[64:65]
    ds_write_b32 v201, v248 offset:41472
    ds_max_u64 v0, v[248:249] offset:41504
    s_mov_b64 exec, 1
    ds_add_rtn_u32 v1, v0, v255 offset:42816
    s_mov_b64 exec, 31
    ds_read_b64 v[172:173], v5 offset:41472
    s_mov_b64 exec, s[64:65]
    ds_write_b16 v202, v161 offset:41568
    ds_write_b32 v203, v164 offset:42752
    s_mov_b64 exec, -1
    s_nop 0
    v_mov_b32_dpp v6, v128 wave_rol:1 row_mask:0xf bank_mask:0xf
    v_mov_b32_dpp v7, v132 wave_rol:1 row_mask:0xf bank_mask:0xf
    v_bfi_b32 v221, s59, v131, v130
    v_bfi_b32 v222, s59, v130, v129
    v_bfi_b32 v223, s59, v129, v128
    v_bfi_b32 v217, s59, v135, v134
    v_bfi_b32 v218, s59, v134, v133
    v_bfi_b32 v219, s59, v133, v132
    v_cndmask_b32 v220, v6, v7, s[66:67]
    v_cndmask_b32 v216, v7, v6, s[66:67]
    v_bfi_b32 v220, s59, v220, v131
    v_bfi_b32 v216, s59, v216, v135
    s_waitcnt lgkmcnt(2)
    v_readfirstlane_b32 s31, v1
    s_nop 0
    s_cmp_lg_u32 s31, 3
    s_cbranch_scc1 L_not_last
    s_mov_b64 exec, 31
    buffer_store_dwordx4 v[172:175], v4, s[12:15], 0 offen sc1
    s_mov_b64 exec, -1
    s_waitcnt vmcnt(1)
    s_branch L_b_ready
L_not_last:
    s_waitcnt vmcnt(0)
L_b_ready:
    s_setprio 3
    ds_write_b128 v204, v[120:123] offset:0
    ds_write_b128 v204, v[124:127] offset:1280
    s_cmp_lg_u32 s50, 0
    s_cbranch_scc1 L_plain1
    ds_write_b128 v205, v[216:219]
    ds_write_b128 v205, v[220:223] offset:1280
    s_branch L_second1
L_plain1:
    ds_write_b128 v204, v[128:131] offset:20736
    ds_write_b128 v204, v[132:135] offset:22016
L_second1:
    v_add_u32 v204, s62, v204
    v_add_u32 v205, s62, v205
    v_dot2c_f32_bf16 v162, s57, v136
    v_dot2c_f32_bf16 v166, v136, v136
    v_dot2c_f32_bf16 v162, s57, v137
    v_dot2c_f32_bf16 v166, v137, v137
    v_dot2c_f32_bf16 v162, s57, v138
    v_dot2c_f32_bf16 v166, v138, v138
    v_dot2c_f32_bf16 v162, s57, v139
    v_dot2c_f32_bf16 v166, v139, v139
    v_dot2c_f32_bf16 v162, s57, v140
    v_dot2c_f32_bf16 v166, v140, v140
    v_dot2c_f32_bf16 v162, s57, v141
    v_dot2c_f32_bf16 v166, v141, v141
    v_dot2c_f32_bf16 v162, s57, v142
    v_dot2c_f32_bf16 v166, v142, v142
    v_dot2c_f32_bf16 v162, s57, v143
    v_dot2c_f32_bf16 v166, v143, v143
    ds_write_b128 v204, v[136:139] offset:0
    ds_write_b128 v204, v[140:143] offset:1280
    v_dot2c_f32_bf16 v163, s57, v144
    v_dot2c_f32_bf16 v167, v144, v144
    v_dot2c_f32_bf16 v163, s57, v145
    v_dot2c_f32_bf16 v167, v145, v145
    v_dot2c_f32_bf16 v163, s57, v146
    v_dot2c_f32_bf16 v167, v146, v146
    v_dot2c_f32_bf16 v163, s57, v147
    v_dot2c_f32_bf16 v167, v147, v147
    v_dot2c_f32_bf16 v163, s57, v148
    v_dot2c_f32_bf16 v167, v148, v148
    v_dot2c_f32_bf16 v163, s57, v149
    v_dot2c_f32_bf16 v167, v149, v149
    v_dot2c_f32_bf16 v163, s57, v150
    v_dot2c_f32_bf16 v167, v150, v150
    v_dot2c_f32_bf16 v163, s57, v151
    v_dot2c_f32_bf16 v167, v151, v151
    v_xor_b32 v202, 8, v202
    v_xor_b32 v203, 16, v203
    s_waitcnt lgkmcnt(2)
    s_nop 0
    v_mov_b32_dpp v6, v144 wave_rol:1 row_mask:0xf bank_mask:0xf
    v_mov_b32_dpp v7, v148 wave_rol:1 row_mask:0xf bank_mask:0xf
    v_bfi_b32 v221, s59, v147, v146
    v_bfi_b32 v222, s59, v146, v145
    v_bfi_b32 v223, s59, v145, v144
    v_bfi_b32 v217, s59, v151, v150
    v_bfi_b32 v218, s59, v150, v149
    v_bfi_b32 v219, s59, v149, v148
    v_cndmask_b32 v220, v6, v7, s[66:67]
    v_cndmask_b32 v216, v7, v6, s[66:67]
    v_bfi_b32 v220, s59, v220, v147
    v_bfi_b32 v216, s59, v216, v151
    s_cmp_lg_u32 s50, 0
    s_cbranch_scc1 L_plain3
    ds_write_b128 v205, v[216:219]
    ds_write_b128 v205, v[220:223] offset:1280
    s_branch L_second3
L_plain3:
    ds_write_b128 v204, v[144:147] offset:20736
    ds_write_b128 v204, v[148:151] offset:22016
L_second3:
    v_permlane32_swap_b32 v162, v163
    v_permlane32_swap_b32 v166, v167
    v_add_f32 v162, v162, v163
    v_add_f32 v166, v166, v167
    s_nop 0
    v_add_f32_dpp v162, v162, v162 row_shr:1 row_mask:0xf bank_mask:0xf
    v_add_f32_dpp v166, v166, v166 row_shr:1 row_mask:0xf bank_mask:0xf
    s_nop 0
    v_add_f32_dpp v162, v162, v162 row_shr:2 row_mask:0xf bank_mask:0xf
    v_add_f32_dpp v166, v166, v166 row_shr:2 row_mask:0xf bank_mask:0xf
    s_nop 0
    v_add_f32_dpp v162, v162, v162 row_shr:4 row_mask:0xf bank_mask:0xf
    v_add_f32_dpp v166, v166, v166 row_shr:4 row_mask:0xf bank_mask:0xf
    s_nop 0
    v_add_f32_dpp v162, v162, v162 row_shr:8 row_mask:0xf bank_mask:0xf
    v_add_f32_dpp v166, v166, v166 row_shr:8 row_mask:0xf bank_mask:0xf
    s_nop 0
    v_add_f32_dpp v162, v162, v162 row_bcast:15 row_mask:0xa bank_mask:0xf
    v_add_f32_dpp v166, v166, v166 row_bcast:15 row_mask:0xa bank_mask:0xf
    v_mul_f32 v162, 0x3a800000, v162
    v_mul_f32 v166, 0x3a800000, v166
    v_fma_f32 v166, -v162, v162, v166
    v_cvt_pk_bf16_f32 v161, -v162, -v162
    v_max_f32 v166, 0, v166
    v_cvt_pk_bf16_f32 v166, v166, v166
    v_and_b32 v166, 0xffff0000, v166
    v_add_f32 v166, 0x3727c5ac, v166
    v_cvt_pk_bf16_f32 v166, v166, v166
    v_and_b32 v166, 0xffff0000, v166
    v_sqrt_f32 v166, v166
    v_and_b32 v167, 0xffff0000, v161
    v_cvt_pk_bf16_f32 v248, v162, v166
    v_and_b32 v166, 0xffff0000, v248
    v_rcp_f32 v166, v166
    s_mov_b64 exec, s[64:65]
    ds_write_b16 v202, v161 offset:41568
    ds_write_b32 v203, v166 offset:42752
    s_mov_b64 exec, 1
    ds_add_u32 v0, v255 offset:42820
    s_mov_b64 exec, -1
L_sync2:
    ds_read_b32 v1, v0 offset:42820
    ds_read_b128 v[176:179], v0 offset:42752
    ds_read_b128 v[180:183], v0 offset:42768
    ds_read_b128 v[184:187], v0 offset:42784
    ds_read_b128 v[188:191], v0 offset:42800
    ds_read_b128 v[192:195], v0 offset:41568
    ds_read_b128 v[196:199], v0 offset:41584
    s_add_u32 s92, s92, 1
    s_bitcmp1_b32 s92, 20
    s_cbranch_scc1 L_sync2x
    s_waitcnt lgkmcnt(6)
    v_readfirstlane_b32 s31, v1
    s_nop 0
    s_cmp_ge_u32 s31, 4
    s_cbranch_scc0 L_sync2
L_sync2x:
    ds_read_b64_tr_b16 v[120:121], v206 offset:0
    ds_read_b64_tr_b16 v[122:123], v206 offset:10368
    ds_read_b64_tr_b16 v[124:125], v206 offset:20736
    ds_read_b64_tr_b16 v[126:127], v206 offset:31104
    ds_read_b64_tr_b16 v[128:129], v206 offset:32
    ds_read_b64_tr_b16 v[130:131], v206 offset:10400
    ds_read_b64_tr_b16 v[132:133], v206 offset:20768
    ds_read_b64_tr_b16 v[134:135], v206 offset:31136
    s_waitcnt lgkmcnt(10)
    s_nop 0
    ds_read_b64_tr_b16 v[136:137], v206 offset:64
    ds_read_b64_tr_b16 v[138:139], v206 offset:10432
    ds_read_b64_tr_b16 v[140:141], v206 offset:20800
    ds_read_b64_tr_b16 v[142:143], v206 offset:31168
    v_pk_mul_f32 v[176:177], v[176:177], v[8:9]
    v_pk_mul_f32 v[178:179], v[178:179], v[10:11]
    v_pk_mul_f32 v[180:181], v[180:181], v[12:13]
    v_pk_mul_f32 v[182:183], v[182:183], v[14:15]
    v_pk_mul_f32 v[184:185], v[184:185], v[8:9]
    v_pk_mul_f32 v[186:187], v[186:187], v[10:11]
    v_pk_mul_f32 v[188:189], v[188:189], v[12:13]
    v_pk_mul_f32 v[190:191], v[190:191], v[14:15]
    v_cvt_pk_bf16_f32 v160, v176, v177
    v_cvt_pk_bf16_f32 v152, v184, v185
    v_cvt_pk_bf16_f32 v161, v178, v179
    v_cvt_pk_bf16_f32 v153, v186, v187
    v_cvt_pk_bf16_f32 v162, v180, v181
    v_cvt_pk_bf16_f32 v154, v188, v189
    v_cvt_pk_bf16_f32 v163, v182, v183
    v_cvt_pk_bf16_f32 v155, v190, v191
    v_xor_b32 v164, v208, v160
    v_xor_b32 v156, v208, v152
    v_xor_b32 v165, v208, v161
    v_xor_b32 v157, v208, v153
    v_xor_b32 v166, v208, v162
    v_xor_b32 v158, v208, v154
    v_xor_b32 v167, v208, v163
    v_xor_b32 v159, v208, v155
    s_waitcnt lgkmcnt(12)
    s_cmp_lg_u32 s50, 0
    s_cbranch_scc1 L_st1_split
    v_mfma_f32_16x16x32_bf16 v[168:171], v[160:163], v[192:195], 0
    v_mfma_f32_16x16x32_bf16 v[168:171], v[152:155], v[196:199], v[168:171]
    s_waitcnt lgkmcnt(10)
    ds_read_b64_tr_b16 v[144:145], v206 offset:96
    ds_read_b64_tr_b16 v[146:147], v206 offset:10464
    ds_read_b64_tr_b16 v[148:149], v206 offset:20832
    ds_read_b64_tr_b16 v[150:151], v206 offset:31200
    v_mfma_f32_16x16x32_bf16 v[216:219], v[160:163], v[120:123], v[168:171]
    s_waitcnt lgkmcnt(12)
    v_mfma_f32_16x16x32_bf16 v[216:219], v[152:155], v[124:127], v[216:219]
    s_waitcnt lgkmcnt(10)
    v_mfma_f32_16x16x32_bf16 v[224:227], v[160:163], v[128:131], v[168:171]
    s_waitcnt lgkmcnt(8)
    v_mfma_f32_16x16x32_bf16 v[224:227], v[152:155], v[132:135], v[224:227]
    s_waitcnt lgkmcnt(6)
    v_mfma_f32_16x16x32_bf16 v[232:235], v[160:163], v[136:139], v[168:171]
    s_waitcnt lgkmcnt(4)
    v_mfma_f32_16x16x32_bf16 v[232:235], v[152:155], v[140:143], v[232:235]
    s_waitcnt lgkmcnt(2)
    v_mfma_f32_16x16x32_bf16 v[240:243], v[160:163], v[144:147], v[168:171]
    s_waitcnt lgkmcnt(0)
    v_mfma_f32_16x16x32_bf16 v[240:243], v[152:155], v[148:151], v[240:243]
    v_mfma_f32_16x16x32_bf16 v[220:223], v[164:167], v[120:123], 0
    v_mfma_f32_16x16x32_bf16 v[220:223], v[156:159], v[124:127], v[220:223]
    v_mfma_f32_16x16x32_bf16 v[228:231], v[164:167], v[128:131], 0
    v_mfma_f32_16x16x32_bf16 v[228:231], v[156:159], v[132:135], v[228:231]
    v_cvt_pk_f16_f32 v176, v216, v217
    v_cvt_pk_f16_f32 v177, v224, v225
    v_cvt_pk_f16_f32 v178, v232, v233
    s_nop 0
    v_cvt_pk_f16_f32 v179, v240, v241
    ds_write_b128 v207, v[176:179] offset:44032
    v_mfma_f32_16x16x32_bf16 v[236:239], v[164:167], v[136:139], 0
    v_mfma_f32_16x16x32_bf16 v[236:239], v[156:159], v[140:143], v[236:239]
    v_cvt_pk_f16_f32 v180, v218, v219
    v_cvt_pk_f16_f32 v181, v226, v227
    v_cvt_pk_f16_f32 v182, v234, v235
    v_cvt_pk_f16_f32 v183, v242, v243
    ds_write_b128 v207, v[180:183] offset:45056
    v_mfma_f32_16x16x32_bf16 v[244:247], v[164:167], v[144:147], 0
    v_mfma_f32_16x16x32_bf16 v[244:247], v[156:159], v[148:151], v[244:247]
    v_cvt_pk_f16_f32 v184, v220, v221
    v_cvt_pk_f16_f32 v185, v228, v229
    v_cvt_pk_f16_f32 v186, v236, v237
    s_nop 4
    v_cvt_pk_f16_f32 v187, v244, v245
    ds_write_b128 v207, v[184:187] offset:46080
    v_cvt_pk_f16_f32 v188, v222, v223
    v_cvt_pk_f16_f32 v189, v230, v231
    v_cvt_pk_f16_f32 v190, v238, v239
    v_cvt_pk_f16_f32 v191, v246, v247
    ds_write_b128 v207, v[188:191] offset:47104
    s_branch L_st1_done
L_st1_split:
    s_waitcnt lgkmcnt(8)
    ds_read_b64_tr_b16 v[144:145], v206 offset:96
    ds_read_b64_tr_b16 v[146:147], v206 offset:10464
    ds_read_b64_tr_b16 v[148:149], v206 offset:20832
    ds_read_b64_tr_b16 v[150:151], v206 offset:31200
    s_waitcnt lgkmcnt(0)
    v_mfma_f32_16x16x32_bf16 v[168:171], v[160:163], v[192:195], 0
    v_mfma_f32_16x16x32_bf16 v[220:223], v[164:167], v[120:123], 0
    v_mfma_f32_16x16x32_bf16 v[216:219], v[160:163], v[120:123], v[168:171]
    v_mfma_f32_16x16x32_bf16 v[228:231], v[164:167], v[128:131], 0
    v_mfma_f32_16x16x32_bf16 v[224:227], v[160:163], v[128:131], v[168:171]
    v_mfma_f32_16x16x32_bf16 v[236:239], v[164:167], v[136:139], 0
    v_mfma_f32_16x16x32_bf16 v[232:235], v[160:163], v[136:139], v[168:171]
    v_mfma_f32_16x16x32_bf16 v[244:247], v[164:167], v[144:147], 0
    v_mfma_f32_16x16x32_bf16 v[240:243], v[160:163], v[144:147], v[168:171]
    s_nop 1
    s_nop 0
    v_cvt_pk_f16_f32 v176, v216, v217
    v_cvt_pk_f16_f32 v180, v218, v219
    v_cvt_pk_f16_f32 v184, v220, v221
    v_cvt_pk_f16_f32 v188, v222, v223
    v_cvt_pk_f16_f32 v177, v224, v225
    v_cvt_pk_f16_f32 v181, v226, v227
    v_cvt_pk_f16_f32 v185, v228, v229
    v_cvt_pk_f16_f32 v189, v230, v231
    v_cvt_pk_f16_f32 v178, v232, v233
    v_cvt_pk_f16_f32 v182, v234, v235
    v_cvt_pk_f16_f32 v186, v236, v237
    v_cvt_pk_f16_f32 v190, v238, v239
    v_cvt_pk_f16_f32 v179, v240, v241
    v_cvt_pk_f16_f32 v183, v242, v243
    v_cvt_pk_f16_f32 v187, v244, v245
    v_cvt_pk_f16_f32 v191, v246, v247
    ds_write_b128 v207, v[176:179] offset:44032
    ds_write_b128 v207, v[180:183] offset:45056
    ds_write_b128 v207, v[184:187] offset:46080
    ds_write_b128 v207, v[188:191] offset:47104
    v_mfma_f32_16x16x32_bf16 v[168:171], v[152:155], v[196:199], 0
    v_mfma_f32_16x16x32_bf16 v[220:223], v[156:159], v[124:127], 0
    v_mfma_f32_16x16x32_bf16 v[216:219], v[152:155], v[124:127], v[168:171]
    v_mfma_f32_16x16x32_bf16 v[228:231], v[156:159], v[132:135], 0
    v_mfma_f32_16x16x32_bf16 v[224:227], v[152:155], v[132:135], v[168:171]
    v_mfma_f32_16x16x32_bf16 v[236:239], v[156:159], v[140:143], 0
    v_mfma_f32_16x16x32_bf16 v[232:235], v[152:155], v[140:143], v[168:171]
    v_mfma_f32_16x16x32_bf16 v[244:247], v[156:159], v[148:151], 0
    v_mfma_f32_16x16x32_bf16 v[240:243], v[152:155], v[148:151], v[168:171]
    s_waitcnt lgkmcnt(0)
    s_nop 0
    v_cvt_pk_f16_f32 v176, v216, v217
    v_cvt_pk_f16_f32 v180, v218, v219
    v_cvt_pk_f16_f32 v184, v220, v221
    v_cvt_pk_f16_f32 v188, v222, v223
    v_cvt_pk_f16_f32 v177, v224, v225
    v_cvt_pk_f16_f32 v181, v226, v227
    v_cvt_pk_f16_f32 v185, v228, v229
    v_cvt_pk_f16_f32 v189, v230, v231
    v_cvt_pk_f16_f32 v178, v232, v233
    v_cvt_pk_f16_f32 v182, v234, v235
    v_cvt_pk_f16_f32 v186, v236, v237
    v_cvt_pk_f16_f32 v190, v238, v239
    v_cvt_pk_f16_f32 v179, v240, v241
    v_cvt_pk_f16_f32 v183, v242, v243
    v_cvt_pk_f16_f32 v187, v244, v245
    v_cvt_pk_f16_f32 v191, v246, v247
    ds_write_b128 v207, v[176:179] offset:60416
    ds_write_b128 v207, v[180:183] offset:61440
    ds_write_b128 v207, v[184:187] offset:62464
    ds_write_b128 v207, v[188:191] offset:63488
L_st1_done:
    s_mov_b64 exec, 1
    ds_add_u32 v0, v255 offset:42824
    s_mov_b64 exec, -1
    s_lshl_b32 s31, s30, 12
    v_add_u32 v5, s31, v3
    s_and_b32 s31, s28, 0x30003
    v_mov_b32 v210, s31
    s_mov_b32 s58, 0xfffcfffc
    s_and_b32 s32, s48, 3
    s_cselect_b32 s72, -1, 0xff
    s_cselect_b32 s73, -1, 0
    s_mov_b32 s74, s48
    s_mov_b64 s[60:61], 0
    s_mov_b64 s[62:63], 0
    v_mov_b32 v209, 2147483392
    s_cmp_eq_u32 s48, 7
    s_cbranch_scc1 L_no_consts
    v_mul_f32 v250, v212, v251
    v_fmamk_f32 v68, v250, 0x3d800000, v252
    v_sin_f32 v36, v250
    v_cos_f32 v250, v250
    v_cos_f32 v64, v68
    v_sin_f32 v68, v68
    v_cvt_pk_f16_f32 v32, v250, v36
    v_cvt_pk_f16_f32 v36, -v36, v250
    v_mul_f32 v250, v213, v251
    v_fmamk_f32 v69, v250, 0x3d800000, v252
    v_sin_f32 v37, v250
    v_cos_f32 v250, v250
    v_cos_f32 v65, v69
    v_sin_f32 v69, v69
    v_cvt_pk_f16_f32 v33, v250, v37
    v_cvt_pk_f16_f32 v37, -v37, v250
    v_mul_f32 v250, v214, v251
    v_fmamk_f32 v70, v250, 0x3d800000, v252
    v_sin_f32 v38, v250
    v_cos_f32 v250, v250
    v_cos_f32 v66, v70
    v_sin_f32 v70, v70
    v_cvt_pk_f16_f32 v34, v250, v38
    v_cvt_pk_f16_f32 v38, -v38, v250
    v_mul_f32 v250, v215, v251
    v_fmamk_f32 v71, v250, 0x3d800000, v252
    v_sin_f32 v39, v250
    v_cos_f32 v250, v250
    v_cos_f32 v67, v71
    v_sin_f32 v71, v71
    v_cvt_pk_f16_f32 v35, v250, v39
    v_cvt_pk_f16_f32 v39, -v39, v250
    v_add_f32 v251, 1.0, v251
    v_mul_f32 v250, v212, v251
    v_fmamk_f32 v76, v250, 0x3d800000, v252
    v_sin_f32 v44, v250
    v_cos_f32 v250, v250
    v_cos_f32 v72, v76
    v_sin_f32 v76, v76
    v_cvt_pk_f16_f32 v40, v250, v44
    v_cvt_pk_f16_f32 v44, -v44, v250
    v_mul_f32 v250, v213, v251
    v_fmamk_f32 v77, v250, 0x3d800000, v252
    v_sin_f32 v45, v250
    v_cos_f32 v250, v250
    v_cos_f32 v73, v77
    v_sin_f32 v77, v77
    v_cvt_pk_f16_f32 v41, v250, v45
    v_cvt_pk_f16_f32 v45, -v45, v250
    v_mul_f32 v250, v214, v251
    v_fmamk_f32 v78, v250, 0x3d800000, v252
    v_sin_f32 v46, v250
    v_cos_f32 v250, v250
    v_cos_f32 v74, v78
    v_sin_f32 v78, v78
    v_cvt_pk_f16_f32 v42, v250, v46
    v_cvt_pk_f16_f32 v46, -v46, v250
    v_mul_f32 v250, v215, v251
    v_fmamk_f32 v79, v250, 0x3d800000, v252
    v_sin_f32 v47, v250
    v_cos_f32 v250, v250
    v_cos_f32 v75, v79
    v_sin_f32 v79, v79
    v_cvt_pk_f16_f32 v43, v250, v47
    v_cvt_pk_f16_f32 v47, -v47, v250
    s_and_b32 s31, s46, 1
    s_lshl_b32 s31, s31, 6
    s_lshr_b32 s32, s46, 1
    s_add_u32 s49, s31, s32
    s_bitcmp1_b32 s49, 2
    s_cselect_b64 vcc, -1, 0
    v_cndmask_b32 v80, v16, v20, vcc
    v_cndmask_b32 v84, v20, v16, vcc
    v_cndmask_b32 v81, v17, v21, vcc
    v_cndmask_b32 v85, v21, v17, vcc
    v_cndmask_b32 v82, v18, v22, vcc
    v_cndmask_b32 v86, v22, v18, vcc
    v_cndmask_b32 v83, v19, v23, vcc
    v_cndmask_b32 v87, v23, v19, vcc
    s_bfe_u32 s31, s49, 0x10001
    v_and_b32 v6, 7, v2
    v_xor_b32 v6, s31, v6
    v_lshlrev_b32 v6, 4, v6
    v_lshrrev_b32 v7, 4, v2
    v_lshlrev_b32 v7, 3, v7
    v_bfe_u32 v209, v2, 3, 1
    v_add_u32 v7, v7, v209
    v_mul_u32_u24 v7, 16512, v7
    v_add_u32 v209, v6, v7
    s_mul_i32 s31, s48, 528384
    s_lshl_b32 s32, s49, 7
    s_add_u32 s31, s31, s32
    s_add_u32 s60, s31, 2097152
L_no_consts:
L_st23:
L_sync3:
    ds_read_b32 v1, v0 offset:42824
    ds_read_b128 v[120:123], v5 offset:44032
    ds_read_b128 v[124:127], v5 offset:45056
    ds_read_b128 v[128:131], v5 offset:46080
    ds_read_b128 v[132:135], v5 offset:47104
    s_add_u32 s92, s92, 1
    s_bitcmp1_b32 s92, 20
    s_cbranch_scc1 L_sync3x
    s_waitcnt lgkmcnt(4)
    v_readfirstlane_b32 s31, v1
    s_nop 0
    s_cmp_ge_u32 s31, 4
    s_cbranch_scc0 L_sync3
L_sync3x:
    s_cmp_eq_u32 s48, 7
    s_cbranch_scc1 L_p1_done
    s_add_u32 s61, s60, 33024
    s_add_u32 s62, s61, 33024
    s_add_u32 s63, s62, 33024
    s_waitcnt lgkmcnt(3)
    v_mfma_f32_16x16x32_f16 v[136:139], v[120:123], v[16:19], 0
    v_mfma_f32_16x16x32_f16 v[140:143], v[120:123], v[20:23], 0
    s_waitcnt lgkmcnt(2)
    v_mfma_f32_16x16x32_f16 v[144:147], v[124:127], v[24:27], 0
    v_mfma_f32_16x16x32_f16 v[148:151], v[124:127], v[28:31], 0
    s_nop 3
    s_nop 0
    v_pk_mul_f32 v[152:153], v[48:49], v[136:137]
    v_pk_mul_f32 v[154:155], v[50:51], v[138:139]
    v_pk_mul_f32 v[156:157], v[52:53], v[136:137]
    v_pk_mul_f32 v[158:159], v[54:55], v[138:139]
    v_pk_fma_f32 v[152:153], v[52:53], v[140:141], v[152:153]
    v_pk_fma_f32 v[156:157], v[48:49], v[140:141], v[156:157] neg_lo:[0,0,1] neg_hi:[0,0,1]
    v_pk_fma_f32 v[154:155], v[54:55], v[142:143], v[154:155]
    v_pk_fma_f32 v[158:159], v[50:51], v[142:143], v[158:159] neg_lo:[0,0,1] neg_hi:[0,0,1]
    v_cvt_pk_f16_f32 v120, v152, v156
    v_cvt_pk_f16_f32 v121, v153, v157
    v_cvt_pk_f16_f32 v122, v154, v158
    v_cvt_pk_f16_f32 v123, v155, v159
    s_waitcnt lgkmcnt(1)
    s_nop 0
    v_mfma_f32_16x16x32_f16 v[136:139], v[128:131], v[32:35], 0
    v_mfma_f32_16x16x32_f16 v[140:143], v[128:131], v[36:39], 0
    v_mfma_f32_16x16x32_f16 v[216:219], v[80:83], v[120:123], 0
    v_mfma_f32_16x16x32_f16 v[220:223], v[84:87], v[120:123], 0
    v_pk_mul_f32 v[152:153], v[56:57], v[144:145]
    v_pk_mul_f32 v[154:155], v[58:59], v[146:147]
    v_pk_mul_f32 v[156:157], v[60:61], v[144:145]
    v_pk_mul_f32 v[158:159], v[62:63], v[146:147]
    v_pk_fma_f32 v[152:153], v[60:61], v[148:149], v[152:153]
    v_pk_fma_f32 v[156:157], v[56:57], v[148:149], v[156:157] neg_lo:[0,0,1] neg_hi:[0,0,1]
    v_pk_fma_f32 v[154:155], v[62:63], v[150:151], v[154:155]
    v_pk_fma_f32 v[158:159], v[58:59], v[150:151], v[158:159] neg_lo:[0,0,1] neg_hi:[0,0,1]
    v_cvt_pk_f16_f32 v124, v152, v156
    v_cvt_pk_f16_f32 v125, v153, v157
    v_cvt_pk_f16_f32 v126, v154, v158
    v_cvt_pk_f16_f32 v127, v155, v159
    s_waitcnt lgkmcnt(0)
    s_nop 0
    v_mfma_f32_16x16x32_f16 v[144:147], v[132:135], v[40:43], 0
    v_mfma_f32_16x16x32_f16 v[148:151], v[132:135], v[44:47], 0
    v_mfma_f32_16x16x32_f16 v[224:227], v[80:83], v[124:127], 0
    v_mfma_f32_16x16x32_f16 v[228:231], v[84:87], v[124:127], 0
    v_pk_mul_f32 v[152:153], v[64:65], v[136:137]
    v_pk_mul_f32 v[154:155], v[66:67], v[138:139]
    v_pk_mul_f32 v[156:157], v[68:69], v[136:137]
    v_pk_mul_f32 v[158:159], v[70:71], v[138:139]
    v_pk_fma_f32 v[152:153], v[68:69], v[140:141], v[152:153]
    v_pk_fma_f32 v[156:157], v[64:65], v[140:141], v[156:157] neg_lo:[0,0,1] neg_hi:[0,0,1]
    v_pk_fma_f32 v[154:155], v[70:71], v[142:143], v[154:155]
    v_pk_fma_f32 v[158:159], v[66:67], v[142:143], v[158:159] neg_lo:[0,0,1] neg_hi:[0,0,1]
    v_cvt_pk_f16_f32 v128, v152, v156
    v_cvt_pk_f16_f32 v129, v153, v157
    v_cvt_pk_f16_f32 v130, v154, v158
    v_cvt_pk_f16_f32 v131, v155, v159
    s_nop 1
    s_nop 0
    v_mfma_f32_16x16x32_f16 v[232:235], v[80:83], v[128:131], 0
    v_mfma_f32_16x16x32_f16 v[236:239], v[84:87], v[128:131], 0
    v_pk_mul_f32 v[152:153], v[72:73], v[144:145]
    v_pk_mul_f32 v[154:155], v[74:75], v[146:147]
    v_pk_mul_f32 v[156:157], v[76:77], v[144:145]
    v_pk_mul_f32 v[158:159], v[78:79], v[146:147]
    v_pk_fma_f32 v[152:153], v[76:77], v[148:149], v[152:153]
    v_pk_fma_f32 v[156:157], v[72:73], v[148:149], v[156:157] neg_lo:[0,0,1] neg_hi:[0,0,1]
    v_pk_fma_f32 v[154:155], v[78:79], v[150:151], v[154:155]
    v_pk_fma_f32 v[158:159], v[74:75], v[150:151], v[158:159] neg_lo:[0,0,1] neg_hi:[0,0,1]
    v_cvt_pk_f16_f32 v132, v152, v156
    v_cvt_pk_f16_f32 v133, v153, v157
    v_cvt_pk_f16_f32 v134, v154, v158
    v_cvt_pk_f16_f32 v135, v155, v159
    s_nop 1
    s_nop 0
    v_mfma_f32_16x16x32_f16 v[240:243], v[80:83], v[132:135], 0
    v_mfma_f32_16x16x32_f16 v[244:247], v[84:87], v[132:135], 0
    v_cvt_pk_f16_f32 v176, v216, v224
    v_cvt_pk_f16_f32 v178, v220, v228
    v_and_or_b32 v176, v176, s58, v210
    v_and_or_b32 v178, v178, s58, v210
    v_cvt_pk_f16_f32 v180, v217, v225
    v_cvt_pk_f16_f32 v182, v221, v229
    v_and_or_b32 v180, v180, s58, v210
    v_and_or_b32 v182, v182, s58, v210
    v_cvt_pk_f16_f32 v184, v218, v226
    v_cvt_pk_f16_f32 v186, v222, v230
    v_and_or_b32 v184, v184, s58, v210
    v_and_or_b32 v186, v186, s58, v210
    v_cvt_pk_f16_f32 v188, v219, v227
    v_cvt_pk_f16_f32 v190, v223, v231
    v_and_or_b32 v188, v188, s58, v210
    v_and_or_b32 v190, v190, s58, v210
    v_cvt_pk_f16_f32 v177, v232, v240
    v_cvt_pk_f16_f32 v179, v236, v244
    v_and_or_b32 v177, v177, s58, v210
    v_and_or_b32 v179, v179, s58, v210
    v_cvt_pk_f16_f32 v181, v233, v241
    v_cvt_pk_f16_f32 v183, v237, v245
    v_and_or_b32 v181, v181, s58, v210
    v_and_or_b32 v183, v183, s58, v210
    v_cvt_pk_f16_f32 v185, v234, v242
    v_cvt_pk_f16_f32 v187, v238, v246
    v_and_or_b32 v185, v185, s58, v210
    v_and_or_b32 v187, v187, s58, v210
    v_cvt_pk_f16_f32 v189, v235, v243
    v_cvt_pk_f16_f32 v191, v239, v247
    v_and_or_b32 v189, v189, s58, v210
    v_and_or_b32 v191, v191, s58, v210
    s_cmp_eq_u32 s50, 0
    s_cbranch_scc1 L_p1_done
    s_mov_b32 exec_hi, s72
    buffer_store_dwordx4 v[176:179], v209, s[12:15], s60 offen sc1
    s_mov_b32 exec_hi, s73
    buffer_store_dwordx4 v[180:183], v209, s[12:15], s61 offen sc1
    buffer_store_dwordx4 v[184:187], v209, s[12:15], s62 offen sc1
    buffer_store_dwordx4 v[188:191], v209, s[12:15], s63 offen sc1
    s_mov_b32 exec_hi, -1
    s_mov_b32 s50, 0
    s_add_u32 s60, s60, 16384
    v_add_u32 v5, 16384, v5
    s_sub_u32 s31, s48, 4
    v_cvt_f32_i32 v252, s31
    v_mul_f32 v252, 0x3d800000, v252
    v_and_b32 v251, 15, v2
    v_lshlrev_b32 v251, 2, v251
    v_cvt_f32_u32 v251, v251
    v_fma_f32 v250, v212, v251, v252
    v_sin_f32 v84, v250
    v_cos_f32 v250, v250
    s_nop 0
    v_cvt_pk_f16_f32 v80, v250, v84
    v_cvt_pk_f16_f32 v84, -v84, v250
    v_fma_f32 v250, v213, v251, v252
    v_sin_f32 v85, v250
    v_cos_f32 v250, v250
    s_nop 0
    v_cvt_pk_f16_f32 v81, v250, v85
    v_cvt_pk_f16_f32 v85, -v85, v250
    v_fma_f32 v250, v214, v251, v252
    v_sin_f32 v86, v250
    v_cos_f32 v250, v250
    s_nop 0
    v_cvt_pk_f16_f32 v82, v250, v86
    v_cvt_pk_f16_f32 v86, -v86, v250
    v_fma_f32 v250, v215, v251, v252
    v_sin_f32 v87, v250
    v_cos_f32 v250, v250
    s_nop 0
    v_cvt_pk_f16_f32 v83, v250, v87
    v_cvt_pk_f16_f32 v87, -v87, v250
    s_branch L_st23
L_p1_done:
    s_mov_b64 exec, 1
    ds_add_u32 v0, v255 offset:42828
    s_mov_b64 exec, -1
    s_setprio 0
    v_mov_b32 v4, v112
    v_mov_b32 v5, v113
    v_mov_b32 v249, v114
    v_mov_b32 v205, v115
    v_mov_b32 v248, v116
    v_mov_b32 v208, v117
    v_mov_b32 v7, v118
    v_mov_b32 v6, v119
    s_and_b32 s31, s2, 7
    s_sub_u32 s32, 8, s31
    s_min_u32 s46, s31, s32
    s_lshr_b32 s53, s31, 2
    s_lshr_b32 s47, s2, 3
    s_and_b32 s32, s47, 1
    s_and_b32 s31, s31, 3
    s_cselect_b32 s53, s53, s32
    s_cselect_b32 s31, 0, 1
    s_lshr_b32 s47, s47, s31
    s_lshl_b32 s53, s53, 4
    s_lshl_b32 s31, s30, 5
    s_add_u32 s53, s53, s31
    s_lshl_b32 s48, s46, 1
    s_add_u32 s48, s48, 2040
    s_mov_b32 s49, 32768
    v_mov_b32 v212, v210
    v_mov_b32 v213, v210
    v_mov_b32 v214, v210
    v_mov_b32 v215, v210
    s_cmp_ge_u32 s2, 224
    s_cbranch_scc1 L_zst_go
L_sync4:
    ds_read_b32 v1, v0 offset:42840
    s_add_u32 s92, s92, 1
    s_bitcmp1_b32 s92, 20
    s_cbranch_scc1 L_sync4x
    s_waitcnt lgkmcnt(0)
    v_readfirstlane_b32 s31, v1
    s_nop 0
    s_cmp_ge_u32 s31, 1
    s_cbranch_scc0 L_sync4
L_sync4x:
L_zst_go:
    s_mov_b32 exec_hi, s72
    buffer_store_dwordx4 v[176:179], v209, s[12:15], s60 offen sc1
    s_mov_b32 exec_hi, s73
    buffer_store_dwordx4 v[180:183], v209, s[12:15], s61 offen sc1
    buffer_store_dwordx4 v[184:187], v209, s[12:15], s62 offen sc1
    buffer_store_dwordx4 v[188:191], v209, s[12:15], s63 offen sc1
    s_mov_b32 exec_hi, -1
L_sync5:
    ds_read_b32 v1, v0 offset:42860
    s_add_u32 s92, s92, 1
    s_bitcmp1_b32 s92, 20
    s_cbranch_scc1 L_sync5x
    s_waitcnt lgkmcnt(0)
    v_readfirstlane_b32 s31, v1
    s_nop 0
    s_cmp_ge_u32 s31, 1
    s_cbranch_scc0 L_sync5
L_sync5x:
    buffer_load_dwordx4 v[24:27], v6, s[12:15], s49 offen
    s_add_u32 m0, s76, 0
    s_nop 0
    buffer_load_dwordx4 v4, s[8:11], 0 offen lds
    s_add_u32 m0, s76, 1024
    s_nop 0
    buffer_load_dwordx4 v5, s[8:11], 0 offen lds
    v_and_b32 v160, 15, v2
    v_add_u32 v160, s53, v160
    v_cvt_f32_u32 v160, v160
    v_add_f32 v160, 0.5, v160
    v_mul_f32 v160, 0x3b800000, v160
    v_and_b32 v161, 32, v2
    v_bfe_u32 v162, v2, 4, 1
    v_lshl_add_u32 v161, v162, 3, v161
    v_cvt_f32_u32 v161, v161
    v_mul_f32 v161, v161, v160
    v_fmamk_f32 v88, v160, 0x0, v161
    v_fmamk_f32 v162, v160, 0x40000000, v161
    v_sin_f32 v104, v88
    v_sin_f32 v163, v162
    v_cos_f32 v88, v88
    v_cos_f32 v162, v162
    v_cvt_pk_f16_f32 v104, v104, v163
    v_cvt_pk_f16_f32 v88, v88, v162
    v_fmamk_f32 v89, v160, 0x40800000, v161
    v_fmamk_f32 v162, v160, 0x40c00000, v161
    v_sin_f32 v105, v89
    v_sin_f32 v163, v162
    v_cos_f32 v89, v89
    v_cos_f32 v162, v162
    v_cvt_pk_f16_f32 v105, v105, v163
    v_cvt_pk_f16_f32 v89, v89, v162
    v_fmamk_f32 v90, v160, 0x41800000, v161
    v_fmamk_f32 v162, v160, 0x41900000, v161
    v_sin_f32 v106, v90
    v_sin_f32 v163, v162
    v_cos_f32 v90, v90
    v_cos_f32 v162, v162
    v_cvt_pk_f16_f32 v106, v106, v163
    v_cvt_pk_f16_f32 v90, v90, v162
    v_fmamk_f32 v91, v160, 0x41a00000, v161
    v_fmamk_f32 v162, v160, 0x41b00000, v161
    v_sin_f32 v107, v91
    v_sin_f32 v163, v162
    v_cos_f32 v91, v91
    v_cos_f32 v162, v162
    v_cvt_pk_f16_f32 v107, v107, v163
    v_cvt_pk_f16_f32 v91, v91, v162
    v_fmamk_f32 v92, v160, 0x42800000, v161
    v_fmamk_f32 v162, v160, 0x42840000, v161
    v_sin_f32 v108, v92
    v_sin_f32 v163, v162
    v_cos_f32 v92, v92
    v_cos_f32 v162, v162
    v_cvt_pk_f16_f32 v108, v108, v163
    v_cvt_pk_f16_f32 v92, v92, v162
    v_fmamk_f32 v93, v160, 0x42880000, v161
    v_fmamk_f32 v162, v160, 0x428c0000, v161
    v_sin_f32 v109, v93
    v_sin_f32 v163, v162
    v_cos_f32 v93, v93
    v_cos_f32 v162, v162
    v_cvt_pk_f16_f32 v109, v109, v163
    v_cvt_pk_f16_f32 v93, v93, v162
    v_fmamk_f32 v94, v160, 0x42a00000, v161
    v_fmamk_f32 v162, v160, 0x42a40000, v161
    v_sin_f32 v110, v94
    v_sin_f32 v163, v162
    v_cos_f32 v94, v94
    v_cos_f32 v162, v162
    v_cvt_pk_f16_f32 v110, v110, v163
    v_cvt_pk_f16_f32 v94, v94, v162
    v_fmamk_f32 v95, v160, 0x42a80000, v161
    v_fmamk_f32 v162, v160, 0x42ac0000, v161
    v_sin_f32 v111, v95
    v_sin_f32 v163, v162
    v_cos_f32 v95, v95
    v_cos_f32 v162, v162
    v_cvt_pk_f16_f32 v111, v111, v163
    v_cvt_pk_f16_f32 v95, v95, v162
    v_fmamk_f32 v96, v160, 0x3f800000, v161
    v_fmamk_f32 v162, v160, 0x40400000, v161
    v_sin_f32 v112, v96
    v_sin_f32 v163, v162
    v_cos_f32 v96, v96
    v_cos_f32 v162, v162
    v_cvt_pk_f16_f32 v112, v112, v163
    v_cvt_pk_f16_f32 v96, v96, v162
    v_fmamk_f32 v97, v160, 0x40a00000, v161
    v_fmamk_f32 v162, v160, 0x40e00000, v161
    v_sin_f32 v113, v97
    v_sin_f32 v163, v162
    v_cos_f32 v97, v97
    v_cos_f32 v162, v162
    v_cvt_pk_f16_f32 v113, v113, v163
    v_cvt_pk_f16_f32 v97, v97, v162
    v_fmamk_f32 v98, v160, 0x41880000, v161
    v_fmamk_f32 v162, v160, 0x41980000, v161
    v_sin_f32 v114, v98
    v_sin_f32 v163, v162
    v_cos_f32 v98, v98
    v_cos_f32 v162, v162
    v_cvt_pk_f16_f32 v114, v114, v163
    v_cvt_pk_f16_f32 v98, v98, v162
    v_fmamk_f32 v99, v160, 0x41a80000, v161
    v_fmamk_f32 v162, v160, 0x41b80000, v161
    v_sin_f32 v115, v99
    v_sin_f32 v163, v162
    v_cos_f32 v99, v99
    v_cos_f32 v162, v162
    v_cvt_pk_f16_f32 v115, v115, v163
    v_cvt_pk_f16_f32 v99, v99, v162
    v_fmamk_f32 v100, v160, 0x42820000, v161
    v_fmamk_f32 v162, v160, 0x42860000, v161
    v_sin_f32 v116, v100
    v_sin_f32 v163, v162
    v_cos_f32 v100, v100
    v_cos_f32 v162, v162
    v_cvt_pk_f16_f32 v116, v116, v163
    v_cvt_pk_f16_f32 v100, v100, v162
    v_fmamk_f32 v101, v160, 0x428a0000, v161
    v_fmamk_f32 v162, v160, 0x428e0000, v161
    v_sin_f32 v117, v101
    v_sin_f32 v163, v162
    v_cos_f32 v101, v101
    v_cos_f32 v162, v162
    v_cvt_pk_f16_f32 v117, v117, v163
    v_cvt_pk_f16_f32 v101, v101, v162
    v_fmamk_f32 v102, v160, 0x42a20000, v161
    v_fmamk_f32 v162, v160, 0x42a60000, v161
    v_sin_f32 v118, v102
    v_sin_f32 v163, v162
    v_cos_f32 v102, v102
    v_cos_f32 v162, v162
    v_cvt_pk_f16_f32 v118, v118, v163
    v_cvt_pk_f16_f32 v102, v102, v162
    v_fmamk_f32 v103, v160, 0x42aa0000, v161
    v_fmamk_f32 v162, v160, 0x42ae0000, v161
    v_sin_f32 v119, v103
    v_sin_f32 v163, v162
    v_cos_f32 v103, v103
    v_cos_f32 v162, v162
    v_cvt_pk_f16_f32 v119, v119, v163
    v_cvt_pk_f16_f32 v103, v103, v162
    v_cmp_gt_u32 vcc, 16, v2
    v_and_b32 v162, 1, v2
    v_lshlrev_b32 v162, 15, v162
    v_or_b32 v162, 0x3c00, v162
    v_and_b32 v160, 0xffff0000, v104
    v_or_b32 v162, v162, v160
    v_cndmask_b32 v104, v104, v162, vcc
    s_mul_i32 s51, s46, 528384
    s_add_u32 s51, s51, 2097152
    s_mul_i32 s54, s47, 16512
    s_lshl_b32 s32, s30, 12
    s_add_u32 s50, s51, s54
    s_add_u32 s50, s50, s32
    s_add_u32 s55, s47, 1
    s_and_b32 s55, s55, 31
    s_mul_i32 s55, s55, 16512
    v_add_u32 v250, s32, v3
    v_add_u32 v199, s76, v3
    v_lshl_add_u32 v200, v2, 7, s32
    v_and_b32 v1, 2, v2
    v_lshl_add_u32 v200, v1, 3, v200
    v_and_b32 v1, 0x70, v3
    v_add_u32 v1, 16384, v1
    s_mov_b32 vcc_lo, 0
    s_mov_b32 vcc_hi, -1
    v_cndmask_b32 v200, v200, v1, vcc
    s_mov_b32 vcc_hi, 0xff
    v_mov_b32 v1, s55
    v_mov_b32 v201, s54
    v_cndmask_b32 v1, v1, v201, vcc
    v_mov_b32 v201, 16640
    v_cndmask_b32 v201, v201, v0, vcc
    v_add_u32 v201, v201, v200
    v_add_u32 v200, v1, v200
    v_lshrrev_b32 v251, 5, v2
    v_lshlrev_b32 v251, 11, v251
    v_bfe_u32 v1, v2, 2, 3
    v_lshl_add_u32 v251, v1, 7, v251
    v_and_b32 v1, 3, v2
    v_lshl_add_u32 v251, v1, 5, v251
    v_bfe_u32 v1, v2, 3, 1
    v_lshl_add_u32 v251, v1, 4, v251
    v_bfe_u32 v1, v2, 4, 1
    v_lshl_add_u32 v251, v1, 3, v251
    v_xor_b32 v252, 16, v251
    v_xor_b32 v253, 8, v251
    v_xor_b32 v254, 24, v251
    v_cmp_gt_u32 vcc, 4, v2
    v_mov_b32 v1, 16384
    s_nop 0
    v_cndmask_b32 v1, v0, v1, vcc
    v_add_u32 v206, v253, v1
    v_add_u32 v207, v254, v1
    s_mov_b32 vcc_lo, 0x88888888
    s_mov_b32 vcc_hi, 0x88888888
    v_mov_b32 v1, 16544
    v_cndmask_b32 v1, 32, v1, vcc
    v_add_u32 v202, v251, v1
    v_add_u32 v203, v253, v1
    v_add_u32 v204, v206, v1
    s_waitcnt vmcnt(0)
L_stat_check:
    v_cmp_ne_u64 vcc, s[28:29], v[26:27]
    s_nop 0
    s_cbranch_vccz L_stat_got
    s_cmp_eq_u32 s35, 0
    s_cbranch_scc1 L_stat_got
    s_sub_u32 s35, s35, 1
    s_sleep 2
    s_mov_b64 exec, vcc
    buffer_load_dwordx4 v[24:27], v6, s[12:15], s49 offen sc1
    s_mov_b64 exec, -1
    s_waitcnt vmcnt(0)
    s_branch L_stat_check
L_stat_got:
    v_cndmask_b32 v24, v24, v25, s[88:89]
    v_mov_b32 v32, v24
    s_nop 1
    v_permlane32_swap_b32 v24, v32
    v_mov_b32 v28, v24
    v_mov_b32 v36, v32
    s_nop 0
    v_permlane16_swap_b32 v24, v28
    v_permlane16_swap_b32 v32, v36
    v_lshlrev_b32 v26, 16, v24
    v_and_b32 v24, 0xffff0000, v24
    v_rcp_f32 v24, v24
    v_lshlrev_b32 v30, 16, v28
    v_and_b32 v28, 0xffff0000, v28
    v_rcp_f32 v28, v28
    v_lshlrev_b32 v34, 16, v32
    v_and_b32 v32, 0xffff0000, v32
    v_rcp_f32 v32, v32
    v_lshlrev_b32 v38, 16, v36
    v_and_b32 v36, 0xffff0000, v36
    v_rcp_f32 v36, v36
    v_mul_f32 v24, 0xbfb8aa3b, v24
    v_mul_f32_e64 v26, -v26, v24
    v_mul_f32 v28, 0xbfb8aa3b, v28
    v_mul_f32_e64 v30, -v30, v28
    v_mul_f32 v32, 0xbfb8aa3b, v32
    v_mul_f32_e64 v34, -v34, v32
    v_mul_f32 v36, 0xbfb8aa3b, v36
    v_mul_f32_e64 v38, -v38, v36
    ds_read_b128 v[8:11], v208 offset:0
    ds_read_b128 v[12:15], v208 offset:1024
    s_waitcnt lgkmcnt(0)
    v_lshlrev_b32 v40, 16, v8
    v_and_b32 v41, 0xffff0000, v8
    v_lshlrev_b32 v42, 16, v9
    v_and_b32 v43, 0xffff0000, v9
    v_lshlrev_b32 v44, 16, v10
    v_and_b32 v45, 0xffff0000, v10
    v_lshlrev_b32 v46, 16, v11
    v_and_b32 v47, 0xffff0000, v11
    v_lshlrev_b32 v48, 16, v12
    v_and_b32 v55, 0xffff0000, v12
    v_lshlrev_b32 v54, 16, v13
    v_and_b32 v53, 0xffff0000, v13
    v_lshlrev_b32 v52, 16, v14
    v_and_b32 v51, 0xffff0000, v14
    v_lshlrev_b32_e64 v50, 16, v15
    v_and_b32 v49, 0xffff0000, v15
    v_pk_fma_f32 v[120:121], v[40:41], v[24:25], v[26:27] op_sel_hi:[1,0,0]
    v_pk_fma_f32 v[122:123], v[42:43], v[24:25], v[26:27] op_sel_hi:[1,0,0]
    v_pk_fma_f32 v[124:125], v[44:45], v[24:25], v[26:27] op_sel_hi:[1,0,0]
    v_pk_fma_f32 v[126:127], v[46:47], v[24:25], v[26:27] op_sel_hi:[1,0,0]
    v_pk_fma_f32 v[128:129], v[48:49], v[28:29], v[30:31] op_sel_hi:[1,0,0]
    v_pk_fma_f32 v[130:131], v[50:51], v[28:29], v[30:31] op_sel_hi:[1,0,0]
    v_pk_fma_f32 v[132:133], v[52:53], v[28:29], v[30:31] op_sel_hi:[1,0,0]
    v_pk_fma_f32 v[134:135], v[54:55], v[28:29], v[30:31] op_sel_hi:[1,0,0]
    v_exp_f32 v216, v120
    v_exp_f32 v217, v121
    v_exp_f32 v218, v122
    v_exp_f32 v219, v123
    v_exp_f32 v220, v124
    v_exp_f32 v221, v125
    v_exp_f32 v222, v126
    v_exp_f32 v223, v127
    v_exp_f32 v224, v128
    v_exp_f32 v225, v129
    v_exp_f32 v226, v130
    v_exp_f32 v227, v131
    v_exp_f32 v228, v132
    v_exp_f32 v229, v133
    v_exp_f32 v230, v134
    v_exp_f32 v231, v135
    v_pk_add_f32 v[216:217], v[216:217], 1.0 op_sel_hi:[1,0]
    v_pk_add_f32 v[218:219], v[218:219], 1.0 op_sel_hi:[1,0]
    v_pk_add_f32 v[220:221], v[220:221], 1.0 op_sel_hi:[1,0]
    v_pk_add_f32 v[222:223], v[222:223], 1.0 op_sel_hi:[1,0]
    v_pk_add_f32 v[224:225], v[224:225], 1.0 op_sel_hi:[1,0]
    v_pk_add_f32 v[226:227], v[226:227], 1.0 op_sel_hi:[1,0]
    v_pk_add_f32 v[228:229], v[228:229], 1.0 op_sel_hi:[1,0]
    v_pk_add_f32 v[230:231], v[230:231], 1.0 op_sel_hi:[1,0]
    v_rcp_f32 v216, v216
    v_rcp_f32 v217, v217
    v_rcp_f32 v218, v218
    v_rcp_f32 v219, v219
    v_rcp_f32 v220, v220
    v_rcp_f32 v221, v221
    v_rcp_f32 v222, v222
    v_rcp_f32 v223, v223
    v_rcp_f32 v224, v224
    v_rcp_f32 v225, v225
    v_rcp_f32 v226, v226
    v_rcp_f32 v227, v227
    v_rcp_f32 v228, v228
    v_rcp_f32 v229, v229
    v_rcp_f32 v230, v230
    v_rcp_f32 v231, v231
    v_pk_mul_f32 v[120:121], v[120:121], v[216:217]
    v_pk_mul_f32 v[122:123], v[122:123], v[218:219]
    v_pk_mul_f32 v[124:125], v[124:125], v[220:221]
    v_pk_mul_f32 v[126:127], v[126:127], v[222:223]
    v_pk_mul_f32 v[128:129], v[128:129], v[224:225]
    v_pk_mul_f32 v[130:131], v[130:131], v[226:227]
    v_pk_mul_f32 v[132:133], v[132:133], v[228:229]
    v_pk_mul_f32 v[134:135], v[134:135], v[230:231]
L_sync6:
    ds_read_b32 v1, v0 offset:42848
    s_add_u32 s92, s92, 1
    s_bitcmp1_b32 s92, 20
    s_cbranch_scc1 L_sync6x
    s_waitcnt lgkmcnt(0)
    v_readfirstlane_b32 s31, v1
    s_nop 0
    s_cmp_ge_u32 s31, 4
    s_cbranch_scc0 L_sync6
L_sync6x:
    s_add_u32 m0, s76, 2048
    s_nop 0
    buffer_load_dwordx4 v249, s[8:11], 0 offen lds
    s_add_u32 m0, s76, 3072
    s_nop 0
    buffer_load_dwordx4 v205, s[8:11], 0 offen lds
L_sync7:
    ds_read_b32 v1, v0 offset:42844
    ds_read_b32 v198, v0 offset:41556
    s_add_u32 s92, s92, 1
    s_bitcmp1_b32 s92, 20
    s_cbranch_scc1 L_sync7x
    s_waitcnt lgkmcnt(1)
    v_readfirstlane_b32 s31, v1
    s_nop 0
    s_cmp_ge_u32 s31, 1
    s_cbranch_scc0 L_sync7
L_sync7x:
    v_and_b32 v6, 48, v2
    v_lshlrev_b32 v6, 1, v6
    v_mov_b32 v209, 2147483392
    s_waitcnt lgkmcnt(0)
    v_readfirstlane_b32 s33, v198
    s_nop 0
    s_andn2_b32 s33, 0x7ff, s33
    s_sub_u32 s31, 0, s33
    s_and_b32 s31, s31, 2047
    s_sub_u32 s32, s33, 1024
    s_sub_u32 s34, s31, 1024
    v_cmp_eq_u32 vcc, s33, v7
    v_cmp_eq_u32 s[54:55], s33, v248
    s_nop 0
    v_cndmask_b32 v4, v4, v209, vcc
    v_cmp_eq_u32 vcc, s31, v7
    v_cmp_eq_u32 s[56:57], s31, v248
    s_nop 0
    v_cndmask_b32 v5, v5, v209, vcc
    v_cmp_eq_u32 vcc, s32, v7
    v_cmp_eq_u32 s[58:59], s32, v248
    s_nop 0
    v_cndmask_b32 v249, v249, v209, vcc
    v_cmp_eq_u32 vcc, s34, v7
    v_cmp_eq_u32 s[60:61], s34, v248
    s_nop 0
    v_cndmask_b32 v205, v205, v209, vcc
    s_or_b64 s[62:63], s[54:55], s[58:59]
    s_or_b64 s[64:65], s[56:57], s[60:61]
    s_waitcnt vmcnt(0)
    buffer_load_dwordx4 v[72:75], v3, s[12:15], s50 offen offset:0 sc1
    buffer_load_dwordx4 v[76:79], v3, s[12:15], s50 offen offset:1024 sc1
    buffer_load_dwordx4 v[80:83], v3, s[12:15], s50 offen offset:2048 sc1
    buffer_load_dwordx4 v[84:87], v3, s[12:15], s50 offen offset:3072 sc1
    s_mov_b32 exec_hi, 0x1ff
    buffer_load_dwordx4 v[212:215], v200, s[12:15], s51 offen sc1
    s_mov_b32 exec_hi, -1
    s_setprio 2
    ds_read_b128 v[16:19], v208 offset:2048
    ds_read_b128 v[20:23], v208 offset:3072
    s_waitcnt lgkmcnt(0)
    v_lshlrev_b32 v56, 16, v16
    v_and_b32 v57, 0xffff0000, v16
    v_lshlrev_b32 v58, 16, v17
    v_and_b32 v59, 0xffff0000, v17
    v_lshlrev_b32 v60, 16, v18
    v_and_b32 v61, 0xffff0000, v18
    v_lshlrev_b32 v62, 16, v19
    v_and_b32 v63, 0xffff0000, v19
    v_lshlrev_b32 v64, 16, v20
    v_and_b32 v71, 0xffff0000, v20
    v_lshlrev_b32 v70, 16, v21
    v_and_b32 v69, 0xffff0000, v21
    v_lshlrev_b32 v68, 16, v22
    v_and_b32 v67, 0xffff0000, v22
    v_lshlrev_b32 v66, 16, v23
    v_and_b32 v65, 0xffff0000, v23
    v_pk_fma_f32 v[136:137], v[56:57], v[32:33], v[34:35] op_sel_hi:[1,0,0]
    v_pk_fma_f32 v[138:139], v[58:59], v[32:33], v[34:35] op_sel_hi:[1,0,0]
    v_pk_fma_f32 v[140:141], v[60:61], v[32:33], v[34:35] op_sel_hi:[1,0,0]
    v_pk_fma_f32 v[142:143], v[62:63], v[32:33], v[34:35] op_sel_hi:[1,0,0]
    v_pk_fma_f32 v[144:145], v[64:65], v[36:37], v[38:39] op_sel_hi:[1,0,0]
    v_pk_fma_f32 v[146:147], v[66:67], v[36:37], v[38:39] op_sel_hi:[1,0,0]
    v_pk_fma_f32 v[148:149], v[68:69], v[36:37], v[38:39] op_sel_hi:[1,0,0]
    v_pk_fma_f32 v[150:151], v[70:71], v[36:37], v[38:39] op_sel_hi:[1,0,0]
    v_exp_f32 v232, v136
    v_exp_f32 v233, v137
    v_exp_f32 v234, v138
    v_exp_f32 v235, v139
    v_exp_f32 v236, v140
    v_exp_f32 v237, v141
    v_exp_f32 v238, v142
    v_exp_f32 v239, v143
    v_exp_f32 v240, v144
    v_exp_f32 v241, v145
    v_exp_f32 v242, v146
    v_exp_f32 v243, v147
    v_exp_f32 v244, v148
    v_exp_f32 v245, v149
    v_exp_f32 v246, v150
    v_exp_f32 v247, v151
    v_pk_add_f32 v[232:233], v[232:233], 1.0 op_sel_hi:[1,0]
    v_pk_add_f32 v[234:235], v[234:235], 1.0 op_sel_hi:[1,0]
    v_pk_add_f32 v[236:237], v[236:237], 1.0 op_sel_hi:[1,0]
    v_pk_add_f32 v[238:239], v[238:239], 1.0 op_sel_hi:[1,0]
    v_pk_add_f32 v[240:241], v[240:241], 1.0 op_sel_hi:[1,0]
    v_pk_add_f32 v[242:243], v[242:243], 1.0 op_sel_hi:[1,0]
    v_pk_add_f32 v[244:245], v[244:245], 1.0 op_sel_hi:[1,0]
    v_pk_add_f32 v[246:247], v[246:247], 1.0 op_sel_hi:[1,0]
    v_rcp_f32 v232, v232
    v_rcp_f32 v233, v233
    v_rcp_f32 v234, v234
    v_rcp_f32 v235, v235
    v_rcp_f32 v236, v236
    v_rcp_f32 v237, v237
    v_rcp_f32 v238, v238
    v_rcp_f32 v239, v239
    v_rcp_f32 v240, v240
    v_rcp_f32 v241, v241
    v_rcp_f32 v242, v242
    v_rcp_f32 v243, v243
    v_rcp_f32 v244, v244
    v_rcp_f32 v245, v245
    v_rcp_f32 v246, v246
    v_rcp_f32 v247, v247
    v_pk_mul_f32 v[136:137], v[136:137], v[232:233]
    v_pk_mul_f32 v[138:139], v[138:139], v[234:235]
    v_pk_mul_f32 v[140:141], v[140:141], v[236:237]
    v_pk_mul_f32 v[142:143], v[142:143], v[238:239]
    v_pk_mul_f32 v[144:145], v[144:145], v[240:241]
    v_pk_mul_f32 v[146:147], v[146:147], v[242:243]
    v_pk_mul_f32 v[148:149], v[148:149], v[244:245]
    v_pk_mul_f32 v[150:151], v[150:151], v[246:247]
L_z_wait:
    s_setprio 2
    s_waitcnt vmcnt(4)
    v_xor_b32 v160, v210, v72
    v_xor_b32 v161, v210, v73
    v_xor_b32 v162, v210, v74
    v_xor_b32 v163, v210, v75
    ds_write_b128 v250, v[160:163] offset:0
    v_or3_b32 v1, v160, v161, v162
    v_or_b32 v1, v1, v163
    s_waitcnt vmcnt(3)
    v_xor_b32 v164, v210, v76
    v_xor_b32 v165, v210, v77
    v_xor_b32 v166, v210, v78
    v_xor_b32 v167, v210, v79
    ds_write_b128 v250, v[164:167] offset:1024
    v_or3_b32 v1, v1, v164, v165
    v_or3_b32 v1, v1, v166, v167
    s_waitcnt vmcnt(2)
    v_xor_b32 v168, v210, v80
    v_xor_b32 v169, v210, v81
    v_xor_b32 v170, v210, v82
    v_xor_b32 v171, v210, v83
    ds_write_b128 v250, v[168:171] offset:2048
    v_or3_b32 v1, v1, v168, v169
    v_or3_b32 v1, v1, v170, v171
    s_waitcnt vmcnt(1)
    v_xor_b32 v172, v210, v84
    v_xor_b32 v173, v210, v85
    v_xor_b32 v174, v210, v86
    v_xor_b32 v175, v210, v87
    ds_write_b128 v250, v[172:175] offset:3072
    v_or3_b32 v1, v1, v172, v173
    v_or3_b32 v1, v1, v174, v175
    s_waitcnt vmcnt(0)
    v_xor_b32 v176, v210, v212
    v_xor_b32 v177, v210, v213
    v_xor_b32 v178, v210, v214
    v_xor_b32 v179, v210, v215
    s_mov_b32 exec_hi, 0x1ff
    ds_write_b128 v201, v[176:179]
    s_mov_b32 exec_hi, -1
    v_or3_b32 v1, v1, v176, v177
    v_or3_b32 v1, v1, v178, v179
    v_and_b32 v1, 0x30003, v1
    v_cmp_ne_u32 vcc, 0, v1
    s_nop 0
    s_cbranch_vccz L_z_got
    s_cmp_eq_u32 s35, 0
    s_cbranch_scc1 L_z_got
    s_sub_u32 s35, s35, 1
    s_sleep 2
    s_mov_b64 exec, vcc
    buffer_load_dwordx4 v[72:75], v3, s[12:15], s50 offen offset:0 sc1
    buffer_load_dwordx4 v[76:79], v3, s[12:15], s50 offen offset:1024 sc1
    buffer_load_dwordx4 v[80:83], v3, s[12:15], s50 offen offset:2048 sc1
    buffer_load_dwordx4 v[84:87], v3, s[12:15], s50 offen offset:3072 sc1
    s_and_b32 exec_hi, exec_hi, 0x1ff
    s_or_b32 exec_lo, exec_lo, 1
    buffer_load_dwordx4 v[212:215], v200, s[12:15], s51 offen sc1
    s_mov_b64 exec, -1
    s_waitcnt lgkmcnt(0)
    s_branch L_z_wait
L_z_got:
    s_mov_b64 exec, 1
    ds_add_u32 v0, v255 offset:42832
    s_mov_b64 exec, -1
L_sync8:
    ds_read_b32 v1, v0 offset:42832
    ds_read_b64_tr_b16 v[152:153], v251 offset:0
    ds_read_b64_tr_b16 v[154:155], v251 offset:1024
    ds_read_b64_tr_b16 v[156:157], v252 offset:0
    ds_read_b64_tr_b16 v[158:159], v252 offset:1024
    s_add_u32 s92, s92, 1
    s_bitcmp1_b32 s92, 20
    s_cbranch_scc1 L_sync8x
    s_waitcnt lgkmcnt(4)
    v_readfirstlane_b32 s31, v1
    s_nop 0
    s_cmp_ge_u32 s31, 4
    s_cbranch_scc0 L_sync8
L_sync8x:
    ds_read_b64_tr_b16 v[160:161], v251 offset:4096
    ds_read_b64_tr_b16 v[162:163], v251 offset:5120
    ds_read_b64_tr_b16 v[164:165], v252 offset:4096
    ds_read_b64_tr_b16 v[166:167], v252 offset:5120
    ds_read_b64_tr_b16 v[168:169], v251 offset:8192
    ds_read_b64_tr_b16 v[170:171], v251 offset:9216
    ds_read_b64_tr_b16 v[172:173], v252 offset:8192
    ds_read_b64_tr_b16 v[174:175], v252 offset:9216
    s_waitcnt lgkmcnt(8)
    v_mfma_f32_16x16x32_f16 v[216:219], v[152:155], v[88:91], 0
    v_mfma_f32_16x16x32_f16 v[220:223], v[156:159], v[88:91], 0
    ds_read_b64_tr_b16 v[176:177], v251 offset:12288
    ds_read_b64_tr_b16 v[178:179], v251 offset:13312
    ds_read_b64_tr_b16 v[180:181], v252 offset:12288
    ds_read_b64_tr_b16 v[182:183], v252 offset:13312
    s_waitcnt lgkmcnt(8)
    v_mfma_f32_16x16x32_f16 v[216:219], v[160:163], v[92:95], v[216:219]
    v_mfma_f32_16x16x32_f16 v[220:223], v[164:167], v[92:95], v[220:223]
    ds_read_b64_tr_b16 v[152:153], v206 offset:0
    ds_read_b64_tr_b16 v[154:155], v253 offset:1024
    ds_read_b64_tr_b16 v[156:157], v207 offset:0
    ds_read_b64_tr_b16 v[158:159], v254 offset:1024
    s_waitcnt lgkmcnt(8)
    v_mfma_f32_16x16x32_f16 v[224:227], v[168:171], v[96:99], 0
    v_mfma_f32_16x16x32_f16 v[228:231], v[172:175], v[96:99], 0
    ds_read_b64_tr_b16 v[160:161], v253 offset:4096
    ds_read_b64_tr_b16 v[162:163], v253 offset:5120
    ds_read_b64_tr_b16 v[164:165], v254 offset:4096
    ds_read_b64_tr_b16 v[166:167], v254 offset:5120
    s_waitcnt lgkmcnt(8)
    v_mfma_f32_16x16x32_f16 v[224:227], v[176:179], v[100:103], v[224:227]
    v_mfma_f32_16x16x32_f16 v[228:231], v[180:183], v[100:103], v[228:231]
    ds_read_b64_tr_b16 v[168:169], v253 offset:8192
    ds_read_b64_tr_b16 v[170:171], v253 offset:9216
    ds_read_b64_tr_b16 v[172:173], v254 offset:8192
    ds_read_b64_tr_b16 v[174:175], v254 offset:9216
    s_waitcnt lgkmcnt(8)
    v_mfma_f32_16x16x32_f16 v[216:219], v[152:155], v[104:107], v[216:219]
    v_mfma_f32_16x16x32_f16 v[220:223], v[156:159], v[104:107], v[220:223]
    ds_read_b64_tr_b16 v[176:177], v253 offset:12288
    ds_read_b64_tr_b16 v[178:179], v253 offset:13312
    ds_read_b64_tr_b16 v[180:181], v254 offset:12288
    ds_read_b64_tr_b16 v[182:183], v254 offset:13312
    s_waitcnt lgkmcnt(8)
    v_mfma_f32_16x16x32_f16 v[216:219], v[160:163], v[108:111], v[216:219]
    v_mfma_f32_16x16x32_f16 v[220:223], v[164:167], v[108:111], v[220:223]
    ds_read_b64_tr_b16 v[72:73], v202 offset:0
    ds_read_b64_tr_b16 v[74:75], v202 offset:1024
    ds_read_b64_tr_b16 v[76:77], v202 offset:4096
    ds_read_b64_tr_b16 v[78:79], v202 offset:5120
    s_waitcnt lgkmcnt(8)
    v_mfma_f32_16x16x32_f16 v[224:227], v[168:171], v[112:115], v[224:227]
    v_mfma_f32_16x16x32_f16 v[228:231], v[172:175], v[112:115], v[228:231]
    ds_read_b64_tr_b16 v[80:81], v202 offset:8192
    ds_read_b64_tr_b16 v[82:83], v202 offset:9216
    ds_read_b64_tr_b16 v[84:85], v202 offset:12288
    ds_read_b64_tr_b16 v[86:87], v202 offset:13312
    s_waitcnt lgkmcnt(8)
    v_mfma_f32_16x16x32_f16 v[224:227], v[176:179], v[116:119], v[224:227]
    v_mfma_f32_16x16x32_f16 v[228:231], v[180:183], v[116:119], v[228:231]
    ds_read_b64_tr_b16 v[240:241], v204 offset:0
    ds_read_b64_tr_b16 v[242:243], v203 offset:1024
    ds_read_b64_tr_b16 v[244:245], v203 offset:4096
    ds_read_b64_tr_b16 v[246:247], v203 offset:5120
    s_waitcnt lgkmcnt(8)
    ds_read_b64_tr_b16 v[184:185], v203 offset:8192
    ds_read_b64_tr_b16 v[186:187], v203 offset:9216
    ds_read_b64_tr_b16 v[188:189], v203 offset:12288
    ds_read_b64_tr_b16 v[190:191], v203 offset:13312
    v_mfma_f32_16x16x32_f16 v[232:235], v[72:75], v[88:91], 0
    v_mfma_f32_16x16x32_f16 v[232:235], v[76:79], v[92:95], v[232:235]
    s_waitcnt lgkmcnt(4)
    v_mfma_f32_16x16x32_f16 v[236:239], v[80:83], v[96:99], 0
    v_mfma_f32_16x16x32_f16 v[236:239], v[84:87], v[100:103], v[236:239]
    v_pk_add_f32 v[152:153], v[216:217], v[224:225]
    v_pk_add_f32 v[154:155], v[218:219], v[226:227]
    v_pk_add_f32 v[156:157], v[220:221], v[228:229]
    v_pk_add_f32 v[158:159], v[222:223], v[230:231]
    v_mfma_f32_16x16x32_f16 v[232:235], v[240:243], v[104:107], v[232:235]
    v_mfma_f32_16x16x32_f16 v[232:235], v[244:247], v[108:111], v[232:235]
    v_pk_fma_f32 v[40:41], v[152:153], v[120:121], v[40:41]
    v_pk_fma_f32 v[42:43], v[154:155], v[122:123], v[42:43]
    v_pk_fma_f32 v[44:45], v[156:157], v[124:125], v[44:45]
    v_pk_fma_f32 v[46:47], v[158:159], v[126:127], v[46:47]
    s_waitcnt lgkmcnt(0)
    s_nop 0
    v_mfma_f32_16x16x32_f16 v[236:239], v[184:187], v[112:115], v[236:239]
    v_mfma_f32_16x16x32_f16 v[236:239], v[188:191], v[116:119], v[236:239]
    v_cvt_pk_bf16_f32 v8, v40, v41
    v_cvt_pk_bf16_f32 v9, v42, v43
    v_cvt_pk_bf16_f32 v10, v44, v45
    v_cvt_pk_bf16_f32 v11, v46, v47
    ds_write_b128 v208, v[8:11] offset:0
    ds_read_b128 v[24:27], v199 offset:0
    v_pk_add_f32 v[160:161], v[216:217], v[224:225] neg_lo:[0,1] neg_hi:[0,1]
    v_pk_add_f32 v[162:163], v[218:219], v[226:227] neg_lo:[0,1] neg_hi:[0,1]
    v_pk_add_f32 v[164:165], v[220:221], v[228:229] neg_lo:[0,1] neg_hi:[0,1]
    v_pk_add_f32 v[166:167], v[222:223], v[230:231] neg_lo:[0,1] neg_hi:[0,1]
    s_cmp_eq_u64 s[62:63], 0
    s_cbranch_scc1 L_nodump0
    s_mov_b64 exec, s[54:55]
    ds_write_b128 v6, v[152:155] offset:42496
    ds_write_b128 v6, v[156:159] offset:42512
    s_mov_b64 exec, s[58:59]
    ds_write_b128 v6, v[160:163] offset:42496
    ds_write_b128 v6, v[164:167] offset:42512
    s_mov_b64 exec, 1
    ds_add_u32 v0, v255 offset:42836
    s_mov_b64 exec, -1
    s_waitcnt lgkmcnt(0)
L_nodump0:
    s_nop 0
    v_pk_fma_f32 v[56:57], v[160:161], v[136:137], v[56:57]
    v_pk_fma_f32 v[58:59], v[162:163], v[138:139], v[58:59]
    v_pk_fma_f32 v[60:61], v[164:165], v[140:141], v[60:61]
    v_pk_fma_f32 v[62:63], v[166:167], v[142:143], v[62:63]
    v_cvt_pk_bf16_f32 v16, v56, v57
    v_cvt_pk_bf16_f32 v17, v58, v59
    v_cvt_pk_bf16_f32 v18, v60, v61
    v_cvt_pk_bf16_f32 v19, v62, v63
    ds_write_b128 v208, v[16:19] offset:2048
    ds_read_b128 v[32:35], v199 offset:2048
    s_waitcnt lgkmcnt(2)
    buffer_store_dwordx4 v[24:27], v4, s[16:19], 0 offen sc1
    v_add_f32 v152, v232, v236
    v_sub_f32 v160, v232, v236
    s_cmp_eq_u64 s[64:65], 0
    s_cbranch_scc1 L_nodump1
    s_mov_b64 exec, s[56:57]
    ds_write_b128 v6, v[152:155] offset:42624
    ds_write_b128 v6, v[156:159] offset:42640
    s_mov_b64 exec, s[60:61]
    ds_write_b128 v6, v[160:163] offset:42624
    ds_write_b128 v6, v[164:167] offset:42640
    s_mov_b64 exec, 1
    ds_add_u32 v0, v255 offset:42864
    s_mov_b64 exec, -1
    s_waitcnt lgkmcnt(0)
L_nodump1:
    v_pk_fma_f32 v[48:49], v[152:153], v[128:129], v[48:49]
    v_pk_fma_f32 v[50:51], v[154:155], v[130:131], v[50:51]
    v_pk_fma_f32 v[52:53], v[156:157], v[132:133], v[52:53]
    v_pk_fma_f32 v[54:55], v[158:159], v[134:135], v[54:55]
    v_cvt_pk_bf16_f32 v12, v48, v55
    v_cvt_pk_bf16_f32 v13, v54, v53
    v_cvt_pk_bf16_f32 v14, v52, v51
    v_cvt_pk_bf16_f32 v15, v50, v49
    ds_write_b128 v208, v[12:15] offset:1024
    ds_read_b128 v[28:31], v199 offset:1024
    s_waitcnt lgkmcnt(2)
    s_nop 0
    buffer_store_dwordx4 v[32:35], v249, s[16:19], 0 offen sc1
    v_pk_fma_f32 v[64:65], v[160:161], v[144:145], v[64:65]
    v_pk_fma_f32 v[66:67], v[162:163], v[146:147], v[66:67]
    v_pk_fma_f32 v[68:69], v[164:165], v[148:149], v[68:69]
    v_pk_fma_f32 v[70:71], v[166:167], v[150:151], v[70:71]
    v_cvt_pk_bf16_f32 v20, v64, v71
    v_cvt_pk_bf16_f32 v21, v70, v69
    v_cvt_pk_bf16_f32 v22, v68, v67
    v_cvt_pk_bf16_f32 v23, v66, v65
    ds_write_b128 v208, v[20:23] offset:3072
    ds_read_b128 v[36:39], v199 offset:3072
    s_waitcnt lgkmcnt(2)
    buffer_store_dwordx4 v[28:31], v5, s[16:19], 0 offen sc1
    s_waitcnt lgkmcnt(0)
    buffer_store_dwordx4 v[36:39], v205, s[16:19], 0 offen sc1
    s_branch L_fin
L_dma_done:
    s_setprio 0
    s_lshr_b32 s31, s47, 2
    s_andn2_b32 s31, s31, s75
    s_add_u32 s50, s31, s46
    s_lshl_b32 s31, s50, 17
    s_bfe_u32 s32, s2, 0x20003
    s_lshl_b32 s32, s32, 2
    s_add_u32 s51, s32, s30
    s_lshl_b32 s32, s51, 7
    s_add_u32 s31, s31, s32
    v_lshrrev_b32 v6, 3, v2
    v_lshlrev_b32 v6, 11, v6
    v_and_b32 v7, 0x70, v3
    v_and_b32 v11, 16, v2
    v_lshlrev_b32 v11, 1, v11
    v_xor_b32 v11, v11, v7
    v_add3_u32 v6, v6, v11, s31
    v_xor_b32 v11, 64, v6
    s_lshl_b32 s74, s30, 13
    s_cmp_lt_u32 s30, 2
    s_mov_b32 s31, 125952
    s_cselect_b32 s31, 60416, s31
    s_add_u32 s74, s74, s31
    s_mov_b32 s60, 4096
    s_mov_b32 s61, 8192
    s_mov_b32 s62, 12288
    v_bfe_u32 v8, v2, 2, 3
    v_lshlrev_b32 v9, 5, v8
    s_lshl_b32 s31, s30, 6
    v_xor_b32 v9, s31, v9
    v_bfe_u32 v8, v2, 2, 2
    v_lshl_add_u32 v9, v8, 8, v9
    v_lshrrev_b32 v8, 4, v2
    v_lshl_add_u32 v9, v8, 11, v9
    v_and_b32 v10, 3, v2
    v_lshl_add_u32 v9, v10, 3, v9
    v_add_u32 v9, 76800, v9
    v_xor_b32 v10, 32, v9
    v_lshlrev_b32 v8, 4, v8
    s_lshr_b32 s31, s30, 1
    s_and_b32 s32, s31, s75
    s_lshl_b32 s32, s32, 8
    v_add_u32 v8, s32, v8
    s_cmp_eq_u32 s75, 0
    s_cselect_b32 s32, 12, 9
    s_lshl_b32 s31, s31, s32
    s_lshl_b32 s32, s46, 3
    s_add_u32 s32, s32, s47
    s_lshl_b32 s32, s32, 9
    s_add_u32 s31, s31, s32
    s_and_b32 s32, s30, 1
    s_lshl_b32 s32, s32, 8
    s_add_u32 s31, s31, s32
    s_add_u32 s31, s31, 262144
    v_lshl_add_u32 v13, v2, 3, s31
    s_waitcnt lgkmcnt(0)
    s_add_u32 s28, s28, 0x7f4a7c15
    s_addc_u32 s29, s29, 0x9e3779b9
    s_and_b32 s31, s28, 0xff
    v_mov_b32 v14, s31
    s_mov_b32 s49, 0xffffff00
    s_cmp_lg_u32 s30, 2
    s_cbranch_scc1 L_no_tlb
    s_mov_b32 s52, s44
    s_mov_b32 s53, s45
    s_mov_b32 s54, 0x400000
    s_mov_b32 s55, 0x00020000
    v_lshlrev_b32 v250, 18, v2
    v_min_u32 v250, 0x3ffffc, v250
    s_mov_b32 exec_lo, 0x1ffff
    s_mov_b32 exec_hi, 0x0
    buffer_load_dword v252, v250, s[52:55], 0 offen
    s_mov_b64 exec, 0x3f
    v_lshlrev_b32 v250, 20, v2
    v_add_u32 v250, 753664, v250
    v_min_u32 v250, 4491392, v250
    buffer_load_dword v251, v250, s[12:15], 0 offen
    s_mov_b64 exec, 3
    v_mul_u32_u24 v250, 0x1f800, v2
    v_add_u32 v250, v250, v6
    buffer_load_dword v253, v250, s[24:27], 0 offen
    s_mov_b64 exec, -1
L_no_tlb:
    s_cmp_lg_u32 s66, 0
    s_cbranch_scc1 L_tagged
    s_mov_b64 exec, 1
    ds_add_u32 v0, v255 offset:42872
    s_mov_b64 exec, -1
L_tagged:
    s_cmp_eq_u32 s30, 3
    s_cbranch_scc1 L_h1
    s_cmp_eq_u32 s66, 0
    s_cbranch_scc1 L_key
    s_cmp_lg_u32 s30, 0
    s_cbranch_scc1 L_follower
    s_setprio 3
    s_waitcnt vmcnt(16)
    s_mov_b64 exec, 1
    ds_add_u32 v0, v255 offset:42868
    s_mov_b64 exec, -1
    s_nop 0
    ds_read_b64_tr_b16 v[36:37], v9 offset:0
    ds_read_b64_tr_b16 v[38:39], v9 offset:1024
    ds_read_b64_tr_b16 v[40:41], v10 offset:0
    ds_read_b64_tr_b16 v[42:43], v10 offset:1024
    ds_read_b64_tr_b16 v[44:45], v9 offset:32768
    ds_read_b64_tr_b16 v[46:47], v9 offset:33792
    ds_read_b64_tr_b16 v[48:49], v10 offset:32768
    ds_read_b64_tr_b16 v[50:51], v10 offset:33792
    ds_read_b64_tr_b16 v[52:53], v9 offset:8192
    ds_read_b64_tr_b16 v[54:55], v9 offset:9216
    ds_read_b64_tr_b16 v[56:57], v10 offset:8192
    ds_read_b64_tr_b16 v[58:59], v10 offset:9216
    ds_read_b64_tr_b16 v[60:61], v9 offset:40960
    ds_read_b64_tr_b16 v[62:63], v9 offset:41984
    s_waitcnt lgkmcnt(12)
    ds_read_b64_tr_b16 v[64:65], v10 offset:40960
    ds_read_b64_tr_b16 v[66:67], v10 offset:41984
    s_waitcnt lgkmcnt(12)
    ds_read_b64_tr_b16 v[68:69], v9 offset:16384
    ds_read_b64_tr_b16 v[70:71], v9 offset:17408
    s_waitcnt lgkmcnt(12)
    ds_read_b64_tr_b16 v[72:73], v10 offset:16384
    ds_read_b64_tr_b16 v[74:75], v10 offset:17408
    s_waitcnt lgkmcnt(12)
    ds_read_b64_tr_b16 v[76:77], v9 offset:49152
    ds_read_b64_tr_b16 v[78:79], v9 offset:50176
    s_waitcnt lgkmcnt(12)
    ds_read_b64_tr_b16 v[80:81], v10 offset:49152
    ds_read_b64_tr_b16 v[82:83], v10 offset:50176
    s_waitcnt vmcnt(8)
    s_mov_b64 exec, 1
    ds_add_u32 v0, v255 offset:42868
    s_mov_b64 exec, -1
    s_branch L_d_first
L_follower:
    v_readfirstlane_b32 s52, v13
    s_and_b32 s32, s30, 1
    s_lshl_b32 s32, s32, 8
    s_sub_u32 s52, s52, s32
    s_lshl_b32 s31, s50, 12
    s_sub_u32 s31, s31, s32
    s_lshl_b32 s32, s51, 8
    s_add_u32 s31, s31, s32
    s_add_u32 s53, s31, 524288
    s_load_dword s54, s[12:13], s53
    s_load_dword s54, s[12:13], s52
    s_add_u32 s52, s52, 64
    s_add_u32 s53, s53, 64
    s_load_dword s54, s[12:13], s53
    s_load_dword s54, s[12:13], s52
    s_add_u32 s52, s52, 64
    s_add_u32 s53, s53, 64
    s_load_dword s54, s[12:13], s53
    s_load_dword s54, s[12:13], s52
    s_add_u32 s52, s52, 64
    s_add_u32 s53, s53, 64
    s_load_dword s54, s[12:13], s53
    s_load_dword s54, s[12:13], s52
    s_add_u32 s52, s52, 64
    s_add_u32 s53, s53, 64
    s_waitcnt lgkmcnt(0)
    s_load_dword s54, s[12:13], s53
    s_load_dword s54, s[12:13], s52
    s_add_u32 s52, s52, 64
    s_add_u32 s53, s53, 64
    s_load_dword s54, s[12:13], s53
    s_load_dword s54, s[12:13], s52
    s_add_u32 s52, s52, 64
    s_add_u32 s53, s53, 64
    s_load_dword s54, s[12:13], s53
    s_load_dword s54, s[12:13], s52
    s_add_u32 s52, s52, 64
    s_add_u32 s53, s53, 64
    s_load_dword s54, s[12:13], s53
    s_load_dword s54, s[12:13], s52
L_sync9:
    ds_read_b32 v1, v0 offset:42868
    s_add_u32 s92, s92, 1
    s_bitcmp1_b32 s92, 20
    s_cbranch_scc1 L_sync9x
    s_waitcnt lgkmcnt(0)
    v_readfirstlane_b32 s31, v1
    s_nop 0
    s_cmp_ge_u32 s31, 1
    s_cbranch_scc0 L_sync9
L_sync9x:
    s_setprio 3
    s_nop 0
    ds_read_b64_tr_b16 v[36:37], v9 offset:0
    ds_read_b64_tr_b16 v[38:39], v9 offset:1024
    ds_read_b64_tr_b16 v[40:41], v10 offset:0
    ds_read_b64_tr_b16 v[42:43], v10 offset:1024
    ds_read_b64_tr_b16 v[44:45], v9 offset:32768
    ds_read_b64_tr_b16 v[46:47], v9 offset:33792
    ds_read_b64_tr_b16 v[48:49], v10 offset:32768
    ds_read_b64_tr_b16 v[50:51], v10 offset:33792
    ds_read_b64_tr_b16 v[52:53], v9 offset:8192
    ds_read_b64_tr_b16 v[54:55], v9 offset:9216
    ds_read_b64_tr_b16 v[56:57], v10 offset:8192
    ds_read_b64_tr_b16 v[58:59], v10 offset:9216
    ds_read_b64_tr_b16 v[60:61], v9 offset:40960
    ds_read_b64_tr_b16 v[62:63], v9 offset:41984
    s_waitcnt lgkmcnt(12)
    ds_read_b64_tr_b16 v[64:65], v10 offset:40960
    ds_read_b64_tr_b16 v[66:67], v10 offset:41984
    s_waitcnt lgkmcnt(12)
    ds_read_b64_tr_b16 v[68:69], v9 offset:16384
    ds_read_b64_tr_b16 v[70:71], v9 offset:17408
    s_waitcnt lgkmcnt(12)
    ds_read_b64_tr_b16 v[72:73], v10 offset:16384
    ds_read_b64_tr_b16 v[74:75], v10 offset:17408
    s_waitcnt lgkmcnt(12)
    ds_read_b64_tr_b16 v[76:77], v9 offset:49152
    ds_read_b64_tr_b16 v[78:79], v9 offset:50176
    s_waitcnt lgkmcnt(12)
    ds_read_b64_tr_b16 v[80:81], v10 offset:49152
    ds_read_b64_tr_b16 v[82:83], v10 offset:50176
    s_add_u32 s67, s30, 0
L_sync10:
    ds_read_b32 v1, v0 offset:42868
    s_add_u32 s92, s92, 1
    s_bitcmp1_b32 s92, 20
    s_cbranch_scc1 L_sync10x
    s_waitcnt lgkmcnt(0)
    v_readfirstlane_b32 s31, v1
    s_nop 0
    s_cmp_ge_u32 s31, s67
    s_cbranch_scc0 L_sync10
L_sync10x:
L_d_first:
    s_add_u32 m0, s74, 0
    s_mov_b32 s31, 0
    buffer_load_dwordx4 v6, s[24:27], s31 offen nt lds
    s_add_u32 m0, s74, 1024
    s_mov_b32 s31, 16384
    buffer_load_dwordx4 v11, s[24:27], s31 offen nt lds
    s_add_u32 m0, s74, 2048
    s_mov_b32 s31, 32768
    buffer_load_dwordx4 v6, s[24:27], s31 offen nt lds
    s_add_u32 m0, s74, 3072
    s_mov_b32 s31, 49152
    buffer_load_dwordx4 v11, s[24:27], s31 offen nt lds
    s_add_u32 m0, s74, 4096
    s_mov_b32 s31, 65536
    buffer_load_dwordx4 v6, s[24:27], s31 offen nt lds
    s_cmp_lg_u32 s30, 0
    s_cbranch_scc1 L_k3_waitp
    s_waitcnt vmcnt(5)
    s_mov_b64 exec, 1
    ds_add_u32 v0, v255 offset:42868
    s_mov_b64 exec, -1
L_k3_waitp:
    s_waitcnt lgkmcnt(4)
    s_branch L_sync11a
L_sync11:
    s_waitcnt lgkmcnt(0)
L_sync11a:
    ds_read_b32 v1, v0 offset:42868
    ds_read_b64_tr_b16 v[84:85], v9 offset:24576
    ds_read_b64_tr_b16 v[86:87], v9 offset:25600
    ds_read_b64_tr_b16 v[88:89], v10 offset:24576
    ds_read_b64_tr_b16 v[90:91], v10 offset:25600
    ds_read_b64_tr_b16 v[92:93], v9 offset:57344
    ds_read_b64_tr_b16 v[94:95], v9 offset:58368
    ds_read_b64_tr_b16 v[96:97], v10 offset:57344
    ds_read_b64_tr_b16 v[98:99], v10 offset:58368
    s_add_u32 s92, s92, 1
    s_bitcmp1_b32 s92, 20
    s_cbranch_scc1 L_sync11x
    s_waitcnt lgkmcnt(8)
    v_readfirstlane_b32 s31, v1
    s_nop 0
    s_cmp_ge_u32 s31, 3
    s_cbranch_scc0 L_sync11
L_sync11x:
L_key:
    s_waitcnt lgkmcnt(0)
L_sync12:
    ds_read_b32 v1, v0 offset:42844
    ds_read_b64 v[18:19], v0 offset:41552
    ds_read_b128 v[20:23], v8 offset:41600
    ds_read_b128 v[24:27], v8 offset:41664
    ds_read_b128 v[28:31], v8 offset:41728
    ds_read_b128 v[32:35], v8 offset:41792
    s_add_u32 s92, s92, 1
    s_bitcmp1_b32 s92, 20
    s_cbranch_scc1 L_sync12x
    s_waitcnt lgkmcnt(5)
    v_readfirstlane_b32 s31, v1
    s_nop 0
    s_cmp_ge_u32 s31, 1
    s_cbranch_scc0 L_sync12
L_sync12x:
    s_cmp_eq_u32 s66, 0
    s_cbranch_scc1 L_idle
    s_branch L_xs_ok
L_h1:
    s_mov_b32 s63, 4096
    s_lshl_b32 s31, s47, 8
    v_lshlrev_b32 v15, 3, v2
    v_add_u32 v16, s31, v15
    s_cmp_lg_u32 s66, 0
    s_cbranch_scc1 L_gate
L_sync13:
    ds_read_b32 v1, v0 offset:42828
    s_add_u32 s92, s92, 1
    s_bitcmp1_b32 s92, 20
    s_cbranch_scc1 L_sync13x
    s_waitcnt lgkmcnt(0)
    v_readfirstlane_b32 s31, v1
    s_nop 0
    s_cmp_ge_u32 s31, 4
    s_cbranch_scc0 L_sync13
L_sync13x:
    s_branch L_gate_open
L_gate:
L_sync14:
    ds_read_b32 v1, v0 offset:42828
    s_add_u32 s92, s92, 1
    s_bitcmp1_b32 s92, 20
    s_cbranch_scc1 L_sync14x
    s_waitcnt lgkmcnt(0)
    v_readfirstlane_b32 s31, v1
    s_nop 0
    s_cmp_ge_u32 s31, 1
    s_cbranch_scc0 L_sync14
L_sync14x:
L_gate_open:
    s_setprio 3
    buffer_load_dwordx4 v[20:23], v3, s[12:15], s63 offen offset:0 sc1
    buffer_load_dwordx4 v[24:27], v3, s[12:15], s63 offen offset:1024 sc1
    buffer_load_dwordx4 v[28:31], v3, s[12:15], s63 offen offset:2048 sc1
    buffer_load_dwordx4 v[32:35], v3, s[12:15], s63 offen offset:3072 sc1
    s_mov_b64 exec, 1
    ds_add_u32 v0, v255 offset:42860
    s_mov_b64 exec, -1
    s_waitcnt vmcnt(0)
L_mi_check:
    v_cmp_ne_u64 s[52:53], s[28:29], v[22:23]
    v_cmp_ne_u64 s[54:55], s[28:29], v[26:27]
    v_cmp_ne_u64 s[56:57], s[28:29], v[30:31]
    v_cmp_ne_u64 s[58:59], s[28:29], v[34:35]
    v_max_u32 v18, v21, v25
    v_max3_u32 v18, v18, v29, v33
    s_or_b64 s[64:65], s[52:53], s[54:55]
    s_or_b64 vcc, s[56:57], s[58:59]
    s_or_b64 s[64:65], s[64:65], vcc
    s_cbranch_scc0 L_mi_got
    s_cmp_eq_u32 s35, 0
    s_cbranch_scc1 L_mi_got
    s_sub_u32 s35, s35, 1
    s_sleep 2
    s_mov_b64 exec, s[52:53]
    s_cbranch_execz L_mi_skip0
    buffer_load_dwordx4 v[20:23], v3, s[12:15], s63 offen offset:0 sc1
L_mi_skip0:
    s_mov_b64 exec, s[54:55]
    s_cbranch_execz L_mi_skip1
    buffer_load_dwordx4 v[24:27], v3, s[12:15], s63 offen offset:1024 sc1
L_mi_skip1:
    s_mov_b64 exec, s[56:57]
    s_cbranch_execz L_mi_skip2
    buffer_load_dwordx4 v[28:31], v3, s[12:15], s63 offen offset:2048 sc1
L_mi_skip2:
    s_mov_b64 exec, s[58:59]
    s_cbranch_execz L_mi_skip3
    buffer_load_dwordx4 v[32:35], v3, s[12:15], s63 offen offset:3072 sc1
L_mi_skip3:
    s_mov_b64 exec, -1
    s_waitcnt vmcnt(0)
    s_branch L_mi_check
L_mi_got:
    v_max_u32_dpp v19, v18, v18 row_ror:1 row_mask:0xf bank_mask:0xf
    s_nop 1
    v_max_u32_dpp v19, v19, v19 row_ror:2 row_mask:0xf bank_mask:0xf
    s_nop 1
    v_max_u32_dpp v19, v19, v19 row_ror:4 row_mask:0xf bank_mask:0xf
    s_nop 1
    v_max_u32_dpp v19, v19, v19 row_ror:8 row_mask:0xf bank_mask:0xf
    s_nop 0
    v_readlane_b32 s33, v19, 0
    v_readlane_b32 s31, v19, 16
    v_readlane_b32 s32, v19, 32
    v_readlane_b32 s34, v19, 48
    s_max_u32 s33, s33, s31
    s_max_u32 s32, s32, s34
    s_max_u32 s33, s33, s32
    s_andn2_b32 s31, 0x7ff, s33
    s_lshl_b32 s48, s31, 11
    buffer_load_dwordx2 v[150:151], v16, s[8:11], s48 offen
    s_mov_b64 exec, 1
    ds_add_u32 v0, v255 offset:42840
    s_mov_b64 exec, -1
    v_cmp_eq_u32 s[52:53], s33, v25
    v_cmp_eq_u32 s[54:55], s33, v29
    v_cmp_eq_u32 s[56:57], s33, v33
    v_cmp_eq_u32 vcc, s33, v18
    v_cndmask_b32 v19, v20, v24, s[52:53]
    v_cndmask_b32 v19, v19, v28, s[54:55]
    v_cndmask_b32 v19, v19, v32, s[56:57]
    s_ff1_i32_b64 s32, vcc
    v_readlane_b32 s34, v19, s32
    v_mov_b32 v19, s33
    s_nop 0
    v_mov_b32 v18, s34
    ds_write_b64 v0, v[18:19] offset:41552
    s_lshl_b32 s52, s34, 16
    s_and_b32 s32, s34, 0xffff0000
    v_rcp_f32 v148, s32
    s_cmp_eq_u32 s66, 0
    s_cbranch_scc1 L_h1_idle
L_sync15:
    ds_read_b32 v1, v0 offset:42868
    s_add_u32 s92, s92, 1
    s_bitcmp1_b32 s92, 20
    s_cbranch_scc1 L_sync15x
    s_waitcnt lgkmcnt(0)
    v_readfirstlane_b32 s31, v1
    s_nop 0
    s_cmp_ge_u32 s31, 1
    s_cbranch_scc0 L_sync15
L_sync15x:
    s_nop 0
    ds_read_b64_tr_b16 v[36:37], v9 offset:0
    ds_read_b64_tr_b16 v[38:39], v9 offset:1024
    ds_read_b64_tr_b16 v[40:41], v10 offset:0
    ds_read_b64_tr_b16 v[42:43], v10 offset:1024
    ds_read_b64_tr_b16 v[44:45], v9 offset:32768
    ds_read_b64_tr_b16 v[46:47], v9 offset:33792
    ds_read_b64_tr_b16 v[48:49], v10 offset:32768
    ds_read_b64_tr_b16 v[50:51], v10 offset:33792
    ds_read_b64_tr_b16 v[52:53], v9 offset:8192
    ds_read_b64_tr_b16 v[54:55], v9 offset:9216
    ds_read_b64_tr_b16 v[56:57], v10 offset:8192
    ds_read_b64_tr_b16 v[58:59], v10 offset:9216
    ds_read_b64_tr_b16 v[60:61], v9 offset:40960
    ds_read_b64_tr_b16 v[62:63], v9 offset:41984
    s_waitcnt lgkmcnt(12)
    ds_read_b64_tr_b16 v[64:65], v10 offset:40960
    ds_read_b64_tr_b16 v[66:67], v10 offset:41984
    s_waitcnt lgkmcnt(12)
    ds_read_b64_tr_b16 v[68:69], v9 offset:16384
    ds_read_b64_tr_b16 v[70:71], v9 offset:17408
    s_waitcnt lgkmcnt(12)
    ds_read_b64_tr_b16 v[72:73], v10 offset:16384
    ds_read_b64_tr_b16 v[74:75], v10 offset:17408
    s_waitcnt lgkmcnt(12)
    ds_read_b64_tr_b16 v[76:77], v9 offset:49152
    ds_read_b64_tr_b16 v[78:79], v9 offset:50176
    s_waitcnt lgkmcnt(12)
    ds_read_b64_tr_b16 v[80:81], v10 offset:49152
    ds_read_b64_tr_b16 v[82:83], v10 offset:50176
    s_waitcnt lgkmcnt(4)
    s_branch L_sync16a
L_sync16:
    s_waitcnt lgkmcnt(0)
L_sync16a:
    ds_read_b32 v1, v0 offset:42868
    ds_read_b64_tr_b16 v[84:85], v9 offset:24576
    ds_read_b64_tr_b16 v[86:87], v9 offset:25600
    ds_read_b64_tr_b16 v[88:89], v10 offset:24576
    ds_read_b64_tr_b16 v[90:91], v10 offset:25600
    ds_read_b64_tr_b16 v[92:93], v9 offset:57344
    ds_read_b64_tr_b16 v[94:95], v9 offset:58368
    ds_read_b64_tr_b16 v[96:97], v10 offset:57344
    ds_read_b64_tr_b16 v[98:99], v10 offset:58368
    s_add_u32 s92, s92, 1
    s_bitcmp1_b32 s92, 20
    s_cbranch_scc1 L_sync16x
    s_waitcnt lgkmcnt(8)
    v_readfirstlane_b32 s31, v1
    s_nop 0
    s_cmp_ge_u32 s31, 3
    s_cbranch_scc0 L_sync16
L_sync16x:
    s_waitcnt vmcnt(0) lgkmcnt(0)
    s_branch L_h1_x
L_h1_idle:
    s_waitcnt vmcnt(0)
L_h1_x:
    v_lshlrev_b32 v20, 16, v150
    v_and_b32 v21, 0xffff0000, v150
    v_lshlrev_b32 v22, 16, v151
    v_and_b32 v23, 0xffff0000, v151
    v_pk_add_f32 v[20:21], v[20:21], s[52:53] op_sel_hi:[1,0] neg_lo:[0,1] neg_hi:[0,1]
    v_pk_add_f32 v[22:23], v[22:23], s[52:53] op_sel_hi:[1,0] neg_lo:[0,1] neg_hi:[0,1]
    v_cvt_pk_bf16_f32 v150, v20, v21
    v_cvt_pk_bf16_f32 v151, v22, v23
    v_lshlrev_b32 v20, 16, v150
    v_and_b32 v21, 0xffff0000, v150
    v_lshlrev_b32 v22, 16, v151
    v_and_b32 v23, 0xffff0000, v151
    v_pk_mul_f32 v[20:21], v[20:21], v[148:149] op_sel_hi:[1,0]
    v_pk_mul_f32 v[22:23], v[22:23], v[148:149] op_sel_hi:[1,0]
    v_cvt_pk_bf16_f32 v150, v20, v21
    v_cvt_pk_bf16_f32 v151, v22, v23
    ds_write_b64 v15, v[150:151] offset:41600
    s_mov_b64 exec, 1
    ds_add_u32 v0, v255 offset:42844
    s_mov_b64 exec, -1
    s_cmp_eq_u32 s66, 0
    s_cbranch_scc1 L_idle
    ds_read_b128 v[20:23], v8 offset:41600
    ds_read_b128 v[24:27], v8 offset:41664
    ds_read_b128 v[28:31], v8 offset:41728
    ds_read_b128 v[32:35], v8 offset:41792
    s_add_u32 m0, s74, 0
    s_mov_b32 s31, 0
    s_nop 0
    buffer_load_dwordx4 v6, s[24:27], s31 offen nt lds
    s_add_u32 m0, s74, 1024
    s_mov_b32 s31, 16384
    buffer_load_dwordx4 v11, s[24:27], s31 offen nt lds
    s_add_u32 m0, s74, 2048
    s_mov_b32 s31, 32768
    buffer_load_dwordx4 v6, s[24:27], s31 offen nt lds
    s_add_u32 m0, s74, 3072
    s_mov_b32 s31, 49152
    buffer_load_dwordx4 v11, s[24:27], s31 offen nt lds
    s_add_u32 m0, s74, 4096
    s_mov_b32 s31, 65536
    buffer_load_dwordx4 v6, s[24:27], s31 offen nt lds
L_xs_ok:
    s_waitcnt lgkmcnt(3)
    v_mfma_f32_16x16x32_bf16 v[132:135], v[20:23], v[36:39], 0
    v_mfma_f32_16x16x32_bf16 v[136:139], v[20:23], v[40:43], 0
    v_mfma_f32_16x16x32_bf16 v[140:143], v[20:23], v[44:47], 0
    v_mfma_f32_16x16x32_bf16 v[144:147], v[20:23], v[48:51], 0
    s_waitcnt lgkmcnt(2)
    v_mfma_f32_16x16x32_bf16 v[132:135], v[24:27], v[52:55], v[132:135]
    v_mfma_f32_16x16x32_bf16 v[136:139], v[24:27], v[56:59], v[136:139]
    v_mfma_f32_16x16x32_bf16 v[140:143], v[24:27], v[60:63], v[140:143]
    v_mfma_f32_16x16x32_bf16 v[144:147], v[24:27], v[64:67], v[144:147]
    s_waitcnt lgkmcnt(1)
    v_mfma_f32_16x16x32_bf16 v[132:135], v[28:31], v[68:71], v[132:135]
    v_mfma_f32_16x16x32_bf16 v[136:139], v[28:31], v[72:75], v[136:139]
    v_mfma_f32_16x16x32_bf16 v[140:143], v[28:31], v[76:79], v[140:143]
    v_mfma_f32_16x16x32_bf16 v[144:147], v[28:31], v[80:83], v[144:147]
    v_readfirstlane_b32 s33, v19
    v_readfirstlane_b32 s34, v18
    s_waitcnt lgkmcnt(0)
    v_mfma_f32_16x16x32_bf16 v[132:135], v[32:35], v[84:87], v[132:135]
    v_mfma_f32_16x16x32_bf16 v[136:139], v[32:35], v[88:91], v[136:139]
    v_mfma_f32_16x16x32_bf16 v[140:143], v[32:35], v[92:95], v[140:143]
    v_mfma_f32_16x16x32_bf16 v[144:147], v[32:35], v[96:99], v[144:147]
    s_mov_b32 vcc_lo, 0xffff0000
    s_mov_b32 vcc_hi, 0
    s_lshl_b32 s31, s50, 12
    s_lshl_b32 s32, s30, 7
    s_add_u32 s31, s31, s32
    s_add_u32 s31, s31, 262144
    v_lshrrev_b32 v15, 3, v2
    v_lshlrev_b32 v15, 9, v15
    v_add3_u32 v15, v15, v7, s31
    v_cndmask_b32 v26, v132, v136, vcc
    v_cndmask_b32 v27, v140, v144, vcc
    v_and_or_b32 v26, v26, s49, v14
    v_and_or_b32 v27, v27, s49, v14
    s_mov_b32 exec_hi, 0
    buffer_store_dwordx2 v[26:27], v13, s[12:15], 0 offen sc1
    s_mov_b64 exec, -1
    s_add_u32 m0, s74, 5120
    s_mov_b32 s31, 81920
    buffer_load_dwordx4 v11, s[24:27], s31 offen nt lds
    s_add_u32 m0, s74, 6144
    s_mov_b32 s31, 98304
    buffer_load_dwordx4 v6, s[24:27], s31 offen nt lds
    s_add_u32 m0, s74, 7168
    s_mov_b32 s31, 114688
    buffer_load_dwordx4 v11, s[24:27], s31 offen nt lds
L_d_done:
    s_mov_b64 exec, 1
    ds_add_u32 v0, v255 offset:42848
    s_mov_b64 exec, -1
    s_cmp_eq_u32 s30, 1
    s_cselect_b32 s31, s2, 0
    s_cmp_lt_u32 s31, 192
    s_cbranch_scc1 L_no_hint
    s_and_b32 s31, s2, 31
    s_lshl_b32 s31, s31, 7
    s_add_u32 s31, s31, 12288
    v_mov_b32 v250, s28
    v_mov_b32 v251, s29
    s_mov_b64 exec, 1
    buffer_store_dwordx2 v[250:251], v0, s[12:15], s31 offen sc1
    s_mov_b64 exec, -1
L_no_hint:
    s_setprio 3
    v_and_b32 v16, 7, v2
    v_lshlrev_b32 v16, 2, v16
    v_lshrrev_b32 v17, 5, v2
    v_lshl_add_u32 v16, v17, 1, v16
    s_lshl_b32 s31, s30, 5
    v_add_u32 v16, s31, v16
    v_and_b32 v17, 48, v2
    v_bfe_u32 v9, v2, 3, 2
    v_lshlrev_b32 v9, 5, v9
    v_bfe_u32 v10, v2, 2, 2
    v_lshl_add_u32 v9, v10, 7, v9
    v_lshl_add_u32 v9, v17, 6, v9
    v_and_b32 v10, 3, v2
    v_lshlrev_b32 v10, 3, v10
    v_add3_u32 v9, v9, v10, s74
    v_xor_b32 v10, 32, v9
    v_xor_b32 v12, 96, v9
    v_xor_b32 v8, 64, v9
    s_lshl_b32 s31, s50, 12
    s_lshl_b32 s32, s51, 8
    s_add_u32 s31, s31, s32
    s_add_u32 s31, s31, 524288
    v_lshl_add_u32 v18, v2, 2, s31
    s_waitcnt vmcnt(5)
    s_waitcnt lgkmcnt(4)
    ds_read_b64_tr_b16 v[100:101], v9 offset:0
    ds_read_b64_tr_b16 v[102:103], v9 offset:512
    ds_read_b64_tr_b16 v[104:105], v10 offset:0
    ds_read_b64_tr_b16 v[106:107], v10 offset:512
    ds_read_b64_tr_b16 v[108:109], v8 offset:0
    ds_read_b64_tr_b16 v[110:111], v8 offset:512
    ds_read_b64_tr_b16 v[112:113], v12 offset:0
    ds_read_b64_tr_b16 v[114:115], v12 offset:512
    s_waitcnt vmcnt(0)
    buffer_load_dwordx4 v[20:23], v15, s[12:15], 0 offen sc1
    s_waitcnt lgkmcnt(4)
    ds_read_b64_tr_b16 v[116:117], v9 offset:4096
    ds_read_b64_tr_b16 v[118:119], v9 offset:4608
    ds_read_b64_tr_b16 v[120:121], v10 offset:4096
    ds_read_b64_tr_b16 v[122:123], v10 offset:4608
    ds_read_b64_tr_b16 v[124:125], v8 offset:4096
    ds_read_b64_tr_b16 v[126:127], v8 offset:4608
    ds_read_b64_tr_b16 v[128:129], v12 offset:4096
    ds_read_b64_tr_b16 v[130:131], v12 offset:4608
    s_mov_b32 s54, 0
    s_branch L_hp_wait
L_hp_poll:
    buffer_load_dwordx4 v[20:23], v15, s[12:15], 0 offen sc1
L_hp_wait:
    s_waitcnt vmcnt(0)
    v_xor_b32 v20, v14, v20
    v_xor_b32 v21, v14, v21
    v_xor_b32 v22, v14, v22
    v_xor_b32 v23, v14, v23
    v_or3_b32 v24, v20, v21, v22
    v_or_b32 v24, v24, v23
    v_and_b32 v24, 0xff, v24
    v_cmp_ne_u32 vcc, 0, v24
    v_permlane16_swap_b32 v20, v21
    v_permlane16_swap_b32 v22, v23
    s_cbranch_vccz L_hp_got
    s_cmp_eq_u32 s35, 0
    s_cbranch_scc1 L_hp_got
    s_sub_u32 s35, s35, 1
    s_branch L_hp_poll
L_hp_got:
    v_add_f32 v20, v20, v21
    v_add_f32 v22, v22, v23
    s_nop 1
    v_permlane32_swap_b32 v20, v22
    v_add_f32 v20, v20, v22
    s_nop 1
    v_add_f32_dpp v21, v20, v20 row_ror:8 row_mask:0xf bank_mask:0xf
    v_add_f32_dpp v20, v20, v20 row_ror:8 row_mask:0xf bank_mask:0xf
    s_nop 1
    v_permlane16_swap_b32 v20, v21
    v_cvt_pk_bf16_f32 v20, v20, v21
    v_and_b32 v21, 0xffff0000, v20
    v_lshlrev_b32 v20, 16, v20
    v_mul_f32 v22, 0xbfb8aa3b, v20
    v_exp_f32 v22, v22
    s_nop 0
    v_add_f32 v22, 1.0, v22
    v_rcp_f32 v22, v22
    s_nop 0
    v_mul_f32 v20, v20, v22
    v_cvt_pk_bf16_f32 v20, v20, v20
    v_lshlrev_b32 v20, 16, v20
    v_mul_f32 v20, v20, v21
    v_cvt_pk_bf16_f32 v20, v20, v20
    ds_write_b16 v16, v20 offset:42368
    s_mov_b64 exec, 1
    ds_add_u32 v0, v255 offset:42852
    s_mov_b64 exec, -1
L_sync17:
    ds_read_b32 v1, v0 offset:42852
    ds_read_b128 v[28:31], v17 offset:42368
    ds_read_b128 v[32:35], v17 offset:42432
    s_add_u32 s92, s92, 1
    s_bitcmp1_b32 s92, 20
    s_cbranch_scc1 L_sync17x
    s_waitcnt lgkmcnt(2)
    v_readfirstlane_b32 s31, v1
    s_nop 0
    s_cmp_ge_u32 s31, 4
    s_cbranch_scc0 L_sync17
L_sync17x:
    s_waitcnt lgkmcnt(1)
    v_mfma_f32_16x16x32_bf16 v[36:39], v[28:31], v[100:103], 0
    v_mfma_f32_16x16x32_bf16 v[40:43], v[28:31], v[104:107], 0
    v_mfma_f32_16x16x32_bf16 v[44:47], v[28:31], v[108:111], 0
    v_mfma_f32_16x16x32_bf16 v[48:51], v[28:31], v[112:115], 0
    s_waitcnt lgkmcnt(0)
    v_mfma_f32_16x16x32_bf16 v[36:39], v[32:35], v[116:119], v[36:39]
    v_mfma_f32_16x16x32_bf16 v[40:43], v[32:35], v[120:123], v[40:43]
    v_mfma_f32_16x16x32_bf16 v[44:47], v[32:35], v[124:127], v[44:47]
    v_mfma_f32_16x16x32_bf16 v[48:51], v[32:35], v[128:131], v[48:51]
    s_mov_b32 vcc_lo, 0xffff0000
    s_mov_b32 vcc_hi, 0xffff0000
    s_mov_b32 s52, 0
    s_mov_b32 s53, -1
    s_nop 1
    v_cndmask_b32 v36, v36, v40, vcc
    s_nop 0
    v_cndmask_b32 v44, v44, v48, vcc
    v_cndmask_b32 v36, v36, v44, s[52:53]
    v_and_or_b32 v36, v36, s49, v14
    buffer_store_dword v36, v18, s[12:15], 0 offen sc1
    s_mov_b64 exec, 1
    ds_add_u32 v0, v255 offset:42856
    s_mov_b64 exec, -1
    s_branch L_owner
L_idle:
    s_mov_b64 exec, 1
    ds_add_u32 v0, v255 offset:42868
    s_mov_b64 exec, -1
    s_and_b32 s52, s2, 31
    s_lshl_b32 s52, s52, 7
    s_add_u32 s52, s52, 12288
L_hint:
    s_load_dwordx2 s[54:55], s[12:13], s52 glc
    s_waitcnt lgkmcnt(0)
    s_cmp_eq_u64 s[54:55], s[28:29]
    s_cbranch_scc1 L_hint_ok
    s_cmp_eq_u32 s35, 0
    s_cbranch_scc1 L_hint_ok
    s_sub_u32 s35, s35, 1
    s_sleep 4
    s_branch L_hint
L_hint_ok:
    s_mov_b64 exec, 1
    ds_add_u32 v0, v255 offset:42848
    s_mov_b64 exec, -1
    s_mov_b64 exec, 1
    ds_add_u32 v0, v255 offset:42852
    s_mov_b64 exec, -1
    s_mov_b64 exec, 1
    ds_add_u32 v0, v255 offset:42856
    s_mov_b64 exec, -1
L_idle_done:
    s_waitcnt lgkmcnt(0)
    v_readfirstlane_b32 s33, v19
    v_readfirstlane_b32 s34, v18
L_owner:
    s_setprio 1
    s_and_b32 s31, s2, 7
    s_sub_u32 s32, 8, s31
    s_min_u32 s46, s31, s32
    s_lshr_b32 s53, s31, 2
    s_lshr_b32 s47, s2, 3
    s_and_b32 s32, s47, 1
    s_and_b32 s31, s31, 3
    s_cselect_b32 s53, s53, s32
    s_cselect_b32 s31, 0, 1
    s_lshr_b32 s47, s47, s31
    s_lshl_b32 s53, s53, 4
    s_lshl_b32 s53, s53, 3
    s_add_u32 s53, s53, s46
    s_andn2_b32 s51, 0x7ff, s33
    s_mov_b32 s54, s51
    s_mov_b32 s55, 0
    s_mov_b32 s56, 0
    s_mov_b32 s16, s44
    s_mov_b32 s17, s45
    s_mov_b32 s18, 0x400000
    v_and_b32 v8, 31, v2
    v_lshlrev_b32 v15, 2, v8
    v_lshlrev_b32 v8, 1, v8
    v_mov_b32 v16, 0
L_seg:
    s_xor_b32 s31, s54, s53
    s_and_b32 s31, s31, 0x87
    s_cbranch_scc1 L_seg_next
    s_lshl_b32 s31, s51, 11
    s_lshl_b32 s32, s47, 6
    s_add_u32 s63, s31, s32
    buffer_load_ushort v9, v8, s[8:11], s63 offen
    v_lshrrev_b32 v4, 3, v2
    s_lshl_b32 s31, s30, 4
    v_add_u32 v4, s31, v4
    v_lshlrev_b32 v4, 12, v4
    s_lshl_b32 s31, s47, 7
    s_add_u32 s31, s31, 524288
    v_add3_u32 v4, v4, v7, s31
    s_mov_b32 s62, 32768
    v_mov_b32 v24, v14
    v_mov_b32 v25, v14
    v_mov_b32 v26, v14
    v_mov_b32 v27, v14
    v_lshrrev_b32 v5, 4, v2
    v_lshl_add_u32 v6, v5, 2, v7
    s_lshl_b32 s31, s30, 7
    s_add_u32 s31, s31, s55
    v_add_u32 v6, s31, v6
    s_ashr_i32 s31, s33, 31
    s_orn2_b32 s31, 0x80000000, s31
    s_xor_b32 s31, s31, s33
    s_and_b32 s31, s31, 0xfffff800
    v_cvt_pk_bf16_f32 v11, s31, s31
    v_lshlrev_b32 v11, 16, v11
    v_mul_f32 v11, 0xbfb8aa3b, v11
    v_exp_f32 v11, v11
    s_and_b32 s32, s34, 0xffff0000
    v_add_f32 v11, 1.0, v11
    v_rcp_f32 v11, v11
    v_rcp_f32 v12, s32
    v_cvt_pk_bf16_f32 v11, v11, v11
    v_lshlrev_b32 v11, 16, v11
    s_lshl_b32 s31, s34, 16
    s_waitcnt vmcnt(0)
    v_lshl_add_u32 v13, v8, 1, s55
    s_mov_b64 vcc, -1
    s_mov_b32 s56, 1
L_y_poll:
    s_mov_b64 exec, vcc
    buffer_load_dwordx4 v[20:23], v4, s[12:15], 0 offen sc1
    s_cmp_eq_u32 s30, 3
    s_cbranch_scc1 L_y_one
    buffer_load_dwordx4 v[24:27], v4, s[12:15], s62 offen sc1
L_y_one:
    s_mov_b64 exec, -1
    s_waitcnt vmcnt(0)
    v_xor_b32 v28, v14, v20
    v_xor_b32 v29, v14, v21
    v_xor_b32 v30, v14, v22
    v_xor_b32 v31, v14, v23
    v_xor_b32 v32, v14, v24
    v_xor_b32 v33, v14, v25
    v_xor_b32 v34, v14, v26
    v_xor_b32 v35, v14, v27
    v_or3_b32 v1, v28, v29, v30
    v_or3_b32 v1, v1, v31, v32
    v_or3_b32 v1, v1, v33, v34
    v_or_b32 v1, v1, v35
    v_and_b32 v1, 0xff, v1
    v_cmp_ne_u32 vcc, 0, v1
    v_pk_add_f32 v[28:29], v[28:29], v[32:33]
    v_pk_add_f32 v[30:31], v[30:31], v[34:35]
    s_cbranch_vccz L_y_got
    s_cmp_eq_u32 s35, 0
    s_cbranch_scc1 L_y_got
    s_sub_u32 s35, s35, 1
    s_branch L_y_poll
L_y_got:
    v_permlane16_swap_b32 v28, v29
    v_permlane16_swap_b32 v30, v31
    v_add_f32 v28, v28, v29
    v_add_f32 v30, v30, v31
    s_nop 1
    v_permlane32_swap_b32 v28, v30
    v_add_f32 v28, v28, v30
    s_nop 1
    v_add_f32_dpp v28, v28, v28 row_ror:8 row_mask:0xf bank_mask:0xf
    ds_write_b32 v6, v28 offset:43008
    s_mov_b64 exec, 1
    ds_add_u32 v16, v255 offset:42836
    s_mov_b64 exec, -1
    s_cmp_lg_u32 s30, 0
    s_cbranch_scc1 L_seg_next
    s_cmp_eq_u32 s47, 0
    s_cselect_b32 s32, 0, 2147483392
    v_mov_b32 v5, 2147483392
    v_writelane_b32 v5, s32, 0
    v_mov_b32 v18, s28
    v_mov_b32 v19, s29
    s_lshl_b32 s31, s34, 16
    v_lshlrev_b32 v9, 16, v9
    v_subrev_f32 v10, s31, v9
    v_cvt_pk_bf16_f32 v10, v10, v10
    v_lshlrev_b32 v10, 16, v10
    v_mul_f32 v10, v10, v12
    v_cvt_pk_bf16_f32 v10, v10, v10
    v_lshlrev_b32 v10, 16, v10
L_sync18:
    ds_read_b32 v1, v16 offset:42836
    ds_read_b32 v20, v13 offset:43008
    ds_read_b32 v21, v13 offset:43136
    ds_read_b32 v22, v13 offset:43264
    ds_read_b32 v23, v13 offset:43392
    ds_read_b32 v24, v15 offset:42496
    s_add_u32 s92, s92, 1
    s_bitcmp1_b32 s92, 20
    s_cbranch_scc1 L_sync18x
    s_waitcnt lgkmcnt(5)
    v_readfirstlane_b32 s31, v1
    s_nop 0
    s_cmp_ge_u32 s31, 5
    s_cbranch_scc0 L_sync18
L_sync18x:
    s_waitcnt lgkmcnt(0)
    v_add_f32 v20, v20, v21
    v_add_f32 v22, v22, v23
    v_add_f32 v20, v20, v22
    v_cvt_pk_bf16_f32 v20, v20, v20
    v_lshlrev_b32 v20, 16, v20
    v_mul_f32 v20, v20, v11
    v_cvt_pk_bf16_f32 v20, v20, v20
    v_lshlrev_b32 v20, 16, v20
    v_add_f32 v20, v20, v10
    v_cvt_pk_bf16_f32 v20, v20, v20
    v_lshlrev_b32 v20, 16, v20
    v_mul_f32 v1, 0xbfb8aa3b, v20
    v_mul_f32 v20, v1, v24
    v_exp_f32 v1, v1
    s_nop 0
    v_add_f32 v1, 1.0, v1
    v_rcp_f32 v1, v1
    s_mov_b32 exec_hi, 0
    v_fma_f32 v20, v20, v1, v9
    v_cvt_pk_bf16_f32 v20, v20, v20
    buffer_store_short v20, v8, s[16:19], s63 offen sc1
    buffer_store_dwordx2 v[18:19], v5, s[12:15], 0 offen sc1
    s_mov_b64 exec, -1
L_seg_next:
    s_cmp_lg_u32 s55, 0
    s_cbranch_scc1 L_seg_end
    s_mov_b32 s55, 512
    s_sub_u32 s54, 0, s51
    s_sub_u32 s47, 31, s47
    v_mov_b32 v16, 28
    v_and_b32 v15, 24, v2
    v_xor_b32 v15, 24, v15
    v_sub_u32 v1, 0, v2
    v_and_b32 v1, 7, v1
    v_add_u32 v15, v15, v1
    v_lshlrev_b32 v15, 2, v15
    v_add_u32 v15, 128, v15
    s_branch L_seg
L_seg_end:
L_fin:
L_exit:
    s_endpgm
L_code_end:
.section .rodata,"a"
.p2align 6
.amdhsa_kernel recurrent_scan__spectral_fnet__moe_arch_mod__prompt_kernel
  .amdhsa_next_free_vgpr 256
  .amdhsa_next_free_sgpr 94
  .amdhsa_accum_offset 256
  .amdhsa_group_segment_fixed_size 0
  .amdhsa_kernarg_size 104
  .amdhsa_user_sgpr_count 2
  .amdhsa_user_sgpr_kernarg_segment_ptr 1
  .amdhsa_system_sgpr_workgroup_id_x 1
  .amdhsa_float_denorm_mode_32 3
.end_amdhsa_kernel
```

```asm
; @launch grid=(256,1,1) block=(512,1,1) lds=158720
.amdgcn_target "amdgcn-amd-amdhsa--gfx950"
.text
.globl recurrent_scan__spectral_fnet__moe_arch_mod__prompt_kernel
.p2align 8
.type recurrent_scan__spectral_fnet__moe_arch_mod__prompt_kernel,@function
recurrent_scan__spectral_fnet__moe_arch_mod__prompt_kernel:
    s_cmp_ge_u32 s2, 256
    s_cbranch_scc1 L_exit
    s_load_dwordx2 s[8:9], s[0:1], 0
    s_load_dwordx4 s[36:39], s[0:1], 48
    s_load_dwordx2 s[12:13], s[0:1], 96
    s_getpc_b64 s[32:33]
L_pc:
    s_bfe_u32 s31, s2, 0x30003
    v_subrev_u32 v3, 492, v0
    v_lshl_add_u32 v3, v3, 3, s31
    v_lshlrev_b32 v3, 7, v3
    v_cmp_gt_u32 vcc, L_code_end-L_pc, v3
    s_nop 0
    s_and_saveexec_b64 s[46:47], vcc
    s_cbranch_execz L_nopf
    global_load_dword v254, v3, s[32:33]
L_nopf:
    s_mov_b64 exec, -1
    v_lshrrev_b32 v1, 6, v0
    v_and_b32 v2, 63, v0
    v_readfirstlane_b32 s30, v1
    s_mov_b32 s10, 0x400000
    s_mov_b32 s11, 0x00020000
    s_mov_b32 s14, 0x10000000
    s_mov_b32 s15, 0x00020000
    s_mov_b32 s35, 65536
    s_mov_b32 s92, 0
    v_lshlrev_b32 v3, 4, v2
    v_mov_b32 v0, 0
    s_mov_b32 s3, s30
    s_and_b32 s30, s30, 3
    v_mov_b32 v255, 1
    s_cmp_ge_u32 s3, 4
    s_cbranch_scc1 L_moe
    s_and_b32 s31, s2, 7
    s_lshr_b32 s32, s2, 4
    s_sub_u32 s32, 15, s32
    s_lshl_b32 s32, s32, 3
    s_add_u32 s46, s32, s31
    s_bfe_u32 s47, s2, 0x10003
    s_lshl_b32 s31, s47, 2
    s_add_u32 s51, s31, s30
    s_lshl_b32 s31, s51, 8
    s_add_u32 s52, s31, s46
    s_xor_b32 s54, s52, 1024
    s_sub_u32 s53, 2048, s52
    s_add_u32 s31, s52, 128
    s_cmp_eq_u32 s46, 0
    s_cselect_b32 s53, s31, s53
    s_cselect_b32 s50, 1, 0
    s_xor_b32 s55, s53, 1024
    s_lshl_b32 s56, s52, 11
    s_lshl_b32 s57, s53, 11
    s_lshl_b32 s58, s54, 11
    s_lshl_b32 s59, s55, 11
    s_mov_b32 s22, 2048
    s_mov_b32 s23, 0x00020000
    v_mov_b32 v1, 0
    v_and_b32 v6, 15, v2
    v_lshlrev_b32 v6, 2, v6
    ds_write_b64 v0, v[0:1] offset:41504
    ds_write_b32 v6, v0 offset:42816
    s_waitcnt lgkmcnt(0)
    s_load_dwordx2 s[28:29], s[12:13], 0
    s_load_dwordx2 s[16:17], s[0:1], 80
    buffer_load_dwordx4 v[120:123], v3, s[8:11], s56 offen
    buffer_load_dwordx4 v[124:127], v3, s[8:11], s56 offen offset:1024
    buffer_load_dwordx4 v[128:131], v3, s[8:11], s57 offen
    buffer_load_dwordx4 v[132:135], v3, s[8:11], s57 offen offset:1024
    s_mov_b32 s20, s36
    s_mov_b32 s21, s37
    buffer_load_dwordx4 v[152:155], v3, s[20:23], 0 offen
    buffer_load_dwordx4 v[156:159], v3, s[20:23], 0 offen offset:1024
    buffer_load_dwordx4 v[136:139], v3, s[8:11], s58 offen
    buffer_load_dwordx4 v[140:143], v3, s[8:11], s58 offen offset:1024
    buffer_load_dwordx4 v[144:147], v3, s[8:11], s59 offen
    buffer_load_dwordx4 v[148:151], v3, s[8:11], s59 offen offset:1024
    s_barrier
    s_branch L_dft_rest
L_moe:
    s_load_dwordx2 s[20:21], s[0:1], 64
    s_and_b32 s32, s2, 7
    s_mul_i32 s32, s32, 28
    s_lshr_b32 s31, s2, 3
    s_add_u32 s31, s31, s32
    s_lshr_b32 s46, s31, 3
    s_lshl_b32 s46, s46, 1
    s_and_b32 s47, s31, 7
    s_mov_b32 s75, 0
    s_mov_b32 s18, 7340032
    s_mov_b32 s19, 0x00020000
    s_mov_b32 s22, 7340032
    s_mov_b32 s23, 0x00020000
    s_mov_b32 s26, 7340032
    s_mov_b32 s27, 0x00020000
    v_lshrrev_b32 v4, 4, v2
    v_lshlrev_b32 v5, 5, v4
    v_and_b32 v6, 0x70, v3
    v_xor_b32 v5, v5, v6
    v_mul_u32_u24 v4, 7168, v4
    s_mul_i32 s31, s47, 917504
    s_lshl_b32 s32, s46, 7
    s_add_u32 s31, s31, s32
    v_add3_u32 v4, v4, v5, s31
    s_cmp_eq_u32 s75, 0
    s_mov_b32 s31, 917504
    s_cselect_b32 s31, 128, s31
    v_add_u32 v6, s31, v4
    s_mov_b32 vcc_lo, 0xff00ff00
    s_mov_b32 vcc_hi, 0xff00ff00
    v_cndmask_b32 v5, v6, v4, vcc
    v_cndmask_b32 v4, v4, v6, vcc
    s_mov_b32 s48, 0
    s_mov_b32 s49, 76800
    s_waitcnt lgkmcnt(0)
    s_mov_b32 s16, s38
    s_mov_b32 s17, s39
    s_load_dwordx2 s[28:29], s[12:13], 0
    s_load_dwordx2 s[24:25], s[0:1], 72
    s_load_dwordx2 s[44:45], s[0:1], 80
    s_barrier
    s_cmp_ge_u32 s2, 224
    s_cselect_b32 s66, 0, 1
    s_cbranch_scc1 L_dma_done
    s_cmp_lg_u32 s30, 0
    s_cbranch_scc1 L_dma_done
    s_setprio 3
L_dma0:
    s_mov_b32 m0, s49
    s_waitcnt vmcnt(20)
    buffer_load_dwordx4 v4, s[16:19], s48 offen nt lds
    s_add_u32 m0, s49, 32768
    s_add_u32 s49, s49, 1024
    s_waitcnt vmcnt(20)
    buffer_load_dwordx4 v4, s[20:23], s48 offen nt lds
    s_add_u32 s48, s48, 28672
    s_mov_b32 m0, s49
    s_waitcnt vmcnt(20)
    buffer_load_dwordx4 v4, s[16:19], s48 offen nt lds
    s_add_u32 m0, s49, 32768
    s_add_u32 s49, s49, 1024
    s_waitcnt vmcnt(20)
    buffer_load_dwordx4 v4, s[20:23], s48 offen nt lds
    s_add_u32 s48, s48, 28672
    s_mov_b32 m0, s49
    s_waitcnt vmcnt(20)
    buffer_load_dwordx4 v5, s[16:19], s48 offen nt lds
    s_add_u32 m0, s49, 32768
    s_add_u32 s49, s49, 1024
    s_waitcnt vmcnt(20)
    buffer_load_dwordx4 v5, s[20:23], s48 offen nt lds
    s_add_u32 s48, s48, 28672
    s_mov_b32 m0, s49
    s_waitcnt vmcnt(20)
    buffer_load_dwordx4 v5, s[16:19], s48 offen nt lds
    s_add_u32 m0, s49, 32768
    s_add_u32 s49, s49, 1024
    s_waitcnt vmcnt(20)
    buffer_load_dwordx4 v5, s[20:23], s48 offen nt lds
    s_add_u32 s48, s48, 28672
    s_cmp_lt_u32 s48, 917504
    s_cbranch_scc1 L_dma0
    s_branch L_dma_done
L_dft_rest:
    s_mov_b32 s18, 0x400000
    s_mov_b32 s19, 0x00020000
    s_sub_u32 s31, 2047, s52
    s_sub_u32 s32, 2047, s53
    v_mov_b32 v200, s31
    v_writelane_b32 v200, s32, 63
    s_lshl_b32 s31, s30, 2
    v_mov_b32 v201, s31
    s_bfe_u32 s31, s53, 0x20008
    s_lshl_b32 s31, s31, 2
    s_add_u32 s31, s31, 16
    v_writelane_b32 v201, s31, 63
    v_and_b32 v6, 32, v2
    s_lshl_b32 s31, s51, 2
    v_add_u32 v203, s31, v6
    v_lshrrev_b32 v202, 1, v203
    s_and_b32 s31, s2, 7
    s_lshl_b32 s31, s31, 9
    s_lshr_b32 s32, s2, 3
    s_lshl_b32 s32, s32, 4
    s_add_u32 s31, s31, s32
    s_add_u32 s31, s31, 4096
    v_mov_b32 v4, s31
    v_lshlrev_b32 v5, 3, v2
    s_and_b32 s31, s52, 7
    s_lshl_b32 s31, s31, 11
    s_and_b32 s32, s52, 1024
    s_add_u32 s31, s31, s32
    s_and_b32 s32, s52, 0xf8
    s_lshl_b32 s32, s32, 2
    s_add_u32 s31, s31, s32
    s_add_u32 s31, s31, 32768
    v_writelane_b32 v4, s31, 0
    s_add_u32 s31, s31, 16
    v_writelane_b32 v4, s31, 1
    s_and_b32 s31, s53, 7
    s_lshl_b32 s31, s31, 11
    s_and_b32 s32, s53, 1024
    s_add_u32 s31, s31, s32
    s_and_b32 s32, s53, 0xf8
    s_lshl_b32 s32, s32, 2
    s_add_u32 s31, s31, s32
    s_add_u32 s31, s31, 32768
    v_writelane_b32 v4, s31, 2
    s_add_u32 s31, s31, 16
    v_writelane_b32 v4, s31, 3
    s_mul_i32 s31, s51, 2592
    v_and_b32 v204, 32, v2
    v_lshlrev_b32 v204, 2, v204
    v_add3_u32 v204, v204, v3, s31
    s_lshl_b32 s32, s31, 1
    s_add_u32 s32, s32, 21872
    v_sub_u32 v205, s32, v204
    v_bfe_u32 v206, v2, 2, 2
    v_mul_u32_u24 v206, 2592, v206
    v_lshrrev_b32 v6, 4, v2
    v_mul_u32_u24 v7, 640, v6
    v_add_u32 v206, v206, v7
    v_and_b32 v7, 3, v2
    v_lshlrev_b32 v7, 3, v7
    s_lshl_b32 s31, s30, 7
    v_add3_u32 v206, v206, v7, s31
    v_lshlrev_b32 v6, 12, v6
    v_and_b32 v7, 15, v2
    v_lshl_add_u32 v6, v7, 4, v6
    s_lshl_b32 s31, s30, 8
    v_add_u32 v207, s31, v6
    v_bfe_i32 v208, v2, 4, 1
    v_and_b32 v208, 0x80008000, v208
    s_cmp_eq_u32 s47, 0
    s_movk_i32 s48, 0x7403
    s_cselect_b32 s48, 0x7721, s48
    v_and_b32 v250, 12, v2
    v_bfe_u32 v250, s48, v250, 4
    v_lshrrev_b32 v251, 4, v2
    v_bfe_u32 v252, v2, 1, 1
    v_mul_u32_u24 v251, v251, v252
    v_and_b32 v252, 1, v2
    v_add_u32 v251, v251, v252
    v_cvt_f32_u32 v250, v250
    v_cvt_f32_u32 v251, v251
    v_mul_f32 v250, 0x3e000000, v250
    v_mul_f32 v251, 0x3e800000, v251
    v_cos_f32 v8, v251
    v_add_f32 v251, v251, v250
    v_cos_f32 v9, v251
    v_add_f32 v251, v251, v250
    v_cos_f32 v10, v251
    v_add_f32 v251, v251, v250
    v_cos_f32 v11, v251
    v_add_f32 v251, v251, v250
    v_cos_f32 v12, v251
    v_add_f32 v251, v251, v250
    v_cos_f32 v13, v251
    v_add_f32 v251, v251, v250
    v_cos_f32 v14, v251
    v_add_f32 v251, v251, v250
    v_cos_f32 v15, v251
    v_mul_f32 v8, 0xbf317218, v8
    v_mul_f32 v9, 0xbf317218, v9
    v_mul_f32 v10, 0xbf317218, v10
    v_mul_f32 v11, 0xbf317218, v11
    v_mul_f32 v12, 0xbf317218, v12
    v_mul_f32 v13, 0xbf317218, v13
    v_mul_f32 v14, 0xbf317218, v14
    v_mul_f32 v15, 0xbf317218, v15
    v_lshrrev_b32 v250, 2, v2
    v_and_b32 v250, 12, v250
    v_and_b32 v251, 15, v2
    v_lshlrev_b32 v251, 2, v251
    v_cvt_f32_u32 v250, v250
    v_cvt_f32_u32 v251, v251
    v_mul_f32 v212, 0x3c800000, v250
    s_lshl_b32 s31, s30, 2
    s_lshr_b32 s48, s48, s31
    s_and_b32 s48, s48, 15
    s_sub_u32 s31, s48, 4
    s_mul_i32 s31, s31, s46
    v_cvt_f32_i32 v252, s31
    v_mul_f32 v252, 0x3a000000, v252
    v_add_f32 v213, 0x3c800000, v212
    v_add_f32 v214, 0x3d000000, v212
    v_add_f32 v215, 0x3d400000, v212
    s_and_b32 s31, s2, 7
    s_sub_u32 s32, 8, s31
    s_min_u32 s76, s31, s32
    s_lshr_b32 s78, s31, 2
    s_lshr_b32 s77, s2, 3
    s_and_b32 s32, s77, 1
    s_and_b32 s31, s31, 3
    s_cselect_b32 s78, s78, s32
    s_cselect_b32 s31, 0, 1
    s_lshr_b32 s77, s77, s31
    s_lshl_b32 s78, s78, 4
    s_lshl_b32 s31, s30, 5
    s_add_u32 s78, s78, s31
    s_lshl_b32 s78, s78, 3
    s_add_u32 s78, s78, s76
    s_lshl_b32 s77, s77, 6
    s_sub_u32 s79, 1984, s77
    s_lshl_b32 s76, s76, 1
    s_add_u32 s76, s76, 2040
    v_and_b32 v116, 15, v2
    v_lshl_add_u32 v116, v116, 3, s78
    v_and_b32 v7, 32, v2
    v_lshl_add_u32 v7, v7, 5, v116
    s_mov_b32 vcc_lo, 0xffff0000
    s_mov_b32 vcc_hi, 0xffff0000
    v_sub_u32 v6, 0, v7
    v_cndmask_b32 v7, v7, v6, vcc
    v_and_b32 v6, 7, v7
    v_and_b32 v1, 1024, v7
    v_lshl_add_u32 v6, v6, 11, v1
    v_and_b32 v1, 0xf8, v7
    v_lshl_add_u32 v6, v1, 2, v6
    v_bfe_u32 v1, v7, 9, 1
    v_lshl_add_u32 v119, v1, 4, v6
    v_and_b32 v1, 256, v7
    v_cmp_ne_u32 s[88:89], 0, v1
    v_lshrrev_b32 v118, 2, v2
    v_lshl_add_u32 v118, v118, 3, s78
    v_lshlrev_b32 v1, 1, v2
    v_xor_b32 v1, v1, v3
    v_and_b32 v1, 48, v1
    v_add_u32 v114, 1024, v118
    v_sub_u32 v113, 0, v118
    v_and_b32 v113, 2047, v113
    v_sub_u32 v115, 2048, v114
    v_add_u32 v112, s77, v1
    v_lshl_add_u32 v114, v114, 11, v112
    v_lshl_add_u32 v112, v118, 11, v112
    v_xor_b32 v1, 48, v1
    v_add_u32 v1, s79, v1
    v_lshl_add_u32 v113, v113, 11, v1
    v_lshl_add_u32 v115, v115, 11, v1
    s_lshl_b32 s76, s30, 12
    s_add_u32 s76, s76, 44032
    v_and_b32 v1, 15, v2
    v_lshlrev_b32 v6, 6, v1
    v_lshlrev_b32 v1, 3, v2
    v_xor_b32 v1, v1, v2
    v_and_b32 v1, 48, v1
    v_add3_u32 v117, v6, v1, s76
    v_mul_f32 v250, v212, v251
    v_fmamk_f32 v52, v250, 0x3d800000, v252
    v_sin_f32 v20, v250
    v_cos_f32 v250, v250
    v_cos_f32 v48, v52
    v_sin_f32 v52, v52
    v_cvt_pk_f16_f32 v16, v250, v20
    v_cvt_pk_f16_f32 v20, -v20, v250
    v_mul_f32 v250, v213, v251
    v_fmamk_f32 v53, v250, 0x3d800000, v252
    v_sin_f32 v21, v250
    v_cos_f32 v250, v250
    v_cos_f32 v49, v53
    v_sin_f32 v53, v53
    v_cvt_pk_f16_f32 v17, v250, v21
    v_cvt_pk_f16_f32 v21, -v21, v250
    v_mul_f32 v250, v214, v251
    v_fmamk_f32 v54, v250, 0x3d800000, v252
    v_sin_f32 v22, v250
    v_cos_f32 v250, v250
    v_cos_f32 v50, v54
    v_sin_f32 v54, v54
    v_cvt_pk_f16_f32 v18, v250, v22
    v_cvt_pk_f16_f32 v22, -v22, v250
    v_mul_f32 v250, v215, v251
    v_fmamk_f32 v55, v250, 0x3d800000, v252
    v_sin_f32 v23, v250
    v_cos_f32 v250, v250
    v_cos_f32 v51, v55
    v_sin_f32 v55, v55
    v_cvt_pk_f16_f32 v19, v250, v23
    v_cvt_pk_f16_f32 v23, -v23, v250
    v_add_f32 v251, 1.0, v251
    v_mul_f32 v250, v212, v251
    v_fmamk_f32 v60, v250, 0x3d800000, v252
    v_sin_f32 v28, v250
    v_cos_f32 v250, v250
    v_cos_f32 v56, v60
    v_sin_f32 v60, v60
    v_cvt_pk_f16_f32 v24, v250, v28
    v_cvt_pk_f16_f32 v28, -v28, v250
    v_mul_f32 v250, v213, v251
    v_fmamk_f32 v61, v250, 0x3d800000, v252
    v_sin_f32 v29, v250
    v_cos_f32 v250, v250
    v_cos_f32 v57, v61
    v_sin_f32 v61, v61
    v_cvt_pk_f16_f32 v25, v250, v29
    v_cvt_pk_f16_f32 v29, -v29, v250
    v_mul_f32 v250, v214, v251
    v_fmamk_f32 v62, v250, 0x3d800000, v252
    v_sin_f32 v30, v250
    v_cos_f32 v250, v250
    v_cos_f32 v58, v62
    v_sin_f32 v62, v62
    v_cvt_pk_f16_f32 v26, v250, v30
    v_cvt_pk_f16_f32 v30, -v30, v250
    v_mul_f32 v250, v215, v251
    v_fmamk_f32 v63, v250, 0x3d800000, v252
    v_sin_f32 v31, v250
    v_cos_f32 v250, v250
    v_cos_f32 v59, v63
    v_sin_f32 v63, v63
    v_cvt_pk_f16_f32 v27, v250, v31
    v_cvt_pk_f16_f32 v31, -v31, v250
    v_add_f32 v251, 1.0, v251
    v_mul_f32 v250, v212, v251
    v_fmamk_f32 v68, v250, 0x3d800000, v252
    v_sin_f32 v36, v250
    v_cos_f32 v250, v250
    v_cos_f32 v64, v68
    v_sin_f32 v68, v68
    v_cvt_pk_f16_f32 v32, v250, v36
    v_cvt_pk_f16_f32 v36, -v36, v250
    v_mul_f32 v250, v213, v251
    v_fmamk_f32 v69, v250, 0x3d800000, v252
    v_sin_f32 v37, v250
    v_cos_f32 v250, v250
    v_cos_f32 v65, v69
    v_sin_f32 v69, v69
    v_cvt_pk_f16_f32 v33, v250, v37
    v_cvt_pk_f16_f32 v37, -v37, v250
    v_mul_f32 v250, v214, v251
    v_fmamk_f32 v70, v250, 0x3d800000, v252
    v_sin_f32 v38, v250
    v_cos_f32 v250, v250
    v_cos_f32 v66, v70
    v_sin_f32 v70, v70
    v_cvt_pk_f16_f32 v34, v250, v38
    v_cvt_pk_f16_f32 v38, -v38, v250
    v_mul_f32 v250, v215, v251
    v_fmamk_f32 v71, v250, 0x3d800000, v252
    v_sin_f32 v39, v250
    v_cos_f32 v250, v250
    v_cos_f32 v67, v71
    v_sin_f32 v71, v71
    v_cvt_pk_f16_f32 v35, v250, v39
    v_cvt_pk_f16_f32 v39, -v39, v250
    v_add_f32 v251, 1.0, v251
    v_mov_b32 v160, 0
    v_mov_b32 v161, 0
    v_mov_b32 v162, 0
    v_mov_b32 v163, 0
    v_mov_b32 v164, 0
    v_mov_b32 v165, 0
    v_mov_b32 v166, 0
    v_mov_b32 v167, 0
    v_mov_b32 v168, 0
    v_mov_b32 v169, 0
    v_mov_b32 v170, 0
    s_mov_b32 s57, 0x3f803f80
    s_mov_b32 s59, 0xffff
    s_brev_b32 s67, 1
    s_mov_b32 s66, 0
    s_brev_b32 s64, 1
    s_brev_b32 s65, 1
    s_cmp_eq_u32 s47, 0
    s_movk_i32 s62, -10368
    s_cselect_b32 s62, 10368, s62
    s_waitcnt lgkmcnt(0)
    s_add_u32 s28, s28, 0x7f4a7c15
    s_addc_u32 s29, s29, 0x9e3779b9
    v_mov_b32 v174, s28
    v_mov_b32 v175, s29
    s_cmp_lt_u32 s2, 224
    s_cbranch_scc1 L_epoch_ok
L_sync1:
    ds_read_b32 v1, v0 offset:42872
    s_add_u32 s92, s92, 1
    s_bitcmp1_b32 s92, 20
    s_cbranch_scc1 L_sync1x
    s_waitcnt lgkmcnt(0)
    v_readfirstlane_b32 s31, v1
    s_nop 0
    s_cmp_ge_u32 s31, 4
    s_cbranch_scc0 L_sync1
L_sync1x:
L_epoch_ok:
    s_setprio 3
    s_waitcnt vmcnt(8)
    v_dot2c_f32_bf16 v160, s57, v120
    v_dot2c_f32_bf16 v164, v120, v120
    v_dot2c_f32_bf16 v160, s57, v121
    v_dot2c_f32_bf16 v164, v121, v121
    v_dot2c_f32_bf16 v160, s57, v122
    v_dot2c_f32_bf16 v164, v122, v122
    v_dot2c_f32_bf16 v160, s57, v123
    v_dot2c_f32_bf16 v164, v123, v123
    v_dot2c_f32_bf16 v160, s57, v124
    v_dot2c_f32_bf16 v164, v124, v124
    v_dot2c_f32_bf16 v160, s57, v125
    v_dot2c_f32_bf16 v164, v125, v125
    v_dot2c_f32_bf16 v160, s57, v126
    v_dot2c_f32_bf16 v164, v126, v126
    v_dot2c_f32_bf16 v160, s57, v127
    v_dot2c_f32_bf16 v164, v127, v127
    s_waitcnt vmcnt(6)
    v_dot2c_f32_bf16 v161, s57, v128
    v_dot2c_f32_bf16 v165, v128, v128
    v_dot2c_f32_bf16 v161, s57, v129
    v_dot2c_f32_bf16 v165, v129, v129
    v_dot2c_f32_bf16 v161, s57, v130
    v_dot2c_f32_bf16 v165, v130, v130
    v_dot2c_f32_bf16 v161, s57, v131
    v_dot2c_f32_bf16 v165, v131, v131
    v_dot2c_f32_bf16 v161, s57, v132
    v_dot2c_f32_bf16 v165, v132, v132
    v_dot2c_f32_bf16 v161, s57, v133
    v_dot2c_f32_bf16 v165, v133, v133
    v_dot2c_f32_bf16 v161, s57, v134
    v_dot2c_f32_bf16 v165, v134, v134
    v_dot2c_f32_bf16 v161, s57, v135
    v_dot2c_f32_bf16 v165, v135, v135
    s_waitcnt vmcnt(4)
    v_dot2c_f32_bf16 v170, s57, v152
    v_dot2c_f32_bf16 v170, s57, v153
    v_dot2c_f32_bf16 v170, s57, v154
    v_dot2c_f32_bf16 v170, s57, v155
    v_dot2c_f32_bf16 v170, s57, v156
    v_dot2c_f32_bf16 v170, s57, v157
    v_dot2c_f32_bf16 v170, s57, v158
    v_dot2c_f32_bf16 v170, s57, v159
    v_dot2c_f32_bf16 v168, v152, v120
    v_dot2c_f32_bf16 v169, v152, v128
    v_dot2c_f32_bf16 v168, v153, v121
    v_dot2c_f32_bf16 v169, v153, v129
    v_dot2c_f32_bf16 v168, v154, v122
    v_dot2c_f32_bf16 v169, v154, v130
    v_dot2c_f32_bf16 v168, v155, v123
    v_dot2c_f32_bf16 v169, v155, v131
    v_mov_b32 v171, v170
    v_dot2c_f32_bf16 v168, v156, v124
    v_dot2c_f32_bf16 v169, v156, v132
    v_dot2c_f32_bf16 v168, v157, v125
    v_dot2c_f32_bf16 v169, v157, v133
    v_dot2c_f32_bf16 v168, v158, v126
    v_dot2c_f32_bf16 v169, v158, v134
    v_dot2c_f32_bf16 v168, v159, v127
    v_dot2c_f32_bf16 v169, v159, v135
    v_permlane32_swap_b32 v160, v161
    v_permlane32_swap_b32 v164, v165
    v_permlane32_swap_b32 v170, v171
    v_permlane32_swap_b32 v168, v169
    v_add_f32 v160, v160, v161
    v_add_f32 v164, v164, v165
    v_add_f32 v170, v170, v171
    v_add_f32_e64 v168, v168, v169
    v_add_f32_dpp v160, v160, v160 row_shr:1 row_mask:0xf bank_mask:0xf
    v_add_f32_dpp v164, v164, v164 row_shr:1 row_mask:0xf bank_mask:0xf
    v_add_f32_dpp v170, v170, v170 row_shr:1 row_mask:0xf bank_mask:0xf
    v_add_f32_dpp v168, v168, v168 row_shr:1 row_mask:0xf bank_mask:0xf
    v_add_f32_dpp v160, v160, v160 row_shr:2 row_mask:0xf bank_mask:0xf
    v_add_f32_dpp v164, v164, v164 row_shr:2 row_mask:0xf bank_mask:0xf
    v_add_f32_dpp v170, v170, v170 row_shr:2 row_mask:0xf bank_mask:0xf
    v_add_f32_dpp v168, v168, v168 row_shr:2 row_mask:0xf bank_mask:0xf
    v_add_f32_dpp v160, v160, v160 row_shr:4 row_mask:0xf bank_mask:0xf
    v_add_f32_dpp v164, v164, v164 row_shr:4 row_mask:0xf bank_mask:0xf
    v_add_f32_dpp v170, v170, v170 row_shr:4 row_mask:0xf bank_mask:0xf
    v_add_f32_dpp v168, v168, v168 row_shr:4 row_mask:0xf bank_mask:0xf
    v_add_f32_dpp v160, v160, v160 row_shr:8 row_mask:0xf bank_mask:0xf
    v_add_f32_dpp v164, v164, v164 row_shr:8 row_mask:0xf bank_mask:0xf
    v_add_f32_dpp v170, v170, v170 row_shr:8 row_mask:0xf bank_mask:0xf
    v_add_f32_dpp v168, v168, v168 row_shr:8 row_mask:0xf bank_mask:0xf
    v_add_f32_dpp v160, v160, v160 row_bcast:15 row_mask:0xa bank_mask:0xf
    v_add_f32_dpp v164, v164, v164 row_bcast:15 row_mask:0xa bank_mask:0xf
    v_add_f32_dpp v170, v170, v170 row_bcast:15 row_mask:0xa bank_mask:0xf
    v_add_f32_dpp v168, v168, v168 row_bcast:15 row_mask:0xa bank_mask:0xf
    v_mul_f32 v160, 0x3a800000, v160
    v_mul_f32 v164, 0x3a800000, v164
    v_fma_f32 v164, -v160, v160, v164
    v_cvt_pk_bf16_f32 v161, -v160, -v160
    v_max_f32 v164, 0, v164
    v_cvt_pk_bf16_f32 v164, v164, v164
    v_and_b32 v164, 0xffff0000, v164
    v_add_f32 v164, 0x3727c5ac, v164
    v_cvt_pk_bf16_f32 v164, v164, v164
    v_and_b32 v164, 0xffff0000, v164
    v_sqrt_f32 v164, v164
    v_and_b32 v165, 0xffff0000, v161
    v_cvt_pk_bf16_f32 v248, v160, v164
    v_and_b32 v164, 0xffff0000, v248
    v_rcp_f32 v164, v164
    v_fmac_f32 v168, v170, v165
    v_mul_f32 v168, v168, v164
    v_ashrrev_i32 v170, 31, v168
    v_or_b32 v170, 0x80000000, v170
    v_xor_b32 v168, v168, v170
    v_and_b32 v168, 0xfffff800, v168
    v_or_b32 v249, v200, v168
    s_mov_b64 exec, s[64:65]
    ds_write_b32 v201, v248 offset:41472
    ds_max_u64 v0, v[248:249] offset:41504
    s_mov_b64 exec, 1
    ds_add_rtn_u32 v1, v0, v255 offset:42816
    s_mov_b64 exec, 31
    ds_read_b64 v[172:173], v5 offset:41472
    s_mov_b64 exec, s[64:65]
    ds_write_b16 v202, v161 offset:41568
    ds_write_b32 v203, v164 offset:42752
    s_mov_b64 exec, -1
    s_nop 0
    v_mov_b32_dpp v6, v128 wave_rol:1 row_mask:0xf bank_mask:0xf
    v_mov_b32_dpp v7, v132 wave_rol:1 row_mask:0xf bank_mask:0xf
    v_bfi_b32 v221, s59, v131, v130
    v_bfi_b32 v222, s59, v130, v129
    v_bfi_b32 v223, s59, v129, v128
    v_bfi_b32 v217, s59, v135, v134
    v_bfi_b32 v218, s59, v134, v133
    v_bfi_b32 v219, s59, v133, v132
    v_cndmask_b32 v220, v6, v7, s[66:67]
    v_cndmask_b32 v216, v7, v6, s[66:67]
    v_bfi_b32 v220, s59, v220, v131
    v_bfi_b32 v216, s59, v216, v135
    s_waitcnt lgkmcnt(2)
    v_readfirstlane_b32 s31, v1
    s_nop 0
    s_cmp_lg_u32 s31, 3
    s_cbranch_scc1 L_not_last
    s_mov_b64 exec, 31
    buffer_store_dwordx4 v[172:175], v4, s[12:15], 0 offen sc1
    s_mov_b64 exec, -1
    s_waitcnt vmcnt(1)
    s_branch L_b_ready
L_not_last:
    s_waitcnt vmcnt(0)
L_b_ready:
    s_setprio 3
    ds_write_b128 v204, v[120:123] offset:0
    ds_write_b128 v204, v[124:127] offset:1280
    s_cmp_lg_u32 s50, 0
    s_cbranch_scc1 L_plain1
    ds_write_b128 v205, v[216:219]
    ds_write_b128 v205, v[220:223] offset:1280
    s_branch L_second1
L_plain1:
    ds_write_b128 v204, v[128:131] offset:20736
    ds_write_b128 v204, v[132:135] offset:22016
L_second1:
    v_add_u32 v204, s62, v204
    v_add_u32 v205, s62, v205
    v_dot2c_f32_bf16 v162, s57, v136
    v_dot2c_f32_bf16 v166, v136, v136
    v_dot2c_f32_bf16 v162, s57, v137
    v_dot2c_f32_bf16 v166, v137, v137
    v_dot2c_f32_bf16 v162, s57, v138
    v_dot2c_f32_bf16 v166, v138, v138
    v_dot2c_f32_bf16 v162, s57, v139
    v_dot2c_f32_bf16 v166, v139, v139
    v_dot2c_f32_bf16 v162, s57, v140
    v_dot2c_f32_bf16 v166, v140, v140
    v_dot2c_f32_bf16 v162, s57, v141
    v_dot2c_f32_bf16 v166, v141, v141
    v_dot2c_f32_bf16 v162, s57, v142
    v_dot2c_f32_bf16 v166, v142, v142
    v_dot2c_f32_bf16 v162, s57, v143
    v_dot2c_f32_bf16 v166, v143, v143
    ds_write_b128 v204, v[136:139] offset:0
    ds_write_b128 v204, v[140:143] offset:1280
    v_dot2c_f32_bf16 v163, s57, v144
    v_dot2c_f32_bf16 v167, v144, v144
    v_dot2c_f32_bf16 v163, s57, v145
    v_dot2c_f32_bf16 v167, v145, v145
    v_dot2c_f32_bf16 v163, s57, v146
    v_dot2c_f32_bf16 v167, v146, v146
    v_dot2c_f32_bf16 v163, s57, v147
    v_dot2c_f32_bf16 v167, v147, v147
    v_dot2c_f32_bf16 v163, s57, v148
    v_dot2c_f32_bf16 v167, v148, v148
    v_dot2c_f32_bf16 v163, s57, v149
    v_dot2c_f32_bf16 v167, v149, v149
    v_dot2c_f32_bf16 v163, s57, v150
    v_dot2c_f32_bf16 v167, v150, v150
    v_dot2c_f32_bf16 v163, s57, v151
    v_dot2c_f32_bf16 v167, v151, v151
    v_xor_b32 v202, 8, v202
    v_xor_b32 v203, 16, v203
    s_waitcnt lgkmcnt(2)
    s_nop 0
    v_mov_b32_dpp v6, v144 wave_rol:1 row_mask:0xf bank_mask:0xf
    v_mov_b32_dpp v7, v148 wave_rol:1 row_mask:0xf bank_mask:0xf
    v_bfi_b32 v221, s59, v147, v146
    v_bfi_b32 v222, s59, v146, v145
    v_bfi_b32 v223, s59, v145, v144
    v_bfi_b32 v217, s59, v151, v150
    v_bfi_b32 v218, s59, v150, v149
    v_bfi_b32 v219, s59, v149, v148
    v_cndmask_b32 v220, v6, v7, s[66:67]
    v_cndmask_b32 v216, v7, v6, s[66:67]
    v_bfi_b32 v220, s59, v220, v147
    v_bfi_b32 v216, s59, v216, v151
    s_cmp_lg_u32 s50, 0
    s_cbranch_scc1 L_plain3
    ds_write_b128 v205, v[216:219]
    ds_write_b128 v205, v[220:223] offset:1280
    s_branch L_second3
L_plain3:
    ds_write_b128 v204, v[144:147] offset:20736
    ds_write_b128 v204, v[148:151] offset:22016
L_second3:
    v_permlane32_swap_b32 v162, v163
    v_permlane32_swap_b32 v166, v167
    v_add_f32 v162, v162, v163
    v_add_f32 v166, v166, v167
    s_nop 0
    v_add_f32_dpp v162, v162, v162 row_shr:1 row_mask:0xf bank_mask:0xf
    v_add_f32_dpp v166, v166, v166 row_shr:1 row_mask:0xf bank_mask:0xf
    s_nop 0
    v_add_f32_dpp v162, v162, v162 row_shr:2 row_mask:0xf bank_mask:0xf
    v_add_f32_dpp v166, v166, v166 row_shr:2 row_mask:0xf bank_mask:0xf
    s_nop 0
    v_add_f32_dpp v162, v162, v162 row_shr:4 row_mask:0xf bank_mask:0xf
    v_add_f32_dpp v166, v166, v166 row_shr:4 row_mask:0xf bank_mask:0xf
    s_nop 0
    v_add_f32_dpp v162, v162, v162 row_shr:8 row_mask:0xf bank_mask:0xf
    v_add_f32_dpp v166, v166, v166 row_shr:8 row_mask:0xf bank_mask:0xf
    s_nop 0
    v_add_f32_dpp v162, v162, v162 row_bcast:15 row_mask:0xa bank_mask:0xf
    v_add_f32_dpp v166, v166, v166 row_bcast:15 row_mask:0xa bank_mask:0xf
    v_mul_f32 v162, 0x3a800000, v162
    v_mul_f32 v166, 0x3a800000, v166
    v_fma_f32 v166, -v162, v162, v166
    v_cvt_pk_bf16_f32 v161, -v162, -v162
    v_max_f32 v166, 0, v166
    v_cvt_pk_bf16_f32 v166, v166, v166
    v_and_b32 v166, 0xffff0000, v166
    v_add_f32 v166, 0x3727c5ac, v166
    v_cvt_pk_bf16_f32 v166, v166, v166
    v_and_b32 v166, 0xffff0000, v166
    v_sqrt_f32 v166, v166
    v_and_b32 v167, 0xffff0000, v161
    v_cvt_pk_bf16_f32 v248, v162, v166
    v_and_b32 v166, 0xffff0000, v248
    v_rcp_f32 v166, v166
    s_mov_b64 exec, s[64:65]
    ds_write_b16 v202, v161 offset:41568
    ds_write_b32 v203, v166 offset:42752
    s_mov_b64 exec, 1
    ds_add_u32 v0, v255 offset:42820
    s_mov_b64 exec, -1
L_sync2:
    ds_read_b32 v1, v0 offset:42820
    ds_read_b128 v[176:179], v0 offset:42752
    ds_read_b128 v[180:183], v0 offset:42768
    ds_read_b128 v[184:187], v0 offset:42784
    ds_read_b128 v[188:191], v0 offset:42800
    ds_read_b128 v[192:195], v0 offset:41568
    ds_read_b128 v[196:199], v0 offset:41584
    s_add_u32 s92, s92, 1
    s_bitcmp1_b32 s92, 20
    s_cbranch_scc1 L_sync2x
    s_waitcnt lgkmcnt(6)
    v_readfirstlane_b32 s31, v1
    s_nop 0
    s_cmp_ge_u32 s31, 4
    s_cbranch_scc0 L_sync2
L_sync2x:
    ds_read_b64_tr_b16 v[120:121], v206 offset:0
    ds_read_b64_tr_b16 v[122:123], v206 offset:10368
    ds_read_b64_tr_b16 v[124:125], v206 offset:20736
    ds_read_b64_tr_b16 v[126:127], v206 offset:31104
    ds_read_b64_tr_b16 v[128:129], v206 offset:32
    ds_read_b64_tr_b16 v[130:131], v206 offset:10400
    ds_read_b64_tr_b16 v[132:133], v206 offset:20768
    ds_read_b64_tr_b16 v[134:135], v206 offset:31136
    s_waitcnt lgkmcnt(10)
    s_nop 0
    ds_read_b64_tr_b16 v[136:137], v206 offset:64
    ds_read_b64_tr_b16 v[138:139], v206 offset:10432
    ds_read_b64_tr_b16 v[140:141], v206 offset:20800
    ds_read_b64_tr_b16 v[142:143], v206 offset:31168
    v_pk_mul_f32 v[176:177], v[176:177], v[8:9]
    v_pk_mul_f32 v[178:179], v[178:179], v[10:11]
    v_pk_mul_f32 v[180:181], v[180:181], v[12:13]
    v_pk_mul_f32 v[182:183], v[182:183], v[14:15]
    v_pk_mul_f32 v[184:185], v[184:185], v[8:9]
    v_pk_mul_f32 v[186:187], v[186:187], v[10:11]
    v_pk_mul_f32 v[188:189], v[188:189], v[12:13]
    v_pk_mul_f32 v[190:191], v[190:191], v[14:15]
    v_cvt_pk_bf16_f32 v160, v176, v177
    v_cvt_pk_bf16_f32 v152, v184, v185
    v_cvt_pk_bf16_f32 v161, v178, v179
    v_cvt_pk_bf16_f32 v153, v186, v187
    v_cvt_pk_bf16_f32 v162, v180, v181
    v_cvt_pk_bf16_f32 v154, v188, v189
    v_cvt_pk_bf16_f32 v163, v182, v183
    v_cvt_pk_bf16_f32 v155, v190, v191
    v_xor_b32 v164, v208, v160
    v_xor_b32 v156, v208, v152
    v_xor_b32 v165, v208, v161
    v_xor_b32 v157, v208, v153
    v_xor_b32 v166, v208, v162
    v_xor_b32 v158, v208, v154
    v_xor_b32 v167, v208, v163
    v_xor_b32 v159, v208, v155
    s_waitcnt lgkmcnt(12)
    s_cmp_lg_u32 s50, 0
    s_cbranch_scc1 L_st1_split
    v_mfma_f32_16x16x32_bf16 v[168:171], v[160:163], v[192:195], 0
    v_mfma_f32_16x16x32_bf16 v[168:171], v[152:155], v[196:199], v[168:171]
    s_waitcnt lgkmcnt(10)
    ds_read_b64_tr_b16 v[144:145], v206 offset:96
    ds_read_b64_tr_b16 v[146:147], v206 offset:10464
    ds_read_b64_tr_b16 v[148:149], v206 offset:20832
    ds_read_b64_tr_b16 v[150:151], v206 offset:31200
    v_mfma_f32_16x16x32_bf16 v[216:219], v[160:163], v[120:123], v[168:171]
    s_waitcnt lgkmcnt(12)
    v_mfma_f32_16x16x32_bf16 v[216:219], v[152:155], v[124:127], v[216:219]
    s_waitcnt lgkmcnt(10)
    v_mfma_f32_16x16x32_bf16 v[224:227], v[160:163], v[128:131], v[168:171]
    s_waitcnt lgkmcnt(8)
    v_mfma_f32_16x16x32_bf16 v[224:227], v[152:155], v[132:135], v[224:227]
    s_waitcnt lgkmcnt(6)
    v_mfma_f32_16x16x32_bf16 v[232:235], v[160:163], v[136:139], v[168:171]
    s_waitcnt lgkmcnt(4)
    v_mfma_f32_16x16x32_bf16 v[232:235], v[152:155], v[140:143], v[232:235]
    s_waitcnt lgkmcnt(2)
    v_mfma_f32_16x16x32_bf16 v[240:243], v[160:163], v[144:147], v[168:171]
    s_waitcnt lgkmcnt(0)
    v_mfma_f32_16x16x32_bf16 v[240:243], v[152:155], v[148:151], v[240:243]
    v_mfma_f32_16x16x32_bf16 v[220:223], v[164:167], v[120:123], 0
    v_mfma_f32_16x16x32_bf16 v[220:223], v[156:159], v[124:127], v[220:223]
    v_mfma_f32_16x16x32_bf16 v[228:231], v[164:167], v[128:131], 0
    v_mfma_f32_16x16x32_bf16 v[228:231], v[156:159], v[132:135], v[228:231]
    v_cvt_pk_f16_f32 v176, v216, v217
    v_cvt_pk_f16_f32 v177, v224, v225
    v_cvt_pk_f16_f32 v178, v232, v233
    s_nop 0
    v_cvt_pk_f16_f32 v179, v240, v241
    ds_write_b128 v207, v[176:179] offset:44032
    v_mfma_f32_16x16x32_bf16 v[236:239], v[164:167], v[136:139], 0
    v_mfma_f32_16x16x32_bf16 v[236:239], v[156:159], v[140:143], v[236:239]
    v_cvt_pk_f16_f32 v180, v218, v219
    v_cvt_pk_f16_f32 v181, v226, v227
    v_cvt_pk_f16_f32 v182, v234, v235
    v_cvt_pk_f16_f32 v183, v242, v243
    ds_write_b128 v207, v[180:183] offset:45056
    v_mfma_f32_16x16x32_bf16 v[244:247], v[164:167], v[144:147], 0
    v_mfma_f32_16x16x32_bf16 v[244:247], v[156:159], v[148:151], v[244:247]
    v_cvt_pk_f16_f32 v184, v220, v221
    v_cvt_pk_f16_f32 v185, v228, v229
    v_cvt_pk_f16_f32 v186, v236, v237
    s_nop 4
    v_cvt_pk_f16_f32 v187, v244, v245
    ds_write_b128 v207, v[184:187] offset:46080
    v_cvt_pk_f16_f32 v188, v222, v223
    v_cvt_pk_f16_f32 v189, v230, v231
    v_cvt_pk_f16_f32 v190, v238, v239
    v_cvt_pk_f16_f32 v191, v246, v247
    ds_write_b128 v207, v[188:191] offset:47104
    s_branch L_st1_done
L_st1_split:
    s_waitcnt lgkmcnt(8)
    ds_read_b64_tr_b16 v[144:145], v206 offset:96
    ds_read_b64_tr_b16 v[146:147], v206 offset:10464
    ds_read_b64_tr_b16 v[148:149], v206 offset:20832
    ds_read_b64_tr_b16 v[150:151], v206 offset:31200
    s_waitcnt lgkmcnt(0)
    v_mfma_f32_16x16x32_bf16 v[168:171], v[160:163], v[192:195], 0
    v_mfma_f32_16x16x32_bf16 v[220:223], v[164:167], v[120:123], 0
    v_mfma_f32_16x16x32_bf16 v[216:219], v[160:163], v[120:123], v[168:171]
    v_mfma_f32_16x16x32_bf16 v[228:231], v[164:167], v[128:131], 0
    v_mfma_f32_16x16x32_bf16 v[224:227], v[160:163], v[128:131], v[168:171]
    v_mfma_f32_16x16x32_bf16 v[236:239], v[164:167], v[136:139], 0
    v_mfma_f32_16x16x32_bf16 v[232:235], v[160:163], v[136:139], v[168:171]
    v_mfma_f32_16x16x32_bf16 v[244:247], v[164:167], v[144:147], 0
    v_mfma_f32_16x16x32_bf16 v[240:243], v[160:163], v[144:147], v[168:171]
    s_nop 1
    s_nop 0
    v_cvt_pk_f16_f32 v176, v216, v217
    v_cvt_pk_f16_f32 v180, v218, v219
    v_cvt_pk_f16_f32 v184, v220, v221
    v_cvt_pk_f16_f32 v188, v222, v223
    v_cvt_pk_f16_f32 v177, v224, v225
    v_cvt_pk_f16_f32 v181, v226, v227
    v_cvt_pk_f16_f32 v185, v228, v229
    v_cvt_pk_f16_f32 v189, v230, v231
    v_cvt_pk_f16_f32 v178, v232, v233
    v_cvt_pk_f16_f32 v182, v234, v235
    v_cvt_pk_f16_f32 v186, v236, v237
    v_cvt_pk_f16_f32 v190, v238, v239
    v_cvt_pk_f16_f32 v179, v240, v241
    v_cvt_pk_f16_f32 v183, v242, v243
    v_cvt_pk_f16_f32 v187, v244, v245
    v_cvt_pk_f16_f32 v191, v246, v247
    ds_write_b128 v207, v[176:179] offset:44032
    ds_write_b128 v207, v[180:183] offset:45056
    ds_write_b128 v207, v[184:187] offset:46080
    ds_write_b128 v207, v[188:191] offset:47104
    v_mfma_f32_16x16x32_bf16 v[168:171], v[152:155], v[196:199], 0
    v_mfma_f32_16x16x32_bf16 v[220:223], v[156:159], v[124:127], 0
    v_mfma_f32_16x16x32_bf16 v[216:219], v[152:155], v[124:127], v[168:171]
    v_mfma_f32_16x16x32_bf16 v[228:231], v[156:159], v[132:135], 0
    v_mfma_f32_16x16x32_bf16 v[224:227], v[152:155], v[132:135], v[168:171]
    v_mfma_f32_16x16x32_bf16 v[236:239], v[156:159], v[140:143], 0
    v_mfma_f32_16x16x32_bf16 v[232:235], v[152:155], v[140:143], v[168:171]
    v_mfma_f32_16x16x32_bf16 v[244:247], v[156:159], v[148:151], 0
    v_mfma_f32_16x16x32_bf16 v[240:243], v[152:155], v[148:151], v[168:171]
    s_waitcnt lgkmcnt(0)
    s_nop 0
    v_cvt_pk_f16_f32 v176, v216, v217
    v_cvt_pk_f16_f32 v180, v218, v219
    v_cvt_pk_f16_f32 v184, v220, v221
    v_cvt_pk_f16_f32 v188, v222, v223
    v_cvt_pk_f16_f32 v177, v224, v225
    v_cvt_pk_f16_f32 v181, v226, v227
    v_cvt_pk_f16_f32 v185, v228, v229
    v_cvt_pk_f16_f32 v189, v230, v231
    v_cvt_pk_f16_f32 v178, v232, v233
    v_cvt_pk_f16_f32 v182, v234, v235
    v_cvt_pk_f16_f32 v186, v236, v237
    v_cvt_pk_f16_f32 v190, v238, v239
    v_cvt_pk_f16_f32 v179, v240, v241
    v_cvt_pk_f16_f32 v183, v242, v243
    v_cvt_pk_f16_f32 v187, v244, v245
    v_cvt_pk_f16_f32 v191, v246, v247
    ds_write_b128 v207, v[176:179] offset:60416
    ds_write_b128 v207, v[180:183] offset:61440
    ds_write_b128 v207, v[184:187] offset:62464
    ds_write_b128 v207, v[188:191] offset:63488
L_st1_done:
    s_mov_b64 exec, 1
    ds_add_u32 v0, v255 offset:42824
    s_mov_b64 exec, -1
    s_lshl_b32 s31, s30, 12
    v_add_u32 v5, s31, v3
    s_and_b32 s31, s28, 0x30003
    v_mov_b32 v210, s31
    s_mov_b32 s58, 0xfffcfffc
    s_and_b32 s32, s48, 3
    s_cselect_b32 s72, -1, 0xff
    s_cselect_b32 s73, -1, 0
    s_mov_b32 s74, s48
    s_mov_b64 s[60:61], 0
    s_mov_b64 s[62:63], 0
    v_mov_b32 v209, 2147483392
    s_cmp_eq_u32 s48, 7
    s_cbranch_scc1 L_no_consts
    v_mul_f32 v250, v212, v251
    v_fmamk_f32 v76, v250, 0x3d800000, v252
    v_sin_f32 v44, v250
    v_cos_f32 v250, v250
    v_cos_f32 v72, v76
    v_sin_f32 v76, v76
    v_cvt_pk_f16_f32 v40, v250, v44
    v_cvt_pk_f16_f32 v44, -v44, v250
    v_mul_f32 v250, v213, v251
    v_fmamk_f32 v77, v250, 0x3d800000, v252
    v_sin_f32 v45, v250
    v_cos_f32 v250, v250
    v_cos_f32 v73, v77
    v_sin_f32 v77, v77
    v_cvt_pk_f16_f32 v41, v250, v45
    v_cvt_pk_f16_f32 v45, -v45, v250
    v_mul_f32 v250, v214, v251
    v_fmamk_f32 v78, v250, 0x3d800000, v252
    v_sin_f32 v46, v250
    v_cos_f32 v250, v250
    v_cos_f32 v74, v78
    v_sin_f32 v78, v78
    v_cvt_pk_f16_f32 v42, v250, v46
    v_cvt_pk_f16_f32 v46, -v46, v250
    v_mul_f32 v250, v215, v251
    v_fmamk_f32 v79, v250, 0x3d800000, v252
    v_sin_f32 v47, v250
    v_cos_f32 v250, v250
    v_cos_f32 v75, v79
    v_sin_f32 v79, v79
    v_cvt_pk_f16_f32 v43, v250, v47
    v_cvt_pk_f16_f32 v47, -v47, v250
    s_and_b32 s31, s46, 1
    s_lshl_b32 s31, s31, 6
    s_lshr_b32 s32, s46, 1
    s_add_u32 s49, s31, s32
    s_bitcmp1_b32 s49, 2
    s_cselect_b64 vcc, -1, 0
    v_cndmask_b32 v80, v16, v20, vcc
    v_cndmask_b32 v84, v20, v16, vcc
    v_cndmask_b32 v81, v17, v21, vcc
    v_cndmask_b32 v85, v21, v17, vcc
    v_cndmask_b32 v82, v18, v22, vcc
    v_cndmask_b32 v86, v22, v18, vcc
    v_cndmask_b32 v83, v19, v23, vcc
    v_cndmask_b32 v87, v23, v19, vcc
    s_bfe_u32 s31, s49, 0x10001
    v_and_b32 v6, 7, v2
    v_xor_b32 v6, s31, v6
    v_lshlrev_b32 v6, 4, v6
    v_lshrrev_b32 v7, 4, v2
    v_lshlrev_b32 v7, 3, v7
    v_bfe_u32 v209, v2, 3, 1
    v_add_u32 v7, v7, v209
    v_mul_u32_u24 v7, 16512, v7
    v_add_u32 v209, v6, v7
    s_mul_i32 s31, s48, 528384
    s_lshl_b32 s32, s49, 7
    s_add_u32 s31, s31, s32
    s_add_u32 s60, s31, 2097152
L_no_consts:
L_st23:
L_sync3:
    ds_read_b32 v1, v0 offset:42824
    ds_read_b128 v[120:123], v5 offset:44032
    ds_read_b128 v[124:127], v5 offset:45056
    ds_read_b128 v[128:131], v5 offset:46080
    ds_read_b128 v[132:135], v5 offset:47104
    s_add_u32 s92, s92, 1
    s_bitcmp1_b32 s92, 20
    s_cbranch_scc1 L_sync3x
    s_waitcnt lgkmcnt(4)
    v_readfirstlane_b32 s31, v1
    s_nop 0
    s_cmp_ge_u32 s31, 4
    s_cbranch_scc0 L_sync3
L_sync3x:
    s_cmp_eq_u32 s48, 7
    s_cbranch_scc1 L_p1_done
    s_add_u32 s61, s60, 33024
    s_add_u32 s62, s61, 33024
    s_add_u32 s63, s62, 33024
    s_waitcnt lgkmcnt(3)
    v_mfma_f32_16x16x32_f16 v[136:139], v[120:123], v[16:19], 0
    v_mfma_f32_16x16x32_f16 v[140:143], v[120:123], v[20:23], 0
    s_waitcnt lgkmcnt(2)
    v_mfma_f32_16x16x32_f16 v[144:147], v[124:127], v[24:27], 0
    v_mfma_f32_16x16x32_f16 v[148:151], v[124:127], v[28:31], 0
    s_nop 3
    v_pk_mul_f32 v[152:153], v[48:49], v[136:137]
    v_pk_mul_f32 v[154:155], v[50:51], v[138:139]
    v_pk_mul_f32 v[156:157], v[52:53], v[136:137]
    v_pk_mul_f32 v[158:159], v[54:55], v[138:139]
    v_pk_fma_f32 v[152:153], v[52:53], v[140:141], v[152:153]
    v_pk_fma_f32 v[156:157], v[48:49], v[140:141], v[156:157] neg_lo:[0,0,1] neg_hi:[0,0,1]
    v_pk_fma_f32 v[154:155], v[54:55], v[142:143], v[154:155]
    v_pk_fma_f32 v[158:159], v[50:51], v[142:143], v[158:159] neg_lo:[0,0,1] neg_hi:[0,0,1]
    v_cvt_pk_f16_f32 v120, v152, v156
    v_cvt_pk_f16_f32 v121, v153, v157
    v_cvt_pk_f16_f32 v122, v154, v158
    v_cvt_pk_f16_f32 v123, v155, v159
    s_waitcnt lgkmcnt(1)
    s_nop 0
    v_mfma_f32_16x16x32_f16 v[136:139], v[128:131], v[32:35], 0
    v_mfma_f32_16x16x32_f16 v[140:143], v[128:131], v[36:39], 0
    v_mfma_f32_16x16x32_f16 v[216:219], v[80:83], v[120:123], 0
    v_mfma_f32_16x16x32_f16 v[220:223], v[84:87], v[120:123], 0
    v_pk_mul_f32 v[152:153], v[56:57], v[144:145]
    v_pk_mul_f32 v[154:155], v[58:59], v[146:147]
    v_pk_mul_f32 v[156:157], v[60:61], v[144:145]
    v_pk_mul_f32 v[158:159], v[62:63], v[146:147]
    v_pk_fma_f32 v[152:153], v[60:61], v[148:149], v[152:153]
    v_pk_fma_f32 v[156:157], v[56:57], v[148:149], v[156:157] neg_lo:[0,0,1] neg_hi:[0,0,1]
    v_pk_fma_f32 v[154:155], v[62:63], v[150:151], v[154:155]
    v_pk_fma_f32 v[158:159], v[58:59], v[150:151], v[158:159] neg_lo:[0,0,1] neg_hi:[0,0,1]
    v_cvt_pk_f16_f32 v124, v152, v156
    v_cvt_pk_f16_f32 v125, v153, v157
    v_cvt_pk_f16_f32 v126, v154, v158
    v_cvt_pk_f16_f32 v127, v155, v159
    s_waitcnt lgkmcnt(0)
    s_nop 0
    v_mfma_f32_16x16x32_f16 v[144:147], v[132:135], v[40:43], 0
    v_mfma_f32_16x16x32_f16 v[148:151], v[132:135], v[44:47], 0
    v_mfma_f32_16x16x32_f16 v[224:227], v[80:83], v[124:127], 0
    v_mfma_f32_16x16x32_f16 v[228:231], v[84:87], v[124:127], 0
    v_pk_mul_f32 v[152:153], v[64:65], v[136:137]
    v_pk_mul_f32 v[154:155], v[66:67], v[138:139]
    v_pk_mul_f32 v[156:157], v[68:69], v[136:137]
    v_pk_mul_f32 v[158:159], v[70:71], v[138:139]
    v_pk_fma_f32 v[152:153], v[68:69], v[140:141], v[152:153]
    v_pk_fma_f32 v[156:157], v[64:65], v[140:141], v[156:157] neg_lo:[0,0,1] neg_hi:[0,0,1]
    v_pk_fma_f32 v[154:155], v[70:71], v[142:143], v[154:155]
    v_pk_fma_f32 v[158:159], v[66:67], v[142:143], v[158:159] neg_lo:[0,0,1] neg_hi:[0,0,1]
    v_cvt_pk_f16_f32 v128, v152, v156
    v_cvt_pk_f16_f32 v129, v153, v157
    v_cvt_pk_f16_f32 v130, v154, v158
    v_cvt_pk_f16_f32 v131, v155, v159
    s_nop 1
    s_nop 0
    v_mfma_f32_16x16x32_f16 v[232:235], v[80:83], v[128:131], 0
    v_mfma_f32_16x16x32_f16 v[236:239], v[84:87], v[128:131], 0
    v_pk_mul_f32 v[152:153], v[72:73], v[144:145]
    v_pk_mul_f32 v[154:155], v[74:75], v[146:147]
    v_pk_mul_f32 v[156:157], v[76:77], v[144:145]
    v_pk_mul_f32 v[158:159], v[78:79], v[146:147]
    v_pk_fma_f32 v[152:153], v[76:77], v[148:149], v[152:153]
    v_pk_fma_f32 v[156:157], v[72:73], v[148:149], v[156:157] neg_lo:[0,0,1] neg_hi:[0,0,1]
    v_pk_fma_f32 v[154:155], v[78:79], v[150:151], v[154:155]
    v_pk_fma_f32 v[158:159], v[74:75], v[150:151], v[158:159] neg_lo:[0,0,1] neg_hi:[0,0,1]
    v_cvt_pk_f16_f32 v132, v152, v156
    v_cvt_pk_f16_f32 v133, v153, v157
    v_cvt_pk_f16_f32 v134, v154, v158
    v_cvt_pk_f16_f32 v135, v155, v159
    s_nop 1
    s_nop 0
    v_mfma_f32_16x16x32_f16 v[240:243], v[80:83], v[132:135], 0
    v_mfma_f32_16x16x32_f16 v[244:247], v[84:87], v[132:135], 0
    v_cvt_pk_f16_f32 v176, v216, v224
    v_cvt_pk_f16_f32 v178, v220, v228
    v_and_or_b32 v176, v176, s58, v210
    v_and_or_b32 v178, v178, s58, v210
    v_cvt_pk_f16_f32 v180, v217, v225
    v_cvt_pk_f16_f32 v182, v221, v229
    v_and_or_b32 v180, v180, s58, v210
    v_and_or_b32 v182, v182, s58, v210
    v_cvt_pk_f16_f32 v184, v218, v226
    v_cvt_pk_f16_f32 v186, v222, v230
    v_and_or_b32 v184, v184, s58, v210
    v_and_or_b32 v186, v186, s58, v210
    v_cvt_pk_f16_f32 v188, v219, v227
    v_cvt_pk_f16_f32 v190, v223, v231
    v_and_or_b32 v188, v188, s58, v210
    v_and_or_b32 v190, v190, s58, v210
    v_cvt_pk_f16_f32 v177, v232, v240
    v_cvt_pk_f16_f32 v179, v236, v244
    v_and_or_b32 v177, v177, s58, v210
    v_and_or_b32 v179, v179, s58, v210
    v_cvt_pk_f16_f32 v181, v233, v241
    v_cvt_pk_f16_f32 v183, v237, v245
    v_and_or_b32 v181, v181, s58, v210
    v_and_or_b32 v183, v183, s58, v210
    v_cvt_pk_f16_f32 v185, v234, v242
    v_cvt_pk_f16_f32 v187, v238, v246
    v_and_or_b32 v185, v185, s58, v210
    v_and_or_b32 v187, v187, s58, v210
    v_cvt_pk_f16_f32 v189, v235, v243
    v_cvt_pk_f16_f32 v191, v239, v247
    v_and_or_b32 v189, v189, s58, v210
    v_and_or_b32 v191, v191, s58, v210
    s_cmp_eq_u32 s50, 0
    s_cbranch_scc1 L_p1_done
    s_mov_b32 exec_hi, s72
    buffer_store_dwordx4 v[176:179], v209, s[12:15], s60 offen sc1
    s_mov_b32 exec_hi, s73
    buffer_store_dwordx4 v[180:183], v209, s[12:15], s61 offen sc1
    buffer_store_dwordx4 v[184:187], v209, s[12:15], s62 offen sc1
    buffer_store_dwordx4 v[188:191], v209, s[12:15], s63 offen sc1
    s_mov_b32 exec_hi, -1
    s_mov_b32 s50, 0
    s_add_u32 s60, s60, 16384
    v_add_u32 v5, 16384, v5
    s_sub_u32 s31, s48, 4
    v_cvt_f32_i32 v252, s31
    v_mul_f32 v252, 0x3d800000, v252
    v_and_b32 v251, 15, v2
    v_lshlrev_b32 v251, 2, v251
    v_cvt_f32_u32 v251, v251
    v_fma_f32 v250, v212, v251, v252
    v_sin_f32 v84, v250
    v_cos_f32 v250, v250
    s_nop 0
    v_cvt_pk_f16_f32 v80, v250, v84
    v_cvt_pk_f16_f32 v84, -v84, v250
    v_fma_f32 v250, v213, v251, v252
    v_sin_f32 v85, v250
    v_cos_f32 v250, v250
    s_nop 0
    v_cvt_pk_f16_f32 v81, v250, v85
    v_cvt_pk_f16_f32 v85, -v85, v250
    v_fma_f32 v250, v214, v251, v252
    v_sin_f32 v86, v250
    v_cos_f32 v250, v250
    s_nop 0
    v_cvt_pk_f16_f32 v82, v250, v86
    v_cvt_pk_f16_f32 v86, -v86, v250
    v_fma_f32 v250, v215, v251, v252
    v_sin_f32 v87, v250
    v_cos_f32 v250, v250
    s_nop 0
    v_cvt_pk_f16_f32 v83, v250, v87
    v_cvt_pk_f16_f32 v87, -v87, v250
    s_branch L_st23
L_p1_done:
    s_mov_b64 exec, 1
    ds_add_u32 v0, v255 offset:42828
    s_mov_b64 exec, -1
    s_setprio 0
    v_mov_b32 v4, v112
    v_mov_b32 v5, v113
    v_mov_b32 v249, v114
    v_mov_b32 v205, v115
    v_mov_b32 v248, v116
    v_mov_b32 v208, v117
    v_mov_b32 v7, v118
    v_mov_b32 v6, v119
    s_and_b32 s31, s2, 7
    s_sub_u32 s32, 8, s31
    s_min_u32 s46, s31, s32
    s_lshr_b32 s53, s31, 2
    s_lshr_b32 s47, s2, 3
    s_and_b32 s32, s47, 1
    s_and_b32 s31, s31, 3
    s_cselect_b32 s53, s53, s32
    s_cselect_b32 s31, 0, 1
    s_lshr_b32 s47, s47, s31
    s_lshl_b32 s53, s53, 4
    s_lshl_b32 s31, s30, 5
    s_add_u32 s53, s53, s31
    s_lshl_b32 s48, s46, 1
    s_add_u32 s48, s48, 2040
    s_mov_b32 s49, 32768
    v_mov_b32 v212, v210
    v_mov_b32 v213, v210
    v_mov_b32 v214, v210
    v_mov_b32 v215, v210
    s_cmp_ge_u32 s2, 224
    s_cbranch_scc1 L_zst_go
L_sync4:
    ds_read_b32 v1, v0 offset:42840
    s_add_u32 s92, s92, 1
    s_bitcmp1_b32 s92, 20
    s_cbranch_scc1 L_sync4x
    s_waitcnt lgkmcnt(0)
    v_readfirstlane_b32 s31, v1
    s_nop 0
    s_cmp_ge_u32 s31, 1
    s_cbranch_scc0 L_sync4
L_sync4x:
L_zst_go:
    s_mov_b32 exec_hi, s72
    buffer_store_dwordx4 v[176:179], v209, s[12:15], s60 offen sc1
    s_mov_b32 exec_hi, s73
    buffer_store_dwordx4 v[180:183], v209, s[12:15], s61 offen sc1
    buffer_store_dwordx4 v[184:187], v209, s[12:15], s62 offen sc1
    buffer_store_dwordx4 v[188:191], v209, s[12:15], s63 offen sc1
    s_mov_b32 exec_hi, -1
L_sync5:
    ds_read_b32 v1, v0 offset:42860
    s_add_u32 s92, s92, 1
    s_bitcmp1_b32 s92, 20
    s_cbranch_scc1 L_sync5x
    s_waitcnt lgkmcnt(0)
    v_readfirstlane_b32 s31, v1
    s_nop 0
    s_cmp_ge_u32 s31, 1
    s_cbranch_scc0 L_sync5
L_sync5x:
    buffer_load_dwordx4 v[24:27], v6, s[12:15], s49 offen
    s_add_u32 m0, s76, 0
    s_nop 0
    buffer_load_dwordx4 v4, s[8:11], 0 offen lds
    s_add_u32 m0, s76, 1024
    s_nop 0
    buffer_load_dwordx4 v5, s[8:11], 0 offen lds
    v_and_b32 v160, 15, v2
    v_add_u32 v160, s53, v160
    v_cvt_f32_u32 v160, v160
    v_add_f32 v160, 0.5, v160
    v_mul_f32 v160, 0x3b800000, v160
    v_and_b32 v161, 32, v2
    v_bfe_u32 v162, v2, 4, 1
    v_lshl_add_u32 v161, v162, 3, v161
    v_cvt_f32_u32 v161, v161
    v_mul_f32 v161, v161, v160
    v_fmamk_f32 v88, v160, 0x0, v161
    v_fmamk_f32 v162, v160, 0x40000000, v161
    v_sin_f32 v104, v88
    v_sin_f32 v163, v162
    v_cos_f32 v88, v88
    v_cos_f32 v162, v162
    v_cvt_pk_f16_f32 v104, v104, v163
    v_cvt_pk_f16_f32 v88, v88, v162
    v_fmamk_f32 v89, v160, 0x40800000, v161
    v_fmamk_f32 v162, v160, 0x40c00000, v161
    v_sin_f32 v105, v89
    v_sin_f32 v163, v162
    v_cos_f32 v89, v89
    v_cos_f32 v162, v162
    v_cvt_pk_f16_f32 v105, v105, v163
    v_cvt_pk_f16_f32 v89, v89, v162
    v_fmamk_f32 v90, v160, 0x41800000, v161
    v_fmamk_f32 v162, v160, 0x41900000, v161
    v_sin_f32 v106, v90
    v_sin_f32 v163, v162
    v_cos_f32 v90, v90
    v_cos_f32 v162, v162
    v_cvt_pk_f16_f32 v106, v106, v163
    v_cvt_pk_f16_f32 v90, v90, v162
    v_fmamk_f32 v91, v160, 0x41a00000, v161
    v_fmamk_f32 v162, v160, 0x41b00000, v161
    v_sin_f32 v107, v91
    v_sin_f32 v163, v162
    v_cos_f32 v91, v91
    v_cos_f32 v162, v162
    v_cvt_pk_f16_f32 v107, v107, v163
    v_cvt_pk_f16_f32 v91, v91, v162
    v_fmamk_f32 v92, v160, 0x42800000, v161
    v_fmamk_f32 v162, v160, 0x42840000, v161
    v_sin_f32 v108, v92
    v_sin_f32 v163, v162
    v_cos_f32 v92, v92
    v_cos_f32 v162, v162
    v_cvt_pk_f16_f32 v108, v108, v163
    v_cvt_pk_f16_f32 v92, v92, v162
    v_fmamk_f32 v93, v160, 0x42880000, v161
    v_fmamk_f32 v162, v160, 0x428c0000, v161
    v_sin_f32 v109, v93
    v_sin_f32 v163, v162
    v_cos_f32 v93, v93
    v_cos_f32 v162, v162
    v_cvt_pk_f16_f32 v109, v109, v163
    v_cvt_pk_f16_f32 v93, v93, v162
    v_fmamk_f32 v94, v160, 0x42a00000, v161
    v_fmamk_f32 v162, v160, 0x42a40000, v161
    v_sin_f32 v110, v94
    v_sin_f32 v163, v162
    v_cos_f32 v94, v94
    v_cos_f32 v162, v162
    v_cvt_pk_f16_f32 v110, v110, v163
    v_cvt_pk_f16_f32 v94, v94, v162
    v_fmamk_f32 v95, v160, 0x42a80000, v161
    v_fmamk_f32 v162, v160, 0x42ac0000, v161
    v_sin_f32 v111, v95
    v_sin_f32 v163, v162
    v_cos_f32 v95, v95
    v_cos_f32 v162, v162
    v_cvt_pk_f16_f32 v111, v111, v163
    v_cvt_pk_f16_f32 v95, v95, v162
    v_fmamk_f32 v96, v160, 0x3f800000, v161
    v_fmamk_f32 v162, v160, 0x40400000, v161
    v_sin_f32 v112, v96
    v_sin_f32 v163, v162
    v_cos_f32 v96, v96
    v_cos_f32 v162, v162
    v_cvt_pk_f16_f32 v112, v112, v163
    v_cvt_pk_f16_f32 v96, v96, v162
    v_fmamk_f32 v97, v160, 0x40a00000, v161
    v_fmamk_f32 v162, v160, 0x40e00000, v161
    v_sin_f32 v113, v97
    v_sin_f32 v163, v162
    v_cos_f32 v97, v97
    v_cos_f32 v162, v162
    v_cvt_pk_f16_f32 v113, v113, v163
    v_cvt_pk_f16_f32 v97, v97, v162
    v_fmamk_f32 v98, v160, 0x41880000, v161
    v_fmamk_f32 v162, v160, 0x41980000, v161
    v_sin_f32 v114, v98
    v_sin_f32 v163, v162
    v_cos_f32 v98, v98
    v_cos_f32 v162, v162
    v_cvt_pk_f16_f32 v114, v114, v163
    v_cvt_pk_f16_f32 v98, v98, v162
    v_fmamk_f32 v99, v160, 0x41a80000, v161
    v_fmamk_f32 v162, v160, 0x41b80000, v161
    v_sin_f32 v115, v99
    v_sin_f32 v163, v162
    v_cos_f32 v99, v99
    v_cos_f32 v162, v162
    v_cvt_pk_f16_f32 v115, v115, v163
    v_cvt_pk_f16_f32 v99, v99, v162
    v_fmamk_f32 v100, v160, 0x42820000, v161
    v_fmamk_f32 v162, v160, 0x42860000, v161
    v_sin_f32 v116, v100
    v_sin_f32 v163, v162
    v_cos_f32 v100, v100
    v_cos_f32 v162, v162
    v_cvt_pk_f16_f32 v116, v116, v163
    v_cvt_pk_f16_f32 v100, v100, v162
    v_fmamk_f32 v101, v160, 0x428a0000, v161
    v_fmamk_f32 v162, v160, 0x428e0000, v161
    v_sin_f32 v117, v101
    v_sin_f32 v163, v162
    v_cos_f32 v101, v101
    v_cos_f32 v162, v162
    v_cvt_pk_f16_f32 v117, v117, v163
    v_cvt_pk_f16_f32 v101, v101, v162
    v_fmamk_f32 v102, v160, 0x42a20000, v161
    v_fmamk_f32 v162, v160, 0x42a60000, v161
    v_sin_f32 v118, v102
    v_sin_f32 v163, v162
    v_cos_f32 v102, v102
    v_cos_f32 v162, v162
    v_cvt_pk_f16_f32 v118, v118, v163
    v_cvt_pk_f16_f32 v102, v102, v162
    v_fmamk_f32 v103, v160, 0x42aa0000, v161
    v_fmamk_f32 v162, v160, 0x42ae0000, v161
    v_sin_f32 v119, v103
    v_sin_f32 v163, v162
    v_cos_f32 v103, v103
    v_cos_f32 v162, v162
    v_cvt_pk_f16_f32 v119, v119, v163
    v_cvt_pk_f16_f32 v103, v103, v162
    v_cmp_gt_u32 vcc, 16, v2
    v_and_b32 v162, 1, v2
    v_lshlrev_b32 v162, 15, v162
    v_or_b32 v162, 0x3c00, v162
    v_and_b32 v160, 0xffff0000, v104
    v_or_b32 v162, v162, v160
    v_cndmask_b32 v104, v104, v162, vcc
    s_mul_i32 s51, s46, 528384
    s_add_u32 s51, s51, 2097152
    s_mul_i32 s54, s47, 16512
    s_lshl_b32 s32, s30, 12
    s_add_u32 s50, s51, s54
    s_add_u32 s50, s50, s32
    s_add_u32 s55, s47, 1
    s_and_b32 s55, s55, 31
    s_mul_i32 s55, s55, 16512
    v_add_u32 v250, s32, v3
    v_add_u32 v199, s76, v3
    v_lshl_add_u32 v200, v2, 7, s32
    v_and_b32 v1, 2, v2
    v_lshl_add_u32 v200, v1, 3, v200
    v_and_b32 v1, 0x70, v3
    v_add_u32 v1, 16384, v1
    s_mov_b32 vcc_lo, 0
    s_mov_b32 vcc_hi, -1
    v_cndmask_b32 v200, v200, v1, vcc
    s_mov_b32 vcc_hi, 0xff
    v_mov_b32 v1, s55
    v_mov_b32 v201, s54
    v_cndmask_b32 v1, v1, v201, vcc
    v_mov_b32 v201, 16640
    v_cndmask_b32 v201, v201, v0, vcc
    v_add_u32 v201, v201, v200
    v_add_u32 v200, v1, v200
    v_lshrrev_b32 v251, 5, v2
    v_lshlrev_b32 v251, 11, v251
    v_bfe_u32 v1, v2, 2, 3
    v_lshl_add_u32 v251, v1, 7, v251
    v_and_b32 v1, 3, v2
    v_lshl_add_u32 v251, v1, 5, v251
    v_bfe_u32 v1, v2, 3, 1
    v_lshl_add_u32 v251, v1, 4, v251
    v_bfe_u32 v1, v2, 4, 1
    v_lshl_add_u32 v251, v1, 3, v251
    v_xor_b32 v252, 16, v251
    v_xor_b32 v253, 8, v251
    v_xor_b32 v254, 24, v251
    v_cmp_gt_u32 vcc, 4, v2
    v_mov_b32 v1, 16384
    s_nop 0
    v_cndmask_b32 v1, v0, v1, vcc
    v_add_u32 v206, v253, v1
    v_add_u32 v207, v254, v1
    s_mov_b32 vcc_lo, 0x88888888
    s_mov_b32 vcc_hi, 0x88888888
    v_mov_b32 v1, 16544
    v_cndmask_b32 v1, 32, v1, vcc
    v_add_u32 v202, v251, v1
    v_add_u32 v203, v253, v1
    v_add_u32 v204, v206, v1
    s_waitcnt vmcnt(0)
L_stat_check:
    v_cmp_ne_u64 vcc, s[28:29], v[26:27]
    s_nop 0
    s_cbranch_vccz L_stat_got
    s_cmp_eq_u32 s35, 0
    s_cbranch_scc1 L_stat_got
    s_sub_u32 s35, s35, 1
    s_sleep 2
    s_mov_b64 exec, vcc
    buffer_load_dwordx4 v[24:27], v6, s[12:15], s49 offen sc1
    s_mov_b64 exec, -1
    s_waitcnt vmcnt(0)
    s_branch L_stat_check
L_stat_got:
    v_cndmask_b32 v24, v24, v25, s[88:89]
    v_mov_b32 v32, v24
    s_nop 1
    v_permlane32_swap_b32 v24, v32
    v_mov_b32 v28, v24
    v_mov_b32 v36, v32
    s_nop 0
    v_permlane16_swap_b32 v24, v28
    v_permlane16_swap_b32 v32, v36
    v_lshlrev_b32 v26, 16, v24
    v_and_b32 v24, 0xffff0000, v24
    v_rcp_f32 v24, v24
    v_lshlrev_b32 v30, 16, v28
    v_and_b32 v28, 0xffff0000, v28
    v_rcp_f32 v28, v28
    v_lshlrev_b32 v34, 16, v32
    v_and_b32 v32, 0xffff0000, v32
    v_rcp_f32 v32, v32
    v_lshlrev_b32 v38, 16, v36
    v_and_b32 v36, 0xffff0000, v36
    v_rcp_f32 v36, v36
    v_mul_f32 v24, 0xbfb8aa3b, v24
    v_mul_f32_e64 v26, -v26, v24
    v_mul_f32 v28, 0xbfb8aa3b, v28
    v_mul_f32_e64 v30, -v30, v28
    v_mul_f32 v32, 0xbfb8aa3b, v32
    v_mul_f32_e64 v34, -v34, v32
    v_mul_f32 v36, 0xbfb8aa3b, v36
    v_mul_f32_e64 v38, -v38, v36
    ds_read_b128 v[8:11], v208 offset:0
    ds_read_b128 v[12:15], v208 offset:1024
    s_waitcnt lgkmcnt(0)
    v_lshlrev_b32 v40, 16, v8
    v_and_b32 v41, 0xffff0000, v8
    v_lshlrev_b32 v42, 16, v9
    v_and_b32 v43, 0xffff0000, v9
    v_lshlrev_b32 v44, 16, v10
    v_and_b32 v45, 0xffff0000, v10
    v_lshlrev_b32 v46, 16, v11
    v_and_b32 v47, 0xffff0000, v11
    v_lshlrev_b32 v48, 16, v12
    v_and_b32 v55, 0xffff0000, v12
    v_lshlrev_b32 v54, 16, v13
    v_and_b32 v53, 0xffff0000, v13
    v_lshlrev_b32 v52, 16, v14
    v_and_b32 v51, 0xffff0000, v14
    v_lshlrev_b32_e64 v50, 16, v15
    v_and_b32 v49, 0xffff0000, v15
    v_pk_fma_f32 v[120:121], v[40:41], v[24:25], v[26:27] op_sel_hi:[1,0,0]
    v_pk_fma_f32 v[122:123], v[42:43], v[24:25], v[26:27] op_sel_hi:[1,0,0]
    v_pk_fma_f32 v[124:125], v[44:45], v[24:25], v[26:27] op_sel_hi:[1,0,0]
    v_pk_fma_f32 v[126:127], v[46:47], v[24:25], v[26:27] op_sel_hi:[1,0,0]
    v_pk_fma_f32 v[128:129], v[48:49], v[28:29], v[30:31] op_sel_hi:[1,0,0]
    v_pk_fma_f32 v[130:131], v[50:51], v[28:29], v[30:31] op_sel_hi:[1,0,0]
    v_pk_fma_f32 v[132:133], v[52:53], v[28:29], v[30:31] op_sel_hi:[1,0,0]
    v_pk_fma_f32 v[134:135], v[54:55], v[28:29], v[30:31] op_sel_hi:[1,0,0]
    v_exp_f32 v216, v120
    v_exp_f32 v217, v121
    v_exp_f32 v218, v122
    v_exp_f32 v219, v123
    v_exp_f32 v220, v124
    v_exp_f32 v221, v125
    v_exp_f32 v222, v126
    v_exp_f32 v223, v127
    v_exp_f32 v224, v128
    v_exp_f32 v225, v129
    v_exp_f32 v226, v130
    v_exp_f32 v227, v131
    v_exp_f32 v228, v132
    v_exp_f32 v229, v133
    v_exp_f32 v230, v134
    v_exp_f32 v231, v135
    v_pk_add_f32 v[216:217], v[216:217], 1.0 op_sel_hi:[1,0]
    v_pk_add_f32 v[218:219], v[218:219], 1.0 op_sel_hi:[1,0]
    v_pk_add_f32 v[220:221], v[220:221], 1.0 op_sel_hi:[1,0]
    v_pk_add_f32 v[222:223], v[222:223], 1.0 op_sel_hi:[1,0]
    v_pk_add_f32 v[224:225], v[224:225], 1.0 op_sel_hi:[1,0]
    v_pk_add_f32 v[226:227], v[226:227], 1.0 op_sel_hi:[1,0]
    v_pk_add_f32 v[228:229], v[228:229], 1.0 op_sel_hi:[1,0]
    v_pk_add_f32 v[230:231], v[230:231], 1.0 op_sel_hi:[1,0]
    v_rcp_f32 v216, v216
    v_rcp_f32 v217, v217
    v_rcp_f32 v218, v218
    v_rcp_f32 v219, v219
    v_rcp_f32 v220, v220
    v_rcp_f32 v221, v221
    v_rcp_f32 v222, v222
    v_rcp_f32 v223, v223
    v_rcp_f32 v224, v224
    v_rcp_f32 v225, v225
    v_rcp_f32 v226, v226
    v_rcp_f32 v227, v227
    v_rcp_f32 v228, v228
    v_rcp_f32 v229, v229
    v_rcp_f32 v230, v230
    v_rcp_f32 v231, v231
    v_pk_mul_f32 v[120:121], v[120:121], v[216:217]
    v_pk_mul_f32 v[122:123], v[122:123], v[218:219]
    v_pk_mul_f32 v[124:125], v[124:125], v[220:221]
    v_pk_mul_f32 v[126:127], v[126:127], v[222:223]
    v_pk_mul_f32 v[128:129], v[128:129], v[224:225]
    v_pk_mul_f32 v[130:131], v[130:131], v[226:227]
    v_pk_mul_f32 v[132:133], v[132:133], v[228:229]
    v_pk_mul_f32 v[134:135], v[134:135], v[230:231]
L_sync6:
    ds_read_b32 v1, v0 offset:42848
    s_add_u32 s92, s92, 1
    s_bitcmp1_b32 s92, 20
    s_cbranch_scc1 L_sync6x
    s_waitcnt lgkmcnt(0)
    v_readfirstlane_b32 s31, v1
    s_nop 0
    s_cmp_ge_u32 s31, 4
    s_cbranch_scc0 L_sync6
L_sync6x:
    s_add_u32 m0, s76, 2048
    s_nop 0
    buffer_load_dwordx4 v249, s[8:11], 0 offen lds
    s_add_u32 m0, s76, 3072
    s_nop 0
    buffer_load_dwordx4 v205, s[8:11], 0 offen lds
L_sync7:
    ds_read_b32 v1, v0 offset:42844
    ds_read_b32 v198, v0 offset:41556
    s_add_u32 s92, s92, 1
    s_bitcmp1_b32 s92, 20
    s_cbranch_scc1 L_sync7x
    s_waitcnt lgkmcnt(1)
    v_readfirstlane_b32 s31, v1
    s_nop 0
    s_cmp_ge_u32 s31, 1
    s_cbranch_scc0 L_sync7
L_sync7x:
    v_and_b32 v6, 48, v2
    v_lshlrev_b32 v6, 1, v6
    v_mov_b32 v209, 2147483392
    s_waitcnt lgkmcnt(0)
    v_readfirstlane_b32 s33, v198
    s_nop 0
    s_andn2_b32 s33, 0x7ff, s33
    s_sub_u32 s31, 0, s33
    s_and_b32 s31, s31, 2047
    s_sub_u32 s32, s33, 1024
    s_sub_u32 s34, s31, 1024
    v_cmp_eq_u32 vcc, s33, v7
    v_cmp_eq_u32 s[54:55], s33, v248
    s_nop 0
    v_cndmask_b32 v4, v4, v209, vcc
    v_cmp_eq_u32 vcc, s31, v7
    v_cmp_eq_u32 s[56:57], s31, v248
    s_nop 0
    v_cndmask_b32 v5, v5, v209, vcc
    v_cmp_eq_u32 vcc, s32, v7
    v_cmp_eq_u32 s[58:59], s32, v248
    s_nop 0
    v_cndmask_b32 v249, v249, v209, vcc
    v_cmp_eq_u32 vcc, s34, v7
    v_cmp_eq_u32 s[60:61], s34, v248
    s_nop 0
    v_cndmask_b32 v205, v205, v209, vcc
    s_or_b64 s[62:63], s[54:55], s[58:59]
    s_or_b64 s[64:65], s[56:57], s[60:61]
    s_waitcnt vmcnt(0)
    buffer_load_dwordx4 v[72:75], v3, s[12:15], s50 offen offset:0 sc1
    buffer_load_dwordx4 v[76:79], v3, s[12:15], s50 offen offset:1024 sc1
    buffer_load_dwordx4 v[80:83], v3, s[12:15], s50 offen offset:2048 sc1
    buffer_load_dwordx4 v[84:87], v3, s[12:15], s50 offen offset:3072 sc1
    s_mov_b32 exec_hi, 0x1ff
    buffer_load_dwordx4 v[212:215], v200, s[12:15], s51 offen sc1
    s_mov_b32 exec_hi, -1
    s_setprio 2
    ds_read_b128 v[16:19], v208 offset:2048
    ds_read_b128 v[20:23], v208 offset:3072
    s_waitcnt lgkmcnt(0)
    v_lshlrev_b32 v56, 16, v16
    v_and_b32 v57, 0xffff0000, v16
    v_lshlrev_b32 v58, 16, v17
    v_and_b32 v59, 0xffff0000, v17
    v_lshlrev_b32 v60, 16, v18
    v_and_b32 v61, 0xffff0000, v18
    v_lshlrev_b32 v62, 16, v19
    v_and_b32 v63, 0xffff0000, v19
    v_lshlrev_b32 v64, 16, v20
    v_and_b32 v71, 0xffff0000, v20
    v_lshlrev_b32 v70, 16, v21
    v_and_b32 v69, 0xffff0000, v21
    v_lshlrev_b32 v68, 16, v22
    v_and_b32 v67, 0xffff0000, v22
    v_lshlrev_b32 v66, 16, v23
    v_and_b32 v65, 0xffff0000, v23
    v_pk_fma_f32 v[136:137], v[56:57], v[32:33], v[34:35] op_sel_hi:[1,0,0]
    v_pk_fma_f32 v[138:139], v[58:59], v[32:33], v[34:35] op_sel_hi:[1,0,0]
    v_pk_fma_f32 v[140:141], v[60:61], v[32:33], v[34:35] op_sel_hi:[1,0,0]
    v_pk_fma_f32 v[142:143], v[62:63], v[32:33], v[34:35] op_sel_hi:[1,0,0]
    v_pk_fma_f32 v[144:145], v[64:65], v[36:37], v[38:39] op_sel_hi:[1,0,0]
    v_pk_fma_f32 v[146:147], v[66:67], v[36:37], v[38:39] op_sel_hi:[1,0,0]
    v_pk_fma_f32 v[148:149], v[68:69], v[36:37], v[38:39] op_sel_hi:[1,0,0]
    v_pk_fma_f32 v[150:151], v[70:71], v[36:37], v[38:39] op_sel_hi:[1,0,0]
    v_exp_f32 v232, v136
    v_exp_f32 v233, v137
    v_exp_f32 v234, v138
    v_exp_f32 v235, v139
    v_exp_f32 v236, v140
    v_exp_f32 v237, v141
    v_exp_f32 v238, v142
    v_exp_f32 v239, v143
    v_exp_f32 v240, v144
    v_exp_f32 v241, v145
    v_exp_f32 v242, v146
    v_exp_f32 v243, v147
    v_exp_f32 v244, v148
    v_exp_f32 v245, v149
    v_exp_f32 v246, v150
    v_exp_f32 v247, v151
    v_pk_add_f32 v[232:233], v[232:233], 1.0 op_sel_hi:[1,0]
    v_pk_add_f32 v[234:235], v[234:235], 1.0 op_sel_hi:[1,0]
    v_pk_add_f32 v[236:237], v[236:237], 1.0 op_sel_hi:[1,0]
    v_pk_add_f32 v[238:239], v[238:239], 1.0 op_sel_hi:[1,0]
    v_pk_add_f32 v[240:241], v[240:241], 1.0 op_sel_hi:[1,0]
    v_pk_add_f32 v[242:243], v[242:243], 1.0 op_sel_hi:[1,0]
    v_pk_add_f32 v[244:245], v[244:245], 1.0 op_sel_hi:[1,0]
    v_pk_add_f32 v[246:247], v[246:247], 1.0 op_sel_hi:[1,0]
    v_rcp_f32 v232, v232
    v_rcp_f32 v233, v233
    v_rcp_f32 v234, v234
    v_rcp_f32 v235, v235
    v_rcp_f32 v236, v236
    v_rcp_f32 v237, v237
    v_rcp_f32 v238, v238
    v_rcp_f32 v239, v239
    v_rcp_f32 v240, v240
    v_rcp_f32 v241, v241
    v_rcp_f32 v242, v242
    v_rcp_f32 v243, v243
    v_rcp_f32 v244, v244
    v_rcp_f32 v245, v245
    v_rcp_f32 v246, v246
    v_rcp_f32 v247, v247
    v_pk_mul_f32 v[136:137], v[136:137], v[232:233]
    v_pk_mul_f32 v[138:139], v[138:139], v[234:235]
    v_pk_mul_f32 v[140:141], v[140:141], v[236:237]
    v_pk_mul_f32 v[142:143], v[142:143], v[238:239]
    v_pk_mul_f32 v[144:145], v[144:145], v[240:241]
    v_pk_mul_f32 v[146:147], v[146:147], v[242:243]
    v_pk_mul_f32 v[148:149], v[148:149], v[244:245]
    v_pk_mul_f32 v[150:151], v[150:151], v[246:247]
L_z_wait:
    s_setprio 2
    s_waitcnt vmcnt(4)
    v_xor_b32 v160, v210, v72
    v_xor_b32 v161, v210, v73
    v_xor_b32 v162, v210, v74
    v_xor_b32 v163, v210, v75
    ds_write_b128 v250, v[160:163] offset:0
    v_or3_b32 v1, v160, v161, v162
    v_or_b32 v1, v1, v163
    s_waitcnt vmcnt(3)
    v_xor_b32 v164, v210, v76
    v_xor_b32 v165, v210, v77
    v_xor_b32 v166, v210, v78
    v_xor_b32 v167, v210, v79
    ds_write_b128 v250, v[164:167] offset:1024
    v_or3_b32 v1, v1, v164, v165
    v_or3_b32 v1, v1, v166, v167
    s_waitcnt vmcnt(2)
    v_xor_b32 v168, v210, v80
    v_xor_b32 v169, v210, v81
    v_xor_b32 v170, v210, v82
    v_xor_b32 v171, v210, v83
    ds_write_b128 v250, v[168:171] offset:2048
    v_or3_b32 v1, v1, v168, v169
    v_or3_b32 v1, v1, v170, v171
    s_waitcnt vmcnt(1)
    v_xor_b32 v172, v210, v84
    v_xor_b32 v173, v210, v85
    v_xor_b32 v174, v210, v86
    v_xor_b32 v175, v210, v87
    ds_write_b128 v250, v[172:175] offset:3072
    v_or3_b32 v1, v1, v172, v173
    v_or3_b32 v1, v1, v174, v175
    s_waitcnt vmcnt(0)
    v_xor_b32 v176, v210, v212
    v_xor_b32 v177, v210, v213
    v_xor_b32 v178, v210, v214
    v_xor_b32 v179, v210, v215
    s_mov_b32 exec_hi, 0x1ff
    ds_write_b128 v201, v[176:179]
    s_mov_b32 exec_hi, -1
    v_or3_b32 v1, v1, v176, v177
    v_or3_b32 v1, v1, v178, v179
    v_and_b32 v1, 0x30003, v1
    v_cmp_ne_u32 vcc, 0, v1
    s_nop 0
    s_cbranch_vccz L_z_got
    s_cmp_eq_u32 s35, 0
    s_cbranch_scc1 L_z_got
    s_sub_u32 s35, s35, 1
    s_sleep 2
    s_mov_b64 exec, vcc
    buffer_load_dwordx4 v[72:75], v3, s[12:15], s50 offen offset:0 sc1
    buffer_load_dwordx4 v[76:79], v3, s[12:15], s50 offen offset:1024 sc1
    buffer_load_dwordx4 v[80:83], v3, s[12:15], s50 offen offset:2048 sc1
    buffer_load_dwordx4 v[84:87], v3, s[12:15], s50 offen offset:3072 sc1
    s_and_b32 exec_hi, exec_hi, 0x1ff
    s_or_b32 exec_lo, exec_lo, 1
    buffer_load_dwordx4 v[212:215], v200, s[12:15], s51 offen sc1
    s_mov_b64 exec, -1
    s_waitcnt lgkmcnt(0)
    s_branch L_z_wait
L_z_got:
    s_mov_b64 exec, 1
    ds_add_u32 v0, v255 offset:42832
    s_mov_b64 exec, -1
L_sync8:
    ds_read_b32 v1, v0 offset:42832
    ds_read_b64_tr_b16 v[152:153], v251 offset:0
    ds_read_b64_tr_b16 v[154:155], v251 offset:1024
    ds_read_b64_tr_b16 v[156:157], v252 offset:0
    ds_read_b64_tr_b16 v[158:159], v252 offset:1024
    s_add_u32 s92, s92, 1
    s_bitcmp1_b32 s92, 20
    s_cbranch_scc1 L_sync8x
    s_waitcnt lgkmcnt(4)
    v_readfirstlane_b32 s31, v1
    s_nop 0
    s_cmp_ge_u32 s31, 4
    s_cbranch_scc0 L_sync8
L_sync8x:
    ds_read_b64_tr_b16 v[160:161], v251 offset:4096
    ds_read_b64_tr_b16 v[162:163], v251 offset:5120
    ds_read_b64_tr_b16 v[164:165], v252 offset:4096
    ds_read_b64_tr_b16 v[166:167], v252 offset:5120
    ds_read_b64_tr_b16 v[168:169], v251 offset:8192
    ds_read_b64_tr_b16 v[170:171], v251 offset:9216
    ds_read_b64_tr_b16 v[172:173], v252 offset:8192
    ds_read_b64_tr_b16 v[174:175], v252 offset:9216
    s_waitcnt lgkmcnt(8)
    v_mfma_f32_16x16x32_f16 v[216:219], v[152:155], v[88:91], 0
    v_mfma_f32_16x16x32_f16 v[220:223], v[156:159], v[88:91], 0
    ds_read_b64_tr_b16 v[176:177], v251 offset:12288
    ds_read_b64_tr_b16 v[178:179], v251 offset:13312
    ds_read_b64_tr_b16 v[180:181], v252 offset:12288
    ds_read_b64_tr_b16 v[182:183], v252 offset:13312
    s_waitcnt lgkmcnt(8)
    v_mfma_f32_16x16x32_f16 v[216:219], v[160:163], v[92:95], v[216:219]
    v_mfma_f32_16x16x32_f16 v[220:223], v[164:167], v[92:95], v[220:223]
    ds_read_b64_tr_b16 v[152:153], v206 offset:0
    ds_read_b64_tr_b16 v[154:155], v253 offset:1024
    ds_read_b64_tr_b16 v[156:157], v207 offset:0
    ds_read_b64_tr_b16 v[158:159], v254 offset:1024
    s_waitcnt lgkmcnt(8)
    v_mfma_f32_16x16x32_f16 v[224:227], v[168:171], v[96:99], 0
    v_mfma_f32_16x16x32_f16 v[228:231], v[172:175], v[96:99], 0
    ds_read_b64_tr_b16 v[160:161], v253 offset:4096
    ds_read_b64_tr_b16 v[162:163], v253 offset:5120
    ds_read_b64_tr_b16 v[164:165], v254 offset:4096
    ds_read_b64_tr_b16 v[166:167], v254 offset:5120
    s_waitcnt lgkmcnt(8)
    v_mfma_f32_16x16x32_f16 v[224:227], v[176:179], v[100:103], v[224:227]
    v_mfma_f32_16x16x32_f16 v[228:231], v[180:183], v[100:103], v[228:231]
    ds_read_b64_tr_b16 v[168:169], v253 offset:8192
    ds_read_b64_tr_b16 v[170:171], v253 offset:9216
    ds_read_b64_tr_b16 v[172:173], v254 offset:8192
    ds_read_b64_tr_b16 v[174:175], v254 offset:9216
    s_waitcnt lgkmcnt(8)
    v_mfma_f32_16x16x32_f16 v[216:219], v[152:155], v[104:107], v[216:219]
    v_mfma_f32_16x16x32_f16 v[220:223], v[156:159], v[104:107], v[220:223]
    ds_read_b64_tr_b16 v[176:177], v253 offset:12288
    ds_read_b64_tr_b16 v[178:179], v253 offset:13312
    ds_read_b64_tr_b16 v[180:181], v254 offset:12288
    ds_read_b64_tr_b16 v[182:183], v254 offset:13312
    s_waitcnt lgkmcnt(8)
    v_mfma_f32_16x16x32_f16 v[216:219], v[160:163], v[108:111], v[216:219]
    v_mfma_f32_16x16x32_f16 v[220:223], v[164:167], v[108:111], v[220:223]
    ds_read_b64_tr_b16 v[72:73], v202 offset:0
    ds_read_b64_tr_b16 v[74:75], v202 offset:1024
    ds_read_b64_tr_b16 v[76:77], v202 offset:4096
    ds_read_b64_tr_b16 v[78:79], v202 offset:5120
    s_waitcnt lgkmcnt(8)
    v_mfma_f32_16x16x32_f16 v[224:227], v[168:171], v[112:115], v[224:227]
    v_mfma_f32_16x16x32_f16 v[228:231], v[172:175], v[112:115], v[228:231]
    ds_read_b64_tr_b16 v[80:81], v202 offset:8192
    ds_read_b64_tr_b16 v[82:83], v202 offset:9216
    ds_read_b64_tr_b16 v[84:85], v202 offset:12288
    ds_read_b64_tr_b16 v[86:87], v202 offset:13312
    s_waitcnt lgkmcnt(8)
    v_mfma_f32_16x16x32_f16 v[224:227], v[176:179], v[116:119], v[224:227]
    v_mfma_f32_16x16x32_f16 v[228:231], v[180:183], v[116:119], v[228:231]
    ds_read_b64_tr_b16 v[240:241], v204 offset:0
    ds_read_b64_tr_b16 v[242:243], v203 offset:1024
    ds_read_b64_tr_b16 v[244:245], v203 offset:4096
    ds_read_b64_tr_b16 v[246:247], v203 offset:5120
    s_waitcnt lgkmcnt(8)
    ds_read_b64_tr_b16 v[184:185], v203 offset:8192
    ds_read_b64_tr_b16 v[186:187], v203 offset:9216
    ds_read_b64_tr_b16 v[188:189], v203 offset:12288
    ds_read_b64_tr_b16 v[190:191], v203 offset:13312
    v_mfma_f32_16x16x32_f16 v[232:235], v[72:75], v[88:91], 0
    v_mfma_f32_16x16x32_f16 v[232:235], v[76:79], v[92:95], v[232:235]
    s_waitcnt lgkmcnt(4)
    v_mfma_f32_16x16x32_f16 v[236:239], v[80:83], v[96:99], 0
    v_mfma_f32_16x16x32_f16 v[236:239], v[84:87], v[100:103], v[236:239]
    v_pk_add_f32 v[152:153], v[216:217], v[224:225]
    v_pk_add_f32 v[154:155], v[218:219], v[226:227]
    v_pk_add_f32 v[156:157], v[220:221], v[228:229]
    v_pk_add_f32 v[158:159], v[222:223], v[230:231]
    v_mfma_f32_16x16x32_f16 v[232:235], v[240:243], v[104:107], v[232:235]
    v_mfma_f32_16x16x32_f16 v[232:235], v[244:247], v[108:111], v[232:235]
    v_pk_fma_f32 v[40:41], v[152:153], v[120:121], v[40:41]
    v_pk_fma_f32 v[42:43], v[154:155], v[122:123], v[42:43]
    v_pk_fma_f32 v[44:45], v[156:157], v[124:125], v[44:45]
    v_pk_fma_f32 v[46:47], v[158:159], v[126:127], v[46:47]
    s_waitcnt lgkmcnt(0)
    s_nop 0
    v_mfma_f32_16x16x32_f16 v[236:239], v[184:187], v[112:115], v[236:239]
    v_mfma_f32_16x16x32_f16 v[236:239], v[188:191], v[116:119], v[236:239]
    v_cvt_pk_bf16_f32 v8, v40, v41
    v_cvt_pk_bf16_f32 v9, v42, v43
    v_cvt_pk_bf16_f32 v10, v44, v45
    v_cvt_pk_bf16_f32 v11, v46, v47
    ds_write_b128 v208, v[8:11] offset:0
    ds_read_b128 v[24:27], v199 offset:0
    v_pk_add_f32 v[160:161], v[216:217], v[224:225] neg_lo:[0,1] neg_hi:[0,1]
    v_pk_add_f32 v[162:163], v[218:219], v[226:227] neg_lo:[0,1] neg_hi:[0,1]
    v_pk_add_f32 v[164:165], v[220:221], v[228:229] neg_lo:[0,1] neg_hi:[0,1]
    v_pk_add_f32 v[166:167], v[222:223], v[230:231] neg_lo:[0,1] neg_hi:[0,1]
    s_cmp_eq_u64 s[62:63], 0
    s_cbranch_scc1 L_nodump0
    s_mov_b64 exec, s[54:55]
    ds_write_b128 v6, v[152:155] offset:42496
    ds_write_b128 v6, v[156:159] offset:42512
    s_mov_b64 exec, s[58:59]
    ds_write_b128 v6, v[160:163] offset:42496
    ds_write_b128 v6, v[164:167] offset:42512
    s_mov_b64 exec, 1
    ds_add_u32 v0, v255 offset:42836
    s_mov_b64 exec, -1
    s_waitcnt lgkmcnt(0)
L_nodump0:
    s_nop 0
    v_pk_fma_f32 v[56:57], v[160:161], v[136:137], v[56:57]
    v_pk_fma_f32 v[58:59], v[162:163], v[138:139], v[58:59]
    v_pk_fma_f32 v[60:61], v[164:165], v[140:141], v[60:61]
    v_pk_fma_f32 v[62:63], v[166:167], v[142:143], v[62:63]
    v_cvt_pk_bf16_f32 v16, v56, v57
    v_cvt_pk_bf16_f32 v17, v58, v59
    v_cvt_pk_bf16_f32 v18, v60, v61
    v_cvt_pk_bf16_f32 v19, v62, v63
    ds_write_b128 v208, v[16:19] offset:2048
    ds_read_b128 v[32:35], v199 offset:2048
    s_waitcnt lgkmcnt(2)
    buffer_store_dwordx4 v[24:27], v4, s[16:19], 0 offen sc1
    v_add_f32 v152, v232, v236
    v_sub_f32 v160, v232, v236
    s_cmp_eq_u64 s[64:65], 0
    s_cbranch_scc1 L_nodump1
    s_mov_b64 exec, s[56:57]
    ds_write_b128 v6, v[152:155] offset:42624
    ds_write_b128 v6, v[156:159] offset:42640
    s_mov_b64 exec, s[60:61]
    ds_write_b128 v6, v[160:163] offset:42624
    ds_write_b128 v6, v[164:167] offset:42640
    s_mov_b64 exec, 1
    ds_add_u32 v0, v255 offset:42864
    s_mov_b64 exec, -1
    s_waitcnt lgkmcnt(0)
L_nodump1:
    v_pk_fma_f32 v[48:49], v[152:153], v[128:129], v[48:49]
    v_pk_fma_f32 v[50:51], v[154:155], v[130:131], v[50:51]
    v_pk_fma_f32 v[52:53], v[156:157], v[132:133], v[52:53]
    v_pk_fma_f32 v[54:55], v[158:159], v[134:135], v[54:55]
    v_cvt_pk_bf16_f32 v12, v48, v55
    v_cvt_pk_bf16_f32 v13, v54, v53
    v_cvt_pk_bf16_f32 v14, v52, v51
    v_cvt_pk_bf16_f32 v15, v50, v49
    ds_write_b128 v208, v[12:15] offset:1024
    ds_read_b128 v[28:31], v199 offset:1024
    s_waitcnt lgkmcnt(2)
    s_nop 0
    buffer_store_dwordx4 v[32:35], v249, s[16:19], 0 offen sc1
    v_pk_fma_f32 v[64:65], v[160:161], v[144:145], v[64:65]
    v_pk_fma_f32 v[66:67], v[162:163], v[146:147], v[66:67]
    v_pk_fma_f32 v[68:69], v[164:165], v[148:149], v[68:69]
    v_pk_fma_f32 v[70:71], v[166:167], v[150:151], v[70:71]
    v_cvt_pk_bf16_f32 v20, v64, v71
    v_cvt_pk_bf16_f32 v21, v70, v69
    v_cvt_pk_bf16_f32 v22, v68, v67
    v_cvt_pk_bf16_f32 v23, v66, v65
    ds_write_b128 v208, v[20:23] offset:3072
    ds_read_b128 v[36:39], v199 offset:3072
    s_waitcnt lgkmcnt(2)
    buffer_store_dwordx4 v[28:31], v5, s[16:19], 0 offen sc1
    s_waitcnt lgkmcnt(0)
    buffer_store_dwordx4 v[36:39], v205, s[16:19], 0 offen sc1
    s_branch L_fin
L_dma_done:
    s_setprio 0
    s_lshr_b32 s31, s47, 2
    s_andn2_b32 s31, s31, s75
    s_add_u32 s50, s31, s46
    s_lshl_b32 s31, s50, 17
    s_bfe_u32 s32, s2, 0x20003
    s_lshl_b32 s32, s32, 2
    s_add_u32 s51, s32, s30
    s_lshl_b32 s32, s51, 7
    s_add_u32 s31, s31, s32
    v_lshrrev_b32 v6, 3, v2
    v_lshlrev_b32 v6, 11, v6
    v_and_b32 v7, 0x70, v3
    v_and_b32 v11, 16, v2
    v_lshlrev_b32 v11, 1, v11
    v_xor_b32 v11, v11, v7
    v_add3_u32 v6, v6, v11, s31
    v_xor_b32 v11, 64, v6
    s_lshl_b32 s74, s30, 13
    s_cmp_lt_u32 s30, 2
    s_mov_b32 s31, 125952
    s_cselect_b32 s31, 60416, s31
    s_add_u32 s74, s74, s31
    s_mov_b32 s60, 4096
    s_mov_b32 s61, 8192
    s_mov_b32 s62, 12288
    v_bfe_u32 v8, v2, 2, 3
    v_lshlrev_b32 v9, 5, v8
    s_lshl_b32 s31, s30, 6
    v_xor_b32 v9, s31, v9
    v_bfe_u32 v8, v2, 2, 2
    v_lshl_add_u32 v9, v8, 8, v9
    v_lshrrev_b32 v8, 4, v2
    v_lshl_add_u32 v9, v8, 11, v9
    v_and_b32 v10, 3, v2
    v_lshl_add_u32 v9, v10, 3, v9
    v_add_u32 v9, 76800, v9
    v_xor_b32 v10, 32, v9
    v_lshlrev_b32 v8, 4, v8
    s_lshr_b32 s31, s30, 1
    s_and_b32 s32, s31, s75
    s_lshl_b32 s32, s32, 8
    v_add_u32 v8, s32, v8
    s_cmp_eq_u32 s75, 0
    s_cselect_b32 s32, 12, 9
    s_lshl_b32 s31, s31, s32
    s_lshl_b32 s32, s46, 3
    s_add_u32 s32, s32, s47
    s_lshl_b32 s32, s32, 9
    s_add_u32 s31, s31, s32
    s_and_b32 s32, s30, 1
    s_lshl_b32 s32, s32, 8
    s_add_u32 s31, s31, s32
    s_add_u32 s31, s31, 262144
    v_lshl_add_u32 v13, v2, 3, s31
    s_waitcnt lgkmcnt(0)
    s_add_u32 s28, s28, 0x7f4a7c15
    s_addc_u32 s29, s29, 0x9e3779b9
    s_and_b32 s31, s28, 0xff
    v_mov_b32 v14, s31
    s_mov_b32 s49, 0xffffff00
    s_cmp_lg_u32 s30, 2
    s_cbranch_scc1 L_no_tlb
    s_mov_b32 s52, s44
    s_mov_b32 s53, s45
    s_mov_b32 s54, 0x400000
    s_mov_b32 s55, 0x00020000
    v_lshlrev_b32 v250, 18, v2
    v_min_u32 v250, 0x3ffffc, v250
    s_mov_b32 exec_lo, 0x1ffff
    s_mov_b32 exec_hi, 0x0
    buffer_load_dword v252, v250, s[52:55], 0 offen
    s_mov_b64 exec, 0x3f
    v_lshlrev_b32 v250, 20, v2
    v_add_u32 v250, 753664, v250
    v_min_u32 v250, 4491392, v250
    buffer_load_dword v251, v250, s[12:15], 0 offen
    s_mov_b64 exec, 3
    v_mul_u32_u24 v250, 0x1f800, v2
    v_add_u32 v250, v250, v6
    buffer_load_dword v253, v250, s[24:27], 0 offen
    s_mov_b64 exec, -1
L_no_tlb:
    s_cmp_lg_u32 s66, 0
    s_cbranch_scc1 L_tagged
    s_mov_b64 exec, 1
    ds_add_u32 v0, v255 offset:42872
    s_mov_b64 exec, -1
L_tagged:
    s_cmp_eq_u32 s30, 3
    s_cbranch_scc1 L_h1
    s_cmp_eq_u32 s66, 0
    s_cbranch_scc1 L_key
    s_cmp_lg_u32 s30, 0
    s_cbranch_scc1 L_follower
    s_setprio 3
    s_waitcnt vmcnt(16)
    s_mov_b64 exec, 1
    ds_add_u32 v0, v255 offset:42868
    s_mov_b64 exec, -1
    s_nop 0
    ds_read_b64_tr_b16 v[36:37], v9 offset:0
    ds_read_b64_tr_b16 v[38:39], v9 offset:1024
    ds_read_b64_tr_b16 v[40:41], v10 offset:0
    ds_read_b64_tr_b16 v[42:43], v10 offset:1024
    ds_read_b64_tr_b16 v[44:45], v9 offset:32768
    ds_read_b64_tr_b16 v[46:47], v9 offset:33792
    ds_read_b64_tr_b16 v[48:49], v10 offset:32768
    ds_read_b64_tr_b16 v[50:51], v10 offset:33792
    ds_read_b64_tr_b16 v[52:53], v9 offset:8192
    ds_read_b64_tr_b16 v[54:55], v9 offset:9216
    ds_read_b64_tr_b16 v[56:57], v10 offset:8192
    ds_read_b64_tr_b16 v[58:59], v10 offset:9216
    ds_read_b64_tr_b16 v[60:61], v9 offset:40960
    ds_read_b64_tr_b16 v[62:63], v9 offset:41984
    s_waitcnt lgkmcnt(12)
    ds_read_b64_tr_b16 v[64:65], v10 offset:40960
    ds_read_b64_tr_b16 v[66:67], v10 offset:41984
    s_waitcnt lgkmcnt(12)
    ds_read_b64_tr_b16 v[68:69], v9 offset:16384
    ds_read_b64_tr_b16 v[70:71], v9 offset:17408
    s_waitcnt lgkmcnt(12)
    ds_read_b64_tr_b16 v[72:73], v10 offset:16384
    ds_read_b64_tr_b16 v[74:75], v10 offset:17408
    s_waitcnt lgkmcnt(12)
    ds_read_b64_tr_b16 v[76:77], v9 offset:49152
    ds_read_b64_tr_b16 v[78:79], v9 offset:50176
    s_waitcnt lgkmcnt(12)
    ds_read_b64_tr_b16 v[80:81], v10 offset:49152
    ds_read_b64_tr_b16 v[82:83], v10 offset:50176
    s_waitcnt vmcnt(8)
    s_mov_b64 exec, 1
    ds_add_u32 v0, v255 offset:42868
    s_mov_b64 exec, -1
    s_branch L_d_first
L_follower:
    v_readfirstlane_b32 s52, v13
    s_and_b32 s32, s30, 1
    s_lshl_b32 s32, s32, 8
    s_sub_u32 s52, s52, s32
    s_lshl_b32 s31, s50, 12
    s_sub_u32 s31, s31, s32
    s_lshl_b32 s32, s51, 8
    s_add_u32 s31, s31, s32
    s_add_u32 s53, s31, 524288
    s_load_dword s54, s[12:13], s53
    s_load_dword s54, s[12:13], s52
    s_add_u32 s52, s52, 64
    s_add_u32 s53, s53, 64
    s_load_dword s54, s[12:13], s53
    s_load_dword s54, s[12:13], s52
    s_add_u32 s52, s52, 64
    s_add_u32 s53, s53, 64
    s_load_dword s54, s[12:13], s53
    s_load_dword s54, s[12:13], s52
    s_add_u32 s52, s52, 64
    s_add_u32 s53, s53, 64
    s_load_dword s54, s[12:13], s53
    s_load_dword s54, s[12:13], s52
    s_add_u32 s52, s52, 64
    s_add_u32 s53, s53, 64
    s_waitcnt lgkmcnt(0)
    s_load_dword s54, s[12:13], s53
    s_load_dword s54, s[12:13], s52
    s_add_u32 s52, s52, 64
    s_add_u32 s53, s53, 64
    s_load_dword s54, s[12:13], s53
    s_load_dword s54, s[12:13], s52
    s_add_u32 s52, s52, 64
    s_add_u32 s53, s53, 64
    s_load_dword s54, s[12:13], s53
    s_load_dword s54, s[12:13], s52
    s_add_u32 s52, s52, 64
    s_add_u32 s53, s53, 64
    s_load_dword s54, s[12:13], s53
    s_load_dword s54, s[12:13], s52
L_sync9:
    ds_read_b32 v1, v0 offset:42868
    s_add_u32 s92, s92, 1
    s_bitcmp1_b32 s92, 20
    s_cbranch_scc1 L_sync9x
    s_waitcnt lgkmcnt(0)
    v_readfirstlane_b32 s31, v1
    s_nop 0
    s_cmp_ge_u32 s31, 1
    s_cbranch_scc0 L_sync9
L_sync9x:
    s_setprio 3
    s_nop 0
    ds_read_b64_tr_b16 v[36:37], v9 offset:0
    ds_read_b64_tr_b16 v[38:39], v9 offset:1024
    ds_read_b64_tr_b16 v[40:41], v10 offset:0
    ds_read_b64_tr_b16 v[42:43], v10 offset:1024
    ds_read_b64_tr_b16 v[44:45], v9 offset:32768
    ds_read_b64_tr_b16 v[46:47], v9 offset:33792
    ds_read_b64_tr_b16 v[48:49], v10 offset:32768
    ds_read_b64_tr_b16 v[50:51], v10 offset:33792
    ds_read_b64_tr_b16 v[52:53], v9 offset:8192
    ds_read_b64_tr_b16 v[54:55], v9 offset:9216
    ds_read_b64_tr_b16 v[56:57], v10 offset:8192
    ds_read_b64_tr_b16 v[58:59], v10 offset:9216
    ds_read_b64_tr_b16 v[60:61], v9 offset:40960
    ds_read_b64_tr_b16 v[62:63], v9 offset:41984
    s_waitcnt lgkmcnt(12)
    ds_read_b64_tr_b16 v[64:65], v10 offset:40960
    ds_read_b64_tr_b16 v[66:67], v10 offset:41984
    s_waitcnt lgkmcnt(12)
    ds_read_b64_tr_b16 v[68:69], v9 offset:16384
    ds_read_b64_tr_b16 v[70:71], v9 offset:17408
    s_waitcnt lgkmcnt(12)
    ds_read_b64_tr_b16 v[72:73], v10 offset:16384
    ds_read_b64_tr_b16 v[74:75], v10 offset:17408
    s_waitcnt lgkmcnt(12)
    ds_read_b64_tr_b16 v[76:77], v9 offset:49152
    ds_read_b64_tr_b16 v[78:79], v9 offset:50176
    s_waitcnt lgkmcnt(12)
    ds_read_b64_tr_b16 v[80:81], v10 offset:49152
    ds_read_b64_tr_b16 v[82:83], v10 offset:50176
    s_add_u32 s67, s30, 0
L_sync10:
    ds_read_b32 v1, v0 offset:42868
    s_add_u32 s92, s92, 1
    s_bitcmp1_b32 s92, 20
    s_cbranch_scc1 L_sync10x
    s_waitcnt lgkmcnt(0)
    v_readfirstlane_b32 s31, v1
    s_nop 0
    s_cmp_ge_u32 s31, s67
    s_cbranch_scc0 L_sync10
L_sync10x:
L_d_first:
    s_add_u32 m0, s74, 0
    s_mov_b32 s31, 0
    buffer_load_dwordx4 v6, s[24:27], s31 offen nt lds
    s_add_u32 m0, s74, 1024
    s_mov_b32 s31, 16384
    buffer_load_dwordx4 v11, s[24:27], s31 offen nt lds
    s_add_u32 m0, s74, 2048
    s_mov_b32 s31, 32768
    buffer_load_dwordx4 v6, s[24:27], s31 offen nt lds
    s_add_u32 m0, s74, 3072
    s_mov_b32 s31, 49152
    buffer_load_dwordx4 v11, s[24:27], s31 offen nt lds
    s_add_u32 m0, s74, 4096
    s_mov_b32 s31, 65536
    buffer_load_dwordx4 v6, s[24:27], s31 offen nt lds
    s_cmp_lg_u32 s30, 0
    s_cbranch_scc1 L_k3_waitp
    s_waitcnt vmcnt(5)
    s_mov_b64 exec, 1
    ds_add_u32 v0, v255 offset:42868
    s_mov_b64 exec, -1
L_k3_waitp:
    s_waitcnt lgkmcnt(4)
    s_branch L_sync11a
L_sync11:
    s_waitcnt lgkmcnt(0)
L_sync11a:
    ds_read_b32 v1, v0 offset:42868
    ds_read_b64_tr_b16 v[84:85], v9 offset:24576
    ds_read_b64_tr_b16 v[86:87], v9 offset:25600
    ds_read_b64_tr_b16 v[88:89], v10 offset:24576
    ds_read_b64_tr_b16 v[90:91], v10 offset:25600
    ds_read_b64_tr_b16 v[92:93], v9 offset:57344
    ds_read_b64_tr_b16 v[94:95], v9 offset:58368
    ds_read_b64_tr_b16 v[96:97], v10 offset:57344
    ds_read_b64_tr_b16 v[98:99], v10 offset:58368
    s_add_u32 s92, s92, 1
    s_bitcmp1_b32 s92, 20
    s_cbranch_scc1 L_sync11x
    s_waitcnt lgkmcnt(8)
    v_readfirstlane_b32 s31, v1
    s_nop 0
    s_cmp_ge_u32 s31, 3
    s_cbranch_scc0 L_sync11
L_sync11x:
L_key:
    s_waitcnt lgkmcnt(0)
L_sync12:
    ds_read_b32 v1, v0 offset:42844
    ds_read_b64 v[18:19], v0 offset:41552
    ds_read_b128 v[20:23], v8 offset:41600
    ds_read_b128 v[24:27], v8 offset:41664
    ds_read_b128 v[28:31], v8 offset:41728
    ds_read_b128 v[32:35], v8 offset:41792
    s_add_u32 s92, s92, 1
    s_bitcmp1_b32 s92, 20
    s_cbranch_scc1 L_sync12x
    s_waitcnt lgkmcnt(5)
    v_readfirstlane_b32 s31, v1
    s_nop 0
    s_cmp_ge_u32 s31, 1
    s_cbranch_scc0 L_sync12
L_sync12x:
    s_cmp_eq_u32 s66, 0
    s_cbranch_scc1 L_idle
    s_branch L_xs_ok
L_h1:
    s_mov_b32 s63, 4096
    s_lshl_b32 s31, s47, 8
    v_lshlrev_b32 v15, 3, v2
    v_add_u32 v16, s31, v15
    s_cmp_lg_u32 s66, 0
    s_cbranch_scc1 L_gate
L_sync13:
    ds_read_b32 v1, v0 offset:42828
    s_add_u32 s92, s92, 1
    s_bitcmp1_b32 s92, 20
    s_cbranch_scc1 L_sync13x
    s_waitcnt lgkmcnt(0)
    v_readfirstlane_b32 s31, v1
    s_nop 0
    s_cmp_ge_u32 s31, 4
    s_cbranch_scc0 L_sync13
L_sync13x:
    s_branch L_gate_open
L_gate:
L_sync14:
    ds_read_b32 v1, v0 offset:42828
    s_add_u32 s92, s92, 1
    s_bitcmp1_b32 s92, 20
    s_cbranch_scc1 L_sync14x
    s_waitcnt lgkmcnt(0)
    v_readfirstlane_b32 s31, v1
    s_nop 0
    s_cmp_ge_u32 s31, 1
    s_cbranch_scc0 L_sync14
L_sync14x:
L_gate_open:
    s_setprio 3
    buffer_load_dwordx4 v[20:23], v3, s[12:15], s63 offen offset:0 sc1
    buffer_load_dwordx4 v[24:27], v3, s[12:15], s63 offen offset:1024 sc1
    buffer_load_dwordx4 v[28:31], v3, s[12:15], s63 offen offset:2048 sc1
    buffer_load_dwordx4 v[32:35], v3, s[12:15], s63 offen offset:3072 sc1
    s_mov_b64 exec, 1
    ds_add_u32 v0, v255 offset:42860
    s_mov_b64 exec, -1
    s_waitcnt vmcnt(0)
L_mi_check:
    v_cmp_ne_u64 s[52:53], s[28:29], v[22:23]
    v_cmp_ne_u64 s[54:55], s[28:29], v[26:27]
    v_cmp_ne_u64 s[56:57], s[28:29], v[30:31]
    v_cmp_ne_u64 s[58:59], s[28:29], v[34:35]
    v_max_u32 v18, v21, v25
    v_max3_u32 v18, v18, v29, v33
    s_or_b64 s[64:65], s[52:53], s[54:55]
    s_or_b64 vcc, s[56:57], s[58:59]
    s_or_b64 s[64:65], s[64:65], vcc
    s_cbranch_scc0 L_mi_got
    s_cmp_eq_u32 s35, 0
    s_cbranch_scc1 L_mi_got
    s_sub_u32 s35, s35, 1
    s_sleep 2
    s_mov_b64 exec, s[52:53]
    s_cbranch_execz L_mi_skip0
    buffer_load_dwordx4 v[20:23], v3, s[12:15], s63 offen offset:0 sc1
L_mi_skip0:
    s_mov_b64 exec, s[54:55]
    s_cbranch_execz L_mi_skip1
    buffer_load_dwordx4 v[24:27], v3, s[12:15], s63 offen offset:1024 sc1
L_mi_skip1:
    s_mov_b64 exec, s[56:57]
    s_cbranch_execz L_mi_skip2
    buffer_load_dwordx4 v[28:31], v3, s[12:15], s63 offen offset:2048 sc1
L_mi_skip2:
    s_mov_b64 exec, s[58:59]
    s_cbranch_execz L_mi_skip3
    buffer_load_dwordx4 v[32:35], v3, s[12:15], s63 offen offset:3072 sc1
L_mi_skip3:
    s_mov_b64 exec, -1
    s_waitcnt vmcnt(0)
    s_branch L_mi_check
L_mi_got:
    v_max_u32_dpp v19, v18, v18 row_ror:1 row_mask:0xf bank_mask:0xf
    s_nop 1
    v_max_u32_dpp v19, v19, v19 row_ror:2 row_mask:0xf bank_mask:0xf
    s_nop 1
    v_max_u32_dpp v19, v19, v19 row_ror:4 row_mask:0xf bank_mask:0xf
    s_nop 1
    v_max_u32_dpp v19, v19, v19 row_ror:8 row_mask:0xf bank_mask:0xf
    s_nop 0
    v_readlane_b32 s33, v19, 0
    v_readlane_b32 s31, v19, 16
    v_readlane_b32 s32, v19, 32
    v_readlane_b32 s34, v19, 48
    s_max_u32 s33, s33, s31
    s_max_u32 s32, s32, s34
    s_max_u32 s33, s33, s32
    s_andn2_b32 s31, 0x7ff, s33
    s_lshl_b32 s48, s31, 11
    buffer_load_dwordx2 v[150:151], v16, s[8:11], s48 offen
    s_mov_b64 exec, 1
    ds_add_u32 v0, v255 offset:42840
    s_mov_b64 exec, -1
    v_cmp_eq_u32 s[52:53], s33, v25
    v_cmp_eq_u32 s[54:55], s33, v29
    v_cmp_eq_u32 s[56:57], s33, v33
    v_cmp_eq_u32 vcc, s33, v18
    v_cndmask_b32 v19, v20, v24, s[52:53]
    v_cndmask_b32 v19, v19, v28, s[54:55]
    v_cndmask_b32 v19, v19, v32, s[56:57]
    s_ff1_i32_b64 s32, vcc
    v_readlane_b32 s34, v19, s32
    v_mov_b32 v19, s33
    s_nop 0
    v_mov_b32 v18, s34
    ds_write_b64 v0, v[18:19] offset:41552
    s_lshl_b32 s52, s34, 16
    s_and_b32 s32, s34, 0xffff0000
    v_rcp_f32 v148, s32
    s_cmp_eq_u32 s66, 0
    s_cbranch_scc1 L_h1_idle
L_sync15:
    ds_read_b32 v1, v0 offset:42868
    s_add_u32 s92, s92, 1
    s_bitcmp1_b32 s92, 20
    s_cbranch_scc1 L_sync15x
    s_waitcnt lgkmcnt(0)
    v_readfirstlane_b32 s31, v1
    s_nop 0
    s_cmp_ge_u32 s31, 1
    s_cbranch_scc0 L_sync15
L_sync15x:
    s_nop 0
    ds_read_b64_tr_b16 v[36:37], v9 offset:0
    ds_read_b64_tr_b16 v[38:39], v9 offset:1024
    ds_read_b64_tr_b16 v[40:41], v10 offset:0
    ds_read_b64_tr_b16 v[42:43], v10 offset:1024
    ds_read_b64_tr_b16 v[44:45], v9 offset:32768
    ds_read_b64_tr_b16 v[46:47], v9 offset:33792
    ds_read_b64_tr_b16 v[48:49], v10 offset:32768
    ds_read_b64_tr_b16 v[50:51], v10 offset:33792
    ds_read_b64_tr_b16 v[52:53], v9 offset:8192
    ds_read_b64_tr_b16 v[54:55], v9 offset:9216
    ds_read_b64_tr_b16 v[56:57], v10 offset:8192
    ds_read_b64_tr_b16 v[58:59], v10 offset:9216
    ds_read_b64_tr_b16 v[60:61], v9 offset:40960
    ds_read_b64_tr_b16 v[62:63], v9 offset:41984
    s_waitcnt lgkmcnt(12)
    ds_read_b64_tr_b16 v[64:65], v10 offset:40960
    ds_read_b64_tr_b16 v[66:67], v10 offset:41984
    s_waitcnt lgkmcnt(12)
    ds_read_b64_tr_b16 v[68:69], v9 offset:16384
    ds_read_b64_tr_b16 v[70:71], v9 offset:17408
    s_waitcnt lgkmcnt(12)
    ds_read_b64_tr_b16 v[72:73], v10 offset:16384
    ds_read_b64_tr_b16 v[74:75], v10 offset:17408
    s_waitcnt lgkmcnt(12)
    ds_read_b64_tr_b16 v[76:77], v9 offset:49152
    ds_read_b64_tr_b16 v[78:79], v9 offset:50176
    s_waitcnt lgkmcnt(12)
    ds_read_b64_tr_b16 v[80:81], v10 offset:49152
    ds_read_b64_tr_b16 v[82:83], v10 offset:50176
    s_waitcnt lgkmcnt(4)
    s_branch L_sync16a
L_sync16:
    s_waitcnt lgkmcnt(0)
L_sync16a:
    ds_read_b32 v1, v0 offset:42868
    ds_read_b64_tr_b16 v[84:85], v9 offset:24576
    ds_read_b64_tr_b16 v[86:87], v9 offset:25600
    ds_read_b64_tr_b16 v[88:89], v10 offset:24576
    ds_read_b64_tr_b16 v[90:91], v10 offset:25600
    ds_read_b64_tr_b16 v[92:93], v9 offset:57344
    ds_read_b64_tr_b16 v[94:95], v9 offset:58368
    ds_read_b64_tr_b16 v[96:97], v10 offset:57344
    ds_read_b64_tr_b16 v[98:99], v10 offset:58368
    s_add_u32 s92, s92, 1
    s_bitcmp1_b32 s92, 20
    s_cbranch_scc1 L_sync16x
    s_waitcnt lgkmcnt(8)
    v_readfirstlane_b32 s31, v1
    s_nop 0
    s_cmp_ge_u32 s31, 3
    s_cbranch_scc0 L_sync16
L_sync16x:
    s_waitcnt vmcnt(0) lgkmcnt(0)
    s_branch L_h1_x
L_h1_idle:
    s_waitcnt vmcnt(0)
L_h1_x:
    v_lshlrev_b32 v20, 16, v150
    v_and_b32 v21, 0xffff0000, v150
    v_lshlrev_b32 v22, 16, v151
    v_and_b32 v23, 0xffff0000, v151
    v_pk_add_f32 v[20:21], v[20:21], s[52:53] op_sel_hi:[1,0] neg_lo:[0,1] neg_hi:[0,1]
    v_pk_add_f32 v[22:23], v[22:23], s[52:53] op_sel_hi:[1,0] neg_lo:[0,1] neg_hi:[0,1]
    v_cvt_pk_bf16_f32 v150, v20, v21
    v_cvt_pk_bf16_f32 v151, v22, v23
    v_lshlrev_b32 v20, 16, v150
    v_and_b32 v21, 0xffff0000, v150
    v_lshlrev_b32 v22, 16, v151
    v_and_b32 v23, 0xffff0000, v151
    v_pk_mul_f32 v[20:21], v[20:21], v[148:149] op_sel_hi:[1,0]
    v_pk_mul_f32 v[22:23], v[22:23], v[148:149] op_sel_hi:[1,0]
    v_cvt_pk_bf16_f32 v150, v20, v21
    v_cvt_pk_bf16_f32 v151, v22, v23
    ds_write_b64 v15, v[150:151] offset:41600
    s_mov_b64 exec, 1
    ds_add_u32 v0, v255 offset:42844
    s_mov_b64 exec, -1
    s_cmp_eq_u32 s66, 0
    s_cbranch_scc1 L_idle
    ds_read_b128 v[20:23], v8 offset:41600
    ds_read_b128 v[24:27], v8 offset:41664
    ds_read_b128 v[28:31], v8 offset:41728
    ds_read_b128 v[32:35], v8 offset:41792
    s_add_u32 m0, s74, 0
    s_mov_b32 s31, 0
    s_nop 0
    buffer_load_dwordx4 v6, s[24:27], s31 offen nt lds
    s_add_u32 m0, s74, 1024
    s_mov_b32 s31, 16384
    buffer_load_dwordx4 v11, s[24:27], s31 offen nt lds
    s_add_u32 m0, s74, 2048
    s_mov_b32 s31, 32768
    buffer_load_dwordx4 v6, s[24:27], s31 offen nt lds
    s_add_u32 m0, s74, 3072
    s_mov_b32 s31, 49152
    buffer_load_dwordx4 v11, s[24:27], s31 offen nt lds
    s_add_u32 m0, s74, 4096
    s_mov_b32 s31, 65536
    buffer_load_dwordx4 v6, s[24:27], s31 offen nt lds
L_xs_ok:
    s_waitcnt lgkmcnt(3)
    v_mfma_f32_16x16x32_bf16 v[132:135], v[20:23], v[36:39], 0
    v_mfma_f32_16x16x32_bf16 v[136:139], v[20:23], v[40:43], 0
    v_mfma_f32_16x16x32_bf16 v[140:143], v[20:23], v[44:47], 0
    v_mfma_f32_16x16x32_bf16 v[144:147], v[20:23], v[48:51], 0
    s_waitcnt lgkmcnt(2)
    v_mfma_f32_16x16x32_bf16 v[132:135], v[24:27], v[52:55], v[132:135]
    v_mfma_f32_16x16x32_bf16 v[136:139], v[24:27], v[56:59], v[136:139]
    v_mfma_f32_16x16x32_bf16 v[140:143], v[24:27], v[60:63], v[140:143]
    v_mfma_f32_16x16x32_bf16 v[144:147], v[24:27], v[64:67], v[144:147]
    s_waitcnt lgkmcnt(1)
    v_mfma_f32_16x16x32_bf16 v[132:135], v[28:31], v[68:71], v[132:135]
    v_mfma_f32_16x16x32_bf16 v[136:139], v[28:31], v[72:75], v[136:139]
    v_mfma_f32_16x16x32_bf16 v[140:143], v[28:31], v[76:79], v[140:143]
    v_mfma_f32_16x16x32_bf16 v[144:147], v[28:31], v[80:83], v[144:147]
    v_readfirstlane_b32 s33, v19
    v_readfirstlane_b32 s34, v18
    s_waitcnt lgkmcnt(0)
    v_mfma_f32_16x16x32_bf16 v[132:135], v[32:35], v[84:87], v[132:135]
    v_mfma_f32_16x16x32_bf16 v[136:139], v[32:35], v[88:91], v[136:139]
    v_mfma_f32_16x16x32_bf16 v[140:143], v[32:35], v[92:95], v[140:143]
    v_mfma_f32_16x16x32_bf16 v[144:147], v[32:35], v[96:99], v[144:147]
    s_mov_b32 vcc_lo, 0xffff0000
    s_mov_b32 vcc_hi, 0
    s_lshl_b32 s31, s50, 12
    s_lshl_b32 s32, s30, 7
    s_add_u32 s31, s31, s32
    s_add_u32 s31, s31, 262144
    v_lshrrev_b32 v15, 3, v2
    v_lshlrev_b32 v15, 9, v15
    v_add3_u32 v15, v15, v7, s31
    v_cndmask_b32 v26, v132, v136, vcc
    v_cndmask_b32 v27, v140, v144, vcc
    v_and_or_b32 v26, v26, s49, v14
    v_and_or_b32 v27, v27, s49, v14
    s_mov_b32 exec_hi, 0
    buffer_store_dwordx2 v[26:27], v13, s[12:15], 0 offen sc1
    s_mov_b64 exec, -1
    s_add_u32 m0, s74, 5120
    s_mov_b32 s31, 81920
    buffer_load_dwordx4 v11, s[24:27], s31 offen nt lds
    s_add_u32 m0, s74, 6144
    s_mov_b32 s31, 98304
    buffer_load_dwordx4 v6, s[24:27], s31 offen nt lds
    s_add_u32 m0, s74, 7168
    s_mov_b32 s31, 114688
    buffer_load_dwordx4 v11, s[24:27], s31 offen nt lds
L_d_done:
    s_mov_b64 exec, 1
    ds_add_u32 v0, v255 offset:42848
    s_mov_b64 exec, -1
    s_cmp_eq_u32 s30, 1
    s_cselect_b32 s31, s2, 0
    s_cmp_lt_u32 s31, 192
    s_cbranch_scc1 L_no_hint
    s_and_b32 s31, s2, 31
    s_lshl_b32 s31, s31, 7
    s_add_u32 s31, s31, 12288
    v_mov_b32 v250, s28
    v_mov_b32 v251, s29
    s_mov_b64 exec, 1
    buffer_store_dwordx2 v[250:251], v0, s[12:15], s31 offen sc1
    s_mov_b64 exec, -1
L_no_hint:
    s_setprio 3
    v_and_b32 v16, 7, v2
    v_lshlrev_b32 v16, 2, v16
    v_lshrrev_b32 v17, 5, v2
    v_lshl_add_u32 v16, v17, 1, v16
    s_lshl_b32 s31, s30, 5
    v_add_u32 v16, s31, v16
    v_and_b32 v17, 48, v2
    v_bfe_u32 v9, v2, 3, 2
    v_lshlrev_b32 v9, 5, v9
    v_bfe_u32 v10, v2, 2, 2
    v_lshl_add_u32 v9, v10, 7, v9
    v_lshl_add_u32 v9, v17, 6, v9
    v_and_b32 v10, 3, v2
    v_lshlrev_b32 v10, 3, v10
    v_add3_u32 v9, v9, v10, s74
    v_xor_b32 v10, 32, v9
    v_xor_b32 v12, 96, v9
    v_xor_b32 v8, 64, v9
    s_lshl_b32 s31, s50, 12
    s_lshl_b32 s32, s51, 8
    s_add_u32 s31, s31, s32
    s_add_u32 s31, s31, 524288
    v_lshl_add_u32 v18, v2, 2, s31
    s_waitcnt vmcnt(5)
    s_waitcnt lgkmcnt(4)
    ds_read_b64_tr_b16 v[100:101], v9 offset:0
    ds_read_b64_tr_b16 v[102:103], v9 offset:512
    ds_read_b64_tr_b16 v[104:105], v10 offset:0
    ds_read_b64_tr_b16 v[106:107], v10 offset:512
    ds_read_b64_tr_b16 v[108:109], v8 offset:0
    ds_read_b64_tr_b16 v[110:111], v8 offset:512
    ds_read_b64_tr_b16 v[112:113], v12 offset:0
    ds_read_b64_tr_b16 v[114:115], v12 offset:512
    s_waitcnt vmcnt(0)
    buffer_load_dwordx4 v[20:23], v15, s[12:15], 0 offen sc1
    s_waitcnt lgkmcnt(4)
    ds_read_b64_tr_b16 v[116:117], v9 offset:4096
    ds_read_b64_tr_b16 v[118:119], v9 offset:4608
    ds_read_b64_tr_b16 v[120:121], v10 offset:4096
    ds_read_b64_tr_b16 v[122:123], v10 offset:4608
    ds_read_b64_tr_b16 v[124:125], v8 offset:4096
    ds_read_b64_tr_b16 v[126:127], v8 offset:4608
    ds_read_b64_tr_b16 v[128:129], v12 offset:4096
    ds_read_b64_tr_b16 v[130:131], v12 offset:4608
    s_mov_b32 s54, 0
    s_branch L_hp_wait
L_hp_poll:
    buffer_load_dwordx4 v[20:23], v15, s[12:15], 0 offen sc1
L_hp_wait:
    s_waitcnt vmcnt(0)
    v_xor_b32 v20, v14, v20
    v_xor_b32 v21, v14, v21
    v_xor_b32 v22, v14, v22
    v_xor_b32 v23, v14, v23
    v_or3_b32 v24, v20, v21, v22
    v_or_b32 v24, v24, v23
    v_and_b32 v24, 0xff, v24
    v_cmp_ne_u32 vcc, 0, v24
    v_permlane16_swap_b32 v20, v21
    v_permlane16_swap_b32 v22, v23
    s_cbranch_vccz L_hp_got
    s_cmp_eq_u32 s35, 0
    s_cbranch_scc1 L_hp_got
    s_sub_u32 s35, s35, 1
    s_branch L_hp_poll
L_hp_got:
    v_add_f32 v20, v20, v21
    v_add_f32 v22, v22, v23
    s_nop 1
    v_permlane32_swap_b32 v20, v22
    v_add_f32 v20, v20, v22
    s_nop 1
    v_add_f32_dpp v21, v20, v20 row_ror:8 row_mask:0xf bank_mask:0xf
    v_add_f32_dpp v20, v20, v20 row_ror:8 row_mask:0xf bank_mask:0xf
    s_nop 1
    v_permlane16_swap_b32 v20, v21
    v_cvt_pk_bf16_f32 v20, v20, v21
    v_and_b32 v21, 0xffff0000, v20
    v_lshlrev_b32 v20, 16, v20
    v_mul_f32 v22, 0xbfb8aa3b, v20
    v_exp_f32 v22, v22
    s_nop 0
    v_add_f32 v22, 1.0, v22
    v_rcp_f32 v22, v22
    s_nop 0
    v_mul_f32 v20, v20, v22
    v_cvt_pk_bf16_f32 v20, v20, v20
    v_lshlrev_b32 v20, 16, v20
    v_mul_f32 v20, v20, v21
    v_cvt_pk_bf16_f32 v20, v20, v20
    ds_write_b16 v16, v20 offset:42368
    s_mov_b64 exec, 1
    ds_add_u32 v0, v255 offset:42852
    s_mov_b64 exec, -1
L_sync17:
    ds_read_b32 v1, v0 offset:42852
    ds_read_b128 v[28:31], v17 offset:42368
    ds_read_b128 v[32:35], v17 offset:42432
    s_add_u32 s92, s92, 1
    s_bitcmp1_b32 s92, 20
    s_cbranch_scc1 L_sync17x
    s_waitcnt lgkmcnt(2)
    v_readfirstlane_b32 s31, v1
    s_nop 0
    s_cmp_ge_u32 s31, 4
    s_cbranch_scc0 L_sync17
L_sync17x:
    s_waitcnt lgkmcnt(1)
    v_mfma_f32_16x16x32_bf16 v[36:39], v[28:31], v[100:103], 0
    v_mfma_f32_16x16x32_bf16 v[40:43], v[28:31], v[104:107], 0
    v_mfma_f32_16x16x32_bf16 v[44:47], v[28:31], v[108:111], 0
    v_mfma_f32_16x16x32_bf16 v[48:51], v[28:31], v[112:115], 0
    s_waitcnt lgkmcnt(0)
    v_mfma_f32_16x16x32_bf16 v[36:39], v[32:35], v[116:119], v[36:39]
    v_mfma_f32_16x16x32_bf16 v[40:43], v[32:35], v[120:123], v[40:43]
    v_mfma_f32_16x16x32_bf16 v[44:47], v[32:35], v[124:127], v[44:47]
    v_mfma_f32_16x16x32_bf16 v[48:51], v[32:35], v[128:131], v[48:51]
    s_mov_b32 vcc_lo, 0xffff0000
    s_mov_b32 vcc_hi, 0xffff0000
    s_mov_b32 s52, 0
    s_mov_b32 s53, -1
    s_nop 1
    v_cndmask_b32 v36, v36, v40, vcc
    s_nop 0
    v_cndmask_b32 v44, v44, v48, vcc
    v_cndmask_b32 v36, v36, v44, s[52:53]
    v_and_or_b32 v36, v36, s49, v14
    buffer_store_dword v36, v18, s[12:15], 0 offen sc1
    s_mov_b64 exec, 1
    ds_add_u32 v0, v255 offset:42856
    s_mov_b64 exec, -1
    s_branch L_owner
L_idle:
    s_mov_b64 exec, 1
    ds_add_u32 v0, v255 offset:42868
    s_mov_b64 exec, -1
    s_and_b32 s52, s2, 31
    s_lshl_b32 s52, s52, 7
    s_add_u32 s52, s52, 12288
L_hint:
    s_load_dwordx2 s[54:55], s[12:13], s52 glc
    s_waitcnt lgkmcnt(0)
    s_cmp_eq_u64 s[54:55], s[28:29]
    s_cbranch_scc1 L_hint_ok
    s_cmp_eq_u32 s35, 0
    s_cbranch_scc1 L_hint_ok
    s_sub_u32 s35, s35, 1
    s_sleep 4
    s_branch L_hint
L_hint_ok:
    s_mov_b64 exec, 1
    ds_add_u32 v0, v255 offset:42848
    s_mov_b64 exec, -1
    s_mov_b64 exec, 1
    ds_add_u32 v0, v255 offset:42852
    s_mov_b64 exec, -1
    s_mov_b64 exec, 1
    ds_add_u32 v0, v255 offset:42856
    s_mov_b64 exec, -1
L_idle_done:
    s_waitcnt lgkmcnt(0)
    v_readfirstlane_b32 s33, v19
    v_readfirstlane_b32 s34, v18
L_owner:
    s_setprio 1
    s_and_b32 s31, s2, 7
    s_sub_u32 s32, 8, s31
    s_min_u32 s46, s31, s32
    s_lshr_b32 s53, s31, 2
    s_lshr_b32 s47, s2, 3
    s_and_b32 s32, s47, 1
    s_and_b32 s31, s31, 3
    s_cselect_b32 s53, s53, s32
    s_cselect_b32 s31, 0, 1
    s_lshr_b32 s47, s47, s31
    s_lshl_b32 s53, s53, 4
    s_lshl_b32 s53, s53, 3
    s_add_u32 s53, s53, s46
    s_andn2_b32 s51, 0x7ff, s33
    s_mov_b32 s54, s51
    s_mov_b32 s55, 0
    s_mov_b32 s56, 0
    s_mov_b32 s16, s44
    s_mov_b32 s17, s45
    s_mov_b32 s18, 0x400000
    v_and_b32 v8, 31, v2
    v_lshlrev_b32 v15, 2, v8
    v_lshlrev_b32 v8, 1, v8
    v_mov_b32 v16, 0
L_seg:
    s_xor_b32 s31, s54, s53
    s_and_b32 s31, s31, 0x87
    s_cbranch_scc1 L_seg_next
    s_lshl_b32 s31, s51, 11
    s_lshl_b32 s32, s47, 6
    s_add_u32 s63, s31, s32
    buffer_load_ushort v9, v8, s[8:11], s63 offen
    v_lshrrev_b32 v4, 3, v2
    s_lshl_b32 s31, s30, 4
    v_add_u32 v4, s31, v4
    v_lshlrev_b32 v4, 12, v4
    s_lshl_b32 s31, s47, 7
    s_add_u32 s31, s31, 524288
    v_add3_u32 v4, v4, v7, s31
    s_mov_b32 s62, 32768
    v_mov_b32 v24, v14
    v_mov_b32 v25, v14
    v_mov_b32 v26, v14
    v_mov_b32 v27, v14
    v_lshrrev_b32 v5, 4, v2
    v_lshl_add_u32 v6, v5, 2, v7
    s_lshl_b32 s31, s30, 7
    s_add_u32 s31, s31, s55
    v_add_u32 v6, s31, v6
    s_ashr_i32 s31, s33, 31
    s_orn2_b32 s31, 0x80000000, s31
    s_xor_b32 s31, s31, s33
    s_and_b32 s31, s31, 0xfffff800
    v_cvt_pk_bf16_f32 v11, s31, s31
    v_lshlrev_b32 v11, 16, v11
    v_mul_f32 v11, 0xbfb8aa3b, v11
    v_exp_f32 v11, v11
    s_and_b32 s32, s34, 0xffff0000
    v_add_f32 v11, 1.0, v11
    v_rcp_f32 v11, v11
    v_rcp_f32 v12, s32
    v_cvt_pk_bf16_f32 v11, v11, v11
    v_lshlrev_b32 v11, 16, v11
    s_lshl_b32 s31, s34, 16
    s_waitcnt vmcnt(0)
    v_lshl_add_u32 v13, v8, 1, s55
    s_mov_b64 vcc, -1
    s_mov_b32 s56, 1
L_y_poll:
    s_mov_b64 exec, vcc
    buffer_load_dwordx4 v[20:23], v4, s[12:15], 0 offen sc1
    s_cmp_eq_u32 s30, 3
    s_cbranch_scc1 L_y_one
    buffer_load_dwordx4 v[24:27], v4, s[12:15], s62 offen sc1
L_y_one:
    s_mov_b64 exec, -1
    s_waitcnt vmcnt(0)
    v_xor_b32 v28, v14, v20
    v_xor_b32 v29, v14, v21
    v_xor_b32 v30, v14, v22
    v_xor_b32 v31, v14, v23
    v_xor_b32 v32, v14, v24
    v_xor_b32 v33, v14, v25
    v_xor_b32 v34, v14, v26
    v_xor_b32 v35, v14, v27
    v_or3_b32 v1, v28, v29, v30
    v_or3_b32 v1, v1, v31, v32
    v_or3_b32 v1, v1, v33, v34
    v_or_b32 v1, v1, v35
    v_and_b32 v1, 0xff, v1
    v_cmp_ne_u32 vcc, 0, v1
    v_pk_add_f32 v[28:29], v[28:29], v[32:33]
    v_pk_add_f32 v[30:31], v[30:31], v[34:35]
    s_cbranch_vccz L_y_got
    s_cmp_eq_u32 s35, 0
    s_cbranch_scc1 L_y_got
    s_sub_u32 s35, s35, 1
    s_branch L_y_poll
L_y_got:
    v_permlane16_swap_b32 v28, v29
    v_permlane16_swap_b32 v30, v31
    v_add_f32 v28, v28, v29
    v_add_f32 v30, v30, v31
    s_nop 1
    v_permlane32_swap_b32 v28, v30
    v_add_f32 v28, v28, v30
    s_nop 1
    v_add_f32_dpp v28, v28, v28 row_ror:8 row_mask:0xf bank_mask:0xf
    ds_write_b32 v6, v28 offset:43008
    s_mov_b64 exec, 1
    ds_add_u32 v16, v255 offset:42836
    s_mov_b64 exec, -1
    s_cmp_lg_u32 s30, 0
    s_cbranch_scc1 L_seg_next
    s_cmp_eq_u32 s47, 0
    s_cselect_b32 s32, 0, 2147483392
    v_mov_b32 v5, 2147483392
    v_writelane_b32 v5, s32, 0
    v_mov_b32 v18, s28
    v_mov_b32 v19, s29
    s_lshl_b32 s31, s34, 16
    v_lshlrev_b32 v9, 16, v9
    v_subrev_f32 v10, s31, v9
    v_cvt_pk_bf16_f32 v10, v10, v10
    v_lshlrev_b32 v10, 16, v10
    v_mul_f32 v10, v10, v12
    v_cvt_pk_bf16_f32 v10, v10, v10
    v_lshlrev_b32 v10, 16, v10
L_sync18:
    ds_read_b32 v1, v16 offset:42836
    ds_read_b32 v20, v13 offset:43008
    ds_read_b32 v21, v13 offset:43136
    ds_read_b32 v22, v13 offset:43264
    ds_read_b32 v23, v13 offset:43392
    ds_read_b32 v24, v15 offset:42496
    s_add_u32 s92, s92, 1
    s_bitcmp1_b32 s92, 20
    s_cbranch_scc1 L_sync18x
    s_waitcnt lgkmcnt(5)
    v_readfirstlane_b32 s31, v1
    s_nop 0
    s_cmp_ge_u32 s31, 5
    s_cbranch_scc0 L_sync18
L_sync18x:
    s_waitcnt lgkmcnt(0)
    v_add_f32 v20, v20, v21
    v_add_f32 v22, v22, v23
    v_add_f32 v20, v20, v22
    v_cvt_pk_bf16_f32 v20, v20, v20
    v_lshlrev_b32 v20, 16, v20
    v_mul_f32 v20, v20, v11
    v_cvt_pk_bf16_f32 v20, v20, v20
    v_lshlrev_b32 v20, 16, v20
    v_add_f32 v20, v20, v10
    v_cvt_pk_bf16_f32 v20, v20, v20
    v_lshlrev_b32 v20, 16, v20
    v_mul_f32 v1, 0xbfb8aa3b, v20
    v_mul_f32 v20, v1, v24
    v_exp_f32 v1, v1
    s_nop 0
    v_add_f32 v1, 1.0, v1
    v_rcp_f32 v1, v1
    s_mov_b32 exec_hi, 0
    v_fma_f32 v20, v20, v1, v9
    v_cvt_pk_bf16_f32 v20, v20, v20
    buffer_store_short v20, v8, s[16:19], s63 offen sc1
    buffer_store_dwordx2 v[18:19], v5, s[12:15], 0 offen sc1
    s_mov_b64 exec, -1
L_seg_next:
    s_cmp_lg_u32 s55, 0
    s_cbranch_scc1 L_seg_end
    s_mov_b32 s55, 512
    s_sub_u32 s54, 0, s51
    s_sub_u32 s47, 31, s47
    v_mov_b32 v16, 28
    v_and_b32 v15, 24, v2
    v_xor_b32 v15, 24, v15
    v_sub_u32 v1, 0, v2
    v_and_b32 v1, 7, v1
    v_add_u32 v15, v15, v1
    v_lshlrev_b32 v15, 2, v15
    v_add_u32 v15, 128, v15
    s_branch L_seg
L_seg_end:
L_fin:
L_exit:
    s_endpgm
L_code_end:
.section .rodata,"a"
.p2align 6
.amdhsa_kernel recurrent_scan__spectral_fnet__moe_arch_mod__prompt_kernel
  .amdhsa_next_free_vgpr 256
  .amdhsa_next_free_sgpr 94
  .amdhsa_accum_offset 256
  .amdhsa_group_segment_fixed_size 0
  .amdhsa_kernarg_size 104
  .amdhsa_user_sgpr_count 2
  .amdhsa_user_sgpr_kernarg_segment_ptr 1
  .amdhsa_system_sgpr_workgroup_id_x 1
  .amdhsa_float_denorm_mode_32 3
.end_amdhsa_kernel
```
